```python
import torch

def _softmax(x, axis=-1):
    return torch.softmax(x, dim=axis)
def _gelu(x):
    return torch.nn.functional.gelu(x, approximate="tanh")
def _silu(x):
    return torch.nn.functional.silu(x)
def _sigmoid(x):
    return torch.sigmoid(x)
def _layernorm(x, axis=-1, eps=1e-5):
    m = x.mean(dim=axis, keepdim=True)
    v = x.var(dim=axis, keepdim=True, unbiased=False)
    return (x - m) / torch.sqrt(v + eps)
def _scatter_add(tgt, idx, src, axis=0):
    return tgt.clone().index_add_(axis, idx, src)
def _segment_sum(src, seg, n):
    out = torch.zeros((n,) + src.shape[1:], dtype=src.dtype)
    return out.index_add_(0, seg, src)
def _pad(x, pw):
    flat = tuple(v for pair in reversed(pw) for v in pair)
    return torch.nn.functional.pad(x, flat)

kernel_name = 'sequential_preLN__spectral_fnet__moe_arch_mod__prompt'

def setup_inputs():

    _w = (lambda a: (lambda t: t.to(torch.bfloat16) if t.is_floating_point() else t)(torch.as_tensor(a)))
    def _A_setup():
        B, S, D = 1, 2048, 1024
        ns = torch.arange(S)[:, None] * torch.arange(S)[None, :]
        nd = torch.arange(D)[:, None] * torch.arange(D)[None, :]
        Ws_re = torch.cos(-2.0 * torch.pi * ns / S).to(float)
        Ws_im = torch.sin(-2.0 * torch.pi * ns / S).to(float)
        Wd_re = torch.cos(-2.0 * torch.pi * nd / D).to(float)
        Wd_im = torch.sin(-2.0 * torch.pi * nd / D).to(float)
        return {
            "x": _w((lambda *s: torch.randn(*s, dtype=torch.bfloat16) * 0.05)(B, S, D)),
            "dft_seq_re": _w(Ws_re),
            "dft_seq_im": _w(Ws_im),
            "dft_hid_re": _w(Wd_re),
            "dft_hid_im": _w(Wd_im),
        }
    _A_in = _A_setup()

    def _B_setup():
        B, S, D, F, C = 1, 2048, 1024, 3584, 1
        return {
            "x": _w((lambda *s: torch.randn(*s, dtype=torch.bfloat16) * 0.05)(B, S, D)),
            "w_r": _w((lambda *s: torch.randn(*s, dtype=torch.bfloat16) * 1.6)(D)),
            "w_gate": _w((lambda *s: torch.randn(*s, dtype=torch.bfloat16) * 0.4)(D, F)),
            "w_up": _w((lambda *s: torch.randn(*s, dtype=torch.bfloat16) * 0.4)(D, F)),
            "w_down": _w((lambda *s: torch.randn(*s, dtype=torch.bfloat16) * 0.4)(F, D)),
        }
    _B_in = _B_setup()

    return {
        "A_x": _A_in["x"],
        "A_dft_seq_re": _A_in["dft_seq_re"],
        "A_dft_seq_im": _A_in["dft_seq_im"],
        "A_dft_hid_re": _A_in["dft_hid_re"],
        "A_dft_hid_im": _A_in["dft_hid_im"],
        "B_x": _B_in["x"],
        "B_w_r": _B_in["w_r"],
        "B_w_gate": _B_in["w_gate"],
        "B_w_up": _B_in["w_up"],
        "B_w_down": _B_in["w_down"],
    }

def reference(A_x, A_dft_seq_re, A_dft_seq_im, A_dft_hid_re, A_dft_hid_im, B_x, B_w_r, B_w_gate, B_w_up, B_w_down):
    def _A_ref(x, dft_seq_re, dft_seq_im, dft_hid_re, dft_hid_im):
        a = torch.einsum("bsd,ed->bse", x, dft_hid_re)
        b = torch.einsum("bsd,ed->bse", x, dft_hid_im)
        y = torch.einsum("ts,bse->bte", dft_seq_re, a) - torch.einsum("ts,bse->bte", dft_seq_im, b)
        return y

    def _B_ref(x, w_r, w_gate, w_up, w_down):
        B, S, D = x.shape
        C = 1
        r = x @ w_r
        idx = torch.argsort(-r, axis=-1)[:, :C]
        idx_e = (lambda x, n, axis: torch.repeat_interleave(x, n, dim=axis))(idx.reshape(B, C, 1), D, axis=2)
        x_sel = (lambda x, i, axis: torch.take_along_dim(x, i, dim=axis))(x, idx_e, axis=1)
        g = _silu(x_sel @ w_gate)
        u = x_sel @ w_up
        y = (g * u) @ w_down
        r_sel = _sigmoid((lambda x, i, axis: torch.take_along_dim(x, i, dim=axis))(r, idx, axis=1))
        y = y * r_sel.reshape(B, C, 1)
        b_off = (torch.arange(B) * S).reshape(B, 1)
        flat_idx = (idx + b_off).reshape(B * C)
        zero = (x * 0.0).reshape(B * S, D)
        upd = _scatter_add(zero, flat_idx, y.reshape(B * C, D), axis=0)
        return x + upd.reshape(B, S, D)

    x = A_x
    h = x + _A_ref(_layernorm(x, axis=-1), A_dft_seq_re, A_dft_seq_im, A_dft_hid_re, A_dft_hid_im)
    h2 = h + _B_ref(_layernorm(h, axis=-1), B_w_r, B_w_gate, B_w_up, B_w_down)
    return h2
```

```asm
; @launch kernel=fz_kernel grid=(256,1,1) block=(512,1,1) lds=163840
.amdgcn_target "amdgcn-amd-amdhsa--gfx950"
.text
.globl fz_kernel
.p2align 8
.type fz_kernel,@function
fz_kernel:
    s_load_dwordx2 s[4:5], s[0:1], 96
    s_cmp_gt_u32 s2, 240
    s_cbranch_scc1 fz_end
    v_lshrrev_b32 v2, 6, v0
    v_and_b32 v1, 63, v0
    s_mov_b32 s58, 0
    v_readfirstlane_b32 s3, v2
    s_mov_b32 s6, 0x510000
    s_mov_b32 s7, 0x00020000
    s_sub_u32 s20, s2, 128
    s_cmp_lt_u32 s20, 112
    s_cbranch_scc1 ffn
    s_load_dwordx2 s[8:9], s[0:1], 0
    s_load_dwordx2 s[12:13], s[0:1], 80
    s_load_dwordx2 s[16:17], s[0:1], 48
    s_min_u32 s20, s2, 128
    s_lshr_b32 s21, s20, 3
    s_add_u32 s21, s21, 1
    s_and_b32 s22, s20, 7
    s_sub_u32 s23, s20, 124
    s_cmp_ge_u32 s20, 124
    s_cselect_b32 s21, 0, s21
    s_cselect_b32 s22, s23, s22
    s_lshr_b32 s23, s3, 2
    s_and_b32 s24, s3, 3
    s_lshl_b32 s25, s22, 6
    s_add_u32 s25, s25, s21
    s_lshl_b32 s26, s23, 5
    s_add_u32 s26, s26, s25
    s_lshl_b32 s27, s24, 9
    s_add_u32 s28, s26, s27
    s_sub_u32 s27, 2048, s27
    s_sub_u32 s27, s27, s26
    s_lshl_b32 s29, s24, 1
    s_add_u32 s29, s29, s23
    s_sub_u32 s30, 15, s29
    s_cmp_lt_u32 s24, 2
    s_cselect_b32 s27, s28, s27
    s_cselect_b32 s31, s29, s30
    s_cselect_b32 s30, s30, s29
    s_sub_u32 s28, 2048, s27
    s_and_b32 s28, s28, 2047
    s_cmp_eq_u32 s20, 124
    s_cbranch_scc1 fz_spec
fz_specback:
    s_lshl_b32 s27, s27, 11
    s_lshl_b32 s28, s28, 11
    s_mul_i32 s31, s31, 2064
    s_mul_i32 s30, s30, 2064
    v_lshlrev_b32 v239, 4, v1
    s_mov_b32 s10, 0x400000
    s_mov_b32 s11, 0x00020000
    s_waitcnt lgkmcnt(0)
    s_cmp_eq_u32 s20, 124
    s_cbranch_scc1 fz_spec2
fz_spec2back:
    s_mov_b32 m0, s31
    s_nop 0
    buffer_load_dwordx4 v239, s[8:11], s27 offen lds
    buffer_load_dwordx4 v239, s[8:11], s27 offen offset:1024 lds
    s_mov_b32 m0, s30
    s_load_dword s40, s[4:5], 0
    buffer_load_dwordx4 v239, s[8:11], s28 offen lds
    buffer_load_dwordx4 v239, s[8:11], s28 offen offset:1024 lds
    v_lshlrev_b32 v2, 2, v0
    v_mov_b32 v3, -1
    s_lshl_b32 s32, s20, 11
    s_add_u32 s32, s32, 0x440000
    s_mov_b32 s18, 0x800
    s_mov_b32 s19, 0x00020000
    s_mov_b32 s14, 0x400000
    s_mov_b32 s15, 0x00020000
    s_lshl_b32 s33, s3, 10
    s_min_u32 s34, s33, 2048
    s_add_u32 s34, s34, 98944
    s_mov_b32 m0, s34
    buffer_store_dword v3, v2, s[4:7], s32 offen sc1
    buffer_load_dwordx4 v239, s[16:19], s33 offen lds
    v_and_b32 v2, 31, v1
    v_lshrrev_b32 v3, 5, v1
    v_and_b32 v4, 15, v1
    v_lshrrev_b32 v5, 4, v1
    v_add_u32 v6, 43520, v239
    s_cmp_eq_u32 s3, 1
    s_cbranch_scc1 fz_j1
    s_cmp_eq_u32 s3, 2
    s_cbranch_scc1 fz_j2
    s_cmp_eq_u32 s3, 3
    s_cbranch_scc1 fz_j3
    s_cmp_eq_u32 s3, 4
    s_cbranch_scc1 fz_j4
    s_cmp_eq_u32 s3, 5
    s_cbranch_scc1 fz_j5
    s_cmp_eq_u32 s3, 6
    s_cbranch_scc1 fz_j6
    s_cmp_eq_u32 s3, 7
    s_cbranch_scc1 fz_j7
    v_lshrrev_b32 v10, 1, v2
    v_and_b32 v8, 9, v10
    v_and_b32 v11, 2, v10
    v_lshl_or_b32 v8, v11, 1, v8
    v_bfe_u32 v11, v10, 2, 1
    v_lshl_or_b32 v8, v11, 1, v8
    v_and_b32 v9, 1, v2
    v_cmp_eq_u32 vcc, 1, v2
    s_nop 1
    v_cndmask_b32 v8, v8, 16, vcc
    v_cndmask_b32 v9, v9, 0, vcc
    v_cvt_f32_u32 v8, v8
    v_cvt_f32_u32 v9, v9
    v_cvt_f32_u32 v10, v3
    v_mul_f32 v8, 0x3d000000, v8
    v_mul_f32 v9, 0x3e800000, v9
    v_mul_f32 v10, 0x41000000, v10
    v_fma_f32 v9, v8, v10, v9
    v_mov_b32 v104, v9
    v_fmamk_f32 v105, v8, 0x3f800000, v9
    v_fmamk_f32 v106, v8, 0x40000000, v9
    v_fmamk_f32 v107, v8, 0x40400000, v9
    v_fmamk_f32 v108, v8, 0x40800000, v9
    v_fmamk_f32 v109, v8, 0x40a00000, v9
    v_fmamk_f32 v110, v8, 0x40c00000, v9
    v_fmamk_f32 v111, v8, 0x40e00000, v9
    v_fmamk_f32 v112, v8, 0x41800000, v9
    v_fmamk_f32 v113, v8, 0x41880000, v9
    v_fmamk_f32 v114, v8, 0x41900000, v9
    v_fmamk_f32 v115, v8, 0x41980000, v9
    v_fmamk_f32 v116, v8, 0x41a00000, v9
    v_fmamk_f32 v117, v8, 0x41a80000, v9
    v_fmamk_f32 v118, v8, 0x41b00000, v9
    v_fmamk_f32 v119, v8, 0x41b80000, v9
    v_cos_f32 v104, v104
    v_cos_f32 v105, v105
    v_cos_f32 v106, v106
    v_cos_f32 v107, v107
    v_cos_f32 v108, v108
    v_cos_f32 v109, v109
    v_cos_f32 v110, v110
    v_cos_f32 v111, v111
    v_cos_f32 v112, v112
    v_cos_f32 v113, v113
    v_cos_f32 v114, v114
    v_cos_f32 v115, v115
    v_cos_f32 v116, v116
    v_cos_f32 v117, v117
    v_cos_f32 v118, v118
    v_cos_f32 v119, v119
    v_cvt_pk_bf16_f32 v16, v104, v105
    v_cvt_pk_bf16_f32 v17, v106, v107
    v_cvt_pk_bf16_f32 v18, v108, v109
    v_cvt_pk_bf16_f32 v19, v110, v111
    v_cvt_pk_bf16_f32 v20, v112, v113
    v_cvt_pk_bf16_f32 v21, v114, v115
    v_cvt_pk_bf16_f32 v22, v116, v117
    v_cvt_pk_bf16_f32 v23, v118, v119
    ds_write_b128 v6, v[16:19] offset:0
    ds_write_b128 v6, v[20:23] offset:1024
    s_branch fz_jend
    s_nop 1
fz_j1:
    v_lshrrev_b32 v10, 1, v2
    v_and_b32 v8, 9, v10
    v_and_b32 v11, 2, v10
    v_lshl_or_b32 v8, v11, 1, v8
    v_bfe_u32 v11, v10, 2, 1
    v_lshl_or_b32 v8, v11, 1, v8
    v_cvt_f32_u32 v8, v8
    v_mul_f32 v8, 0x3a800000, v8
    v_cvt_f32_u32 v9, v3
    v_mul_f32 v9, 4.0, v9
    v_mul_f32 v9, v8, v9
    v_cmp_eq_u32 vcc, 1, v2
    v_mov_b32 v10, 0x3e800000
    s_nop 0
    v_cndmask_b32 v9, v9, v10, vcc
    v_mov_b32 v104, v9
    v_fmamk_f32 v105, v8, 0x3f800000, v9
    v_fmamk_f32 v106, v8, 0x40000000, v9
    v_fmamk_f32 v107, v8, 0x40400000, v9
    v_fmamk_f32 v108, v8, 0x41000000, v9
    v_fmamk_f32 v109, v8, 0x41100000, v9
    v_fmamk_f32 v110, v8, 0x41200000, v9
    v_fmamk_f32 v111, v8, 0x41300000, v9
    v_fmamk_f32 v112, v8, 0x41800000, v9
    v_fmamk_f32 v113, v8, 0x41880000, v9
    v_fmamk_f32 v114, v8, 0x41900000, v9
    v_fmamk_f32 v115, v8, 0x41980000, v9
    v_fmamk_f32 v116, v8, 0x41c00000, v9
    v_fmamk_f32 v117, v8, 0x41c80000, v9
    v_fmamk_f32 v118, v8, 0x41d00000, v9
    v_fmamk_f32 v119, v8, 0x41d80000, v9
    v_cos_f32 v104, v104
    v_cos_f32 v105, v105
    v_cos_f32 v106, v106
    v_cos_f32 v107, v107
    v_cos_f32 v108, v108
    v_cos_f32 v109, v109
    v_cos_f32 v110, v110
    v_cos_f32 v111, v111
    v_cos_f32 v112, v112
    v_cos_f32 v113, v113
    v_cos_f32 v114, v114
    v_cos_f32 v115, v115
    v_cos_f32 v116, v116
    v_cos_f32 v117, v117
    v_cos_f32 v118, v118
    v_cos_f32 v119, v119
    v_cvt_pk_f16_f32 v24, v104, v105
    v_cvt_pk_f16_f32 v25, v106, v107
    v_cvt_pk_f16_f32 v26, v108, v109
    v_cvt_pk_f16_f32 v27, v110, v111
    v_cvt_pk_f16_f32 v28, v112, v113
    v_cvt_pk_f16_f32 v29, v114, v115
    v_cvt_pk_f16_f32 v30, v116, v117
    v_cvt_pk_f16_f32 v31, v118, v119
    ds_write_b128 v6, v[24:27] offset:2048
    ds_write_b128 v6, v[28:31] offset:3072
    s_branch fz_jend
    s_nop 1
fz_j2:
    v_lshrrev_b32 v10, 1, v2
    v_and_b32 v8, 9, v10
    v_and_b32 v11, 2, v10
    v_lshl_or_b32 v8, v11, 1, v8
    v_bfe_u32 v11, v10, 2, 1
    v_lshl_or_b32 v8, v11, 1, v8
    v_cvt_f32_u32 v8, v8
    v_mul_f32 v8, 0x3a800000, v8
    v_lshlrev_b32 v9, 31, v2
    v_xor_b32 v8, v9, v8
    v_cvt_f32_u32 v9, v3
    v_mul_f32 v9, 4.0, v9
    v_mul_f32 v9, v8, v9
    v_mov_b32 v104, v9
    v_fmamk_f32 v105, v8, 0x3f800000, v9
    v_fmamk_f32 v106, v8, 0x40000000, v9
    v_fmamk_f32 v107, v8, 0x40400000, v9
    v_fmamk_f32 v108, v8, 0x41000000, v9
    v_fmamk_f32 v109, v8, 0x41100000, v9
    v_fmamk_f32 v110, v8, 0x41200000, v9
    v_fmamk_f32 v111, v8, 0x41300000, v9
    v_fmamk_f32 v112, v8, 0x41800000, v9
    v_fmamk_f32 v113, v8, 0x41880000, v9
    v_fmamk_f32 v114, v8, 0x41900000, v9
    v_fmamk_f32 v115, v8, 0x41980000, v9
    v_fmamk_f32 v116, v8, 0x41c00000, v9
    v_fmamk_f32 v117, v8, 0x41c80000, v9
    v_fmamk_f32 v118, v8, 0x41d00000, v9
    v_fmamk_f32 v119, v8, 0x41d80000, v9
    v_sin_f32 v104, v104
    v_sin_f32 v105, v105
    v_sin_f32 v106, v106
    v_sin_f32 v107, v107
    v_sin_f32 v108, v108
    v_sin_f32 v109, v109
    v_sin_f32 v110, v110
    v_sin_f32 v111, v111
    v_sin_f32 v112, v112
    v_sin_f32 v113, v113
    v_sin_f32 v114, v114
    v_sin_f32 v115, v115
    v_sin_f32 v116, v116
    v_sin_f32 v117, v117
    v_sin_f32 v118, v118
    v_sin_f32 v119, v119
    v_cvt_pk_f16_f32 v32, v104, v105
    v_cvt_pk_f16_f32 v33, v106, v107
    v_cvt_pk_f16_f32 v34, v108, v109
    v_cvt_pk_f16_f32 v35, v110, v111
    v_cvt_pk_f16_f32 v36, v112, v113
    v_cvt_pk_f16_f32 v37, v114, v115
    v_cvt_pk_f16_f32 v38, v116, v117
    v_cvt_pk_f16_f32 v39, v118, v119
    ds_write_b128 v6, v[32:35] offset:4096
    ds_write_b128 v6, v[36:39] offset:5120
    s_branch fz_jend
    s_nop 1
fz_j3:
    v_cvt_f32_u32 v8, v2
    v_mul_f32 v8, 0x3d000000, v8
    v_cvt_f32_u32 v9, v3
    v_mul_f32 v9, 4.0, v9
    v_mul_f32 v9, v8, v9
    v_mov_b32 v104, v9
    v_fmamk_f32 v105, v8, 0x3f800000, v9
    v_fmamk_f32 v106, v8, 0x40000000, v9
    v_fmamk_f32 v107, v8, 0x40400000, v9
    v_fmamk_f32 v108, v8, 0x41000000, v9
    v_fmamk_f32 v109, v8, 0x41100000, v9
    v_fmamk_f32 v110, v8, 0x41200000, v9
    v_fmamk_f32 v111, v8, 0x41300000, v9
    v_fmamk_f32 v112, v8, 0x41800000, v9
    v_fmamk_f32 v113, v8, 0x41880000, v9
    v_fmamk_f32 v114, v8, 0x41900000, v9
    v_fmamk_f32 v115, v8, 0x41980000, v9
    v_fmamk_f32 v116, v8, 0x41c00000, v9
    v_fmamk_f32 v117, v8, 0x41c80000, v9
    v_fmamk_f32 v118, v8, 0x41d00000, v9
    v_fmamk_f32 v119, v8, 0x41d80000, v9
    v_cos_f32 v104, v104
    v_cos_f32 v105, v105
    v_cos_f32 v106, v106
    v_cos_f32 v107, v107
    v_cos_f32 v108, v108
    v_cos_f32 v109, v109
    v_cos_f32 v110, v110
    v_cos_f32 v111, v111
    v_cos_f32 v112, v112
    v_cos_f32 v113, v113
    v_cos_f32 v114, v114
    v_cos_f32 v115, v115
    v_cos_f32 v116, v116
    v_cos_f32 v117, v117
    v_cos_f32 v118, v118
    v_cos_f32 v119, v119
    v_cvt_pk_f16_f32 v40, v104, v105
    v_cvt_pk_f16_f32 v41, v106, v107
    v_cvt_pk_f16_f32 v42, v108, v109
    v_cvt_pk_f16_f32 v43, v110, v111
    v_cvt_pk_f16_f32 v44, v112, v113
    v_cvt_pk_f16_f32 v45, v114, v115
    v_cvt_pk_f16_f32 v46, v116, v117
    v_cvt_pk_f16_f32 v47, v118, v119
    ds_write_b128 v6, v[40:43] offset:6144
    ds_write_b128 v6, v[44:47] offset:7168
    s_branch fz_jend
    s_nop 1
fz_j4:
    v_cvt_f32_u32 v8, v2
    v_mul_f32 v8, 0x3d000000, v8
    v_cvt_f32_u32 v9, v3
    v_mul_f32 v9, 4.0, v9
    v_mul_f32 v9, v8, v9
    v_mov_b32 v104, v9
    v_fmamk_f32 v105, v8, 0x3f800000, v9
    v_fmamk_f32 v106, v8, 0x40000000, v9
    v_fmamk_f32 v107, v8, 0x40400000, v9
    v_fmamk_f32 v108, v8, 0x41000000, v9
    v_fmamk_f32 v109, v8, 0x41100000, v9
    v_fmamk_f32 v110, v8, 0x41200000, v9
    v_fmamk_f32 v111, v8, 0x41300000, v9
    v_fmamk_f32 v112, v8, 0x41800000, v9
    v_fmamk_f32 v113, v8, 0x41880000, v9
    v_fmamk_f32 v114, v8, 0x41900000, v9
    v_fmamk_f32 v115, v8, 0x41980000, v9
    v_fmamk_f32 v116, v8, 0x41c00000, v9
    v_fmamk_f32 v117, v8, 0x41c80000, v9
    v_fmamk_f32 v118, v8, 0x41d00000, v9
    v_fmamk_f32 v119, v8, 0x41d80000, v9
    v_sin_f32 v104, v104
    v_sin_f32 v105, v105
    v_sin_f32 v106, v106
    v_sin_f32 v107, v107
    v_sin_f32 v108, v108
    v_sin_f32 v109, v109
    v_sin_f32 v110, v110
    v_sin_f32 v111, v111
    v_sin_f32 v112, v112
    v_sin_f32 v113, v113
    v_sin_f32 v114, v114
    v_sin_f32 v115, v115
    v_sin_f32 v116, v116
    v_sin_f32 v117, v117
    v_sin_f32 v118, v118
    v_sin_f32 v119, v119
    v_cvt_pk_f16_f32 v48, v104, v105
    v_cvt_pk_f16_f32 v49, v106, v107
    v_cvt_pk_f16_f32 v50, v108, v109
    v_cvt_pk_f16_f32 v51, v110, v111
    v_cvt_pk_f16_f32 v52, v112, v113
    v_cvt_pk_f16_f32 v53, v114, v115
    v_cvt_pk_f16_f32 v54, v116, v117
    v_cvt_pk_f16_f32 v55, v118, v119
    ds_write_b128 v6, v[48:51] offset:8192
    ds_write_b128 v6, v[52:55] offset:9216
    s_branch fz_jend
    s_nop 1
fz_j5:
    v_lshl_add_u32 v8, v4, 1, 1
    v_cvt_f32_u32 v8, v8
    v_mul_f32 v8, 0x3c800000, v8
    v_cvt_f32_u32 v9, v3
    v_mul_f32 v9, 4.0, v9
    v_mul_f32 v9, v8, v9
    v_and_b32 v10, 1, v5
    v_cmp_eq_u32 vcc, 1, v10
    v_mov_b32 v10, 0x3e800000
    s_nop 0
    v_cndmask_b32 v8, v8, 0, vcc
    v_cndmask_b32 v9, v9, v10, vcc
    v_mov_b32 v104, v9
    v_fmamk_f32 v105, v8, 0x3f800000, v9
    v_fmamk_f32 v106, v8, 0x40000000, v9
    v_fmamk_f32 v107, v8, 0x40400000, v9
    v_fmamk_f32 v108, v8, 0x41000000, v9
    v_fmamk_f32 v109, v8, 0x41100000, v9
    v_fmamk_f32 v110, v8, 0x41200000, v9
    v_fmamk_f32 v111, v8, 0x41300000, v9
    v_fmamk_f32 v112, v8, 0x41800000, v9
    v_fmamk_f32 v113, v8, 0x41880000, v9
    v_fmamk_f32 v114, v8, 0x41900000, v9
    v_fmamk_f32 v115, v8, 0x41980000, v9
    v_fmamk_f32 v116, v8, 0x41c00000, v9
    v_fmamk_f32 v117, v8, 0x41c80000, v9
    v_fmamk_f32 v118, v8, 0x41d00000, v9
    v_fmamk_f32 v119, v8, 0x41d80000, v9
    v_cos_f32 v104, v104
    v_cos_f32 v105, v105
    v_cos_f32 v106, v106
    v_cos_f32 v107, v107
    v_cos_f32 v108, v108
    v_cos_f32 v109, v109
    v_cos_f32 v110, v110
    v_cos_f32 v111, v111
    v_cos_f32 v112, v112
    v_cos_f32 v113, v113
    v_cos_f32 v114, v114
    v_cos_f32 v115, v115
    v_cos_f32 v116, v116
    v_cos_f32 v117, v117
    v_cos_f32 v118, v118
    v_cos_f32 v119, v119
    v_cvt_pk_f16_f32 v56, v104, v105
    v_cvt_pk_f16_f32 v57, v106, v107
    v_cvt_pk_f16_f32 v58, v108, v109
    v_cvt_pk_f16_f32 v59, v110, v111
    v_cvt_pk_f16_f32 v60, v112, v113
    v_cvt_pk_f16_f32 v61, v114, v115
    v_cvt_pk_f16_f32 v62, v116, v117
    v_cvt_pk_f16_f32 v63, v118, v119
    ds_write_b128 v6, v[56:59] offset:10240
    ds_write_b128 v6, v[60:63] offset:11264
    v_and_b32 v8, 3, v4
    v_lshrrev_b32 v9, 2, v4
    v_lshl_add_u32 v8, v8, 3, v9
    v_add_u32 v8, 4, v8
    v_cvt_f32_u32 v8, v8
    v_mul_f32 v8, 0x3d000000, v8
    v_cvt_f32_u32 v9, v5
    v_mul_f32 v9, 4.0, v9
    v_mul_f32 v9, v8, v9
    v_mov_b32 v104, v9
    v_fmamk_f32 v105, v8, 0x3f800000, v9
    v_fmamk_f32 v106, v8, 0x40000000, v9
    v_fmamk_f32 v107, v8, 0x40400000, v9
    v_fmamk_f32 v108, v8, 0x41800000, v9
    v_fmamk_f32 v109, v8, 0x41880000, v9
    v_fmamk_f32 v110, v8, 0x41900000, v9
    v_fmamk_f32 v111, v8, 0x41980000, v9
    v_cos_f32 v104, v104
    v_cos_f32 v105, v105
    v_cos_f32 v106, v106
    v_cos_f32 v107, v107
    v_cos_f32 v108, v108
    v_cos_f32 v109, v109
    v_cos_f32 v110, v110
    v_cos_f32 v111, v111
    v_cvt_pk_f16_f32 v80, v104, v105
    v_cvt_pk_f16_f32 v81, v106, v107
    v_cvt_pk_f16_f32 v82, v108, v109
    v_cvt_pk_f16_f32 v83, v110, v111
    ds_write_b128 v6, v[80:83] offset:16384
    s_branch fz_jend
    s_nop 2
fz_j6:
    v_lshl_add_u32 v8, v4, 1, 1
    v_cvt_f32_u32 v8, v8
    v_mul_f32 v8, 0x3c800000, v8
    v_cvt_f32_u32 v9, v3
    v_mul_f32 v9, 4.0, v9
    v_mul_f32 v9, v8, v9
    v_add_f32 v9, 0x3e800000, v9
    v_and_b32 v10, 1, v5
    v_cmp_eq_u32 vcc, 1, v10
    v_mov_b32 v10, 0x3e800000
    s_nop 0
    v_cndmask_b32 v8, v8, 0, vcc
    v_cndmask_b32 v9, v9, v10, vcc
    v_mov_b32 v104, v9
    v_fmamk_f32 v105, v8, 0x3f800000, v9
    v_fmamk_f32 v106, v8, 0x40000000, v9
    v_fmamk_f32 v107, v8, 0x40400000, v9
    v_fmamk_f32 v108, v8, 0x41000000, v9
    v_fmamk_f32 v109, v8, 0x41100000, v9
    v_fmamk_f32 v110, v8, 0x41200000, v9
    v_fmamk_f32 v111, v8, 0x41300000, v9
    v_fmamk_f32 v112, v8, 0x41800000, v9
    v_fmamk_f32 v113, v8, 0x41880000, v9
    v_fmamk_f32 v114, v8, 0x41900000, v9
    v_fmamk_f32 v115, v8, 0x41980000, v9
    v_fmamk_f32 v116, v8, 0x41c00000, v9
    v_fmamk_f32 v117, v8, 0x41c80000, v9
    v_fmamk_f32 v118, v8, 0x41d00000, v9
    v_fmamk_f32 v119, v8, 0x41d80000, v9
    v_cos_f32 v104, v104
    v_cos_f32 v105, v105
    v_cos_f32 v106, v106
    v_cos_f32 v107, v107
    v_cos_f32 v108, v108
    v_cos_f32 v109, v109
    v_cos_f32 v110, v110
    v_cos_f32 v111, v111
    v_cos_f32 v112, v112
    v_cos_f32 v113, v113
    v_cos_f32 v114, v114
    v_cos_f32 v115, v115
    v_cos_f32 v116, v116
    v_cos_f32 v117, v117
    v_cos_f32 v118, v118
    v_cos_f32 v119, v119
    v_cvt_pk_f16_f32 v64, v104, v105
    v_cvt_pk_f16_f32 v65, v106, v107
    v_cvt_pk_f16_f32 v66, v108, v109
    v_cvt_pk_f16_f32 v67, v110, v111
    v_cvt_pk_f16_f32 v68, v112, v113
    v_cvt_pk_f16_f32 v69, v114, v115
    v_cvt_pk_f16_f32 v70, v116, v117
    v_cvt_pk_f16_f32 v71, v118, v119
    ds_write_b128 v6, v[64:67] offset:12288
    ds_write_b128 v6, v[68:71] offset:13312
    v_and_b32 v8, 3, v4
    v_lshrrev_b32 v9, 2, v4
    v_lshl_add_u32 v8, v8, 3, v9
    v_add_u32 v8, 4, v8
    v_cvt_f32_u32 v8, v8
    v_mul_f32 v8, 0x3d000000, v8
    v_cvt_f32_u32 v9, v5
    v_mul_f32 v9, 4.0, v9
    v_mul_f32 v9, v8, v9
    v_mov_b32 v104, v9
    v_fmamk_f32 v105, v8, 0x3f800000, v9
    v_fmamk_f32 v106, v8, 0x40000000, v9
    v_fmamk_f32 v107, v8, 0x40400000, v9
    v_fmamk_f32 v108, v8, 0x41800000, v9
    v_fmamk_f32 v109, v8, 0x41880000, v9
    v_fmamk_f32 v110, v8, 0x41900000, v9
    v_fmamk_f32 v111, v8, 0x41980000, v9
    v_sin_f32 v104, v104
    v_sin_f32 v105, v105
    v_sin_f32 v106, v106
    v_sin_f32 v107, v107
    v_sin_f32 v108, v108
    v_sin_f32 v109, v109
    v_sin_f32 v110, v110
    v_sin_f32 v111, v111
    v_cvt_pk_f16_f32 v84, v104, v105
    v_cvt_pk_f16_f32 v85, v106, v107
    v_cvt_pk_f16_f32 v86, v108, v109
    v_cvt_pk_f16_f32 v87, v110, v111
    ds_write_b128 v6, v[84:87] offset:17408
    s_branch fz_jend
    s_nop 2
fz_j7:
    v_and_b32 v8, 3, v4
    v_lshrrev_b32 v9, 2, v4
    v_lshl_add_u32 v8, v8, 3, v9
    v_add_u32 v8, 0, v8
    v_cvt_f32_u32 v8, v8
    v_mul_f32 v8, 0x3d000000, v8
    v_cvt_f32_u32 v9, v5
    v_mul_f32 v9, 4.0, v9
    v_mul_f32 v9, v8, v9
    v_mov_b32 v104, v9
    v_fmamk_f32 v105, v8, 0x3f800000, v9
    v_fmamk_f32 v106, v8, 0x40000000, v9
    v_fmamk_f32 v107, v8, 0x40400000, v9
    v_fmamk_f32 v108, v8, 0x41800000, v9
    v_fmamk_f32 v109, v8, 0x41880000, v9
    v_fmamk_f32 v110, v8, 0x41900000, v9
    v_fmamk_f32 v111, v8, 0x41980000, v9
    v_cos_f32 v104, v104
    v_cos_f32 v105, v105
    v_cos_f32 v106, v106
    v_cos_f32 v107, v107
    v_cos_f32 v108, v108
    v_cos_f32 v109, v109
    v_cos_f32 v110, v110
    v_cos_f32 v111, v111
    v_cvt_pk_f16_f32 v72, v104, v105
    v_cvt_pk_f16_f32 v73, v106, v107
    v_cvt_pk_f16_f32 v74, v108, v109
    v_cvt_pk_f16_f32 v75, v110, v111
    ds_write_b128 v6, v[72:75] offset:14336
    v_mov_b32 v104, v9
    v_fmamk_f32 v105, v8, 0x3f800000, v9
    v_fmamk_f32 v106, v8, 0x40000000, v9
    v_fmamk_f32 v107, v8, 0x40400000, v9
    v_fmamk_f32 v108, v8, 0x41800000, v9
    v_fmamk_f32 v109, v8, 0x41880000, v9
    v_fmamk_f32 v110, v8, 0x41900000, v9
    v_fmamk_f32 v111, v8, 0x41980000, v9
    v_sin_f32 v104, v104
    v_sin_f32 v105, v105
    v_sin_f32 v106, v106
    v_sin_f32 v107, v107
    v_sin_f32 v108, v108
    v_sin_f32 v109, v109
    v_sin_f32 v110, v110
    v_sin_f32 v111, v111
    v_cvt_pk_f16_f32 v76, v104, v105
    v_cvt_pk_f16_f32 v77, v106, v107
    v_cvt_pk_f16_f32 v78, v108, v109
    v_cvt_pk_f16_f32 v79, v110, v111
    ds_write_b128 v6, v[76:79] offset:15360
    s_nop 3
fz_jend:
    v_lshlrev_b32 v7, 9, v3
    v_bfe_u32 v10, v1, 2, 2
    v_lshl_add_u32 v7, v10, 6, v7
    v_and_b32 v10, 1, v5
    v_lshl_add_u32 v7, v10, 5, v7
    v_and_b32 v10, 3, v1
    v_lshl_add_u32 v7, v10, 3, v7
    v_add_u32 v7, s31, v7
    v_lshlrev_b32 v8, 9, v3
    v_lshl_add_u32 v8, v2, 1, v8
    v_sub_u32 v9, 2048, v8
    v_and_b32 v9, 2047, v9
    v_add_u32 v9, s30, v9
    s_add_u32 s32, s30, 576
    v_sub_u32 v8, s32, v8
    v_cmp_eq_u32 vcc, 0, v2
    v_mov_b32 v10, 0xc2000000
    s_nop 0
    v_cndmask_b32 v234, 0, v10, vcc
    v_mov_b32 v235, 0x3727c5ac
    v_mov_b32 v242, 0xffff0000
    v_lshlrev_b32 v240, 31, v1
    v_lshrrev_b32 v10, 16, v240
    v_or_b32 v240, v240, v10
    v_mov_b32 v229, 0xfffcfffc
    s_lshr_b32 s32, s24, 1
    s_lshl_b32 s33, s23, 1
    s_add_u32 s32, s32, s33
    s_lshl_b32 s32, s32, 5
    s_mul_i32 s33, s3, 2304
    s_add_u32 s32, s32, s33
    s_add_u32 s32, s32, 61952
    v_add_u32 v10, v1, v3
    v_lshlrev_b32 v10, 4, v10
    v_add_u32 v216, s32, v10
    v_bfe_u32 v10, v0, 3, 1
    v_mul_u32_u24 v10, 33, v10
    v_lshrrev_b32 v11, 5, v0
    v_add_u32 v10, v10, v11
    v_lshlrev_b32 v10, 4, v10
    v_bfe_u32 v11, v0, 4, 1
    v_lshl_add_u32 v10, v11, 3, v10
    v_bfe_u32 v11, v0, 2, 1
    v_lshl_add_u32 v10, v11, 2, v10
    v_add_u32 v10, 61952, v10
    v_and_b32 v11, 3, v1
    v_lshrrev_b32 v12, 1, v11
    v_xor_b32 v11, v11, v12
    v_and_b32 v11, 1, v11
    v_mul_u32_u24 v11, 9280, v11
    v_add_u32 v10, v10, v11
    v_cmp_eq_u32 vcc, 1, v12
    v_mov_b32 v11, 0
    v_mov_b32 v12, 6944
    v_cndmask_b32 v11, v11, v12, vcc
    v_add_u32 v217, v10, v11
    v_mov_b32 v11, 2304
    v_mov_b32 v12, 4640
    v_cndmask_b32 v11, v11, v12, vcc
    v_add_u32 v218, v10, v11
    v_mov_b32 v11, 5792
    v_mov_b32 v12, 3456
    v_cndmask_b32 v11, v11, v12, vcc
    v_add_u32 v219, v10, v11
    v_mov_b32 v11, 8096
    v_mov_b32 v12, 1152
    v_cndmask_b32 v11, v11, v12, vcc
    v_add_u32 v220, v10, v11
    v_lshlrev_b32 v221, 4, v0
    s_min_u32 s32, s20, 124
    s_cmp_eq_u32 s20, 128
    s_cselect_b32 s33, s32, s20
    s_mul_i32 s52, s33, 16512
    s_cselect_b32 s33, 48, 0
    s_add_u32 s52, s52, s33
    s_add_u32 s52, s52, 0x1000
    s_mov_b64 s[54:55], -1
    s_cmp_eq_u32 s20, 124
    s_cselect_b32 s54, 0x77777777, s54
    s_cmp_eq_u32 s20, 128
    s_cselect_b32 s54, 0x11111111, s54
    s_mov_b32 s55, s54
    s_waitcnt lgkmcnt(0)
    s_barrier
    ds_read_b128 v[16:19], v6 offset:0
    ds_read_b128 v[20:23], v6 offset:1024
    ds_read_b128 v[24:27], v6 offset:2048
    ds_read_b128 v[28:31], v6 offset:3072
    ds_read_b128 v[32:35], v6 offset:4096
    ds_read_b128 v[36:39], v6 offset:5120
    ds_read_b128 v[40:43], v6 offset:6144
    ds_read_b128 v[44:47], v6 offset:7168
    ds_read_b128 v[48:51], v6 offset:8192
    ds_read_b128 v[52:55], v6 offset:9216
    ds_read_b128 v[56:59], v6 offset:10240
    ds_read_b128 v[60:63], v6 offset:11264
    ds_read_b128 v[64:67], v6 offset:12288
    ds_read_b128 v[68:71], v6 offset:13312
    s_add_u32 s40, s40, 1
    s_bfe_u32 s44, s40, 0x20000
    s_bfe_u32 s41, s40, 0x20002
    s_lshl_b32 s41, s41, 16
    s_or_b32 s44, s44, s41
    s_bfe_u32 s48, s40, 0x80000
    s_bfe_u32 s45, s40, 0x20004
    s_bfe_u32 s41, s40, 0x20006
    s_lshl_b32 s41, s41, 16
    s_or_b32 s45, s45, s41
    s_bfe_u32 s49, s40, 0x80008
    s_bfe_u32 s46, s40, 0x20008
    s_bfe_u32 s41, s40, 0x2000a
    s_lshl_b32 s41, s41, 16
    s_or_b32 s46, s46, s41
    s_bfe_u32 s50, s40, 0x80010
    s_bfe_u32 s47, s40, 0x2000c
    s_bfe_u32 s41, s40, 0x2000e
    s_lshl_b32 s41, s41, 16
    s_or_b32 s47, s47, s41
    s_bfe_u32 s51, s40, 0x80018
    s_mov_b32 s42, 0x3f803f80
    v_mov_b32 v160, 0
    v_mov_b32 v161, 0
    v_mov_b32 v162, 0
    v_mov_b32 v163, 0
    s_waitcnt vmcnt(2) lgkmcnt(0)
    ds_read_b64_tr_b16 v[88:89], v7 offset:0
    ds_read_b64_tr_b16 v[90:91], v7 offset:256
    ds_read_b64_tr_b16 v[92:93], v7 offset:1024
    ds_read_b64_tr_b16 v[94:95], v7 offset:1280
    ds_read_u16_d16 v96, v9
    ds_read_u16_d16_hi v136, v8 offset:1408
    ds_read_u16_d16 v97, v8 offset:1344
    ds_read_u16_d16_hi v137, v8 offset:1280
    ds_read_u16_d16 v98, v8 offset:1216
    ds_read_u16_d16_hi v138, v8 offset:1152
    ds_read_u16_d16 v99, v8 offset:1088
    ds_read_u16_d16_hi v139, v8 offset:1024
    s_waitcnt lgkmcnt(8)
    v_mfma_f32_32x32x16_bf16 v[104:119], v[88:91], v[16:19], 0
    v_mfma_f32_32x32x16_bf16 v[104:119], v[92:95], v[20:23], v[104:119]
    ds_read_u16_d16 v100, v8 offset:448
    ds_read_u16_d16_hi v140, v8 offset:384
    ds_read_u16_d16 v101, v8 offset:320
    ds_read_u16_d16_hi v141, v8 offset:256
    ds_read_u16_d16 v102, v8 offset:192
    ds_read_u16_d16_hi v142, v8 offset:128
    ds_read_u16_d16 v103, v8 offset:64
    ds_read_u16_d16_hi v143, v8 offset:0
    v_dot2_f32_bf16 v160, v88, s42, v160
    v_dot2_f32_bf16 v161, v88, v88, v161
    v_dot2_f32_bf16 v160, v89, s42, v160
    v_dot2_f32_bf16 v161, v89, v89, v161
    v_dot2_f32_bf16 v160, v90, s42, v160
    v_dot2_f32_bf16 v161, v90, v90, v161
    v_dot2_f32_bf16 v160, v91, s42, v160
    v_dot2_f32_bf16 v161, v91, v91, v161
    v_dot2_f32_bf16 v160, v92, s42, v160
    v_dot2_f32_bf16 v161, v92, v92, v161
    v_dot2_f32_bf16 v160, v93, s42, v160
    v_dot2_f32_bf16 v161, v93, v93, v161
    v_dot2_f32_bf16 v160, v94, s42, v160
    v_dot2_f32_bf16 v161, v94, v94, v161
    v_dot2_f32_bf16 v160, v95, s42, v160
    v_dot2_f32_bf16 v161, v95, v95, v161
    s_waitcnt lgkmcnt(0)
    v_or_b32 v96, v96, v136
    v_or_b32 v97, v97, v137
    v_or_b32 v98, v98, v138
    v_or_b32 v99, v99, v139
    v_or_b32 v100, v100, v140
    v_or_b32 v101, v101, v141
    v_or_b32 v102, v102, v142
    v_or_b32 v103, v103, v143
    v_mfma_f32_32x32x16_bf16 v[120:135], v[96:99], v[16:19], 0
    s_nop 0
    v_mfma_f32_32x32x16_bf16 v[120:135], v[100:103], v[20:23], v[120:135]
    v_dot2_f32_bf16 v162, v96, s42, v162
    v_dot2_f32_bf16 v163, v96, v96, v163
    v_dot2_f32_bf16 v162, v97, s42, v162
    v_dot2_f32_bf16 v163, v97, v97, v163
    v_dot2_f32_bf16 v162, v98, s42, v162
    v_dot2_f32_bf16 v163, v98, v98, v163
    v_dot2_f32_bf16 v162, v99, s42, v162
    v_dot2_f32_bf16 v163, v99, v99, v163
    v_dot2_f32_bf16 v162, v100, s42, v162
    v_dot2_f32_bf16 v163, v100, v100, v163
    v_dot2_f32_bf16 v162, v101, s42, v162
    v_dot2_f32_bf16 v163, v101, v101, v163
    v_dot2_f32_bf16 v162, v102, s42, v162
    v_dot2_f32_bf16 v163, v102, v102, v163
    v_dot2_f32_bf16 v162, v103, s42, v162
    v_dot2_f32_bf16 v163, v103, v103, v163
    v_add_f32_dpp v160, v160, v160 quad_perm:[1,0,3,2] row_mask:0xf bank_mask:0xf
    v_add_f32_dpp v161, v161, v161 quad_perm:[1,0,3,2] row_mask:0xf bank_mask:0xf
    v_add_f32_dpp v162, v162, v162 quad_perm:[1,0,3,2] row_mask:0xf bank_mask:0xf
    v_add_f32_dpp v163, v163, v163 quad_perm:[1,0,3,2] row_mask:0xf bank_mask:0xf
    v_add_f32_dpp v160, v160, v160 quad_perm:[2,3,0,1] row_mask:0xf bank_mask:0xf
    v_add_f32_dpp v161, v161, v161 quad_perm:[2,3,0,1] row_mask:0xf bank_mask:0xf
    v_add_f32_dpp v162, v162, v162 quad_perm:[2,3,0,1] row_mask:0xf bank_mask:0xf
    v_add_f32_dpp v163, v163, v163 quad_perm:[2,3,0,1] row_mask:0xf bank_mask:0xf
    v_add_f32_dpp v160, v160, v160 row_half_mirror row_mask:0xf bank_mask:0xf
    v_add_f32_dpp v161, v161, v161 row_half_mirror row_mask:0xf bank_mask:0xf
    v_add_f32_dpp v162, v162, v162 row_half_mirror row_mask:0xf bank_mask:0xf
    v_add_f32_dpp v163, v163, v163 row_half_mirror row_mask:0xf bank_mask:0xf
    v_add_f32_dpp v160, v160, v160 row_mirror row_mask:0xf bank_mask:0xf
    v_add_f32_dpp v161, v161, v161 row_mirror row_mask:0xf bank_mask:0xf
    v_add_f32_dpp v162, v162, v162 row_mirror row_mask:0xf bank_mask:0xf
    v_add_f32_dpp v163, v163, v163 row_mirror row_mask:0xf bank_mask:0xf
    v_add_f32_dpp v160, v160, v160 row_bcast:15 row_mask:0xa bank_mask:0xf
    v_add_f32_dpp v161, v161, v161 row_bcast:15 row_mask:0xa bank_mask:0xf
    v_add_f32_dpp v162, v162, v162 row_bcast:15 row_mask:0xa bank_mask:0xf
    v_add_f32_dpp v163, v163, v163 row_bcast:15 row_mask:0xa bank_mask:0xf
    v_add_f32_dpp v160, v160, v160 row_bcast:31 row_mask:0xc bank_mask:0xf
    v_add_f32_dpp v161, v161, v161 row_bcast:31 row_mask:0xc bank_mask:0xf
    v_add_f32_dpp v162, v162, v162 row_bcast:31 row_mask:0xc bank_mask:0xf
    v_add_f32_dpp v163, v163, v163 row_bcast:31 row_mask:0xc bank_mask:0xf
    s_mov_b32 s43, 0x3a800000
    v_mul_f32 v160, 0x3a800000, v160
    v_mul_f32 v162, 0x3a800000, v162
    v_fma_f32 v161, v161, s43, v235
    v_fma_f32 v163, v163, s43, v235
    v_fma_f32 v161, -v160, v160, v161
    v_fma_f32 v163, -v162, v162, v163
    v_rsq_f32 v161, v161
    v_rsq_f32 v163, v163
    v_mul_f32 v160, v160, v161
    v_fmac_f32 v160, v162, v163
    v_readlane_b32 s32, v161, 63
    v_readlane_b32 s34, v163, 63
    v_readlane_b32 s36, v160, 63
    s_nop 1
    v_mul_f32 v164, s36, v234
    v_pk_fma_f32 v[104:105], v[104:105], s[32:33], v[164:165] op_sel_hi:[1,0,0]
    v_pk_fma_f32 v[106:107], v[106:107], s[32:33], v[164:165] op_sel_hi:[1,0,0]
    v_pk_fma_f32 v[108:109], v[108:109], s[32:33], v[164:165] op_sel_hi:[1,0,0]
    v_pk_fma_f32 v[110:111], v[110:111], s[32:33], v[164:165] op_sel_hi:[1,0,0]
    v_pk_fma_f32 v[112:113], v[112:113], s[32:33], v[164:165] op_sel_hi:[1,0,0]
    v_pk_fma_f32 v[114:115], v[114:115], s[32:33], v[164:165] op_sel_hi:[1,0,0]
    v_pk_fma_f32 v[116:117], v[116:117], s[32:33], v[164:165] op_sel_hi:[1,0,0]
    v_pk_fma_f32 v[118:119], v[118:119], s[32:33], v[164:165] op_sel_hi:[1,0,0]
    v_pk_fma_f32 v[104:105], v[120:121], s[34:35], v[104:105] op_sel_hi:[1,0,1]
    v_pk_fma_f32 v[106:107], v[122:123], s[34:35], v[106:107] op_sel_hi:[1,0,1]
    v_pk_fma_f32 v[108:109], v[124:125], s[34:35], v[108:109] op_sel_hi:[1,0,1]
    v_pk_fma_f32 v[110:111], v[126:127], s[34:35], v[110:111] op_sel_hi:[1,0,1]
    v_pk_fma_f32 v[112:113], v[128:129], s[34:35], v[112:113] op_sel_hi:[1,0,1]
    v_pk_fma_f32 v[114:115], v[130:131], s[34:35], v[114:115] op_sel_hi:[1,0,1]
    v_pk_fma_f32 v[116:117], v[132:133], s[34:35], v[116:117] op_sel_hi:[1,0,1]
    v_pk_fma_f32 v[118:119], v[134:135], s[34:35], v[118:119] op_sel_hi:[1,0,1]
    v_cvt_pk_f16_f32 v136, v104, v105
    v_cvt_pk_f16_f32 v137, v106, v107
    v_cvt_pk_f16_f32 v138, v108, v109
    v_cvt_pk_f16_f32 v139, v110, v111
    v_cvt_pk_f16_f32 v140, v112, v113
    v_cvt_pk_f16_f32 v141, v114, v115
    v_cvt_pk_f16_f32 v142, v116, v117
    v_cvt_pk_f16_f32 v143, v118, v119
    v_mov_b32_dpp v152, v136 quad_perm:[1,0,3,2] row_mask:0xf bank_mask:0xf
    v_mov_b32_dpp v153, v137 quad_perm:[1,0,3,2] row_mask:0xf bank_mask:0xf
    v_mov_b32_dpp v154, v138 quad_perm:[1,0,3,2] row_mask:0xf bank_mask:0xf
    v_mov_b32_dpp v155, v139 quad_perm:[1,0,3,2] row_mask:0xf bank_mask:0xf
    v_mov_b32_dpp v156, v140 quad_perm:[1,0,3,2] row_mask:0xf bank_mask:0xf
    v_mov_b32_dpp v157, v141 quad_perm:[1,0,3,2] row_mask:0xf bank_mask:0xf
    v_mov_b32_dpp v158, v142 quad_perm:[1,0,3,2] row_mask:0xf bank_mask:0xf
    v_mov_b32_dpp v159, v143 quad_perm:[1,0,3,2] row_mask:0xf bank_mask:0xf
    v_pk_mul_f16 v144, v136, v24
    v_pk_mul_f16 v145, v137, v25
    v_pk_mul_f16 v146, v138, v26
    v_pk_mul_f16 v147, v139, v27
    v_pk_mul_f16 v148, v140, v28
    v_pk_mul_f16 v149, v141, v29
    v_pk_mul_f16 v150, v142, v30
    v_pk_mul_f16 v151, v143, v31
    v_mfma_f32_16x16x32_f16 v[120:123], v[136:139], v[56:59], 0
    v_pk_fma_f16 v144, v152, v32, v144
    v_pk_fma_f16 v145, v153, v33, v145
    v_pk_fma_f16 v146, v154, v34, v146
    v_pk_fma_f16 v147, v155, v35, v147
    v_mfma_f32_16x16x32_f16 v[120:123], v[140:143], v[60:63], v[120:123]
    v_pk_fma_f16 v148, v156, v36, v148
    v_pk_fma_f16 v149, v157, v37, v149
    v_pk_fma_f16 v150, v158, v38, v150
    v_pk_fma_f16 v151, v159, v39, v151
    v_mfma_f32_32x32x16_f16 v[104:119], v[144:147], v[40:43], 0
    v_xor_b32_dpp v152, v144, v240 quad_perm:[1,0,3,2] row_mask:0xf bank_mask:0xf
    v_xor_b32_dpp v153, v145, v240 quad_perm:[1,0,3,2] row_mask:0xf bank_mask:0xf
    v_xor_b32_dpp v154, v146, v240 quad_perm:[1,0,3,2] row_mask:0xf bank_mask:0xf
    v_xor_b32_dpp v155, v147, v240 quad_perm:[1,0,3,2] row_mask:0xf bank_mask:0xf
    v_mfma_f32_32x32x16_f16 v[104:119], v[148:151], v[44:47], v[104:119]
    v_xor_b32_dpp v156, v148, v240 quad_perm:[1,0,3,2] row_mask:0xf bank_mask:0xf
    v_xor_b32_dpp v157, v149, v240 quad_perm:[1,0,3,2] row_mask:0xf bank_mask:0xf
    v_xor_b32_dpp v158, v150, v240 quad_perm:[1,0,3,2] row_mask:0xf bank_mask:0xf
    v_xor_b32_dpp v159, v151, v240 quad_perm:[1,0,3,2] row_mask:0xf bank_mask:0xf
    v_mfma_f32_32x32x16_f16 v[104:119], v[152:155], v[48:51], v[104:119]
    s_nop 0
    v_mfma_f32_32x32x16_f16 v[104:119], v[156:159], v[52:55], v[104:119]
    v_mfma_f32_16x16x32_f16 v[124:127], v[136:139], v[64:67], 0
    v_mfma_f32_16x16x32_f16 v[124:127], v[140:143], v[68:71], v[124:127]
    s_mov_b64 vcc, 0xffff
    s_nop 8
    v_cvt_pk_f16_f32 v143, v118, v119
    v_cvt_pk_f16_f32 v142, v116, v117
    v_cvt_pk_f16_f32 v141, v114, v115
    v_cvt_pk_f16_f32 v140, v112, v113
    v_cvt_pk_f16_f32 v139, v110, v111
    v_cvt_pk_f16_f32 v138, v108, v109
    v_cvt_pk_f16_f32 v137, v106, v107
    v_cndmask_b32 v104, v104, v121, vcc
    v_cndmask_b32 v105, v105, v125, vcc
    v_pk_add_f16 v147, v142, v143 op_sel:[0,1] op_sel_hi:[1,0] neg_lo:[0,1]
    v_pk_add_f16 v151, v142, v143 op_sel:[0,1] op_sel_hi:[1,0] neg_hi:[1,0]
    v_pk_add_f16 v146, v140, v141 op_sel:[0,1] op_sel_hi:[1,0] neg_lo:[0,1]
    v_pk_add_f16 v150, v140, v141 op_sel:[0,1] op_sel_hi:[1,0] neg_hi:[1,0]
    v_pk_add_f16 v145, v138, v139 op_sel:[0,1] op_sel_hi:[1,0] neg_lo:[0,1]
    v_pk_add_f16 v149, v138, v139 op_sel:[0,1] op_sel_hi:[1,0] neg_hi:[1,0]
    v_cvt_pk_f16_f32 v136, v104, v105
    v_pk_add_f16 v144, v136, v137 op_sel:[0,1] op_sel_hi:[1,0] neg_lo:[0,1]
    v_pk_add_f16 v148, v136, v137 op_sel:[0,1] op_sel_hi:[1,0] neg_hi:[1,0]
    ds_write_b128 v216, v[144:147]
    ds_write_b128 v216, v[148:151] offset:1152
    s_add_u32 s53, s52, 8192
    s_waitcnt lgkmcnt(0)
    s_barrier
    ds_read_b32 v104, v217 offset:0
    ds_read_b32 v105, v218 offset:0
    ds_read_b32 v106, v219 offset:0
    ds_read_b32 v107, v220 offset:0
    ds_read_b32 v108, v217 offset:256
    ds_read_b32 v109, v218 offset:256
    ds_read_b32 v110, v219 offset:256
    ds_read_b32 v111, v220 offset:256
    s_mov_b64 exec, s[54:55]
    s_waitcnt lgkmcnt(4)
    v_pk_add_f16 v112, v104, v106
    v_pk_add_f16 v114, v105, v107
    v_pk_add_f16 v113, v104, v106 neg_lo:[0,1] neg_hi:[0,1]
    v_pk_add_f16 v115, v105, v107 neg_lo:[0,1] neg_hi:[0,1]
    v_pk_add_f16 v116, v112, v114
    v_pk_add_f16 v118, v112, v114 neg_lo:[0,1] neg_hi:[0,1]
    v_pk_add_f16 v117, v113, v115 op_sel:[0,1] op_sel_hi:[1,0] neg_hi:[0,1]
    v_pk_add_f16 v119, v113, v115 op_sel:[0,1] op_sel_hi:[1,0] neg_lo:[0,1]
    v_add_u32 v116, 0x20002, v116
    v_add_u32 v117, 0x20002, v117
    v_add_u32 v118, 0x20002, v118
    v_add_u32 v119, 0x20002, v119
    v_and_or_b32 v116, v116, v229, s44
    v_and_or_b32 v117, v117, v229, s45
    v_and_or_b32 v118, v118, v229, s46
    v_and_or_b32 v119, v119, v229, s47
    buffer_store_dwordx4 v[116:119], v221, s[4:7], s52 offen sc1
    s_waitcnt lgkmcnt(0)
    v_pk_add_f16 v120, v108, v110
    v_pk_add_f16 v122, v109, v111
    v_pk_add_f16 v121, v108, v110 neg_lo:[0,1] neg_hi:[0,1]
    v_pk_add_f16 v123, v109, v111 neg_lo:[0,1] neg_hi:[0,1]
    v_pk_add_f16 v124, v120, v122
    v_pk_add_f16 v126, v120, v122 neg_lo:[0,1] neg_hi:[0,1]
    v_pk_add_f16 v125, v121, v123 op_sel:[0,1] op_sel_hi:[1,0] neg_hi:[0,1]
    v_pk_add_f16 v127, v121, v123 op_sel:[0,1] op_sel_hi:[1,0] neg_lo:[0,1]
    v_add_u32 v124, 0x20002, v124
    v_add_u32 v125, 0x20002, v125
    v_add_u32 v126, 0x20002, v126
    v_add_u32 v127, 0x20002, v127
    v_and_or_b32 v124, v124, v229, s44
    v_and_or_b32 v125, v125, v229, s45
    v_and_or_b32 v126, v126, v229, s46
    v_and_or_b32 v127, v127, v229, s47
    buffer_store_dwordx4 v[124:127], v221, s[4:7], s53 offen sc1
    s_mov_b64 exec, -1
    s_cmp_eq_u32 s20, 128
    s_cbranch_scc1 fz_xend
    ds_read_b128 v[72:75], v6 offset:14336
    ds_read_b128 v[76:79], v6 offset:15360
    ds_read_b128 v[80:83], v6 offset:16384
    ds_read_b128 v[84:87], v6 offset:17408
    s_and_b32 s32, s3, 3
    s_lshr_b32 s33, s3, 2
    s_lshl_b32 s33, s33, 4
    s_add_u32 s33, s33, s32
    v_lshrrev_b32 v8, 2, v4
    v_lshlrev_b32 v8, 2, v8
    v_bfe_u32 v9, v4, 1, 1
    v_lshl_add_u32 v8, v9, 5, v8
    v_add_u32 v8, s33, v8
    v_cvt_f32_u32 v8, v8
    v_and_b32 v9, 1, v1
    v_cvt_f32_u32 v9, v9
    v_cvt_f32_u32 v10, v5
    v_mul_f32 v10, 4.0, v10
    v_mul_f32 v11, 0x3c800000, v8
    v_mul_f32 v9, 0x3e800000, v9
    v_fma_f32 v9, v11, v10, v9
    v_mov_b32 v104, v9
    v_mov_b32 v105, v9
    v_fmamk_f32 v106, v11, 0x3f800000, v9
    v_fmamk_f32 v107, v11, 0x3f800000, v9
    v_fmamk_f32 v108, v11, 0x40000000, v9
    v_fmamk_f32 v109, v11, 0x40000000, v9
    v_fmamk_f32 v110, v11, 0x40400000, v9
    v_fmamk_f32 v111, v11, 0x40400000, v9
    v_mul_f32 v11, 0x3a000000, v8
    v_lshlrev_b32 v12, 31, v1
    v_xor_b32 v11, v12, v11
    v_mul_f32 v9, v11, v10
    v_mov_b32 v112, v9
    v_fmamk_f32 v113, v11, 0x3f800000, v9
    v_fmamk_f32 v114, v11, 0x40000000, v9
    v_fmamk_f32 v115, v11, 0x40400000, v9
    v_fmamk_f32 v116, v11, 0x41800000, v9
    v_fmamk_f32 v117, v11, 0x41880000, v9
    v_fmamk_f32 v118, v11, 0x41900000, v9
    v_fmamk_f32 v119, v11, 0x41980000, v9
    v_cos_f32 v104, v104
    v_sin_f32 v105, v105
    v_cos_f32 v106, v106
    v_sin_f32 v107, v107
    v_cos_f32 v108, v108
    v_sin_f32 v109, v109
    v_cos_f32 v110, v110
    v_sin_f32 v111, v111
    v_sin_f32 v120, v112
    v_sin_f32 v121, v113
    v_sin_f32 v122, v114
    v_sin_f32 v123, v115
    v_sin_f32 v124, v116
    v_sin_f32 v125, v117
    v_sin_f32 v126, v118
    v_sin_f32 v127, v119
    v_cos_f32 v112, v112
    v_cos_f32 v113, v113
    v_cos_f32 v114, v114
    v_cos_f32 v115, v115
    v_cos_f32 v116, v116
    v_cos_f32 v117, v117
    v_cos_f32 v118, v118
    v_cos_f32 v119, v119
    s_mov_b32 s32, 0x3d800000
    v_pk_mul_f32 v[104:105], v[104:105], s[32:33] op_sel_hi:[1,0]
    v_pk_mul_f32 v[106:107], v[106:107], s[32:33] op_sel_hi:[1,0]
    v_pk_mul_f32 v[108:109], v[108:109], s[32:33] op_sel_hi:[1,0]
    v_pk_mul_f32 v[110:111], v[110:111], s[32:33] op_sel_hi:[1,0]
    v_pk_mul_f32 v[112:113], v[112:113], s[32:33] op_sel_hi:[1,0]
    v_pk_mul_f32 v[114:115], v[114:115], s[32:33] op_sel_hi:[1,0]
    v_pk_mul_f32 v[116:117], v[116:117], s[32:33] op_sel_hi:[1,0]
    v_pk_mul_f32 v[118:119], v[118:119], s[32:33] op_sel_hi:[1,0]
    v_pk_mul_f32 v[120:121], v[120:121], s[32:33] op_sel_hi:[1,0]
    v_pk_mul_f32 v[122:123], v[122:123], s[32:33] op_sel_hi:[1,0]
    v_pk_mul_f32 v[124:125], v[124:125], s[32:33] op_sel_hi:[1,0]
    v_pk_mul_f32 v[126:127], v[126:127], s[32:33] op_sel_hi:[1,0]
    v_cvt_pk_f16_f32 v16, v104, v105
    v_cvt_pk_f16_f32 v17, v106, v107
    v_cvt_pk_f16_f32 v18, v108, v109
    v_cvt_pk_f16_f32 v19, v110, v111
    v_cvt_pk_f16_f32 v20, v112, v113
    v_cvt_pk_f16_f32 v21, v114, v115
    v_cvt_pk_f16_f32 v22, v116, v117
    v_cvt_pk_f16_f32 v23, v118, v119
    v_cvt_pk_f16_f32 v24, v120, v121
    v_cvt_pk_f16_f32 v25, v122, v123
    v_cvt_pk_f16_f32 v26, v124, v125
    v_cvt_pk_f16_f32 v27, v126, v127
    v_lshrrev_b32 v8, 3, v1
    v_mul_u32_u24 v222, 16512, v8
    v_and_b32 v9, 7, v1
    v_lshl_add_u32 v222, v9, 4, v222
    s_mul_i32 s52, s3, 264192
    s_lshl_b32 s32, s20, 7
    s_add_u32 s52, s52, s32
    s_add_u32 s52, s52, 0x1000
    s_add_u32 s53, s52, 132096
    s_lshl_b32 s32, s3, 4
    v_add_u32 v9, s32, v8
    v_lshrrev_b32 v10, 3, v9
    v_add_u32 v10, 1, v10
    v_and_b32 v11, 7, v9
    v_lshl_add_u32 v10, v11, 6, v10
    v_subrev_u32 v11, 124, v9
    v_lshlrev_b32 v11, 6, v11
    v_cmp_lt_u32 vcc, 123, v9
    s_nop 1
    v_cndmask_b32 v10, v10, v11, vcc
    v_and_b32 v11, 3, v1
    v_lshrrev_b32 v12, 1, v11
    v_xor_b32 v11, v11, v12
    v_and_b32 v11, 1, v11
    v_lshl_add_u32 v10, v11, 5, v10
    v_sub_u32 v11, 512, v10
    v_cmp_eq_u32 vcc, 1, v12
    s_nop 1
    v_cndmask_b32 v10, v10, v11, vcc
    v_mov_b32 v11, 256
    v_cmp_eq_u32 vcc, 512, v10
    s_nop 1
    v_cndmask_b32 v10, v10, v11, vcc
    v_bfe_u32 v11, v10, 4, 1
    v_lshlrev_b32 v11, 10, v11
    v_lshrrev_b32 v12, 7, v10
    v_lshl_add_u32 v11, v12, 8, v11
    v_and_b32 v12, 15, v10
    v_lshl_add_u32 v11, v12, 4, v11
    v_bfe_u32 v12, v10, 5, 2
    v_lshl_add_u32 v11, v12, 2, v11
    v_bfe_u32 v12, v1, 2, 1
    v_mul_u32_u24 v12, 8256, v12
    v_add_u32 v223, v11, v12
    v_add_u32 v223, 80384, v223
    v_add_u32 v9, 8, v9
    v_lshrrev_b32 v10, 3, v9
    v_add_u32 v10, 1, v10
    v_and_b32 v11, 7, v9
    v_lshl_add_u32 v10, v11, 6, v10
    v_subrev_u32 v11, 124, v9
    v_lshlrev_b32 v11, 6, v11
    v_cmp_lt_u32 vcc, 123, v9
    s_nop 1
    v_cndmask_b32 v10, v10, v11, vcc
    v_and_b32 v11, 3, v1
    v_lshrrev_b32 v12, 1, v11
    v_xor_b32 v11, v11, v12
    v_and_b32 v11, 1, v11
    v_lshl_add_u32 v10, v11, 5, v10
    v_sub_u32 v11, 512, v10
    v_cmp_eq_u32 vcc, 1, v12
    s_nop 1
    v_cndmask_b32 v10, v10, v11, vcc
    v_mov_b32 v11, 256
    v_cmp_eq_u32 vcc, 512, v10
    s_nop 1
    v_cndmask_b32 v10, v10, v11, vcc
    v_bfe_u32 v11, v10, 4, 1
    v_lshlrev_b32 v11, 10, v11
    v_lshrrev_b32 v12, 7, v10
    v_lshl_add_u32 v11, v12, 8, v11
    v_and_b32 v12, 15, v10
    v_lshl_add_u32 v11, v12, 4, v11
    v_bfe_u32 v12, v10, 5, 2
    v_lshl_add_u32 v11, v12, 2, v11
    v_bfe_u32 v12, v1, 2, 1
    v_mul_u32_u24 v12, 8256, v12
    v_add_u32 v224, v11, v12
    v_add_u32 v224, 80384, v224
    s_and_b32 s32, s3, 3
    s_lshl_b32 s32, s32, 11
    s_add_u32 s32, s32, 80384
    v_add_u32 v225, s32, v239
    v_lshlrev_b32 v8, 2, v5
    v_add_u32 v8, s33, v8
    v_sub_u32 v9, 32, v8
    v_min_u32 v9, v8, v9
    v_and_b32 v10, 15, v8
    v_cmp_eq_u32 s[32:33], 0, v10
    v_cmp_lt_u32 s[34:35], 16, v8
    v_subrev_u32 v10, 1, v9
    v_lshlrev_b32 v10, 3, v10
    v_mov_b32 v11, 124
    v_cmp_eq_u32 vcc, 0, v8
    s_nop 1
    v_cndmask_b32 v10, v10, v11, vcc
    v_and_b32 v11, 3, v1
    v_lshlrev_b32 v11, 4, v11
    v_lshl_add_u32 v10, v10, 7, v11
    v_lshrrev_b32 v11, 2, v4
    v_add_u32 v12, 0, v11
    v_lshlrev_b32 v12, 7, v12
    v_sub_u32 v13, 960, v12
    v_cndmask_b32 v12, v12, v13, s[34:35]
    v_add_u32 v226, v10, v12
    s_or_b64 s[34:35], s[34:35], s[32:33]
    v_add_u32 v12, 4, v11
    v_lshlrev_b32 v12, 7, v12
    v_sub_u32 v13, 960, v12
    v_cndmask_b32 v12, v12, v13, s[34:35]
    v_add_u32 v227, v10, v12
    s_mul_i32 s56, s20, 16512
    s_add_u32 s56, s56, 0x210000
    v_mov_b32 v14, 0x30003
    s_waitcnt vmcnt(0)
    s_nop 3
fz_h1:
    buffer_load_dwordx4 v[104:107], v222, s[4:7], s52 offen sc1
    buffer_load_dwordx4 v[108:111], v222, s[4:7], s53 offen sc1
    s_waitcnt vmcnt(1)
    v_xor_b32 v104, s44, v104
    v_xor_b32 v105, s45, v105
    v_xor_b32 v106, s46, v106
    v_xor_b32 v107, s47, v107
    v_or3_b32 v112, v104, v105, v106
    s_waitcnt vmcnt(0)
    v_xor_b32 v108, s44, v108
    v_xor_b32 v109, s45, v109
    v_xor_b32 v110, s46, v110
    v_xor_b32 v111, s47, v111
    v_or3_b32 v112, v112, v107, v108
    v_or3_b32 v113, v109, v110, v111
    v_bitop3_b32 v112, v112, v113, v14 bitop3:0xa8
    v_cmp_ne_u32 vcc, 0, v112
    s_cbranch_vccnz fz_h1_rt
fz_h1_ok:
    ds_write_b32 v223, v104 offset:0
    ds_write_b32 v223, v105 offset:2048
    ds_write_b32 v223, v106 offset:4096
    ds_write_b32 v223, v107 offset:6144
    ds_write_b32 v224, v108 offset:0
    ds_write_b32 v224, v109 offset:2048
    ds_write_b32 v224, v110 offset:4096
    ds_write_b32 v224, v111 offset:6144
    s_waitcnt lgkmcnt(0)
    s_barrier
    ds_read_b128 v[104:107], v225 offset:0
    ds_read_b128 v[108:111], v225 offset:1024
    ds_read_b128 v[112:115], v225 offset:8256
    ds_read_b128 v[116:119], v225 offset:9280
    s_waitcnt lgkmcnt(3)
    v_mfma_f32_16x16x32_f16 v[120:123], v[104:107], v[16:19], 0
    s_waitcnt lgkmcnt(2)
    v_mfma_f32_16x16x32_f16 v[124:127], v[108:111], v[16:19], 0
    s_waitcnt lgkmcnt(1)
    v_mfma_f32_16x16x32_f16 v[128:131], v[112:115], v[16:19], 0
    s_waitcnt lgkmcnt(0)
    v_mfma_f32_16x16x32_f16 v[132:135], v[116:119], v[16:19], 0
    s_nop 1
    v_cvt_pk_f16_f32 v136, v120, v121
    v_cvt_pk_f16_f32 v137, v122, v123
    v_cvt_pk_f16_f32 v138, v124, v125
    v_cvt_pk_f16_f32 v139, v126, v127
    v_cvt_pk_f16_f32 v140, v128, v129
    v_cvt_pk_f16_f32 v141, v130, v131
    v_cvt_pk_f16_f32 v142, v132, v133
    v_cvt_pk_f16_f32 v143, v134, v135
    v_pk_mul_f16 v144, v136, v20
    v_pk_mul_f16 v145, v137, v21
    v_pk_mul_f16 v146, v138, v22
    v_pk_mul_f16 v147, v139, v23
    v_mov_b32_dpp v152, v136 quad_perm:[1,0,3,2] row_mask:0xf bank_mask:0xf
    v_mov_b32_dpp v153, v137 quad_perm:[1,0,3,2] row_mask:0xf bank_mask:0xf
    v_mov_b32_dpp v154, v138 quad_perm:[1,0,3,2] row_mask:0xf bank_mask:0xf
    v_mov_b32_dpp v155, v139 quad_perm:[1,0,3,2] row_mask:0xf bank_mask:0xf
    v_pk_fma_f16 v144, v152, v24, v144
    v_pk_fma_f16 v145, v153, v25, v145
    v_pk_fma_f16 v146, v154, v26, v146
    v_pk_fma_f16 v147, v155, v27, v147
    s_nop 1
    v_mfma_f32_16x16x32_f16 v[104:107], v[144:147], v[72:75], 0
    v_mfma_f32_16x16x32_f16 v[108:111], v[144:147], v[80:83], 0
    v_xor_b32_dpp v152, v144, v240 quad_perm:[1,0,3,2] row_mask:0xf bank_mask:0xf
    v_xor_b32_dpp v153, v145, v240 quad_perm:[1,0,3,2] row_mask:0xf bank_mask:0xf
    v_xor_b32_dpp v154, v146, v240 quad_perm:[1,0,3,2] row_mask:0xf bank_mask:0xf
    v_xor_b32_dpp v155, v147, v240 quad_perm:[1,0,3,2] row_mask:0xf bank_mask:0xf
    s_nop 1
    v_mfma_f32_16x16x32_f16 v[104:107], v[152:155], v[76:79], v[104:107]
    v_mfma_f32_16x16x32_f16 v[108:111], v[152:155], v[84:87], v[108:111]
    v_pk_mul_f16 v148, v140, v20
    v_pk_mul_f16 v149, v141, v21
    v_pk_mul_f16 v150, v142, v22
    v_pk_mul_f16 v151, v143, v23
    v_mov_b32_dpp v156, v140 quad_perm:[1,0,3,2] row_mask:0xf bank_mask:0xf
    v_mov_b32_dpp v157, v141 quad_perm:[1,0,3,2] row_mask:0xf bank_mask:0xf
    v_mov_b32_dpp v158, v142 quad_perm:[1,0,3,2] row_mask:0xf bank_mask:0xf
    v_mov_b32_dpp v159, v143 quad_perm:[1,0,3,2] row_mask:0xf bank_mask:0xf
    v_pk_fma_f16 v148, v156, v24, v148
    v_pk_fma_f16 v149, v157, v25, v149
    v_pk_fma_f16 v150, v158, v26, v150
    v_pk_fma_f16 v151, v159, v27, v151
    s_nop 1
    v_mfma_f32_16x16x32_f16 v[112:115], v[148:151], v[72:75], 0
    v_mfma_f32_16x16x32_f16 v[116:119], v[148:151], v[80:83], 0
    v_xor_b32_dpp v156, v148, v240 quad_perm:[1,0,3,2] row_mask:0xf bank_mask:0xf
    v_xor_b32_dpp v157, v149, v240 quad_perm:[1,0,3,2] row_mask:0xf bank_mask:0xf
    v_xor_b32_dpp v158, v150, v240 quad_perm:[1,0,3,2] row_mask:0xf bank_mask:0xf
    v_xor_b32_dpp v159, v151, v240 quad_perm:[1,0,3,2] row_mask:0xf bank_mask:0xf
    s_nop 1
    v_mfma_f32_16x16x32_f16 v[112:115], v[156:159], v[76:79], v[112:115]
    v_mfma_f32_16x16x32_f16 v[116:119], v[156:159], v[84:87], v[116:119]
    v_cvt_pk_f16_f32 v120, v104, v105
    v_cvt_pk_f16_f32 v122, v106, v107
    s_nop 4
    v_cvt_pk_f16_f32 v121, v112, v113
    v_cvt_pk_f16_f32 v123, v114, v115
    v_add_u32 v120, 0x20002, v120
    v_add_u32 v121, 0x20002, v121
    v_add_u32 v122, 0x20002, v122
    v_add_u32 v123, 0x20002, v123
    v_and_or_b32 v120, v120, v229, s44
    v_and_or_b32 v121, v121, v229, s45
    v_and_or_b32 v122, v122, v229, s46
    v_and_or_b32 v123, v123, v229, s47
    buffer_store_dwordx4 v[120:123], v226, s[4:7], s56 offen sc1
    v_cvt_pk_f16_f32 v124, v108, v109
    v_cvt_pk_f16_f32 v126, v110, v111
    v_cvt_pk_f16_f32 v125, v116, v117
    v_cvt_pk_f16_f32 v127, v118, v119
    v_add_u32 v124, 0x20002, v124
    v_add_u32 v125, 0x20002, v125
    v_add_u32 v126, 0x20002, v126
    v_add_u32 v127, 0x20002, v127
    v_and_or_b32 v124, v124, v229, s44
    v_and_or_b32 v125, v125, v229, s45
    v_and_or_b32 v126, v126, v229, s46
    v_and_or_b32 v127, v127, v229, s47
    buffer_store_dwordx4 v[124:127], v227, s[4:7], s56 offen sc1
    v_sub_u32 v8, 15, v4
    v_min_u32 v8, v4, v8
    v_and_b32 v9, 1, v8
    v_lshlrev_b32 v9, 5, v9
    v_lshrrev_b32 v10, 1, v8
    v_lshl_add_u32 v9, v10, 9, v9
    v_add_u32 v9, s25, v9
    v_sub_u32 v10, 2048, v9
    v_cmp_lt_u32 s[34:35], 7, v4
    s_nop 1
    v_cndmask_b32 v230, v9, v10, s[34:35]
    v_mov_b32 v9, v4
    v_mov_b32 v10, s20
    s_mov_b64 s[38:39], 0
    s_cmp_lg_u32 s21, 0
    s_cbranch_scc0 fz_spec3
fz_spec3back:
    v_lshlrev_b32 v10, 7, v10
    v_lshl_add_u32 v10, v9, 3, v10
    v_mul_u32_u24 v11, 66048, v5
    v_add_u32 v228, v10, v11
    v_and_b32 v9, 1, v9
    v_cmp_eq_u32 vcc, 1, v9
    v_mov_b32 v9, s44
    v_mov_b32 v10, s46
    v_cndmask_b32 v236, v9, v10, vcc
    v_mov_b32 v9, s45
    v_mov_b32 v10, s47
    v_cndmask_b32 v237, v9, v10, vcc
    s_mul_i32 s52, s3, 264192
    s_add_u32 s52, s52, 0x210000
    s_add_u32 s53, s52, 16512
    s_add_u32 s54, s52, 33024
    s_add_u32 s55, s52, 49536
    s_lshl_b32 s32, s3, 2
    v_add_u32 v8, s32, v5
    v_lshlrev_b32 v9, 6, v8
    v_cmp_gt_u32 vcc, 16, v8
    s_nop 1
    v_cndmask_b32 v10, 0, 32, vcc
    v_add_u32 v10, v9, v10
    v_sub_u32 v11, 2048, v10
    v_cmp_eq_u32 vcc, 16, v8
    s_nop 1
    v_cndmask_b32 v11, v11, 0, vcc
    v_mov_b32 v12, 0xffff0000
    v_cndmask_b32 v238, -1, v12, vcc
    v_sub_u32 v12, 2018, v9
    v_mul_u32_u24 v13, 2064, v4
    v_add_u32 v231, v13, v9
    v_add_u32 v232, v13, v12
    v_add_u32 v233, v13, v10
    v_add_u32 v241, v13, v11
    ds_read_b128 v[104:107], v231
    ds_read_b128 v[108:111], v231 offset:16
    ds_read_u16_d16_hi v184, v241
    ds_read_u16_d16_hi v185, v232 offset:28
    ds_read_u16_d16_hi v186, v232 offset:26
    ds_read_u16_d16_hi v187, v232 offset:24
    ds_read_u16_d16_hi v188, v232 offset:22
    ds_read_u16_d16_hi v189, v232 offset:20
    ds_read_u16_d16_hi v190, v232 offset:18
    ds_read_u16_d16_hi v191, v232 offset:16
    ds_read_u16_d16_hi v192, v232 offset:14
    ds_read_u16_d16_hi v193, v232 offset:12
    ds_read_u16_d16_hi v194, v232 offset:10
    ds_read_u16_d16_hi v195, v232 offset:8
    ds_read_u16_d16_hi v196, v232 offset:6
    ds_read_u16_d16_hi v197, v232 offset:4
    ds_read_u16_d16_hi v198, v232 offset:2
    ds_read_u16_d16_hi v199, v232 offset:0
    ds_read_u16_d16_hi v168, v233
    v_add_u32 v9, 98944, v9
    v_add_u32 v10, 98944, v10
    v_add_u32 v11, 98944, v11
    v_add_u32 v12, 98944, v12
    s_mov_b32 s36, 0xffff0000
    s_waitcnt lgkmcnt(0)
    ds_read_b128 v[200:203], v9
    ds_read_b128 v[204:207], v9 offset:16
    ds_read_u16_d16 v208, v11
    ds_read_u16_d16_hi v112, v12 offset:28
    ds_read_u16_d16 v209, v12 offset:26
    ds_read_u16_d16_hi v113, v12 offset:24
    ds_read_u16_d16 v210, v12 offset:22
    ds_read_u16_d16_hi v114, v12 offset:20
    ds_read_u16_d16 v211, v12 offset:18
    ds_read_u16_d16_hi v115, v12 offset:16
    ds_read_u16_d16 v212, v12 offset:14
    ds_read_u16_d16_hi v116, v12 offset:12
    ds_read_u16_d16 v213, v12 offset:10
    ds_read_u16_d16_hi v117, v12 offset:8
    ds_read_u16_d16 v214, v12 offset:6
    ds_read_u16_d16_hi v118, v12 offset:4
    ds_read_u16_d16 v215, v12 offset:2
    ds_read_u16_d16_hi v119, v12 offset:0
    ds_read_u16_d16 v13, v10
    v_and_b32 v169, s36, v104
    v_lshlrev_b32 v170, 16, v105
    v_and_b32 v171, s36, v105
    v_lshlrev_b32 v172, 16, v106
    v_and_b32 v173, s36, v106
    v_lshlrev_b32 v174, 16, v107
    v_and_b32 v175, s36, v107
    v_lshlrev_b32 v176, 16, v108
    v_and_b32 v177, s36, v108
    v_lshlrev_b32 v178, 16, v109
    v_and_b32 v179, s36, v109
    v_lshlrev_b32 v180, 16, v110
    v_and_b32 v181, s36, v110
    v_lshlrev_b32 v182, 16, v111
    v_and_b32 v183, s36, v111
    v_cmp_eq_u32 vcc, 1, v4
    v_mov_b32 v9, s42
    s_nop 0
    v_cndmask_b32 v9, 0, v9, vcc
    v_mov_b32 v104, s42
    v_mov_b32 v105, s42
    v_mov_b32 v106, s42
    v_mov_b32 v107, s42
    v_cmp_eq_u32 vcc, 0, v4
    s_waitcnt lgkmcnt(0)
    v_and_or_b32 v200, v200, s36, v13
    v_or_b32 v208, v208, v112
    v_or_b32 v209, v209, v113
    v_or_b32 v210, v210, v114
    v_or_b32 v211, v211, v115
    v_or_b32 v212, v212, v116
    v_or_b32 v213, v213, v117
    v_or_b32 v214, v214, v118
    v_or_b32 v215, v215, v119
    v_cndmask_b32 v200, v9, v200, vcc
    v_cndmask_b32 v201, v9, v201, vcc
    v_cndmask_b32 v202, v9, v202, vcc
    v_cndmask_b32 v203, v9, v203, vcc
    v_cndmask_b32 v204, v9, v204, vcc
    v_cndmask_b32 v205, v9, v205, vcc
    v_cndmask_b32 v206, v9, v206, vcc
    v_cndmask_b32 v207, v9, v207, vcc
    v_cndmask_b32 v208, v9, v208, vcc
    v_cndmask_b32 v209, v9, v209, vcc
    v_cndmask_b32 v210, v9, v210, vcc
    v_cndmask_b32 v211, v9, v211, vcc
    v_cndmask_b32 v212, v9, v212, vcc
    v_cndmask_b32 v213, v9, v213, vcc
    v_cndmask_b32 v214, v9, v214, vcc
    v_cndmask_b32 v215, v9, v215, vcc
    v_mfma_f32_16x16x32_bf16 v[108:111], v[200:203], v[104:107], 0
    v_mfma_f32_16x16x32_bf16 v[108:111], v[204:207], v[104:107], v[108:111]
    v_mfma_f32_16x16x32_bf16 v[108:111], v[208:211], v[104:107], v[108:111]
    v_mfma_f32_16x16x32_bf16 v[108:111], v[212:215], v[104:107], v[108:111]
    s_lshl_b32 s32, s3, 8
    s_add_u32 s32, s32, 96896
    v_lshlrev_b32 v9, 4, v4
    v_add_u32 v10, s32, v9
    v_add_u32 v11, 100992, v239
    v_cmp_gt_u32 vcc, 16, v1
    s_nop 1
    v_cndmask_b32 v2, v11, v10, vcc
    v_lshrrev_b32 v12, 2, v4
    v_cmp_eq_u32 vcc, v12, v5
    s_nop 1
    v_cndmask_b32 v3, v11, v10, vcc
    v_lshrrev_b32 v12, 5, v1
    v_lshl_add_u32 v6, v12, 10, v9
    v_add_u32 v6, 96896, v6
    ds_write_b32 v2, v108 offset:12
    v_and_b32 v9, 1, v1
    v_cmp_eq_u32 s[32:33], 1, v9
    v_and_b32 v9, 2, v1
    v_cmp_eq_u32 s[34:35], 2, v9
    s_lshl_b32 s37, s3, 2
    v_add_u32 v7, s37, v5
    v_mul_u32_u24 v7, 2176, v7
    s_lshl_b32 s26, s20, 4
    s_add_u32 s26, s26, 0x420000
    v_lshlrev_b32 v8, 4, v5
    s_lshl_b32 s27, s20, 11
    s_lshl_b32 s37, s3, 8
    s_add_u32 s27, s27, s37
    s_add_u32 s27, s27, 0x440000
    v_sub_u32 v15, 2047, v230
    s_mov_b32 s36, 0x43000000
    s_mov_b32 s58, 0
    s_waitcnt vmcnt(0)
    s_nop 1
fz_h2:
    buffer_load_dwordx2 v[104:105], v228, s[4:7], s52 offen sc1
    buffer_load_dwordx2 v[106:107], v228, s[4:7], s53 offen sc1
    buffer_load_dwordx2 v[108:109], v228, s[4:7], s54 offen sc1
    buffer_load_dwordx2 v[110:111], v228, s[4:7], s55 offen sc1
    s_waitcnt vmcnt(3)
    v_xor_b32 v104, v236, v104
    v_xor_b32 v105, v237, v105
    v_or_b32 v9, v104, v105
    s_waitcnt vmcnt(2)
    v_xor_b32 v106, v236, v106
    v_xor_b32 v107, v237, v107
    v_or3_b32 v9, v9, v106, v107
    s_waitcnt vmcnt(1)
    v_xor_b32 v108, v236, v108
    v_xor_b32 v109, v237, v109
    v_or3_b32 v9, v9, v108, v109
    s_waitcnt vmcnt(0)
    v_xor_b32 v110, v236, v110
    v_xor_b32 v111, v237, v111
    v_or3_b32 v9, v9, v110, v111
    v_and_b32 v9, v14, v9
    v_cmp_ne_u32 vcc, 0, v9
    s_cbranch_vccnz fz_h2_rt
fz_h2_ok:
    s_mov_b64 vcc, s[38:39]
    v_fma_mix_f32 v168, v104, s36, v168 op_sel:[0,0,0] op_sel_hi:[1,0,0]
    v_fma_mix_f32 v169, v104, s36, v169 op_sel:[1,0,0] op_sel_hi:[1,0,0]
    v_fma_mix_f32 v170, v105, s36, v170 op_sel:[0,0,0] op_sel_hi:[1,0,0]
    v_fma_mix_f32 v171, v105, s36, v171 op_sel:[1,0,0] op_sel_hi:[1,0,0]
    v_fma_mix_f32 v172, v106, s36, v172 op_sel:[0,0,0] op_sel_hi:[1,0,0]
    v_fma_mix_f32 v173, v106, s36, v173 op_sel:[1,0,0] op_sel_hi:[1,0,0]
    v_fma_mix_f32 v174, v107, s36, v174 op_sel:[0,0,0] op_sel_hi:[1,0,0]
    v_fma_mix_f32 v175, v107, s36, v175 op_sel:[1,0,0] op_sel_hi:[1,0,0]
    v_fma_mix_f32 v176, v108, s36, v176 op_sel:[0,0,0] op_sel_hi:[1,0,0]
    v_fma_mix_f32 v177, v108, s36, v177 op_sel:[1,0,0] op_sel_hi:[1,0,0]
    v_fma_mix_f32 v178, v109, s36, v178 op_sel:[0,0,0] op_sel_hi:[1,0,0]
    v_fma_mix_f32 v179, v109, s36, v179 op_sel:[1,0,0] op_sel_hi:[1,0,0]
    v_fma_mix_f32 v180, v110, s36, v180 op_sel:[0,0,0] op_sel_hi:[1,0,0]
    v_fma_mix_f32 v181, v110, s36, v181 op_sel:[1,0,0] op_sel_hi:[1,0,0]
    v_fma_mix_f32 v182, v111, s36, v182 op_sel:[0,0,0] op_sel_hi:[1,0,0]
    v_fma_mix_f32 v183, v111, s36, v183 op_sel:[1,0,0] op_sel_hi:[1,0,0]
    v_cndmask_b32_dpp v112, v104, v104, vcc row_mirror row_mask:0xf bank_mask:0xf
    v_cndmask_b32_dpp v113, v105, v105, vcc row_mirror row_mask:0xf bank_mask:0xf
    v_cndmask_b32_dpp v114, v106, v106, vcc row_mirror row_mask:0xf bank_mask:0xf
    v_cndmask_b32_dpp v115, v107, v107, vcc row_mirror row_mask:0xf bank_mask:0xf
    v_cndmask_b32_dpp v116, v108, v108, vcc row_mirror row_mask:0xf bank_mask:0xf
    v_cndmask_b32_dpp v117, v109, v109, vcc row_mirror row_mask:0xf bank_mask:0xf
    v_cndmask_b32_dpp v118, v110, v110, vcc row_mirror row_mask:0xf bank_mask:0xf
    v_cndmask_b32_dpp v119, v111, v111, vcc row_mirror row_mask:0xf bank_mask:0xf
    v_cvt_pk_bf16_f32 v120, v168, v169
    v_cvt_pk_bf16_f32 v121, v170, v171
    v_cvt_pk_bf16_f32 v122, v172, v173
    v_cvt_pk_bf16_f32 v123, v174, v175
    v_cvt_pk_bf16_f32 v124, v176, v177
    v_cvt_pk_bf16_f32 v125, v178, v179
    v_cvt_pk_bf16_f32 v126, v180, v181
    v_cvt_pk_bf16_f32 v127, v182, v183
    v_and_b32 v112, v238, v112
    v_mfma_f32_16x16x32_bf16 v[136:139], v[120:123], v[120:123], 0
    v_mfma_f32_16x16x32_bf16 v[140:143], v[200:203], v[120:123], 0
    v_mfma_f32_16x16x32_bf16 v[136:139], v[124:127], v[124:127], v[136:139]
    v_mfma_f32_16x16x32_bf16 v[140:143], v[204:207], v[124:127], v[140:143]
    v_fma_mix_f32 v184, v112, s36, v184 op_sel:[0,0,0] op_sel_hi:[1,0,0]
    v_fma_mix_f32 v185, v112, s36, v185 op_sel:[1,0,0] op_sel_hi:[1,0,0]
    v_fma_mix_f32 v186, v113, s36, v186 op_sel:[0,0,0] op_sel_hi:[1,0,0]
    v_fma_mix_f32 v187, v113, s36, v187 op_sel:[1,0,0] op_sel_hi:[1,0,0]
    v_fma_mix_f32 v188, v114, s36, v188 op_sel:[0,0,0] op_sel_hi:[1,0,0]
    v_fma_mix_f32 v189, v114, s36, v189 op_sel:[1,0,0] op_sel_hi:[1,0,0]
    v_fma_mix_f32 v190, v115, s36, v190 op_sel:[0,0,0] op_sel_hi:[1,0,0]
    v_fma_mix_f32 v191, v115, s36, v191 op_sel:[1,0,0] op_sel_hi:[1,0,0]
    v_fma_mix_f32 v192, v116, s36, v192 op_sel:[0,0,0] op_sel_hi:[1,0,0]
    v_fma_mix_f32 v193, v116, s36, v193 op_sel:[1,0,0] op_sel_hi:[1,0,0]
    v_fma_mix_f32 v194, v117, s36, v194 op_sel:[0,0,0] op_sel_hi:[1,0,0]
    v_fma_mix_f32 v195, v117, s36, v195 op_sel:[1,0,0] op_sel_hi:[1,0,0]
    v_fma_mix_f32 v196, v118, s36, v196 op_sel:[0,0,0] op_sel_hi:[1,0,0]
    v_fma_mix_f32 v197, v118, s36, v197 op_sel:[1,0,0] op_sel_hi:[1,0,0]
    v_fma_mix_f32 v198, v119, s36, v198 op_sel:[0,0,0] op_sel_hi:[1,0,0]
    v_fma_mix_f32 v199, v119, s36, v199 op_sel:[1,0,0] op_sel_hi:[1,0,0]
    v_cvt_pk_bf16_f32 v128, v184, v185
    v_cvt_pk_bf16_f32 v129, v186, v187
    v_cvt_pk_bf16_f32 v130, v188, v189
    v_cvt_pk_bf16_f32 v131, v190, v191
    v_cvt_pk_bf16_f32 v132, v192, v193
    v_cvt_pk_bf16_f32 v133, v194, v195
    v_cvt_pk_bf16_f32 v134, v196, v197
    v_cvt_pk_bf16_f32 v135, v198, v199
    v_mfma_f32_16x16x32_bf16 v[136:139], v[128:131], v[128:131], v[136:139]
    v_mfma_f32_16x16x32_bf16 v[140:143], v[208:211], v[128:131], v[140:143]
    v_mfma_f32_16x16x32_bf16 v[136:139], v[132:135], v[132:135], v[136:139]
    v_mfma_f32_16x16x32_bf16 v[140:143], v[212:215], v[132:135], v[140:143]
    s_nop 6
    v_cndmask_b32 v9, v136, v137, s[32:33]
    v_cndmask_b32 v10, v138, v139, s[32:33]
    ds_write_b64 v2, v[140:141]
    v_cndmask_b32 v9, v9, v10, s[34:35]
    ds_write_b32 v3, v9 offset:8
    s_waitcnt lgkmcnt(0)
    s_barrier
    ds_read_b128 v[144:147], v6 offset:0
    ds_read_b128 v[148:151], v6 offset:256
    ds_read_b128 v[152:155], v6 offset:512
    ds_read_b128 v[156:159], v6 offset:768
    s_waitcnt lgkmcnt(2)
    v_pk_add_f32 v[144:145], v[144:145], v[148:149]
    v_pk_add_f32 v[146:147], v[146:147], v[150:151]
    s_waitcnt lgkmcnt(0)
    v_pk_add_f32 v[152:153], v[152:153], v[156:157]
    v_pk_add_f32 v[154:155], v[154:155], v[158:159]
    v_pk_add_f32 v[144:145], v[144:145], v[152:153]
    v_pk_add_f32 v[146:147], v[146:147], v[154:155]
    v_mov_b32 v148, v144
    v_mov_b32 v149, v145
    v_mov_b32 v150, v146
    v_mov_b32 v151, v147
    v_permlane32_swap_b32 v144, v148
    v_permlane32_swap_b32 v145, v149
    v_permlane32_swap_b32 v146, v150
    v_permlane32_swap_b32 v147, v151
    v_pk_add_f32 v[144:145], v[144:145], v[148:149]
    v_pk_add_f32 v[146:147], v[146:147], v[150:151]
    v_mul_f32 v145, 0xba800000, v145
    v_mul_f32 v146, 0x3a800000, v146
    v_fma_f32 v146, -v145, v145, v146
    v_cvt_pk_bf16_f32 v153, 0, v145
    v_cvt_pk_bf16_f32 v146, 0, v146
    v_add_f32 v146, 0x3727c5ac, v146
    v_cvt_pk_bf16_f32 v146, 0, v146
    v_sqrt_f32 v146, v146
    v_fmac_f32 v144, v153, v147
    v_cvt_pk_bf16_f32 v146, 0, v146
    v_rcp_f32 v154, v146
    v_mov_b32 v155, s40
    v_mul_f32 v144, v144, v154
    v_cvt_pk_bf16_f32 v144, 0, v144
    v_ashrrev_i32 v145, 31, v144
    v_or_b32 v145, 0x80000000, v145
    v_bitop3_b32 v152, v144, v145, v242 bitop3:0x28
    v_or_b32 v152, v152, v15
    s_nop 1
    v_max_u32_dpp v144, v152, v152 row_ror:1 row_mask:0xf bank_mask:0xf
    s_nop 1
    v_max_u32_dpp v144, v144, v144 row_ror:2 row_mask:0xf bank_mask:0xf
    s_nop 1
    v_max_u32_dpp v144, v144, v144 row_ror:4 row_mask:0xf bank_mask:0xf
    s_nop 1
    v_max_u32_dpp v144, v144, v144 row_ror:8 row_mask:0xf bank_mask:0xf
    v_cmp_eq_u32 vcc, v144, v152
    s_nop 1
    s_mov_b64 exec, vcc
    buffer_store_dwordx4 v[152:155], v7, s[4:7], s26 offen sc1
    buffer_store_dwordx4 v[120:123], v8, s[4:7], s27 offen offset:0 sc1
    buffer_store_dwordx4 v[124:127], v8, s[4:7], s27 offen offset:64 sc1
    buffer_store_dwordx4 v[128:131], v8, s[4:7], s27 offen offset:128 sc1
    buffer_store_dwordx4 v[132:135], v8, s[4:7], s27 offen offset:192 sc1
    s_mov_b64 exec, -1
    s_ff1_i32_b64 s37, vcc
    v_add_f32 v144, 1.0, v154
    v_mul_f32 v146, v153, v154
    v_pk_fma_f32 v[168:169], v[168:169], v[144:145], v[146:147] op_sel_hi:[1,0,0]
    v_pk_fma_f32 v[170:171], v[170:171], v[144:145], v[146:147] op_sel_hi:[1,0,0]
    v_pk_fma_f32 v[172:173], v[172:173], v[144:145], v[146:147] op_sel_hi:[1,0,0]
    v_pk_fma_f32 v[174:175], v[174:175], v[144:145], v[146:147] op_sel_hi:[1,0,0]
    v_pk_fma_f32 v[176:177], v[176:177], v[144:145], v[146:147] op_sel_hi:[1,0,0]
    v_pk_fma_f32 v[178:179], v[178:179], v[144:145], v[146:147] op_sel_hi:[1,0,0]
    v_pk_fma_f32 v[180:181], v[180:181], v[144:145], v[146:147] op_sel_hi:[1,0,0]
    v_pk_fma_f32 v[182:183], v[182:183], v[144:145], v[146:147] op_sel_hi:[1,0,0]
    v_pk_fma_f32 v[184:185], v[184:185], v[144:145], v[146:147] op_sel_hi:[1,0,0]
    v_pk_fma_f32 v[186:187], v[186:187], v[144:145], v[146:147] op_sel_hi:[1,0,0]
    v_pk_fma_f32 v[188:189], v[188:189], v[144:145], v[146:147] op_sel_hi:[1,0,0]
    v_pk_fma_f32 v[190:191], v[190:191], v[144:145], v[146:147] op_sel_hi:[1,0,0]
    v_pk_fma_f32 v[192:193], v[192:193], v[144:145], v[146:147] op_sel_hi:[1,0,0]
    v_pk_fma_f32 v[194:195], v[194:195], v[144:145], v[146:147] op_sel_hi:[1,0,0]
    v_pk_fma_f32 v[196:197], v[196:197], v[144:145], v[146:147] op_sel_hi:[1,0,0]
    v_pk_fma_f32 v[198:199], v[198:199], v[144:145], v[146:147] op_sel_hi:[1,0,0]
    v_cvt_pk_bf16_f32 v104, v168, v169
    v_cvt_pk_bf16_f32 v105, v170, v171
    v_cvt_pk_bf16_f32 v106, v172, v173
    v_cvt_pk_bf16_f32 v107, v174, v175
    v_cvt_pk_bf16_f32 v108, v176, v177
    v_cvt_pk_bf16_f32 v109, v178, v179
    v_cvt_pk_bf16_f32 v110, v180, v181
    v_cvt_pk_bf16_f32 v111, v182, v183
    v_cvt_pk_bf16_f32 v112, v184, v185
    v_cvt_pk_bf16_f32 v113, v186, v187
    v_cvt_pk_bf16_f32 v114, v188, v189
    v_cvt_pk_bf16_f32 v115, v190, v191
    v_cvt_pk_bf16_f32 v116, v192, v193
    v_cvt_pk_bf16_f32 v117, v194, v195
    v_cvt_pk_bf16_f32 v118, v196, v197
    v_cvt_pk_bf16_f32 v119, v198, v199
    ds_write_b128 v231, v[104:107]
    ds_write_b128 v231, v[108:111] offset:16
    s_waitcnt lgkmcnt(0)
    s_barrier
    ds_write_b16 v233, v104
    ds_write_b16 v241, v112
    ds_write_b16_d16_hi v232, v112 offset:28
    ds_write_b16 v232, v113 offset:26
    ds_write_b16_d16_hi v232, v113 offset:24
    ds_write_b16 v232, v114 offset:22
    ds_write_b16_d16_hi v232, v114 offset:20
    ds_write_b16 v232, v115 offset:18
    ds_write_b16_d16_hi v232, v115 offset:16
    ds_write_b16 v232, v116 offset:14
    ds_write_b16_d16_hi v232, v116 offset:12
    ds_write_b16 v232, v117 offset:10
    ds_write_b16_d16_hi v232, v117 offset:8
    ds_write_b16 v232, v118 offset:6
    ds_write_b16_d16_hi v232, v118 offset:4
    ds_write_b16 v232, v119 offset:2
    ds_write_b16_d16_hi v232, v119 offset:0
    s_lshl_b32 s32, s3, 1
    s_add_u32 s33, s32, 1
    v_readlane_b32 s34, v230, s32
    v_readlane_b32 s35, v230, s33
    s_mul_i32 s38, s3, 4128
    v_add_u32 v9, s38, v239
    s_lshl_b32 s34, s34, 11
    s_lshl_b32 s35, s35, 11
    s_waitcnt lgkmcnt(0)
    s_barrier
    ds_read_b128 v[104:107], v9 offset:0
    ds_read_b128 v[108:111], v9 offset:1024
    ds_read_b128 v[112:115], v9 offset:2064
    ds_read_b128 v[116:119], v9 offset:3088
    s_waitcnt lgkmcnt(0)
    s_cmp_eq_u32 s37, s32
    s_cbranch_scc1 fz_sk0
    buffer_store_dwordx4 v[104:107], v239, s[12:15], s34 offen offset:0 nt
    buffer_store_dwordx4 v[108:111], v239, s[12:15], s34 offen offset:1024 nt
fz_sk0:
    s_cmp_eq_u32 s37, s33
    s_cbranch_scc1 fz_sk1
    buffer_store_dwordx4 v[112:115], v239, s[12:15], s35 offen offset:0 nt
    buffer_store_dwordx4 v[116:119], v239, s[12:15], s35 offen offset:1024 nt
fz_sk1:
    s_lshr_b32 s38, s37, 1
    s_cmp_lg_u32 s38, s3
    s_cbranch_scc1 fz_xend
    s_and_b32 s38, s20, 31
    s_mul_i32 s38, s38, 2176
    s_add_u32 s38, s38, 0x420000
    s_lshr_b32 s52, s20, 4
    s_lshl_b32 s52, s52, 7
    s_and_b32 s53, s20, 3
    s_lshl_b32 s53, s53, 5
    s_add_u32 s52, s52, s53
    s_bfe_u32 s53, s20, 0x20002
    s_lshl_b32 s53, s53, 2
    s_add_u32 s52, s52, s53
    v_and_b32 v2, 1, v1
    v_lshl_add_u32 v2, v2, 4, v5
    v_add_u32 v2, s52, v2
    v_and_b32 v3, 31, v2
    v_lshrrev_b32 v6, 5, v2
    v_cmp_gt_u32 vcc, 16, v6
    v_cmp_lt_u32 s[52:53], 16, v3
    v_cmp_eq_u32 s[54:55], 0, v3
    s_nop 1
    s_and_b64 s[54:55], s[54:55], vcc
    s_or_b64 s[52:53], s[52:53], s[54:55]
    v_cmp_eq_u32 s[54:55], 16, v3
    s_nop 1
    s_andn2_b64 s[54:55], s[54:55], vcc
    s_or_b64 s[52:53], s[52:53], s[54:55]
    v_sub_u32 v7, 1024, v2
    v_cndmask_b32 v7, v2, v7, s[52:53]
    v_mov_b32 v8, 512
    v_cmp_eq_u32 vcc, 1024, v7
    s_nop 1
    v_cndmask_b32 v7, v7, v8, vcc
    v_lshrrev_b32 v8, 5, v7
    v_and_b32 v7, 15, v7
    v_lshrrev_b32 v9, 2, v8
    v_lshlrev_b32 v9, 8, v9
    v_and_b32 v8, 3, v8
    v_lshl_add_u32 v9, v8, 4, v9
    v_lshrrev_b32 v8, 3, v7
    v_lshl_add_u32 v9, v8, 6, v9
    v_and_b32 v7, 7, v7
    v_lshl_add_u32 v9, v7, 1, v9
    v_cndmask_b32 v7, 0, 1, s[52:53]
    v_lshl_add_u32 v9, v7, 7, v9
    v_lshlrev_b32 v2, 1, v2
    v_lshrrev_b32 v3, 1, v1
    v_mul_u32_u24 v3, 4224, v3
    v_and_b32 v6, 1, v1
    v_lshl_add_u32 v3, v6, 4, v3
    v_mov_b32 v6, 0x7fffffff
    v_cmp_gt_u32 vcc, 32, v1
    s_nop 1
    v_cndmask_b32 v6, v6, v3, vcc
    v_mov_b32 v7, s48
    v_cndmask_b32 v16, 0, v7, vcc
    v_mov_b32 v7, s49
    v_cndmask_b32 v17, 0, v7, vcc
    v_mov_b32 v7, s50
    v_cndmask_b32 v18, 0, v7, vcc
    v_mov_b32 v7, s51
    v_cndmask_b32 v19, 0, v7, vcc
    s_lshl_b32 s52, s20, 5
    s_add_u32 s52, s52, 0x490000
    s_add_u32 s53, s52, 135168
    s_add_u32 s54, s52, 270336
    s_add_u32 s55, s52, 405504
    s_mov_b32 s58, 0
    s_nop 0
fz_k2:
    buffer_load_dwordx4 v[24:27], v239, s[4:7], s38 offen sc1
    buffer_load_dwordx4 v[28:31], v239, s[4:7], s38 offen offset:1024 sc1
    s_waitcnt vmcnt(0)
    v_xor_b32 v32, s40, v27
    v_xor_b32 v33, s40, v31
    v_max_u32 v34, v24, v28
    v_or_b32 v32, v32, v33
    v_cmp_ne_u32 vcc, 0, v32
    s_cbranch_vccnz fz_k2_rt
fz_k2_ok:
    v_max_u32_dpp v34, v34, v34 quad_perm:[1,0,3,2] row_mask:0xf bank_mask:0xf
    s_nop 1
    v_max_u32_dpp v34, v34, v34 quad_perm:[2,3,0,1] row_mask:0xf bank_mask:0xf
    s_nop 1
    v_max_u32_dpp v34, v34, v34 row_half_mirror row_mask:0xf bank_mask:0xf
    s_nop 1
    v_max_u32_dpp v34, v34, v34 row_mirror row_mask:0xf bank_mask:0xf
    s_nop 1
    v_max_u32_dpp v34, v34, v34 row_bcast:15 row_mask:0xa bank_mask:0xf
    s_nop 1
    v_max_u32_dpp v34, v34, v34 row_bcast:31 row_mask:0xc bank_mask:0xf
    s_nop 0
    v_readlane_b32 s36, v34, 63
    s_nop 1
    v_cmp_eq_u32 vcc, s36, v24
    v_cmp_eq_u32 s[56:57], s36, v28
    s_nop 1
    v_cndmask_b32 v25, v25, v29, s[56:57]
    v_cndmask_b32 v26, v26, v30, s[56:57]
    s_cmp_lg_u64 vcc, 0
    s_cselect_b32 s39, 0, 64
    s_or_b64 vcc, vcc, s[56:57]
    s_ff1_i32_b64 s41, vcc
    v_readlane_b32 s42, v25, s41
    v_readlane_b32 s43, v26, s41
    s_add_u32 s39, s39, s41
    s_cmp_eq_u32 s39, s20
    s_cbranch_scc1 fz_win
    s_bitcmp1_b32 s37, 0
    s_cbranch_scc1 fz_d1
    buffer_store_dwordx4 v[104:107], v239, s[12:15], s34 offen offset:0 nt
    buffer_store_dwordx4 v[108:111], v239, s[12:15], s34 offen offset:1024 nt
    s_branch fz_win
fz_d1:
    buffer_store_dwordx4 v[112:115], v239, s[12:15], s35 offen offset:0 nt
    buffer_store_dwordx4 v[116:119], v239, s[12:15], s35 offen offset:1024 nt
fz_win:
    s_lshl_b32 s39, s39, 11
    s_add_u32 s39, s39, 0x440000
    s_mov_b32 s58, 0
    s_mov_b32 s41, 0xffff0000
    s_nop 0
fz_c2:
    buffer_load_short_d16_hi v10, v9, s[4:7], s39 offen sc1
    s_waitcnt vmcnt(0)
    v_cmp_eq_u32 vcc, s41, v10
    s_cbranch_vccnz fz_c2_rt
fz_c2_ok:
    v_add_f32 v11, s42, v10
    v_cvt_pk_bf16_f32 v11, 0, v11
    v_mul_f32 v11, s43, v11
    v_cvt_pk_bf16_f32 v11, 0, v11
    s_ashr_i32 s39, s36, 31
    s_not_b32 s39, s39
    s_or_b32 s39, s39, 0x80000000
    s_xor_b32 s39, s36, s39
    s_and_b32 s39, s39, 0xffff0000
    v_mov_b32 v12, s39
    v_mul_f32 v12, 0xbfb8aa3b, v12
    v_exp_f32 v12, v12
    s_nop 0
    v_add_f32 v12, 1.0, v12
    v_rcp_f32 v12, v12
    s_nop 0
    v_cvt_pk_bf16_f32 v12, 0, v12
    s_and_b32 s39, s36, 0xffff
    s_sub_u32 s39, 2047, s39
    s_lshl_b32 s39, s39, 11
    v_mov_b32 v13, 0xff
    s_mov_b32 s58, 0
    s_and_b32 s41, s20, 63
    s_mul_i32 s41, s41, 4224
    s_add_u32 s41, s41, s52
    v_mov_b32 v7, 0
    s_nop 4
fz_p5:
    buffer_load_dword v8, v7, s[4:7], s41 offen sc1
    s_waitcnt vmcnt(0)
    v_and_b32 v8, 0xff, v8
    v_cmp_ne_u32 vcc, s48, v8
    s_cbranch_vccnz fz_p5_rt
fz_p5_ok:
    s_mov_b32 s58, 0
    s_nop 2
fz_h5:
    buffer_load_dwordx4 v[40:43], v3, s[4:7], s52 offen sc1
    buffer_load_dwordx4 v[44:47], v3, s[4:7], s53 offen sc1
    buffer_load_dwordx4 v[48:51], v3, s[4:7], s54 offen sc1
    buffer_load_dwordx4 v[52:55], v6, s[4:7], s55 offen sc1
    s_waitcnt vmcnt(3)
    v_xor_b32 v40, s48, v40
    v_xor_b32 v41, s49, v41
    v_xor_b32 v42, s50, v42
    v_xor_b32 v43, s51, v43
    v_or3_b32 v8, v40, v41, 0
    v_or3_b32 v8, v42, v43, v8
    s_waitcnt vmcnt(2)
    v_xor_b32 v44, s48, v44
    v_xor_b32 v45, s49, v45
    v_xor_b32 v46, s50, v46
    v_xor_b32 v47, s51, v47
    v_or3_b32 v8, v44, v45, v8
    v_or3_b32 v8, v46, v47, v8
    s_waitcnt vmcnt(1)
    v_xor_b32 v48, s48, v48
    v_xor_b32 v49, s49, v49
    v_xor_b32 v50, s50, v50
    v_xor_b32 v51, s51, v51
    v_or3_b32 v8, v48, v49, v8
    v_or3_b32 v8, v50, v51, v8
    s_waitcnt vmcnt(0)
    v_xor_b32 v52, v16, v52
    v_xor_b32 v53, v17, v53
    v_xor_b32 v54, v18, v54
    v_xor_b32 v55, v19, v55
    v_or3_b32 v8, v52, v53, v8
    v_or3_b32 v8, v54, v55, v8
    v_and_b32 v8, 0xff, v8
    v_cmp_ne_u32 vcc, 0, v8
    s_cbranch_vccnz fz_h5_rt
fz_h5_ok:
    v_pk_add_f32 v[40:41], v[40:41], v[44:45]
    v_pk_add_f32 v[42:43], v[42:43], v[46:47]
    v_pk_add_f32 v[48:49], v[48:49], v[52:53]
    v_pk_add_f32 v[50:51], v[50:51], v[54:55]
    v_pk_add_f32 v[40:41], v[40:41], v[48:49]
    v_pk_add_f32 v[42:43], v[42:43], v[50:51]
    s_nop 1
    v_permlane32_swap_b32 v40, v42
    v_permlane32_swap_b32 v41, v43
    v_pk_add_f32 v[40:41], v[40:41], v[42:43]
    s_nop 1
    v_permlane16_swap_b32 v40, v41
    v_add_f32 v40, v40, v41
    s_nop 1
    v_add_f32_dpp v40, v40, v40 quad_perm:[2,3,0,1] row_mask:0xf bank_mask:0xf
    s_nop 1
    v_add_f32_dpp v40, v40, v40 row_ror:4 row_mask:0xf bank_mask:0xf
    s_nop 1
    v_add_f32_dpp v40, v40, v40 row_ror:8 row_mask:0xf bank_mask:0xf
    v_cvt_pk_bf16_f32 v40, 0, v40
    v_mul_f32 v40, v40, v12
    v_cvt_pk_bf16_f32 v40, 0, v40
    v_add_f32 v40, v40, v11
    v_cvt_pk_bf16_f32 v40, 0, v40
    v_add_f32 v40, v40, v10
    v_cvt_pk_bf16_f32 v40, 0, v40
    s_mov_b32 exec_lo, 0x00030003
    s_mov_b32 exec_hi, 0x00030003
    buffer_store_short_d16_hi v40, v2, s[12:15], s39 offen
    s_cmp_lg_u32 s20, 0
    s_cbranch_scc1 fz_xend
    s_mov_b64 exec, 1
    v_mov_b32 v8, s40
    buffer_store_dword v8, v7, s[4:7], 0 offen
fz_xend:
fz_end:
    s_endpgm
fz_spec:
    s_cmp_eq_u32 s3, 0
    s_cselect_b32 s30, 16, s30
    s_cmp_eq_u32 s3, 2
    s_cselect_b32 s31, 17, s31
    s_cselect_b32 s30, 18, s30
    s_cmp_eq_u32 s3, 3
    s_cselect_b32 s31, 19, s31
    s_cselect_b32 s30, 20, s30
    s_branch fz_specback
fz_spec2:
    s_cmp_lg_u32 s3, 0
    s_cbranch_scc1 fz_s2n0
    s_mov_b32 m0, 30960
    s_mov_b32 s32, 2097152
    buffer_load_dwordx4 v239, s[8:11], s32 offen lds
    buffer_load_dwordx4 v239, s[8:11], s32 offen offset:1024 lds
fz_s2n0:
    s_cmp_lg_u32 s3, 2
    s_cbranch_scc1 fz_s2n2
    s_mov_b32 m0, 8256
    s_mov_b32 s32, 524288
    buffer_load_dwordx4 v239, s[8:11], s32 offen lds
    buffer_load_dwordx4 v239, s[8:11], s32 offen offset:1024 lds
    s_mov_b32 m0, 22704
    s_mov_b32 s32, 3670016
    buffer_load_dwordx4 v239, s[8:11], s32 offen lds
    buffer_load_dwordx4 v239, s[8:11], s32 offen offset:1024 lds
fz_s2n2:
    s_cmp_lg_u32 s3, 3
    s_cbranch_scc1 fz_s2n3
    s_mov_b32 m0, 12384
    s_mov_b32 s32, 1572864
    buffer_load_dwordx4 v239, s[8:11], s32 offen lds
    buffer_load_dwordx4 v239, s[8:11], s32 offen offset:1024 lds
    s_mov_b32 m0, 18576
    s_mov_b32 s32, 2621440
    buffer_load_dwordx4 v239, s[8:11], s32 offen lds
    buffer_load_dwordx4 v239, s[8:11], s32 offen offset:1024 lds
fz_s2n3:
    s_branch fz_spec2back
fz_spec3:
    v_xor_b32 v11, 1, v4
    v_cndmask_b32 v9, v9, v11, s[34:35]
    v_and_b32 v11, 1, v4
    v_cndmask_b32 v11, 0, v11, s[34:35]
    v_sub_u32 v10, v10, v11
    s_cmp_lg_u32 s22, 0
    s_cbranch_scc1 fz_spec3back
    v_cmp_eq_u32 vcc, 15, v4
    v_mov_b32 v11, 1024
    v_mov_b32 v12, 124
    v_cndmask_b32 v230, v230, v11, vcc
    v_cndmask_b32 v10, v10, v12, vcc
    v_cndmask_b32 v9, v9, 4, vcc
    v_cmp_eq_u32 vcc, 13, v4
    v_mov_b32 v11, 1536
    v_mov_b32 v12, 124
    v_cndmask_b32 v230, v230, v11, vcc
    v_cndmask_b32 v10, v10, v12, vcc
    v_cndmask_b32 v9, v9, 6, vcc
    v_cmp_eq_u32 vcc, 4, v4
    v_mov_b32 v11, 256
    v_mov_b32 v12, 127
    v_cndmask_b32 v230, v230, v11, vcc
    v_cndmask_b32 v10, v10, v12, vcc
    v_cndmask_b32 v9, v9, 8, vcc
    v_cmp_eq_u32 vcc, 11, v4
    v_mov_b32 v11, 1792
    v_mov_b32 v12, 127
    v_cndmask_b32 v230, v230, v11, vcc
    v_cndmask_b32 v10, v10, v12, vcc
    v_cndmask_b32 v9, v9, 14, vcc
    v_cmp_eq_u32 vcc, 6, v4
    v_mov_b32 v11, 768
    v_mov_b32 v12, 127
    v_cndmask_b32 v230, v230, v11, vcc
    v_cndmask_b32 v10, v10, v12, vcc
    v_cndmask_b32 v9, v9, 10, vcc
    v_cmp_eq_u32 vcc, 9, v4
    v_mov_b32 v11, 1280
    v_mov_b32 v12, 127
    v_cndmask_b32 v230, v230, v11, vcc
    v_cndmask_b32 v10, v10, v12, vcc
    v_cndmask_b32 v9, v9, 12, vcc
    s_mov_b32 s38, 0x80018001
    s_mov_b32 s39, 0x80018001
    s_nop 2
    s_branch fz_spec3back
    s_nop 0
ffn:
    s_load_dwordx2 s[8:9], s[0:1], 56
    s_load_dwordx2 s[12:13], s[0:1], 64
    s_load_dwordx2 s[16:17], s[0:1], 72
    s_and_b32 s21, s20, 7
    s_mul_i32 s21, s21, 14
    s_lshr_b32 s20, s20, 3
    s_add_u32 s20, s20, s21
    s_and_b32 s21, s20, 1
    s_lshr_b32 s22, s20, 1
    v_lshrrev_b32 v2, 3, v1
    v_and_b32 v3, 7, v1
    v_and_b32 v4, 2, v2
    v_xor_b32 v3, v4, v3
    v_mul_u32_u24 v4, 7168, v2
    v_lshl_add_u32 v4, v3, 4, v4
    v_xor_b32 v5, 64, v4
    s_lshl_b32 s23, s21, 9
    s_lshl_b32 s24, s3, 6
    s_add_u32 s23, s23, s24
    s_mul_i32 s23, s23, 7168
    s_lshl_b32 s24, s22, 7
    s_add_u32 s23, s23, s24
    s_lshl_b32 s24, s3, 13
    v_lshrrev_b32 v2, 4, v1
    v_and_b32 v3, 15, v1
    v_lshlrev_b32 v6, 1, v2
    v_xor_b32 v6, v6, v3
    v_lshlrev_b32 v6, 4, v6
    v_lshl_add_u32 v6, v2, 11, v6
    v_xor_b32 v7, 128, v6
    s_lshl_b32 s25, s20, 16
    s_lshl_b32 s26, s3, 8
    s_add_u32 s25, s25, s26
    s_mul_i32 s26, s3, 3072
    s_add_u32 s26, s26, 131072
    s_mul_i32 s27, s3, 5120
    s_mov_b32 s10, 0x700000
    s_mov_b32 s11, 0x00020000
    s_mov_b32 s14, 0x700000
    s_mov_b32 s15, 0x00020000
    s_mov_b32 s18, 0x700000
    s_mov_b32 s19, 0x00020000
    s_waitcnt lgkmcnt(0)
    s_add_u32 s28, s24, 0
    s_mov_b32 m0, s28
    s_add_u32 s29, s23, 0
    buffer_load_dwordx4 v4, s[8:11], s29 offen lds
    s_add_u32 s28, s24, 1024
    s_mov_b32 m0, s28
    s_add_u32 s29, s23, 57344
    buffer_load_dwordx4 v5, s[8:11], s29 offen lds
    s_add_u32 s28, s24, 2048
    s_mov_b32 m0, s28
    s_add_u32 s29, s23, 114688
    buffer_load_dwordx4 v4, s[8:11], s29 offen lds
    s_add_u32 s28, s24, 3072
    s_mov_b32 m0, s28
    s_add_u32 s29, s23, 172032
    buffer_load_dwordx4 v5, s[8:11], s29 offen lds
    s_add_u32 s28, s24, 4096
    s_mov_b32 m0, s28
    s_add_u32 s29, s23, 229376
    buffer_load_dwordx4 v4, s[8:11], s29 offen lds
    s_add_u32 s28, s24, 5120
    s_mov_b32 m0, s28
    s_add_u32 s29, s23, 286720
    buffer_load_dwordx4 v5, s[8:11], s29 offen lds
    s_add_u32 s28, s24, 6144
    s_mov_b32 m0, s28
    s_add_u32 s29, s23, 344064
    buffer_load_dwordx4 v4, s[8:11], s29 offen lds
    s_add_u32 s28, s24, 7168
    s_mov_b32 m0, s28
    s_add_u32 s29, s23, 401408
    buffer_load_dwordx4 v5, s[8:11], s29 offen lds
    s_add_u32 s28, s24, 65536
    s_mov_b32 m0, s28
    s_add_u32 s29, s23, 0
    buffer_load_dwordx4 v4, s[12:15], s29 offen lds
    s_add_u32 s28, s24, 66560
    s_mov_b32 m0, s28
    s_add_u32 s29, s23, 57344
    buffer_load_dwordx4 v5, s[12:15], s29 offen lds
    s_add_u32 s28, s24, 67584
    s_mov_b32 m0, s28
    s_add_u32 s29, s23, 114688
    buffer_load_dwordx4 v4, s[12:15], s29 offen lds
    s_add_u32 s28, s24, 68608
    s_mov_b32 m0, s28
    s_add_u32 s29, s23, 172032
    buffer_load_dwordx4 v5, s[12:15], s29 offen lds
    s_add_u32 s28, s24, 69632
    s_mov_b32 m0, s28
    s_add_u32 s29, s23, 229376
    buffer_load_dwordx4 v4, s[12:15], s29 offen lds
    s_add_u32 s28, s24, 70656
    s_mov_b32 m0, s28
    s_add_u32 s29, s23, 286720
    buffer_load_dwordx4 v5, s[12:15], s29 offen lds
    s_add_u32 s28, s24, 71680
    s_mov_b32 m0, s28
    s_add_u32 s29, s23, 344064
    buffer_load_dwordx4 v4, s[12:15], s29 offen lds
    s_add_u32 s28, s24, 72704
    s_mov_b32 m0, s28
    s_add_u32 s29, s23, 401408
    buffer_load_dwordx4 v5, s[12:15], s29 offen lds
    s_add_u32 s28, s26, 0
    s_mov_b32 m0, s28
    s_add_u32 s29, s25, 0
    buffer_load_dwordx4 v6, s[16:19], s29 offen lds
    s_add_u32 s28, s26, 1024
    s_mov_b32 m0, s28
    s_add_u32 s29, s25, 8192
    buffer_load_dwordx4 v6, s[16:19], s29 offen lds
    s_add_u32 s28, s26, 2048
    s_mov_b32 m0, s28
    s_add_u32 s29, s25, 16384
    buffer_load_dwordx4 v7, s[16:19], s29 offen lds
    s_load_dword s40, s[4:5], 0
    v_bfe_u32 v9, v1, 2, 2
    v_lshl_add_u32 v8, v2, 3, v9
    v_lshlrev_b32 v8, 7, v8
    s_and_b32 s28, s3, 3
    s_lshl_b32 s28, s28, 1
    v_bfe_u32 v10, v1, 1, 1
    v_add_u32 v10, s28, v10
    v_and_b32 v11, 2, v9
    v_xor_b32 v10, v11, v10
    v_and_b32 v11, 1, v2
    v_lshlrev_b32 v11, 2, v11
    v_xor_b32 v10, v11, v10
    v_lshl_add_u32 v8, v10, 4, v8
    v_and_b32 v10, 1, v1
    v_lshl_add_u32 v8, v10, 3, v8
    s_lshr_b32 s28, s3, 2
    s_lshl_b32 s28, s28, 16
    v_add_u32 v8, s28, v8
    v_and_b32 v10, 1, v2
    v_lshl_add_u32 v10, v10, 2, v9
    v_lshlrev_b32 v10, 5, v10
    v_lshl_add_u32 v10, v9, 8, v10
    v_and_b32 v11, 3, v1
    v_lshl_add_u32 v10, v11, 3, v10
    s_sub_u32 s28, s27, 3072
    v_lshl_add_u32 v11, v2, 1, 0
    v_cmp_gt_u32 vcc, 3, v11
    v_mov_b32 v14, s28
    v_mov_b32 v15, s26
    v_cndmask_b32 v14, v14, v15, vcc
    v_lshl_add_u32 v14, v11, 10, v14
    v_add_u32 v12, v14, v10
    v_lshl_add_u32 v11, v2, 1, 1
    v_cmp_gt_u32 vcc, 3, v11
    v_mov_b32 v14, s28
    v_mov_b32 v15, s26
    v_cndmask_b32 v14, v14, v15, vcc
    v_lshl_add_u32 v14, v11, 10, v14
    v_add_u32 v13, v14, v10
    v_bfe_u32 v9, v0, 2, 2
    v_lshrrev_b32 v10, 6, v0
    v_lshl_add_u32 v9, v10, 2, v9
    v_bfe_u32 v10, v0, 4, 1
    v_and_b32 v11, 3, v0
    v_lshlrev_b32 v11, 1, v11
    v_lshl_add_u32 v10, v10, 3, v11
    v_lshl_add_u32 v11, v9, 5, v10
    v_add_u32 v17, 1, v11
    v_cmp_eq_u32 vcc, 0, v10
    v_cmp_gt_u32 s[28:29], 16, v9
    s_nop 1
    s_and_b64 vcc, vcc, s[28:29]
    v_cndmask_b32 v14, 0, 16, vcc
    v_add_u32 v16, v11, v14
    v_bfe_u32 v10, v0, 5, 1
    v_cmp_eq_u32 s[28:29], 1, v10
    v_sub_u32 v14, 1024, v16
    v_cmp_eq_u32 vcc, 512, v16
    s_nop 1
    v_cndmask_b32 v14, v14, 0, vcc
    v_cndmask_b32 v16, v16, v14, s[28:29]
    v_sub_u32 v14, 1024, v17
    v_cndmask_b32 v17, v17, v14, s[28:29]
    v_lshlrev_b32 v16, 1, v16
    v_add_u32 v16, 155648, v16
    v_lshlrev_b32 v17, 1, v17
    v_add_u32 v17, 155648, v17
    v_lshlrev_b32 v18, 2, v0
    v_add_u32 v18, 0x440000, v18
    s_lshl_b32 s28, s21, 10
    s_add_u32 s28, s28, 155648
    v_lshlrev_b32 v19, 4, v2
    v_add_u32 v10, 158016, v19
    v_add_u32 v19, s28, v19
    v_cmp_eq_u32 vcc, 0, v3
    s_nop 1
    v_cndmask_b32 v11, 64, 0, vcc
    v_add_u32 v20, v10, v11
    v_cmp_eq_u32 vcc, 1, v3
    s_nop 1
    v_cndmask_b32 v11, 64, 0, vcc
    v_add_u32 v21, v10, v11
    v_cmp_eq_u32 vcc, 2, v3
    s_nop 1
    v_cndmask_b32 v11, 64, 0, vcc
    v_add_u32 v22, v10, v11
    v_cmp_eq_u32 vcc, 3, v3
    s_nop 1
    v_cndmask_b32 v11, 64, 0, vcc
    v_add_u32 v23, v10, v11
    v_cmp_eq_u32 vcc, 4, v3
    s_nop 1
    v_cndmask_b32 v11, 64, 0, vcc
    v_add_u32 v24, v10, v11
    v_cmp_eq_u32 vcc, 5, v3
    s_nop 1
    v_cndmask_b32 v11, 64, 0, vcc
    v_add_u32 v25, v10, v11
    v_cmp_eq_u32 vcc, 6, v3
    s_nop 1
    v_cndmask_b32 v11, 64, 0, vcc
    v_add_u32 v26, v10, v11
    v_cmp_eq_u32 vcc, 7, v3
    s_nop 1
    v_cndmask_b32 v11, 64, 0, vcc
    v_add_u32 v27, v10, v11
    v_mov_b32 v10, 158080
    v_lshl_add_u32 v10, v3, 2, v10
    v_mov_b32 v11, 0
    ds_write_b32 v10, v11
    v_mov_b32 v28, 157696
    v_lshlrev_b32 v29, 4, v1
    s_lshr_b32 s28, s3, 2
    s_lshl_b32 s28, s28, 1
    s_and_b32 s29, s3, 1
    s_add_u32 s28, s28, s29
    s_lshl_b32 s28, s28, 6
    v_lshlrev_b32 v30, 4, v2
    v_add_u32 v30, s28, v30
    v_add_u32 v31, 157760, v30
    s_xor_b32 s30, s20, 1
    s_lshl_b32 s30, s30, 8
    s_add_u32 s30, s30, 0x481000
    s_lshl_b32 s31, s20, 8
    s_add_u32 s31, s31, 0x481000
    s_bfe_u32 s32, s3, 0x10001
    s_mul_i32 s33, s20, 4224
    s_lshl_b32 s28, s3, 9
    s_add_u32 s33, s33, s28
    s_add_u32 s33, s33, 0x490000
    v_lshlrev_b32 v10, 7, v2
    v_lshl_add_u32 v196, v3, 4, v10
    v_mov_b32 v197, 0xffffff00
    s_waitcnt lgkmcnt(0)
    s_add_u32 s40, s40, 1
    s_bfe_u32 s44, s40, 0x20000
    s_bfe_u32 s41, s40, 0x20002
    s_lshl_b32 s41, s41, 16
    s_or_b32 s44, s44, s41
    s_bfe_u32 s48, s40, 0x80000
    s_bfe_u32 s45, s40, 0x20004
    s_bfe_u32 s41, s40, 0x20006
    s_lshl_b32 s41, s41, 16
    s_or_b32 s45, s45, s41
    s_bfe_u32 s49, s40, 0x80008
    s_bfe_u32 s46, s40, 0x20008
    s_bfe_u32 s41, s40, 0x2000a
    s_lshl_b32 s41, s41, 16
    s_or_b32 s46, s46, s41
    s_bfe_u32 s50, s40, 0x80010
    s_bfe_u32 s47, s40, 0x2000c
    s_bfe_u32 s41, s40, 0x2000e
    s_lshl_b32 s41, s41, 16
    s_or_b32 s47, s47, s41
    s_bfe_u32 s51, s40, 0x80018
    s_and_b32 s34, s20, 31
    s_mul_i32 s34, s34, 2176
    s_add_u32 s34, s34, 0x420000
    s_waitcnt vmcnt(11)
    s_barrier
    s_cmp_gt_u32 s3, 3
    s_cbranch_scc1 ffn_a
    ds_read_b64_tr_b16 v[32:33], v8 offset:0
    ds_read_b64_tr_b16 v[34:35], v8 offset:512
    ds_read_b64_tr_b16 v[36:37], v8 offset:4096
    ds_read_b64_tr_b16 v[38:39], v8 offset:4608
    ds_read_b64_tr_b16 v[40:41], v8 offset:8192
    ds_read_b64_tr_b16 v[42:43], v8 offset:8704
    ds_read_b64_tr_b16 v[44:45], v8 offset:12288
    ds_read_b64_tr_b16 v[46:47], v8 offset:12800
    s_waitcnt lgkmcnt(0)
    ds_read_b64_tr_b16 v[48:49], v8 offset:16384
    ds_read_b64_tr_b16 v[50:51], v8 offset:16896
    ds_read_b64_tr_b16 v[52:53], v8 offset:20480
    ds_read_b64_tr_b16 v[54:55], v8 offset:20992
    ds_read_b64_tr_b16 v[56:57], v8 offset:24576
    ds_read_b64_tr_b16 v[58:59], v8 offset:25088
    ds_read_b64_tr_b16 v[60:61], v8 offset:28672
    ds_read_b64_tr_b16 v[62:63], v8 offset:29184
    s_waitcnt lgkmcnt(0)
    ds_read_b64_tr_b16 v[64:65], v8 offset:32768
    ds_read_b64_tr_b16 v[66:67], v8 offset:33280
    ds_read_b64_tr_b16 v[68:69], v8 offset:36864
    ds_read_b64_tr_b16 v[70:71], v8 offset:37376
    ds_read_b64_tr_b16 v[72:73], v8 offset:40960
    ds_read_b64_tr_b16 v[74:75], v8 offset:41472
    ds_read_b64_tr_b16 v[76:77], v8 offset:45056
    ds_read_b64_tr_b16 v[78:79], v8 offset:45568
    s_waitcnt lgkmcnt(0)
    ds_read_b64_tr_b16 v[80:81], v8 offset:49152
    ds_read_b64_tr_b16 v[82:83], v8 offset:49664
    ds_read_b64_tr_b16 v[84:85], v8 offset:53248
    ds_read_b64_tr_b16 v[86:87], v8 offset:53760
    ds_read_b64_tr_b16 v[88:89], v8 offset:57344
    ds_read_b64_tr_b16 v[90:91], v8 offset:57856
    ds_read_b64_tr_b16 v[92:93], v8 offset:61440
    ds_read_b64_tr_b16 v[94:95], v8 offset:61952
    s_waitcnt lgkmcnt(0)
    s_nop 0
ffn_a:
    s_barrier
    s_add_u32 s28, s27, 0
    s_mov_b32 m0, s28
    s_add_u32 s29, s25, 24576
    buffer_load_dwordx4 v7, s[16:19], s29 offen lds
    s_add_u32 s28, s27, 1024
    s_mov_b32 m0, s28
    s_add_u32 s29, s25, 32768
    buffer_load_dwordx4 v6, s[16:19], s29 offen lds
    s_add_u32 s28, s27, 2048
    s_mov_b32 m0, s28
    s_add_u32 s29, s25, 40960
    buffer_load_dwordx4 v6, s[16:19], s29 offen lds
    s_add_u32 s28, s27, 3072
    s_mov_b32 m0, s28
    s_add_u32 s29, s25, 49152
    buffer_load_dwordx4 v7, s[16:19], s29 offen lds
    s_add_u32 s28, s27, 4096
    s_mov_b32 m0, s28
    s_add_u32 s29, s25, 57344
    buffer_load_dwordx4 v7, s[16:19], s29 offen lds
    s_waitcnt vmcnt(8)
    s_barrier
    s_cmp_lt_u32 s3, 4
    s_cbranch_scc1 ffn_b
    ds_read_b64_tr_b16 v[32:33], v8 offset:0
    ds_read_b64_tr_b16 v[34:35], v8 offset:512
    ds_read_b64_tr_b16 v[36:37], v8 offset:4096
    ds_read_b64_tr_b16 v[38:39], v8 offset:4608
    ds_read_b64_tr_b16 v[40:41], v8 offset:8192
    ds_read_b64_tr_b16 v[42:43], v8 offset:8704
    ds_read_b64_tr_b16 v[44:45], v8 offset:12288
    ds_read_b64_tr_b16 v[46:47], v8 offset:12800
    s_waitcnt lgkmcnt(0)
    ds_read_b64_tr_b16 v[48:49], v8 offset:16384
    ds_read_b64_tr_b16 v[50:51], v8 offset:16896
    ds_read_b64_tr_b16 v[52:53], v8 offset:20480
    ds_read_b64_tr_b16 v[54:55], v8 offset:20992
    ds_read_b64_tr_b16 v[56:57], v8 offset:24576
    ds_read_b64_tr_b16 v[58:59], v8 offset:25088
    ds_read_b64_tr_b16 v[60:61], v8 offset:28672
    ds_read_b64_tr_b16 v[62:63], v8 offset:29184
    s_waitcnt lgkmcnt(0)
    ds_read_b64_tr_b16 v[64:65], v8 offset:32768
    ds_read_b64_tr_b16 v[66:67], v8 offset:33280
    ds_read_b64_tr_b16 v[68:69], v8 offset:36864
    ds_read_b64_tr_b16 v[70:71], v8 offset:37376
    ds_read_b64_tr_b16 v[72:73], v8 offset:40960
    ds_read_b64_tr_b16 v[74:75], v8 offset:41472
    ds_read_b64_tr_b16 v[76:77], v8 offset:45056
    ds_read_b64_tr_b16 v[78:79], v8 offset:45568
    s_waitcnt lgkmcnt(0)
    ds_read_b64_tr_b16 v[80:81], v8 offset:49152
    ds_read_b64_tr_b16 v[82:83], v8 offset:49664
    ds_read_b64_tr_b16 v[84:85], v8 offset:53248
    ds_read_b64_tr_b16 v[86:87], v8 offset:53760
    ds_read_b64_tr_b16 v[88:89], v8 offset:57344
    ds_read_b64_tr_b16 v[90:91], v8 offset:57856
    ds_read_b64_tr_b16 v[92:93], v8 offset:61440
    ds_read_b64_tr_b16 v[94:95], v8 offset:61952
    s_waitcnt lgkmcnt(0)
    s_nop 0
ffn_b:
    s_waitcnt vmcnt(0)
    v_xor_b32 v10, 0, v12
    v_xor_b32 v11, 0, v13
    ds_read_b64_tr_b16 v[96:97], v10
    ds_read_b64_tr_b16 v[98:99], v11
    v_xor_b32 v10, 32, v12
    v_xor_b32 v11, 32, v13
    ds_read_b64_tr_b16 v[100:101], v10
    ds_read_b64_tr_b16 v[102:103], v11
    v_xor_b32 v10, 64, v12
    v_xor_b32 v11, 64, v13
    ds_read_b64_tr_b16 v[104:105], v10
    ds_read_b64_tr_b16 v[106:107], v11
    v_xor_b32 v10, 96, v12
    v_xor_b32 v11, 96, v13
    ds_read_b64_tr_b16 v[108:109], v10
    ds_read_b64_tr_b16 v[110:111], v11
    v_xor_b32 v10, 128, v12
    v_xor_b32 v11, 128, v13
    ds_read_b64_tr_b16 v[112:113], v10
    ds_read_b64_tr_b16 v[114:115], v11
    v_xor_b32 v10, 160, v12
    v_xor_b32 v11, 160, v13
    ds_read_b64_tr_b16 v[116:117], v10
    ds_read_b64_tr_b16 v[118:119], v11
    v_xor_b32 v10, 192, v12
    v_xor_b32 v11, 192, v13
    ds_read_b64_tr_b16 v[120:121], v10
    ds_read_b64_tr_b16 v[122:123], v11
    v_xor_b32 v10, 224, v12
    v_xor_b32 v11, 224, v13
    ds_read_b64_tr_b16 v[124:125], v10
    ds_read_b64_tr_b16 v[126:127], v11
    s_waitcnt lgkmcnt(0)
    s_cmp_lg_u32 s3, 0
    s_cbranch_scc1 ffn_w3
    s_lshl_b32 s28, s20, 4
    s_add_u32 s28, s28, s34
    v_mov_b32 v10, 12
    s_nop 4
ffn_p3:
    buffer_load_dword v11, v10, s[4:7], s28 offen sc1
    s_waitcnt vmcnt(0)
    v_cmp_ne_u32 vcc, s40, v11
    s_cbranch_vccnz ffn_p3_rt
ffn_p3_ok:
    s_mov_b32 s58, 0
    s_nop 2
ffn_k3:
    buffer_load_dwordx4 v[200:203], v29, s[4:7], s34 offen sc1
    buffer_load_dwordx4 v[204:207], v29, s[4:7], s34 offen offset:1024 sc1
    s_waitcnt vmcnt(0)
    v_xor_b32 v208, s40, v203
    v_xor_b32 v209, s40, v207
    v_max_u32 v210, v200, v204
    v_or_b32 v208, v208, v209
    v_cmp_ne_u32 vcc, 0, v208
    s_cbranch_vccnz ffn_k3_rt
ffn_k3_ok:
    v_max_u32_dpp v210, v210, v210 quad_perm:[1,0,3,2] row_mask:0xf bank_mask:0xf
    s_nop 1
    v_max_u32_dpp v210, v210, v210 quad_perm:[2,3,0,1] row_mask:0xf bank_mask:0xf
    s_nop 1
    v_max_u32_dpp v210, v210, v210 row_half_mirror row_mask:0xf bank_mask:0xf
    s_nop 1
    v_max_u32_dpp v210, v210, v210 row_mirror row_mask:0xf bank_mask:0xf
    s_nop 1
    v_max_u32_dpp v210, v210, v210 row_bcast:15 row_mask:0xa bank_mask:0xf
    s_nop 1
    v_max_u32_dpp v210, v210, v210 row_bcast:31 row_mask:0xc bank_mask:0xf
    s_nop 0
    v_readlane_b32 s36, v210, 63
    v_lshlrev_b32 v203, 11, v1
    v_add_u32 v207, 131072, v203
    v_cmp_eq_u32 vcc, s36, v200
    v_cmp_eq_u32 s[28:29], s36, v204
    s_nop 1
    v_cndmask_b32 v201, v201, v205, s[28:29]
    v_cndmask_b32 v202, v202, v206, s[28:29]
    v_cndmask_b32 v203, v203, v207, s[28:29]
    s_or_b64 exec, vcc, s[28:29]
    ds_write_b128 v28, v[200:203]
    s_mov_b64 exec, -1
    s_waitcnt lgkmcnt(0)
    s_nop 0
ffn_w3:
    s_barrier
    ds_read_b128 v[200:203], v28
    s_mov_b32 s58, 0
    s_mov_b32 s28, 0xffff0000
    s_waitcnt lgkmcnt(0)
    v_add_u32 v10, v203, v18
    s_nop 4
ffn_c3:
    buffer_load_dword v11, v10, s[4:7], 0 offen sc1
    s_waitcnt vmcnt(0)
    v_lshlrev_b32 v14, 16, v11
    v_and_b32 v15, s28, v11
    v_cmp_eq_u32 vcc, -1, v11
    s_cbranch_vccnz ffn_c3_rt
ffn_c3_ok:
    v_add_f32 v14, v14, v201
    v_add_f32 v15, v15, v201
    v_cvt_pk_bf16_f32 v14, 0, v14
    v_cvt_pk_bf16_f32 v15, 0, v15
    v_mul_f32 v14, v14, v202
    v_mul_f32 v15, v15, v202
    v_cvt_pk_bf16_f32 v14, v14, v15
    ds_write_b16 v16, v14
    ds_write_b16_d16_hi v17, v14
    s_waitcnt lgkmcnt(0)
    s_barrier
    ds_read_b128 v[128:131], v19 offset:0
    ds_read_b128 v[132:135], v19 offset:64
    ds_read_b128 v[136:139], v19 offset:128
    ds_read_b128 v[140:143], v19 offset:192
    ds_read_b128 v[144:147], v19 offset:256
    ds_read_b128 v[148:151], v19 offset:320
    ds_read_b128 v[152:155], v19 offset:384
    s_waitcnt lgkmcnt(6)
    v_mfma_f32_16x16x32_bf16 v[192:195], v[32:35], v[128:131], 0
    ds_read_b128 v[156:159], v19 offset:448
    s_waitcnt lgkmcnt(6)
    v_mfma_f32_16x16x32_bf16 v[192:195], v[36:39], v[132:135], v[192:195]
    ds_read_b128 v[160:163], v19 offset:512
    s_waitcnt lgkmcnt(6)
    v_mfma_f32_16x16x32_bf16 v[192:195], v[40:43], v[136:139], v[192:195]
    ds_read_b128 v[164:167], v19 offset:576
    s_waitcnt lgkmcnt(6)
    v_mfma_f32_16x16x32_bf16 v[192:195], v[44:47], v[140:143], v[192:195]
    ds_read_b128 v[168:171], v19 offset:640
    s_waitcnt lgkmcnt(6)
    v_mfma_f32_16x16x32_bf16 v[192:195], v[48:51], v[144:147], v[192:195]
    ds_read_b128 v[172:175], v19 offset:704
    s_waitcnt lgkmcnt(6)
    v_mfma_f32_16x16x32_bf16 v[192:195], v[52:55], v[148:151], v[192:195]
    ds_read_b128 v[176:179], v19 offset:768
    s_waitcnt lgkmcnt(6)
    v_mfma_f32_16x16x32_bf16 v[192:195], v[56:59], v[152:155], v[192:195]
    ds_read_b128 v[180:183], v19 offset:832
    s_waitcnt lgkmcnt(6)
    v_mfma_f32_16x16x32_bf16 v[192:195], v[60:63], v[156:159], v[192:195]
    ds_read_b128 v[184:187], v19 offset:896
    s_waitcnt lgkmcnt(6)
    v_mfma_f32_16x16x32_bf16 v[192:195], v[64:67], v[160:163], v[192:195]
    ds_read_b128 v[188:191], v19 offset:960
    s_waitcnt lgkmcnt(6)
    v_mfma_f32_16x16x32_bf16 v[192:195], v[68:71], v[164:167], v[192:195]
    s_waitcnt lgkmcnt(5)
    v_mfma_f32_16x16x32_bf16 v[192:195], v[72:75], v[168:171], v[192:195]
    s_waitcnt lgkmcnt(4)
    v_mfma_f32_16x16x32_bf16 v[192:195], v[76:79], v[172:175], v[192:195]
    s_waitcnt lgkmcnt(3)
    v_mfma_f32_16x16x32_bf16 v[192:195], v[80:83], v[176:179], v[192:195]
    s_waitcnt lgkmcnt(2)
    v_mfma_f32_16x16x32_bf16 v[192:195], v[84:87], v[180:183], v[192:195]
    s_waitcnt lgkmcnt(1)
    v_mfma_f32_16x16x32_bf16 v[192:195], v[88:91], v[184:187], v[192:195]
    s_waitcnt lgkmcnt(0)
    v_mfma_f32_16x16x32_bf16 v[192:195], v[92:95], v[188:191], v[192:195]
    s_mov_b32 exec_lo, 0x00010001
    s_mov_b32 exec_hi, 0x00010001
    s_cmp_eq_u32 s32, s21
    s_cbranch_scc1 ffn_own
    s_nop 3
    v_and_or_b32 v192, v192, v197, s48
    v_and_or_b32 v193, v193, v197, s49
    v_and_or_b32 v194, v194, v197, s50
    v_and_or_b32 v195, v195, v197, s51
    buffer_store_dwordx4 v[192:195], v30, s[4:7], s30 offen sc1
    s_branch ffn_x
    s_nop 2
ffn_own:
    ds_write_b128 v31, v[192:195]
    s_waitcnt lgkmcnt(0)
ffn_x:
    s_mov_b64 exec, -1
    s_barrier
    s_lshl_b32 s28, s21, 1
    s_cmp_lg_u32 s3, s28
    s_cbranch_scc1 ffn_w4
    v_lshlrev_b32 v10, 2, v1
    v_add_u32 v11, 157760, v10
    ds_read_b32 v15, v11
    v_and_b32 v11, 3, v1
    v_lshlrev_b32 v11, 3, v11
    v_mov_b32 v9, s40
    v_lshrrev_b32 v11, v11, v9
    v_and_b32 v11, 0xff, v11
    v_lshrrev_b32 v9, 1, v10
    v_add_u32 v9, 158016, v9
    s_mov_b32 s58, 0
    s_nop 3
ffn_h4:
    buffer_load_dword v14, v10, s[4:7], s31 offen sc1
    s_waitcnt vmcnt(0) lgkmcnt(0)
    v_xor_b32 v14, v11, v14
    v_and_b32 v200, 0xff, v14
    v_add_f32 v14, v14, v15
    v_cmp_ne_u32 vcc, 0, v200
    s_cbranch_vccnz ffn_h4_rt
ffn_h4_ok:
    v_cvt_pk_bf16_f32 v14, 0, v14
    v_mul_f32 v15, 0xbfb8aa3b, v14
    v_mov_b32 v200, v14
    v_exp_f32 v15, v15
    s_nop 0
    v_add_f32 v15, 1.0, v15
    v_permlane32_swap_b32 v200, v201
    v_rcp_f32 v15, v15
    s_nop 0
    v_mul_f32 v14, v14, v15
    v_cvt_pk_bf16_f32 v14, 0, v14
    s_mov_b32 exec_hi, 0
    v_mul_f32 v14, v14, v201
    v_cvt_pk_bf16_f32 v14, 0, v14
    ds_write_b16_d16_hi v9, v14
    s_mov_b64 exec, -1
    s_waitcnt lgkmcnt(0)
    s_nop 1
ffn_w4:
    s_barrier
    ds_read_b128 v[128:131], v20
    ds_read_b128 v[132:135], v21
    ds_read_b128 v[136:139], v22
    ds_read_b128 v[140:143], v23
    ds_read_b128 v[144:147], v24
    ds_read_b128 v[148:151], v25
    ds_read_b128 v[152:155], v26
    ds_read_b128 v[156:159], v27
    s_waitcnt lgkmcnt(7)
    v_mfma_f32_16x16x32_bf16 v[192:195], v[96:99], v[128:131], 0
    s_waitcnt lgkmcnt(6)
    v_mfma_f32_16x16x32_bf16 v[192:195], v[100:103], v[132:135], v[192:195]
    s_waitcnt lgkmcnt(5)
    v_mfma_f32_16x16x32_bf16 v[192:195], v[104:107], v[136:139], v[192:195]
    s_waitcnt lgkmcnt(4)
    v_mfma_f32_16x16x32_bf16 v[192:195], v[108:111], v[140:143], v[192:195]
    s_waitcnt lgkmcnt(3)
    v_mfma_f32_16x16x32_bf16 v[192:195], v[112:115], v[144:147], v[192:195]
    s_waitcnt lgkmcnt(2)
    v_mfma_f32_16x16x32_bf16 v[192:195], v[116:119], v[148:151], v[192:195]
    s_waitcnt lgkmcnt(1)
    v_mfma_f32_16x16x32_bf16 v[192:195], v[120:123], v[152:155], v[192:195]
    s_waitcnt lgkmcnt(0)
    v_mfma_f32_16x16x32_bf16 v[192:195], v[124:127], v[156:159], v[192:195]
    s_mov_b32 exec_lo, 0x00ff00ff
    s_mov_b32 exec_hi, 0x00ff00ff
    s_nop 5
    v_and_or_b32 v192, v192, v197, s48
    v_and_or_b32 v193, v193, v197, s49
    v_and_or_b32 v194, v194, v197, s50
    v_and_or_b32 v195, v195, v197, s51
    buffer_store_dwordx4 v[192:195], v196, s[4:7], s33 offen sc1
    s_endpgm
fz_h1_rt:
    s_add_u32 s58, s58, 1
    s_cmp_lt_u32 s58, 0x10000
    s_cbranch_scc1 fz_h1
    s_branch fz_h1_ok
fz_h2_rt:
    s_add_u32 s58, s58, 1
    s_cmp_lt_u32 s58, 0x10000
    s_cbranch_scc1 fz_h2
    s_branch fz_h2_ok
fz_k2_rt:
    s_add_u32 s58, s58, 1
    s_cmp_lt_u32 s58, 0x10000
    s_cbranch_scc1 fz_k2
    s_branch fz_k2_ok
fz_c2_rt:
    s_add_u32 s58, s58, 1
    s_cmp_lt_u32 s58, 0x10000
    s_cbranch_scc1 fz_c2
    s_branch fz_c2_ok
fz_p5_rt:
    s_add_u32 s58, s58, 1
    s_cmp_lt_u32 s58, 0x10000
    s_cbranch_scc1 fz_p5
    s_branch fz_p5_ok
fz_h5_rt:
    s_add_u32 s58, s58, 1
    s_cmp_lt_u32 s58, 0x10000
    s_cbranch_scc1 fz_h5
    s_branch fz_h5_ok
ffn_p3_rt:
    s_add_u32 s58, s58, 1
    s_cmp_lt_u32 s58, 0x10000
    s_cbranch_scc1 ffn_p3
    s_branch ffn_p3_ok
ffn_k3_rt:
    s_add_u32 s58, s58, 1
    s_cmp_lt_u32 s58, 0x10000
    s_cbranch_scc1 ffn_k3
    s_branch ffn_k3_ok
ffn_c3_rt:
    s_add_u32 s58, s58, 1
    s_cmp_lt_u32 s58, 0x10000
    s_cbranch_scc1 ffn_c3
    s_branch ffn_c3_ok
ffn_h4_rt:
    s_add_u32 s58, s58, 1
    s_cmp_lt_u32 s58, 0x10000
    s_cbranch_scc1 ffn_h4
    s_branch ffn_h4_ok
.section .rodata,"a"
.p2align 6
.amdhsa_kernel fz_kernel
  .amdhsa_next_free_vgpr 256
  .amdhsa_next_free_sgpr 102
  .amdhsa_accum_offset 256
  .amdhsa_group_segment_fixed_size 0
  .amdhsa_kernarg_size 104
  .amdhsa_user_sgpr_count 2
  .amdhsa_user_sgpr_kernarg_segment_ptr 1
  .amdhsa_system_sgpr_workgroup_id_x 1
.end_amdhsa_kernel
```

```asm
; @launch kernel=fz_kernel grid=(256,1,1) block=(512,1,1) lds=163840
.amdgcn_target "amdgcn-amd-amdhsa--gfx950"
.text
.globl fz_kernel
.p2align 8
.type fz_kernel,@function
fz_kernel:
    s_load_dwordx2 s[4:5], s[0:1], 96
    s_load_dwordx2 s[8:9], s[0:1], 0
    s_cmp_gt_u32 s2, 255
    s_cbranch_scc1 fz_end
    v_lshrrev_b32 v2, 6, v0
    v_and_b32 v1, 63, v0
    s_lshr_b32 s59, s2, 7
    v_readfirstlane_b32 s3, v2
    s_cmp_lg_u32 s59, 0
    s_cbranch_scc1 fz_ldh
    s_load_dwordx2 s[12:13], s[0:1], 80
    s_load_dwordx2 s[16:17], s[0:1], 48
    s_load_dwordx2 s[64:65], s[0:1], 72
fz_ldback:
    s_add_u32 s20, s2, 124
    s_and_b32 s20, s20, 127
    s_lshr_b32 s21, s20, 3
    s_add_u32 s21, s21, 1
    s_and_b32 s22, s20, 7
    s_sub_u32 s23, s20, 124
    s_cmp_ge_u32 s20, 124
    s_cselect_b32 s21, 0, s21
    s_cselect_b32 s22, s23, s22
    s_lshr_b32 s57, s3, 2
    s_or_b32 s23, s57, s59
    s_and_b32 s24, s3, 3
    s_lshl_b32 s25, s22, 6
    s_add_u32 s25, s25, s21
    s_lshl_b32 s26, s23, 5
    s_add_u32 s26, s26, s25
    s_lshl_b32 s27, s24, 9
    s_add_u32 s28, s26, s27
    s_sub_u32 s27, 2048, s27
    s_sub_u32 s27, s27, s26
    s_lshl_b32 s29, s24, 1
    s_add_u32 s29, s29, s23
    s_sub_u32 s30, 15, s29
    s_cmp_lt_u32 s24, 2
    s_cselect_b32 s27, s28, s27
    s_cselect_b32 s31, s29, s30
    s_cselect_b32 s30, s30, s29
    s_sub_u32 s28, 2048, s27
    s_and_b32 s28, s28, 2047
    s_lshl_b32 s27, s27, 11
    s_lshl_b32 s28, s28, 11
    s_mul_i32 s31, s31, 2064
    s_mul_i32 s30, s30, 2064
    v_lshlrev_b32 v239, 4, v1
    s_mov_b32 s10, 0x400000
    s_mov_b32 s11, 0x00020000
    s_mov_b32 s6, 0x510000
    s_mov_b32 s7, 0x00020000
    s_and_b32 s32, s57, s59
    s_mov_b32 s58, 0
    s_waitcnt lgkmcnt(0)
    s_cmp_eq_u32 s2, 0
    s_cbranch_scc1 fz_spec
fz_specback:
    s_cmp_lg_u32 s57, 0
    s_cbranch_scc1 fz_nox
    s_mov_b32 m0, s31
    s_nop 0
    buffer_load_dwordx4 v239, s[8:11], s27 offen lds
    buffer_load_dwordx4 v239, s[8:11], s27 offen offset:1024 lds
    s_mov_b32 m0, s30
    s_nop 0
    buffer_load_dwordx4 v239, s[8:11], s28 offen lds
    buffer_load_dwordx4 v239, s[8:11], s28 offen offset:1024 lds
fz_nox:
    s_load_dword s40, s[4:5], 0
    v_and_b32 v2, 31, v1
    v_lshrrev_b32 v3, 5, v1
    v_and_b32 v4, 15, v1
    v_lshrrev_b32 v5, 4, v1
    v_add_u32 v6, 49536, v239
    s_cmp_eq_u32 s3, 1
    s_cbranch_scc1 fz_j1
    s_cmp_eq_u32 s3, 2
    s_cbranch_scc1 fz_j2
    s_cmp_eq_u32 s3, 3
    s_cbranch_scc1 fz_j3
    s_cmp_eq_u32 s3, 4
    s_cbranch_scc1 fz_j4
    s_cmp_eq_u32 s3, 5
    s_cbranch_scc1 fz_j5
    s_cmp_eq_u32 s3, 6
    s_cbranch_scc1 fz_j6
    s_cmp_eq_u32 s3, 7
    s_cbranch_scc1 fz_j7
    v_lshrrev_b32 v10, 1, v2
    v_and_b32 v8, 9, v10
    v_and_b32 v11, 2, v10
    v_lshl_or_b32 v8, v11, 1, v8
    v_bfe_u32 v11, v10, 2, 1
    v_lshl_or_b32 v8, v11, 1, v8
    v_and_b32 v9, 1, v2
    v_cmp_eq_u32 vcc, 1, v2
    s_nop 1
    v_cndmask_b32_e64 v8, v8, 16, vcc
    v_cndmask_b32_e64 v9, v9, 0, vcc
    v_cvt_f32_u32 v8, v8
    v_cvt_f32_u32 v9, v9
    v_cvt_f32_u32 v10, v3
    v_mul_f32 v8, 0x3d000000, v8
    v_mul_f32 v9, 0x3e800000, v9
    v_mul_f32 v10, 0x41000000, v10
    v_fma_f32 v9, v8, v10, v9
    v_mov_b32 v104, v9
    v_fmamk_f32 v105, v8, 0x3f800000, v9
    v_fmamk_f32 v106, v8, 0x40000000, v9
    v_fmamk_f32 v107, v8, 0x40400000, v9
    v_fmamk_f32 v108, v8, 0x40800000, v9
    v_fmamk_f32 v109, v8, 0x40a00000, v9
    v_fmamk_f32 v110, v8, 0x40c00000, v9
    v_fmamk_f32 v111, v8, 0x40e00000, v9
    v_fmamk_f32 v112, v8, 0x41800000, v9
    v_fmamk_f32 v113, v8, 0x41880000, v9
    v_fmamk_f32 v114, v8, 0x41900000, v9
    v_fmamk_f32 v115, v8, 0x41980000, v9
    v_fmamk_f32 v116, v8, 0x41a00000, v9
    v_fmamk_f32 v117, v8, 0x41a80000, v9
    v_fmamk_f32 v118, v8, 0x41b00000, v9
    v_fmamk_f32 v119, v8, 0x41b80000, v9
    v_cos_f32 v104, v104
    v_cos_f32 v105, v105
    v_cos_f32 v106, v106
    v_cos_f32 v107, v107
    v_cos_f32 v108, v108
    v_cos_f32 v109, v109
    v_cos_f32 v110, v110
    v_cos_f32 v111, v111
    v_cos_f32 v112, v112
    v_cos_f32 v113, v113
    v_cos_f32 v114, v114
    v_cos_f32 v115, v115
    v_cos_f32 v116, v116
    v_cos_f32 v117, v117
    v_cos_f32 v118, v118
    v_cos_f32 v119, v119
    v_cvt_pk_bf16_f32 v16, v104, v105
    v_cvt_pk_bf16_f32 v17, v106, v107
    v_cvt_pk_bf16_f32 v18, v108, v109
    v_cvt_pk_bf16_f32 v19, v110, v111
    v_cvt_pk_bf16_f32 v20, v112, v113
    v_cvt_pk_bf16_f32 v21, v114, v115
    v_cvt_pk_bf16_f32 v22, v116, v117
    v_cvt_pk_bf16_f32 v23, v118, v119
    ds_write_b128 v6, v[16:19] offset:0
    ds_write_b128 v6, v[20:23] offset:1024
    s_branch fz_jend
    s_nop 1
fz_j1:
    v_lshrrev_b32 v10, 1, v2
    v_and_b32 v8, 9, v10
    v_and_b32 v11, 2, v10
    v_lshl_or_b32 v8, v11, 1, v8
    v_bfe_u32 v11, v10, 2, 1
    v_lshl_or_b32 v8, v11, 1, v8
    v_cvt_f32_u32 v8, v8
    v_mul_f32 v8, 0x3a800000, v8
    v_cvt_f32_u32 v9, v3
    v_mul_f32 v9, 4.0, v9
    v_mul_f32 v9, v8, v9
    v_cmp_eq_u32 vcc, 1, v2
    v_mov_b32 v10, 0x3e800000
    s_nop 0
    v_cndmask_b32_e64 v9, v9, v10, vcc
    v_mov_b32 v104, v9
    v_fmamk_f32 v105, v8, 0x3f800000, v9
    v_fmamk_f32 v106, v8, 0x40000000, v9
    v_fmamk_f32 v107, v8, 0x40400000, v9
    v_fmamk_f32 v108, v8, 0x41000000, v9
    v_fmamk_f32 v109, v8, 0x41100000, v9
    v_fmamk_f32 v110, v8, 0x41200000, v9
    v_fmamk_f32 v111, v8, 0x41300000, v9
    v_fmamk_f32 v112, v8, 0x41800000, v9
    v_fmamk_f32 v113, v8, 0x41880000, v9
    v_fmamk_f32 v114, v8, 0x41900000, v9
    v_fmamk_f32 v115, v8, 0x41980000, v9
    v_fmamk_f32 v116, v8, 0x41c00000, v9
    v_fmamk_f32 v117, v8, 0x41c80000, v9
    v_fmamk_f32 v118, v8, 0x41d00000, v9
    v_fmamk_f32 v119, v8, 0x41d80000, v9
    v_cos_f32 v104, v104
    v_cos_f32 v105, v105
    v_cos_f32 v106, v106
    v_cos_f32 v107, v107
    v_cos_f32 v108, v108
    v_cos_f32 v109, v109
    v_cos_f32 v110, v110
    v_cos_f32 v111, v111
    v_cos_f32 v112, v112
    v_cos_f32 v113, v113
    v_cos_f32 v114, v114
    v_cos_f32 v115, v115
    v_cos_f32 v116, v116
    v_cos_f32 v117, v117
    v_cos_f32 v118, v118
    v_cos_f32 v119, v119
    v_cvt_pk_f16_f32 v24, v104, v105
    v_cvt_pk_f16_f32 v25, v106, v107
    v_cvt_pk_f16_f32 v26, v108, v109
    v_cvt_pk_f16_f32 v27, v110, v111
    v_cvt_pk_f16_f32 v28, v112, v113
    v_cvt_pk_f16_f32 v29, v114, v115
    v_cvt_pk_f16_f32 v30, v116, v117
    v_cvt_pk_f16_f32 v31, v118, v119
    ds_write_b128 v6, v[24:27] offset:2048
    ds_write_b128 v6, v[28:31] offset:3072
    s_branch fz_jend
    s_nop 1
fz_j2:
    v_lshrrev_b32 v10, 1, v2
    v_and_b32 v8, 9, v10
    v_and_b32 v11, 2, v10
    v_lshl_or_b32 v8, v11, 1, v8
    v_bfe_u32 v11, v10, 2, 1
    v_lshl_or_b32 v8, v11, 1, v8
    v_cvt_f32_u32 v8, v8
    v_mul_f32 v8, 0x3a800000, v8
    v_lshlrev_b32 v9, 31, v2
    v_xor_b32 v8, v9, v8
    v_cvt_f32_u32 v9, v3
    v_mul_f32 v9, 4.0, v9
    v_mul_f32 v9, v8, v9
    v_mov_b32 v104, v9
    v_fmamk_f32 v105, v8, 0x3f800000, v9
    v_fmamk_f32 v106, v8, 0x40000000, v9
    v_fmamk_f32 v107, v8, 0x40400000, v9
    v_fmamk_f32 v108, v8, 0x41000000, v9
    v_fmamk_f32 v109, v8, 0x41100000, v9
    v_fmamk_f32 v110, v8, 0x41200000, v9
    v_fmamk_f32 v111, v8, 0x41300000, v9
    v_fmamk_f32 v112, v8, 0x41800000, v9
    v_fmamk_f32 v113, v8, 0x41880000, v9
    v_fmamk_f32 v114, v8, 0x41900000, v9
    v_fmamk_f32 v115, v8, 0x41980000, v9
    v_fmamk_f32 v116, v8, 0x41c00000, v9
    v_fmamk_f32 v117, v8, 0x41c80000, v9
    v_fmamk_f32 v118, v8, 0x41d00000, v9
    v_fmamk_f32 v119, v8, 0x41d80000, v9
    v_sin_f32 v104, v104
    v_sin_f32 v105, v105
    v_sin_f32 v106, v106
    v_sin_f32 v107, v107
    v_sin_f32 v108, v108
    v_sin_f32 v109, v109
    v_sin_f32 v110, v110
    v_sin_f32 v111, v111
    v_sin_f32 v112, v112
    v_sin_f32 v113, v113
    v_sin_f32 v114, v114
    v_sin_f32 v115, v115
    v_sin_f32 v116, v116
    v_sin_f32 v117, v117
    v_sin_f32 v118, v118
    v_sin_f32 v119, v119
    v_cvt_pk_f16_f32 v32, v104, v105
    v_cvt_pk_f16_f32 v33, v106, v107
    v_cvt_pk_f16_f32 v34, v108, v109
    v_cvt_pk_f16_f32 v35, v110, v111
    v_cvt_pk_f16_f32 v36, v112, v113
    v_cvt_pk_f16_f32 v37, v114, v115
    v_cvt_pk_f16_f32 v38, v116, v117
    v_cvt_pk_f16_f32 v39, v118, v119
    ds_write_b128 v6, v[32:35] offset:4096
    ds_write_b128 v6, v[36:39] offset:5120
    s_branch fz_jend
    s_nop 1
fz_j3:
    v_cvt_f32_u32 v8, v2
    v_mul_f32 v8, 0x3d000000, v8
    v_cvt_f32_u32 v9, v3
    v_mul_f32 v9, 4.0, v9
    v_mul_f32 v9, v8, v9
    v_mov_b32 v104, v9
    v_fmamk_f32 v105, v8, 0x3f800000, v9
    v_fmamk_f32 v106, v8, 0x40000000, v9
    v_fmamk_f32 v107, v8, 0x40400000, v9
    v_fmamk_f32 v108, v8, 0x41000000, v9
    v_fmamk_f32 v109, v8, 0x41100000, v9
    v_fmamk_f32 v110, v8, 0x41200000, v9
    v_fmamk_f32 v111, v8, 0x41300000, v9
    v_fmamk_f32 v112, v8, 0x41800000, v9
    v_fmamk_f32 v113, v8, 0x41880000, v9
    v_fmamk_f32 v114, v8, 0x41900000, v9
    v_fmamk_f32 v115, v8, 0x41980000, v9
    v_fmamk_f32 v116, v8, 0x41c00000, v9
    v_fmamk_f32 v117, v8, 0x41c80000, v9
    v_fmamk_f32 v118, v8, 0x41d00000, v9
    v_fmamk_f32 v119, v8, 0x41d80000, v9
    v_cos_f32 v104, v104
    v_cos_f32 v105, v105
    v_cos_f32 v106, v106
    v_cos_f32 v107, v107
    v_cos_f32 v108, v108
    v_cos_f32 v109, v109
    v_cos_f32 v110, v110
    v_cos_f32 v111, v111
    v_cos_f32 v112, v112
    v_cos_f32 v113, v113
    v_cos_f32 v114, v114
    v_cos_f32 v115, v115
    v_cos_f32 v116, v116
    v_cos_f32 v117, v117
    v_cos_f32 v118, v118
    v_cos_f32 v119, v119
    v_cvt_pk_f16_f32 v40, v104, v105
    v_cvt_pk_f16_f32 v41, v106, v107
    v_cvt_pk_f16_f32 v42, v108, v109
    v_cvt_pk_f16_f32 v43, v110, v111
    v_cvt_pk_f16_f32 v44, v112, v113
    v_cvt_pk_f16_f32 v45, v114, v115
    v_cvt_pk_f16_f32 v46, v116, v117
    v_cvt_pk_f16_f32 v47, v118, v119
    ds_write_b128 v6, v[40:43] offset:6144
    ds_write_b128 v6, v[44:47] offset:7168
    s_branch fz_jend
    s_nop 1
fz_j4:
    v_cvt_f32_u32 v8, v2
    v_mul_f32 v8, 0x3d000000, v8
    v_cvt_f32_u32 v9, v3
    v_mul_f32 v9, 4.0, v9
    v_mul_f32 v9, v8, v9
    v_mov_b32 v104, v9
    v_fmamk_f32 v105, v8, 0x3f800000, v9
    v_fmamk_f32 v106, v8, 0x40000000, v9
    v_fmamk_f32 v107, v8, 0x40400000, v9
    v_fmamk_f32 v108, v8, 0x41000000, v9
    v_fmamk_f32 v109, v8, 0x41100000, v9
    v_fmamk_f32 v110, v8, 0x41200000, v9
    v_fmamk_f32 v111, v8, 0x41300000, v9
    v_fmamk_f32 v112, v8, 0x41800000, v9
    v_fmamk_f32 v113, v8, 0x41880000, v9
    v_fmamk_f32 v114, v8, 0x41900000, v9
    v_fmamk_f32 v115, v8, 0x41980000, v9
    v_fmamk_f32 v116, v8, 0x41c00000, v9
    v_fmamk_f32 v117, v8, 0x41c80000, v9
    v_fmamk_f32 v118, v8, 0x41d00000, v9
    v_fmamk_f32 v119, v8, 0x41d80000, v9
    v_sin_f32 v104, v104
    v_sin_f32 v105, v105
    v_sin_f32 v106, v106
    v_sin_f32 v107, v107
    v_sin_f32 v108, v108
    v_sin_f32 v109, v109
    v_sin_f32 v110, v110
    v_sin_f32 v111, v111
    v_sin_f32 v112, v112
    v_sin_f32 v113, v113
    v_sin_f32 v114, v114
    v_sin_f32 v115, v115
    v_sin_f32 v116, v116
    v_sin_f32 v117, v117
    v_sin_f32 v118, v118
    v_sin_f32 v119, v119
    v_cvt_pk_f16_f32 v48, v104, v105
    v_cvt_pk_f16_f32 v49, v106, v107
    v_cvt_pk_f16_f32 v50, v108, v109
    v_cvt_pk_f16_f32 v51, v110, v111
    v_cvt_pk_f16_f32 v52, v112, v113
    v_cvt_pk_f16_f32 v53, v114, v115
    v_cvt_pk_f16_f32 v54, v116, v117
    v_cvt_pk_f16_f32 v55, v118, v119
    ds_write_b128 v6, v[48:51] offset:8192
    ds_write_b128 v6, v[52:55] offset:9216
    s_branch fz_jend
    s_nop 1
fz_j5:
    v_lshl_add_u32 v8, v4, 1, 1
    v_cvt_f32_u32 v8, v8
    v_mul_f32 v8, 0x3c800000, v8
    v_cvt_f32_u32 v9, v3
    v_mul_f32 v9, 4.0, v9
    v_mul_f32 v9, v8, v9
    v_and_b32 v10, 1, v5
    v_cmp_eq_u32 vcc, 1, v10
    v_mov_b32 v10, 0x3e800000
    s_nop 0
    v_cndmask_b32_e64 v8, v8, 0, vcc
    v_cndmask_b32_e64 v9, v9, v10, vcc
    v_mov_b32 v104, v9
    v_fmamk_f32 v105, v8, 0x3f800000, v9
    v_fmamk_f32 v106, v8, 0x40000000, v9
    v_fmamk_f32 v107, v8, 0x40400000, v9
    v_fmamk_f32 v108, v8, 0x41000000, v9
    v_fmamk_f32 v109, v8, 0x41100000, v9
    v_fmamk_f32 v110, v8, 0x41200000, v9
    v_fmamk_f32 v111, v8, 0x41300000, v9
    v_fmamk_f32 v112, v8, 0x41800000, v9
    v_fmamk_f32 v113, v8, 0x41880000, v9
    v_fmamk_f32 v114, v8, 0x41900000, v9
    v_fmamk_f32 v115, v8, 0x41980000, v9
    v_fmamk_f32 v116, v8, 0x41c00000, v9
    v_fmamk_f32 v117, v8, 0x41c80000, v9
    v_fmamk_f32 v118, v8, 0x41d00000, v9
    v_fmamk_f32 v119, v8, 0x41d80000, v9
    v_cos_f32 v104, v104
    v_cos_f32 v105, v105
    v_cos_f32 v106, v106
    v_cos_f32 v107, v107
    v_cos_f32 v108, v108
    v_cos_f32 v109, v109
    v_cos_f32 v110, v110
    v_cos_f32 v111, v111
    v_cos_f32 v112, v112
    v_cos_f32 v113, v113
    v_cos_f32 v114, v114
    v_cos_f32 v115, v115
    v_cos_f32 v116, v116
    v_cos_f32 v117, v117
    v_cos_f32 v118, v118
    v_cos_f32 v119, v119
    v_cvt_pk_f16_f32 v56, v104, v105
    v_cvt_pk_f16_f32 v57, v106, v107
    v_cvt_pk_f16_f32 v58, v108, v109
    v_cvt_pk_f16_f32 v59, v110, v111
    v_cvt_pk_f16_f32 v60, v112, v113
    v_cvt_pk_f16_f32 v61, v114, v115
    v_cvt_pk_f16_f32 v62, v116, v117
    v_cvt_pk_f16_f32 v63, v118, v119
    ds_write_b128 v6, v[56:59] offset:10240
    ds_write_b128 v6, v[60:63] offset:11264
    v_and_b32 v8, 3, v4
    v_lshrrev_b32 v9, 2, v4
    v_lshl_add_u32 v8, v8, 3, v9
    v_add_u32 v8, 4, v8
    v_cvt_f32_u32 v8, v8
    v_mul_f32 v8, 0x3d000000, v8
    v_cvt_f32_u32 v9, v5
    v_mul_f32 v9, 4.0, v9
    v_mul_f32 v9, v8, v9
    v_mov_b32 v104, v9
    v_fmamk_f32 v105, v8, 0x3f800000, v9
    v_fmamk_f32 v106, v8, 0x40000000, v9
    v_fmamk_f32 v107, v8, 0x40400000, v9
    v_fmamk_f32 v108, v8, 0x41800000, v9
    v_fmamk_f32 v109, v8, 0x41880000, v9
    v_fmamk_f32 v110, v8, 0x41900000, v9
    v_fmamk_f32 v111, v8, 0x41980000, v9
    v_cos_f32 v104, v104
    v_cos_f32 v105, v105
    v_cos_f32 v106, v106
    v_cos_f32 v107, v107
    v_cos_f32 v108, v108
    v_cos_f32 v109, v109
    v_cos_f32 v110, v110
    v_cos_f32 v111, v111
    v_mul_f32 v104, 0x3d800000, v104
    v_mul_f32 v105, 0x3d800000, v105
    v_mul_f32 v106, 0x3d800000, v106
    v_mul_f32 v107, 0x3d800000, v107
    v_mul_f32 v108, 0x3d800000, v108
    v_mul_f32 v109, 0x3d800000, v109
    v_mul_f32 v110, 0x3d800000, v110
    v_mul_f32 v111, 0x3d800000, v111
    v_cvt_pk_f16_f32 v80, v104, v105
    v_cvt_pk_f16_f32 v81, v106, v107
    v_cvt_pk_f16_f32 v82, v108, v109
    v_cvt_pk_f16_f32 v83, v110, v111
    ds_write_b128 v6, v[80:83] offset:16384
    s_branch fz_jend
    s_nop 2
fz_j6:
    v_lshl_add_u32 v8, v4, 1, 1
    v_cvt_f32_u32 v8, v8
    v_mul_f32 v8, 0x3c800000, v8
    v_cvt_f32_u32 v9, v3
    v_mul_f32 v9, 4.0, v9
    v_mul_f32 v9, v8, v9
    v_add_f32 v9, 0x3e800000, v9
    v_and_b32 v10, 1, v5
    v_cmp_eq_u32 vcc, 1, v10
    v_mov_b32 v10, 0x3e800000
    s_nop 0
    v_cndmask_b32_e64 v8, v8, 0, vcc
    v_cndmask_b32_e64 v9, v9, v10, vcc
    v_mov_b32 v104, v9
    v_fmamk_f32 v105, v8, 0x3f800000, v9
    v_fmamk_f32 v106, v8, 0x40000000, v9
    v_fmamk_f32 v107, v8, 0x40400000, v9
    v_fmamk_f32 v108, v8, 0x41000000, v9
    v_fmamk_f32 v109, v8, 0x41100000, v9
    v_fmamk_f32 v110, v8, 0x41200000, v9
    v_fmamk_f32 v111, v8, 0x41300000, v9
    v_fmamk_f32 v112, v8, 0x41800000, v9
    v_fmamk_f32 v113, v8, 0x41880000, v9
    v_fmamk_f32 v114, v8, 0x41900000, v9
    v_fmamk_f32 v115, v8, 0x41980000, v9
    v_fmamk_f32 v116, v8, 0x41c00000, v9
    v_fmamk_f32 v117, v8, 0x41c80000, v9
    v_fmamk_f32 v118, v8, 0x41d00000, v9
    v_fmamk_f32 v119, v8, 0x41d80000, v9
    v_cos_f32 v104, v104
    v_cos_f32 v105, v105
    v_cos_f32 v106, v106
    v_cos_f32 v107, v107
    v_cos_f32 v108, v108
    v_cos_f32 v109, v109
    v_cos_f32 v110, v110
    v_cos_f32 v111, v111
    v_cos_f32 v112, v112
    v_cos_f32 v113, v113
    v_cos_f32 v114, v114
    v_cos_f32 v115, v115
    v_cos_f32 v116, v116
    v_cos_f32 v117, v117
    v_cos_f32 v118, v118
    v_cos_f32 v119, v119
    v_cvt_pk_f16_f32 v64, v104, v105
    v_cvt_pk_f16_f32 v65, v106, v107
    v_cvt_pk_f16_f32 v66, v108, v109
    v_cvt_pk_f16_f32 v67, v110, v111
    v_cvt_pk_f16_f32 v68, v112, v113
    v_cvt_pk_f16_f32 v69, v114, v115
    v_cvt_pk_f16_f32 v70, v116, v117
    v_cvt_pk_f16_f32 v71, v118, v119
    ds_write_b128 v6, v[64:67] offset:12288
    ds_write_b128 v6, v[68:71] offset:13312
    v_and_b32 v8, 3, v4
    v_lshrrev_b32 v9, 2, v4
    v_lshl_add_u32 v8, v8, 3, v9
    v_add_u32 v8, 4, v8
    v_cvt_f32_u32 v8, v8
    v_mul_f32 v8, 0x3d000000, v8
    v_cvt_f32_u32 v9, v5
    v_mul_f32 v9, 4.0, v9
    v_mul_f32 v9, v8, v9
    v_mov_b32 v104, v9
    v_fmamk_f32 v105, v8, 0x3f800000, v9
    v_fmamk_f32 v106, v8, 0x40000000, v9
    v_fmamk_f32 v107, v8, 0x40400000, v9
    v_fmamk_f32 v108, v8, 0x41800000, v9
    v_fmamk_f32 v109, v8, 0x41880000, v9
    v_fmamk_f32 v110, v8, 0x41900000, v9
    v_fmamk_f32 v111, v8, 0x41980000, v9
    v_sin_f32 v104, v104
    v_sin_f32 v105, v105
    v_sin_f32 v106, v106
    v_sin_f32 v107, v107
    v_sin_f32 v108, v108
    v_sin_f32 v109, v109
    v_sin_f32 v110, v110
    v_sin_f32 v111, v111
    v_mul_f32 v104, 0x3d800000, v104
    v_mul_f32 v105, 0x3d800000, v105
    v_mul_f32 v106, 0x3d800000, v106
    v_mul_f32 v107, 0x3d800000, v107
    v_mul_f32 v108, 0x3d800000, v108
    v_mul_f32 v109, 0x3d800000, v109
    v_mul_f32 v110, 0x3d800000, v110
    v_mul_f32 v111, 0x3d800000, v111
    v_cvt_pk_f16_f32 v84, v104, v105
    v_cvt_pk_f16_f32 v85, v106, v107
    v_cvt_pk_f16_f32 v86, v108, v109
    v_cvt_pk_f16_f32 v87, v110, v111
    ds_write_b128 v6, v[84:87] offset:17408
    s_branch fz_jend
    s_nop 2
fz_j7:
    v_and_b32 v8, 3, v4
    v_lshrrev_b32 v9, 2, v4
    v_lshl_add_u32 v8, v8, 3, v9
    v_add_u32 v8, 0, v8
    v_cvt_f32_u32 v8, v8
    v_mul_f32 v8, 0x3d000000, v8
    v_cvt_f32_u32 v9, v5
    v_mul_f32 v9, 4.0, v9
    v_mul_f32 v9, v8, v9
    v_mov_b32 v104, v9
    v_fmamk_f32 v105, v8, 0x3f800000, v9
    v_fmamk_f32 v106, v8, 0x40000000, v9
    v_fmamk_f32 v107, v8, 0x40400000, v9
    v_fmamk_f32 v108, v8, 0x41800000, v9
    v_fmamk_f32 v109, v8, 0x41880000, v9
    v_fmamk_f32 v110, v8, 0x41900000, v9
    v_fmamk_f32 v111, v8, 0x41980000, v9
    v_cos_f32 v104, v104
    v_cos_f32 v105, v105
    v_cos_f32 v106, v106
    v_cos_f32 v107, v107
    v_cos_f32 v108, v108
    v_cos_f32 v109, v109
    v_cos_f32 v110, v110
    v_cos_f32 v111, v111
    v_mul_f32 v104, 0x3d800000, v104
    v_mul_f32 v105, 0x3d800000, v105
    v_mul_f32 v106, 0x3d800000, v106
    v_mul_f32 v107, 0x3d800000, v107
    v_mul_f32 v108, 0x3d800000, v108
    v_mul_f32 v109, 0x3d800000, v109
    v_mul_f32 v110, 0x3d800000, v110
    v_mul_f32 v111, 0x3d800000, v111
    v_cvt_pk_f16_f32 v72, v104, v105
    v_cvt_pk_f16_f32 v73, v106, v107
    v_cvt_pk_f16_f32 v74, v108, v109
    v_cvt_pk_f16_f32 v75, v110, v111
    ds_write_b128 v6, v[72:75] offset:14336
    v_mov_b32 v104, v9
    v_fmamk_f32 v105, v8, 0x3f800000, v9
    v_fmamk_f32 v106, v8, 0x40000000, v9
    v_fmamk_f32 v107, v8, 0x40400000, v9
    v_fmamk_f32 v108, v8, 0x41800000, v9
    v_fmamk_f32 v109, v8, 0x41880000, v9
    v_fmamk_f32 v110, v8, 0x41900000, v9
    v_fmamk_f32 v111, v8, 0x41980000, v9
    v_sin_f32 v104, v104
    v_sin_f32 v105, v105
    v_sin_f32 v106, v106
    v_sin_f32 v107, v107
    v_sin_f32 v108, v108
    v_sin_f32 v109, v109
    v_sin_f32 v110, v110
    v_sin_f32 v111, v111
    v_mul_f32 v104, 0x3d800000, v104
    v_mul_f32 v105, 0x3d800000, v105
    v_mul_f32 v106, 0x3d800000, v106
    v_mul_f32 v107, 0x3d800000, v107
    v_mul_f32 v108, 0x3d800000, v108
    v_mul_f32 v109, 0x3d800000, v109
    v_mul_f32 v110, 0x3d800000, v110
    v_mul_f32 v111, 0x3d800000, v111
    v_cvt_pk_f16_f32 v76, v104, v105
    v_cvt_pk_f16_f32 v77, v106, v107
    v_cvt_pk_f16_f32 v78, v108, v109
    v_cvt_pk_f16_f32 v79, v110, v111
    ds_write_b128 v6, v[76:79] offset:15360
    s_nop 3
fz_jend:
    v_lshlrev_b32 v7, 9, v3
    v_bfe_u32 v10, v1, 2, 2
    v_lshl_add_u32 v7, v10, 6, v7
    v_and_b32 v10, 1, v5
    v_lshl_add_u32 v7, v10, 5, v7
    v_and_b32 v10, 3, v1
    v_lshl_add_u32 v7, v10, 3, v7
    v_add_u32 v7, s31, v7
    v_lshlrev_b32 v8, 9, v3
    v_lshl_add_u32 v8, v2, 1, v8
    v_sub_u32 v9, 2048, v8
    v_and_b32 v9, 2047, v9
    v_add_u32 v9, s30, v9
    s_add_u32 s32, s30, 576
    v_sub_u32 v8, s32, v8
    s_waitcnt lgkmcnt(0)
    s_barrier
    s_cmp_lg_u32 s57, 0
    s_cbranch_scc1 fz_nc0
    ds_read_b128 v[16:19], v6 offset:0
    ds_read_b128 v[20:23], v6 offset:1024
    ds_read_b128 v[24:27], v6 offset:2048
    ds_read_b128 v[28:31], v6 offset:3072
    ds_read_b128 v[32:35], v6 offset:4096
    ds_read_b128 v[36:39], v6 offset:5120
    ds_read_b128 v[40:43], v6 offset:6144
    ds_read_b128 v[44:47], v6 offset:7168
    ds_read_b128 v[48:51], v6 offset:8192
    ds_read_b128 v[52:55], v6 offset:9216
    ds_read_b128 v[56:59], v6 offset:10240
    ds_read_b128 v[60:63], v6 offset:11264
    ds_read_b128 v[64:67], v6 offset:12288
    ds_read_b128 v[68:71], v6 offset:13312
fz_nc0:
    v_cmp_eq_u32 vcc, 0, v2
    s_nop 1
    v_cndmask_b32_e64 v234, 0, -2.0, vcc
    v_mov_b32 v235, 0x3b27c5ac
    v_mov_b32 v242, 0xffff0000
    v_lshlrev_b32 v240, 31, v1
    v_lshrrev_b32 v10, 16, v240
    v_or_b32 v240, v240, v10
    v_mov_b32 v229, 0xfffcfffc
    s_lshr_b32 s32, s24, 1
    s_lshl_b32 s32, s32, 6
    s_mul_i32 s33, s3, 2304
    s_add_u32 s32, s32, s33
    s_add_u32 s32, s32, 67968
    v_lshl_add_u32 v10, v3, 1, v1
    v_lshlrev_b32 v10, 4, v10
    v_add_u32 v216, s32, v10
    v_bfe_u32 v10, v0, 2, 1
    v_mul_u32_u24 v10, 34, v10
    v_lshrrev_b32 v11, 4, v0
    v_add_u32 v10, v10, v11
    v_lshlrev_b32 v10, 4, v10
    v_bfe_u32 v11, v0, 3, 1
    v_lshl_add_u32 v10, v11, 3, v10
    v_bfe_u32 v11, v0, 1, 1
    v_lshl_add_u32 v10, v11, 2, v10
    v_and_b32 v12, 1, v0
    s_mov_b32 s33, 9216
    s_cmp_eq_u32 s2, 0
    s_cselect_b32 s32, s33, 0x1b40
    v_mul_lo_u32 v11, v12, s32
    v_add_u32 v217, v10, v11
    v_add_u32 v217, 67968, v217
    s_cselect_b32 s32, s33, 0x940
    v_mul_lo_u32 v11, v12, s32
    v_add_u32 v218, v10, v11
    v_add_u32 v218, 70272, v218
    s_cselect_b32 s32, s33, 0xfffff6c0
    v_mul_lo_u32 v11, v12, s32
    v_add_u32 v219, v10, v11
    v_add_u32 v219, 73792, v219
    s_cselect_b32 s32, s33, 0xffffe4c0
    v_mul_lo_u32 v11, v12, s32
    v_add_u32 v220, v10, v11
    v_add_u32 v220, 76096, v220
    v_lshrrev_b32 v10, 2, v0
    v_and_b32 v11, 3, v0
    v_lshlrev_b32 v11, 4, v11
    v_lshl_add_u32 v221, v10, 7, v11
    s_mul_i32 s52, s20, 16512
    s_lshl_b32 s33, s59, 6
    s_add_u32 s52, s52, s33
    s_add_u32 s52, s52, 0x1000
    s_add_u32 s40, s40, 1
    s_and_b32 s38, s40, 3
    s_and_b32 s39, s40, 15
    s_bfe_u32 s41, s40, 0x20002
    s_lshl_b32 s41, s41, 16
    s_or_b32 s44, s38, s41
    s_bfe_u32 s41, s40, 0x40004
    s_lshl_b32 s41, s41, 4
    s_or_b32 s48, s39, s41
    s_bfe_u32 s41, s40, 0x20004
    s_lshl_b32 s41, s41, 16
    s_or_b32 s45, s38, s41
    s_bfe_u32 s41, s40, 0x40008
    s_lshl_b32 s41, s41, 4
    s_or_b32 s49, s39, s41
    s_bfe_u32 s41, s40, 0x20006
    s_lshl_b32 s41, s41, 16
    s_or_b32 s46, s38, s41
    s_bfe_u32 s41, s40, 0x4000c
    s_lshl_b32 s41, s41, 4
    s_or_b32 s50, s39, s41
    s_bfe_u32 s41, s40, 0x20008
    s_lshl_b32 s41, s41, 16
    s_or_b32 s47, s38, s41
    s_bfe_u32 s41, s40, 0x40010
    s_lshl_b32 s41, s41, 4
    s_or_b32 s51, s39, s41
    s_mov_b32 s42, 0x3f803f80
    s_cmp_lg_u32 s57, 0
    s_cbranch_scc1 fz_nc1
    v_mov_b32 v160, 0
    v_mov_b32 v161, 0
    v_mov_b32 v162, 0
    v_mov_b32 v163, 0
    s_setprio 3
    s_waitcnt vmcnt(0) lgkmcnt(0)
    ds_read_b64_tr_b16 v[88:89], v7 offset:0
    ds_read_b64_tr_b16 v[90:91], v7 offset:256
    ds_read_b64_tr_b16 v[92:93], v7 offset:1024
    ds_read_b64_tr_b16 v[94:95], v7 offset:1280
    ds_read_u16_d16 v96, v9
    ds_read_u16_d16_hi v136, v8 offset:1408
    ds_read_u16_d16 v97, v8 offset:1344
    ds_read_u16_d16_hi v137, v8 offset:1280
    ds_read_u16_d16 v98, v8 offset:1216
    ds_read_u16_d16_hi v138, v8 offset:1152
    ds_read_u16_d16 v99, v8 offset:1088
    ds_read_u16_d16_hi v139, v8 offset:1024
    s_waitcnt lgkmcnt(8)
    v_mfma_f32_32x32x16_bf16 v[104:119], v[88:91], v[16:19], 0
    v_mfma_f32_32x32x16_bf16 v[104:119], v[92:95], v[20:23], v[104:119]
    ds_read_u16_d16 v100, v8 offset:448
    ds_read_u16_d16_hi v140, v8 offset:384
    ds_read_u16_d16 v101, v8 offset:320
    ds_read_u16_d16_hi v141, v8 offset:256
    ds_read_u16_d16 v102, v8 offset:192
    ds_read_u16_d16_hi v142, v8 offset:128
    ds_read_u16_d16 v103, v8 offset:64
    ds_read_u16_d16_hi v143, v8 offset:0
    v_dot2_f32_bf16 v160, v88, s42, v160
    v_dot2_f32_bf16 v161, v88, v88, v161
    v_dot2_f32_bf16 v160, v89, s42, v160
    v_dot2_f32_bf16 v161, v89, v89, v161
    v_dot2_f32_bf16 v160, v90, s42, v160
    v_dot2_f32_bf16 v161, v90, v90, v161
    v_dot2_f32_bf16 v160, v91, s42, v160
    v_dot2_f32_bf16 v161, v91, v91, v161
    v_dot2_f32_bf16 v160, v92, s42, v160
    v_dot2_f32_bf16 v161, v92, v92, v161
    v_dot2_f32_bf16 v160, v93, s42, v160
    v_dot2_f32_bf16 v161, v93, v93, v161
    v_dot2_f32_bf16 v160, v94, s42, v160
    v_dot2_f32_bf16 v161, v94, v94, v161
    v_dot2_f32_bf16 v160, v95, s42, v160
    v_dot2_f32_bf16 v161, v95, v95, v161
    s_waitcnt lgkmcnt(0)
    v_or_b32 v96, v96, v136
    v_or_b32 v97, v97, v137
    v_or_b32 v98, v98, v138
    v_or_b32 v99, v99, v139
    v_or_b32 v100, v100, v140
    v_or_b32 v101, v101, v141
    v_or_b32 v102, v102, v142
    v_or_b32 v103, v103, v143
    v_mfma_f32_32x32x16_bf16 v[120:135], v[96:99], v[16:19], 0
    s_nop 0
    v_mfma_f32_32x32x16_bf16 v[120:135], v[100:103], v[20:23], v[120:135]
    v_dot2_f32_bf16 v162, v96, s42, v162
    v_dot2_f32_bf16 v163, v96, v96, v163
    v_dot2_f32_bf16 v162, v97, s42, v162
    v_dot2_f32_bf16 v163, v97, v97, v163
    v_dot2_f32_bf16 v162, v98, s42, v162
    v_dot2_f32_bf16 v163, v98, v98, v163
    v_dot2_f32_bf16 v162, v99, s42, v162
    v_dot2_f32_bf16 v163, v99, v99, v163
    v_dot2_f32_bf16 v162, v100, s42, v162
    v_dot2_f32_bf16 v163, v100, v100, v163
    v_dot2_f32_bf16 v162, v101, s42, v162
    v_dot2_f32_bf16 v163, v101, v101, v163
    v_dot2_f32_bf16 v162, v102, s42, v162
    v_dot2_f32_bf16 v163, v102, v102, v163
    v_dot2_f32_bf16 v162, v103, s42, v162
    v_dot2_f32_bf16 v163, v103, v103, v163
    v_add_f32_dpp v160, v160, v160 quad_perm:[1,0,3,2] row_mask:0xf bank_mask:0xf
    v_add_f32_dpp v161, v161, v161 quad_perm:[1,0,3,2] row_mask:0xf bank_mask:0xf
    v_add_f32_dpp v162, v162, v162 quad_perm:[1,0,3,2] row_mask:0xf bank_mask:0xf
    v_add_f32_dpp v163, v163, v163 quad_perm:[1,0,3,2] row_mask:0xf bank_mask:0xf
    v_add_f32_dpp v160, v160, v160 quad_perm:[2,3,0,1] row_mask:0xf bank_mask:0xf
    v_add_f32_dpp v161, v161, v161 quad_perm:[2,3,0,1] row_mask:0xf bank_mask:0xf
    v_add_f32_dpp v162, v162, v162 quad_perm:[2,3,0,1] row_mask:0xf bank_mask:0xf
    v_add_f32_dpp v163, v163, v163 quad_perm:[2,3,0,1] row_mask:0xf bank_mask:0xf
    v_add_f32_dpp v160, v160, v160 row_half_mirror row_mask:0xf bank_mask:0xf
    v_add_f32_dpp v161, v161, v161 row_half_mirror row_mask:0xf bank_mask:0xf
    v_add_f32_dpp v162, v162, v162 row_half_mirror row_mask:0xf bank_mask:0xf
    v_add_f32_dpp v163, v163, v163 row_half_mirror row_mask:0xf bank_mask:0xf
    v_add_f32_dpp v160, v160, v160 row_mirror row_mask:0xf bank_mask:0xf
    v_add_f32_dpp v161, v161, v161 row_mirror row_mask:0xf bank_mask:0xf
    v_add_f32_dpp v162, v162, v162 row_mirror row_mask:0xf bank_mask:0xf
    v_add_f32_dpp v163, v163, v163 row_mirror row_mask:0xf bank_mask:0xf
    v_add_f32_dpp v160, v160, v160 row_bcast:15 row_mask:0xa bank_mask:0xf
    v_add_f32_dpp v161, v161, v161 row_bcast:15 row_mask:0xa bank_mask:0xf
    v_add_f32_dpp v162, v162, v162 row_bcast:15 row_mask:0xa bank_mask:0xf
    v_add_f32_dpp v163, v163, v163 row_bcast:15 row_mask:0xa bank_mask:0xf
    v_add_f32_dpp v160, v160, v160 row_bcast:31 row_mask:0xc bank_mask:0xf
    v_add_f32_dpp v161, v161, v161 row_bcast:31 row_mask:0xc bank_mask:0xf
    v_add_f32_dpp v162, v162, v162 row_bcast:31 row_mask:0xc bank_mask:0xf
    v_add_f32_dpp v163, v163, v163 row_bcast:31 row_mask:0xc bank_mask:0xf
    s_mov_b32 s43, 0x3e800000
    v_mul_f32 v160, 0x3c800000, v160
    v_mul_f32 v162, 0x3c800000, v162
    v_fma_f32 v161, v161, s43, v235
    v_fma_f32 v163, v163, s43, v235
    v_fma_f32 v161, -v160, v160, v161
    v_fma_f32 v163, -v162, v162, v163
    v_rsq_f32 v161, v161
    v_rsq_f32 v163, v163
    v_mul_f32 v160, v160, v161
    v_fmac_f32 v160, v162, v163
    v_readlane_b32 s32, v161, 63
    v_readlane_b32 s34, v163, 63
    v_readlane_b32 s36, v160, 63
    s_nop 1
    v_mul_f32 v164, s36, v234
    v_pk_fma_f32 v[104:105], v[104:105], s[32:33], v[164:165] op_sel_hi:[1,0,0]
    v_pk_fma_f32 v[106:107], v[106:107], s[32:33], v[164:165] op_sel_hi:[1,0,0]
    v_pk_fma_f32 v[108:109], v[108:109], s[32:33], v[164:165] op_sel_hi:[1,0,0]
    v_pk_fma_f32 v[110:111], v[110:111], s[32:33], v[164:165] op_sel_hi:[1,0,0]
    v_pk_fma_f32 v[112:113], v[112:113], s[32:33], v[164:165] op_sel_hi:[1,0,0]
    v_pk_fma_f32 v[114:115], v[114:115], s[32:33], v[164:165] op_sel_hi:[1,0,0]
    v_pk_fma_f32 v[116:117], v[116:117], s[32:33], v[164:165] op_sel_hi:[1,0,0]
    v_pk_fma_f32 v[118:119], v[118:119], s[32:33], v[164:165] op_sel_hi:[1,0,0]
    v_pk_fma_f32 v[104:105], v[120:121], s[34:35], v[104:105] op_sel_hi:[1,0,1]
    v_pk_fma_f32 v[106:107], v[122:123], s[34:35], v[106:107] op_sel_hi:[1,0,1]
    v_pk_fma_f32 v[108:109], v[124:125], s[34:35], v[108:109] op_sel_hi:[1,0,1]
    v_pk_fma_f32 v[110:111], v[126:127], s[34:35], v[110:111] op_sel_hi:[1,0,1]
    v_pk_fma_f32 v[112:113], v[128:129], s[34:35], v[112:113] op_sel_hi:[1,0,1]
    v_pk_fma_f32 v[114:115], v[130:131], s[34:35], v[114:115] op_sel_hi:[1,0,1]
    v_pk_fma_f32 v[116:117], v[132:133], s[34:35], v[116:117] op_sel_hi:[1,0,1]
    v_pk_fma_f32 v[118:119], v[134:135], s[34:35], v[118:119] op_sel_hi:[1,0,1]
    v_cvt_pk_f16_f32 v136, v104, v105
    v_cvt_pk_f16_f32 v137, v106, v107
    v_cvt_pk_f16_f32 v138, v108, v109
    v_cvt_pk_f16_f32 v139, v110, v111
    v_cvt_pk_f16_f32 v140, v112, v113
    v_cvt_pk_f16_f32 v141, v114, v115
    v_cvt_pk_f16_f32 v142, v116, v117
    v_cvt_pk_f16_f32 v143, v118, v119
    v_mov_b32_dpp v152, v136 quad_perm:[1,0,3,2] row_mask:0xf bank_mask:0xf
    v_mov_b32_dpp v153, v137 quad_perm:[1,0,3,2] row_mask:0xf bank_mask:0xf
    v_mov_b32_dpp v154, v138 quad_perm:[1,0,3,2] row_mask:0xf bank_mask:0xf
    v_mov_b32_dpp v155, v139 quad_perm:[1,0,3,2] row_mask:0xf bank_mask:0xf
    v_mov_b32_dpp v156, v140 quad_perm:[1,0,3,2] row_mask:0xf bank_mask:0xf
    v_mov_b32_dpp v157, v141 quad_perm:[1,0,3,2] row_mask:0xf bank_mask:0xf
    v_mov_b32_dpp v158, v142 quad_perm:[1,0,3,2] row_mask:0xf bank_mask:0xf
    v_mov_b32_dpp v159, v143 quad_perm:[1,0,3,2] row_mask:0xf bank_mask:0xf
    v_pk_mul_f16 v144, v136, v24
    v_pk_mul_f16 v145, v137, v25
    v_pk_mul_f16 v146, v138, v26
    v_pk_mul_f16 v147, v139, v27
    v_pk_mul_f16 v148, v140, v28
    v_pk_mul_f16 v149, v141, v29
    v_pk_mul_f16 v150, v142, v30
    v_pk_mul_f16 v151, v143, v31
    v_mfma_f32_16x16x32_f16 v[120:123], v[136:139], v[56:59], 0
    v_pk_fma_f16 v144, v152, v32, v144
    v_pk_fma_f16 v145, v153, v33, v145
    v_pk_fma_f16 v146, v154, v34, v146
    v_pk_fma_f16 v147, v155, v35, v147
    v_mfma_f32_16x16x32_f16 v[120:123], v[140:143], v[60:63], v[120:123]
    v_pk_fma_f16 v148, v156, v36, v148
    v_pk_fma_f16 v149, v157, v37, v149
    v_pk_fma_f16 v150, v158, v38, v150
    v_pk_fma_f16 v151, v159, v39, v151
    v_mfma_f32_32x32x16_f16 v[104:119], v[144:147], v[40:43], 0
    v_xor_b32_dpp v152, v144, v240 quad_perm:[1,0,3,2] row_mask:0xf bank_mask:0xf
    v_xor_b32_dpp v153, v145, v240 quad_perm:[1,0,3,2] row_mask:0xf bank_mask:0xf
    v_xor_b32_dpp v154, v146, v240 quad_perm:[1,0,3,2] row_mask:0xf bank_mask:0xf
    v_xor_b32_dpp v155, v147, v240 quad_perm:[1,0,3,2] row_mask:0xf bank_mask:0xf
    v_mfma_f32_32x32x16_f16 v[104:119], v[148:151], v[44:47], v[104:119]
    v_xor_b32_dpp v156, v148, v240 quad_perm:[1,0,3,2] row_mask:0xf bank_mask:0xf
    v_xor_b32_dpp v157, v149, v240 quad_perm:[1,0,3,2] row_mask:0xf bank_mask:0xf
    v_xor_b32_dpp v158, v150, v240 quad_perm:[1,0,3,2] row_mask:0xf bank_mask:0xf
    v_xor_b32_dpp v159, v151, v240 quad_perm:[1,0,3,2] row_mask:0xf bank_mask:0xf
    v_mfma_f32_32x32x16_f16 v[104:119], v[152:155], v[48:51], v[104:119]
    s_nop 0
    v_mfma_f32_32x32x16_f16 v[104:119], v[156:159], v[52:55], v[104:119]
    v_mfma_f32_16x16x32_f16 v[124:127], v[136:139], v[64:67], 0
    v_mfma_f32_16x16x32_f16 v[124:127], v[140:143], v[68:71], v[124:127]
    s_mov_b64 vcc, 0xffff
    s_nop 8
    v_cvt_pk_f16_f32 v143, v118, v119
    v_cvt_pk_f16_f32 v142, v116, v117
    v_cvt_pk_f16_f32 v141, v114, v115
    v_cvt_pk_f16_f32 v140, v112, v113
    v_cvt_pk_f16_f32 v139, v110, v111
    v_cvt_pk_f16_f32 v138, v108, v109
    v_cvt_pk_f16_f32 v137, v106, v107
    v_cndmask_b32_e64 v104, v104, v121, vcc
    v_cndmask_b32_e64 v105, v105, v125, vcc
    v_pk_add_f16 v147, v142, v143 op_sel:[0,1] op_sel_hi:[1,0] neg_lo:[0,1]
    v_pk_add_f16 v151, v142, v143 op_sel:[0,1] op_sel_hi:[1,0] neg_hi:[1,0]
    v_pk_add_f16 v146, v140, v141 op_sel:[0,1] op_sel_hi:[1,0] neg_lo:[0,1]
    v_pk_add_f16 v150, v140, v141 op_sel:[0,1] op_sel_hi:[1,0] neg_hi:[1,0]
    v_pk_add_f16 v145, v138, v139 op_sel:[0,1] op_sel_hi:[1,0] neg_lo:[0,1]
    v_pk_add_f16 v149, v138, v139 op_sel:[0,1] op_sel_hi:[1,0] neg_hi:[1,0]
    v_cvt_pk_f16_f32 v136, v104, v105
    v_pk_add_f16 v144, v136, v137 op_sel:[0,1] op_sel_hi:[1,0] neg_lo:[0,1]
    v_pk_add_f16 v148, v136, v137 op_sel:[0,1] op_sel_hi:[1,0] neg_hi:[1,0]
    ds_write_b128 v216, v[144:147]
    ds_write_b128 v216, v[148:151] offset:1152
    s_setprio 0
    s_waitcnt lgkmcnt(0)
fz_b1:
    s_barrier
    ds_read_b32 v104, v217
    ds_read_b32 v105, v218
    ds_read_b32 v106, v219
    ds_read_b32 v107, v220
    s_waitcnt lgkmcnt(1)
    v_pk_add_f16 v112, v104, v106
    v_pk_add_f16 v113, v104, v106 neg_lo:[0,1] neg_hi:[0,1]
    s_waitcnt lgkmcnt(0)
    v_pk_add_f16 v114, v105, v107
    v_pk_add_f16 v115, v105, v107 neg_lo:[0,1] neg_hi:[0,1]
    v_pk_add_f16 v116, v112, v114
    v_pk_add_f16 v118, v112, v114 neg_lo:[0,1] neg_hi:[0,1]
    v_pk_add_f16 v117, v113, v115 op_sel:[0,1] op_sel_hi:[1,0] neg_hi:[0,1]
    v_pk_add_f16 v119, v113, v115 op_sel:[0,1] op_sel_hi:[1,0] neg_lo:[0,1]
    v_add_u32 v116, 0x20002, v116
    v_add_u32 v117, 0x20002, v117
    v_add_u32 v118, 0x20002, v118
    v_add_u32 v119, 0x20002, v119
    v_and_or_b32 v116, v116, v229, s44
    v_and_or_b32 v117, v117, v229, s45
    v_and_or_b32 v118, v118, v229, s46
    v_and_or_b32 v119, v119, v229, s47
    buffer_store_dwordx4 v[116:119], v221, s[4:7], s52 offen sc1
    s_cmp_lg_u32 s59, 0
    s_cbranch_scc1 ffn
    s_cmp_lg_u32 s57, 0
    s_cbranch_scc1 fz_nc2
    ds_read_b128 v[72:75], v6 offset:14336
    ds_read_b128 v[76:79], v6 offset:15360
    ds_read_b128 v[80:83], v6 offset:16384
    ds_read_b128 v[84:87], v6 offset:17408
    s_and_b32 s32, s3, 3
    s_lshr_b32 s33, s3, 2
    s_lshl_b32 s33, s33, 4
    s_add_u32 s33, s33, s32
    v_and_b32 v8, 12, v4
    v_bfe_u32 v9, v4, 1, 1
    v_lshl_add_u32 v8, v9, 5, v8
    v_add_u32 v8, s33, v8
    v_cvt_f32_u32 v8, v8
    v_and_b32 v12, 1, v1
    v_cvt_f32_u32 v9, v12
    v_lshlrev_b32 v13, 2, v5
    v_cvt_f32_u32 v10, v13
    v_mul_f32 v11, 0x3c800000, v8
    v_mul_f32 v9, 0x3e800000, v9
    v_fma_f32 v9, v11, v10, v9
    v_mov_b32 v128, v9
    v_fmamk_f32 v129, v11, 0x3f800000, v9
    v_fmamk_f32 v130, v11, 0x40000000, v9
    v_fmamk_f32 v131, v11, 0x40400000, v9
    v_mul_f32 v11, 0x3a000000, v8
    v_lshlrev_b32 v9, 31, v1
    v_xor_b32 v11, v9, v11
    v_mul_f32 v9, v11, v10
    v_mov_b32 v112, v9
    v_fmamk_f32 v113, v11, 0x3f800000, v9
    v_fmamk_f32 v114, v11, 0x40000000, v9
    v_fmamk_f32 v115, v11, 0x40400000, v9
    v_fmamk_f32 v116, v11, 0x41800000, v9
    v_fmamk_f32 v117, v11, 0x41880000, v9
    v_fmamk_f32 v118, v11, 0x41900000, v9
    v_fmamk_f32 v119, v11, 0x41980000, v9
    v_cos_f32 v104, v128
    v_sin_f32 v105, v128
    v_cos_f32 v106, v129
    v_sin_f32 v107, v129
    v_cos_f32 v108, v130
    v_sin_f32 v109, v130
    v_cos_f32 v110, v131
    v_sin_f32 v111, v131
    v_sin_f32 v120, v112
    v_sin_f32 v121, v113
    v_sin_f32 v122, v114
    v_sin_f32 v123, v115
    v_sin_f32 v124, v116
    v_sin_f32 v125, v117
    v_sin_f32 v126, v118
    v_sin_f32 v127, v119
    v_cos_f32 v112, v112
    v_cos_f32 v113, v113
    v_cos_f32 v114, v114
    v_cos_f32 v115, v115
    v_cos_f32 v116, v116
    v_cos_f32 v117, v117
    v_cos_f32 v118, v118
    v_cos_f32 v119, v119
    v_cvt_pk_f16_f32 v16, v104, v105
    v_cvt_pk_f16_f32 v17, v106, v107
    v_cvt_pk_f16_f32 v18, v108, v109
    v_cvt_pk_f16_f32 v19, v110, v111
    v_cvt_pk_f16_f32 v20, v112, v113
    v_cvt_pk_f16_f32 v21, v114, v115
    v_cvt_pk_f16_f32 v22, v116, v117
    v_cvt_pk_f16_f32 v23, v118, v119
    v_cvt_pk_f16_f32 v24, v120, v121
    v_cvt_pk_f16_f32 v25, v122, v123
    v_cvt_pk_f16_f32 v26, v124, v125
    v_cvt_pk_f16_f32 v27, v126, v127
    v_lshrrev_b32 v8, 3, v1
    v_mul_u32_u24 v222, 16512, v8
    v_and_b32 v9, 7, v1
    v_lshl_add_u32 v222, v9, 4, v222
    s_mul_i32 s60, s3, 264192
    s_lshl_b32 s32, s20, 7
    s_add_u32 s60, s60, s32
    s_add_u32 s60, s60, 0x1000
    s_add_u32 s61, s60, 132096
    v_lshlrev_b32 v8, 1, v8
    v_bfe_u32 v9, v1, 2, 1
    v_add_u32 v8, v8, v9
    s_lshl_b32 s32, s3, 1
    s_add_u32 s32, s32, 1
    v_lshl_add_u32 v8, v8, 5, s32
    v_cmp_eq_u32 vcc, 1, v12
    v_bfe_u32 v9, v1, 1, 1
    v_mul_u32_u24 v9, 8256, v9
    v_add_u32 v9, 86400, v9
    s_cmp_eq_u32 s3, 7
    s_cselect_b32 s32, 272, 0
    v_sub_u32 v10, 512, v8
    v_cndmask_b32_e64 v10, v8, v10, vcc
    v_and_b32 v11, 16, v10
    v_lshl_add_u32 v11, v11, 6, v9
    v_lshrrev_b32 v12, 7, v10
    v_lshl_add_u32 v11, v12, 8, v11
    v_and_b32 v12, 15, v10
    v_lshl_add_u32 v11, v12, 4, v11
    v_bfe_u32 v12, v10, 5, 2
    v_lshl_add_u32 v223, v12, 2, v11
    v_mul_u32_u24 v10, s32, v3
    v_sub_u32 v8, v8, v10
    v_add_u32 v8, 1, v8
    v_sub_u32 v10, 512, v8
    v_cndmask_b32_e64 v10, v8, v10, vcc
    v_lshrrev_b32 v11, 1, v10
    v_and_b32 v11, 256, v11
    v_sub_u32 v10, v10, v11
    v_and_b32 v11, 16, v10
    v_lshl_add_u32 v11, v11, 6, v9
    v_lshrrev_b32 v12, 7, v10
    v_lshl_add_u32 v11, v12, 8, v11
    v_and_b32 v12, 15, v10
    v_lshl_add_u32 v11, v12, 4, v11
    v_bfe_u32 v12, v10, 5, 2
    v_lshl_add_u32 v224, v12, 2, v11
    s_and_b32 s32, s3, 3
    s_lshl_b32 s32, s32, 11
    s_add_u32 s32, s32, 86400
    v_add_u32 v225, s32, v239
    v_add_u32 v8, s33, v13
    v_sub_u32 v9, 32, v8
    v_min_u32 v9, v8, v9
    v_and_b32 v10, 15, v8
    v_cmp_eq_u32 s[32:33], 0, v10
    v_cmp_lt_u32 s[34:35], 16, v8
    v_lshlrev_b32 v10, 10, v9
    v_subrev_u32 v10, 1024, v10
    v_mov_b32 v11, 15872
    v_cmp_eq_u32 vcc, 0, v8
    s_nop 1
    v_cndmask_b32_e64 v10, v10, v11, vcc
    v_and_b32 v11, 3, v1
    v_lshl_add_u32 v10, v11, 4, v10
    v_lshrrev_b32 v11, 2, v4
    v_lshlrev_b32 v12, 7, v11
    v_sub_u32 v13, 960, v12
    v_cndmask_b32_e64 v13, v12, v13, s[34:35]
    v_add_u32 v226, v10, v13
    s_or_b64 s[34:35], s[34:35], s[32:33]
    v_add_u32 v12, 512, v12
    v_sub_u32 v13, 960, v12
    v_cndmask_b32_e64 v13, v12, v13, s[34:35]
    v_add_u32 v227, v10, v13
    s_mul_i32 s56, s20, 16512
    s_add_u32 s56, s56, 0x210000
    v_mov_b32 v249, 0x30003
    v_mov_b32 v252, s44
    v_mov_b32 v253, s45
    v_mov_b32 v254, s46
    v_mov_b32 v255, s47
    s_waitcnt lgkmcnt(0)
fz_nc2back:
    s_waitcnt vmcnt(0)
    s_nop 2
fz_h1:
    buffer_load_dwordx4 v[104:107], v222, s[4:7], s60 offen sc1
    buffer_load_dwordx4 v[108:111], v222, s[4:7], s61 offen sc1
    s_waitcnt vmcnt(1)
    v_xor_b32 v104, v252, v104
    v_xor_b32 v105, v253, v105
    v_xor_b32 v106, v254, v106
    v_xor_b32 v107, v255, v107
    v_or3_b32 v112, v104, v105, v106
    s_waitcnt vmcnt(0)
    v_xor_b32 v108, v252, v108
    v_xor_b32 v109, v253, v109
    v_xor_b32 v110, v254, v110
    v_xor_b32 v111, v255, v111
    v_or3_b32 v112, v112, v107, v108
    v_or3_b32 v113, v109, v110, v111
    v_bitop3_b32 v112, v112, v113, v249 bitop3:0xa8
    v_cmp_ne_u32 vcc, 0, v112
    s_cbranch_vccnz fz_h1_rt
fz_h1_ok:
    ds_write_b32 v223, v104 offset:0
    ds_write_b32 v223, v105 offset:2048
    ds_write_b32 v223, v106 offset:4096
    ds_write_b32 v223, v107 offset:6144
    ds_write_b32 v224, v108 offset:0
    ds_write_b32 v224, v109 offset:2048
    ds_write_b32 v224, v110 offset:4096
    ds_write_b32 v224, v111 offset:6144
    s_waitcnt lgkmcnt(0)
    s_barrier
    ds_read_b128 v[104:107], v225 offset:0
    ds_read_b128 v[108:111], v225 offset:1024
    ds_read_b128 v[112:115], v225 offset:8256
    ds_read_b128 v[116:119], v225 offset:9280
    s_waitcnt lgkmcnt(3)
    v_mfma_f32_16x16x32_f16 v[120:123], v[104:107], v[16:19], 0
    s_waitcnt lgkmcnt(2)
    v_mfma_f32_16x16x32_f16 v[124:127], v[108:111], v[16:19], 0
    s_waitcnt lgkmcnt(1)
    v_mfma_f32_16x16x32_f16 v[128:131], v[112:115], v[16:19], 0
    s_waitcnt lgkmcnt(0)
    v_mfma_f32_16x16x32_f16 v[132:135], v[116:119], v[16:19], 0
    s_nop 1
    v_cvt_pk_f16_f32 v136, v120, v121
    v_cvt_pk_f16_f32 v137, v122, v123
    v_cvt_pk_f16_f32 v138, v124, v125
    v_cvt_pk_f16_f32 v139, v126, v127
    v_cvt_pk_f16_f32 v140, v128, v129
    v_cvt_pk_f16_f32 v141, v130, v131
    v_cvt_pk_f16_f32 v142, v132, v133
    v_cvt_pk_f16_f32 v143, v134, v135
    v_pk_mul_f16 v144, v136, v20
    v_pk_mul_f16 v145, v137, v21
    v_pk_mul_f16 v146, v138, v22
    v_pk_mul_f16 v147, v139, v23
    v_mov_b32_dpp v152, v136 quad_perm:[1,0,3,2] row_mask:0xf bank_mask:0xf
    v_mov_b32_dpp v153, v137 quad_perm:[1,0,3,2] row_mask:0xf bank_mask:0xf
    v_mov_b32_dpp v154, v138 quad_perm:[1,0,3,2] row_mask:0xf bank_mask:0xf
    v_mov_b32_dpp v155, v139 quad_perm:[1,0,3,2] row_mask:0xf bank_mask:0xf
    v_pk_fma_f16 v144, v152, v24, v144
    v_pk_fma_f16 v145, v153, v25, v145
    v_pk_fma_f16 v146, v154, v26, v146
    v_pk_fma_f16 v147, v155, v27, v147
    s_nop 1
    v_mfma_f32_16x16x32_f16 v[104:107], v[144:147], v[72:75], 0
    v_mfma_f32_16x16x32_f16 v[108:111], v[144:147], v[80:83], 0
    v_xor_b32_dpp v152, v144, v240 quad_perm:[1,0,3,2] row_mask:0xf bank_mask:0xf
    v_xor_b32_dpp v153, v145, v240 quad_perm:[1,0,3,2] row_mask:0xf bank_mask:0xf
    v_xor_b32_dpp v154, v146, v240 quad_perm:[1,0,3,2] row_mask:0xf bank_mask:0xf
    v_xor_b32_dpp v155, v147, v240 quad_perm:[1,0,3,2] row_mask:0xf bank_mask:0xf
    s_nop 1
    v_mfma_f32_16x16x32_f16 v[104:107], v[152:155], v[76:79], v[104:107]
    v_mfma_f32_16x16x32_f16 v[108:111], v[152:155], v[84:87], v[108:111]
    v_pk_mul_f16 v148, v140, v20
    v_pk_mul_f16 v149, v141, v21
    v_pk_mul_f16 v150, v142, v22
    v_pk_mul_f16 v151, v143, v23
    v_mov_b32_dpp v156, v140 quad_perm:[1,0,3,2] row_mask:0xf bank_mask:0xf
    v_mov_b32_dpp v157, v141 quad_perm:[1,0,3,2] row_mask:0xf bank_mask:0xf
    v_mov_b32_dpp v158, v142 quad_perm:[1,0,3,2] row_mask:0xf bank_mask:0xf
    v_mov_b32_dpp v159, v143 quad_perm:[1,0,3,2] row_mask:0xf bank_mask:0xf
    v_pk_fma_f16 v148, v156, v24, v148
    v_pk_fma_f16 v149, v157, v25, v149
    v_pk_fma_f16 v150, v158, v26, v150
    v_pk_fma_f16 v151, v159, v27, v151
    s_nop 1
    v_mfma_f32_16x16x32_f16 v[112:115], v[148:151], v[72:75], 0
    v_mfma_f32_16x16x32_f16 v[116:119], v[148:151], v[80:83], 0
    v_xor_b32_dpp v156, v148, v240 quad_perm:[1,0,3,2] row_mask:0xf bank_mask:0xf
    v_xor_b32_dpp v157, v149, v240 quad_perm:[1,0,3,2] row_mask:0xf bank_mask:0xf
    v_xor_b32_dpp v158, v150, v240 quad_perm:[1,0,3,2] row_mask:0xf bank_mask:0xf
    v_xor_b32_dpp v159, v151, v240 quad_perm:[1,0,3,2] row_mask:0xf bank_mask:0xf
    s_nop 1
    v_mfma_f32_16x16x32_f16 v[112:115], v[156:159], v[76:79], v[112:115]
    v_mfma_f32_16x16x32_f16 v[116:119], v[156:159], v[84:87], v[116:119]
    v_cvt_pk_f16_f32 v120, v104, v105
    v_cvt_pk_f16_f32 v122, v106, v107
    s_nop 4
    v_cvt_pk_f16_f32 v121, v112, v113
    v_cvt_pk_f16_f32 v123, v114, v115
    v_add_u32 v120, 0x20002, v120
    v_add_u32 v121, 0x20002, v121
    v_add_u32 v122, 0x20002, v122
    v_add_u32 v123, 0x20002, v123
    v_and_or_b32 v120, v120, v229, s44
    v_and_or_b32 v121, v121, v229, s45
    v_and_or_b32 v122, v122, v229, s46
    v_and_or_b32 v123, v123, v229, s47
    buffer_store_dwordx4 v[120:123], v226, s[4:7], s56 offen sc1
    v_cvt_pk_f16_f32 v124, v108, v109
    v_cvt_pk_f16_f32 v126, v110, v111
    v_cvt_pk_f16_f32 v125, v116, v117
    v_cvt_pk_f16_f32 v127, v118, v119
    v_add_u32 v124, 0x20002, v124
    v_add_u32 v125, 0x20002, v125
    v_add_u32 v126, 0x20002, v126
    v_add_u32 v127, 0x20002, v127
    v_and_or_b32 v124, v124, v229, s44
    v_and_or_b32 v125, v125, v229, s45
    v_and_or_b32 v126, v126, v229, s46
    v_and_or_b32 v127, v127, v229, s47
    buffer_store_dwordx4 v[124:127], v227, s[4:7], s56 offen sc1
    s_cmp_lg_u32 s57, 0
    s_cbranch_scc1 fz_nc3
    v_sub_u32 v8, 15, v4
    v_min_u32 v8, v4, v8
    v_and_b32 v9, 1, v8
    v_lshlrev_b32 v9, 5, v9
    v_lshrrev_b32 v10, 1, v8
    v_lshl_add_u32 v9, v10, 9, v9
    v_add_u32 v9, s25, v9
    v_sub_u32 v10, 2048, v9
    v_cmp_lt_u32 s[34:35], 7, v4
    s_nop 1
    v_cndmask_b32_e64 v230, v9, v10, s[34:35]
    v_mov_b32 v9, v4
    v_mov_b32 v10, s20
    s_cmp_lg_u32 s21, 0
    s_cbranch_scc0 fz_spec3a
fz_spec3backa:
    v_lshlrev_b32 v10, 7, v10
    v_lshl_add_u32 v10, v9, 3, v10
    v_mul_u32_u24 v11, 66048, v5
    v_add_u32 v228, v10, v11
    v_and_b32 v9, 1, v9
    v_cmp_eq_u32 vcc, 1, v9
    v_mov_b32 v9, s44
    v_mov_b32 v10, s46
    v_cndmask_b32_e64 v236, v9, v10, vcc
    v_mov_b32 v9, s45
    v_mov_b32 v10, s47
    v_cndmask_b32_e64 v237, v9, v10, vcc
    s_lshl_b32 s32, s3, 2
    v_add_u32 v8, s32, v5
    v_lshlrev_b32 v9, 6, v8
    v_cmp_gt_u32 vcc, 16, v8
    s_nop 1
    v_cndmask_b32_e64 v10, 0, 32, vcc
    v_add_u32 v10, v9, v10
    v_sub_u32 v11, 2048, v10
    v_cmp_eq_u32 vcc, 16, v8
    s_nop 1
    v_cndmask_b32_e64 v11, v11, 0, vcc
    v_mov_b32 v12, 0xffff0000
    v_cndmask_b32_e64 v238, -1, v12, vcc
    v_sub_u32 v12, 2018, v9
    v_mul_u32_u24 v13, 2064, v4
    v_add_u32 v231, v13, v9
    v_add_u32 v232, v13, v12
    v_add_u32 v233, v13, v10
    v_add_u32 v241, v13, v11
    s_lshl_b32 s32, s3, 8
    s_add_u32 s32, s32, 102912
    v_lshlrev_b32 v9, 4, v4
    v_add_u32 v10, s32, v9
    v_add_u32 v11, 107008, v239
    v_cmp_gt_u32 vcc, 16, v1
    s_nop 1
    v_cndmask_b32_e64 v243, v11, v10, vcc
    v_lshrrev_b32 v12, 2, v4
    v_cmp_eq_u32 vcc, v12, v5
    s_nop 1
    v_cndmask_b32_e64 v244, v11, v10, vcc
    v_lshrrev_b32 v12, 5, v1
    v_lshl_add_u32 v10, v12, 10, v9
    v_add_u32 v245, 102912, v10
    v_and_b32 v9, 1, v1
    v_cmp_eq_u32 s[28:29], 1, v9
    v_and_b32 v9, 2, v1
    v_cmp_eq_u32 s[30:31], 2, v9
    s_lshl_b32 s37, s3, 2
    v_add_u32 v9, s37, v5
    v_mul_u32_u24 v246, 2176, v9
    s_lshl_b32 s26, s20, 4
    s_add_u32 s26, s26, 0x420000
    v_lshlrev_b32 v247, 4, v5
    s_lshl_b32 s27, s20, 11
    s_lshl_b32 s37, s3, 8
    s_add_u32 s27, s27, s37
    s_add_u32 s27, s27, 0x440000
    v_sub_u32 v248, 2047, v230
    s_mov_b32 s14, 0x400000
    s_mov_b32 s15, 0x00020000
    s_mov_b32 s66, 0x700000
    s_mov_b32 s67, 0x00020000
    v_lshlrev_b32 v10, 4, v0
    v_min_u32 v10, 4336, v10
    v_add_u32 v10, 108032, v10
    v_mov_b32 v104, 0
    v_mov_b32 v105, 0
    v_mov_b32 v106, 0
    v_mov_b32 v107, 0
    ds_write_b128 v10, v[104:107]
    v_lshlrev_b32 v10, 4, v4
    v_lshl_add_u32 v14, v5, 11, v10
    s_lshl_b32 s62, s20, 16
    s_lshl_b32 s37, s3, 8
    s_add_u32 s62, s62, s37
    ds_read_b128 v[104:107], v231
    ds_read_b128 v[108:111], v231 offset:16
    ds_read_u16_d16_hi v184, v241
    ds_read_u16_d16_hi v185, v232 offset:28
    ds_read_u16_d16_hi v186, v232 offset:26
    ds_read_u16_d16_hi v187, v232 offset:24
    ds_read_u16_d16_hi v188, v232 offset:22
    ds_read_u16_d16_hi v189, v232 offset:20
    ds_read_u16_d16_hi v190, v232 offset:18
    ds_read_u16_d16_hi v191, v232 offset:16
    ds_read_u16_d16_hi v192, v232 offset:14
    ds_read_u16_d16_hi v193, v232 offset:12
    ds_read_u16_d16_hi v194, v232 offset:10
    ds_read_u16_d16_hi v195, v232 offset:8
    ds_read_u16_d16_hi v196, v232 offset:6
    ds_read_u16_d16_hi v197, v232 offset:4
    ds_read_u16_d16_hi v198, v232 offset:2
    ds_read_u16_d16_hi v199, v232 offset:0
    ds_read_u16_d16_hi v168, v233
    v_mul_u32_u24 v13, 2064, v4
    v_subrev_u32 v13, 104960, v13
    v_sub_u32 v9, v231, v13
    v_sub_u32 v10, v233, v13
    v_sub_u32 v11, v241, v13
    v_sub_u32 v12, v232, v13
    s_mov_b32 s36, 0xffff0000
    s_waitcnt lgkmcnt(0)
    ds_read_b128 v[200:203], v9
    ds_read_b128 v[204:207], v9 offset:16
    ds_read_u16_d16 v208, v11
    ds_read_u16_d16_hi v112, v12 offset:28
    ds_read_u16_d16 v209, v12 offset:26
    ds_read_u16_d16_hi v113, v12 offset:24
    ds_read_u16_d16 v210, v12 offset:22
    ds_read_u16_d16_hi v114, v12 offset:20
    ds_read_u16_d16 v211, v12 offset:18
    ds_read_u16_d16_hi v115, v12 offset:16
    ds_read_u16_d16 v212, v12 offset:14
    ds_read_u16_d16_hi v116, v12 offset:12
    ds_read_u16_d16 v213, v12 offset:10
    ds_read_u16_d16_hi v117, v12 offset:8
    ds_read_u16_d16 v214, v12 offset:6
    ds_read_u16_d16_hi v118, v12 offset:4
    ds_read_u16_d16 v215, v12 offset:2
    ds_read_u16_d16_hi v119, v12 offset:0
    ds_read_u16_d16 v13, v10
    v_and_b32 v169, s36, v104
    v_lshlrev_b32 v170, 16, v105
    v_and_b32 v171, s36, v105
    v_lshlrev_b32 v172, 16, v106
    v_and_b32 v173, s36, v106
    v_lshlrev_b32 v174, 16, v107
    v_and_b32 v175, s36, v107
    v_lshlrev_b32 v176, 16, v108
    v_and_b32 v177, s36, v108
    v_lshlrev_b32 v178, 16, v109
    v_and_b32 v179, s36, v109
    v_lshlrev_b32 v180, 16, v110
    v_and_b32 v181, s36, v110
    v_lshlrev_b32 v182, 16, v111
    v_and_b32 v183, s36, v111
    v_cmp_eq_u32 vcc, 1, v4
    v_mov_b32 v9, s42
    s_nop 0
    v_cndmask_b32_e64 v9, 0, v9, vcc
    v_mov_b32 v104, s42
    v_mov_b32 v105, s42
    v_mov_b32 v106, s42
    v_mov_b32 v107, s42
    v_cmp_eq_u32 vcc, 0, v4
    s_waitcnt lgkmcnt(0)
    v_and_or_b32 v200, v200, s36, v13
    v_or_b32 v208, v208, v112
    v_or_b32 v209, v209, v113
    v_or_b32 v210, v210, v114
    v_or_b32 v211, v211, v115
    v_or_b32 v212, v212, v116
    v_or_b32 v213, v213, v117
    v_or_b32 v214, v214, v118
    v_or_b32 v215, v215, v119
    v_cndmask_b32_e64 v200, v9, v200, vcc
    v_cndmask_b32_e64 v201, v9, v201, vcc
    v_cndmask_b32_e64 v202, v9, v202, vcc
    v_cndmask_b32_e64 v203, v9, v203, vcc
    v_cndmask_b32_e64 v204, v9, v204, vcc
    v_cndmask_b32_e64 v205, v9, v205, vcc
    v_cndmask_b32_e64 v206, v9, v206, vcc
    v_cndmask_b32_e64 v207, v9, v207, vcc
    v_cndmask_b32_e64 v208, v9, v208, vcc
    v_cndmask_b32_e64 v209, v9, v209, vcc
    v_cndmask_b32_e64 v210, v9, v210, vcc
    v_cndmask_b32_e64 v211, v9, v211, vcc
    v_cndmask_b32_e64 v212, v9, v212, vcc
    v_cndmask_b32_e64 v213, v9, v213, vcc
    v_cndmask_b32_e64 v214, v9, v214, vcc
    v_cndmask_b32_e64 v215, v9, v215, vcc
    v_mfma_f32_16x16x32_bf16 v[108:111], v[200:203], v[104:107], 0
    v_mfma_f32_16x16x32_bf16 v[108:111], v[204:207], v[104:107], v[108:111]
    v_mfma_f32_16x16x32_bf16 v[108:111], v[208:211], v[104:107], v[108:111]
    v_mfma_f32_16x16x32_bf16 v[108:111], v[212:215], v[104:107], v[108:111]
    s_mul_i32 s52, s3, 264192
    s_add_u32 s52, s52, 0x210000
    s_add_u32 s53, s52, 16512
    s_add_u32 s54, s52, 33024
    s_add_u32 s55, s52, 49536
    s_nop 2
    ds_write_b32 v243, v108 offset:12
fz_nc3:
    s_mov_b32 s36, 0x43000000
    s_mov_b32 s58, 0
    s_waitcnt vmcnt(0)
    s_nop 0
fz_h2:
    buffer_load_dwordx2 v[104:105], v228, s[4:7], s52 offen sc1
    buffer_load_dwordx2 v[106:107], v228, s[4:7], s53 offen sc1
    buffer_load_dwordx2 v[108:109], v228, s[4:7], s54 offen sc1
    buffer_load_dwordx2 v[110:111], v228, s[4:7], s55 offen sc1
    s_waitcnt vmcnt(3)
    v_xor_b32 v104, v236, v104
    v_xor_b32 v105, v237, v105
    v_or_b32 v9, v104, v105
    s_waitcnt vmcnt(2)
    v_xor_b32 v106, v236, v106
    v_xor_b32 v107, v237, v107
    v_or3_b32 v9, v9, v106, v107
    s_waitcnt vmcnt(1)
    v_xor_b32 v108, v236, v108
    v_xor_b32 v109, v237, v109
    v_or3_b32 v9, v9, v108, v109
    s_waitcnt vmcnt(0)
    v_xor_b32 v110, v236, v110
    v_xor_b32 v111, v237, v111
    v_or3_b32 v9, v9, v110, v111
    v_and_b32 v9, v249, v9
    v_cmp_ne_u32 vcc, 0, v9
    s_cbranch_vccnz fz_h2_rt
fz_h2_ok:
    v_fma_mix_f32 v168, v104, s36, v168 op_sel:[0,0,0] op_sel_hi:[1,0,0]
    v_fma_mix_f32 v169, v104, s36, v169 op_sel:[1,0,0] op_sel_hi:[1,0,0]
    v_fma_mix_f32 v170, v105, s36, v170 op_sel:[0,0,0] op_sel_hi:[1,0,0]
    v_fma_mix_f32 v171, v105, s36, v171 op_sel:[1,0,0] op_sel_hi:[1,0,0]
    v_fma_mix_f32 v172, v106, s36, v172 op_sel:[0,0,0] op_sel_hi:[1,0,0]
    v_fma_mix_f32 v173, v106, s36, v173 op_sel:[1,0,0] op_sel_hi:[1,0,0]
    v_fma_mix_f32 v174, v107, s36, v174 op_sel:[0,0,0] op_sel_hi:[1,0,0]
    v_fma_mix_f32 v175, v107, s36, v175 op_sel:[1,0,0] op_sel_hi:[1,0,0]
    v_fma_mix_f32 v176, v108, s36, v176 op_sel:[0,0,0] op_sel_hi:[1,0,0]
    v_fma_mix_f32 v177, v108, s36, v177 op_sel:[1,0,0] op_sel_hi:[1,0,0]
    v_fma_mix_f32 v178, v109, s36, v178 op_sel:[0,0,0] op_sel_hi:[1,0,0]
    v_fma_mix_f32 v179, v109, s36, v179 op_sel:[1,0,0] op_sel_hi:[1,0,0]
    v_fma_mix_f32 v180, v110, s36, v180 op_sel:[0,0,0] op_sel_hi:[1,0,0]
    v_fma_mix_f32 v181, v110, s36, v181 op_sel:[1,0,0] op_sel_hi:[1,0,0]
    v_fma_mix_f32 v182, v111, s36, v182 op_sel:[0,0,0] op_sel_hi:[1,0,0]
    v_fma_mix_f32 v183, v111, s36, v183 op_sel:[1,0,0] op_sel_hi:[1,0,0]
    v_mov_b32_dpp v112, v104 row_mirror row_mask:0xf bank_mask:0xf
    v_mov_b32_dpp v113, v105 row_mirror row_mask:0xf bank_mask:0xf
    v_mov_b32_dpp v114, v106 row_mirror row_mask:0xf bank_mask:0xf
    v_mov_b32_dpp v115, v107 row_mirror row_mask:0xf bank_mask:0xf
    v_mov_b32_dpp v116, v108 row_mirror row_mask:0xf bank_mask:0xf
    v_mov_b32_dpp v117, v109 row_mirror row_mask:0xf bank_mask:0xf
    v_mov_b32_dpp v118, v110 row_mirror row_mask:0xf bank_mask:0xf
    v_mov_b32_dpp v119, v111 row_mirror row_mask:0xf bank_mask:0xf
    s_cmp_eq_u32 s2, 0
    s_cbranch_scc1 fz_spec4
fz_spec4back:
    v_cvt_pk_bf16_f32 v120, v168, v169
    v_cvt_pk_bf16_f32 v121, v170, v171
    v_cvt_pk_bf16_f32 v122, v172, v173
    v_cvt_pk_bf16_f32 v123, v174, v175
    v_cvt_pk_bf16_f32 v124, v176, v177
    v_cvt_pk_bf16_f32 v125, v178, v179
    v_cvt_pk_bf16_f32 v126, v180, v181
    v_cvt_pk_bf16_f32 v127, v182, v183
    v_and_b32 v112, v238, v112
    v_mfma_f32_16x16x32_bf16 v[136:139], v[120:123], v[120:123], 0
    v_mfma_f32_16x16x32_bf16 v[140:143], v[200:203], v[120:123], 0
    v_mfma_f32_16x16x32_bf16 v[136:139], v[124:127], v[124:127], v[136:139]
    v_mfma_f32_16x16x32_bf16 v[140:143], v[204:207], v[124:127], v[140:143]
    v_fma_mix_f32 v184, v112, s36, v184 op_sel:[0,0,0] op_sel_hi:[1,0,0]
    v_fma_mix_f32 v185, v112, s36, v185 op_sel:[1,0,0] op_sel_hi:[1,0,0]
    v_fma_mix_f32 v186, v113, s36, v186 op_sel:[0,0,0] op_sel_hi:[1,0,0]
    v_fma_mix_f32 v187, v113, s36, v187 op_sel:[1,0,0] op_sel_hi:[1,0,0]
    v_fma_mix_f32 v188, v114, s36, v188 op_sel:[0,0,0] op_sel_hi:[1,0,0]
    v_fma_mix_f32 v189, v114, s36, v189 op_sel:[1,0,0] op_sel_hi:[1,0,0]
    v_fma_mix_f32 v190, v115, s36, v190 op_sel:[0,0,0] op_sel_hi:[1,0,0]
    v_fma_mix_f32 v191, v115, s36, v191 op_sel:[1,0,0] op_sel_hi:[1,0,0]
    v_fma_mix_f32 v192, v116, s36, v192 op_sel:[0,0,0] op_sel_hi:[1,0,0]
    v_fma_mix_f32 v193, v116, s36, v193 op_sel:[1,0,0] op_sel_hi:[1,0,0]
    v_fma_mix_f32 v194, v117, s36, v194 op_sel:[0,0,0] op_sel_hi:[1,0,0]
    v_fma_mix_f32 v195, v117, s36, v195 op_sel:[1,0,0] op_sel_hi:[1,0,0]
    v_fma_mix_f32 v196, v118, s36, v196 op_sel:[0,0,0] op_sel_hi:[1,0,0]
    v_fma_mix_f32 v197, v118, s36, v197 op_sel:[1,0,0] op_sel_hi:[1,0,0]
    v_fma_mix_f32 v198, v119, s36, v198 op_sel:[0,0,0] op_sel_hi:[1,0,0]
    v_fma_mix_f32 v199, v119, s36, v199 op_sel:[1,0,0] op_sel_hi:[1,0,0]
    v_cvt_pk_bf16_f32 v128, v184, v185
    v_cvt_pk_bf16_f32 v129, v186, v187
    v_cvt_pk_bf16_f32 v130, v188, v189
    v_cvt_pk_bf16_f32 v131, v190, v191
    v_cvt_pk_bf16_f32 v132, v192, v193
    v_cvt_pk_bf16_f32 v133, v194, v195
    v_cvt_pk_bf16_f32 v134, v196, v197
    v_cvt_pk_bf16_f32 v135, v198, v199
    v_mfma_f32_16x16x32_bf16 v[136:139], v[128:131], v[128:131], v[136:139]
    v_mfma_f32_16x16x32_bf16 v[140:143], v[208:211], v[128:131], v[140:143]
    v_mfma_f32_16x16x32_bf16 v[136:139], v[132:135], v[132:135], v[136:139]
    v_mfma_f32_16x16x32_bf16 v[140:143], v[212:215], v[132:135], v[140:143]
    s_nop 6
    v_cndmask_b32_e64 v9, v136, v137, s[28:29]
    v_cndmask_b32_e64 v10, v138, v139, s[28:29]
    ds_write_b64 v243, v[140:141]
    v_cndmask_b32_e64 v9, v9, v10, s[30:31]
    ds_write_b32 v244, v9 offset:8
    s_cmp_gt_u32 s3, 3
    s_cbranch_scc1 fz_lp
    s_setprio 2
fz_lp:
    s_waitcnt lgkmcnt(0)
    s_barrier
    ds_read_b128 v[144:147], v245 offset:0
    ds_read_b128 v[148:151], v245 offset:256
    ds_read_b128 v[152:155], v245 offset:512
    ds_read_b128 v[156:159], v245 offset:768
    s_waitcnt lgkmcnt(2)
    v_pk_add_f32 v[144:145], v[144:145], v[148:149]
    v_pk_add_f32 v[146:147], v[146:147], v[150:151]
    s_waitcnt lgkmcnt(0)
    v_pk_add_f32 v[152:153], v[152:153], v[156:157]
    v_pk_add_f32 v[154:155], v[154:155], v[158:159]
    v_pk_add_f32 v[144:145], v[144:145], v[152:153]
    v_pk_add_f32 v[146:147], v[146:147], v[154:155]
    v_mov_b32 v148, v144
    v_mov_b32 v149, v145
    v_mov_b32 v150, v146
    v_mov_b32 v151, v147
    v_permlane32_swap_b32 v144, v148
    v_permlane32_swap_b32 v145, v149
    v_permlane32_swap_b32 v146, v150
    v_permlane32_swap_b32 v147, v151
    v_pk_add_f32 v[144:145], v[144:145], v[148:149]
    v_pk_add_f32 v[146:147], v[146:147], v[150:151]
    v_mul_f32 v145, 0xba800000, v145
    v_mul_f32 v146, 0x3a800000, v146
    v_fma_f32 v146, -v145, v145, v146
    v_cvt_pk_bf16_f32 v153, 0, v145
    v_cvt_pk_bf16_f32 v146, 0, v146
    v_add_f32 v146, 0x3727c5ac, v146
    v_cvt_pk_bf16_f32 v146, 0, v146
    v_sqrt_f32 v146, v146
    v_fmac_f32 v144, v153, v147
    v_cvt_pk_bf16_f32 v146, 0, v146
    v_rcp_f32 v154, v146
    v_mov_b32 v155, s40
    v_mul_f32 v144, v144, v154
    v_cvt_pk_bf16_f32 v144, 0, v144
    v_ashrrev_i32 v145, 31, v144
    v_or_b32 v145, 0x80000000, v145
    v_bitop3_b32 v152, v144, v145, v242 bitop3:0x28
    v_or_b32 v152, v152, v248
    s_nop 1
    v_max_u32_dpp v144, v152, v152 row_ror:1 row_mask:0xf bank_mask:0xf
    s_nop 1
    v_max_u32_dpp v144, v144, v144 row_ror:2 row_mask:0xf bank_mask:0xf
    s_nop 1
    v_max_u32_dpp v144, v144, v144 row_ror:4 row_mask:0xf bank_mask:0xf
    s_nop 1
    v_max_u32_dpp v144, v144, v144 row_ror:8 row_mask:0xf bank_mask:0xf
    v_cmp_eq_u32 vcc, v144, v152
    s_nop 1
    s_mov_b64 exec, vcc
    buffer_store_dwordx4 v[152:155], v246, s[4:7], s26 offen sc1
    buffer_store_dwordx4 v[120:123], v247, s[4:7], s27 offen offset:0 sc1
    buffer_store_dwordx4 v[124:127], v247, s[4:7], s27 offen offset:64 sc1
    buffer_store_dwordx4 v[128:131], v247, s[4:7], s27 offen offset:128 sc1
    buffer_store_dwordx4 v[132:135], v247, s[4:7], s27 offen offset:192 sc1
    s_mov_b64 exec, -1
    s_setprio 0
    buffer_load_dwordx4 v[56:59], v14, s[64:67], s62 offen
    s_add_u32 s62, s62, 8192
    buffer_load_dwordx4 v[60:63], v14, s[64:67], s62 offen
    s_add_u32 s62, s62, 8192
    buffer_load_dwordx4 v[64:67], v14, s[64:67], s62 offen
    s_add_u32 s62, s62, 8192
    buffer_load_dwordx4 v[68:71], v14, s[64:67], s62 offen
    s_add_u32 s62, s62, 8192
    buffer_load_dwordx4 v[72:75], v14, s[64:67], s62 offen
    s_add_u32 s62, s62, 8192
    buffer_load_dwordx4 v[76:79], v14, s[64:67], s62 offen
    s_add_u32 s62, s62, 8192
    buffer_load_dwordx4 v[80:83], v14, s[64:67], s62 offen
    s_add_u32 s62, s62, 8192
    buffer_load_dwordx4 v[84:87], v14, s[64:67], s62 offen
    s_ff1_i32_b64 s37, vcc
    v_add_f32 v144, 1.0, v154
    v_mul_f32 v146, v153, v154
    v_pk_fma_f32 v[168:169], v[168:169], v[144:145], v[146:147] op_sel_hi:[1,0,0]
    v_pk_fma_f32 v[170:171], v[170:171], v[144:145], v[146:147] op_sel_hi:[1,0,0]
    v_pk_fma_f32 v[172:173], v[172:173], v[144:145], v[146:147] op_sel_hi:[1,0,0]
    v_pk_fma_f32 v[174:175], v[174:175], v[144:145], v[146:147] op_sel_hi:[1,0,0]
    v_pk_fma_f32 v[176:177], v[176:177], v[144:145], v[146:147] op_sel_hi:[1,0,0]
    v_pk_fma_f32 v[178:179], v[178:179], v[144:145], v[146:147] op_sel_hi:[1,0,0]
    v_pk_fma_f32 v[180:181], v[180:181], v[144:145], v[146:147] op_sel_hi:[1,0,0]
    v_pk_fma_f32 v[182:183], v[182:183], v[144:145], v[146:147] op_sel_hi:[1,0,0]
    v_pk_fma_f32 v[184:185], v[184:185], v[144:145], v[146:147] op_sel_hi:[1,0,0]
    v_pk_fma_f32 v[186:187], v[186:187], v[144:145], v[146:147] op_sel_hi:[1,0,0]
    v_pk_fma_f32 v[188:189], v[188:189], v[144:145], v[146:147] op_sel_hi:[1,0,0]
    v_pk_fma_f32 v[190:191], v[190:191], v[144:145], v[146:147] op_sel_hi:[1,0,0]
    v_pk_fma_f32 v[192:193], v[192:193], v[144:145], v[146:147] op_sel_hi:[1,0,0]
    v_pk_fma_f32 v[194:195], v[194:195], v[144:145], v[146:147] op_sel_hi:[1,0,0]
    v_pk_fma_f32 v[196:197], v[196:197], v[144:145], v[146:147] op_sel_hi:[1,0,0]
    v_pk_fma_f32 v[198:199], v[198:199], v[144:145], v[146:147] op_sel_hi:[1,0,0]
    v_cvt_pk_bf16_f32 v104, v168, v169
    v_cvt_pk_bf16_f32 v105, v170, v171
    v_cvt_pk_bf16_f32 v106, v172, v173
    v_cvt_pk_bf16_f32 v107, v174, v175
    v_cvt_pk_bf16_f32 v108, v176, v177
    v_cvt_pk_bf16_f32 v109, v178, v179
    v_cvt_pk_bf16_f32 v110, v180, v181
    v_cvt_pk_bf16_f32 v111, v182, v183
    v_cvt_pk_bf16_f32 v112, v184, v185
    v_cvt_pk_bf16_f32 v113, v186, v187
    v_cvt_pk_bf16_f32 v114, v188, v189
    v_cvt_pk_bf16_f32 v115, v190, v191
    v_cvt_pk_bf16_f32 v116, v192, v193
    v_cvt_pk_bf16_f32 v117, v194, v195
    v_cvt_pk_bf16_f32 v118, v196, v197
    v_cvt_pk_bf16_f32 v119, v198, v199
    ds_write_b128 v231, v[104:107]
    ds_write_b128 v231, v[108:111] offset:16
    s_waitcnt lgkmcnt(0)
    s_barrier
    ds_write_b16 v233, v104
    ds_write_b16 v241, v112
    ds_write_b16_d16_hi v232, v112 offset:28
    ds_write_b16 v232, v113 offset:26
    ds_write_b16_d16_hi v232, v113 offset:24
    ds_write_b16 v232, v114 offset:22
    ds_write_b16_d16_hi v232, v114 offset:20
    ds_write_b16 v232, v115 offset:18
    ds_write_b16_d16_hi v232, v115 offset:16
    ds_write_b16 v232, v116 offset:14
    ds_write_b16_d16_hi v232, v116 offset:12
    ds_write_b16 v232, v117 offset:10
    ds_write_b16_d16_hi v232, v117 offset:8
    ds_write_b16 v232, v118 offset:6
    ds_write_b16_d16_hi v232, v118 offset:4
    ds_write_b16 v232, v119 offset:2
    ds_write_b16_d16_hi v232, v119 offset:0
    s_lshl_b32 s32, s3, 1
    s_add_u32 s33, s32, 1
    v_readlane_b32 s34, v230, s32
    v_readlane_b32 s35, v230, s33
    s_mul_i32 s38, s3, 4128
    v_add_u32 v9, s38, v239
    s_lshl_b32 s34, s34, 11
    s_lshl_b32 s35, s35, 11
    s_waitcnt lgkmcnt(0)
    s_barrier
    ds_read_b128 v[104:107], v9 offset:0
    ds_read_b128 v[108:111], v9 offset:1024
    ds_read_b128 v[112:115], v9 offset:2064
    ds_read_b128 v[116:119], v9 offset:3088
    s_waitcnt lgkmcnt(0)
    s_cmp_eq_u32 s37, s32
    s_cbranch_scc1 fz_sk0
    buffer_store_dwordx4 v[104:107], v239, s[12:15], s34 offen offset:0 nt
    buffer_store_dwordx4 v[108:111], v239, s[12:15], s34 offen offset:1024 nt
fz_sk0:
    s_cmp_eq_u32 s37, s33
    s_cbranch_scc1 fz_sk1
    buffer_store_dwordx4 v[112:115], v239, s[12:15], s35 offen offset:0 nt
    buffer_store_dwordx4 v[116:119], v239, s[12:15], s35 offen offset:1024 nt
fz_sk1:
    v_and_b32 v15, 7, v4
    v_mul_u32_u24 v15, 544, v15
    v_lshl_add_u32 v15, v5, 4, v15
    v_add_u32 v15, 108032, v15
    s_mul_i32 s63, s20, 4224
    s_lshl_b32 s38, s3, 9
    s_add_u32 s63, s63, s38
    s_add_u32 s63, s63, 0x490000
    v_mov_b32 v14, 0xffffff00
    s_lshr_b32 s59, s37, 1
    s_xor_b32 s38, s59, 4
    s_cmp_eq_u32 s38, s3
    s_cbranch_scc1 fz_act
    s_cmp_lg_u32 s59, s3
    s_cbranch_scc1 fz_f2
    s_and_b32 s38, s20, 15
    s_add_u32 s38, s38, 16
    s_mul_i32 s38, s38, 2176
    s_add_u32 s38, s38, 0x420000
    s_lshr_b32 s52, s20, 4
    s_lshl_b32 s52, s52, 7
    s_and_b32 s53, s20, 7
    s_lshl_b32 s53, s53, 4
    s_add_u32 s52, s52, s53
    s_bfe_u32 s53, s20, 0x10003
    s_lshl_b32 s53, s53, 2
    s_add_u32 s52, s52, s53
    v_and_b32 v2, 1, v1
    v_lshl_add_u32 v2, v2, 3, v5
    v_add_u32 v2, s52, v2
    v_and_b32 v3, 31, v2
    v_lshrrev_b32 v6, 5, v2
    v_cmp_gt_u32 vcc, 16, v6
    v_cmp_lt_u32 s[52:53], 16, v3
    v_cmp_eq_u32 s[54:55], 0, v3
    s_nop 1
    s_and_b64 s[54:55], s[54:55], vcc
    s_or_b64 s[52:53], s[52:53], s[54:55]
    v_cmp_eq_u32 s[54:55], 16, v3
    s_nop 1
    s_andn2_b64 s[54:55], s[54:55], vcc
    s_or_b64 s[52:53], s[52:53], s[54:55]
    v_sub_u32 v7, 1024, v2
    v_cndmask_b32_e64 v7, v2, v7, s[52:53]
    v_mov_b32 v8, 512
    v_cmp_eq_u32 vcc, 1024, v7
    s_nop 1
    v_cndmask_b32_e64 v7, v7, v8, vcc
    v_lshrrev_b32 v8, 5, v7
    v_and_b32 v7, 15, v7
    v_lshrrev_b32 v9, 2, v8
    v_lshlrev_b32 v9, 8, v9
    v_and_b32 v8, 3, v8
    v_lshl_add_u32 v9, v8, 4, v9
    v_lshrrev_b32 v8, 3, v7
    v_lshl_add_u32 v9, v8, 6, v9
    v_and_b32 v7, 7, v7
    v_lshl_add_u32 v9, v7, 1, v9
    v_cndmask_b32_e64 v7, 0, 1, s[52:53]
    v_lshl_add_u32 v9, v7, 7, v9
    v_lshlrev_b32 v2, 1, v2
    v_lshrrev_b32 v3, 1, v1
    v_mul_u32_u24 v3, 4224, v3
    v_and_b32 v6, 1, v1
    v_lshl_add_u32 v3, v6, 4, v3
    v_mov_b32 v6, 0x7fffffff
    v_cmp_gt_u32 vcc, 32, v1
    s_nop 1
    v_cndmask_b32_e64 v6, v6, v3, vcc
    v_mov_b32 v7, s48
    v_cndmask_b32_e64 v16, 0, v7, vcc
    v_mov_b32 v7, s49
    v_cndmask_b32_e64 v17, 0, v7, vcc
    v_mov_b32 v7, s50
    v_cndmask_b32_e64 v18, 0, v7, vcc
    v_mov_b32 v7, s51
    v_cndmask_b32_e64 v19, 0, v7, vcc
    s_lshl_b32 s52, s20, 5
    s_add_u32 s52, s52, 0x490000
    s_add_u32 s53, s52, 135168
    s_add_u32 s54, s52, 270336
    s_add_u32 s55, s52, 405504
    s_mov_b32 s58, 0
    s_nop 0
fz_k2:
    buffer_load_dwordx4 v[24:27], v239, s[4:7], s38 offen sc1
    buffer_load_dwordx4 v[28:31], v239, s[4:7], s38 offen offset:1024 sc1
    s_waitcnt vmcnt(0)
    v_xor_b32 v32, s40, v27
    v_xor_b32 v33, s40, v31
    v_max_u32 v34, v24, v28
    v_or_b32 v32, v32, v33
    v_cmp_ne_u32 vcc, 0, v32
    s_cbranch_vccnz fz_k2_rt
fz_k2_ok:
    v_max_u32_dpp v34, v34, v34 quad_perm:[1,0,3,2] row_mask:0xf bank_mask:0xf
    s_nop 1
    v_max_u32_dpp v34, v34, v34 quad_perm:[2,3,0,1] row_mask:0xf bank_mask:0xf
    s_nop 1
    v_max_u32_dpp v34, v34, v34 row_half_mirror row_mask:0xf bank_mask:0xf
    s_nop 1
    v_max_u32_dpp v34, v34, v34 row_mirror row_mask:0xf bank_mask:0xf
    s_nop 1
    v_max_u32_dpp v34, v34, v34 row_bcast:15 row_mask:0xa bank_mask:0xf
    s_nop 1
    v_max_u32_dpp v34, v34, v34 row_bcast:31 row_mask:0xc bank_mask:0xf
    s_nop 0
    v_readlane_b32 s36, v34, 63
    s_nop 1
    v_cmp_eq_u32 vcc, s36, v24
    v_cmp_eq_u32 s[56:57], s36, v28
    s_nop 1
    v_cndmask_b32_e64 v25, v25, v29, s[56:57]
    v_cndmask_b32_e64 v26, v26, v30, s[56:57]
    s_cmp_lg_u64 vcc, 0
    s_cselect_b32 s39, 0, 64
    s_or_b64 vcc, vcc, s[56:57]
    s_ff1_i32_b64 s41, vcc
    v_readlane_b32 s42, v25, s41
    v_readlane_b32 s43, v26, s41
    s_add_u32 s39, s39, s41
    s_cmp_eq_u32 s39, s20
    s_cbranch_scc1 fz_win
    s_bitcmp1_b32 s37, 0
    s_cbranch_scc1 fz_d1
    buffer_store_dwordx4 v[104:107], v239, s[12:15], s34 offen offset:0 nt
    buffer_store_dwordx4 v[108:111], v239, s[12:15], s34 offen offset:1024 nt
    s_branch fz_win
fz_d1:
    buffer_store_dwordx4 v[112:115], v239, s[12:15], s35 offen offset:0 nt
    buffer_store_dwordx4 v[116:119], v239, s[12:15], s35 offen offset:1024 nt
fz_win:
    s_lshl_b32 s39, s39, 11
    s_add_u32 s39, s39, 0x440000
    s_mov_b32 s58, 0
    s_mov_b32 s41, 0xffff0000
    s_nop 0
fz_c2:
    buffer_load_short_d16_hi v10, v9, s[4:7], s39 offen sc1
    s_waitcnt vmcnt(0)
    v_cmp_eq_u32 vcc, s41, v10
    s_cbranch_vccnz fz_c2_rt
fz_c2_ok:
    v_add_f32 v11, s42, v10
    v_cvt_pk_bf16_f32 v11, 0, v11
    v_mul_f32 v11, s43, v11
    v_cvt_pk_bf16_f32 v11, 0, v11
    s_ashr_i32 s39, s36, 31
    s_not_b32 s39, s39
    s_or_b32 s39, s39, 0x80000000
    s_xor_b32 s39, s36, s39
    s_and_b32 s39, s39, 0xffff0000
    v_mov_b32 v12, s39
    v_mul_f32 v12, 0xbfb8aa3b, v12
    v_exp_f32 v12, v12
    s_nop 0
    v_add_f32 v12, 1.0, v12
    v_rcp_f32 v12, v12
    s_nop 0
    v_cvt_pk_bf16_f32 v12, 0, v12
    s_and_b32 s39, s36, 0xffff
    s_sub_u32 s39, 2047, s39
    s_lshl_b32 s39, s39, 11
fz_f2:
    s_cmp_gt_u32 s20, 111
    s_cbranch_scc1 fz_nof2
    s_barrier
    ds_read_b128 v[120:123], v15 offset:0
    ds_read_b128 v[124:127], v15 offset:64
    ds_read_b128 v[128:131], v15 offset:128
    ds_read_b128 v[132:135], v15 offset:192
    ds_read_b128 v[136:139], v15 offset:256
    ds_read_b128 v[140:143], v15 offset:320
    ds_read_b128 v[144:147], v15 offset:384
    ds_read_b128 v[148:151], v15 offset:448
    s_waitcnt vmcnt(0)
    s_waitcnt lgkmcnt(7)
    v_mfma_f32_16x16x32_bf16 v[152:155], v[120:123], v[56:59], 0
    s_waitcnt lgkmcnt(6)
    v_mfma_f32_16x16x32_bf16 v[152:155], v[124:127], v[60:63], v[152:155]
    s_waitcnt lgkmcnt(5)
    v_mfma_f32_16x16x32_bf16 v[152:155], v[128:131], v[64:67], v[152:155]
    s_waitcnt lgkmcnt(4)
    v_mfma_f32_16x16x32_bf16 v[152:155], v[132:135], v[68:71], v[152:155]
    s_waitcnt lgkmcnt(3)
    v_mfma_f32_16x16x32_bf16 v[152:155], v[136:139], v[72:75], v[152:155]
    s_waitcnt lgkmcnt(2)
    v_mfma_f32_16x16x32_bf16 v[152:155], v[140:143], v[76:79], v[152:155]
    s_waitcnt lgkmcnt(1)
    v_mfma_f32_16x16x32_bf16 v[152:155], v[144:147], v[80:83], v[152:155]
    s_waitcnt lgkmcnt(0)
    v_mfma_f32_16x16x32_bf16 v[152:155], v[148:151], v[84:87], v[152:155]
    s_mov_b32 exec_hi, 0
    s_nop 6
    v_and_or_b32 v152, v152, v14, s48
    v_and_or_b32 v153, v153, v14, s49
    v_and_or_b32 v154, v154, v14, s50
    v_and_or_b32 v155, v155, v14, s51
    buffer_store_dwordx4 v[152:155], v239, s[4:7], s63 offen sc1
    s_mov_b32 exec_hi, -1
    s_cmp_lg_u32 s59, s3
    s_cbranch_scc1 fz_xend
    v_mov_b32 v7, 0
    s_waitcnt vmcnt(0)
    s_branch fz_p5_ok
    s_nop 2
fz_nof2:
    s_cmp_lg_u32 s59, s3
    s_cbranch_scc1 fz_xend
    s_mov_b32 s58, 0
    s_and_b32 s41, s20, 63
    s_mul_i32 s41, s41, 4224
    s_add_u32 s41, s41, s52
    v_mov_b32 v7, 0
    s_nop 4
fz_p5:
    buffer_load_dword v8, v7, s[4:7], s41 offen sc1
    s_waitcnt vmcnt(0)
    v_and_b32 v8, 0xff, v8
    v_cmp_ne_u32 vcc, s48, v8
    s_cbranch_vccnz fz_p5_rt
fz_p5_ok:
    s_mov_b32 s58, 0
    s_nop 2
fz_h5:
    buffer_load_dwordx4 v[40:43], v3, s[4:7], s52 offen sc1
    buffer_load_dwordx4 v[44:47], v3, s[4:7], s53 offen sc1
    buffer_load_dwordx4 v[48:51], v3, s[4:7], s54 offen sc1
    buffer_load_dwordx4 v[52:55], v6, s[4:7], s55 offen sc1
    s_waitcnt vmcnt(3)
    v_xor_b32 v40, s48, v40
    v_xor_b32 v41, s49, v41
    v_xor_b32 v42, s50, v42
    v_xor_b32 v43, s51, v43
    v_or3_b32 v8, v40, v41, 0
    v_or3_b32 v8, v42, v43, v8
    s_waitcnt vmcnt(2)
    v_xor_b32 v44, s48, v44
    v_xor_b32 v45, s49, v45
    v_xor_b32 v46, s50, v46
    v_xor_b32 v47, s51, v47
    v_or3_b32 v8, v44, v45, v8
    v_or3_b32 v8, v46, v47, v8
    s_waitcnt vmcnt(1)
    v_xor_b32 v48, s48, v48
    v_xor_b32 v49, s49, v49
    v_xor_b32 v50, s50, v50
    v_xor_b32 v51, s51, v51
    v_or3_b32 v8, v48, v49, v8
    v_or3_b32 v8, v50, v51, v8
    s_waitcnt vmcnt(0)
    v_xor_b32 v52, v16, v52
    v_xor_b32 v53, v17, v53
    v_xor_b32 v54, v18, v54
    v_xor_b32 v55, v19, v55
    v_or3_b32 v8, v52, v53, v8
    v_or3_b32 v8, v54, v55, v8
    v_and_b32 v8, 0xff, v8
    v_cmp_ne_u32 vcc, 0, v8
    s_cbranch_vccnz fz_h5_rt
fz_h5_ok:
    v_pk_add_f32 v[40:41], v[40:41], v[44:45]
    v_pk_add_f32 v[42:43], v[42:43], v[46:47]
    v_pk_add_f32 v[48:49], v[48:49], v[52:53]
    v_pk_add_f32 v[50:51], v[50:51], v[54:55]
    v_pk_add_f32 v[40:41], v[40:41], v[48:49]
    v_pk_add_f32 v[42:43], v[42:43], v[50:51]
    s_nop 1
    v_permlane32_swap_b32 v40, v42
    v_permlane32_swap_b32 v41, v43
    v_pk_add_f32 v[40:41], v[40:41], v[42:43]
    s_nop 1
    v_permlane16_swap_b32 v40, v41
    v_add_f32 v40, v40, v41
    s_nop 1
    v_add_f32_dpp v40, v40, v40 quad_perm:[2,3,0,1] row_mask:0xf bank_mask:0xf
    s_nop 1
    v_add_f32_dpp v40, v40, v40 row_ror:4 row_mask:0xf bank_mask:0xf
    s_nop 1
    v_add_f32_dpp v40, v40, v40 row_ror:8 row_mask:0xf bank_mask:0xf
    v_cvt_pk_bf16_f32 v40, 0, v40
    v_mul_f32 v40, v40, v12
    v_cvt_pk_bf16_f32 v40, 0, v40
    v_add_f32 v40, v40, v11
    v_cvt_pk_bf16_f32 v40, 0, v40
    v_add_f32 v40, v40, v10
    v_cvt_pk_bf16_f32 v40, 0, v40
    s_mov_b32 exec_lo, 0x00030003
    s_mov_b32 exec_hi, 0x00030003
    buffer_store_short_d16_hi v40, v2, s[12:15], s39 offen
    s_cmp_lg_u32 s20, 0
    s_cbranch_scc1 fz_xend
    s_mov_b64 exec, 1
    v_mov_b32 v8, s40
    buffer_store_dword v8, v7, s[4:7], 0 offen
fz_xend:
fz_end:
    s_endpgm
fz_act:
    s_cmp_gt_u32 s20, 111
    s_cbranch_scc1 fz_xend
    v_lshlrev_b32 v2, 2, v1
    v_and_b32 v11, 3, v1
    v_mov_b32 v3, s48
    v_cmp_eq_u32 vcc, 1, v11
    v_mov_b32 v10, s49
    s_nop 0
    v_cndmask_b32_e64 v3, v3, v10, vcc
    v_cmp_eq_u32 vcc, 2, v11
    v_mov_b32 v10, s50
    s_nop 0
    v_cndmask_b32_e64 v3, v3, v10, vcc
    v_cmp_eq_u32 vcc, 3, v11
    v_mov_b32 v10, s51
    s_nop 0
    v_cndmask_b32_e64 v3, v3, v10, vcc
    v_and_b32 v10, 31, v1
    v_lshlrev_b32 v6, 4, v10
    v_lshrrev_b32 v10, 5, v1
    v_mul_u32_u24 v10, 2184, v10
    v_add_u32 v6, v6, v10
    v_add_u32 v6, 108032, v6
    s_lshl_b32 s38, s20, 9
    s_add_u32 s38, s38, 0x481000
    s_mov_b32 s58, 0
fz_h4:
    buffer_load_dword v8, v2, s[4:7], s38 offen sc1
    buffer_load_dword v9, v2, s[4:7], s38 offen offset:256 sc1
    s_waitcnt vmcnt(0)
    v_xor_b32 v8, v3, v8
    v_xor_b32 v9, v3, v9
    v_or_b32 v10, v8, v9
    v_add_f32 v8, v8, v9
    v_and_b32 v10, 0xff, v10
    v_cmp_ne_u32 vcc, 0, v10
    s_cbranch_vccnz fz_h4_rt
fz_h4_ok:
    v_cvt_pk_bf16_f32 v8, 0, v8
    v_mov_b32 v9, v8
    s_nop 1
    v_permlane32_swap_b32 v8, v9
    v_mul_f32 v10, 0xbfb8aa3b, v8
    v_exp_f32 v10, v10
    s_nop 0
    v_add_f32 v10, 1.0, v10
    v_rcp_f32 v10, v10
    s_nop 0
    v_mul_f32 v8, v8, v10
    v_cvt_pk_bf16_f32 v8, 0, v8
    v_mul_f32 v8, v8, v9
    v_cvt_pk_bf16_f32 v8, 0, v8
    ds_write_b16_d16_hi v6, v8 offset:0
    ds_write_b16_d16_hi v6, v8 offset:546
    ds_write_b16_d16_hi v6, v8 offset:1092
    ds_write_b16_d16_hi v6, v8 offset:1638
    s_waitcnt lgkmcnt(0)
    s_branch fz_f2
fz_ldh:
    s_load_dwordx2 s[12:13], s[0:1], 56
    s_load_dwordx2 s[16:17], s[0:1], 64
    s_mov_b32 s14, 0x700000
    s_mov_b32 s15, 0x00020000
    s_mov_b32 s18, 0x700000
    s_mov_b32 s19, 0x00020000
    s_branch fz_ldback
fz_spec:
    s_cmp_gt_u32 s3, 3
    s_cbranch_scc1 fz_spec_hi
    s_cmp_eq_u32 s3, 0
    s_cselect_b32 s31, 0, s31
    s_cselect_b32 s30, 33024, s30
    s_cmp_eq_u32 s3, 2
    s_cselect_b32 s31, 30960, s31
    s_cselect_b32 s30, 35088, s30
    s_cmp_eq_u32 s3, 3
    s_cselect_b32 s31, 37152, s31
    s_cselect_b32 s30, 39216, s30
    s_branch fz_specback
fz_spec_hi:
    s_mov_b32 m0, s31
    s_nop 0
    buffer_load_dwordx4 v239, s[8:11], s27 offen lds
    buffer_load_dwordx4 v239, s[8:11], s27 offen offset:1024 lds
    s_mov_b32 m0, s30
    s_nop 0
    buffer_load_dwordx4 v239, s[8:11], s28 offen lds
    buffer_load_dwordx4 v239, s[8:11], s28 offen offset:1024 lds
    v_lshlrev_b32 v14, 3, v0
    v_mov_b32 v10, -1
    v_mov_b32 v11, -1
    s_lshl_b32 s32, s20, 11
    s_add_u32 s32, s32, 0x43f800
    s_mov_b32 s18, 0x800
    s_mov_b32 s19, 0x00020000
    s_lshl_b32 s33, s24, 10
    s_min_u32 s34, s33, 2048
    s_add_u32 s34, s34, 104960
    s_mov_b32 m0, s34
    buffer_store_dwordx2 v[10:11], v14, s[4:7], s32 offen sc1
    buffer_load_dwordx4 v239, s[16:19], s33 offen lds
    s_cmp_eq_u32 s24, 0
    s_cselect_b32 s31, 8256, s31
    s_cselect_b32 s30, 22704, s30
    s_cselect_b32 s27, 524288, s27
    s_cselect_b32 s28, 3670016, s28
    s_cmp_eq_u32 s24, 1
    s_cselect_b32 s31, 12384, s31
    s_cselect_b32 s30, 18576, s30
    s_cselect_b32 s27, 1572864, s27
    s_cselect_b32 s28, 2621440, s28
    s_cmp_eq_u32 s24, 2
    s_cselect_b32 s31, 41280, s31
    s_cselect_b32 s30, 43344, s30
    s_cselect_b32 s27, 1572864, s27
    s_cselect_b32 s28, 2621440, s28
    s_cmp_eq_u32 s24, 3
    s_cselect_b32 s31, 45408, s31
    s_cselect_b32 s30, 47472, s30
    s_cselect_b32 s27, 524288, s27
    s_cselect_b32 s28, 3670016, s28
    s_mov_b32 s57, 0
    s_branch fz_specback
fz_spec4:
    s_mov_b32 s38, 0x80018001
    s_mov_b32 s39, 0x80018001
    v_cndmask_b32_e64 v112, v112, v104, s[38:39]
    v_cndmask_b32_e64 v113, v113, v105, s[38:39]
    v_cndmask_b32_e64 v114, v114, v106, s[38:39]
    v_cndmask_b32_e64 v115, v115, v107, s[38:39]
    v_cndmask_b32_e64 v116, v116, v108, s[38:39]
    v_cndmask_b32_e64 v117, v117, v109, s[38:39]
    v_cndmask_b32_e64 v118, v118, v110, s[38:39]
    v_cndmask_b32_e64 v119, v119, v111, s[38:39]
    s_branch fz_spec4back
    s_nop 3
fz_nc1:
    s_cmp_lg_u32 s59, 0
    s_cbranch_scc1 ffn_early
    s_mov_b32 m0, s31
    s_nop 0
    buffer_load_dwordx4 v239, s[8:11], s27 offen lds
    buffer_load_dwordx4 v239, s[8:11], s27 offen offset:1024 lds
    s_mov_b32 m0, s30
    s_nop 0
    buffer_load_dwordx4 v239, s[8:11], s28 offen lds
    buffer_load_dwordx4 v239, s[8:11], s28 offen offset:1024 lds
    v_lshlrev_b32 v14, 3, v0
    v_mov_b32 v10, -1
    v_mov_b32 v11, -1
    s_lshl_b32 s32, s20, 11
    s_add_u32 s32, s32, 0x43f800
    s_mov_b32 s18, 0x800
    s_mov_b32 s19, 0x00020000
    s_lshl_b32 s33, s24, 10
    s_min_u32 s34, s33, 2048
    s_add_u32 s34, s34, 104960
    s_mov_b32 m0, s34
    buffer_store_dwordx2 v[10:11], v14, s[4:7], s32 offen sc1
    buffer_load_dwordx4 v239, s[16:19], s33 offen lds
    ds_read_b128 v[72:75], v6 offset:14336
    ds_read_b128 v[76:79], v6 offset:15360
    ds_read_b128 v[80:83], v6 offset:16384
    ds_read_b128 v[84:87], v6 offset:17408
    s_and_b32 s32, s3, 3
    s_lshr_b32 s33, s3, 2
    s_lshl_b32 s33, s33, 4
    s_add_u32 s33, s33, s32
    v_and_b32 v8, 12, v4
    v_bfe_u32 v9, v4, 1, 1
    v_lshl_add_u32 v8, v9, 5, v8
    v_add_u32 v8, s33, v8
    v_cvt_f32_u32 v8, v8
    v_and_b32 v12, 1, v1
    v_cvt_f32_u32 v9, v12
    v_lshlrev_b32 v13, 2, v5
    v_cvt_f32_u32 v10, v13
    v_mul_f32 v11, 0x3c800000, v8
    v_mul_f32 v9, 0x3e800000, v9
    v_fma_f32 v9, v11, v10, v9
    v_mov_b32 v128, v9
    v_fmamk_f32 v129, v11, 0x3f800000, v9
    v_fmamk_f32 v130, v11, 0x40000000, v9
    v_fmamk_f32 v131, v11, 0x40400000, v9
    v_mul_f32 v11, 0x3a000000, v8
    v_lshlrev_b32 v9, 31, v1
    v_xor_b32 v11, v9, v11
    v_mul_f32 v9, v11, v10
    v_mov_b32 v112, v9
    v_fmamk_f32 v113, v11, 0x3f800000, v9
    v_fmamk_f32 v114, v11, 0x40000000, v9
    v_fmamk_f32 v115, v11, 0x40400000, v9
    v_fmamk_f32 v116, v11, 0x41800000, v9
    v_fmamk_f32 v117, v11, 0x41880000, v9
    v_fmamk_f32 v118, v11, 0x41900000, v9
    v_fmamk_f32 v119, v11, 0x41980000, v9
    v_cos_f32 v104, v128
    v_sin_f32 v105, v128
    v_cos_f32 v106, v129
    v_sin_f32 v107, v129
    v_cos_f32 v108, v130
    v_sin_f32 v109, v130
    v_cos_f32 v110, v131
    v_sin_f32 v111, v131
    v_sin_f32 v120, v112
    v_sin_f32 v121, v113
    v_sin_f32 v122, v114
    v_sin_f32 v123, v115
    v_sin_f32 v124, v116
    v_sin_f32 v125, v117
    v_sin_f32 v126, v118
    v_sin_f32 v127, v119
    v_cos_f32 v112, v112
    v_cos_f32 v113, v113
    v_cos_f32 v114, v114
    v_cos_f32 v115, v115
    v_cos_f32 v116, v116
    v_cos_f32 v117, v117
    v_cos_f32 v118, v118
    v_cos_f32 v119, v119
    v_cvt_pk_f16_f32 v16, v104, v105
    v_cvt_pk_f16_f32 v17, v106, v107
    v_cvt_pk_f16_f32 v18, v108, v109
    v_cvt_pk_f16_f32 v19, v110, v111
    v_cvt_pk_f16_f32 v20, v112, v113
    v_cvt_pk_f16_f32 v21, v114, v115
    v_cvt_pk_f16_f32 v22, v116, v117
    v_cvt_pk_f16_f32 v23, v118, v119
    v_cvt_pk_f16_f32 v24, v120, v121
    v_cvt_pk_f16_f32 v25, v122, v123
    v_cvt_pk_f16_f32 v26, v124, v125
    v_cvt_pk_f16_f32 v27, v126, v127
    v_lshrrev_b32 v8, 3, v1
    v_mul_u32_u24 v222, 16512, v8
    v_and_b32 v9, 7, v1
    v_lshl_add_u32 v222, v9, 4, v222
    s_mul_i32 s60, s3, 264192
    s_lshl_b32 s32, s20, 7
    s_add_u32 s60, s60, s32
    s_add_u32 s60, s60, 0x1000
    s_add_u32 s61, s60, 132096
    v_lshlrev_b32 v8, 1, v8
    v_bfe_u32 v9, v1, 2, 1
    v_add_u32 v8, v8, v9
    s_lshl_b32 s32, s3, 1
    s_add_u32 s32, s32, 1
    v_lshl_add_u32 v8, v8, 5, s32
    v_cmp_eq_u32 vcc, 1, v12
    v_bfe_u32 v9, v1, 1, 1
    v_mul_u32_u24 v9, 8256, v9
    v_add_u32 v9, 86400, v9
    s_cmp_eq_u32 s3, 7
    s_cselect_b32 s32, 272, 0
    v_sub_u32 v10, 512, v8
    v_cndmask_b32_e64 v10, v8, v10, vcc
    v_and_b32 v11, 16, v10
    v_lshl_add_u32 v11, v11, 6, v9
    v_lshrrev_b32 v12, 7, v10
    v_lshl_add_u32 v11, v12, 8, v11
    v_and_b32 v12, 15, v10
    v_lshl_add_u32 v11, v12, 4, v11
    v_bfe_u32 v12, v10, 5, 2
    v_lshl_add_u32 v223, v12, 2, v11
    v_mul_u32_u24 v10, s32, v3
    v_sub_u32 v8, v8, v10
    v_add_u32 v8, 1, v8
    v_sub_u32 v10, 512, v8
    v_cndmask_b32_e64 v10, v8, v10, vcc
    v_lshrrev_b32 v11, 1, v10
    v_and_b32 v11, 256, v11
    v_sub_u32 v10, v10, v11
    v_and_b32 v11, 16, v10
    v_lshl_add_u32 v11, v11, 6, v9
    v_lshrrev_b32 v12, 7, v10
    v_lshl_add_u32 v11, v12, 8, v11
    v_and_b32 v12, 15, v10
    v_lshl_add_u32 v11, v12, 4, v11
    v_bfe_u32 v12, v10, 5, 2
    v_lshl_add_u32 v224, v12, 2, v11
    s_and_b32 s32, s3, 3
    s_lshl_b32 s32, s32, 11
    s_add_u32 s32, s32, 86400
    v_add_u32 v225, s32, v239
    v_add_u32 v8, s33, v13
    v_sub_u32 v9, 32, v8
    v_min_u32 v9, v8, v9
    v_and_b32 v10, 15, v8
    v_cmp_eq_u32 s[32:33], 0, v10
    v_cmp_lt_u32 s[34:35], 16, v8
    v_lshlrev_b32 v10, 10, v9
    v_subrev_u32 v10, 1024, v10
    v_mov_b32 v11, 15872
    v_cmp_eq_u32 vcc, 0, v8
    s_nop 1
    v_cndmask_b32_e64 v10, v10, v11, vcc
    v_and_b32 v11, 3, v1
    v_lshl_add_u32 v10, v11, 4, v10
    v_lshrrev_b32 v11, 2, v4
    v_lshlrev_b32 v12, 7, v11
    v_sub_u32 v13, 960, v12
    v_cndmask_b32_e64 v13, v12, v13, s[34:35]
    v_add_u32 v226, v10, v13
    s_or_b64 s[34:35], s[34:35], s[32:33]
    v_add_u32 v12, 512, v12
    v_sub_u32 v13, 960, v12
    v_cndmask_b32_e64 v13, v12, v13, s[34:35]
    v_add_u32 v227, v10, v13
    s_mul_i32 s56, s20, 16512
    s_add_u32 s56, s56, 0x210000
    v_mov_b32 v249, 0x30003
    v_mov_b32 v252, s44
    v_mov_b32 v253, s45
    v_mov_b32 v254, s46
    v_mov_b32 v255, s47
    s_waitcnt lgkmcnt(0)
    s_waitcnt vmcnt(0)
    s_branch fz_b1
    s_nop 1
fz_nc2:
    v_sub_u32 v8, 15, v4
    v_min_u32 v8, v4, v8
    v_and_b32 v9, 1, v8
    v_lshlrev_b32 v9, 5, v9
    v_lshrrev_b32 v10, 1, v8
    v_lshl_add_u32 v9, v10, 9, v9
    v_add_u32 v9, s25, v9
    v_sub_u32 v10, 2048, v9
    v_cmp_lt_u32 s[34:35], 7, v4
    s_nop 1
    v_cndmask_b32_e64 v230, v9, v10, s[34:35]
    v_mov_b32 v9, v4
    v_mov_b32 v10, s20
    s_cmp_lg_u32 s21, 0
    s_cbranch_scc0 fz_spec3b
fz_spec3backb:
    v_lshlrev_b32 v10, 7, v10
    v_lshl_add_u32 v10, v9, 3, v10
    v_mul_u32_u24 v11, 66048, v5
    v_add_u32 v228, v10, v11
    v_and_b32 v9, 1, v9
    v_cmp_eq_u32 vcc, 1, v9
    v_mov_b32 v9, s44
    v_mov_b32 v10, s46
    v_cndmask_b32_e64 v236, v9, v10, vcc
    v_mov_b32 v9, s45
    v_mov_b32 v10, s47
    v_cndmask_b32_e64 v237, v9, v10, vcc
    s_lshl_b32 s32, s3, 2
    v_add_u32 v8, s32, v5
    v_lshlrev_b32 v9, 6, v8
    v_cmp_gt_u32 vcc, 16, v8
    s_nop 1
    v_cndmask_b32_e64 v10, 0, 32, vcc
    v_add_u32 v10, v9, v10
    v_sub_u32 v11, 2048, v10
    v_cmp_eq_u32 vcc, 16, v8
    s_nop 1
    v_cndmask_b32_e64 v11, v11, 0, vcc
    v_mov_b32 v12, 0xffff0000
    v_cndmask_b32_e64 v238, -1, v12, vcc
    v_sub_u32 v12, 2018, v9
    v_mul_u32_u24 v13, 2064, v4
    v_add_u32 v231, v13, v9
    v_add_u32 v232, v13, v12
    v_add_u32 v233, v13, v10
    v_add_u32 v241, v13, v11
    s_lshl_b32 s32, s3, 8
    s_add_u32 s32, s32, 102912
    v_lshlrev_b32 v9, 4, v4
    v_add_u32 v10, s32, v9
    v_add_u32 v11, 107008, v239
    v_cmp_gt_u32 vcc, 16, v1
    s_nop 1
    v_cndmask_b32_e64 v243, v11, v10, vcc
    v_lshrrev_b32 v12, 2, v4
    v_cmp_eq_u32 vcc, v12, v5
    s_nop 1
    v_cndmask_b32_e64 v244, v11, v10, vcc
    v_lshrrev_b32 v12, 5, v1
    v_lshl_add_u32 v10, v12, 10, v9
    v_add_u32 v245, 102912, v10
    v_and_b32 v9, 1, v1
    v_cmp_eq_u32 s[28:29], 1, v9
    v_and_b32 v9, 2, v1
    v_cmp_eq_u32 s[30:31], 2, v9
    s_lshl_b32 s37, s3, 2
    v_add_u32 v9, s37, v5
    v_mul_u32_u24 v246, 2176, v9
    s_lshl_b32 s26, s20, 4
    s_add_u32 s26, s26, 0x420000
    v_lshlrev_b32 v247, 4, v5
    s_lshl_b32 s27, s20, 11
    s_lshl_b32 s37, s3, 8
    s_add_u32 s27, s27, s37
    s_add_u32 s27, s27, 0x440000
    v_sub_u32 v248, 2047, v230
    s_mov_b32 s14, 0x400000
    s_mov_b32 s15, 0x00020000
    s_mov_b32 s66, 0x700000
    s_mov_b32 s67, 0x00020000
    v_lshlrev_b32 v10, 4, v0
    v_min_u32 v10, 4336, v10
    v_add_u32 v10, 108032, v10
    v_mov_b32 v104, 0
    v_mov_b32 v105, 0
    v_mov_b32 v106, 0
    v_mov_b32 v107, 0
    ds_write_b128 v10, v[104:107]
    v_lshlrev_b32 v10, 4, v4
    v_lshl_add_u32 v14, v5, 11, v10
    s_lshl_b32 s62, s20, 16
    s_lshl_b32 s37, s3, 8
    s_add_u32 s62, s62, s37
    ds_read_b128 v[104:107], v231
    ds_read_b128 v[108:111], v231 offset:16
    ds_read_u16_d16_hi v184, v241
    ds_read_u16_d16_hi v185, v232 offset:28
    ds_read_u16_d16_hi v186, v232 offset:26
    ds_read_u16_d16_hi v187, v232 offset:24
    ds_read_u16_d16_hi v188, v232 offset:22
    ds_read_u16_d16_hi v189, v232 offset:20
    ds_read_u16_d16_hi v190, v232 offset:18
    ds_read_u16_d16_hi v191, v232 offset:16
    ds_read_u16_d16_hi v192, v232 offset:14
    ds_read_u16_d16_hi v193, v232 offset:12
    ds_read_u16_d16_hi v194, v232 offset:10
    ds_read_u16_d16_hi v195, v232 offset:8
    ds_read_u16_d16_hi v196, v232 offset:6
    ds_read_u16_d16_hi v197, v232 offset:4
    ds_read_u16_d16_hi v198, v232 offset:2
    ds_read_u16_d16_hi v199, v232 offset:0
    ds_read_u16_d16_hi v168, v233
    v_mul_u32_u24 v13, 2064, v4
    v_subrev_u32 v13, 104960, v13
    v_sub_u32 v9, v231, v13
    v_sub_u32 v10, v233, v13
    v_sub_u32 v11, v241, v13
    v_sub_u32 v12, v232, v13
    s_mov_b32 s36, 0xffff0000
    s_waitcnt lgkmcnt(0)
    ds_read_b128 v[200:203], v9
    ds_read_b128 v[204:207], v9 offset:16
    ds_read_u16_d16 v208, v11
    ds_read_u16_d16_hi v112, v12 offset:28
    ds_read_u16_d16 v209, v12 offset:26
    ds_read_u16_d16_hi v113, v12 offset:24
    ds_read_u16_d16 v210, v12 offset:22
    ds_read_u16_d16_hi v114, v12 offset:20
    ds_read_u16_d16 v211, v12 offset:18
    ds_read_u16_d16_hi v115, v12 offset:16
    ds_read_u16_d16 v212, v12 offset:14
    ds_read_u16_d16_hi v116, v12 offset:12
    ds_read_u16_d16 v213, v12 offset:10
    ds_read_u16_d16_hi v117, v12 offset:8
    ds_read_u16_d16 v214, v12 offset:6
    ds_read_u16_d16_hi v118, v12 offset:4
    ds_read_u16_d16 v215, v12 offset:2
    ds_read_u16_d16_hi v119, v12 offset:0
    ds_read_u16_d16 v13, v10
    v_and_b32 v169, s36, v104
    v_lshlrev_b32 v170, 16, v105
    v_and_b32 v171, s36, v105
    v_lshlrev_b32 v172, 16, v106
    v_and_b32 v173, s36, v106
    v_lshlrev_b32 v174, 16, v107
    v_and_b32 v175, s36, v107
    v_lshlrev_b32 v176, 16, v108
    v_and_b32 v177, s36, v108
    v_lshlrev_b32 v178, 16, v109
    v_and_b32 v179, s36, v109
    v_lshlrev_b32 v180, 16, v110
    v_and_b32 v181, s36, v110
    v_lshlrev_b32 v182, 16, v111
    v_and_b32 v183, s36, v111
    v_cmp_eq_u32 vcc, 1, v4
    v_mov_b32 v9, s42
    s_nop 0
    v_cndmask_b32_e64 v9, 0, v9, vcc
    v_mov_b32 v104, s42
    v_mov_b32 v105, s42
    v_mov_b32 v106, s42
    v_mov_b32 v107, s42
    v_cmp_eq_u32 vcc, 0, v4
    s_waitcnt lgkmcnt(0)
    v_and_or_b32 v200, v200, s36, v13
    v_or_b32 v208, v208, v112
    v_or_b32 v209, v209, v113
    v_or_b32 v210, v210, v114
    v_or_b32 v211, v211, v115
    v_or_b32 v212, v212, v116
    v_or_b32 v213, v213, v117
    v_or_b32 v214, v214, v118
    v_or_b32 v215, v215, v119
    v_cndmask_b32_e64 v200, v9, v200, vcc
    v_cndmask_b32_e64 v201, v9, v201, vcc
    v_cndmask_b32_e64 v202, v9, v202, vcc
    v_cndmask_b32_e64 v203, v9, v203, vcc
    v_cndmask_b32_e64 v204, v9, v204, vcc
    v_cndmask_b32_e64 v205, v9, v205, vcc
    v_cndmask_b32_e64 v206, v9, v206, vcc
    v_cndmask_b32_e64 v207, v9, v207, vcc
    v_cndmask_b32_e64 v208, v9, v208, vcc
    v_cndmask_b32_e64 v209, v9, v209, vcc
    v_cndmask_b32_e64 v210, v9, v210, vcc
    v_cndmask_b32_e64 v211, v9, v211, vcc
    v_cndmask_b32_e64 v212, v9, v212, vcc
    v_cndmask_b32_e64 v213, v9, v213, vcc
    v_cndmask_b32_e64 v214, v9, v214, vcc
    v_cndmask_b32_e64 v215, v9, v215, vcc
    v_mfma_f32_16x16x32_bf16 v[108:111], v[200:203], v[104:107], 0
    v_mfma_f32_16x16x32_bf16 v[108:111], v[204:207], v[104:107], v[108:111]
    v_mfma_f32_16x16x32_bf16 v[108:111], v[208:211], v[104:107], v[108:111]
    v_mfma_f32_16x16x32_bf16 v[108:111], v[212:215], v[104:107], v[108:111]
    s_mul_i32 s52, s3, 264192
    s_add_u32 s52, s52, 0x210000
    s_add_u32 s53, s52, 16512
    s_add_u32 s54, s52, 33024
    s_add_u32 s55, s52, 49536
    s_nop 2
    ds_write_b32 v243, v108 offset:12
    s_branch fz_nc2back
fz_spec3a:
    v_xor_b32 v11, 1, v4
    v_cndmask_b32_e64 v9, v9, v11, s[34:35]
    v_and_b32 v11, 1, v4
    v_cndmask_b32_e64 v11, 0, v11, s[34:35]
    v_sub_u32 v10, v10, v11
    s_cmp_lg_u32 s22, 0
    s_cbranch_scc1 fz_spec3backa
    v_cmp_eq_u32 vcc, 15, v4
    v_mov_b32 v11, 1024
    v_mov_b32 v12, 124
    v_cndmask_b32_e64 v230, v230, v11, vcc
    v_cndmask_b32_e64 v10, v10, v12, vcc
    v_cndmask_b32_e64 v9, v9, 4, vcc
    v_cmp_eq_u32 vcc, 13, v4
    v_mov_b32 v11, 1536
    v_mov_b32 v12, 124
    v_cndmask_b32_e64 v230, v230, v11, vcc
    v_cndmask_b32_e64 v10, v10, v12, vcc
    v_cndmask_b32_e64 v9, v9, 6, vcc
    v_cmp_eq_u32 vcc, 4, v4
    v_mov_b32 v11, 256
    v_mov_b32 v12, 127
    v_cndmask_b32_e64 v230, v230, v11, vcc
    v_cndmask_b32_e64 v10, v10, v12, vcc
    v_cndmask_b32_e64 v9, v9, 8, vcc
    v_cmp_eq_u32 vcc, 11, v4
    v_mov_b32 v11, 1792
    v_mov_b32 v12, 127
    v_cndmask_b32_e64 v230, v230, v11, vcc
    v_cndmask_b32_e64 v10, v10, v12, vcc
    v_cndmask_b32_e64 v9, v9, 14, vcc
    v_cmp_eq_u32 vcc, 6, v4
    v_mov_b32 v11, 768
    v_mov_b32 v12, 127
    v_cndmask_b32_e64 v230, v230, v11, vcc
    v_cndmask_b32_e64 v10, v10, v12, vcc
    v_cndmask_b32_e64 v9, v9, 10, vcc
    v_cmp_eq_u32 vcc, 9, v4
    v_mov_b32 v11, 1280
    v_mov_b32 v12, 127
    v_cndmask_b32_e64 v230, v230, v11, vcc
    v_cndmask_b32_e64 v10, v10, v12, vcc
    v_cndmask_b32_e64 v9, v9, 12, vcc
    s_nop 4
    s_branch fz_spec3backa
fz_spec3b:
    v_xor_b32 v11, 1, v4
    v_cndmask_b32_e64 v9, v9, v11, s[34:35]
    v_and_b32 v11, 1, v4
    v_cndmask_b32_e64 v11, 0, v11, s[34:35]
    v_sub_u32 v10, v10, v11
    s_cmp_lg_u32 s22, 0
    s_cbranch_scc1 fz_spec3backb
    v_cmp_eq_u32 vcc, 15, v4
    v_mov_b32 v11, 1024
    v_mov_b32 v12, 124
    v_cndmask_b32_e64 v230, v230, v11, vcc
    v_cndmask_b32_e64 v10, v10, v12, vcc
    v_cndmask_b32_e64 v9, v9, 4, vcc
    v_cmp_eq_u32 vcc, 13, v4
    v_mov_b32 v11, 1536
    v_mov_b32 v12, 124
    v_cndmask_b32_e64 v230, v230, v11, vcc
    v_cndmask_b32_e64 v10, v10, v12, vcc
    v_cndmask_b32_e64 v9, v9, 6, vcc
    v_cmp_eq_u32 vcc, 4, v4
    v_mov_b32 v11, 256
    v_mov_b32 v12, 127
    v_cndmask_b32_e64 v230, v230, v11, vcc
    v_cndmask_b32_e64 v10, v10, v12, vcc
    v_cndmask_b32_e64 v9, v9, 8, vcc
    v_cmp_eq_u32 vcc, 11, v4
    v_mov_b32 v11, 1792
    v_mov_b32 v12, 127
    v_cndmask_b32_e64 v230, v230, v11, vcc
    v_cndmask_b32_e64 v10, v10, v12, vcc
    v_cndmask_b32_e64 v9, v9, 14, vcc
    v_cmp_eq_u32 vcc, 6, v4
    v_mov_b32 v11, 768
    v_mov_b32 v12, 127
    v_cndmask_b32_e64 v230, v230, v11, vcc
    v_cndmask_b32_e64 v10, v10, v12, vcc
    v_cndmask_b32_e64 v9, v9, 10, vcc
    v_cmp_eq_u32 vcc, 9, v4
    v_mov_b32 v11, 1280
    v_mov_b32 v12, 127
    v_cndmask_b32_e64 v230, v230, v11, vcc
    v_cndmask_b32_e64 v10, v10, v12, vcc
    v_cndmask_b32_e64 v9, v9, 12, vcc
    s_nop 4
    s_branch fz_spec3backb
    s_nop 0
ffn_early:
    s_branch fz_b1
    s_nop 0
ffn:
    s_cmp_gt_u32 s2, 239
    s_cbranch_scc1 fz_xend
    s_sub_u32 s20, s2, 128
    s_and_b32 s21, s20, 7
    s_mul_i32 s21, s21, 14
    s_lshr_b32 s20, s20, 3
    s_add_u32 s20, s20, s21
    s_and_b32 s21, s20, 1
    s_lshr_b32 s22, s20, 1
    v_lshrrev_b32 v2, 3, v1
    v_and_b32 v3, 7, v1
    v_and_b32 v4, 2, v2
    v_xor_b32 v3, v4, v3
    v_mul_u32_u24 v4, 7168, v2
    v_lshl_add_u32 v4, v3, 4, v4
    v_xor_b32 v5, 64, v4
    s_lshl_b32 s23, s21, 9
    s_lshl_b32 s24, s3, 6
    s_add_u32 s23, s23, s24
    s_mul_i32 s23, s23, 7168
    s_lshl_b32 s24, s22, 7
    s_add_u32 s23, s23, s24
    s_lshl_b32 s24, s3, 13
    s_add_u32 s28, s24, 81920
    s_mov_b32 m0, s28
    s_add_u32 s29, s23, 0
    buffer_load_dwordx4 v4, s[12:15], s29 offen lds
    s_add_u32 s28, s24, 82944
    s_mov_b32 m0, s28
    s_add_u32 s29, s23, 57344
    buffer_load_dwordx4 v5, s[12:15], s29 offen lds
    s_add_u32 s28, s24, 83968
    s_mov_b32 m0, s28
    s_add_u32 s29, s23, 114688
    buffer_load_dwordx4 v4, s[12:15], s29 offen lds
    s_add_u32 s28, s24, 84992
    s_mov_b32 m0, s28
    s_add_u32 s29, s23, 172032
    buffer_load_dwordx4 v5, s[12:15], s29 offen lds
    s_add_u32 s28, s24, 86016
    s_mov_b32 m0, s28
    s_add_u32 s29, s23, 229376
    buffer_load_dwordx4 v4, s[12:15], s29 offen lds
    s_add_u32 s28, s24, 87040
    s_mov_b32 m0, s28
    s_add_u32 s29, s23, 286720
    buffer_load_dwordx4 v5, s[12:15], s29 offen lds
    s_add_u32 s28, s24, 88064
    s_mov_b32 m0, s28
    s_add_u32 s29, s23, 344064
    buffer_load_dwordx4 v4, s[12:15], s29 offen lds
    s_add_u32 s28, s24, 89088
    s_mov_b32 m0, s28
    s_add_u32 s29, s23, 401408
    buffer_load_dwordx4 v5, s[12:15], s29 offen lds
    s_add_u32 s28, s24, 0
    s_mov_b32 m0, s28
    s_add_u32 s29, s23, 0
    buffer_load_dwordx4 v4, s[16:19], s29 offen lds
    s_add_u32 s28, s24, 1024
    s_mov_b32 m0, s28
    s_add_u32 s29, s23, 57344
    buffer_load_dwordx4 v5, s[16:19], s29 offen lds
    s_add_u32 s28, s24, 2048
    s_mov_b32 m0, s28
    s_add_u32 s29, s23, 114688
    buffer_load_dwordx4 v4, s[16:19], s29 offen lds
    s_add_u32 s28, s24, 3072
    s_mov_b32 m0, s28
    s_add_u32 s29, s23, 172032
    buffer_load_dwordx4 v5, s[16:19], s29 offen lds
    s_add_u32 s28, s24, 4096
    s_mov_b32 m0, s28
    s_add_u32 s29, s23, 229376
    buffer_load_dwordx4 v4, s[16:19], s29 offen lds
    s_add_u32 s28, s24, 5120
    s_mov_b32 m0, s28
    s_add_u32 s29, s23, 286720
    buffer_load_dwordx4 v5, s[16:19], s29 offen lds
    s_add_u32 s28, s24, 6144
    s_mov_b32 m0, s28
    s_add_u32 s29, s23, 344064
    buffer_load_dwordx4 v4, s[16:19], s29 offen lds
    s_add_u32 s28, s24, 7168
    s_mov_b32 m0, s28
    s_add_u32 s29, s23, 401408
    buffer_load_dwordx4 v5, s[16:19], s29 offen lds
    v_lshrrev_b32 v2, 4, v1
    v_and_b32 v3, 15, v1
    v_bfe_u32 v9, v1, 2, 2
    v_lshl_add_u32 v8, v2, 3, v9
    v_lshlrev_b32 v8, 7, v8
    s_and_b32 s28, s3, 3
    s_lshl_b32 s28, s28, 1
    v_bfe_u32 v10, v1, 1, 1
    v_add_u32 v10, s28, v10
    v_and_b32 v11, 2, v9
    v_xor_b32 v10, v11, v10
    v_and_b32 v11, 1, v2
    v_lshlrev_b32 v11, 2, v11
    v_xor_b32 v10, v11, v10
    v_lshl_add_u32 v8, v10, 4, v8
    v_and_b32 v10, 1, v1
    v_lshl_add_u32 v8, v10, 3, v8
    s_cmp_lt_u32 s3, 4
    s_cselect_b32 s28, 81920, 0
    v_add_u32 v8, s28, v8
    v_bfe_u32 v9, v0, 2, 2
    v_lshrrev_b32 v10, 6, v0
    v_lshl_add_u32 v9, v10, 2, v9
    v_bfe_u32 v10, v0, 4, 1
    v_and_b32 v11, 3, v0
    v_lshlrev_b32 v11, 1, v11
    v_lshl_add_u32 v10, v10, 3, v11
    v_lshl_add_u32 v11, v9, 5, v10
    v_add_u32 v17, 1, v11
    v_cmp_eq_u32 vcc, 0, v10
    v_cmp_gt_u32 s[28:29], 16, v9
    s_nop 1
    s_and_b64 vcc, vcc, s[28:29]
    v_cndmask_b32_e64 v14, 0, 16, vcc
    v_add_u32 v16, v11, v14
    v_bfe_u32 v10, v0, 5, 1
    v_cmp_eq_u32 s[28:29], 1, v10
    v_sub_u32 v14, 1024, v16
    v_cmp_eq_u32 vcc, 512, v16
    s_nop 1
    v_cndmask_b32_e64 v14, v14, 0, vcc
    v_cndmask_b32_e64 v16, v16, v14, s[28:29]
    v_sub_u32 v14, 1024, v17
    v_cndmask_b32_e64 v17, v17, v14, s[28:29]
    v_lshlrev_b32 v16, 1, v16
    v_add_u32 v16, 147456, v16
    v_lshlrev_b32 v17, 1, v17
    v_add_u32 v17, 147456, v17
    v_lshlrev_b32 v18, 2, v0
    v_add_u32 v18, 149568, v18
    s_lshl_b32 s28, s21, 10
    s_add_u32 s28, s28, 147456
    v_lshlrev_b32 v19, 4, v2
    v_add_u32 v19, s28, v19
    v_mov_b32 v28, 149504
    v_lshlrev_b32 v29, 4, v1
    s_bfe_u32 s28, s3, 0x10001
    s_lshl_b32 s30, s22, 1
    s_add_u32 s30, s30, s28
    s_lshl_b32 s30, s30, 1
    s_add_u32 s30, s30, s21
    s_lshl_b32 s30, s30, 1
    s_lshr_b32 s28, s3, 2
    s_add_u32 s30, s30, s28
    s_lshl_b32 s30, s30, 1
    s_and_b32 s28, s3, 1
    s_add_u32 s30, s30, s28
    s_lshl_b32 s30, s30, 6
    s_add_u32 s30, s30, 0x481000
    v_lshlrev_b32 v30, 4, v2
    v_add_u32 v21, 149568, v29
    v_mov_b32 v197, 0xffffff00
    s_and_b32 s34, s20, 15
    s_mul_i32 s34, s34, 2176
    s_add_u32 s34, s34, 0x420000
    s_waitcnt vmcnt(0)
    s_barrier
    ds_read_b64_tr_b16 v[32:33], v8 offset:0
    ds_read_b64_tr_b16 v[34:35], v8 offset:512
    ds_read_b64_tr_b16 v[36:37], v8 offset:4096
    ds_read_b64_tr_b16 v[38:39], v8 offset:4608
    ds_read_b64_tr_b16 v[40:41], v8 offset:8192
    ds_read_b64_tr_b16 v[42:43], v8 offset:8704
    ds_read_b64_tr_b16 v[44:45], v8 offset:12288
    ds_read_b64_tr_b16 v[46:47], v8 offset:12800
    s_waitcnt lgkmcnt(0)
    ds_read_b64_tr_b16 v[48:49], v8 offset:16384
    ds_read_b64_tr_b16 v[50:51], v8 offset:16896
    ds_read_b64_tr_b16 v[52:53], v8 offset:20480
    ds_read_b64_tr_b16 v[54:55], v8 offset:20992
    ds_read_b64_tr_b16 v[56:57], v8 offset:24576
    ds_read_b64_tr_b16 v[58:59], v8 offset:25088
    ds_read_b64_tr_b16 v[60:61], v8 offset:28672
    ds_read_b64_tr_b16 v[62:63], v8 offset:29184
    s_waitcnt lgkmcnt(0)
    ds_read_b64_tr_b16 v[64:65], v8 offset:32768
    ds_read_b64_tr_b16 v[66:67], v8 offset:33280
    ds_read_b64_tr_b16 v[68:69], v8 offset:36864
    ds_read_b64_tr_b16 v[70:71], v8 offset:37376
    ds_read_b64_tr_b16 v[72:73], v8 offset:40960
    ds_read_b64_tr_b16 v[74:75], v8 offset:41472
    ds_read_b64_tr_b16 v[76:77], v8 offset:45056
    ds_read_b64_tr_b16 v[78:79], v8 offset:45568
    s_waitcnt lgkmcnt(0)
    ds_read_b64_tr_b16 v[80:81], v8 offset:49152
    ds_read_b64_tr_b16 v[82:83], v8 offset:49664
    ds_read_b64_tr_b16 v[84:85], v8 offset:53248
    ds_read_b64_tr_b16 v[86:87], v8 offset:53760
    ds_read_b64_tr_b16 v[88:89], v8 offset:57344
    ds_read_b64_tr_b16 v[90:91], v8 offset:57856
    ds_read_b64_tr_b16 v[92:93], v8 offset:61440
    ds_read_b64_tr_b16 v[94:95], v8 offset:61952
    s_waitcnt lgkmcnt(0)
    s_cmp_lg_u32 s3, 0
    s_cbranch_scc1 ffn_w3
    s_lshl_b32 s28, s20, 4
    s_add_u32 s28, s28, s34
    v_mov_b32 v10, 12
    s_nop 4
ffn_p3:
    buffer_load_dword v11, v10, s[4:7], s28 offen sc1
    s_waitcnt vmcnt(0)
    v_cmp_ne_u32 vcc, s40, v11
    s_cbranch_vccnz ffn_p3_rt
ffn_p3_ok:
    s_mov_b32 s58, 0
    s_nop 2
ffn_k3:
    buffer_load_dwordx4 v[200:203], v29, s[4:7], s34 offen sc1
    buffer_load_dwordx4 v[204:207], v29, s[4:7], s34 offen offset:1024 sc1
    s_waitcnt vmcnt(0)
    v_xor_b32 v208, s40, v203
    v_xor_b32 v209, s40, v207
    v_max_u32 v210, v200, v204
    v_or_b32 v208, v208, v209
    v_cmp_ne_u32 vcc, 0, v208
    s_cbranch_vccnz ffn_k3_rt
ffn_k3_ok:
    v_max_u32_dpp v210, v210, v210 quad_perm:[1,0,3,2] row_mask:0xf bank_mask:0xf
    s_nop 1
    v_max_u32_dpp v210, v210, v210 quad_perm:[2,3,0,1] row_mask:0xf bank_mask:0xf
    s_nop 1
    v_max_u32_dpp v210, v210, v210 row_half_mirror row_mask:0xf bank_mask:0xf
    s_nop 1
    v_max_u32_dpp v210, v210, v210 row_mirror row_mask:0xf bank_mask:0xf
    s_nop 1
    v_max_u32_dpp v210, v210, v210 row_bcast:15 row_mask:0xa bank_mask:0xf
    s_nop 1
    v_max_u32_dpp v210, v210, v210 row_bcast:31 row_mask:0xc bank_mask:0xf
    s_nop 0
    v_readlane_b32 s36, v210, 63
    s_nop 1
    v_cmp_eq_u32 vcc, s36, v200
    v_cmp_eq_u32 s[28:29], s36, v204
    s_nop 0
    s_cmp_lg_u64 vcc, 0
    s_cselect_b32 s39, 0, 64
    s_or_b64 vcc, vcc, s[28:29]
    s_ff1_i32_b64 s41, vcc
    s_add_u32 s39, s39, s41
    s_lshl_b32 s39, s39, 11
    s_add_u32 s39, s39, 0x440000
    s_mov_b32 s58, 0
ffn_c3:
    buffer_load_dwordx4 v[128:131], v29, s[4:7], s39 offen sc1
    buffer_load_dwordx4 v[132:135], v29, s[4:7], s39 offen offset:1024 sc1
    v_cndmask_b32_e64 v201, v201, v205, s[28:29]
    v_cndmask_b32_e64 v202, v202, v206, s[28:29]
    s_mov_b64 s[42:43], vcc
    s_mov_b64 exec, vcc
    ds_write_b128 v28, v[200:203]
    s_mov_b64 exec, -1
    s_waitcnt vmcnt(1)
    ds_write_b128 v21, v[128:131]
    v_max3_u32 v10, v128, v129, v130
    s_waitcnt vmcnt(0)
    ds_write_b128 v21, v[132:135] offset:1024
    v_max3_u32 v10, v10, v131, v132
    v_max3_u32 v11, v133, v134, v135
    v_max_u32 v10, v10, v11
    v_cmp_eq_u32 vcc, -1, v10
    s_cbranch_vccnz ffn_c3_rt
ffn_c3_ok:
    s_waitcnt lgkmcnt(0)
    s_nop 2
ffn_w3:
    s_barrier
    ds_read_b32 v11, v18
    ds_read_b128 v[200:203], v28
    s_mov_b32 s28, 0xffff0000
    s_waitcnt lgkmcnt(1)
    v_lshlrev_b32 v14, 16, v11
    v_and_b32 v15, s28, v11
    s_waitcnt lgkmcnt(0)
    v_add_f32 v14, v14, v201
    v_add_f32 v15, v15, v201
    v_cvt_pk_bf16_f32 v14, 0, v14
    v_cvt_pk_bf16_f32 v15, 0, v15
    v_mul_f32 v14, v14, v202
    v_mul_f32 v15, v15, v202
    v_cvt_pk_bf16_f32 v14, v14, v15
    ds_write_b16 v16, v14
    ds_write_b16_d16_hi v17, v14
    s_waitcnt lgkmcnt(0)
    s_barrier
    ds_read_b128 v[128:131], v19 offset:0
    ds_read_b128 v[132:135], v19 offset:64
    ds_read_b128 v[136:139], v19 offset:128
    ds_read_b128 v[140:143], v19 offset:192
    ds_read_b128 v[144:147], v19 offset:256
    ds_read_b128 v[148:151], v19 offset:320
    ds_read_b128 v[152:155], v19 offset:384
    s_waitcnt lgkmcnt(6)
    v_mfma_f32_16x16x32_bf16 v[192:195], v[32:35], v[128:131], 0
    ds_read_b128 v[156:159], v19 offset:448
    s_waitcnt lgkmcnt(6)
    v_mfma_f32_16x16x32_bf16 v[192:195], v[36:39], v[132:135], v[192:195]
    ds_read_b128 v[160:163], v19 offset:512
    s_waitcnt lgkmcnt(6)
    v_mfma_f32_16x16x32_bf16 v[192:195], v[40:43], v[136:139], v[192:195]
    ds_read_b128 v[164:167], v19 offset:576
    s_waitcnt lgkmcnt(6)
    v_mfma_f32_16x16x32_bf16 v[192:195], v[44:47], v[140:143], v[192:195]
    ds_read_b128 v[168:171], v19 offset:640
    s_waitcnt lgkmcnt(6)
    v_mfma_f32_16x16x32_bf16 v[192:195], v[48:51], v[144:147], v[192:195]
    ds_read_b128 v[172:175], v19 offset:704
    s_waitcnt lgkmcnt(6)
    v_mfma_f32_16x16x32_bf16 v[192:195], v[52:55], v[148:151], v[192:195]
    ds_read_b128 v[176:179], v19 offset:768
    s_waitcnt lgkmcnt(6)
    v_mfma_f32_16x16x32_bf16 v[192:195], v[56:59], v[152:155], v[192:195]
    ds_read_b128 v[180:183], v19 offset:832
    s_waitcnt lgkmcnt(6)
    v_mfma_f32_16x16x32_bf16 v[192:195], v[60:63], v[156:159], v[192:195]
    ds_read_b128 v[184:187], v19 offset:896
    s_waitcnt lgkmcnt(6)
    v_mfma_f32_16x16x32_bf16 v[192:195], v[64:67], v[160:163], v[192:195]
    ds_read_b128 v[188:191], v19 offset:960
    s_waitcnt lgkmcnt(6)
    v_mfma_f32_16x16x32_bf16 v[192:195], v[68:71], v[164:167], v[192:195]
    s_waitcnt lgkmcnt(5)
    v_mfma_f32_16x16x32_bf16 v[192:195], v[72:75], v[168:171], v[192:195]
    s_waitcnt lgkmcnt(4)
    v_mfma_f32_16x16x32_bf16 v[192:195], v[76:79], v[172:175], v[192:195]
    s_waitcnt lgkmcnt(3)
    v_mfma_f32_16x16x32_bf16 v[192:195], v[80:83], v[176:179], v[192:195]
    s_waitcnt lgkmcnt(2)
    v_mfma_f32_16x16x32_bf16 v[192:195], v[84:87], v[180:183], v[192:195]
    s_waitcnt lgkmcnt(1)
    v_mfma_f32_16x16x32_bf16 v[192:195], v[88:91], v[184:187], v[192:195]
    s_waitcnt lgkmcnt(0)
    v_mfma_f32_16x16x32_bf16 v[192:195], v[92:95], v[188:191], v[192:195]
    s_mov_b32 exec_lo, 0x00010001
    s_mov_b32 exec_hi, 0x00010001
    s_nop 5
    v_and_or_b32 v192, v192, v197, s48
    v_and_or_b32 v193, v193, v197, s49
    v_and_or_b32 v194, v194, v197, s50
    v_and_or_b32 v195, v195, v197, s51
    buffer_store_dwordx4 v[192:195], v30, s[4:7], s30 offen sc1
    s_endpgm
ffn_c3_rt:
    s_mov_b64 vcc, s[42:43]
    s_add_u32 s58, s58, 1
    s_cmp_lt_u32 s58, 0x10000
    s_cbranch_scc1 ffn_c3
    s_branch ffn_c3_ok
fz_h1_rt:
    s_add_u32 s58, s58, 1
    s_cmp_lt_u32 s58, 0x10000
    s_cbranch_scc1 fz_h1
    s_branch fz_h1_ok
fz_h2_rt:
    s_add_u32 s58, s58, 1
    s_cmp_lt_u32 s58, 0x10000
    s_cbranch_scc1 fz_h2
    s_branch fz_h2_ok
fz_k2_rt:
    s_add_u32 s58, s58, 1
    s_cmp_lt_u32 s58, 0x10000
    s_cbranch_scc1 fz_k2
    s_branch fz_k2_ok
fz_c2_rt:
    s_add_u32 s58, s58, 1
    s_cmp_lt_u32 s58, 0x10000
    s_cbranch_scc1 fz_c2
    s_branch fz_c2_ok
fz_p5_rt:
    s_add_u32 s58, s58, 1
    s_cmp_lt_u32 s58, 0x10000
    s_cbranch_scc1 fz_p5
    s_branch fz_p5_ok
fz_h5_rt:
    s_add_u32 s58, s58, 1
    s_cmp_lt_u32 s58, 0x10000
    s_cbranch_scc1 fz_h5
    s_branch fz_h5_ok
fz_h4_rt:
    s_add_u32 s58, s58, 1
    s_cmp_lt_u32 s58, 0x10000
    s_cbranch_scc1 fz_h4
    s_branch fz_h4_ok
ffn_p3_rt:
    s_add_u32 s58, s58, 1
    s_cmp_lt_u32 s58, 0x10000
    s_cbranch_scc1 ffn_p3
    s_branch ffn_p3_ok
ffn_k3_rt:
    s_add_u32 s58, s58, 1
    s_cmp_lt_u32 s58, 0x10000
    s_cbranch_scc1 ffn_k3
    s_branch ffn_k3_ok
.section .rodata,"a"
.p2align 6
.amdhsa_kernel fz_kernel
  .amdhsa_next_free_vgpr 256
  .amdhsa_next_free_sgpr 102
  .amdhsa_accum_offset 256
  .amdhsa_group_segment_fixed_size 0
  .amdhsa_kernarg_size 104
  .amdhsa_user_sgpr_count 2
  .amdhsa_user_sgpr_kernarg_segment_ptr 1
  .amdhsa_system_sgpr_workgroup_id_x 1
.end_amdhsa_kernel
```

```asm
; @launch kernel=fz_kernel grid=(256,1,1) block=(512,1,1) lds=163840
.amdgcn_target "amdgcn-amd-amdhsa--gfx950"
.text
.globl fz_kernel
.p2align 8
.type fz_kernel,@function
fz_kernel:
    s_load_dwordx2 s[4:5], s[0:1], 96
    s_load_dwordx2 s[8:9], s[0:1], 0
    s_load_dwordx2 s[64:65], s[0:1], 72
    s_cmp_gt_u32 s2, 255
    s_cbranch_scc1 fz_end
    v_lshrrev_b32 v2, 6, v0
    v_and_b32 v1, 63, v0
    s_lshr_b32 s59, s2, 7
    v_readfirstlane_b32 s3, v2
    s_and_b32 s20, s2, 127
    s_cmp_lt_u32 s20, 16
    s_cselect_b32 s20, s3, 0
    s_cmp_lt_u32 s20, 4
    s_cbranch_scc1 fz_pfcback
    s_getpc_b64 s[20:21]
fz_pcb:
    s_sub_u32 s20, s20, fz_pcb-fz_kernel
    s_subb_u32 s21, s21, 0
    v_and_b32 v3, 255, v0
    v_lshlrev_b32 v3, 7, v3
    v_min_u32 v3, fz_codeend-fz_kernel-4, v3
    v_mov_b32 v5, s21
    v_add_co_u32 v4, vcc, s20, v3
    s_nop 1
    v_addc_co_u32 v5, vcc, 0, v5, vcc
    global_load_dword v251, v[4:5], off
fz_pfcback:
    s_cmp_lg_u32 s59, 0
    s_cbranch_scc1 fz_ldh
    s_load_dwordx2 s[12:13], s[0:1], 80
    s_load_dwordx2 s[16:17], s[0:1], 48
fz_ldback:
    s_add_u32 s20, s2, 58
    s_and_b32 s20, s20, 127
    s_lshr_b32 s21, s20, 3
    s_add_u32 s21, s21, 1
    s_and_b32 s22, s20, 7
    s_sub_u32 s23, s20, 124
    s_cmp_ge_u32 s20, 124
    s_cselect_b32 s21, 0, s21
    s_cselect_b32 s22, s23, s22
    s_lshr_b32 s57, s3, 2
    s_or_b32 s23, s57, s59
    s_and_b32 s24, s3, 3
    s_lshl_b32 s25, s22, 6
    s_add_u32 s25, s25, s21
    s_lshl_b32 s26, s23, 5
    s_add_u32 s26, s26, s25
    s_lshl_b32 s27, s24, 9
    s_add_u32 s28, s26, s27
    s_sub_u32 s27, 2048, s27
    s_sub_u32 s27, s27, s26
    s_lshl_b32 s29, s24, 1
    s_add_u32 s29, s29, s23
    s_sub_u32 s30, 15, s29
    s_cmp_lt_u32 s24, 2
    s_cselect_b32 s27, s28, s27
    s_cselect_b32 s31, s29, s30
    s_cselect_b32 s30, s30, s29
    s_sub_u32 s28, 2048, s27
    s_and_b32 s28, s28, 2047
    s_lshl_b32 s27, s27, 11
    s_lshl_b32 s28, s28, 11
    s_mul_i32 s31, s31, 2064
    s_mul_i32 s30, s30, 2064
    v_lshlrev_b32 v239, 4, v1
    s_mov_b32 s10, 0x400000
    s_mov_b32 s11, 0x00020000
    s_mov_b32 s6, 0x568000
    s_mov_b32 s7, 0x00020000
    s_mov_b32 s66, 0x700000
    s_mov_b32 s67, 0x00020000
    s_and_b32 s32, s57, s59
    s_add_u32 s36, s2, 4
    s_and_b32 s36, s36, 7
    s_bfe_u32 s37, s2, 0x10006
    s_lshl_b32 s63, s36, 1
    s_add_u32 s63, s63, s37
    s_cmp_lg_u32 s37, 0
    s_cselect_b32 s37, 8, s36
    s_add_u32 s37, s37, 6
    s_cmp_lt_u32 s36, 6
    s_cselect_b32 s63, s63, s37
    s_lshl_b32 s63, s63, 3
    s_bfe_u32 s37, s2, 0x30003
    s_add_u32 s63, s63, s37
    v_and_b32 v10, 15, v1
    v_lshlrev_b32 v10, 4, v10
    v_lshrrev_b32 v14, 4, v1
    v_lshl_add_u32 v14, v14, 11, v10
    s_lshl_b32 s62, s63, 16
    s_and_b32 s37, s3, 3
    s_lshl_b32 s37, s37, 9
    s_add_u32 s62, s62, s37
    s_mov_b32 s58, 0
    s_waitcnt lgkmcnt(0)
    s_cmp_eq_u32 s2, 66
    s_cbranch_scc1 fz_spec
fz_specback:
    s_cmp_lg_u32 s57, 0
    s_cbranch_scc1 fz_nox
    s_mov_b32 m0, s31
    s_nop 0
    buffer_load_dwordx4 v239, s[8:11], s27 offen lds
    buffer_load_dwordx4 v239, s[8:11], s27 offen offset:1024 lds
    s_mov_b32 m0, s30
    s_nop 0
    buffer_load_dwordx4 v239, s[8:11], s28 offen lds
    buffer_load_dwordx4 v239, s[8:11], s28 offen offset:1024 lds
fz_nox:
    buffer_load_dword v250, off, s[4:7], 0
    s_andn2_b32 s32, s57, s59
    s_cbranch_scc0 fz_nowe
    buffer_load_dwordx4 v[160:163], v14, s[64:67], s62 offen offset:0 nt
    buffer_load_dwordx4 v[164:167], v14, s[64:67], s62 offen offset:256 nt
    s_add_u32 s62, s62, 8192
    buffer_load_dwordx4 v[168:171], v14, s[64:67], s62 offen offset:0 nt
    buffer_load_dwordx4 v[172:175], v14, s[64:67], s62 offen offset:256 nt
    s_add_u32 s62, s62, 8192
fz_nowe:
    s_cmp_eq_u32 s57, 0
    s_cbranch_scc1 fz_np
    s_setprio 1
fz_np:
    v_and_b32 v2, 31, v1
    v_lshrrev_b32 v3, 5, v1
    v_and_b32 v4, 15, v1
    v_lshrrev_b32 v5, 4, v1
    v_add_u32 v6, 49536, v239
    v_lshrrev_b32 v10, 1, v2
    v_and_b32 v8, 9, v10
    v_and_b32 v11, 2, v10
    v_lshl_or_b32 v8, v11, 1, v8
    v_bfe_u32 v11, v10, 2, 1
    v_lshl_or_b32 v8, v11, 1, v8
    v_and_b32 v12, 1, v5
    v_cmp_eq_u32 vcc, 1, v12
    v_lshl_add_u32 v9, v4, 1, 1
    s_nop 0
    v_cndmask_b32_e64 v9, v9, 0, vcc
    s_cmp_lt_u32 s3, 5
    s_cselect_b64 s[32:33], -1, 0
    s_cmp_lt_u32 s3, 3
    s_cselect_b64 s[34:35], -1, 0
    v_cndmask_b32_e64 v9, v9, v2, s[32:33]
    v_cndmask_b32_e64 v8, v9, v8, s[34:35]
    s_mov_b32 s36, 0x3d000000
    s_cmp_gt_u32 s3, 4
    s_cselect_b32 s36, 0x3c800000, s36
    s_sub_u32 s37, s3, 1
    s_cmp_lt_u32 s37, 2
    s_cselect_b32 s36, 0x3a800000, s36
    s_cmp_eq_u32 s3, 0
    s_cselect_b32 s32, 16, 0
    s_cselect_b32 s33, 0x3e800000, 0
    s_cselect_b32 s34, 4.0, 0x41000000
    s_cselect_b32 s35, 0x41000000, 4.0
    v_cmp_eq_u32 vcc, 1, v2
    v_mov_b32 v10, s32
    s_nop 0
    v_cndmask_b32_e64 v10, 0, v10, vcc
    v_add_u32 v8, v8, v10
    v_cvt_f32_u32 v8, v8
    v_mul_f32 v8, s36, v8
    s_cmp_eq_u32 s3, 2
    s_cselect_b32 s32, 0x80000000, 0
    v_lshlrev_b32 v10, 31, v2
    v_and_b32 v10, s32, v10
    v_xor_b32 v8, v10, v8
    v_and_b32 v10, 1, v2
    v_cvt_f32_u32 v10, v10
    v_mul_f32 v10, s33, v10
    s_cmp_eq_u32 s3, 1
    s_cselect_b32 s33, 0x3e800000, 0
    v_mov_b32 v11, s33
    v_cndmask_b32_e64 v10, v10, v11, vcc
    s_cmp_eq_u32 s3, 5
    s_cselect_b32 s33, 0x3e800000, 0
    v_cvt_f32_u32 v12, v12
    v_fma_f32 v10, v12, s33, v10
    s_cmp_eq_u32 s3, 6
    s_cselect_b32 s33, 0x3e800000, 0
    s_cmp_eq_u32 s3, 2
    s_cselect_b32 s33, 0xbe800000, s33
    s_cmp_eq_u32 s3, 4
    s_cselect_b32 s33, 0xbe800000, s33
    v_add_f32 v10, s33, v10
    v_cvt_f32_u32 v11, v3
    v_mul_f32 v11, s35, v11
    v_fma_f32 v9, v8, v11, v10
    v_mul_f32 v10, s34, v8
    v_mul_f32 v11, 0x41800000, v8
    v_mov_b32 v104, v9
    v_fmamk_f32 v105, v8, 0x3f800000, v9
    v_fmamk_f32 v106, v8, 0x40000000, v9
    v_fmamk_f32 v107, v8, 0x40400000, v9
    v_add_f32 v108, v104, v10
    v_add_f32 v109, v105, v10
    v_add_f32 v110, v106, v10
    v_add_f32 v111, v107, v10
    v_add_f32 v112, v104, v11
    v_add_f32 v113, v105, v11
    v_add_f32 v114, v106, v11
    v_add_f32 v115, v107, v11
    v_add_f32 v116, v108, v11
    v_add_f32 v117, v109, v11
    v_add_f32 v118, v110, v11
    v_add_f32 v119, v111, v11
    v_cos_f32 v104, v104
    v_cos_f32 v105, v105
    v_cos_f32 v106, v106
    v_cos_f32 v107, v107
    v_cos_f32 v108, v108
    v_cos_f32 v109, v109
    v_cos_f32 v110, v110
    v_cos_f32 v111, v111
    v_cos_f32 v112, v112
    v_cos_f32 v113, v113
    v_cos_f32 v114, v114
    v_cos_f32 v115, v115
    v_cos_f32 v116, v116
    v_cos_f32 v117, v117
    v_cos_f32 v118, v118
    v_cos_f32 v119, v119
    s_lshl_b32 s32, s3, 11
    v_add_u32 v8, s32, v6
    s_cmp_eq_u32 s3, 0
    s_cbranch_scc1 fz_jb
    v_cvt_pk_f16_f32 v128, v104, v105
    v_cvt_pk_f16_f32 v129, v106, v107
    v_cvt_pk_f16_f32 v130, v108, v109
    v_cvt_pk_f16_f32 v131, v110, v111
    v_cvt_pk_f16_f32 v132, v112, v113
    v_cvt_pk_f16_f32 v133, v114, v115
    v_cvt_pk_f16_f32 v134, v116, v117
    v_cvt_pk_f16_f32 v135, v118, v119
fz_jend:
    ds_write_b128 v8, v[128:131] offset:0
    ds_write_b128 v8, v[132:135] offset:1024
    v_mov_b32 v15, 49520
    v_mov_b32 v10, 0
    ds_write_b32 v15, v10
    s_waitcnt lgkmcnt(0)
    s_barrier
    v_lshlrev_b32 v240, 31, v1
    v_lshrrev_b32 v10, 16, v240
    v_or_b32 v240, v240, v10
    v_mov_b32 v229, 0xfffcfffc
    v_mov_b32 v242, 0xffff0000
    s_mov_b32 s42, 0x3f803f80
    s_cmp_lg_u32 s57, 0
    s_cbranch_scc1 fz_nc1
    ds_read_b128 v[16:19], v6 offset:0
    ds_read_b128 v[20:23], v6 offset:1024
    ds_read_b128 v[24:27], v6 offset:2048
    ds_read_b128 v[28:31], v6 offset:3072
    ds_read_b128 v[32:35], v6 offset:4096
    ds_read_b128 v[36:39], v6 offset:5120
    ds_read_b128 v[40:43], v6 offset:6144
    ds_read_b128 v[44:47], v6 offset:7168
    ds_read_b128 v[48:51], v6 offset:8192
    ds_read_b128 v[52:55], v6 offset:9216
    ds_read_b128 v[56:59], v6 offset:10240
    ds_read_b128 v[60:63], v6 offset:11264
    ds_read_b128 v[64:67], v6 offset:12288
    ds_read_b128 v[68:71], v6 offset:13312
    v_lshlrev_b32 v7, 9, v3
    v_bfe_u32 v10, v1, 2, 2
    v_lshl_add_u32 v7, v10, 6, v7
    v_and_b32 v10, 1, v5
    v_lshl_add_u32 v7, v10, 5, v7
    v_and_b32 v10, 3, v1
    v_lshl_add_u32 v7, v10, 3, v7
    v_add_u32 v7, s31, v7
    v_lshlrev_b32 v8, 9, v3
    v_lshl_add_u32 v8, v2, 1, v8
    v_sub_u32 v9, 2048, v8
    v_and_b32 v9, 2047, v9
    v_add_u32 v9, s30, v9
    s_add_u32 s32, s30, 576
    v_sub_u32 v8, s32, v8
    v_cmp_eq_u32 vcc, 0, v2
    s_nop 1
    v_cndmask_b32_e64 v234, 0, -2.0, vcc
    v_mov_b32 v235, 0x3b27c5ac
    s_lshr_b32 s32, s24, 1
    s_lshl_b32 s32, s32, 6
    s_mul_i32 s33, s3, 2304
    s_add_u32 s32, s32, s33
    s_add_u32 s32, s32, 67968
    v_lshl_add_u32 v10, v3, 1, v1
    v_lshlrev_b32 v10, 4, v10
    v_add_u32 v216, s32, v10
    v_bfe_u32 v10, v0, 2, 1
    v_mul_u32_u24 v10, 34, v10
    v_lshrrev_b32 v11, 4, v0
    v_add_u32 v10, v10, v11
    v_lshlrev_b32 v10, 4, v10
    v_bfe_u32 v11, v0, 3, 1
    v_lshl_add_u32 v10, v11, 3, v10
    v_bfe_u32 v11, v0, 1, 1
    v_lshl_add_u32 v10, v11, 2, v10
    v_and_b32 v12, 1, v0
    s_mov_b32 s33, 9216
    s_cmp_eq_u32 s2, 66
    s_cselect_b32 s32, s33, 0x1b40
    v_mul_lo_u32 v11, v12, s32
    v_add_u32 v217, v10, v11
    v_add_u32 v217, 67968, v217
    s_cselect_b32 s32, s33, 0x940
    v_mul_lo_u32 v11, v12, s32
    v_add_u32 v218, v10, v11
    v_add_u32 v218, 70272, v218
    s_cselect_b32 s32, s33, 0xfffff6c0
    v_mul_lo_u32 v11, v12, s32
    v_add_u32 v219, v10, v11
    v_add_u32 v219, 73792, v219
    s_cselect_b32 s32, s33, 0xffffe4c0
    v_mul_lo_u32 v11, v12, s32
    v_add_u32 v220, v10, v11
    v_add_u32 v220, 76096, v220
    v_lshrrev_b32 v10, 2, v0
    v_and_b32 v11, 3, v0
    v_lshlrev_b32 v11, 4, v11
    v_lshl_add_u32 v221, v10, 7, v11
    s_mul_i32 s52, s20, 16512
    s_lshl_b32 s33, s59, 6
    s_add_u32 s52, s52, s33
    s_add_u32 s52, s52, 0x1000
    s_add_u32 s53, s52, 8192
    v_mov_b32 v160, 0
    v_mov_b32 v161, 0
    v_mov_b32 v162, 0
    v_mov_b32 v163, 0
    s_setprio 3
    s_waitcnt vmcnt(0) lgkmcnt(0)
    ds_read_b64_tr_b16 v[88:89], v7 offset:0
    ds_read_b64_tr_b16 v[90:91], v7 offset:256
    ds_read_b64_tr_b16 v[92:93], v7 offset:1024
    ds_read_b64_tr_b16 v[94:95], v7 offset:1280
    ds_read_u16_d16 v96, v9
    ds_read_u16_d16_hi v136, v8 offset:1408
    ds_read_u16_d16 v97, v8 offset:1344
    ds_read_u16_d16_hi v137, v8 offset:1280
    ds_read_u16_d16 v98, v8 offset:1216
    ds_read_u16_d16_hi v138, v8 offset:1152
    ds_read_u16_d16 v99, v8 offset:1088
    ds_read_u16_d16_hi v139, v8 offset:1024
    v_readfirstlane_b32 s40, v250
    s_nop 1
    s_add_u32 s40, s40, 1
    s_and_b32 s38, s40, 3
    s_and_b32 s39, s40, 15
    s_bfe_u32 s41, s40, 0x20002
    s_lshl_b32 s41, s41, 16
    s_or_b32 s44, s38, s41
    s_bfe_u32 s41, s40, 0x40004
    s_lshl_b32 s41, s41, 4
    s_or_b32 s48, s39, s41
    s_bfe_u32 s41, s40, 0x20004
    s_lshl_b32 s41, s41, 16
    s_or_b32 s45, s38, s41
    s_bfe_u32 s41, s40, 0x40008
    s_lshl_b32 s41, s41, 4
    s_or_b32 s49, s39, s41
    s_bfe_u32 s41, s40, 0x20006
    s_lshl_b32 s41, s41, 16
    s_or_b32 s46, s38, s41
    s_bfe_u32 s41, s40, 0x4000c
    s_lshl_b32 s41, s41, 4
    s_or_b32 s50, s39, s41
    s_bfe_u32 s41, s40, 0x20008
    s_lshl_b32 s41, s41, 16
    s_or_b32 s47, s38, s41
    s_bfe_u32 s41, s40, 0x40010
    s_lshl_b32 s41, s41, 4
    s_or_b32 s51, s39, s41
    s_mov_b32 s38, 0x404
    s_cmp_eq_u32 s2, 66
    s_cselect_b32 s39, 8, 4
    s_cselect_b32 s38, 8, s38
    s_waitcnt lgkmcnt(8)
    v_mfma_f32_32x32x16_bf16 v[104:119], v[88:91], v[16:19], 0
    v_mfma_f32_32x32x16_bf16 v[104:119], v[92:95], v[20:23], v[104:119]
    ds_read_u16_d16 v100, v8 offset:448
    ds_read_u16_d16_hi v140, v8 offset:384
    ds_read_u16_d16 v101, v8 offset:320
    ds_read_u16_d16_hi v141, v8 offset:256
    ds_read_u16_d16 v102, v8 offset:192
    ds_read_u16_d16_hi v142, v8 offset:128
    ds_read_u16_d16 v103, v8 offset:64
    ds_read_u16_d16_hi v143, v8 offset:0
    v_dot2_f32_bf16 v160, v88, s42, v160
    v_dot2_f32_bf16 v161, v88, v88, v161
    v_dot2_f32_bf16 v160, v89, s42, v160
    v_dot2_f32_bf16 v161, v89, v89, v161
    v_dot2_f32_bf16 v160, v90, s42, v160
    v_dot2_f32_bf16 v161, v90, v90, v161
    v_dot2_f32_bf16 v160, v91, s42, v160
    v_dot2_f32_bf16 v161, v91, v91, v161
    v_dot2_f32_bf16 v160, v92, s42, v160
    v_dot2_f32_bf16 v161, v92, v92, v161
    v_dot2_f32_bf16 v160, v93, s42, v160
    v_dot2_f32_bf16 v161, v93, v93, v161
    v_dot2_f32_bf16 v160, v94, s42, v160
    v_dot2_f32_bf16 v161, v94, v94, v161
    v_dot2_f32_bf16 v160, v95, s42, v160
    v_dot2_f32_bf16 v161, v95, v95, v161
    s_waitcnt lgkmcnt(0)
    v_or_b32 v96, v96, v136
    v_or_b32 v97, v97, v137
    v_or_b32 v98, v98, v138
    v_or_b32 v99, v99, v139
    v_or_b32 v100, v100, v140
    v_or_b32 v101, v101, v141
    v_or_b32 v102, v102, v142
    v_or_b32 v103, v103, v143
    v_mfma_f32_32x32x16_bf16 v[120:135], v[96:99], v[16:19], 0
    s_nop 0
    v_mfma_f32_32x32x16_bf16 v[120:135], v[100:103], v[20:23], v[120:135]
    v_dot2_f32_bf16 v162, v96, s42, v162
    v_dot2_f32_bf16 v163, v96, v96, v163
    v_dot2_f32_bf16 v162, v97, s42, v162
    v_dot2_f32_bf16 v163, v97, v97, v163
    v_dot2_f32_bf16 v162, v98, s42, v162
    v_dot2_f32_bf16 v163, v98, v98, v163
    v_dot2_f32_bf16 v162, v99, s42, v162
    v_dot2_f32_bf16 v163, v99, v99, v163
    v_dot2_f32_bf16 v162, v100, s42, v162
    v_dot2_f32_bf16 v163, v100, v100, v163
    v_dot2_f32_bf16 v162, v101, s42, v162
    v_dot2_f32_bf16 v163, v101, v101, v163
    v_dot2_f32_bf16 v162, v102, s42, v162
    v_dot2_f32_bf16 v163, v102, v102, v163
    v_dot2_f32_bf16 v162, v103, s42, v162
    v_dot2_f32_bf16 v163, v103, v103, v163
    s_nop 1
    v_permlane32_swap_b32 v160, v162
    v_permlane32_swap_b32 v161, v163
    v_add_f32 v160, v160, v162
    v_add_f32 v161, v161, v163
    s_nop 1
    v_permlane16_swap_b32 v160, v161
    v_add_f32 v160, v160, v161
    s_nop 1
    v_add_f32_dpp v160, v160, v160 quad_perm:[1,0,3,2] row_mask:0xf bank_mask:0xf
    s_nop 1
    v_add_f32_dpp v160, v160, v160 quad_perm:[2,3,0,1] row_mask:0xf bank_mask:0xf
    s_nop 1
    v_add_f32_dpp v160, v160, v160 row_half_mirror row_mask:0xf bank_mask:0xf
    s_nop 1
    v_add_f32_dpp v160, v160, v160 row_mirror row_mask:0xf bank_mask:0xf
    s_mov_b32 s43, 0x3e800000
    v_mov_b32 v161, v160
    s_nop 1
    v_permlane16_swap_b32 v160, v161
    v_mul_f32 v160, 0x3c800000, v160
    v_fma_f32 v161, v161, s43, v235
    v_fma_f32 v161, -v160, v160, v161
    v_rsq_f32 v161, v161
    s_nop 0
    v_mul_f32 v160, v160, v161
    v_readlane_b32 s32, v161, 0
    v_readlane_b32 s34, v161, 32
    v_readlane_b32 s36, v160, 0
    v_readlane_b32 s37, v160, 32
    s_nop 0
    v_mul_f32 v164, s36, v234
    v_fmac_f32 v164, s37, v234
    v_pk_fma_f32 v[104:105], v[104:105], s[32:33], v[164:165] op_sel_hi:[1,0,0]
    v_pk_fma_f32 v[106:107], v[106:107], s[32:33], v[164:165] op_sel_hi:[1,0,0]
    v_pk_fma_f32 v[108:109], v[108:109], s[32:33], v[164:165] op_sel_hi:[1,0,0]
    v_pk_fma_f32 v[110:111], v[110:111], s[32:33], v[164:165] op_sel_hi:[1,0,0]
    v_pk_fma_f32 v[112:113], v[112:113], s[32:33], v[164:165] op_sel_hi:[1,0,0]
    v_pk_fma_f32 v[114:115], v[114:115], s[32:33], v[164:165] op_sel_hi:[1,0,0]
    v_pk_fma_f32 v[116:117], v[116:117], s[32:33], v[164:165] op_sel_hi:[1,0,0]
    v_pk_fma_f32 v[118:119], v[118:119], s[32:33], v[164:165] op_sel_hi:[1,0,0]
    v_pk_fma_f32 v[104:105], v[120:121], s[34:35], v[104:105] op_sel_hi:[1,0,1]
    v_pk_fma_f32 v[106:107], v[122:123], s[34:35], v[106:107] op_sel_hi:[1,0,1]
    v_pk_fma_f32 v[108:109], v[124:125], s[34:35], v[108:109] op_sel_hi:[1,0,1]
    v_pk_fma_f32 v[110:111], v[126:127], s[34:35], v[110:111] op_sel_hi:[1,0,1]
    v_pk_fma_f32 v[112:113], v[128:129], s[34:35], v[112:113] op_sel_hi:[1,0,1]
    v_pk_fma_f32 v[114:115], v[130:131], s[34:35], v[114:115] op_sel_hi:[1,0,1]
    v_pk_fma_f32 v[116:117], v[132:133], s[34:35], v[116:117] op_sel_hi:[1,0,1]
    v_pk_fma_f32 v[118:119], v[134:135], s[34:35], v[118:119] op_sel_hi:[1,0,1]
    v_cvt_pk_f16_f32 v136, v104, v105
    v_cvt_pk_f16_f32 v137, v106, v107
    v_cvt_pk_f16_f32 v138, v108, v109
    v_cvt_pk_f16_f32 v139, v110, v111
    v_cvt_pk_f16_f32 v140, v112, v113
    v_cvt_pk_f16_f32 v141, v114, v115
    v_cvt_pk_f16_f32 v142, v116, v117
    v_cvt_pk_f16_f32 v143, v118, v119
    v_mov_b32_dpp v152, v136 quad_perm:[1,0,3,2] row_mask:0xf bank_mask:0xf
    v_mov_b32_dpp v153, v137 quad_perm:[1,0,3,2] row_mask:0xf bank_mask:0xf
    v_mov_b32_dpp v154, v138 quad_perm:[1,0,3,2] row_mask:0xf bank_mask:0xf
    v_mov_b32_dpp v155, v139 quad_perm:[1,0,3,2] row_mask:0xf bank_mask:0xf
    v_mov_b32_dpp v156, v140 quad_perm:[1,0,3,2] row_mask:0xf bank_mask:0xf
    v_mov_b32_dpp v157, v141 quad_perm:[1,0,3,2] row_mask:0xf bank_mask:0xf
    v_mov_b32_dpp v158, v142 quad_perm:[1,0,3,2] row_mask:0xf bank_mask:0xf
    v_mov_b32_dpp v159, v143 quad_perm:[1,0,3,2] row_mask:0xf bank_mask:0xf
    v_pk_mul_f16 v144, v136, v24
    v_pk_mul_f16 v145, v137, v25
    v_pk_mul_f16 v146, v138, v26
    v_pk_mul_f16 v147, v139, v27
    v_pk_mul_f16 v148, v140, v28
    v_pk_mul_f16 v149, v141, v29
    v_pk_mul_f16 v150, v142, v30
    v_pk_mul_f16 v151, v143, v31
    v_mfma_f32_16x16x32_f16 v[120:123], v[136:139], v[56:59], 0
    v_pk_fma_f16 v144, v152, v32, v144
    v_pk_fma_f16 v145, v153, v33, v145
    v_pk_fma_f16 v146, v154, v34, v146
    v_pk_fma_f16 v147, v155, v35, v147
    v_mfma_f32_16x16x32_f16 v[120:123], v[140:143], v[60:63], v[120:123]
    v_pk_fma_f16 v148, v156, v36, v148
    v_pk_fma_f16 v149, v157, v37, v149
    v_pk_fma_f16 v150, v158, v38, v150
    v_pk_fma_f16 v151, v159, v39, v151
    v_mfma_f32_32x32x16_f16 v[104:119], v[144:147], v[40:43], 0
    v_xor_b32_dpp v152, v144, v240 quad_perm:[1,0,3,2] row_mask:0xf bank_mask:0xf
    v_xor_b32_dpp v153, v145, v240 quad_perm:[1,0,3,2] row_mask:0xf bank_mask:0xf
    v_xor_b32_dpp v154, v146, v240 quad_perm:[1,0,3,2] row_mask:0xf bank_mask:0xf
    v_xor_b32_dpp v155, v147, v240 quad_perm:[1,0,3,2] row_mask:0xf bank_mask:0xf
    v_mfma_f32_32x32x16_f16 v[104:119], v[148:151], v[44:47], v[104:119]
    v_xor_b32_dpp v156, v148, v240 quad_perm:[1,0,3,2] row_mask:0xf bank_mask:0xf
    v_xor_b32_dpp v157, v149, v240 quad_perm:[1,0,3,2] row_mask:0xf bank_mask:0xf
    v_xor_b32_dpp v158, v150, v240 quad_perm:[1,0,3,2] row_mask:0xf bank_mask:0xf
    v_xor_b32_dpp v159, v151, v240 quad_perm:[1,0,3,2] row_mask:0xf bank_mask:0xf
    v_mfma_f32_32x32x16_f16 v[104:119], v[152:155], v[48:51], v[104:119]
    s_nop 0
    v_mfma_f32_32x32x16_f16 v[104:119], v[156:159], v[52:55], v[104:119]
    v_mfma_f32_16x16x32_f16 v[124:127], v[136:139], v[64:67], 0
    v_mfma_f32_16x16x32_f16 v[124:127], v[140:143], v[68:71], v[124:127]
    s_mov_b64 vcc, 0xffff
    s_nop 8
    v_cvt_pk_f16_f32 v143, v118, v119
    v_cvt_pk_f16_f32 v142, v116, v117
    v_cvt_pk_f16_f32 v141, v114, v115
    v_cvt_pk_f16_f32 v140, v112, v113
    v_cvt_pk_f16_f32 v139, v110, v111
    v_cvt_pk_f16_f32 v138, v108, v109
    v_cvt_pk_f16_f32 v137, v106, v107
    v_cndmask_b32_e64 v104, v104, v121, vcc
    v_cndmask_b32_e64 v105, v105, v125, vcc
    v_pk_add_f16 v147, v142, v143 op_sel:[0,1] op_sel_hi:[1,0] neg_lo:[0,1]
    v_pk_add_f16 v151, v142, v143 op_sel:[0,1] op_sel_hi:[1,0] neg_hi:[1,0]
    v_pk_add_f16 v146, v140, v141 op_sel:[0,1] op_sel_hi:[1,0] neg_lo:[0,1]
    v_pk_add_f16 v150, v140, v141 op_sel:[0,1] op_sel_hi:[1,0] neg_hi:[1,0]
    v_pk_add_f16 v145, v138, v139 op_sel:[0,1] op_sel_hi:[1,0] neg_lo:[0,1]
    v_pk_add_f16 v149, v138, v139 op_sel:[0,1] op_sel_hi:[1,0] neg_hi:[1,0]
    v_cvt_pk_f16_f32 v136, v104, v105
    v_pk_add_f16 v144, v136, v137 op_sel:[0,1] op_sel_hi:[1,0] neg_lo:[0,1]
    v_pk_add_f16 v148, v136, v137 op_sel:[0,1] op_sel_hi:[1,0] neg_hi:[1,0]
    ds_write_b128 v216, v[144:147]
    ds_write_b128 v216, v[148:151] offset:1152
    s_waitcnt lgkmcnt(0)
    v_mov_b32 v10, 1
    s_mov_b64 exec, 1
    ds_add_u32 v15, v10
    s_mov_b64 exec, -1
    s_cmp_gt_u32 s3, 3
    s_cbranch_scc1 fz_bsp
fz_sy:
    ds_read_b32 v10, v15
    s_waitcnt lgkmcnt(0)
    v_and_b32 v10, 0xff, v10
    v_cmp_ne_u32 vcc, s39, v10
    s_cbranch_vccnz fz_sy
    ds_read_b32 v104, v217 offset:0
    ds_read_b32 v105, v218 offset:0
    ds_read_b32 v106, v219 offset:0
    ds_read_b32 v107, v220 offset:0
    ds_read_b32 v108, v217 offset:256
    ds_read_b32 v109, v218 offset:256
    ds_read_b32 v110, v219 offset:256
    ds_read_b32 v111, v220 offset:256
    s_waitcnt lgkmcnt(4)
    v_pk_add_f16 v112, v104, v106
    v_pk_add_f16 v114, v105, v107
    v_pk_add_f16 v113, v104, v106 neg_lo:[0,1] neg_hi:[0,1]
    v_pk_add_f16 v115, v105, v107 neg_lo:[0,1] neg_hi:[0,1]
    v_pk_add_f16 v116, v112, v114
    v_pk_add_f16 v118, v112, v114 neg_lo:[0,1] neg_hi:[0,1]
    v_pk_add_f16 v117, v113, v115 op_sel:[0,1] op_sel_hi:[1,0] neg_hi:[0,1]
    v_pk_add_f16 v119, v113, v115 op_sel:[0,1] op_sel_hi:[1,0] neg_lo:[0,1]
    v_add_u32 v116, 0x20002, v116
    v_add_u32 v117, 0x20002, v117
    v_add_u32 v118, 0x20002, v118
    v_add_u32 v119, 0x20002, v119
    v_and_or_b32 v116, v116, v229, s44
    v_and_or_b32 v117, v117, v229, s45
    v_and_or_b32 v118, v118, v229, s46
    v_and_or_b32 v119, v119, v229, s47
    buffer_store_dwordx4 v[116:119], v221, s[4:7], s52 offen sc1
    s_waitcnt lgkmcnt(0)
    v_pk_add_f16 v120, v108, v110
    v_pk_add_f16 v122, v109, v111
    v_pk_add_f16 v121, v108, v110 neg_lo:[0,1] neg_hi:[0,1]
    v_pk_add_f16 v123, v109, v111 neg_lo:[0,1] neg_hi:[0,1]
    v_pk_add_f16 v124, v120, v122
    v_pk_add_f16 v126, v120, v122 neg_lo:[0,1] neg_hi:[0,1]
    v_pk_add_f16 v125, v121, v123 op_sel:[0,1] op_sel_hi:[1,0] neg_hi:[0,1]
    v_pk_add_f16 v127, v121, v123 op_sel:[0,1] op_sel_hi:[1,0] neg_lo:[0,1]
    v_add_u32 v124, 0x20002, v124
    v_add_u32 v125, 0x20002, v125
    v_add_u32 v126, 0x20002, v126
    v_add_u32 v127, 0x20002, v127
    v_and_or_b32 v124, v124, v229, s44
    v_and_or_b32 v125, v125, v229, s45
    v_and_or_b32 v126, v126, v229, s46
    v_and_or_b32 v127, v127, v229, s47
    buffer_store_dwordx4 v[124:127], v221, s[4:7], s53 offen sc1
    s_cmp_lg_u32 s59, 0
    s_cbranch_scc1 ffn
    s_and_b32 s32, s3, 3
    s_lshr_b32 s33, s3, 2
    s_lshl_b32 s33, s33, 4
    s_add_u32 s33, s33, s32
    v_and_b32 v8, 12, v4
    v_bfe_u32 v9, v4, 1, 1
    v_lshl_add_u32 v8, v9, 5, v8
    v_add_u32 v8, s33, v8
    v_cvt_f32_u32 v8, v8
    v_and_b32 v12, 1, v1
    v_cvt_f32_u32 v9, v12
    v_lshlrev_b32 v13, 2, v5
    v_cvt_f32_u32 v10, v13
    v_mul_f32 v11, 0x3c800000, v8
    v_mul_f32 v9, 0x3e800000, v9
    v_fma_f32 v9, v11, v10, v9
    v_mov_b32 v128, v9
    v_fmamk_f32 v129, v11, 0x3f800000, v9
    v_fmamk_f32 v130, v11, 0x40000000, v9
    v_fmamk_f32 v131, v11, 0x40400000, v9
    v_mul_f32 v11, 0x3a000000, v8
    v_lshlrev_b32 v9, 31, v1
    v_xor_b32 v11, v9, v11
    v_mul_f32 v9, v11, v10
    v_mov_b32 v112, v9
    v_fmamk_f32 v113, v11, 0x3f800000, v9
    v_fmamk_f32 v114, v11, 0x40000000, v9
    v_fmamk_f32 v115, v11, 0x40400000, v9
    v_fmamk_f32 v116, v11, 0x41800000, v9
    v_fmamk_f32 v117, v11, 0x41880000, v9
    v_fmamk_f32 v118, v11, 0x41900000, v9
    v_fmamk_f32 v119, v11, 0x41980000, v9
    v_cos_f32 v104, v128
    v_sin_f32 v105, v128
    v_cos_f32 v106, v129
    v_sin_f32 v107, v129
    v_cos_f32 v108, v130
    v_sin_f32 v109, v130
    v_cos_f32 v110, v131
    v_sin_f32 v111, v131
    v_sin_f32 v120, v112
    v_sin_f32 v121, v113
    v_sin_f32 v122, v114
    v_sin_f32 v123, v115
    v_sin_f32 v124, v116
    v_sin_f32 v125, v117
    v_sin_f32 v126, v118
    v_sin_f32 v127, v119
    v_cos_f32 v112, v112
    v_cos_f32 v113, v113
    v_cos_f32 v114, v114
    v_cos_f32 v115, v115
    v_cos_f32 v116, v116
    v_cos_f32 v117, v117
    v_cos_f32 v118, v118
    v_cos_f32 v119, v119
    v_cvt_pk_f16_f32 v16, v104, v105
    v_cvt_pk_f16_f32 v17, v106, v107
    v_cvt_pk_f16_f32 v18, v108, v109
    v_cvt_pk_f16_f32 v19, v110, v111
    v_cvt_pk_f16_f32 v20, v112, v113
    v_cvt_pk_f16_f32 v21, v114, v115
    v_cvt_pk_f16_f32 v22, v116, v117
    v_cvt_pk_f16_f32 v23, v118, v119
    v_cvt_pk_f16_f32 v24, v120, v121
    v_cvt_pk_f16_f32 v25, v122, v123
    v_cvt_pk_f16_f32 v26, v124, v125
    v_cvt_pk_f16_f32 v27, v126, v127
    v_lshrrev_b32 v8, 3, v1
    v_mul_u32_u24 v222, 16512, v8
    v_and_b32 v9, 7, v1
    v_lshl_add_u32 v222, v9, 4, v222
    s_mul_i32 s60, s3, 528384
    s_lshl_b32 s32, s20, 7
    s_add_u32 s60, s60, s32
    s_add_u32 s60, s60, 0x1000
    s_add_u32 s61, s60, 132096
    s_add_u32 s16, s60, 264192
    s_add_u32 s17, s60, 396288
    v_lshlrev_b32 v8, 1, v8
    v_bfe_u32 v9, v1, 2, 1
    v_add_u32 v8, v8, v9
    s_lshl_b32 s32, s3, 2
    s_add_u32 s32, s32, 1
    v_lshl_add_u32 v8, v8, 5, s32
    v_cmp_eq_u32 vcc, 1, v12
    v_bfe_u32 v9, v1, 1, 1
    v_mul_u32_u24 v9, 8256, v9
    v_add_u32 v9, 86400, v9
    s_cmp_eq_u32 s3, 3
    s_cselect_b32 s32, 272, 0
    v_sub_u32 v10, 512, v8
    v_cndmask_b32_e64 v10, v8, v10, vcc
    v_and_b32 v11, 16, v10
    v_lshl_add_u32 v11, v11, 6, v9
    v_lshrrev_b32 v12, 7, v10
    v_lshl_add_u32 v11, v12, 8, v11
    v_and_b32 v12, 15, v10
    v_lshl_add_u32 v11, v12, 4, v11
    v_bfe_u32 v12, v10, 5, 2
    v_lshl_add_u32 v223, v12, 2, v11
    v_add_u32 v8, 1, v8
    v_sub_u32 v10, 512, v8
    v_cndmask_b32_e64 v10, v8, v10, vcc
    v_and_b32 v11, 16, v10
    v_lshl_add_u32 v11, v11, 6, v9
    v_lshrrev_b32 v12, 7, v10
    v_lshl_add_u32 v11, v12, 8, v11
    v_and_b32 v12, 15, v10
    v_lshl_add_u32 v11, v12, 4, v11
    v_bfe_u32 v12, v10, 5, 2
    v_lshl_add_u32 v224, v12, 2, v11
    v_add_u32 v8, 1, v8
    v_sub_u32 v10, 512, v8
    v_cndmask_b32_e64 v10, v8, v10, vcc
    v_and_b32 v11, 16, v10
    v_lshl_add_u32 v11, v11, 6, v9
    v_lshrrev_b32 v12, 7, v10
    v_lshl_add_u32 v11, v12, 8, v11
    v_and_b32 v12, 15, v10
    v_lshl_add_u32 v11, v12, 4, v11
    v_bfe_u32 v12, v10, 5, 2
    v_lshl_add_u32 v100, v12, 2, v11
    v_mul_u32_u24 v10, s32, v3
    v_sub_u32 v8, v8, v10
    v_add_u32 v8, 1, v8
    v_sub_u32 v10, 512, v8
    v_cndmask_b32_e64 v10, v8, v10, vcc
    v_lshrrev_b32 v11, 1, v10
    v_and_b32 v11, 256, v11
    v_sub_u32 v10, v10, v11
    v_and_b32 v11, 16, v10
    v_lshl_add_u32 v11, v11, 6, v9
    v_lshrrev_b32 v12, 7, v10
    v_lshl_add_u32 v11, v12, 8, v11
    v_and_b32 v12, 15, v10
    v_lshl_add_u32 v11, v12, 4, v11
    v_bfe_u32 v12, v10, 5, 2
    v_lshl_add_u32 v101, v12, 2, v11
    s_and_b32 s32, s3, 3
    s_lshl_b32 s32, s32, 11
    s_add_u32 s32, s32, 86400
    v_add_u32 v225, s32, v239
    v_add_u32 v8, s33, v13
    v_sub_u32 v9, 32, v8
    v_min_u32 v9, v8, v9
    v_and_b32 v10, 15, v8
    v_cmp_eq_u32 s[32:33], 0, v10
    v_cmp_lt_u32 s[34:35], 16, v8
    v_lshlrev_b32 v10, 10, v9
    v_subrev_u32 v10, 1024, v10
    v_mov_b32 v11, 15872
    v_cmp_eq_u32 vcc, 0, v8
    s_nop 1
    v_cndmask_b32_e64 v10, v10, v11, vcc
    v_and_b32 v11, 3, v1
    v_lshl_add_u32 v10, v11, 4, v10
    v_lshrrev_b32 v11, 2, v4
    v_lshlrev_b32 v12, 7, v11
    v_sub_u32 v13, 960, v12
    v_cndmask_b32_e64 v13, v12, v13, s[34:35]
    v_add_u32 v226, v10, v13
    s_or_b64 s[34:35], s[34:35], s[32:33]
    v_add_u32 v12, 512, v12
    v_sub_u32 v13, 960, v12
    v_cndmask_b32_e64 v13, v12, v13, s[34:35]
    v_add_u32 v227, v10, v13
    s_mul_i32 s56, s20, 16512
    s_add_u32 s56, s56, 0x210000
    v_mov_b32 v249, 0x30003
    v_mov_b32 v252, s44
    v_mov_b32 v253, s45
    v_mov_b32 v254, s46
    v_mov_b32 v255, s47
    s_waitcnt lgkmcnt(0)
    s_waitcnt vmcnt(0)
    buffer_load_dwordx4 v[104:107], v222, s[4:7], s60 offen sc1
    buffer_load_dwordx4 v[108:111], v222, s[4:7], s61 offen sc1
    buffer_load_dwordx4 v[112:115], v222, s[4:7], s16 offen sc1
    buffer_load_dwordx4 v[116:119], v222, s[4:7], s17 offen sc1
fz_h1_c0:
    s_waitcnt vmcnt(3)
    v_xor_b32 v104, v252, v104
    v_xor_b32 v105, v253, v105
    v_xor_b32 v106, v254, v106
    v_xor_b32 v107, v255, v107
    v_or3_b32 v10, v104, v105, v106
    v_bitop3_b32 v10, v10, v107, v249 bitop3:0xa8
    v_cmp_ne_u32 vcc, 0, v10
    s_cbranch_vccnz fz_h1_r0
fz_h1_o0:
    ds_write_b32 v223, v104 offset:0
    ds_write_b32 v223, v105 offset:2048
    ds_write_b32 v223, v106 offset:4096
    ds_write_b32 v223, v107 offset:6144
fz_h1_c1:
    s_waitcnt vmcnt(2)
    v_xor_b32 v108, v252, v108
    v_xor_b32 v109, v253, v109
    v_xor_b32 v110, v254, v110
    v_xor_b32 v111, v255, v111
    v_or3_b32 v10, v108, v109, v110
    v_bitop3_b32 v10, v10, v111, v249 bitop3:0xa8
    v_cmp_ne_u32 vcc, 0, v10
    s_cbranch_vccnz fz_h1_r1
fz_h1_o1:
    ds_write_b32 v224, v108 offset:0
    ds_write_b32 v224, v109 offset:2048
    ds_write_b32 v224, v110 offset:4096
    ds_write_b32 v224, v111 offset:6144
fz_h1_c2:
    s_waitcnt vmcnt(1)
    v_xor_b32 v112, v252, v112
    v_xor_b32 v113, v253, v113
    v_xor_b32 v114, v254, v114
    v_xor_b32 v115, v255, v115
    v_or3_b32 v10, v112, v113, v114
    v_bitop3_b32 v10, v10, v115, v249 bitop3:0xa8
    v_cmp_ne_u32 vcc, 0, v10
    s_cbranch_vccnz fz_h1_r2
fz_h1_o2:
    ds_write_b32 v100, v112 offset:0
    ds_write_b32 v100, v113 offset:2048
    ds_write_b32 v100, v114 offset:4096
    ds_write_b32 v100, v115 offset:6144
fz_h1_c3:
    s_waitcnt vmcnt(0)
    v_xor_b32 v116, v252, v116
    v_xor_b32 v117, v253, v117
    v_xor_b32 v118, v254, v118
    v_xor_b32 v119, v255, v119
    v_or3_b32 v10, v116, v117, v118
    v_bitop3_b32 v10, v10, v119, v249 bitop3:0xa8
    v_cmp_ne_u32 vcc, 0, v10
    s_cbranch_vccnz fz_h1_r3
fz_h1_o3:
    ds_write_b32 v101, v116 offset:0
    ds_write_b32 v101, v117 offset:2048
    ds_write_b32 v101, v118 offset:4096
    ds_write_b32 v101, v119 offset:6144
    s_waitcnt lgkmcnt(0)
    s_setprio 0
fz_hb:
    s_barrier
    ds_read_b128 v[104:107], v225 offset:0
    ds_read_b128 v[108:111], v225 offset:1024
    ds_read_b128 v[112:115], v225 offset:8256
    ds_read_b128 v[116:119], v225 offset:9280
    ds_read_b128 v[72:75], v6 offset:14336
    ds_read_b128 v[76:79], v6 offset:15360
    ds_read_b128 v[80:83], v6 offset:16384
    ds_read_b128 v[84:87], v6 offset:17408
    s_waitcnt lgkmcnt(7)
    v_mfma_f32_16x16x32_f16 v[120:123], v[104:107], v[16:19], 0
    s_waitcnt lgkmcnt(6)
    v_mfma_f32_16x16x32_f16 v[124:127], v[108:111], v[16:19], 0
    s_waitcnt lgkmcnt(5)
    v_mfma_f32_16x16x32_f16 v[128:131], v[112:115], v[16:19], 0
    s_waitcnt lgkmcnt(4)
    v_mfma_f32_16x16x32_f16 v[132:135], v[116:119], v[16:19], 0
    s_waitcnt lgkmcnt(0)
    s_nop 0
    v_cvt_pk_f16_f32 v136, v120, v121
    v_cvt_pk_f16_f32 v137, v122, v123
    v_cvt_pk_f16_f32 v138, v124, v125
    v_cvt_pk_f16_f32 v139, v126, v127
    v_cvt_pk_f16_f32 v140, v128, v129
    v_cvt_pk_f16_f32 v141, v130, v131
    v_cvt_pk_f16_f32 v142, v132, v133
    v_cvt_pk_f16_f32 v143, v134, v135
    v_pk_mul_f16 v144, v136, v20
    v_pk_mul_f16 v145, v137, v21
    v_pk_mul_f16 v146, v138, v22
    v_pk_mul_f16 v147, v139, v23
    v_mov_b32_dpp v152, v136 quad_perm:[1,0,3,2] row_mask:0xf bank_mask:0xf
    v_mov_b32_dpp v153, v137 quad_perm:[1,0,3,2] row_mask:0xf bank_mask:0xf
    v_mov_b32_dpp v154, v138 quad_perm:[1,0,3,2] row_mask:0xf bank_mask:0xf
    v_mov_b32_dpp v155, v139 quad_perm:[1,0,3,2] row_mask:0xf bank_mask:0xf
    v_pk_fma_f16 v144, v152, v24, v144
    v_pk_fma_f16 v145, v153, v25, v145
    v_pk_fma_f16 v146, v154, v26, v146
    v_pk_fma_f16 v147, v155, v27, v147
    s_nop 1
    v_mfma_f32_16x16x32_f16 v[104:107], v[144:147], v[72:75], 0
    v_mfma_f32_16x16x32_f16 v[108:111], v[144:147], v[80:83], 0
    v_xor_b32_dpp v152, v144, v240 quad_perm:[1,0,3,2] row_mask:0xf bank_mask:0xf
    v_xor_b32_dpp v153, v145, v240 quad_perm:[1,0,3,2] row_mask:0xf bank_mask:0xf
    v_xor_b32_dpp v154, v146, v240 quad_perm:[1,0,3,2] row_mask:0xf bank_mask:0xf
    v_xor_b32_dpp v155, v147, v240 quad_perm:[1,0,3,2] row_mask:0xf bank_mask:0xf
    s_nop 1
    v_mfma_f32_16x16x32_f16 v[104:107], v[152:155], v[76:79], v[104:107]
    v_mfma_f32_16x16x32_f16 v[108:111], v[152:155], v[84:87], v[108:111]
    v_pk_mul_f16 v148, v140, v20
    v_pk_mul_f16 v149, v141, v21
    v_pk_mul_f16 v150, v142, v22
    v_pk_mul_f16 v151, v143, v23
    v_mov_b32_dpp v156, v140 quad_perm:[1,0,3,2] row_mask:0xf bank_mask:0xf
    v_mov_b32_dpp v157, v141 quad_perm:[1,0,3,2] row_mask:0xf bank_mask:0xf
    v_mov_b32_dpp v158, v142 quad_perm:[1,0,3,2] row_mask:0xf bank_mask:0xf
    v_mov_b32_dpp v159, v143 quad_perm:[1,0,3,2] row_mask:0xf bank_mask:0xf
    v_pk_fma_f16 v148, v156, v24, v148
    v_pk_fma_f16 v149, v157, v25, v149
    v_pk_fma_f16 v150, v158, v26, v150
    v_pk_fma_f16 v151, v159, v27, v151
    s_nop 1
    v_mfma_f32_16x16x32_f16 v[112:115], v[148:151], v[72:75], 0
    v_mfma_f32_16x16x32_f16 v[116:119], v[148:151], v[80:83], 0
    v_xor_b32_dpp v156, v148, v240 quad_perm:[1,0,3,2] row_mask:0xf bank_mask:0xf
    v_xor_b32_dpp v157, v149, v240 quad_perm:[1,0,3,2] row_mask:0xf bank_mask:0xf
    v_xor_b32_dpp v158, v150, v240 quad_perm:[1,0,3,2] row_mask:0xf bank_mask:0xf
    v_xor_b32_dpp v159, v151, v240 quad_perm:[1,0,3,2] row_mask:0xf bank_mask:0xf
    s_nop 1
    v_mfma_f32_16x16x32_f16 v[112:115], v[156:159], v[76:79], v[112:115]
    v_mfma_f32_16x16x32_f16 v[116:119], v[156:159], v[84:87], v[116:119]
    v_cvt_pk_f16_f32 v120, v104, v105
    v_cvt_pk_f16_f32 v122, v106, v107
    s_nop 4
    v_cvt_pk_f16_f32 v121, v112, v113
    v_cvt_pk_f16_f32 v123, v114, v115
    v_add_u32 v120, 0x20002, v120
    v_add_u32 v121, 0x20002, v121
    v_add_u32 v122, 0x20002, v122
    v_add_u32 v123, 0x20002, v123
    v_and_or_b32 v120, v120, v229, s44
    v_and_or_b32 v121, v121, v229, s45
    v_and_or_b32 v122, v122, v229, s46
    v_and_or_b32 v123, v123, v229, s47
    buffer_store_dwordx4 v[120:123], v226, s[4:7], s56 offen sc1
    v_cvt_pk_f16_f32 v124, v108, v109
    v_cvt_pk_f16_f32 v126, v110, v111
    v_cvt_pk_f16_f32 v125, v116, v117
    v_cvt_pk_f16_f32 v127, v118, v119
    v_add_u32 v124, 0x20002, v124
    v_add_u32 v125, 0x20002, v125
    v_add_u32 v126, 0x20002, v126
    v_add_u32 v127, 0x20002, v127
    v_and_or_b32 v124, v124, v229, s44
    v_and_or_b32 v125, v125, v229, s45
    v_and_or_b32 v126, v126, v229, s46
    v_and_or_b32 v127, v127, v229, s47
    buffer_store_dwordx4 v[124:127], v227, s[4:7], s56 offen sc1
    s_cmp_lg_u32 s57, 0
    s_cbranch_scc1 fz_nc3
    v_sub_u32 v8, 15, v4
    v_min_u32 v8, v4, v8
    v_and_b32 v9, 1, v8
    v_lshlrev_b32 v9, 5, v9
    v_lshrrev_b32 v10, 1, v8
    v_lshl_add_u32 v9, v10, 9, v9
    v_add_u32 v9, s25, v9
    v_sub_u32 v10, 2048, v9
    v_cmp_lt_u32 s[34:35], 7, v4
    s_nop 1
    v_cndmask_b32_e64 v230, v9, v10, s[34:35]
    v_mov_b32 v9, v4
    v_mov_b32 v10, s20
    s_cmp_lg_u32 s21, 0
    s_cbranch_scc0 fz_spec3a
fz_spec3backa:
    v_lshlrev_b32 v10, 7, v10
    v_lshl_add_u32 v10, v9, 3, v10
    v_mul_u32_u24 v11, 66048, v5
    v_add_u32 v228, v10, v11
    v_and_b32 v9, 1, v9
    v_cmp_eq_u32 vcc, 1, v9
    v_mov_b32 v9, s44
    v_mov_b32 v10, s46
    v_cndmask_b32_e64 v236, v9, v10, vcc
    v_mov_b32 v9, s45
    v_mov_b32 v10, s47
    v_cndmask_b32_e64 v237, v9, v10, vcc
    s_lshl_b32 s32, s3, 2
    v_add_u32 v8, s32, v5
    v_lshlrev_b32 v9, 6, v8
    v_cmp_gt_u32 vcc, 16, v8
    s_nop 1
    v_cndmask_b32_e64 v10, 0, 32, vcc
    v_add_u32 v10, v9, v10
    v_sub_u32 v11, 2048, v10
    v_cmp_eq_u32 vcc, 16, v8
    s_nop 1
    v_cndmask_b32_e64 v11, v11, 0, vcc
    v_mov_b32 v12, 0xffff0000
    v_cndmask_b32_e64 v238, -1, v12, vcc
    v_sub_u32 v12, 2018, v9
    v_mul_u32_u24 v13, 2064, v4
    v_add_u32 v231, v13, v9
    v_add_u32 v232, v13, v12
    v_add_u32 v233, v13, v10
    v_add_u32 v241, v13, v11
    s_lshl_b32 s32, s3, 8
    s_add_u32 s32, s32, 102912
    v_lshlrev_b32 v9, 4, v4
    v_add_u32 v10, s32, v9
    v_add_u32 v11, 107008, v239
    v_cmp_gt_u32 vcc, 16, v1
    s_nop 1
    v_cndmask_b32_e64 v243, v11, v10, vcc
    v_lshrrev_b32 v12, 2, v4
    v_cmp_eq_u32 vcc, v12, v5
    s_nop 1
    v_cndmask_b32_e64 v244, v11, v10, vcc
    v_lshrrev_b32 v12, 5, v1
    v_lshl_add_u32 v10, v12, 10, v9
    v_add_u32 v245, 102912, v10
    v_and_b32 v9, 1, v1
    v_cmp_eq_u32 s[28:29], 1, v9
    v_and_b32 v9, 2, v1
    v_cmp_eq_u32 s[30:31], 2, v9
    s_lshl_b32 s37, s3, 2
    v_add_u32 v9, s37, v5
    v_mul_u32_u24 v246, 2176, v9
    s_lshl_b32 s26, s20, 4
    s_add_u32 s26, s26, 0x420000
    v_lshlrev_b32 v247, 4, v5
    s_lshl_b32 s27, s20, 11
    s_lshl_b32 s37, s3, 8
    s_add_u32 s27, s27, s37
    s_add_u32 s27, s27, 0x448000
    v_sub_u32 v248, 2047, v230
    s_mov_b32 s14, 0x400000
    s_mov_b32 s15, 0x00020000
    s_mul_i32 s52, s3, 264192
    s_add_u32 s52, s52, 0x210000
    s_add_u32 s53, s52, 16512
    s_add_u32 s54, s52, 33024
    s_add_u32 s55, s52, 49536
    s_mov_b32 s23, s63
    s_getreg_b32 s24, hwreg(HW_REG_XCC_ID)
    s_and_b32 s24, s24, 15
    v_lshlrev_b32 v10, 4, v0
    v_min_u32 v10, 4336, v10
    v_add_u32 v10, 108032, v10
    v_mov_b32 v104, 0
    v_mov_b32 v105, 0
    v_mov_b32 v106, 0
    v_mov_b32 v107, 0
    ds_write_b128 v10, v[104:107]
    s_mov_b32 s58, 0
    s_waitcnt vmcnt(0)
    buffer_load_dwordx2 v[104:105], v228, s[4:7], s52 offen sc1
    buffer_load_dwordx2 v[106:107], v228, s[4:7], s53 offen sc1
    buffer_load_dwordx2 v[108:109], v228, s[4:7], s54 offen sc1
    buffer_load_dwordx2 v[110:111], v228, s[4:7], s55 offen sc1
    ds_read_b128 v[116:119], v231
    ds_read_b128 v[120:123], v231 offset:16
    ds_read_u16_d16_hi v44, v241
    ds_read_u16_d16_hi v45, v232 offset:28
    ds_read_u16_d16_hi v46, v232 offset:26
    ds_read_u16_d16_hi v47, v232 offset:24
    ds_read_u16_d16_hi v48, v232 offset:22
    ds_read_u16_d16_hi v49, v232 offset:20
    ds_read_u16_d16_hi v50, v232 offset:18
    ds_read_u16_d16_hi v51, v232 offset:16
    ds_read_u16_d16_hi v52, v232 offset:14
    ds_read_u16_d16_hi v53, v232 offset:12
    ds_read_u16_d16_hi v54, v232 offset:10
    ds_read_u16_d16_hi v55, v232 offset:8
    ds_read_u16_d16_hi v56, v232 offset:6
    ds_read_u16_d16_hi v57, v232 offset:4
    ds_read_u16_d16_hi v58, v232 offset:2
    ds_read_u16_d16_hi v59, v232 offset:0
    ds_read_u16_d16_hi v28, v233
    v_mul_u32_u24 v13, 2064, v4
    v_subrev_u32 v13, 104960, v13
    v_sub_u32 v9, v231, v13
    v_sub_u32 v10, v233, v13
    v_sub_u32 v11, v241, v13
    v_sub_u32 v12, v232, v13
    s_mov_b32 s36, 0xffff0000
    s_waitcnt lgkmcnt(0)
    ds_read_b128 v[200:203], v9
    ds_read_b128 v[204:207], v9 offset:16
    ds_read_u16_d16 v208, v11
    ds_read_u16_d16_hi v124, v12 offset:28
    ds_read_u16_d16 v209, v12 offset:26
    ds_read_u16_d16_hi v125, v12 offset:24
    ds_read_u16_d16 v210, v12 offset:22
    ds_read_u16_d16_hi v126, v12 offset:20
    ds_read_u16_d16 v211, v12 offset:18
    ds_read_u16_d16_hi v127, v12 offset:16
    ds_read_u16_d16 v212, v12 offset:14
    ds_read_u16_d16_hi v128, v12 offset:12
    ds_read_u16_d16 v213, v12 offset:10
    ds_read_u16_d16_hi v129, v12 offset:8
    ds_read_u16_d16 v214, v12 offset:6
    ds_read_u16_d16_hi v130, v12 offset:4
    ds_read_u16_d16 v215, v12 offset:2
    ds_read_u16_d16_hi v131, v12 offset:0
    ds_read_u16_d16 v13, v10
    v_and_b32 v29, s36, v116
    v_lshlrev_b32 v30, 16, v117
    v_and_b32 v31, s36, v117
    v_lshlrev_b32 v32, 16, v118
    v_and_b32 v33, s36, v118
    v_lshlrev_b32 v34, 16, v119
    v_and_b32 v35, s36, v119
    v_lshlrev_b32 v36, 16, v120
    v_and_b32 v37, s36, v120
    v_lshlrev_b32 v38, 16, v121
    v_and_b32 v39, s36, v121
    v_lshlrev_b32 v40, 16, v122
    v_and_b32 v41, s36, v122
    v_lshlrev_b32 v42, 16, v123
    v_and_b32 v43, s36, v123
    v_cmp_eq_u32 vcc, 1, v4
    v_mov_b32 v9, s42
    s_nop 0
    v_cndmask_b32_e64 v9, 0, v9, vcc
    v_mov_b32 v116, s42
    v_mov_b32 v117, s42
    v_mov_b32 v118, s42
    v_mov_b32 v119, s42
    v_cmp_eq_u32 vcc, 0, v4
    s_waitcnt lgkmcnt(0)
    v_and_or_b32 v200, v200, s36, v13
    v_or_b32 v208, v208, v124
    v_or_b32 v209, v209, v125
    v_or_b32 v210, v210, v126
    v_or_b32 v211, v211, v127
    v_or_b32 v212, v212, v128
    v_or_b32 v213, v213, v129
    v_or_b32 v214, v214, v130
    v_or_b32 v215, v215, v131
    v_cndmask_b32_e64 v200, v9, v200, vcc
    v_cndmask_b32_e64 v201, v9, v201, vcc
    v_cndmask_b32_e64 v202, v9, v202, vcc
    v_cndmask_b32_e64 v203, v9, v203, vcc
    v_cndmask_b32_e64 v204, v9, v204, vcc
    v_cndmask_b32_e64 v205, v9, v205, vcc
    v_cndmask_b32_e64 v206, v9, v206, vcc
    v_cndmask_b32_e64 v207, v9, v207, vcc
    v_cndmask_b32_e64 v208, v9, v208, vcc
    v_cndmask_b32_e64 v209, v9, v209, vcc
    v_cndmask_b32_e64 v210, v9, v210, vcc
    v_cndmask_b32_e64 v211, v9, v211, vcc
    v_cndmask_b32_e64 v212, v9, v212, vcc
    v_cndmask_b32_e64 v213, v9, v213, vcc
    v_cndmask_b32_e64 v214, v9, v214, vcc
    v_cndmask_b32_e64 v215, v9, v215, vcc
    v_mfma_f32_16x16x32_bf16 v[120:123], v[200:203], v[116:119], 0
    v_mfma_f32_16x16x32_bf16 v[120:123], v[204:207], v[116:119], v[120:123]
    v_mfma_f32_16x16x32_bf16 v[120:123], v[208:211], v[116:119], v[120:123]
    v_mfma_f32_16x16x32_bf16 v[120:123], v[212:215], v[116:119], v[120:123]
    s_nop 7
    ds_write_b32 v243, v120 offset:12
    s_branch fz_h2c
fz_h2:
    buffer_load_dwordx2 v[104:105], v228, s[4:7], s52 offen sc1
    buffer_load_dwordx2 v[106:107], v228, s[4:7], s53 offen sc1
    buffer_load_dwordx2 v[108:109], v228, s[4:7], s54 offen sc1
    buffer_load_dwordx2 v[110:111], v228, s[4:7], s55 offen sc1
fz_h2c:
    s_mov_b32 s36, 0x43000000
fz_h2_c0:
    s_waitcnt vmcnt(3)
    v_xor_b32 v104, v236, v104
    v_xor_b32 v105, v237, v105
    v_bitop3_b32 v9, v104, v105, v249 bitop3:0xa8
    v_cmp_ne_u32 vcc, 0, v9
    s_cbranch_vccnz fz_h2_r0
fz_h2_o0:
    v_fma_mix_f32 v28, v104, s36, v28 op_sel:[0,0,0] op_sel_hi:[1,0,0]
    v_fma_mix_f32 v29, v104, s36, v29 op_sel:[1,0,0] op_sel_hi:[1,0,0]
    v_fma_mix_f32 v30, v105, s36, v30 op_sel:[0,0,0] op_sel_hi:[1,0,0]
    v_fma_mix_f32 v31, v105, s36, v31 op_sel:[1,0,0] op_sel_hi:[1,0,0]
    v_mov_b32_dpp v112, v104 row_mirror row_mask:0xf bank_mask:0xf
    v_mov_b32_dpp v113, v105 row_mirror row_mask:0xf bank_mask:0xf
fz_h2_c1:
    s_waitcnt vmcnt(2)
    v_xor_b32 v106, v236, v106
    v_xor_b32 v107, v237, v107
    v_bitop3_b32 v9, v106, v107, v249 bitop3:0xa8
    v_cmp_ne_u32 vcc, 0, v9
    s_cbranch_vccnz fz_h2_r1
fz_h2_o1:
    v_fma_mix_f32 v32, v106, s36, v32 op_sel:[0,0,0] op_sel_hi:[1,0,0]
    v_fma_mix_f32 v33, v106, s36, v33 op_sel:[1,0,0] op_sel_hi:[1,0,0]
    v_fma_mix_f32 v34, v107, s36, v34 op_sel:[0,0,0] op_sel_hi:[1,0,0]
    v_fma_mix_f32 v35, v107, s36, v35 op_sel:[1,0,0] op_sel_hi:[1,0,0]
    v_mov_b32_dpp v114, v106 row_mirror row_mask:0xf bank_mask:0xf
    v_mov_b32_dpp v115, v107 row_mirror row_mask:0xf bank_mask:0xf
fz_h2_c2:
    s_waitcnt vmcnt(1)
    v_xor_b32 v108, v236, v108
    v_xor_b32 v109, v237, v109
    v_bitop3_b32 v9, v108, v109, v249 bitop3:0xa8
    v_cmp_ne_u32 vcc, 0, v9
    s_cbranch_vccnz fz_h2_r2
fz_h2_o2:
    v_fma_mix_f32 v36, v108, s36, v36 op_sel:[0,0,0] op_sel_hi:[1,0,0]
    v_fma_mix_f32 v37, v108, s36, v37 op_sel:[1,0,0] op_sel_hi:[1,0,0]
    v_fma_mix_f32 v38, v109, s36, v38 op_sel:[0,0,0] op_sel_hi:[1,0,0]
    v_fma_mix_f32 v39, v109, s36, v39 op_sel:[1,0,0] op_sel_hi:[1,0,0]
    v_mov_b32_dpp v116, v108 row_mirror row_mask:0xf bank_mask:0xf
    v_mov_b32_dpp v117, v109 row_mirror row_mask:0xf bank_mask:0xf
fz_h2_c3:
    s_waitcnt vmcnt(0)
    v_xor_b32 v110, v236, v110
    v_xor_b32 v111, v237, v111
    v_bitop3_b32 v9, v110, v111, v249 bitop3:0xa8
    v_cmp_ne_u32 vcc, 0, v9
    s_cbranch_vccnz fz_h2_r3
fz_h2_o3:
    v_fma_mix_f32 v40, v110, s36, v40 op_sel:[0,0,0] op_sel_hi:[1,0,0]
    v_fma_mix_f32 v41, v110, s36, v41 op_sel:[1,0,0] op_sel_hi:[1,0,0]
    v_fma_mix_f32 v42, v111, s36, v42 op_sel:[0,0,0] op_sel_hi:[1,0,0]
    v_fma_mix_f32 v43, v111, s36, v43 op_sel:[1,0,0] op_sel_hi:[1,0,0]
    v_mov_b32_dpp v118, v110 row_mirror row_mask:0xf bank_mask:0xf
    v_mov_b32_dpp v119, v111 row_mirror row_mask:0xf bank_mask:0xf
    s_cmp_eq_u32 s2, 66
    s_cbranch_scc1 fz_spec4
fz_spec4back:
    v_cvt_pk_bf16_f32 v120, v28, v29
    v_cvt_pk_bf16_f32 v121, v30, v31
    v_cvt_pk_bf16_f32 v122, v32, v33
    v_cvt_pk_bf16_f32 v123, v34, v35
    v_cvt_pk_bf16_f32 v124, v36, v37
    v_cvt_pk_bf16_f32 v125, v38, v39
    v_cvt_pk_bf16_f32 v126, v40, v41
    v_cvt_pk_bf16_f32 v127, v42, v43
    v_and_b32 v112, v238, v112
    v_mfma_f32_16x16x32_bf16 v[136:139], v[120:123], v[120:123], 0
    v_mfma_f32_16x16x32_bf16 v[140:143], v[200:203], v[120:123], 0
    v_mfma_f32_16x16x32_bf16 v[136:139], v[124:127], v[124:127], v[136:139]
    v_mfma_f32_16x16x32_bf16 v[140:143], v[204:207], v[124:127], v[140:143]
    v_fma_mix_f32 v44, v112, s36, v44 op_sel:[0,0,0] op_sel_hi:[1,0,0]
    v_fma_mix_f32 v45, v112, s36, v45 op_sel:[1,0,0] op_sel_hi:[1,0,0]
    v_fma_mix_f32 v46, v113, s36, v46 op_sel:[0,0,0] op_sel_hi:[1,0,0]
    v_fma_mix_f32 v47, v113, s36, v47 op_sel:[1,0,0] op_sel_hi:[1,0,0]
    v_fma_mix_f32 v48, v114, s36, v48 op_sel:[0,0,0] op_sel_hi:[1,0,0]
    v_fma_mix_f32 v49, v114, s36, v49 op_sel:[1,0,0] op_sel_hi:[1,0,0]
    v_fma_mix_f32 v50, v115, s36, v50 op_sel:[0,0,0] op_sel_hi:[1,0,0]
    v_fma_mix_f32 v51, v115, s36, v51 op_sel:[1,0,0] op_sel_hi:[1,0,0]
    v_fma_mix_f32 v52, v116, s36, v52 op_sel:[0,0,0] op_sel_hi:[1,0,0]
    v_fma_mix_f32 v53, v116, s36, v53 op_sel:[1,0,0] op_sel_hi:[1,0,0]
    v_fma_mix_f32 v54, v117, s36, v54 op_sel:[0,0,0] op_sel_hi:[1,0,0]
    v_fma_mix_f32 v55, v117, s36, v55 op_sel:[1,0,0] op_sel_hi:[1,0,0]
    v_fma_mix_f32 v56, v118, s36, v56 op_sel:[0,0,0] op_sel_hi:[1,0,0]
    v_fma_mix_f32 v57, v118, s36, v57 op_sel:[1,0,0] op_sel_hi:[1,0,0]
    v_fma_mix_f32 v58, v119, s36, v58 op_sel:[0,0,0] op_sel_hi:[1,0,0]
    v_fma_mix_f32 v59, v119, s36, v59 op_sel:[1,0,0] op_sel_hi:[1,0,0]
    v_cvt_pk_bf16_f32 v128, v44, v45
    v_cvt_pk_bf16_f32 v129, v46, v47
    v_cvt_pk_bf16_f32 v130, v48, v49
    v_cvt_pk_bf16_f32 v131, v50, v51
    v_cvt_pk_bf16_f32 v132, v52, v53
    v_cvt_pk_bf16_f32 v133, v54, v55
    v_cvt_pk_bf16_f32 v134, v56, v57
    v_cvt_pk_bf16_f32 v135, v58, v59
    v_mfma_f32_16x16x32_bf16 v[136:139], v[128:131], v[128:131], v[136:139]
    v_mfma_f32_16x16x32_bf16 v[140:143], v[208:211], v[128:131], v[140:143]
    v_mfma_f32_16x16x32_bf16 v[136:139], v[132:135], v[132:135], v[136:139]
    v_mfma_f32_16x16x32_bf16 v[140:143], v[212:215], v[132:135], v[140:143]
    s_nop 6
    v_cndmask_b32_e64 v9, v136, v137, s[28:29]
    v_cndmask_b32_e64 v10, v138, v139, s[28:29]
    ds_write_b64 v243, v[140:141]
    v_cndmask_b32_e64 v9, v9, v10, s[30:31]
    ds_write_b32 v244, v9 offset:8
    s_cmp_gt_u32 s3, 3
    s_cbranch_scc1 fz_lp
    s_setprio 2
fz_lp:
    s_waitcnt lgkmcnt(0)
    s_barrier
    ds_read_b128 v[144:147], v245 offset:0
    ds_read_b128 v[148:151], v245 offset:256
    ds_read_b128 v[152:155], v245 offset:512
    ds_read_b128 v[156:159], v245 offset:768
    s_waitcnt lgkmcnt(2)
    v_pk_add_f32 v[144:145], v[144:145], v[148:149]
    v_pk_add_f32 v[146:147], v[146:147], v[150:151]
    s_waitcnt lgkmcnt(0)
    v_pk_add_f32 v[152:153], v[152:153], v[156:157]
    v_pk_add_f32 v[154:155], v[154:155], v[158:159]
    v_pk_add_f32 v[144:145], v[144:145], v[152:153]
    v_pk_add_f32 v[146:147], v[146:147], v[154:155]
    v_mov_b32 v148, v144
    v_mov_b32 v149, v145
    v_mov_b32 v150, v146
    v_mov_b32 v151, v147
    v_permlane32_swap_b32 v144, v148
    v_permlane32_swap_b32 v145, v149
    v_permlane32_swap_b32 v146, v150
    v_permlane32_swap_b32 v147, v151
    v_pk_add_f32 v[144:145], v[144:145], v[148:149]
    v_pk_add_f32 v[146:147], v[146:147], v[150:151]
    v_mul_f32 v145, 0xba800000, v145
    v_mul_f32 v146, 0x3a800000, v146
    v_fma_f32 v146, -v145, v145, v146
    v_cvt_pk_bf16_f32 v153, 0, v145
    v_cvt_pk_bf16_f32 v146, 0, v146
    v_add_f32 v146, 0x3727c5ac, v146
    v_cvt_pk_bf16_f32 v146, 0, v146
    v_sqrt_f32 v146, v146
    v_fmac_f32 v144, v153, v147
    v_cvt_pk_bf16_f32 v146, 0, v146
    v_rcp_f32 v154, v146
    v_mov_b32 v155, s40
    v_mul_f32 v144, v144, v154
    v_cvt_pk_bf16_f32 v144, 0, v144
    v_ashrrev_i32 v145, 31, v144
    v_or_b32 v145, 0x80000000, v145
    v_bitop3_b32 v152, v144, v145, v242 bitop3:0x28
    v_or_b32 v152, v152, v248
    s_nop 1
    v_max_u32_dpp v144, v152, v152 row_ror:1 row_mask:0xf bank_mask:0xf
    s_nop 1
    v_max_u32_dpp v144, v144, v144 row_ror:2 row_mask:0xf bank_mask:0xf
    s_nop 1
    v_max_u32_dpp v144, v144, v144 row_ror:4 row_mask:0xf bank_mask:0xf
    s_nop 1
    v_max_u32_dpp v144, v144, v144 row_ror:8 row_mask:0xf bank_mask:0xf
    v_cmp_eq_u32 vcc, v144, v152
    v_or_b32 v153, s24, v153
    s_nop 0
    s_mov_b64 exec, vcc
    buffer_store_dwordx4 v[152:155], v246, s[4:7], s26 offen sc1
    s_add_u32 s26, s26, 69632
    buffer_store_dwordx4 v[152:155], v246, s[4:7], s26 offen sc1
    buffer_store_dwordx4 v[120:123], v247, s[4:7], s27 offen offset:0 sc1
    buffer_store_dwordx4 v[124:127], v247, s[4:7], s27 offen offset:64 sc1
    buffer_store_dwordx4 v[128:131], v247, s[4:7], s27 offen offset:128 sc1
    buffer_store_dwordx4 v[132:135], v247, s[4:7], s27 offen offset:192 sc1
    s_mov_b64 exec, -1
    s_setprio 0
    s_ff1_i32_b64 s37, vcc
    v_add_f32 v144, 1.0, v154
    v_and_b32 v146, v242, v153
    v_mul_f32 v146, v146, v154
    v_pk_fma_f32 v[28:29], v[28:29], v[144:145], v[146:147] op_sel_hi:[1,0,0]
    v_pk_fma_f32 v[30:31], v[30:31], v[144:145], v[146:147] op_sel_hi:[1,0,0]
    v_pk_fma_f32 v[32:33], v[32:33], v[144:145], v[146:147] op_sel_hi:[1,0,0]
    v_pk_fma_f32 v[34:35], v[34:35], v[144:145], v[146:147] op_sel_hi:[1,0,0]
    v_pk_fma_f32 v[36:37], v[36:37], v[144:145], v[146:147] op_sel_hi:[1,0,0]
    v_pk_fma_f32 v[38:39], v[38:39], v[144:145], v[146:147] op_sel_hi:[1,0,0]
    v_pk_fma_f32 v[40:41], v[40:41], v[144:145], v[146:147] op_sel_hi:[1,0,0]
    v_pk_fma_f32 v[42:43], v[42:43], v[144:145], v[146:147] op_sel_hi:[1,0,0]
    v_pk_fma_f32 v[44:45], v[44:45], v[144:145], v[146:147] op_sel_hi:[1,0,0]
    v_pk_fma_f32 v[46:47], v[46:47], v[144:145], v[146:147] op_sel_hi:[1,0,0]
    v_pk_fma_f32 v[48:49], v[48:49], v[144:145], v[146:147] op_sel_hi:[1,0,0]
    v_pk_fma_f32 v[50:51], v[50:51], v[144:145], v[146:147] op_sel_hi:[1,0,0]
    v_pk_fma_f32 v[52:53], v[52:53], v[144:145], v[146:147] op_sel_hi:[1,0,0]
    v_pk_fma_f32 v[54:55], v[54:55], v[144:145], v[146:147] op_sel_hi:[1,0,0]
    v_pk_fma_f32 v[56:57], v[56:57], v[144:145], v[146:147] op_sel_hi:[1,0,0]
    v_pk_fma_f32 v[58:59], v[58:59], v[144:145], v[146:147] op_sel_hi:[1,0,0]
    v_cvt_pk_bf16_f32 v104, v28, v29
    v_cvt_pk_bf16_f32 v105, v30, v31
    v_cvt_pk_bf16_f32 v106, v32, v33
    v_cvt_pk_bf16_f32 v107, v34, v35
    v_cvt_pk_bf16_f32 v108, v36, v37
    v_cvt_pk_bf16_f32 v109, v38, v39
    v_cvt_pk_bf16_f32 v110, v40, v41
    v_cvt_pk_bf16_f32 v111, v42, v43
    v_cvt_pk_bf16_f32 v112, v44, v45
    v_cvt_pk_bf16_f32 v113, v46, v47
    v_cvt_pk_bf16_f32 v114, v48, v49
    v_cvt_pk_bf16_f32 v115, v50, v51
    v_cvt_pk_bf16_f32 v116, v52, v53
    v_cvt_pk_bf16_f32 v117, v54, v55
    v_cvt_pk_bf16_f32 v118, v56, v57
    v_cvt_pk_bf16_f32 v119, v58, v59
    ds_write_b128 v231, v[104:107]
    ds_write_b128 v231, v[108:111] offset:16
    s_waitcnt lgkmcnt(0)
    s_barrier
    ds_write_b16 v233, v104
    ds_write_b16 v241, v112
    ds_write_b16_d16_hi v232, v112 offset:28
    ds_write_b16 v232, v113 offset:26
    ds_write_b16_d16_hi v232, v113 offset:24
    ds_write_b16 v232, v114 offset:22
    ds_write_b16_d16_hi v232, v114 offset:20
    ds_write_b16 v232, v115 offset:18
    ds_write_b16_d16_hi v232, v115 offset:16
    ds_write_b16 v232, v116 offset:14
    ds_write_b16_d16_hi v232, v116 offset:12
    ds_write_b16 v232, v117 offset:10
    ds_write_b16_d16_hi v232, v117 offset:8
    ds_write_b16 v232, v118 offset:6
    ds_write_b16_d16_hi v232, v118 offset:4
    ds_write_b16 v232, v119 offset:2
    ds_write_b16_d16_hi v232, v119 offset:0
    s_lshl_b32 s32, s3, 1
    s_add_u32 s33, s32, 1
    v_readlane_b32 s34, v230, s32
    v_readlane_b32 s35, v230, s33
    s_mul_i32 s38, s3, 4128
    v_add_u32 v9, s38, v239
    s_lshl_b32 s34, s34, 11
    s_lshl_b32 s35, s35, 11
    s_waitcnt lgkmcnt(0)
    s_barrier
    ds_read_b128 v[104:107], v9 offset:0
    ds_read_b128 v[108:111], v9 offset:1024
    ds_read_b128 v[112:115], v9 offset:2064
    ds_read_b128 v[116:119], v9 offset:3088
    s_lshr_b32 s59, s37, 1
    s_xor_b32 s18, s59, 1
    s_and_b32 s18, s18, 3
    s_cmp_lt_u32 s23, 112
    s_cselect_b32 s38, s18, 8
    s_cmp_eq_u32 s38, s3
    s_cbranch_scc1 fz_sk1
    s_waitcnt lgkmcnt(0)
    s_cmp_eq_u32 s37, s32
    s_cbranch_scc1 fz_sk0
    buffer_store_dwordx4 v[104:107], v239, s[12:15], s34 offen offset:0 sc1
    buffer_store_dwordx4 v[108:111], v239, s[12:15], s34 offen offset:1024 sc1
fz_sk0:
    s_cmp_eq_u32 s37, s33
    s_cbranch_scc1 fz_sk1
    buffer_store_dwordx4 v[112:115], v239, s[12:15], s35 offen offset:0 sc1
    buffer_store_dwordx4 v[116:119], v239, s[12:15], s35 offen offset:1024 sc1
fz_sk1:
    v_and_b32 v15, 7, v4
    v_mul_u32_u24 v15, 544, v15
    v_lshl_add_u32 v15, v5, 4, v15
    v_add_u32 v15, 108032, v15
    s_mul_i32 s63, s23, 4224
    s_and_b32 s38, s3, 3
    s_lshl_b32 s38, s38, 10
    s_add_u32 s63, s63, s38
    s_add_u32 s63, s63, 0x4c8000
    s_lshl_b32 s38, s20, 10
    s_add_u32 s38, s38, 0x548000
    s_cmp_lt_u32 s3, 4
    s_cselect_b32 s63, s38, s63
    v_mov_b32 v14, 0xffffff00
    s_cmp_eq_u32 s18, s3
    s_cbranch_scc1 fz_act
    s_cmp_lg_u32 s59, s3
    s_cbranch_scc1 fz_f2
    s_and_b32 s38, s20, 15
    s_add_u32 s38, s38, 16
    s_mul_i32 s38, s38, 2176
    s_add_u32 s38, s38, 0x420000
    s_lshr_b32 s52, s20, 4
    s_lshl_b32 s52, s52, 7
    s_and_b32 s53, s20, 7
    s_lshl_b32 s53, s53, 4
    s_add_u32 s52, s52, s53
    s_bfe_u32 s53, s20, 0x10003
    s_lshl_b32 s53, s53, 2
    s_add_u32 s52, s52, s53
    v_and_b32 v2, 1, v1
    v_lshl_add_u32 v2, v2, 3, v5
    v_add_u32 v2, s52, v2
    v_and_b32 v3, 31, v2
    v_lshrrev_b32 v6, 5, v2
    v_cmp_gt_u32 vcc, 16, v6
    v_cmp_lt_u32 s[52:53], 16, v3
    v_cmp_eq_u32 s[54:55], 0, v3
    s_nop 1
    s_and_b64 s[54:55], s[54:55], vcc
    s_or_b64 s[52:53], s[52:53], s[54:55]
    v_cmp_eq_u32 s[54:55], 16, v3
    s_nop 1
    s_andn2_b64 s[54:55], s[54:55], vcc
    s_or_b64 s[52:53], s[52:53], s[54:55]
    v_sub_u32 v7, 1024, v2
    v_cndmask_b32_e64 v7, v2, v7, s[52:53]
    v_mov_b32 v8, 512
    v_cmp_eq_u32 vcc, 1024, v7
    s_nop 1
    v_cndmask_b32_e64 v7, v7, v8, vcc
    v_lshrrev_b32 v8, 5, v7
    v_and_b32 v7, 15, v7
    v_lshrrev_b32 v9, 2, v8
    v_lshlrev_b32 v9, 8, v9
    v_and_b32 v8, 3, v8
    v_lshl_add_u32 v9, v8, 4, v9
    v_lshrrev_b32 v8, 3, v7
    v_lshl_add_u32 v9, v8, 6, v9
    v_and_b32 v7, 7, v7
    v_lshl_add_u32 v9, v7, 1, v9
    v_cndmask_b32_e64 v7, 0, 1, s[52:53]
    v_lshl_add_u32 v9, v7, 7, v9
    v_lshlrev_b32 v2, 1, v2
    v_lshrrev_b32 v3, 1, v1
    v_mul_u32_u24 v3, 4224, v3
    v_and_b32 v6, 1, v1
    v_lshl_add_u32 v3, v6, 4, v3
    v_mov_b32 v6, 0x7fffffff
    v_cmp_gt_u32 vcc, 32, v1
    s_nop 1
    v_cndmask_b32_e64 v6, v6, v3, vcc
    v_mov_b32 v7, s48
    v_cndmask_b32_e64 v16, 0, v7, vcc
    v_mov_b32 v7, s49
    v_cndmask_b32_e64 v17, 0, v7, vcc
    v_mov_b32 v7, s50
    v_cndmask_b32_e64 v18, 0, v7, vcc
    v_mov_b32 v7, s51
    v_cndmask_b32_e64 v19, 0, v7, vcc
    s_lshl_b32 s52, s20, 5
    s_add_u32 s52, s52, 0x4c8000
    s_add_u32 s53, s52, 135168
    s_add_u32 s54, s52, 270336
    s_add_u32 s55, s52, 405504
    s_mov_b32 s58, 0
    s_nop 0
fz_k2:
    buffer_load_dwordx4 v[24:27], v239, s[4:7], s38 offen sc1
    buffer_load_dwordx4 v[28:31], v239, s[4:7], s38 offen offset:1024 sc1
    s_waitcnt vmcnt(0)
    v_xor_b32 v32, s40, v27
    v_xor_b32 v33, s40, v31
    v_max_u32 v34, v24, v28
    v_or_b32 v32, v32, v33
    v_cmp_ne_u32 vcc, 0, v32
    s_cbranch_vccnz fz_k2_rt
fz_k2_ok:
    v_max_u32_dpp v34, v34, v34 quad_perm:[1,0,3,2] row_mask:0xf bank_mask:0xf
    s_nop 1
    v_max_u32_dpp v34, v34, v34 quad_perm:[2,3,0,1] row_mask:0xf bank_mask:0xf
    s_nop 1
    v_max_u32_dpp v34, v34, v34 row_half_mirror row_mask:0xf bank_mask:0xf
    s_nop 1
    v_max_u32_dpp v34, v34, v34 row_mirror row_mask:0xf bank_mask:0xf
    s_nop 1
    v_max_u32_dpp v34, v34, v34 row_bcast:15 row_mask:0xa bank_mask:0xf
    s_nop 1
    v_max_u32_dpp v34, v34, v34 row_bcast:31 row_mask:0xc bank_mask:0xf
    s_nop 0
    v_readlane_b32 s36, v34, 63
    s_nop 1
    v_cmp_eq_u32 vcc, s36, v24
    v_cmp_eq_u32 s[56:57], s36, v28
    s_nop 1
    v_cndmask_b32_e64 v25, v25, v29, s[56:57]
    v_cndmask_b32_e64 v26, v26, v30, s[56:57]
    s_cmp_lg_u64 vcc, 0
    s_cselect_b32 s39, 0, 64
    s_or_b64 vcc, vcc, s[56:57]
    s_ff1_i32_b64 s41, vcc
    v_readlane_b32 s42, v25, s41
    v_readlane_b32 s43, v26, s41
    s_add_u32 s39, s39, s41
    s_and_b32 s42, s42, 0xffff0000
    s_cmp_eq_u32 s39, s20
    s_cbranch_scc1 fz_win
    s_bitcmp1_b32 s37, 0
    s_cbranch_scc1 fz_d1
    buffer_store_dwordx4 v[104:107], v239, s[12:15], s34 offen offset:0 sc1
    buffer_store_dwordx4 v[108:111], v239, s[12:15], s34 offen offset:1024 sc1
    s_branch fz_win
fz_d1:
    buffer_store_dwordx4 v[112:115], v239, s[12:15], s35 offen offset:0 sc1
    buffer_store_dwordx4 v[116:119], v239, s[12:15], s35 offen offset:1024 sc1
fz_win:
    s_lshl_b32 s39, s39, 11
    s_add_u32 s39, s39, 0x448000
    s_mov_b32 s58, 0
    s_mov_b32 s41, 0xffff0000
    s_nop 0
fz_c2:
    buffer_load_short_d16_hi v10, v9, s[4:7], s39 offen sc1
    s_waitcnt vmcnt(0)
    v_cmp_eq_u32 vcc, s41, v10
    s_cbranch_vccnz fz_c2_rt
fz_c2_ok:
    v_add_f32 v11, s42, v10
    v_cvt_pk_bf16_f32 v11, 0, v11
    v_mul_f32 v11, s43, v11
    v_cvt_pk_bf16_f32 v11, 0, v11
    s_ashr_i32 s39, s36, 31
    s_not_b32 s39, s39
    s_or_b32 s39, s39, 0x80000000
    s_xor_b32 s39, s36, s39
    s_and_b32 s39, s39, 0xffff0000
    v_mov_b32 v12, s39
    v_mul_f32 v12, 0xbfb8aa3b, v12
    v_exp_f32 v12, v12
    s_nop 0
    v_add_f32 v12, 1.0, v12
    v_rcp_f32 v12, v12
    s_nop 0
    v_cvt_pk_bf16_f32 v12, 0, v12
    s_and_b32 s39, s36, 0xffff
    s_sub_u32 s39, 2047, s39
    s_lshl_b32 s39, s39, 11
    v_mov_b32 v13, 0xff
fz_f2:
    s_cmp_gt_u32 s23, 111
    s_cbranch_scc1 fz_nof2
    s_barrier
    s_cmp_eq_u32 s59, s3
    s_cselect_b32 s19, 4, s3
    s_cmp_lt_u32 s19, 4
    s_cbranch_scc1 fz_f2d
    ds_read_b128 v[120:123], v15 offset:0
    ds_read_b128 v[124:127], v15 offset:64
    ds_read_b128 v[128:131], v15 offset:128
    ds_read_b128 v[132:135], v15 offset:192
    ds_read_b128 v[136:139], v15 offset:256
    ds_read_b128 v[140:143], v15 offset:320
    ds_read_b128 v[144:147], v15 offset:384
    ds_read_b128 v[148:151], v15 offset:448
    s_waitcnt lgkmcnt(7)
    v_mfma_f32_16x16x32_bf16 v[152:155], v[120:123], v[160:163], 0
    v_mfma_f32_16x16x32_bf16 v[156:159], v[120:123], v[164:167], 0
    s_waitcnt lgkmcnt(6)
    v_mfma_f32_16x16x32_bf16 v[152:155], v[124:127], v[168:171], v[152:155]
    v_mfma_f32_16x16x32_bf16 v[156:159], v[124:127], v[172:175], v[156:159]
    s_waitcnt lgkmcnt(5)
    v_mfma_f32_16x16x32_bf16 v[152:155], v[128:131], v[176:179], v[152:155]
    v_mfma_f32_16x16x32_bf16 v[156:159], v[128:131], v[180:183], v[156:159]
    s_waitcnt lgkmcnt(4)
    v_mfma_f32_16x16x32_bf16 v[152:155], v[132:135], v[184:187], v[152:155]
    v_mfma_f32_16x16x32_bf16 v[156:159], v[132:135], v[188:191], v[156:159]
    s_waitcnt lgkmcnt(3)
    v_mfma_f32_16x16x32_bf16 v[152:155], v[136:139], v[192:195], v[152:155]
    v_mfma_f32_16x16x32_bf16 v[156:159], v[136:139], v[196:199], v[156:159]
    s_waitcnt lgkmcnt(2)
    v_mfma_f32_16x16x32_bf16 v[152:155], v[140:143], v[60:63], v[152:155]
    v_mfma_f32_16x16x32_bf16 v[156:159], v[140:143], v[64:67], v[156:159]
    s_waitcnt lgkmcnt(1)
    v_mfma_f32_16x16x32_bf16 v[152:155], v[144:147], v[68:71], v[152:155]
    v_mfma_f32_16x16x32_bf16 v[156:159], v[144:147], v[88:91], v[156:159]
    s_waitcnt lgkmcnt(0)
    v_mfma_f32_16x16x32_bf16 v[152:155], v[148:151], v[92:95], v[152:155]
    v_mfma_f32_16x16x32_bf16 v[156:159], v[148:151], v[96:99], v[156:159]
    s_mov_b32 exec_hi, 0
    s_nop 5
    v_and_or_b32 v152, v152, v14, s48
    v_and_or_b32 v153, v153, v14, s49
    v_and_or_b32 v154, v154, v14, s50
    v_and_or_b32 v155, v155, v14, s51
    buffer_store_dwordx4 v[152:155], v239, s[4:7], s63 offen offset:0 sc1
    v_and_or_b32 v156, v156, v14, s48
    v_and_or_b32 v157, v157, v14, s49
    v_and_or_b32 v158, v158, v14, s50
    v_and_or_b32 v159, v159, v14, s51
    buffer_store_dwordx4 v[156:159], v239, s[4:7], s63 offen offset:512 sc1
fz_f2d:
    s_mov_b32 exec_hi, -1
    s_cmp_eq_u32 s18, s3
    s_cbranch_scc1 fz_late
    s_cmp_lg_u32 s59, s3
    s_cbranch_scc1 fz_xend
    v_mov_b32 v7, 0
    s_waitcnt vmcnt(0)
    s_branch fz_p5_ok
    s_nop 2
fz_nof2:
    s_cmp_lg_u32 s59, s3
    s_cbranch_scc1 fz_xend
    s_mov_b32 s58, 0
    s_and_b32 s41, s20, 63
    s_mul_i32 s41, s41, 4224
    s_add_u32 s41, s41, s52
    v_mov_b32 v7, 0
    s_nop 4
fz_p5:
    buffer_load_dword v8, v7, s[4:7], s41 offen sc1
    s_waitcnt vmcnt(0)
    v_and_b32 v8, 0xff, v8
    v_cmp_ne_u32 vcc, s48, v8
    s_cbranch_vccnz fz_p5_rt
fz_p5_ok:
    s_mov_b32 s58, 0
    buffer_load_dwordx4 v[40:43], v3, s[4:7], s52 offen sc1
    buffer_load_dwordx4 v[44:47], v3, s[4:7], s53 offen sc1
    buffer_load_dwordx4 v[48:51], v3, s[4:7], s54 offen sc1
    buffer_load_dwordx4 v[52:55], v6, s[4:7], s55 offen sc1
fz_h5_c0:
    s_waitcnt vmcnt(3)
    v_xor_b32 v40, s48, v40
    v_xor_b32 v41, s49, v41
    v_xor_b32 v42, s50, v42
    v_xor_b32 v43, s51, v43
    v_or3_b32 v8, v40, v41, v42
    v_bitop3_b32 v8, v8, v43, v13 bitop3:0xa8
    v_cmp_ne_u32 vcc, 0, v8
    s_cbranch_vccnz fz_h5_r0
fz_h5_o0:
fz_h5_c1:
    s_waitcnt vmcnt(2)
    v_xor_b32 v44, s48, v44
    v_xor_b32 v45, s49, v45
    v_xor_b32 v46, s50, v46
    v_xor_b32 v47, s51, v47
    v_or3_b32 v8, v44, v45, v46
    v_bitop3_b32 v8, v8, v47, v13 bitop3:0xa8
    v_cmp_ne_u32 vcc, 0, v8
    s_cbranch_vccnz fz_h5_r1
fz_h5_o1:
    v_pk_add_f32 v[40:41], v[40:41], v[44:45]
    v_pk_add_f32 v[42:43], v[42:43], v[46:47]
fz_h5_c2:
    s_waitcnt vmcnt(1)
    v_xor_b32 v48, s48, v48
    v_xor_b32 v49, s49, v49
    v_xor_b32 v50, s50, v50
    v_xor_b32 v51, s51, v51
    v_or3_b32 v8, v48, v49, v50
    v_bitop3_b32 v8, v8, v51, v13 bitop3:0xa8
    v_cmp_ne_u32 vcc, 0, v8
    s_cbranch_vccnz fz_h5_r2
fz_h5_o2:
    v_pk_add_f32 v[40:41], v[40:41], v[48:49]
    v_pk_add_f32 v[42:43], v[42:43], v[50:51]
fz_h5_c3:
    s_waitcnt vmcnt(0)
    v_xor_b32 v52, v16, v52
    v_xor_b32 v53, v17, v53
    v_xor_b32 v54, v18, v54
    v_xor_b32 v55, v19, v55
    v_or3_b32 v8, v52, v53, v54
    v_bitop3_b32 v8, v8, v55, v13 bitop3:0xa8
    v_cmp_ne_u32 vcc, 0, v8
    s_cbranch_vccnz fz_h5_r3
fz_h5_o3:
    v_pk_add_f32 v[40:41], v[40:41], v[52:53]
    v_pk_add_f32 v[42:43], v[42:43], v[54:55]
    s_nop 1
    v_permlane32_swap_b32 v40, v42
    v_permlane32_swap_b32 v41, v43
    v_pk_add_f32 v[40:41], v[40:41], v[42:43]
    s_nop 1
    v_permlane16_swap_b32 v40, v41
    v_add_f32 v40, v40, v41
    s_nop 1
    v_add_f32_dpp v40, v40, v40 quad_perm:[2,3,0,1] row_mask:0xf bank_mask:0xf
    s_nop 1
    v_add_f32_dpp v40, v40, v40 row_ror:4 row_mask:0xf bank_mask:0xf
    s_nop 1
    v_add_f32_dpp v40, v40, v40 row_ror:8 row_mask:0xf bank_mask:0xf
    v_cvt_pk_bf16_f32 v40, 0, v40
    v_mul_f32 v40, v40, v12
    v_cvt_pk_bf16_f32 v40, 0, v40
    v_add_f32 v40, v40, v11
    v_cvt_pk_bf16_f32 v40, 0, v40
    v_add_f32 v40, v40, v10
    v_cvt_pk_bf16_f32 v40, 0, v40
    s_mov_b32 exec_lo, 0x00030003
    s_mov_b32 exec_hi, 0x00030003
    buffer_store_short_d16_hi v40, v2, s[12:15], s39 offen
    s_cmp_lg_u32 s20, 0
    s_cbranch_scc1 fz_xend
    s_mov_b64 exec, 1
    v_mov_b32 v8, s40
    buffer_store_dword v8, v7, s[4:7], 0 offen
fz_xend:
fz_end:
    s_endpgm
fz_late:
    buffer_store_dwordx4 v[104:107], v239, s[12:15], s34 offen offset:0 sc1
    buffer_store_dwordx4 v[108:111], v239, s[12:15], s34 offen offset:1024 sc1
    buffer_store_dwordx4 v[112:115], v239, s[12:15], s35 offen offset:0 sc1
    buffer_store_dwordx4 v[116:119], v239, s[12:15], s35 offen offset:1024 sc1
    s_branch fz_xend
fz_act:
    s_cmp_gt_u32 s23, 111
    s_cbranch_scc1 fz_xend
    v_lshlrev_b32 v2, 2, v1
    v_and_b32 v11, 3, v1
    v_mov_b32 v3, s48
    v_cmp_eq_u32 vcc, 1, v11
    v_mov_b32 v10, s49
    s_nop 0
    v_cndmask_b32_e64 v3, v3, v10, vcc
    v_cmp_eq_u32 vcc, 2, v11
    v_mov_b32 v10, s50
    s_nop 0
    v_cndmask_b32_e64 v3, v3, v10, vcc
    v_cmp_eq_u32 vcc, 3, v11
    v_mov_b32 v10, s51
    s_nop 0
    v_cndmask_b32_e64 v3, v3, v10, vcc
    v_and_b32 v10, 31, v1
    v_lshlrev_b32 v6, 4, v10
    v_lshrrev_b32 v10, 5, v1
    v_mul_u32_u24 v10, 2184, v10
    v_add_u32 v6, v6, v10
    v_add_u32 v6, 108032, v6
    s_lshl_b32 s38, s23, 11
    s_add_u32 s38, s38, 0x488000
    s_mov_b32 s58, 0
fz_h4:
    buffer_load_dword v16, v2, s[4:7], s38 offen offset:0 sc1
    buffer_load_dword v17, v2, s[4:7], s38 offen offset:256 sc1
    buffer_load_dword v18, v2, s[4:7], s38 offen offset:512 sc1
    buffer_load_dword v19, v2, s[4:7], s38 offen offset:768 sc1
    buffer_load_dword v20, v2, s[4:7], s38 offen offset:1024 sc1
    buffer_load_dword v21, v2, s[4:7], s38 offen offset:1280 sc1
    buffer_load_dword v22, v2, s[4:7], s38 offen offset:1536 sc1
    buffer_load_dword v23, v2, s[4:7], s38 offen offset:1792 sc1
    s_waitcnt vmcnt(6)
    v_xor_b32 v16, v3, v16
    v_xor_b32 v17, v3, v17
    v_or3_b32 v10, v16, v17, 0
    v_add_f32 v16, v16, v17
    s_waitcnt vmcnt(4)
    v_xor_b32 v18, v3, v18
    v_xor_b32 v19, v3, v19
    v_or3_b32 v10, v18, v19, v10
    v_add_f32 v18, v18, v19
    v_add_f32 v16, v16, v18
    s_waitcnt vmcnt(2)
    v_xor_b32 v20, v3, v20
    v_xor_b32 v21, v3, v21
    v_or3_b32 v10, v20, v21, v10
    v_add_f32 v20, v20, v21
    s_waitcnt vmcnt(0)
    v_xor_b32 v22, v3, v22
    v_xor_b32 v23, v3, v23
    v_or3_b32 v10, v22, v23, v10
    v_add_f32 v22, v22, v23
    v_add_f32 v20, v20, v22
    v_and_b32 v10, 0xff, v10
    v_add_f32 v8, v16, v20
    v_cmp_ne_u32 vcc, 0, v10
    s_cbranch_vccnz fz_h4_rt
fz_h4_ok:
    v_cvt_pk_bf16_f32 v8, 0, v8
    v_mov_b32 v9, v8
    s_nop 1
    v_permlane32_swap_b32 v8, v9
    v_mul_f32 v10, 0xbfb8aa3b, v8
    v_exp_f32 v10, v10
    s_nop 0
    v_add_f32 v10, 1.0, v10
    v_rcp_f32 v10, v10
    s_nop 0
    v_mul_f32 v8, v8, v10
    v_cvt_pk_bf16_f32 v8, 0, v8
    v_mul_f32 v8, v8, v9
    v_cvt_pk_bf16_f32 v8, 0, v8
    ds_write_b16_d16_hi v6, v8 offset:0
    ds_write_b16_d16_hi v6, v8 offset:546
    ds_write_b16_d16_hi v6, v8 offset:1092
    ds_write_b16_d16_hi v6, v8 offset:1638
    s_waitcnt lgkmcnt(0)
    s_branch fz_f2
fz_ldh:
    s_load_dwordx2 s[12:13], s[0:1], 56
    s_load_dwordx2 s[16:17], s[0:1], 64
    s_mov_b32 s14, 0x700000
    s_mov_b32 s15, 0x00020000
    s_mov_b32 s18, 0x700000
    s_mov_b32 s19, 0x00020000
    s_branch fz_ldback
fz_spec:
    s_cmp_gt_u32 s3, 3
    s_cbranch_scc1 fz_spec_hi
    s_cmp_eq_u32 s3, 0
    s_cselect_b32 s31, 0, s31
    s_cselect_b32 s30, 33024, s30
    s_cmp_eq_u32 s3, 2
    s_cselect_b32 s31, 30960, s31
    s_cselect_b32 s30, 35088, s30
    s_cmp_eq_u32 s3, 3
    s_cselect_b32 s31, 37152, s31
    s_cselect_b32 s30, 39216, s30
    s_branch fz_specback
fz_spec_hi:
    s_mov_b32 m0, s31
    s_nop 0
    buffer_load_dwordx4 v239, s[8:11], s27 offen lds
    buffer_load_dwordx4 v239, s[8:11], s27 offen offset:1024 lds
    s_mov_b32 m0, s30
    s_nop 0
    buffer_load_dwordx4 v239, s[8:11], s28 offen lds
    buffer_load_dwordx4 v239, s[8:11], s28 offen offset:1024 lds
    v_lshlrev_b32 v13, 3, v0
    v_mov_b32 v10, -1
    v_mov_b32 v11, -1
    s_lshl_b32 s32, s20, 11
    s_add_u32 s32, s32, 0x447800
    s_mov_b32 s18, 0x800
    s_mov_b32 s19, 0x00020000
    s_lshl_b32 s33, s24, 10
    s_min_u32 s34, s33, 2048
    s_add_u32 s34, s34, 104960
    s_mov_b32 m0, s34
    buffer_store_dwordx2 v[10:11], v13, s[4:7], s32 offen sc1
    buffer_load_dwordx4 v239, s[16:19], s33 offen lds
    s_cmp_eq_u32 s24, 0
    s_cselect_b32 s31, 8256, s31
    s_cselect_b32 s30, 22704, s30
    s_cselect_b32 s27, 524288, s27
    s_cselect_b32 s28, 3670016, s28
    s_cmp_eq_u32 s24, 1
    s_cselect_b32 s31, 12384, s31
    s_cselect_b32 s30, 18576, s30
    s_cselect_b32 s27, 1572864, s27
    s_cselect_b32 s28, 2621440, s28
    s_cmp_eq_u32 s24, 2
    s_cselect_b32 s31, 41280, s31
    s_cselect_b32 s30, 43344, s30
    s_cselect_b32 s27, 1572864, s27
    s_cselect_b32 s28, 2621440, s28
    s_cmp_eq_u32 s24, 3
    s_cselect_b32 s31, 45408, s31
    s_cselect_b32 s30, 47472, s30
    s_cselect_b32 s27, 524288, s27
    s_cselect_b32 s28, 3670016, s28
    s_mov_b32 s57, 0
    s_branch fz_specback
fz_jb:
    v_cvt_pk_bf16_f32 v128, v104, v105
    v_cvt_pk_bf16_f32 v129, v106, v107
    v_cvt_pk_bf16_f32 v130, v108, v109
    v_cvt_pk_bf16_f32 v131, v110, v111
    v_cvt_pk_bf16_f32 v132, v112, v113
    v_cvt_pk_bf16_f32 v133, v114, v115
    v_cvt_pk_bf16_f32 v134, v116, v117
    v_cvt_pk_bf16_f32 v135, v118, v119
    s_branch fz_jend
fz_spec4:
    s_mov_b32 s38, 0x80018001
    s_mov_b32 s39, 0x80018001
    v_cndmask_b32_e64 v112, v112, v104, s[38:39]
    v_cndmask_b32_e64 v113, v113, v105, s[38:39]
    v_cndmask_b32_e64 v114, v114, v106, s[38:39]
    v_cndmask_b32_e64 v115, v115, v107, s[38:39]
    v_cndmask_b32_e64 v116, v116, v108, s[38:39]
    v_cndmask_b32_e64 v117, v117, v109, s[38:39]
    v_cndmask_b32_e64 v118, v118, v110, s[38:39]
    v_cndmask_b32_e64 v119, v119, v111, s[38:39]
    s_branch fz_spec4back
    s_nop 3
fz_nc1:
    s_setprio 0
    s_cmp_lg_u32 s59, 0
    s_cbranch_scc1 ffn_b
    buffer_load_dwordx4 v[176:179], v14, s[64:67], s62 offen offset:0 nt
    buffer_load_dwordx4 v[180:183], v14, s[64:67], s62 offen offset:256 nt
    s_add_u32 s62, s62, 8192
    buffer_load_dwordx4 v[184:187], v14, s[64:67], s62 offen offset:0 nt
    buffer_load_dwordx4 v[188:191], v14, s[64:67], s62 offen offset:256 nt
    s_add_u32 s62, s62, 8192
    buffer_load_dwordx4 v[192:195], v14, s[64:67], s62 offen offset:0 nt
    buffer_load_dwordx4 v[196:199], v14, s[64:67], s62 offen offset:256 nt
    s_add_u32 s62, s62, 8192
    buffer_load_dwordx4 v[60:63], v14, s[64:67], s62 offen offset:0 nt
    buffer_load_dwordx4 v[64:67], v14, s[64:67], s62 offen offset:256 nt
    s_add_u32 s62, s62, 8192
    buffer_load_dwordx4 v[68:71], v14, s[64:67], s62 offen offset:0 nt
    buffer_load_dwordx4 v[88:91], v14, s[64:67], s62 offen offset:256 nt
    s_add_u32 s62, s62, 8192
    buffer_load_dwordx4 v[92:95], v14, s[64:67], s62 offen offset:0 nt
    buffer_load_dwordx4 v[96:99], v14, s[64:67], s62 offen offset:256 nt
    s_mov_b32 m0, s31
    s_nop 0
    buffer_load_dwordx4 v239, s[8:11], s27 offen lds
    buffer_load_dwordx4 v239, s[8:11], s27 offen offset:1024 lds
    s_mov_b32 m0, s30
    s_nop 0
    buffer_load_dwordx4 v239, s[8:11], s28 offen lds
    buffer_load_dwordx4 v239, s[8:11], s28 offen offset:1024 lds
    v_lshlrev_b32 v13, 3, v0
    v_mov_b32 v10, -1
    v_mov_b32 v11, -1
    s_lshl_b32 s32, s20, 11
    s_add_u32 s32, s32, 0x447800
    s_mov_b32 s18, 0x800
    s_mov_b32 s19, 0x00020000
    s_lshl_b32 s33, s24, 10
    s_min_u32 s34, s33, 2048
    s_add_u32 s34, s34, 104960
    s_mov_b32 m0, s34
    buffer_store_dwordx2 v[10:11], v13, s[4:7], s32 offen sc1
    buffer_load_dwordx4 v239, s[16:19], s33 offen lds
    s_waitcnt vmcnt(22)
    v_readfirstlane_b32 s40, v250
    s_nop 1
    s_add_u32 s40, s40, 1
    s_and_b32 s38, s40, 3
    s_and_b32 s39, s40, 15
    s_bfe_u32 s41, s40, 0x20002
    s_lshl_b32 s41, s41, 16
    s_or_b32 s44, s38, s41
    s_bfe_u32 s41, s40, 0x40004
    s_lshl_b32 s41, s41, 4
    s_or_b32 s48, s39, s41
    s_bfe_u32 s41, s40, 0x20004
    s_lshl_b32 s41, s41, 16
    s_or_b32 s45, s38, s41
    s_bfe_u32 s41, s40, 0x40008
    s_lshl_b32 s41, s41, 4
    s_or_b32 s49, s39, s41
    s_bfe_u32 s41, s40, 0x20006
    s_lshl_b32 s41, s41, 16
    s_or_b32 s46, s38, s41
    s_bfe_u32 s41, s40, 0x4000c
    s_lshl_b32 s41, s41, 4
    s_or_b32 s50, s39, s41
    s_bfe_u32 s41, s40, 0x20008
    s_lshl_b32 s41, s41, 16
    s_or_b32 s47, s38, s41
    s_bfe_u32 s41, s40, 0x40010
    s_lshl_b32 s41, s41, 4
    s_or_b32 s51, s39, s41
    s_mov_b32 s38, 0x404
    s_cmp_eq_u32 s2, 66
    s_cselect_b32 s39, 8, 4
    s_cselect_b32 s38, 8, s38
fz_bsp:
    s_setprio 0
    s_mov_b32 s57, 1
    s_cmp_gt_u32 s3, 5
    s_cbranch_scc1 fz_nocq
    s_and_b32 s32, s3, 1
    s_lshl_b32 s33, s32, 2
    s_lshl_b32 s32, s32, 11
    v_and_b32 v8, 3, v4
    v_lshrrev_b32 v9, 2, v4
    v_lshl_add_u32 v8, v8, 3, v9
    v_add_u32 v8, s33, v8
    v_cvt_f32_u32 v8, v8
    v_mul_f32 v8, 0x3d000000, v8
    v_cvt_f32_u32 v9, v5
    v_mul_f32 v9, 4.0, v9
    v_mul_f32 v9, v8, v9
    v_mov_b32 v104, v9
    v_fmamk_f32 v105, v8, 0x3f800000, v9
    v_fmamk_f32 v106, v8, 0x40000000, v9
    v_fmamk_f32 v107, v8, 0x40400000, v9
    v_fmamk_f32 v108, v8, 0x41800000, v9
    v_fmamk_f32 v109, v8, 0x41880000, v9
    v_fmamk_f32 v110, v8, 0x41900000, v9
    v_fmamk_f32 v111, v8, 0x41980000, v9
    v_sin_f32 v112, v104
    v_sin_f32 v113, v105
    v_sin_f32 v114, v106
    v_sin_f32 v115, v107
    v_sin_f32 v116, v108
    v_sin_f32 v117, v109
    v_sin_f32 v118, v110
    v_sin_f32 v119, v111
    v_cos_f32 v104, v104
    v_cos_f32 v105, v105
    v_cos_f32 v106, v106
    v_cos_f32 v107, v107
    v_cos_f32 v108, v108
    v_cos_f32 v109, v109
    v_cos_f32 v110, v110
    v_cos_f32 v111, v111
    v_mul_f32 v104, 0x3d800000, v104
    v_mul_f32 v105, 0x3d800000, v105
    v_mul_f32 v106, 0x3d800000, v106
    v_mul_f32 v107, 0x3d800000, v107
    v_mul_f32 v108, 0x3d800000, v108
    v_mul_f32 v109, 0x3d800000, v109
    v_mul_f32 v110, 0x3d800000, v110
    v_mul_f32 v111, 0x3d800000, v111
    v_mul_f32 v112, 0x3d800000, v112
    v_mul_f32 v113, 0x3d800000, v113
    v_mul_f32 v114, 0x3d800000, v114
    v_mul_f32 v115, 0x3d800000, v115
    v_mul_f32 v116, 0x3d800000, v116
    v_mul_f32 v117, 0x3d800000, v117
    v_mul_f32 v118, 0x3d800000, v118
    v_mul_f32 v119, 0x3d800000, v119
    v_cvt_pk_f16_f32 v128, v104, v105
    v_cvt_pk_f16_f32 v129, v106, v107
    v_cvt_pk_f16_f32 v130, v108, v109
    v_cvt_pk_f16_f32 v131, v110, v111
    v_cvt_pk_f16_f32 v132, v112, v113
    v_cvt_pk_f16_f32 v133, v114, v115
    v_cvt_pk_f16_f32 v134, v116, v117
    v_cvt_pk_f16_f32 v135, v118, v119
    v_add_u32 v8, s32, v6
    ds_write_b128 v8, v[128:131] offset:14336
    ds_write_b128 v8, v[132:135] offset:15360
fz_nocq:
    s_and_b32 s32, s3, 3
    s_lshr_b32 s33, s3, 2
    s_lshl_b32 s33, s33, 4
    s_add_u32 s33, s33, s32
    v_and_b32 v8, 12, v4
    v_bfe_u32 v9, v4, 1, 1
    v_lshl_add_u32 v8, v9, 5, v8
    v_add_u32 v8, s33, v8
    v_cvt_f32_u32 v8, v8
    v_and_b32 v12, 1, v1
    v_cvt_f32_u32 v9, v12
    v_lshlrev_b32 v13, 2, v5
    v_cvt_f32_u32 v10, v13
    v_mul_f32 v11, 0x3c800000, v8
    v_mul_f32 v9, 0x3e800000, v9
    v_fma_f32 v9, v11, v10, v9
    v_mov_b32 v128, v9
    v_fmamk_f32 v129, v11, 0x3f800000, v9
    v_fmamk_f32 v130, v11, 0x40000000, v9
    v_fmamk_f32 v131, v11, 0x40400000, v9
    v_mul_f32 v11, 0x3a000000, v8
    v_lshlrev_b32 v9, 31, v1
    v_xor_b32 v11, v9, v11
    v_mul_f32 v9, v11, v10
    v_mov_b32 v112, v9
    v_fmamk_f32 v113, v11, 0x3f800000, v9
    v_fmamk_f32 v114, v11, 0x40000000, v9
    v_fmamk_f32 v115, v11, 0x40400000, v9
    v_fmamk_f32 v116, v11, 0x41800000, v9
    v_fmamk_f32 v117, v11, 0x41880000, v9
    v_fmamk_f32 v118, v11, 0x41900000, v9
    v_fmamk_f32 v119, v11, 0x41980000, v9
    v_cos_f32 v104, v128
    v_sin_f32 v105, v128
    v_cos_f32 v106, v129
    v_sin_f32 v107, v129
    v_cos_f32 v108, v130
    v_sin_f32 v109, v130
    v_cos_f32 v110, v131
    v_sin_f32 v111, v131
    v_sin_f32 v120, v112
    v_sin_f32 v121, v113
    v_sin_f32 v122, v114
    v_sin_f32 v123, v115
    v_sin_f32 v124, v116
    v_sin_f32 v125, v117
    v_sin_f32 v126, v118
    v_sin_f32 v127, v119
    v_cos_f32 v112, v112
    v_cos_f32 v113, v113
    v_cos_f32 v114, v114
    v_cos_f32 v115, v115
    v_cos_f32 v116, v116
    v_cos_f32 v117, v117
    v_cos_f32 v118, v118
    v_cos_f32 v119, v119
    v_cvt_pk_f16_f32 v16, v104, v105
    v_cvt_pk_f16_f32 v17, v106, v107
    v_cvt_pk_f16_f32 v18, v108, v109
    v_cvt_pk_f16_f32 v19, v110, v111
    v_cvt_pk_f16_f32 v20, v112, v113
    v_cvt_pk_f16_f32 v21, v114, v115
    v_cvt_pk_f16_f32 v22, v116, v117
    v_cvt_pk_f16_f32 v23, v118, v119
    v_cvt_pk_f16_f32 v24, v120, v121
    v_cvt_pk_f16_f32 v25, v122, v123
    v_cvt_pk_f16_f32 v26, v124, v125
    v_cvt_pk_f16_f32 v27, v126, v127
    v_lshrrev_b32 v8, 3, v1
    v_mul_u32_u24 v222, 16512, v8
    v_and_b32 v9, 7, v1
    v_lshl_add_u32 v222, v9, 4, v222
    s_mul_i32 s60, s3, 528384
    s_lshl_b32 s32, s20, 7
    s_add_u32 s60, s60, s32
    s_add_u32 s60, s60, 0x1000
    s_add_u32 s61, s60, 132096
    s_add_u32 s16, s60, 264192
    s_add_u32 s17, s60, 396288
    v_lshlrev_b32 v8, 1, v8
    v_bfe_u32 v9, v1, 2, 1
    v_add_u32 v8, v8, v9
    s_lshl_b32 s32, s3, 2
    s_add_u32 s32, s32, 1
    v_lshl_add_u32 v8, v8, 5, s32
    v_cmp_eq_u32 vcc, 1, v12
    v_bfe_u32 v9, v1, 1, 1
    v_mul_u32_u24 v9, 8256, v9
    v_add_u32 v9, 86400, v9
    s_cmp_eq_u32 s3, 3
    s_cselect_b32 s32, 272, 0
    v_sub_u32 v10, 512, v8
    v_cndmask_b32_e64 v10, v8, v10, vcc
    v_and_b32 v11, 16, v10
    v_lshl_add_u32 v11, v11, 6, v9
    v_lshrrev_b32 v12, 7, v10
    v_lshl_add_u32 v11, v12, 8, v11
    v_and_b32 v12, 15, v10
    v_lshl_add_u32 v11, v12, 4, v11
    v_bfe_u32 v12, v10, 5, 2
    v_lshl_add_u32 v223, v12, 2, v11
    v_add_u32 v8, 1, v8
    v_sub_u32 v10, 512, v8
    v_cndmask_b32_e64 v10, v8, v10, vcc
    v_and_b32 v11, 16, v10
    v_lshl_add_u32 v11, v11, 6, v9
    v_lshrrev_b32 v12, 7, v10
    v_lshl_add_u32 v11, v12, 8, v11
    v_and_b32 v12, 15, v10
    v_lshl_add_u32 v11, v12, 4, v11
    v_bfe_u32 v12, v10, 5, 2
    v_lshl_add_u32 v224, v12, 2, v11
    v_add_u32 v8, 1, v8
    v_sub_u32 v10, 512, v8
    v_cndmask_b32_e64 v10, v8, v10, vcc
    v_and_b32 v11, 16, v10
    v_lshl_add_u32 v11, v11, 6, v9
    v_lshrrev_b32 v12, 7, v10
    v_lshl_add_u32 v11, v12, 8, v11
    v_and_b32 v12, 15, v10
    v_lshl_add_u32 v11, v12, 4, v11
    v_bfe_u32 v12, v10, 5, 2
    v_lshl_add_u32 v100, v12, 2, v11
    v_mul_u32_u24 v10, s32, v3
    v_sub_u32 v8, v8, v10
    v_add_u32 v8, 1, v8
    v_sub_u32 v10, 512, v8
    v_cndmask_b32_e64 v10, v8, v10, vcc
    v_lshrrev_b32 v11, 1, v10
    v_and_b32 v11, 256, v11
    v_sub_u32 v10, v10, v11
    v_and_b32 v11, 16, v10
    v_lshl_add_u32 v11, v11, 6, v9
    v_lshrrev_b32 v12, 7, v10
    v_lshl_add_u32 v11, v12, 8, v11
    v_and_b32 v12, 15, v10
    v_lshl_add_u32 v11, v12, 4, v11
    v_bfe_u32 v12, v10, 5, 2
    v_lshl_add_u32 v101, v12, 2, v11
    s_and_b32 s32, s3, 3
    s_lshl_b32 s32, s32, 11
    s_add_u32 s32, s32, 86400
    v_add_u32 v225, s32, v239
    v_add_u32 v8, s33, v13
    v_sub_u32 v9, 32, v8
    v_min_u32 v9, v8, v9
    v_and_b32 v10, 15, v8
    v_cmp_eq_u32 s[32:33], 0, v10
    v_cmp_lt_u32 s[34:35], 16, v8
    v_lshlrev_b32 v10, 10, v9
    v_subrev_u32 v10, 1024, v10
    v_mov_b32 v11, 15872
    v_cmp_eq_u32 vcc, 0, v8
    s_nop 1
    v_cndmask_b32_e64 v10, v10, v11, vcc
    v_and_b32 v11, 3, v1
    v_lshl_add_u32 v10, v11, 4, v10
    v_lshrrev_b32 v11, 2, v4
    v_lshlrev_b32 v12, 7, v11
    v_sub_u32 v13, 960, v12
    v_cndmask_b32_e64 v13, v12, v13, s[34:35]
    v_add_u32 v226, v10, v13
    s_or_b64 s[34:35], s[34:35], s[32:33]
    v_add_u32 v12, 512, v12
    v_sub_u32 v13, 960, v12
    v_cndmask_b32_e64 v13, v12, v13, s[34:35]
    v_add_u32 v227, v10, v13
    s_mul_i32 s56, s20, 16512
    s_add_u32 s56, s56, 0x210000
    v_mov_b32 v249, 0x30003
    v_mov_b32 v252, s44
    v_mov_b32 v253, s45
    v_mov_b32 v254, s46
    v_mov_b32 v255, s47
    s_waitcnt lgkmcnt(0)
    v_sub_u32 v8, 15, v4
    v_min_u32 v8, v4, v8
    v_and_b32 v9, 1, v8
    v_lshlrev_b32 v9, 5, v9
    v_lshrrev_b32 v10, 1, v8
    v_lshl_add_u32 v9, v10, 9, v9
    v_add_u32 v9, s25, v9
    v_sub_u32 v10, 2048, v9
    v_cmp_lt_u32 s[34:35], 7, v4
    s_nop 1
    v_cndmask_b32_e64 v230, v9, v10, s[34:35]
    v_mov_b32 v9, v4
    v_mov_b32 v10, s20
    s_cmp_lg_u32 s21, 0
    s_cbranch_scc0 fz_spec3b
fz_spec3backb:
    v_lshlrev_b32 v10, 7, v10
    v_lshl_add_u32 v10, v9, 3, v10
    v_mul_u32_u24 v11, 66048, v5
    v_add_u32 v228, v10, v11
    v_and_b32 v9, 1, v9
    v_cmp_eq_u32 vcc, 1, v9
    v_mov_b32 v9, s44
    v_mov_b32 v10, s46
    v_cndmask_b32_e64 v236, v9, v10, vcc
    v_mov_b32 v9, s45
    v_mov_b32 v10, s47
    v_cndmask_b32_e64 v237, v9, v10, vcc
    s_lshl_b32 s32, s3, 2
    v_add_u32 v8, s32, v5
    v_lshlrev_b32 v9, 6, v8
    v_cmp_gt_u32 vcc, 16, v8
    s_nop 1
    v_cndmask_b32_e64 v10, 0, 32, vcc
    v_add_u32 v10, v9, v10
    v_sub_u32 v11, 2048, v10
    v_cmp_eq_u32 vcc, 16, v8
    s_nop 1
    v_cndmask_b32_e64 v11, v11, 0, vcc
    v_mov_b32 v12, 0xffff0000
    v_cndmask_b32_e64 v238, -1, v12, vcc
    v_sub_u32 v12, 2018, v9
    v_mul_u32_u24 v13, 2064, v4
    v_add_u32 v231, v13, v9
    v_add_u32 v232, v13, v12
    v_add_u32 v233, v13, v10
    v_add_u32 v241, v13, v11
    s_lshl_b32 s32, s3, 8
    s_add_u32 s32, s32, 102912
    v_lshlrev_b32 v9, 4, v4
    v_add_u32 v10, s32, v9
    v_add_u32 v11, 107008, v239
    v_cmp_gt_u32 vcc, 16, v1
    s_nop 1
    v_cndmask_b32_e64 v243, v11, v10, vcc
    v_lshrrev_b32 v12, 2, v4
    v_cmp_eq_u32 vcc, v12, v5
    s_nop 1
    v_cndmask_b32_e64 v244, v11, v10, vcc
    v_lshrrev_b32 v12, 5, v1
    v_lshl_add_u32 v10, v12, 10, v9
    v_add_u32 v245, 102912, v10
    v_and_b32 v9, 1, v1
    v_cmp_eq_u32 s[28:29], 1, v9
    v_and_b32 v9, 2, v1
    v_cmp_eq_u32 s[30:31], 2, v9
    s_lshl_b32 s37, s3, 2
    v_add_u32 v9, s37, v5
    v_mul_u32_u24 v246, 2176, v9
    s_lshl_b32 s26, s20, 4
    s_add_u32 s26, s26, 0x420000
    v_lshlrev_b32 v247, 4, v5
    s_lshl_b32 s27, s20, 11
    s_lshl_b32 s37, s3, 8
    s_add_u32 s27, s27, s37
    s_add_u32 s27, s27, 0x448000
    v_sub_u32 v248, 2047, v230
    s_mov_b32 s14, 0x400000
    s_mov_b32 s15, 0x00020000
    s_mul_i32 s52, s3, 264192
    s_add_u32 s52, s52, 0x210000
    s_add_u32 s53, s52, 16512
    s_add_u32 s54, s52, 33024
    s_add_u32 s55, s52, 49536
    s_mov_b32 s23, s63
    s_getreg_b32 s24, hwreg(HW_REG_XCC_ID)
    s_and_b32 s24, s24, 15
    v_lshlrev_b32 v10, 4, v0
    v_min_u32 v10, 4336, v10
    v_add_u32 v10, 108032, v10
    v_mov_b32 v104, 0
    v_mov_b32 v105, 0
    v_mov_b32 v106, 0
    v_mov_b32 v107, 0
    ds_write_b128 v10, v[104:107]
    s_cmp_eq_u32 s2, 66
    s_cbranch_scc1 fz_sz
    s_waitcnt vmcnt(0)
    v_mov_b32 v10, 256
    s_mov_b64 exec, 1
    ds_add_u32 v15, v10
    s_mov_b64 exec, -1
fz_sz:
    ds_read_b32 v10, v15
    s_waitcnt lgkmcnt(0)
    v_cmp_ne_u32 vcc, s38, v10
    s_cbranch_vccnz fz_sz
    ds_read_b128 v[116:119], v231
    ds_read_b128 v[120:123], v231 offset:16
    ds_read_u16_d16_hi v44, v241
    ds_read_u16_d16_hi v45, v232 offset:28
    ds_read_u16_d16_hi v46, v232 offset:26
    ds_read_u16_d16_hi v47, v232 offset:24
    ds_read_u16_d16_hi v48, v232 offset:22
    ds_read_u16_d16_hi v49, v232 offset:20
    ds_read_u16_d16_hi v50, v232 offset:18
    ds_read_u16_d16_hi v51, v232 offset:16
    ds_read_u16_d16_hi v52, v232 offset:14
    ds_read_u16_d16_hi v53, v232 offset:12
    ds_read_u16_d16_hi v54, v232 offset:10
    ds_read_u16_d16_hi v55, v232 offset:8
    ds_read_u16_d16_hi v56, v232 offset:6
    ds_read_u16_d16_hi v57, v232 offset:4
    ds_read_u16_d16_hi v58, v232 offset:2
    ds_read_u16_d16_hi v59, v232 offset:0
    ds_read_u16_d16_hi v28, v233
    v_mul_u32_u24 v13, 2064, v4
    v_subrev_u32 v13, 104960, v13
    v_sub_u32 v9, v231, v13
    v_sub_u32 v10, v233, v13
    v_sub_u32 v11, v241, v13
    v_sub_u32 v12, v232, v13
    s_mov_b32 s36, 0xffff0000
    s_waitcnt lgkmcnt(0)
    ds_read_b128 v[200:203], v9
    ds_read_b128 v[204:207], v9 offset:16
    ds_read_u16_d16 v208, v11
    ds_read_u16_d16_hi v124, v12 offset:28
    ds_read_u16_d16 v209, v12 offset:26
    ds_read_u16_d16_hi v125, v12 offset:24
    ds_read_u16_d16 v210, v12 offset:22
    ds_read_u16_d16_hi v126, v12 offset:20
    ds_read_u16_d16 v211, v12 offset:18
    ds_read_u16_d16_hi v127, v12 offset:16
    ds_read_u16_d16 v212, v12 offset:14
    ds_read_u16_d16_hi v128, v12 offset:12
    ds_read_u16_d16 v213, v12 offset:10
    ds_read_u16_d16_hi v129, v12 offset:8
    ds_read_u16_d16 v214, v12 offset:6
    ds_read_u16_d16_hi v130, v12 offset:4
    ds_read_u16_d16 v215, v12 offset:2
    ds_read_u16_d16_hi v131, v12 offset:0
    ds_read_u16_d16 v13, v10
    v_and_b32 v29, s36, v116
    v_lshlrev_b32 v30, 16, v117
    v_and_b32 v31, s36, v117
    v_lshlrev_b32 v32, 16, v118
    v_and_b32 v33, s36, v118
    v_lshlrev_b32 v34, 16, v119
    v_and_b32 v35, s36, v119
    v_lshlrev_b32 v36, 16, v120
    v_and_b32 v37, s36, v120
    v_lshlrev_b32 v38, 16, v121
    v_and_b32 v39, s36, v121
    v_lshlrev_b32 v40, 16, v122
    v_and_b32 v41, s36, v122
    v_lshlrev_b32 v42, 16, v123
    v_and_b32 v43, s36, v123
    v_cmp_eq_u32 vcc, 1, v4
    v_mov_b32 v9, s42
    s_nop 0
    v_cndmask_b32_e64 v9, 0, v9, vcc
    v_mov_b32 v116, s42
    v_mov_b32 v117, s42
    v_mov_b32 v118, s42
    v_mov_b32 v119, s42
    v_cmp_eq_u32 vcc, 0, v4
    s_waitcnt lgkmcnt(0)
    v_and_or_b32 v200, v200, s36, v13
    v_or_b32 v208, v208, v124
    v_or_b32 v209, v209, v125
    v_or_b32 v210, v210, v126
    v_or_b32 v211, v211, v127
    v_or_b32 v212, v212, v128
    v_or_b32 v213, v213, v129
    v_or_b32 v214, v214, v130
    v_or_b32 v215, v215, v131
    v_cndmask_b32_e64 v200, v9, v200, vcc
    v_cndmask_b32_e64 v201, v9, v201, vcc
    v_cndmask_b32_e64 v202, v9, v202, vcc
    v_cndmask_b32_e64 v203, v9, v203, vcc
    v_cndmask_b32_e64 v204, v9, v204, vcc
    v_cndmask_b32_e64 v205, v9, v205, vcc
    v_cndmask_b32_e64 v206, v9, v206, vcc
    v_cndmask_b32_e64 v207, v9, v207, vcc
    v_cndmask_b32_e64 v208, v9, v208, vcc
    v_cndmask_b32_e64 v209, v9, v209, vcc
    v_cndmask_b32_e64 v210, v9, v210, vcc
    v_cndmask_b32_e64 v211, v9, v211, vcc
    v_cndmask_b32_e64 v212, v9, v212, vcc
    v_cndmask_b32_e64 v213, v9, v213, vcc
    v_cndmask_b32_e64 v214, v9, v214, vcc
    v_cndmask_b32_e64 v215, v9, v215, vcc
    v_mfma_f32_16x16x32_bf16 v[120:123], v[200:203], v[116:119], 0
    v_mfma_f32_16x16x32_bf16 v[120:123], v[204:207], v[116:119], v[120:123]
    v_mfma_f32_16x16x32_bf16 v[120:123], v[208:211], v[116:119], v[120:123]
    v_mfma_f32_16x16x32_bf16 v[120:123], v[212:215], v[116:119], v[120:123]
    s_nop 7
    ds_write_b32 v243, v120 offset:12
    s_waitcnt lgkmcnt(0)
    s_branch fz_hb
    s_nop 0
fz_nc3:
    s_mov_b32 s58, 0
    s_waitcnt vmcnt(0)
    s_branch fz_h2
fz_spec3a:
    v_xor_b32 v11, 1, v4
    v_cndmask_b32_e64 v9, v9, v11, s[34:35]
    v_and_b32 v11, 1, v4
    v_cndmask_b32_e64 v11, 0, v11, s[34:35]
    v_sub_u32 v10, v10, v11
    s_cmp_lg_u32 s22, 0
    s_cbranch_scc1 fz_spec3backa
    v_cmp_eq_u32 vcc, 15, v4
    v_mov_b32 v11, 1024
    v_mov_b32 v12, 124
    v_cndmask_b32_e64 v230, v230, v11, vcc
    v_cndmask_b32_e64 v10, v10, v12, vcc
    v_cndmask_b32_e64 v9, v9, 4, vcc
    v_cmp_eq_u32 vcc, 13, v4
    v_mov_b32 v11, 1536
    v_mov_b32 v12, 124
    v_cndmask_b32_e64 v230, v230, v11, vcc
    v_cndmask_b32_e64 v10, v10, v12, vcc
    v_cndmask_b32_e64 v9, v9, 6, vcc
    v_cmp_eq_u32 vcc, 4, v4
    v_mov_b32 v11, 256
    v_mov_b32 v12, 127
    v_cndmask_b32_e64 v230, v230, v11, vcc
    v_cndmask_b32_e64 v10, v10, v12, vcc
    v_cndmask_b32_e64 v9, v9, 8, vcc
    v_cmp_eq_u32 vcc, 11, v4
    v_mov_b32 v11, 1792
    v_mov_b32 v12, 127
    v_cndmask_b32_e64 v230, v230, v11, vcc
    v_cndmask_b32_e64 v10, v10, v12, vcc
    v_cndmask_b32_e64 v9, v9, 14, vcc
    v_cmp_eq_u32 vcc, 6, v4
    v_mov_b32 v11, 768
    v_mov_b32 v12, 127
    v_cndmask_b32_e64 v230, v230, v11, vcc
    v_cndmask_b32_e64 v10, v10, v12, vcc
    v_cndmask_b32_e64 v9, v9, 10, vcc
    v_cmp_eq_u32 vcc, 9, v4
    v_mov_b32 v11, 1280
    v_mov_b32 v12, 127
    v_cndmask_b32_e64 v230, v230, v11, vcc
    v_cndmask_b32_e64 v10, v10, v12, vcc
    v_cndmask_b32_e64 v9, v9, 12, vcc
    s_nop 4
    s_branch fz_spec3backa
fz_spec3b:
    v_xor_b32 v11, 1, v4
    v_cndmask_b32_e64 v9, v9, v11, s[34:35]
    v_and_b32 v11, 1, v4
    v_cndmask_b32_e64 v11, 0, v11, s[34:35]
    v_sub_u32 v10, v10, v11
    s_cmp_lg_u32 s22, 0
    s_cbranch_scc1 fz_spec3backb
    v_cmp_eq_u32 vcc, 15, v4
    v_mov_b32 v11, 1024
    v_mov_b32 v12, 124
    v_cndmask_b32_e64 v230, v230, v11, vcc
    v_cndmask_b32_e64 v10, v10, v12, vcc
    v_cndmask_b32_e64 v9, v9, 4, vcc
    v_cmp_eq_u32 vcc, 13, v4
    v_mov_b32 v11, 1536
    v_mov_b32 v12, 124
    v_cndmask_b32_e64 v230, v230, v11, vcc
    v_cndmask_b32_e64 v10, v10, v12, vcc
    v_cndmask_b32_e64 v9, v9, 6, vcc
    v_cmp_eq_u32 vcc, 4, v4
    v_mov_b32 v11, 256
    v_mov_b32 v12, 127
    v_cndmask_b32_e64 v230, v230, v11, vcc
    v_cndmask_b32_e64 v10, v10, v12, vcc
    v_cndmask_b32_e64 v9, v9, 8, vcc
    v_cmp_eq_u32 vcc, 11, v4
    v_mov_b32 v11, 1792
    v_mov_b32 v12, 127
    v_cndmask_b32_e64 v230, v230, v11, vcc
    v_cndmask_b32_e64 v10, v10, v12, vcc
    v_cndmask_b32_e64 v9, v9, 14, vcc
    v_cmp_eq_u32 vcc, 6, v4
    v_mov_b32 v11, 768
    v_mov_b32 v12, 127
    v_cndmask_b32_e64 v230, v230, v11, vcc
    v_cndmask_b32_e64 v10, v10, v12, vcc
    v_cndmask_b32_e64 v9, v9, 10, vcc
    v_cmp_eq_u32 vcc, 9, v4
    v_mov_b32 v11, 1280
    v_mov_b32 v12, 127
    v_cndmask_b32_e64 v230, v230, v11, vcc
    v_cndmask_b32_e64 v10, v10, v12, vcc
    v_cndmask_b32_e64 v9, v9, 12, vcc
    s_nop 4
    s_branch fz_spec3backb
    s_nop 0
ffn_b:
    s_waitcnt vmcnt(0)
    v_readfirstlane_b32 s40, v250
    s_nop 1
    s_add_u32 s40, s40, 1
    s_and_b32 s38, s40, 3
    s_and_b32 s39, s40, 15
    s_bfe_u32 s41, s40, 0x20002
    s_lshl_b32 s41, s41, 16
    s_or_b32 s44, s38, s41
    s_bfe_u32 s41, s40, 0x40004
    s_lshl_b32 s41, s41, 4
    s_or_b32 s48, s39, s41
    s_bfe_u32 s41, s40, 0x20004
    s_lshl_b32 s41, s41, 16
    s_or_b32 s45, s38, s41
    s_bfe_u32 s41, s40, 0x40008
    s_lshl_b32 s41, s41, 4
    s_or_b32 s49, s39, s41
    s_bfe_u32 s41, s40, 0x20006
    s_lshl_b32 s41, s41, 16
    s_or_b32 s46, s38, s41
    s_bfe_u32 s41, s40, 0x4000c
    s_lshl_b32 s41, s41, 4
    s_or_b32 s50, s39, s41
    s_bfe_u32 s41, s40, 0x20008
    s_lshl_b32 s41, s41, 16
    s_or_b32 s47, s38, s41
    s_bfe_u32 s41, s40, 0x40010
    s_lshl_b32 s41, s41, 4
    s_or_b32 s51, s39, s41
    s_nop 0
ffn:
    s_add_u32 s36, s2, 4
    s_and_b32 s36, s36, 7
    s_bfe_u32 s37, s2, 0x10006
    s_lshl_b32 s22, s36, 1
    s_add_u32 s22, s22, s37
    s_cmp_lg_u32 s37, 0
    s_cselect_b32 s37, 8, s36
    s_add_u32 s37, s37, 6
    s_cmp_lt_u32 s36, 6
    s_cselect_b32 s22, s22, s37
    s_cmp_gt_u32 s22, 13
    s_cbranch_scc1 fz_xend
    s_bfe_u32 s21, s2, 0x30003
    v_lshrrev_b32 v2, 5, v1
    v_and_b32 v3, 31, v1
    v_lshlrev_b32 v4, 1, v2
    v_xor_b32 v3, v4, v3
    v_mul_u32_u24 v4, 7168, v2
    v_lshl_add_u32 v4, v3, 4, v4
    v_xor_b32 v5, 64, v4
    v_xor_b32 v6, 128, v4
    v_xor_b32 v7, 192, v4
    s_lshl_b32 s23, s21, 7
    s_lshl_b32 s24, s3, 4
    s_add_u32 s23, s23, s24
    s_mul_i32 s23, s23, 7168
    s_lshl_b32 s24, s22, 9
    s_add_u32 s23, s23, s24
    s_lshl_b32 s24, s3, 13
    s_setprio 0
    s_barrier
    s_add_u32 s28, s24, 81920
    s_mov_b32 m0, s28
    s_add_u32 s29, s23, 0
    buffer_load_dwordx4 v4, s[12:15], s29 offen nt lds
    s_add_u32 s28, s24, 82944
    s_mov_b32 m0, s28
    s_add_u32 s29, s23, 14336
    buffer_load_dwordx4 v5, s[12:15], s29 offen nt lds
    s_add_u32 s28, s24, 83968
    s_mov_b32 m0, s28
    s_add_u32 s29, s23, 28672
    buffer_load_dwordx4 v4, s[12:15], s29 offen nt lds
    s_add_u32 s28, s24, 84992
    s_mov_b32 m0, s28
    s_add_u32 s29, s23, 43008
    buffer_load_dwordx4 v5, s[12:15], s29 offen nt lds
    s_add_u32 s28, s24, 86016
    s_mov_b32 m0, s28
    s_add_u32 s29, s23, 57344
    buffer_load_dwordx4 v6, s[12:15], s29 offen nt lds
    s_add_u32 s28, s24, 87040
    s_mov_b32 m0, s28
    s_add_u32 s29, s23, 71680
    buffer_load_dwordx4 v7, s[12:15], s29 offen nt lds
    s_add_u32 s28, s24, 88064
    s_mov_b32 m0, s28
    s_add_u32 s29, s23, 86016
    buffer_load_dwordx4 v6, s[12:15], s29 offen nt lds
    s_add_u32 s28, s24, 89088
    s_mov_b32 m0, s28
    s_add_u32 s29, s23, 100352
    buffer_load_dwordx4 v7, s[12:15], s29 offen nt lds
    s_add_u32 s28, s24, 0
    s_mov_b32 m0, s28
    s_add_u32 s29, s23, 0
    buffer_load_dwordx4 v4, s[16:19], s29 offen nt lds
    s_add_u32 s28, s24, 1024
    s_mov_b32 m0, s28
    s_add_u32 s29, s23, 14336
    buffer_load_dwordx4 v5, s[16:19], s29 offen nt lds
    s_add_u32 s28, s24, 2048
    s_mov_b32 m0, s28
    s_add_u32 s29, s23, 28672
    buffer_load_dwordx4 v4, s[16:19], s29 offen nt lds
    s_add_u32 s28, s24, 3072
    s_mov_b32 m0, s28
    s_add_u32 s29, s23, 43008
    buffer_load_dwordx4 v5, s[16:19], s29 offen nt lds
    s_add_u32 s28, s24, 4096
    s_mov_b32 m0, s28
    s_add_u32 s29, s23, 57344
    buffer_load_dwordx4 v6, s[16:19], s29 offen nt lds
    s_add_u32 s28, s24, 5120
    s_mov_b32 m0, s28
    s_add_u32 s29, s23, 71680
    buffer_load_dwordx4 v7, s[16:19], s29 offen nt lds
    s_add_u32 s28, s24, 6144
    s_mov_b32 m0, s28
    s_add_u32 s29, s23, 86016
    buffer_load_dwordx4 v6, s[16:19], s29 offen nt lds
    s_add_u32 s28, s24, 7168
    s_mov_b32 m0, s28
    s_add_u32 s29, s23, 100352
    buffer_load_dwordx4 v7, s[16:19], s29 offen nt lds
    v_lshrrev_b32 v2, 4, v1
    v_and_b32 v3, 15, v1
    v_bfe_u32 v9, v1, 2, 2
    v_lshl_add_u32 v8, v2, 3, v9
    v_lshlrev_b32 v8, 9, v8
    v_and_b32 v10, 1, v2
    v_lshl_add_u32 v10, v10, 2, v9
    s_lshl_b32 s28, s3, 1
    v_xor_b32 v10, s28, v10
    v_lshl_add_u32 v8, v10, 5, v8
    v_and_b32 v10, 3, v1
    v_lshl_add_u32 v8, v10, 3, v8
    v_xor_b32 v12, 32, v8
    v_add_u32 v13, 81920, v8
    v_add_u32 v20, 81920, v12
    v_bfe_u32 v9, v0, 2, 2
    v_lshrrev_b32 v10, 6, v0
    v_lshl_add_u32 v9, v10, 2, v9
    v_bfe_u32 v10, v0, 4, 1
    v_and_b32 v11, 3, v0
    v_lshlrev_b32 v11, 1, v11
    v_lshl_add_u32 v10, v10, 3, v11
    v_lshl_add_u32 v11, v9, 5, v10
    v_add_u32 v17, 1, v11
    v_cmp_eq_u32 vcc, 0, v10
    v_cmp_gt_u32 s[28:29], 16, v9
    s_nop 1
    s_and_b64 vcc, vcc, s[28:29]
    v_cndmask_b32_e64 v14, 0, 16, vcc
    v_add_u32 v16, v11, v14
    v_bfe_u32 v10, v0, 5, 1
    v_cmp_eq_u32 s[28:29], 1, v10
    v_sub_u32 v14, 1024, v16
    v_cmp_eq_u32 vcc, 512, v16
    s_nop 1
    v_cndmask_b32_e64 v14, v14, 0, vcc
    v_cndmask_b32_e64 v16, v16, v14, s[28:29]
    v_sub_u32 v14, 1024, v17
    v_cndmask_b32_e64 v17, v17, v14, s[28:29]
    v_lshlrev_b32 v16, 1, v16
    v_add_u32 v16, 147456, v16
    v_lshlrev_b32 v17, 1, v17
    v_add_u32 v17, 147456, v17
    v_lshlrev_b32 v18, 2, v0
    v_add_u32 v18, 149568, v18
    s_lshl_b32 s28, s21, 8
    s_add_u32 s28, s28, 147456
    v_lshlrev_b32 v19, 4, v2
    v_add_u32 v19, s28, v19
    v_mov_b32 v28, 149504
    v_lshlrev_b32 v29, 4, v1
    s_lshl_b32 s30, s22, 3
    s_add_u32 s30, s30, s3
    s_lshl_b32 s30, s30, 3
    s_add_u32 s30, s30, s21
    s_lshl_b32 s30, s30, 8
    s_add_u32 s30, s30, 0x488000
    v_lshlrev_b32 v30, 4, v2
    v_lshl_add_u32 v30, v3, 6, v30
    v_cmp_eq_u32 s[60:61], 1, v3
    v_cmp_eq_u32 s[62:63], 2, v3
    v_cmp_eq_u32 s[64:65], 3, v3
    v_add_u32 v21, 149568, v29
    v_mov_b32 v197, 0xffffff00
    s_and_b32 s35, s2, 0x47
    s_lshl_b32 s31, s3, 3
    s_add_u32 s35, s35, s31
    s_add_u32 s35, s35, 58
    s_and_b32 s35, s35, 127
    s_getreg_b32 s33, hwreg(HW_REG_XCC_ID)
    s_and_b32 s33, s33, 15
    s_lshr_b32 s31, s35, 5
    s_lshl_b32 s31, s31, 2
    s_add_u32 s31, s31, 149520
    v_mov_b32 v22, s31
    s_lshl_b32 s20, s22, 3
    s_add_u32 s20, s20, s21
    s_and_b32 s34, s20, 15
    s_bfe_u32 s28, s20, 0x10004
    s_lshl_b32 s28, s28, 5
    s_add_u32 s34, s34, s28
    s_mul_i32 s34, s34, 2176
    s_add_u32 s34, s34, 0x420000
    s_waitcnt vmcnt(0)
    s_barrier
    ds_read_b64_tr_b16 v[32:33], v13 offset:0
    ds_read_b64_tr_b16 v[34:35], v13 offset:2048
    ds_read_b64_tr_b16 v[36:37], v13 offset:16384
    ds_read_b64_tr_b16 v[38:39], v13 offset:18432
    ds_read_b64_tr_b16 v[40:41], v13 offset:32768
    ds_read_b64_tr_b16 v[42:43], v13 offset:34816
    ds_read_b64_tr_b16 v[44:45], v13 offset:49152
    ds_read_b64_tr_b16 v[46:47], v13 offset:51200
    s_waitcnt lgkmcnt(0)
    ds_read_b64_tr_b16 v[48:49], v20 offset:0
    ds_read_b64_tr_b16 v[50:51], v20 offset:2048
    ds_read_b64_tr_b16 v[52:53], v20 offset:16384
    ds_read_b64_tr_b16 v[54:55], v20 offset:18432
    ds_read_b64_tr_b16 v[56:57], v20 offset:32768
    ds_read_b64_tr_b16 v[58:59], v20 offset:34816
    ds_read_b64_tr_b16 v[60:61], v20 offset:49152
    ds_read_b64_tr_b16 v[62:63], v20 offset:51200
    s_waitcnt lgkmcnt(0)
    ds_read_b64_tr_b16 v[64:65], v8 offset:0
    ds_read_b64_tr_b16 v[66:67], v8 offset:2048
    ds_read_b64_tr_b16 v[68:69], v8 offset:16384
    ds_read_b64_tr_b16 v[70:71], v8 offset:18432
    ds_read_b64_tr_b16 v[72:73], v8 offset:32768
    ds_read_b64_tr_b16 v[74:75], v8 offset:34816
    ds_read_b64_tr_b16 v[76:77], v8 offset:49152
    ds_read_b64_tr_b16 v[78:79], v8 offset:51200
    s_waitcnt lgkmcnt(0)
    ds_read_b64_tr_b16 v[80:81], v12 offset:0
    ds_read_b64_tr_b16 v[82:83], v12 offset:2048
    ds_read_b64_tr_b16 v[84:85], v12 offset:16384
    ds_read_b64_tr_b16 v[86:87], v12 offset:18432
    ds_read_b64_tr_b16 v[88:89], v12 offset:32768
    ds_read_b64_tr_b16 v[90:91], v12 offset:34816
    ds_read_b64_tr_b16 v[92:93], v12 offset:49152
    ds_read_b64_tr_b16 v[94:95], v12 offset:51200
    s_waitcnt lgkmcnt(0)
    s_cmp_lg_u32 s3, 0
    s_cbranch_scc1 ffn_w3
    s_lshl_b32 s28, s20, 4
    s_add_u32 s28, s28, s34
    v_mov_b32 v10, 34828
    s_nop 4
ffn_p3:
    buffer_load_dword v11, v10, s[4:7], s28 offen sc1
    s_waitcnt vmcnt(0)
    v_cmp_ne_u32 vcc, s40, v11
    s_cbranch_vccnz ffn_p3_rt
ffn_p3_ok:
    s_mov_b32 s58, 0
    s_nop 2
ffn_k3:
    buffer_load_dwordx4 v[200:203], v29, s[4:7], s34 offen sc1
    buffer_load_dwordx4 v[204:207], v29, s[4:7], s34 offen offset:1024 sc1
    s_waitcnt vmcnt(0)
    v_xor_b32 v208, s40, v203
    v_xor_b32 v209, s40, v207
    v_max_u32 v210, v200, v204
    v_or_b32 v208, v208, v209
    v_cmp_ne_u32 vcc, 0, v208
    s_cbranch_vccnz ffn_k3_rt
ffn_k3_ok:
    v_max_u32_dpp v210, v210, v210 quad_perm:[1,0,3,2] row_mask:0xf bank_mask:0xf
    s_nop 1
    v_max_u32_dpp v210, v210, v210 quad_perm:[2,3,0,1] row_mask:0xf bank_mask:0xf
    s_nop 1
    v_max_u32_dpp v210, v210, v210 row_half_mirror row_mask:0xf bank_mask:0xf
    s_nop 1
    v_max_u32_dpp v210, v210, v210 row_mirror row_mask:0xf bank_mask:0xf
    s_nop 1
    v_max_u32_dpp v210, v210, v210 row_bcast:15 row_mask:0xa bank_mask:0xf
    s_nop 1
    v_max_u32_dpp v210, v210, v210 row_bcast:31 row_mask:0xc bank_mask:0xf
    s_nop 0
    v_readlane_b32 s36, v210, 63
    s_nop 1
    v_cmp_eq_u32 vcc, s36, v200
    v_cmp_eq_u32 s[28:29], s36, v204
    s_nop 0
    s_cmp_lg_u64 vcc, 0
    s_cselect_b32 s39, 0, 64
    s_or_b64 vcc, vcc, s[28:29]
    s_ff1_i32_b64 s41, vcc
    s_add_u32 s39, s39, s41
    s_lshl_b32 s39, s39, 11
    s_add_u32 s39, s39, 0x448000
    s_mov_b32 s58, 0
ffn_c3:
    buffer_load_dwordx4 v[128:131], v29, s[4:7], s39 offen sc1
    buffer_load_dwordx4 v[132:135], v29, s[4:7], s39 offen offset:1024 sc1
    v_and_b32 v10, 15, v201
    v_and_b32 v11, 15, v205
    v_cmp_eq_u32 s[24:25], s33, v10
    v_cmp_eq_u32 s[26:27], s33, v11
    s_nop 0
    v_mov_b32 v212, s24
    v_mov_b32 v213, s25
    v_mov_b32 v214, s26
    v_mov_b32 v215, s27
    v_cndmask_b32_e64 v209, v201, v205, s[28:29]
    v_cndmask_b32_e64 v210, v202, v206, s[28:29]
    v_and_b32 v209, 0xffff0000, v209
    s_mov_b64 s[42:43], vcc
    s_mov_b64 exec, vcc
    ds_write_b128 v28, v[208:211]
    ds_write_b128 v28, v[212:215] offset:16
    s_mov_b64 exec, -1
    s_waitcnt vmcnt(1)
    ds_write_b128 v21, v[128:131]
    v_max3_u32 v10, v128, v129, v130
    s_waitcnt vmcnt(0)
    ds_write_b128 v21, v[132:135] offset:1024
    v_max3_u32 v10, v10, v131, v132
    v_max3_u32 v11, v133, v134, v135
    v_max_u32 v10, v10, v11
    v_cmp_eq_u32 vcc, -1, v10
    s_cbranch_vccnz ffn_c3_rt
ffn_c3_ok:
    s_waitcnt lgkmcnt(0)
    s_nop 2
ffn_w3:
    s_barrier
    ds_read_b32 v11, v18
    ds_read_b128 v[200:203], v28
    ds_read_b32 v203, v22
    s_mov_b32 s28, 0xffff0000
    s_waitcnt lgkmcnt(2)
    v_lshlrev_b32 v14, 16, v11
    v_and_b32 v15, s28, v11
    s_waitcnt lgkmcnt(0)
    v_add_f32 v14, v14, v201
    v_add_f32 v15, v15, v201
    v_cvt_pk_bf16_f32 v14, 0, v14
    v_cvt_pk_bf16_f32 v15, 0, v15
    v_mul_f32 v14, v14, v202
    v_mul_f32 v15, v15, v202
    v_cvt_pk_bf16_f32 v14, v14, v15
    ds_write_b16 v16, v14
    ds_write_b16_d16_hi v17, v14
    v_readfirstlane_b32 s24, v203
    s_waitcnt lgkmcnt(0)
    s_barrier
    ds_read_b128 v[128:131], v19 offset:0
    ds_read_b128 v[132:135], v19 offset:64
    ds_read_b128 v[136:139], v19 offset:128
    ds_read_b128 v[140:143], v19 offset:192
    s_waitcnt lgkmcnt(3)
    v_mfma_f32_16x16x32_bf16 v[192:195], v[32:35], v[128:131], 0
    v_mfma_f32_16x16x32_bf16 v[148:151], v[48:51], v[128:131], 0
    v_mfma_f32_16x16x32_bf16 v[152:155], v[64:67], v[128:131], 0
    v_mfma_f32_16x16x32_bf16 v[156:159], v[80:83], v[128:131], 0
    s_waitcnt lgkmcnt(2)
    v_mfma_f32_16x16x32_bf16 v[192:195], v[36:39], v[132:135], v[192:195]
    v_mfma_f32_16x16x32_bf16 v[148:151], v[52:55], v[132:135], v[148:151]
    v_mfma_f32_16x16x32_bf16 v[152:155], v[68:71], v[132:135], v[152:155]
    v_mfma_f32_16x16x32_bf16 v[156:159], v[84:87], v[132:135], v[156:159]
    s_waitcnt lgkmcnt(1)
    v_mfma_f32_16x16x32_bf16 v[192:195], v[40:43], v[136:139], v[192:195]
    v_mfma_f32_16x16x32_bf16 v[148:151], v[56:59], v[136:139], v[148:151]
    v_mfma_f32_16x16x32_bf16 v[152:155], v[72:75], v[136:139], v[152:155]
    v_mfma_f32_16x16x32_bf16 v[156:159], v[88:91], v[136:139], v[156:159]
    s_waitcnt lgkmcnt(0)
    v_mfma_f32_16x16x32_bf16 v[192:195], v[44:47], v[140:143], v[192:195]
    v_mfma_f32_16x16x32_bf16 v[148:151], v[60:63], v[140:143], v[148:151]
    v_mfma_f32_16x16x32_bf16 v[152:155], v[76:79], v[140:143], v[152:155]
    v_mfma_f32_16x16x32_bf16 v[156:159], v[92:95], v[140:143], v[156:159]
    s_nop 5
    v_cndmask_b32_e64 v192, v192, v148, s[60:61]
    v_cndmask_b32_e64 v193, v193, v149, s[60:61]
    v_cndmask_b32_e64 v194, v194, v150, s[60:61]
    v_cndmask_b32_e64 v195, v195, v151, s[60:61]
    v_cndmask_b32_e64 v192, v192, v152, s[62:63]
    v_cndmask_b32_e64 v193, v193, v153, s[62:63]
    v_cndmask_b32_e64 v194, v194, v154, s[62:63]
    v_cndmask_b32_e64 v195, v195, v155, s[62:63]
    v_cndmask_b32_e64 v192, v192, v156, s[64:65]
    v_cndmask_b32_e64 v193, v193, v157, s[64:65]
    v_cndmask_b32_e64 v194, v194, v158, s[64:65]
    v_cndmask_b32_e64 v195, v195, v159, s[64:65]
    s_mov_b32 exec_lo, 0x000f000f
    s_mov_b32 exec_hi, 0x000f000f
    v_and_or_b32 v192, v192, v197, s48
    v_and_or_b32 v193, v193, v197, s49
    v_and_or_b32 v194, v194, v197, s50
    v_and_or_b32 v195, v195, v197, s51
    s_bitcmp1_b32 s24, s35
    s_cbranch_scc0 ffn_rem
    buffer_store_dwordx4 v[192:195], v30, s[4:7], s30 offen
ffn_fin:
    s_endpgm
ffn_rem:
    buffer_store_dwordx4 v[192:195], v30, s[4:7], s30 offen sc1
    s_branch ffn_fin
ffn_c3_rt:
    s_mov_b64 vcc, s[42:43]
    s_add_u32 s58, s58, 1
    s_cmp_lt_u32 s58, 0x10000
    s_cbranch_scc1 ffn_c3
    s_branch ffn_c3_ok
fz_h1_r0:
    s_add_u32 s58, s58, 1
    s_cmp_gt_u32 s58, 0x10000
    s_cbranch_scc1 fz_h1_o0
    buffer_load_dwordx4 v[104:107], v222, s[4:7], s60 offen sc1
    buffer_load_dwordx4 v[108:111], v222, s[4:7], s61 offen sc1
    buffer_load_dwordx4 v[112:115], v222, s[4:7], s16 offen sc1
    buffer_load_dwordx4 v[116:119], v222, s[4:7], s17 offen sc1
    s_branch fz_h1_c0
fz_h1_r1:
    s_add_u32 s58, s58, 1
    s_cmp_gt_u32 s58, 0x10000
    s_cbranch_scc1 fz_h1_o1
    buffer_load_dwordx4 v[108:111], v222, s[4:7], s61 offen sc1
    buffer_load_dwordx4 v[112:115], v222, s[4:7], s16 offen sc1
    buffer_load_dwordx4 v[116:119], v222, s[4:7], s17 offen sc1
    s_branch fz_h1_c1
fz_h1_r2:
    s_add_u32 s58, s58, 1
    s_cmp_gt_u32 s58, 0x10000
    s_cbranch_scc1 fz_h1_o2
    buffer_load_dwordx4 v[112:115], v222, s[4:7], s16 offen sc1
    buffer_load_dwordx4 v[116:119], v222, s[4:7], s17 offen sc1
    s_branch fz_h1_c2
fz_h1_r3:
    s_add_u32 s58, s58, 1
    s_cmp_gt_u32 s58, 0x10000
    s_cbranch_scc1 fz_h1_o3
    buffer_load_dwordx4 v[116:119], v222, s[4:7], s17 offen sc1
    s_branch fz_h1_c3
fz_h2_r0:
    s_add_u32 s58, s58, 1
    s_cmp_gt_u32 s58, 0x10000
    s_cbranch_scc1 fz_h2_o0
    buffer_load_dwordx2 v[104:105], v228, s[4:7], s52 offen sc1
    buffer_load_dwordx2 v[106:107], v228, s[4:7], s53 offen sc1
    buffer_load_dwordx2 v[108:109], v228, s[4:7], s54 offen sc1
    buffer_load_dwordx2 v[110:111], v228, s[4:7], s55 offen sc1
    s_branch fz_h2_c0
fz_h2_r1:
    s_add_u32 s58, s58, 1
    s_cmp_gt_u32 s58, 0x10000
    s_cbranch_scc1 fz_h2_o1
    buffer_load_dwordx2 v[106:107], v228, s[4:7], s53 offen sc1
    buffer_load_dwordx2 v[108:109], v228, s[4:7], s54 offen sc1
    buffer_load_dwordx2 v[110:111], v228, s[4:7], s55 offen sc1
    s_branch fz_h2_c1
fz_h2_r2:
    s_add_u32 s58, s58, 1
    s_cmp_gt_u32 s58, 0x10000
    s_cbranch_scc1 fz_h2_o2
    buffer_load_dwordx2 v[108:109], v228, s[4:7], s54 offen sc1
    buffer_load_dwordx2 v[110:111], v228, s[4:7], s55 offen sc1
    s_branch fz_h2_c2
fz_h2_r3:
    s_add_u32 s58, s58, 1
    s_cmp_gt_u32 s58, 0x10000
    s_cbranch_scc1 fz_h2_o3
    buffer_load_dwordx2 v[110:111], v228, s[4:7], s55 offen sc1
    s_branch fz_h2_c3
fz_h5_r0:
    s_add_u32 s58, s58, 1
    s_cmp_gt_u32 s58, 0x10000
    s_cbranch_scc1 fz_h5_o0
    buffer_load_dwordx4 v[40:43], v3, s[4:7], s52 offen sc1
    buffer_load_dwordx4 v[44:47], v3, s[4:7], s53 offen sc1
    buffer_load_dwordx4 v[48:51], v3, s[4:7], s54 offen sc1
    buffer_load_dwordx4 v[52:55], v6, s[4:7], s55 offen sc1
    s_branch fz_h5_c0
fz_h5_r1:
    s_add_u32 s58, s58, 1
    s_cmp_gt_u32 s58, 0x10000
    s_cbranch_scc1 fz_h5_o1
    buffer_load_dwordx4 v[44:47], v3, s[4:7], s53 offen sc1
    buffer_load_dwordx4 v[48:51], v3, s[4:7], s54 offen sc1
    buffer_load_dwordx4 v[52:55], v6, s[4:7], s55 offen sc1
    s_branch fz_h5_c1
fz_h5_r2:
    s_add_u32 s58, s58, 1
    s_cmp_gt_u32 s58, 0x10000
    s_cbranch_scc1 fz_h5_o2
    buffer_load_dwordx4 v[48:51], v3, s[4:7], s54 offen sc1
    buffer_load_dwordx4 v[52:55], v6, s[4:7], s55 offen sc1
    s_branch fz_h5_c2
fz_h5_r3:
    s_add_u32 s58, s58, 1
    s_cmp_gt_u32 s58, 0x10000
    s_cbranch_scc1 fz_h5_o3
    buffer_load_dwordx4 v[52:55], v6, s[4:7], s55 offen sc1
    s_branch fz_h5_c3
fz_k2_rt:
    s_add_u32 s58, s58, 1
    s_cmp_lt_u32 s58, 0x10000
    s_cbranch_scc1 fz_k2
    s_branch fz_k2_ok
fz_c2_rt:
    s_add_u32 s58, s58, 1
    s_cmp_lt_u32 s58, 0x10000
    s_cbranch_scc1 fz_c2
    s_branch fz_c2_ok
fz_p5_rt:
    s_add_u32 s58, s58, 1
    s_cmp_lt_u32 s58, 0x10000
    s_cbranch_scc1 fz_p5
    s_branch fz_p5_ok
fz_h4_rt:
    s_add_u32 s58, s58, 1
    s_cmp_lt_u32 s58, 0x10000
    s_cbranch_scc1 fz_h4
    s_branch fz_h4_ok
ffn_p3_rt:
    s_add_u32 s58, s58, 1
    s_cmp_lt_u32 s58, 0x10000
    s_cbranch_scc1 ffn_p3
    s_branch ffn_p3_ok
ffn_k3_rt:
    s_add_u32 s58, s58, 1
    s_cmp_lt_u32 s58, 0x10000
    s_cbranch_scc1 ffn_k3
    s_branch ffn_k3_ok
fz_codeend:
.section .rodata,"a"
.p2align 6
.amdhsa_kernel fz_kernel
  .amdhsa_next_free_vgpr 256
  .amdhsa_next_free_sgpr 102
  .amdhsa_accum_offset 256
  .amdhsa_group_segment_fixed_size 0
  .amdhsa_kernarg_size 104
  .amdhsa_user_sgpr_count 2
  .amdhsa_user_sgpr_kernarg_segment_ptr 1
  .amdhsa_system_sgpr_workgroup_id_x 1
.end_amdhsa_kernel
```

```asm
; @launch kernel=fz_kernel grid=(256,1,1) block=(512,1,1) lds=163840
.amdgcn_target "amdgcn-amd-amdhsa--gfx950"
.text
.globl fz_kernel
.p2align 8
.type fz_kernel,@function
fz_kernel:
    s_load_dwordx2 s[4:5], s[0:1], 96
    s_load_dwordx2 s[8:9], s[0:1], 0
    s_load_dwordx2 s[64:65], s[0:1], 72
    s_cmp_gt_u32 s2, 255
    s_cbranch_scc1 fz_end
    v_lshrrev_b32 v2, 6, v0
    v_and_b32 v1, 63, v0
    s_lshr_b32 s59, s2, 7
    v_readfirstlane_b32 s3, v2
    s_and_b32 s20, s2, 127
    s_cmp_lt_u32 s20, 16
    s_cselect_b32 s20, s3, 0
    s_cmp_lt_u32 s20, 4
    s_cbranch_scc1 fz_pfcback
    s_getpc_b64 s[20:21]
fz_pcb:
    s_sub_u32 s20, s20, fz_pcb-fz_kernel
    s_subb_u32 s21, s21, 0
    v_and_b32 v3, 255, v0
    v_lshlrev_b32 v3, 7, v3
    v_min_u32 v3, fz_codeend-fz_kernel-4, v3
    v_mov_b32 v5, s21
    v_add_co_u32 v4, vcc, s20, v3
    s_nop 1
    v_addc_co_u32 v5, vcc, 0, v5, vcc
    global_load_dword v251, v[4:5], off
fz_pfcback:
    s_cmp_lg_u32 s59, 0
    s_cbranch_scc1 fz_ldh
    s_load_dwordx2 s[12:13], s[0:1], 80
    s_load_dwordx2 s[16:17], s[0:1], 48
fz_ldback:
    s_add_u32 s20, s2, 58
    s_and_b32 s20, s20, 127
    s_lshr_b32 s21, s20, 3
    s_add_u32 s21, s21, 1
    s_and_b32 s22, s20, 7
    s_sub_u32 s23, s20, 124
    s_cmp_ge_u32 s20, 124
    s_cselect_b32 s21, 0, s21
    s_cselect_b32 s22, s23, s22
    s_lshr_b32 s57, s3, 2
    s_or_b32 s23, s57, s59
    s_and_b32 s24, s3, 3
    s_lshl_b32 s25, s22, 6
    s_add_u32 s25, s25, s21
    s_lshl_b32 s26, s23, 5
    s_add_u32 s26, s26, s25
    s_lshl_b32 s27, s24, 9
    s_add_u32 s28, s26, s27
    s_sub_u32 s27, 2048, s27
    s_sub_u32 s27, s27, s26
    s_lshl_b32 s29, s24, 1
    s_add_u32 s29, s29, s23
    s_sub_u32 s30, 15, s29
    s_cmp_lt_u32 s24, 2
    s_cselect_b32 s27, s28, s27
    s_cselect_b32 s31, s29, s30
    s_cselect_b32 s30, s30, s29
    s_sub_u32 s28, 2048, s27
    s_and_b32 s28, s28, 2047
    s_lshl_b32 s27, s27, 11
    s_lshl_b32 s28, s28, 11
    s_mul_i32 s31, s31, 2064
    s_mul_i32 s30, s30, 2064
    v_lshlrev_b32 v239, 4, v1
    s_mov_b32 s10, 0x400000
    s_mov_b32 s11, 0x00020000
    s_mov_b32 s6, 0x570000
    s_mov_b32 s7, 0x00020000
    s_mov_b32 s66, 0x700000
    s_mov_b32 s67, 0x00020000
    s_and_b32 s32, s57, s59
    s_add_u32 s36, s2, 4
    s_and_b32 s36, s36, 7
    s_bfe_u32 s37, s2, 0x10006
    s_lshl_b32 s63, s36, 1
    s_add_u32 s63, s63, s37
    s_cmp_lg_u32 s37, 0
    s_cselect_b32 s37, 8, s36
    s_add_u32 s37, s37, 6
    s_cmp_lt_u32 s36, 6
    s_cselect_b32 s63, s63, s37
    s_lshl_b32 s63, s63, 3
    s_bfe_u32 s37, s2, 0x30003
    s_add_u32 s63, s63, s37
    v_and_b32 v10, 15, v1
    v_lshlrev_b32 v10, 4, v10
    v_lshrrev_b32 v14, 4, v1
    v_lshl_add_u32 v14, v14, 11, v10
    s_lshl_b32 s62, s63, 16
    s_and_b32 s37, s3, 3
    s_lshl_b32 s37, s37, 9
    s_add_u32 s62, s62, s37
    s_mov_b32 s58, 0
    s_waitcnt lgkmcnt(0)
    s_cmp_eq_u32 s2, 66
    s_cbranch_scc1 fz_spec
fz_specback:
    s_cmp_lg_u32 s57, 0
    s_cbranch_scc1 fz_nox
    s_mov_b32 m0, s31
    s_nop 0
    buffer_load_dwordx4 v239, s[8:11], s27 offen lds
    buffer_load_dwordx4 v239, s[8:11], s27 offen offset:1024 lds
    s_mov_b32 m0, s30
    s_nop 0
    buffer_load_dwordx4 v239, s[8:11], s28 offen lds
    buffer_load_dwordx4 v239, s[8:11], s28 offen offset:1024 lds
fz_nox:
    buffer_load_dword v250, off, s[4:7], 0
    s_andn2_b32 s32, s57, s59
    s_cbranch_scc0 fz_nowe
    buffer_load_dwordx4 v[160:163], v14, s[64:67], s62 offen offset:0 nt
    buffer_load_dwordx4 v[164:167], v14, s[64:67], s62 offen offset:256 nt
    s_add_u32 s62, s62, 8192
    buffer_load_dwordx4 v[168:171], v14, s[64:67], s62 offen offset:0 nt
    buffer_load_dwordx4 v[172:175], v14, s[64:67], s62 offen offset:256 nt
    s_add_u32 s62, s62, 8192
fz_nowe:
    s_cmp_eq_u32 s57, 0
    s_cbranch_scc1 fz_np
    s_setprio 1
fz_np:
    v_and_b32 v2, 31, v1
    v_lshrrev_b32 v3, 5, v1
    v_and_b32 v4, 15, v1
    v_lshrrev_b32 v5, 4, v1
    v_add_u32 v6, 49536, v239
    v_lshrrev_b32 v10, 1, v2
    v_and_b32 v8, 9, v10
    v_and_b32 v11, 2, v10
    v_lshl_or_b32 v8, v11, 1, v8
    v_bfe_u32 v11, v10, 2, 1
    v_lshl_or_b32 v8, v11, 1, v8
    v_and_b32 v12, 1, v5
    v_cmp_eq_u32 vcc, 1, v12
    v_lshl_add_u32 v9, v4, 1, 1
    s_nop 0
    v_cndmask_b32_e64 v9, v9, 0, vcc
    s_cmp_lt_u32 s3, 5
    s_cselect_b64 s[32:33], -1, 0
    s_cmp_lt_u32 s3, 3
    s_cselect_b64 s[34:35], -1, 0
    v_cndmask_b32_e64 v9, v9, v2, s[32:33]
    v_cndmask_b32_e64 v8, v9, v8, s[34:35]
    s_mov_b32 s36, 0x3d000000
    s_cmp_gt_u32 s3, 4
    s_cselect_b32 s36, 0x3c800000, s36
    s_sub_u32 s37, s3, 1
    s_cmp_lt_u32 s37, 2
    s_cselect_b32 s36, 0x3a800000, s36
    s_cmp_eq_u32 s3, 0
    s_cselect_b32 s32, 16, 0
    s_cselect_b32 s33, 0x3e800000, 0
    s_cselect_b32 s34, 4.0, 0x41000000
    s_cselect_b32 s35, 0x41000000, 4.0
    v_cmp_eq_u32 vcc, 1, v2
    v_mov_b32 v10, s32
    s_nop 0
    v_cndmask_b32_e64 v10, 0, v10, vcc
    v_add_u32 v8, v8, v10
    v_cvt_f32_u32 v8, v8
    v_mul_f32 v8, s36, v8
    s_cmp_eq_u32 s3, 2
    s_cselect_b32 s32, 0x80000000, 0
    v_lshlrev_b32 v10, 31, v2
    v_and_b32 v10, s32, v10
    v_xor_b32 v8, v10, v8
    v_and_b32 v10, 1, v2
    v_cvt_f32_u32 v10, v10
    v_mul_f32 v10, s33, v10
    s_cmp_eq_u32 s3, 1
    s_cselect_b32 s33, 0x3e800000, 0
    v_mov_b32 v11, s33
    v_cndmask_b32_e64 v10, v10, v11, vcc
    s_cmp_eq_u32 s3, 5
    s_cselect_b32 s33, 0x3e800000, 0
    v_cvt_f32_u32 v12, v12
    v_fma_f32 v10, v12, s33, v10
    s_cmp_eq_u32 s3, 6
    s_cselect_b32 s33, 0x3e800000, 0
    s_cmp_eq_u32 s3, 2
    s_cselect_b32 s33, 0xbe800000, s33
    s_cmp_eq_u32 s3, 4
    s_cselect_b32 s33, 0xbe800000, s33
    v_add_f32 v10, s33, v10
    v_cvt_f32_u32 v11, v3
    v_mul_f32 v11, s35, v11
    v_fma_f32 v9, v8, v11, v10
    v_mul_f32 v10, s34, v8
    v_mul_f32 v11, 0x41800000, v8
    v_mov_b32 v104, v9
    v_fmamk_f32 v105, v8, 0x3f800000, v9
    v_fmamk_f32 v106, v8, 0x40000000, v9
    v_fmamk_f32 v107, v8, 0x40400000, v9
    v_add_f32 v108, v104, v10
    v_add_f32 v109, v105, v10
    v_add_f32 v110, v106, v10
    v_add_f32 v111, v107, v10
    v_add_f32 v112, v104, v11
    v_add_f32 v113, v105, v11
    v_add_f32 v114, v106, v11
    v_add_f32 v115, v107, v11
    v_add_f32 v116, v108, v11
    v_add_f32 v117, v109, v11
    v_add_f32 v118, v110, v11
    v_add_f32 v119, v111, v11
    v_cos_f32 v104, v104
    v_cos_f32 v105, v105
    v_cos_f32 v106, v106
    v_cos_f32 v107, v107
    v_cos_f32 v108, v108
    v_cos_f32 v109, v109
    v_cos_f32 v110, v110
    v_cos_f32 v111, v111
    v_cos_f32 v112, v112
    v_cos_f32 v113, v113
    v_cos_f32 v114, v114
    v_cos_f32 v115, v115
    v_cos_f32 v116, v116
    v_cos_f32 v117, v117
    v_cos_f32 v118, v118
    v_cos_f32 v119, v119
    s_lshl_b32 s32, s3, 11
    v_add_u32 v8, s32, v6
    s_cmp_eq_u32 s3, 0
    s_cbranch_scc1 fz_jb
    v_cvt_pk_f16_f32 v128, v104, v105
    v_cvt_pk_f16_f32 v129, v106, v107
    v_cvt_pk_f16_f32 v130, v108, v109
    v_cvt_pk_f16_f32 v131, v110, v111
    v_cvt_pk_f16_f32 v132, v112, v113
    v_cvt_pk_f16_f32 v133, v114, v115
    v_cvt_pk_f16_f32 v134, v116, v117
    v_cvt_pk_f16_f32 v135, v118, v119
fz_jend:
    ds_write_b128 v8, v[128:131] offset:0
    ds_write_b128 v8, v[132:135] offset:1024
    v_mov_b32 v15, 49520
    v_mov_b32 v10, 0
    ds_write_b32 v15, v10
    s_waitcnt lgkmcnt(0)
    s_barrier
    v_lshlrev_b32 v240, 31, v1
    v_lshrrev_b32 v10, 16, v240
    v_or_b32 v240, v240, v10
    v_mov_b32 v229, 0xfffcfffc
    v_mov_b32 v242, 0xffff0000
    s_mov_b32 s42, 0x3f803f80
    s_cmp_lg_u32 s57, 0
    s_cbranch_scc1 fz_nc1
    ds_read_b128 v[16:19], v6 offset:0
    ds_read_b128 v[20:23], v6 offset:1024
    ds_read_b128 v[24:27], v6 offset:2048
    ds_read_b128 v[28:31], v6 offset:3072
    ds_read_b128 v[32:35], v6 offset:4096
    ds_read_b128 v[36:39], v6 offset:5120
    ds_read_b128 v[40:43], v6 offset:6144
    ds_read_b128 v[44:47], v6 offset:7168
    ds_read_b128 v[48:51], v6 offset:8192
    ds_read_b128 v[52:55], v6 offset:9216
    ds_read_b128 v[56:59], v6 offset:10240
    ds_read_b128 v[60:63], v6 offset:11264
    ds_read_b128 v[64:67], v6 offset:12288
    ds_read_b128 v[68:71], v6 offset:13312
    v_lshlrev_b32 v7, 9, v3
    v_bfe_u32 v10, v1, 2, 2
    v_lshl_add_u32 v7, v10, 6, v7
    v_and_b32 v10, 1, v5
    v_lshl_add_u32 v7, v10, 5, v7
    v_and_b32 v10, 3, v1
    v_lshl_add_u32 v7, v10, 3, v7
    v_add_u32 v7, s31, v7
    v_lshlrev_b32 v8, 9, v3
    v_lshl_add_u32 v8, v2, 1, v8
    v_sub_u32 v9, 2048, v8
    v_and_b32 v9, 2047, v9
    v_add_u32 v9, s30, v9
    s_add_u32 s32, s30, 576
    v_sub_u32 v8, s32, v8
    v_cmp_eq_u32 vcc, 0, v2
    s_nop 1
    v_cndmask_b32_e64 v234, 0, -2.0, vcc
    v_mov_b32 v235, 0x3b27c5ac
    s_lshr_b32 s32, s24, 1
    s_lshl_b32 s32, s32, 6
    s_mul_i32 s33, s3, 2304
    s_add_u32 s32, s32, s33
    s_add_u32 s32, s32, 67968
    v_lshl_add_u32 v10, v3, 1, v1
    v_lshlrev_b32 v10, 4, v10
    v_add_u32 v216, s32, v10
    v_bfe_u32 v10, v0, 2, 1
    v_mul_u32_u24 v10, 34, v10
    v_lshrrev_b32 v11, 4, v0
    v_add_u32 v10, v10, v11
    v_lshlrev_b32 v10, 4, v10
    v_bfe_u32 v11, v0, 3, 1
    v_lshl_add_u32 v10, v11, 3, v10
    v_bfe_u32 v11, v0, 1, 1
    v_lshl_add_u32 v10, v11, 2, v10
    v_and_b32 v12, 1, v0
    s_mov_b32 s33, 9216
    s_cmp_eq_u32 s2, 66
    s_cselect_b32 s32, s33, 0x1b40
    v_mul_lo_u32 v11, v12, s32
    v_add_u32 v217, v10, v11
    v_add_u32 v217, 67968, v217
    s_cselect_b32 s32, s33, 0x940
    v_mul_lo_u32 v11, v12, s32
    v_add_u32 v218, v10, v11
    v_add_u32 v218, 70272, v218
    s_cselect_b32 s32, s33, 0xfffff6c0
    v_mul_lo_u32 v11, v12, s32
    v_add_u32 v219, v10, v11
    v_add_u32 v219, 73792, v219
    s_cselect_b32 s32, s33, 0xffffe4c0
    v_mul_lo_u32 v11, v12, s32
    v_add_u32 v220, v10, v11
    v_add_u32 v220, 76096, v220
    v_lshrrev_b32 v10, 2, v0
    v_and_b32 v11, 3, v0
    v_lshlrev_b32 v11, 4, v11
    v_lshl_add_u32 v221, v10, 7, v11
    s_mul_i32 s52, s20, 16512
    s_lshl_b32 s33, s59, 6
    s_add_u32 s52, s52, s33
    s_add_u32 s52, s52, 0x1000
    s_add_u32 s53, s52, 8192
    v_mov_b32 v160, 0
    v_mov_b32 v161, 0
    v_mov_b32 v162, 0
    v_mov_b32 v163, 0
    s_setprio 3
    s_waitcnt vmcnt(0) lgkmcnt(0)
    ds_read_b64_tr_b16 v[88:89], v7 offset:0
    ds_read_b64_tr_b16 v[90:91], v7 offset:256
    ds_read_b64_tr_b16 v[92:93], v7 offset:1024
    ds_read_b64_tr_b16 v[94:95], v7 offset:1280
    ds_read_u16_d16 v96, v9
    ds_read_u16_d16_hi v136, v8 offset:1408
    ds_read_u16_d16 v97, v8 offset:1344
    ds_read_u16_d16_hi v137, v8 offset:1280
    ds_read_u16_d16 v98, v8 offset:1216
    ds_read_u16_d16_hi v138, v8 offset:1152
    ds_read_u16_d16 v99, v8 offset:1088
    ds_read_u16_d16_hi v139, v8 offset:1024
    s_waitcnt lgkmcnt(8)
    v_mfma_f32_32x32x16_bf16 v[104:119], v[88:91], v[16:19], 0
    v_mfma_f32_32x32x16_bf16 v[104:119], v[92:95], v[20:23], v[104:119]
    ds_read_u16_d16 v100, v8 offset:448
    ds_read_u16_d16_hi v140, v8 offset:384
    ds_read_u16_d16 v101, v8 offset:320
    ds_read_u16_d16_hi v141, v8 offset:256
    ds_read_u16_d16 v102, v8 offset:192
    ds_read_u16_d16_hi v142, v8 offset:128
    ds_read_u16_d16 v103, v8 offset:64
    ds_read_u16_d16_hi v143, v8 offset:0
    v_dot2_f32_bf16 v160, v88, s42, v160
    v_dot2_f32_bf16 v161, v88, v88, v161
    v_dot2_f32_bf16 v160, v89, s42, v160
    v_dot2_f32_bf16 v161, v89, v89, v161
    v_dot2_f32_bf16 v160, v90, s42, v160
    v_dot2_f32_bf16 v161, v90, v90, v161
    v_dot2_f32_bf16 v160, v91, s42, v160
    v_dot2_f32_bf16 v161, v91, v91, v161
    v_dot2_f32_bf16 v160, v92, s42, v160
    v_dot2_f32_bf16 v161, v92, v92, v161
    v_dot2_f32_bf16 v160, v93, s42, v160
    v_dot2_f32_bf16 v161, v93, v93, v161
    v_dot2_f32_bf16 v160, v94, s42, v160
    v_dot2_f32_bf16 v161, v94, v94, v161
    v_dot2_f32_bf16 v160, v95, s42, v160
    v_dot2_f32_bf16 v161, v95, v95, v161
    s_waitcnt lgkmcnt(0)
    v_or_b32 v96, v96, v136
    v_or_b32 v97, v97, v137
    v_or_b32 v98, v98, v138
    v_or_b32 v99, v99, v139
    v_or_b32 v100, v100, v140
    v_or_b32 v101, v101, v141
    v_or_b32 v102, v102, v142
    v_or_b32 v103, v103, v143
    v_mfma_f32_32x32x16_bf16 v[120:135], v[96:99], v[16:19], 0
    s_nop 0
    v_mfma_f32_32x32x16_bf16 v[120:135], v[100:103], v[20:23], v[120:135]
    v_dot2_f32_bf16 v162, v96, s42, v162
    v_dot2_f32_bf16 v163, v96, v96, v163
    v_dot2_f32_bf16 v162, v97, s42, v162
    v_dot2_f32_bf16 v163, v97, v97, v163
    v_dot2_f32_bf16 v162, v98, s42, v162
    v_dot2_f32_bf16 v163, v98, v98, v163
    v_dot2_f32_bf16 v162, v99, s42, v162
    v_dot2_f32_bf16 v163, v99, v99, v163
    v_dot2_f32_bf16 v162, v100, s42, v162
    v_dot2_f32_bf16 v163, v100, v100, v163
    v_dot2_f32_bf16 v162, v101, s42, v162
    v_dot2_f32_bf16 v163, v101, v101, v163
    v_dot2_f32_bf16 v162, v102, s42, v162
    v_dot2_f32_bf16 v163, v102, v102, v163
    v_dot2_f32_bf16 v162, v103, s42, v162
    v_dot2_f32_bf16 v163, v103, v103, v163
    s_nop 1
    v_permlane32_swap_b32 v160, v162
    v_permlane32_swap_b32 v161, v163
    v_add_f32 v160, v160, v162
    v_add_f32 v161, v161, v163
    s_nop 1
    v_permlane16_swap_b32 v160, v161
    v_add_f32 v160, v160, v161
    s_nop 1
    v_add_f32_dpp v160, v160, v160 quad_perm:[1,0,3,2] row_mask:0xf bank_mask:0xf
    s_nop 1
    v_add_f32_dpp v160, v160, v160 quad_perm:[2,3,0,1] row_mask:0xf bank_mask:0xf
    s_nop 1
    v_add_f32_dpp v160, v160, v160 row_half_mirror row_mask:0xf bank_mask:0xf
    s_nop 1
    v_add_f32_dpp v160, v160, v160 row_mirror row_mask:0xf bank_mask:0xf
    s_mov_b32 s43, 0x3e800000
    v_mov_b32 v161, v160
    s_nop 1
    v_permlane16_swap_b32 v160, v161
    v_mul_f32 v160, 0x3c800000, v160
    v_fma_f32 v161, v161, s43, v235
    v_fma_f32 v161, -v160, v160, v161
    v_rsq_f32 v161, v161
    s_nop 0
    v_mul_f32 v160, v160, v161
    v_readlane_b32 s32, v161, 0
    v_readlane_b32 s34, v161, 32
    v_readlane_b32 s36, v160, 0
    v_readlane_b32 s37, v160, 32
    s_nop 0
    v_mul_f32 v164, s36, v234
    v_fmac_f32 v164, s37, v234
    v_pk_fma_f32 v[104:105], v[104:105], s[32:33], v[164:165] op_sel_hi:[1,0,0]
    v_pk_fma_f32 v[106:107], v[106:107], s[32:33], v[164:165] op_sel_hi:[1,0,0]
    v_pk_fma_f32 v[108:109], v[108:109], s[32:33], v[164:165] op_sel_hi:[1,0,0]
    v_pk_fma_f32 v[110:111], v[110:111], s[32:33], v[164:165] op_sel_hi:[1,0,0]
    v_pk_fma_f32 v[112:113], v[112:113], s[32:33], v[164:165] op_sel_hi:[1,0,0]
    v_pk_fma_f32 v[114:115], v[114:115], s[32:33], v[164:165] op_sel_hi:[1,0,0]
    v_pk_fma_f32 v[116:117], v[116:117], s[32:33], v[164:165] op_sel_hi:[1,0,0]
    v_pk_fma_f32 v[118:119], v[118:119], s[32:33], v[164:165] op_sel_hi:[1,0,0]
    v_pk_fma_f32 v[104:105], v[120:121], s[34:35], v[104:105] op_sel_hi:[1,0,1]
    v_pk_fma_f32 v[106:107], v[122:123], s[34:35], v[106:107] op_sel_hi:[1,0,1]
    v_pk_fma_f32 v[108:109], v[124:125], s[34:35], v[108:109] op_sel_hi:[1,0,1]
    v_pk_fma_f32 v[110:111], v[126:127], s[34:35], v[110:111] op_sel_hi:[1,0,1]
    v_pk_fma_f32 v[112:113], v[128:129], s[34:35], v[112:113] op_sel_hi:[1,0,1]
    v_pk_fma_f32 v[114:115], v[130:131], s[34:35], v[114:115] op_sel_hi:[1,0,1]
    v_pk_fma_f32 v[116:117], v[132:133], s[34:35], v[116:117] op_sel_hi:[1,0,1]
    v_pk_fma_f32 v[118:119], v[134:135], s[34:35], v[118:119] op_sel_hi:[1,0,1]
    v_cvt_pk_f16_f32 v136, v104, v105
    v_cvt_pk_f16_f32 v137, v106, v107
    v_cvt_pk_f16_f32 v138, v108, v109
    v_cvt_pk_f16_f32 v139, v110, v111
    v_cvt_pk_f16_f32 v140, v112, v113
    v_cvt_pk_f16_f32 v141, v114, v115
    v_cvt_pk_f16_f32 v142, v116, v117
    v_cvt_pk_f16_f32 v143, v118, v119
    v_mov_b32_dpp v152, v136 quad_perm:[1,0,3,2] row_mask:0xf bank_mask:0xf
    v_mov_b32_dpp v153, v137 quad_perm:[1,0,3,2] row_mask:0xf bank_mask:0xf
    v_mov_b32_dpp v154, v138 quad_perm:[1,0,3,2] row_mask:0xf bank_mask:0xf
    v_mov_b32_dpp v155, v139 quad_perm:[1,0,3,2] row_mask:0xf bank_mask:0xf
    v_mov_b32_dpp v156, v140 quad_perm:[1,0,3,2] row_mask:0xf bank_mask:0xf
    v_mov_b32_dpp v157, v141 quad_perm:[1,0,3,2] row_mask:0xf bank_mask:0xf
    v_mov_b32_dpp v158, v142 quad_perm:[1,0,3,2] row_mask:0xf bank_mask:0xf
    v_mov_b32_dpp v159, v143 quad_perm:[1,0,3,2] row_mask:0xf bank_mask:0xf
    v_pk_mul_f16 v144, v136, v24
    v_pk_mul_f16 v145, v137, v25
    v_pk_mul_f16 v146, v138, v26
    v_pk_mul_f16 v147, v139, v27
    v_pk_mul_f16 v148, v140, v28
    v_pk_mul_f16 v149, v141, v29
    v_pk_mul_f16 v150, v142, v30
    v_pk_mul_f16 v151, v143, v31
    v_mfma_f32_16x16x32_f16 v[120:123], v[136:139], v[56:59], 0
    v_pk_fma_f16 v144, v152, v32, v144
    v_pk_fma_f16 v145, v153, v33, v145
    v_pk_fma_f16 v146, v154, v34, v146
    v_pk_fma_f16 v147, v155, v35, v147
    v_mfma_f32_16x16x32_f16 v[120:123], v[140:143], v[60:63], v[120:123]
    v_pk_fma_f16 v148, v156, v36, v148
    v_pk_fma_f16 v149, v157, v37, v149
    v_pk_fma_f16 v150, v158, v38, v150
    v_pk_fma_f16 v151, v159, v39, v151
    v_mfma_f32_32x32x16_f16 v[104:119], v[144:147], v[40:43], 0
    v_xor_b32_dpp v152, v144, v240 quad_perm:[1,0,3,2] row_mask:0xf bank_mask:0xf
    v_xor_b32_dpp v153, v145, v240 quad_perm:[1,0,3,2] row_mask:0xf bank_mask:0xf
    v_xor_b32_dpp v154, v146, v240 quad_perm:[1,0,3,2] row_mask:0xf bank_mask:0xf
    v_xor_b32_dpp v155, v147, v240 quad_perm:[1,0,3,2] row_mask:0xf bank_mask:0xf
    v_mfma_f32_32x32x16_f16 v[104:119], v[148:151], v[44:47], v[104:119]
    v_xor_b32_dpp v156, v148, v240 quad_perm:[1,0,3,2] row_mask:0xf bank_mask:0xf
    v_xor_b32_dpp v157, v149, v240 quad_perm:[1,0,3,2] row_mask:0xf bank_mask:0xf
    v_xor_b32_dpp v158, v150, v240 quad_perm:[1,0,3,2] row_mask:0xf bank_mask:0xf
    v_xor_b32_dpp v159, v151, v240 quad_perm:[1,0,3,2] row_mask:0xf bank_mask:0xf
    v_mfma_f32_32x32x16_f16 v[104:119], v[152:155], v[48:51], v[104:119]
    s_nop 0
    v_mfma_f32_32x32x16_f16 v[104:119], v[156:159], v[52:55], v[104:119]
    v_mfma_f32_16x16x32_f16 v[124:127], v[136:139], v[64:67], 0
    v_mfma_f32_16x16x32_f16 v[124:127], v[140:143], v[68:71], v[124:127]
    v_readfirstlane_b32 s40, v250
    s_nop 1
    s_add_u32 s40, s40, 1
    s_and_b32 s38, s40, 3
    s_and_b32 s39, s40, 15
    s_bfe_u32 s41, s40, 0x20002
    s_lshl_b32 s41, s41, 16
    s_or_b32 s44, s38, s41
    s_bfe_u32 s41, s40, 0x40004
    s_lshl_b32 s41, s41, 4
    s_or_b32 s48, s39, s41
    s_bfe_u32 s41, s40, 0x20004
    s_lshl_b32 s41, s41, 16
    s_or_b32 s45, s38, s41
    s_bfe_u32 s41, s40, 0x40008
    s_lshl_b32 s41, s41, 4
    s_or_b32 s49, s39, s41
    s_bfe_u32 s41, s40, 0x20006
    s_lshl_b32 s41, s41, 16
    s_or_b32 s46, s38, s41
    s_bfe_u32 s41, s40, 0x4000c
    s_lshl_b32 s41, s41, 4
    s_or_b32 s50, s39, s41
    s_bfe_u32 s41, s40, 0x20008
    s_lshl_b32 s41, s41, 16
    s_or_b32 s47, s38, s41
    s_bfe_u32 s41, s40, 0x40010
    s_lshl_b32 s41, s41, 4
    s_or_b32 s51, s39, s41
    s_mov_b32 s38, 0x404
    s_cmp_eq_u32 s2, 66
    s_cselect_b32 s39, 8, 4
    s_cselect_b32 s38, 8, s38
    s_mov_b64 vcc, 0xffff
    v_cvt_pk_f16_f32 v143, v118, v119
    v_cvt_pk_f16_f32 v142, v116, v117
    v_cvt_pk_f16_f32 v141, v114, v115
    v_cvt_pk_f16_f32 v140, v112, v113
    v_cvt_pk_f16_f32 v139, v110, v111
    v_cvt_pk_f16_f32 v138, v108, v109
    v_cvt_pk_f16_f32 v137, v106, v107
    v_cndmask_b32_e64 v104, v104, v121, vcc
    v_cndmask_b32_e64 v105, v105, v125, vcc
    v_pk_add_f16 v147, v142, v143 op_sel:[0,1] op_sel_hi:[1,0] neg_lo:[0,1]
    v_pk_add_f16 v151, v142, v143 op_sel:[0,1] op_sel_hi:[1,0] neg_hi:[1,0]
    v_pk_add_f16 v146, v140, v141 op_sel:[0,1] op_sel_hi:[1,0] neg_lo:[0,1]
    v_pk_add_f16 v150, v140, v141 op_sel:[0,1] op_sel_hi:[1,0] neg_hi:[1,0]
    v_pk_add_f16 v145, v138, v139 op_sel:[0,1] op_sel_hi:[1,0] neg_lo:[0,1]
    v_pk_add_f16 v149, v138, v139 op_sel:[0,1] op_sel_hi:[1,0] neg_hi:[1,0]
    v_cvt_pk_f16_f32 v136, v104, v105
    v_pk_add_f16 v144, v136, v137 op_sel:[0,1] op_sel_hi:[1,0] neg_lo:[0,1]
    v_pk_add_f16 v148, v136, v137 op_sel:[0,1] op_sel_hi:[1,0] neg_hi:[1,0]
    ds_write_b128 v216, v[144:147]
    ds_write_b128 v216, v[148:151] offset:1152
    s_waitcnt lgkmcnt(0)
    v_mov_b32 v10, 1
    s_mov_b64 exec, 1
    ds_add_u32 v15, v10
    s_mov_b64 exec, -1
    s_cmp_gt_u32 s3, 3
    s_cbranch_scc1 fz_bsp0
fz_sy:
    ds_read_b32 v10, v15
    s_waitcnt lgkmcnt(0)
    v_and_b32 v10, 0xff, v10
    v_cmp_ne_u32 vcc, s39, v10
    s_cbranch_vccnz fz_sy
    ds_read_b32 v104, v217 offset:0
    ds_read_b32 v105, v218 offset:0
    ds_read_b32 v106, v219 offset:0
    ds_read_b32 v107, v220 offset:0
    ds_read_b32 v108, v217 offset:256
    ds_read_b32 v109, v218 offset:256
    ds_read_b32 v110, v219 offset:256
    ds_read_b32 v111, v220 offset:256
    s_waitcnt lgkmcnt(4)
    v_pk_add_f16 v112, v104, v106
    v_pk_add_f16 v114, v105, v107
    v_pk_add_f16 v113, v104, v106 neg_lo:[0,1] neg_hi:[0,1]
    v_pk_add_f16 v115, v105, v107 neg_lo:[0,1] neg_hi:[0,1]
    v_pk_add_f16 v116, v112, v114
    v_pk_add_f16 v118, v112, v114 neg_lo:[0,1] neg_hi:[0,1]
    v_pk_add_f16 v117, v113, v115 op_sel:[0,1] op_sel_hi:[1,0] neg_hi:[0,1]
    v_pk_add_f16 v119, v113, v115 op_sel:[0,1] op_sel_hi:[1,0] neg_lo:[0,1]
    v_add_u32 v116, 0x20002, v116
    v_add_u32 v117, 0x20002, v117
    v_add_u32 v118, 0x20002, v118
    v_add_u32 v119, 0x20002, v119
    v_and_or_b32 v116, v116, v229, s44
    v_and_or_b32 v117, v117, v229, s45
    v_and_or_b32 v118, v118, v229, s46
    v_and_or_b32 v119, v119, v229, s47
    buffer_store_dwordx4 v[116:119], v221, s[4:7], s52 offen sc1
    s_waitcnt lgkmcnt(0)
    v_pk_add_f16 v120, v108, v110
    v_pk_add_f16 v122, v109, v111
    v_pk_add_f16 v121, v108, v110 neg_lo:[0,1] neg_hi:[0,1]
    v_pk_add_f16 v123, v109, v111 neg_lo:[0,1] neg_hi:[0,1]
    v_pk_add_f16 v124, v120, v122
    v_pk_add_f16 v126, v120, v122 neg_lo:[0,1] neg_hi:[0,1]
    v_pk_add_f16 v125, v121, v123 op_sel:[0,1] op_sel_hi:[1,0] neg_hi:[0,1]
    v_pk_add_f16 v127, v121, v123 op_sel:[0,1] op_sel_hi:[1,0] neg_lo:[0,1]
    v_add_u32 v124, 0x20002, v124
    v_add_u32 v125, 0x20002, v125
    v_add_u32 v126, 0x20002, v126
    v_add_u32 v127, 0x20002, v127
    v_and_or_b32 v124, v124, v229, s44
    v_and_or_b32 v125, v125, v229, s45
    v_and_or_b32 v126, v126, v229, s46
    v_and_or_b32 v127, v127, v229, s47
    buffer_store_dwordx4 v[124:127], v221, s[4:7], s53 offen sc1
    s_cmp_lg_u32 s59, 0
    s_cbranch_scc1 ffn
    s_and_b32 s32, s3, 3
    s_lshr_b32 s33, s3, 2
    s_lshl_b32 s33, s33, 4
    s_add_u32 s33, s33, s32
    v_and_b32 v8, 12, v4
    v_bfe_u32 v9, v4, 1, 1
    v_lshl_add_u32 v8, v9, 5, v8
    v_add_u32 v8, s33, v8
    v_cvt_f32_u32 v8, v8
    v_and_b32 v12, 1, v1
    v_cvt_f32_u32 v9, v12
    v_lshlrev_b32 v13, 2, v5
    v_cvt_f32_u32 v10, v13
    v_mul_f32 v11, 0x3c800000, v8
    v_mul_f32 v9, 0x3e800000, v9
    v_fma_f32 v9, v11, v10, v9
    v_mov_b32 v128, v9
    v_fmamk_f32 v129, v11, 0x3f800000, v9
    v_fmamk_f32 v130, v11, 0x40000000, v9
    v_fmamk_f32 v131, v11, 0x40400000, v9
    v_mul_f32 v11, 0x3a000000, v8
    v_lshlrev_b32 v9, 31, v1
    v_xor_b32 v11, v9, v11
    v_mul_f32 v9, v11, v10
    v_mov_b32 v112, v9
    v_fmamk_f32 v113, v11, 0x3f800000, v9
    v_fmamk_f32 v114, v11, 0x40000000, v9
    v_fmamk_f32 v115, v11, 0x40400000, v9
    v_fmamk_f32 v116, v11, 0x41800000, v9
    v_fmamk_f32 v117, v11, 0x41880000, v9
    v_fmamk_f32 v118, v11, 0x41900000, v9
    v_fmamk_f32 v119, v11, 0x41980000, v9
    v_cos_f32 v104, v128
    v_sin_f32 v105, v128
    v_cos_f32 v106, v129
    v_sin_f32 v107, v129
    v_cos_f32 v108, v130
    v_sin_f32 v109, v130
    v_cos_f32 v110, v131
    v_sin_f32 v111, v131
    v_sin_f32 v120, v112
    v_sin_f32 v121, v113
    v_sin_f32 v122, v114
    v_sin_f32 v123, v115
    v_sin_f32 v124, v116
    v_sin_f32 v125, v117
    v_sin_f32 v126, v118
    v_sin_f32 v127, v119
    v_cos_f32 v112, v112
    v_cos_f32 v113, v113
    v_cos_f32 v114, v114
    v_cos_f32 v115, v115
    v_cos_f32 v116, v116
    v_cos_f32 v117, v117
    v_cos_f32 v118, v118
    v_cos_f32 v119, v119
    v_cvt_pk_f16_f32 v16, v104, v105
    v_cvt_pk_f16_f32 v17, v106, v107
    v_cvt_pk_f16_f32 v18, v108, v109
    v_cvt_pk_f16_f32 v19, v110, v111
    v_cvt_pk_f16_f32 v20, v112, v113
    v_cvt_pk_f16_f32 v21, v114, v115
    v_cvt_pk_f16_f32 v22, v116, v117
    v_cvt_pk_f16_f32 v23, v118, v119
    v_cvt_pk_f16_f32 v24, v120, v121
    v_cvt_pk_f16_f32 v25, v122, v123
    v_cvt_pk_f16_f32 v26, v124, v125
    v_cvt_pk_f16_f32 v27, v126, v127
    v_lshrrev_b32 v8, 3, v1
    v_mul_u32_u24 v222, 16512, v8
    v_and_b32 v9, 7, v1
    v_lshl_add_u32 v222, v9, 4, v222
    s_mul_i32 s60, s3, 528384
    s_lshl_b32 s32, s20, 7
    s_add_u32 s60, s60, s32
    s_add_u32 s60, s60, 0x1000
    s_add_u32 s61, s60, 132096
    s_add_u32 s16, s60, 264192
    s_add_u32 s17, s60, 396288
    v_lshlrev_b32 v8, 1, v8
    v_bfe_u32 v9, v1, 2, 1
    v_add_u32 v8, v8, v9
    s_lshl_b32 s32, s3, 2
    s_add_u32 s32, s32, 1
    v_lshl_add_u32 v8, v8, 5, s32
    v_cmp_eq_u32 vcc, 1, v12
    v_bfe_u32 v9, v1, 1, 1
    v_mul_u32_u24 v9, 8256, v9
    v_add_u32 v9, 86400, v9
    s_cmp_eq_u32 s3, 3
    s_cselect_b32 s32, 272, 0
    v_sub_u32 v10, 512, v8
    v_cndmask_b32_e64 v10, v8, v10, vcc
    v_and_b32 v11, 16, v10
    v_lshl_add_u32 v11, v11, 6, v9
    v_lshrrev_b32 v12, 7, v10
    v_lshl_add_u32 v11, v12, 8, v11
    v_and_b32 v12, 15, v10
    v_lshl_add_u32 v11, v12, 4, v11
    v_bfe_u32 v12, v10, 5, 2
    v_lshl_add_u32 v223, v12, 2, v11
    v_add_u32 v8, 1, v8
    v_sub_u32 v10, 512, v8
    v_cndmask_b32_e64 v10, v8, v10, vcc
    v_and_b32 v11, 16, v10
    v_lshl_add_u32 v11, v11, 6, v9
    v_lshrrev_b32 v12, 7, v10
    v_lshl_add_u32 v11, v12, 8, v11
    v_and_b32 v12, 15, v10
    v_lshl_add_u32 v11, v12, 4, v11
    v_bfe_u32 v12, v10, 5, 2
    v_lshl_add_u32 v224, v12, 2, v11
    v_add_u32 v8, 1, v8
    v_sub_u32 v10, 512, v8
    v_cndmask_b32_e64 v10, v8, v10, vcc
    v_and_b32 v11, 16, v10
    v_lshl_add_u32 v11, v11, 6, v9
    v_lshrrev_b32 v12, 7, v10
    v_lshl_add_u32 v11, v12, 8, v11
    v_and_b32 v12, 15, v10
    v_lshl_add_u32 v11, v12, 4, v11
    v_bfe_u32 v12, v10, 5, 2
    v_lshl_add_u32 v100, v12, 2, v11
    v_mul_u32_u24 v10, s32, v3
    v_sub_u32 v8, v8, v10
    v_add_u32 v8, 1, v8
    v_sub_u32 v10, 512, v8
    v_cndmask_b32_e64 v10, v8, v10, vcc
    v_lshrrev_b32 v11, 1, v10
    v_and_b32 v11, 256, v11
    v_sub_u32 v10, v10, v11
    v_and_b32 v11, 16, v10
    v_lshl_add_u32 v11, v11, 6, v9
    v_lshrrev_b32 v12, 7, v10
    v_lshl_add_u32 v11, v12, 8, v11
    v_and_b32 v12, 15, v10
    v_lshl_add_u32 v11, v12, 4, v11
    v_bfe_u32 v12, v10, 5, 2
    v_lshl_add_u32 v101, v12, 2, v11
    s_and_b32 s32, s3, 3
    s_lshl_b32 s32, s32, 11
    s_add_u32 s32, s32, 86400
    v_add_u32 v225, s32, v239
    v_add_u32 v8, s33, v13
    v_sub_u32 v9, 32, v8
    v_min_u32 v9, v8, v9
    v_and_b32 v10, 15, v8
    v_cmp_eq_u32 s[32:33], 0, v10
    v_cmp_lt_u32 s[34:35], 16, v8
    v_lshlrev_b32 v10, 10, v9
    v_subrev_u32 v10, 1024, v10
    v_mov_b32 v11, 15872
    v_cmp_eq_u32 vcc, 0, v8
    s_nop 1
    v_cndmask_b32_e64 v10, v10, v11, vcc
    v_and_b32 v11, 3, v1
    v_lshl_add_u32 v10, v11, 4, v10
    v_lshrrev_b32 v11, 2, v4
    v_lshlrev_b32 v12, 7, v11
    v_sub_u32 v13, 960, v12
    v_cndmask_b32_e64 v13, v12, v13, s[34:35]
    v_add_u32 v226, v10, v13
    s_or_b64 s[34:35], s[34:35], s[32:33]
    v_add_u32 v12, 512, v12
    v_sub_u32 v13, 960, v12
    v_cndmask_b32_e64 v13, v12, v13, s[34:35]
    v_add_u32 v227, v10, v13
    s_mul_i32 s56, s20, 16512
    s_add_u32 s56, s56, 0x210000
    v_mov_b32 v249, 0x30003
    v_mov_b32 v252, s44
    v_mov_b32 v253, s45
    v_mov_b32 v254, s46
    v_mov_b32 v255, s47
    s_waitcnt lgkmcnt(0)
    s_waitcnt vmcnt(0)
    buffer_load_dwordx4 v[104:107], v222, s[4:7], s60 offen sc1
    buffer_load_dwordx4 v[108:111], v222, s[4:7], s61 offen sc1
    buffer_load_dwordx4 v[112:115], v222, s[4:7], s16 offen sc1
    buffer_load_dwordx4 v[116:119], v222, s[4:7], s17 offen sc1
fz_h1_c0:
    s_waitcnt vmcnt(3)
    v_xor_b32 v104, v252, v104
    v_xor_b32 v105, v253, v105
    v_xor_b32 v106, v254, v106
    v_xor_b32 v107, v255, v107
    v_or3_b32 v10, v104, v105, v106
    v_bitop3_b32 v10, v10, v107, v249 bitop3:0xa8
    v_cmp_ne_u32 vcc, 0, v10
    s_cbranch_vccnz fz_h1_r0
fz_h1_o0:
    ds_write_b32 v223, v104 offset:0
    ds_write_b32 v223, v105 offset:2048
    ds_write_b32 v223, v106 offset:4096
    ds_write_b32 v223, v107 offset:6144
fz_h1_c1:
    s_waitcnt vmcnt(2)
    v_xor_b32 v108, v252, v108
    v_xor_b32 v109, v253, v109
    v_xor_b32 v110, v254, v110
    v_xor_b32 v111, v255, v111
    v_or3_b32 v10, v108, v109, v110
    v_bitop3_b32 v10, v10, v111, v249 bitop3:0xa8
    v_cmp_ne_u32 vcc, 0, v10
    s_cbranch_vccnz fz_h1_r1
fz_h1_o1:
    ds_write_b32 v224, v108 offset:0
    ds_write_b32 v224, v109 offset:2048
    ds_write_b32 v224, v110 offset:4096
    ds_write_b32 v224, v111 offset:6144
fz_h1_c2:
    s_waitcnt vmcnt(1)
    v_xor_b32 v112, v252, v112
    v_xor_b32 v113, v253, v113
    v_xor_b32 v114, v254, v114
    v_xor_b32 v115, v255, v115
    v_or3_b32 v10, v112, v113, v114
    v_bitop3_b32 v10, v10, v115, v249 bitop3:0xa8
    v_cmp_ne_u32 vcc, 0, v10
    s_cbranch_vccnz fz_h1_r2
fz_h1_o2:
    ds_write_b32 v100, v112 offset:0
    ds_write_b32 v100, v113 offset:2048
    ds_write_b32 v100, v114 offset:4096
    ds_write_b32 v100, v115 offset:6144
fz_h1_c3:
    s_waitcnt vmcnt(0)
    v_xor_b32 v116, v252, v116
    v_xor_b32 v117, v253, v117
    v_xor_b32 v118, v254, v118
    v_xor_b32 v119, v255, v119
    v_or3_b32 v10, v116, v117, v118
    v_bitop3_b32 v10, v10, v119, v249 bitop3:0xa8
    v_cmp_ne_u32 vcc, 0, v10
    s_cbranch_vccnz fz_h1_r3
fz_h1_o3:
    ds_write_b32 v101, v116 offset:0
    ds_write_b32 v101, v117 offset:2048
    ds_write_b32 v101, v118 offset:4096
    ds_write_b32 v101, v119 offset:6144
    s_waitcnt lgkmcnt(0)
    s_setprio 0
fz_hb:
    s_barrier
    ds_read_b128 v[104:107], v225 offset:0
    ds_read_b128 v[108:111], v225 offset:1024
    ds_read_b128 v[112:115], v225 offset:8256
    ds_read_b128 v[116:119], v225 offset:9280
    ds_read_b128 v[72:75], v6 offset:14336
    ds_read_b128 v[76:79], v6 offset:15360
    ds_read_b128 v[80:83], v6 offset:16384
    ds_read_b128 v[84:87], v6 offset:17408
    s_waitcnt lgkmcnt(7)
    v_mfma_f32_16x16x32_f16 v[120:123], v[104:107], v[16:19], 0
    s_waitcnt lgkmcnt(6)
    v_mfma_f32_16x16x32_f16 v[124:127], v[108:111], v[16:19], 0
    s_waitcnt lgkmcnt(5)
    v_mfma_f32_16x16x32_f16 v[128:131], v[112:115], v[16:19], 0
    s_waitcnt lgkmcnt(4)
    v_mfma_f32_16x16x32_f16 v[132:135], v[116:119], v[16:19], 0
    s_waitcnt lgkmcnt(0)
    s_nop 0
    v_cvt_pk_f16_f32 v136, v120, v121
    v_cvt_pk_f16_f32 v137, v122, v123
    v_cvt_pk_f16_f32 v138, v124, v125
    v_cvt_pk_f16_f32 v139, v126, v127
    v_cvt_pk_f16_f32 v140, v128, v129
    v_cvt_pk_f16_f32 v141, v130, v131
    v_cvt_pk_f16_f32 v142, v132, v133
    v_cvt_pk_f16_f32 v143, v134, v135
    v_pk_mul_f16 v144, v136, v20
    v_pk_mul_f16 v145, v137, v21
    v_pk_mul_f16 v146, v138, v22
    v_pk_mul_f16 v147, v139, v23
    v_mov_b32_dpp v152, v136 quad_perm:[1,0,3,2] row_mask:0xf bank_mask:0xf
    v_mov_b32_dpp v153, v137 quad_perm:[1,0,3,2] row_mask:0xf bank_mask:0xf
    v_mov_b32_dpp v154, v138 quad_perm:[1,0,3,2] row_mask:0xf bank_mask:0xf
    v_mov_b32_dpp v155, v139 quad_perm:[1,0,3,2] row_mask:0xf bank_mask:0xf
    v_pk_fma_f16 v144, v152, v24, v144
    v_pk_fma_f16 v145, v153, v25, v145
    v_pk_fma_f16 v146, v154, v26, v146
    v_pk_fma_f16 v147, v155, v27, v147
    s_nop 1
    v_mfma_f32_16x16x32_f16 v[104:107], v[144:147], v[72:75], 0
    v_mfma_f32_16x16x32_f16 v[108:111], v[144:147], v[80:83], 0
    v_xor_b32_dpp v152, v144, v240 quad_perm:[1,0,3,2] row_mask:0xf bank_mask:0xf
    v_xor_b32_dpp v153, v145, v240 quad_perm:[1,0,3,2] row_mask:0xf bank_mask:0xf
    v_xor_b32_dpp v154, v146, v240 quad_perm:[1,0,3,2] row_mask:0xf bank_mask:0xf
    v_xor_b32_dpp v155, v147, v240 quad_perm:[1,0,3,2] row_mask:0xf bank_mask:0xf
    s_nop 1
    v_mfma_f32_16x16x32_f16 v[104:107], v[152:155], v[76:79], v[104:107]
    v_mfma_f32_16x16x32_f16 v[108:111], v[152:155], v[84:87], v[108:111]
    v_pk_mul_f16 v148, v140, v20
    v_pk_mul_f16 v149, v141, v21
    v_pk_mul_f16 v150, v142, v22
    v_pk_mul_f16 v151, v143, v23
    v_mov_b32_dpp v156, v140 quad_perm:[1,0,3,2] row_mask:0xf bank_mask:0xf
    v_mov_b32_dpp v157, v141 quad_perm:[1,0,3,2] row_mask:0xf bank_mask:0xf
    v_mov_b32_dpp v158, v142 quad_perm:[1,0,3,2] row_mask:0xf bank_mask:0xf
    v_mov_b32_dpp v159, v143 quad_perm:[1,0,3,2] row_mask:0xf bank_mask:0xf
    v_pk_fma_f16 v148, v156, v24, v148
    v_pk_fma_f16 v149, v157, v25, v149
    v_pk_fma_f16 v150, v158, v26, v150
    v_pk_fma_f16 v151, v159, v27, v151
    s_nop 1
    v_mfma_f32_16x16x32_f16 v[112:115], v[148:151], v[72:75], 0
    v_mfma_f32_16x16x32_f16 v[116:119], v[148:151], v[80:83], 0
    v_xor_b32_dpp v156, v148, v240 quad_perm:[1,0,3,2] row_mask:0xf bank_mask:0xf
    v_xor_b32_dpp v157, v149, v240 quad_perm:[1,0,3,2] row_mask:0xf bank_mask:0xf
    v_xor_b32_dpp v158, v150, v240 quad_perm:[1,0,3,2] row_mask:0xf bank_mask:0xf
    v_xor_b32_dpp v159, v151, v240 quad_perm:[1,0,3,2] row_mask:0xf bank_mask:0xf
    s_nop 1
    v_mfma_f32_16x16x32_f16 v[112:115], v[156:159], v[76:79], v[112:115]
    v_mfma_f32_16x16x32_f16 v[116:119], v[156:159], v[84:87], v[116:119]
    v_cvt_pk_f16_f32 v120, v104, v105
    v_cvt_pk_f16_f32 v122, v106, v107
    s_nop 4
    v_cvt_pk_f16_f32 v121, v112, v113
    v_cvt_pk_f16_f32 v123, v114, v115
    v_add_u32 v120, 0x20002, v120
    v_add_u32 v121, 0x20002, v121
    v_add_u32 v122, 0x20002, v122
    v_add_u32 v123, 0x20002, v123
    v_and_or_b32 v120, v120, v229, s44
    v_and_or_b32 v121, v121, v229, s45
    v_and_or_b32 v122, v122, v229, s46
    v_and_or_b32 v123, v123, v229, s47
    buffer_store_dwordx4 v[120:123], v226, s[4:7], s56 offen sc1
    v_cvt_pk_f16_f32 v124, v108, v109
    v_cvt_pk_f16_f32 v126, v110, v111
    v_cvt_pk_f16_f32 v125, v116, v117
    v_cvt_pk_f16_f32 v127, v118, v119
    v_add_u32 v124, 0x20002, v124
    v_add_u32 v125, 0x20002, v125
    v_add_u32 v126, 0x20002, v126
    v_add_u32 v127, 0x20002, v127
    v_and_or_b32 v124, v124, v229, s44
    v_and_or_b32 v125, v125, v229, s45
    v_and_or_b32 v126, v126, v229, s46
    v_and_or_b32 v127, v127, v229, s47
    buffer_store_dwordx4 v[124:127], v227, s[4:7], s56 offen sc1
    s_cmp_lg_u32 s57, 0
    s_cbranch_scc1 fz_nc3
    v_sub_u32 v8, 15, v4
    v_min_u32 v8, v4, v8
    v_and_b32 v9, 1, v8
    v_lshlrev_b32 v9, 5, v9
    v_lshrrev_b32 v10, 1, v8
    v_lshl_add_u32 v9, v10, 9, v9
    v_add_u32 v9, s25, v9
    v_sub_u32 v10, 2048, v9
    v_cmp_lt_u32 s[34:35], 7, v4
    s_nop 1
    v_cndmask_b32_e64 v230, v9, v10, s[34:35]
    v_mov_b32 v9, v4
    v_mov_b32 v10, s20
    s_cmp_lg_u32 s21, 0
    s_cbranch_scc0 fz_spec3a
fz_spec3backa:
    v_lshlrev_b32 v10, 7, v10
    v_lshl_add_u32 v10, v9, 3, v10
    v_mul_u32_u24 v11, 66048, v5
    v_add_u32 v228, v10, v11
    v_and_b32 v9, 1, v9
    v_cmp_eq_u32 vcc, 1, v9
    v_mov_b32 v9, s44
    v_mov_b32 v10, s46
    v_cndmask_b32_e64 v236, v9, v10, vcc
    v_mov_b32 v9, s45
    v_mov_b32 v10, s47
    v_cndmask_b32_e64 v237, v9, v10, vcc
    s_lshl_b32 s32, s3, 2
    v_add_u32 v8, s32, v5
    v_lshlrev_b32 v9, 6, v8
    v_cmp_gt_u32 vcc, 16, v8
    s_nop 1
    v_cndmask_b32_e64 v10, 0, 32, vcc
    v_add_u32 v10, v9, v10
    v_sub_u32 v11, 2048, v10
    v_cmp_eq_u32 vcc, 16, v8
    s_nop 1
    v_cndmask_b32_e64 v11, v11, 0, vcc
    v_mov_b32 v12, 0xffff0000
    v_cndmask_b32_e64 v238, -1, v12, vcc
    v_sub_u32 v12, 2018, v9
    v_mul_u32_u24 v13, 2064, v4
    v_add_u32 v231, v13, v9
    v_add_u32 v232, v13, v12
    v_add_u32 v233, v13, v10
    v_add_u32 v241, v13, v11
    s_lshl_b32 s32, s3, 8
    s_add_u32 s32, s32, 102912
    v_lshlrev_b32 v9, 4, v4
    v_add_u32 v10, s32, v9
    v_add_u32 v11, 107008, v239
    v_cmp_gt_u32 vcc, 16, v1
    s_nop 1
    v_cndmask_b32_e64 v243, v11, v10, vcc
    v_lshrrev_b32 v12, 2, v4
    v_cmp_eq_u32 vcc, v12, v5
    s_nop 1
    v_cndmask_b32_e64 v244, v11, v10, vcc
    v_lshrrev_b32 v12, 5, v1
    v_lshl_add_u32 v10, v12, 10, v9
    v_add_u32 v245, 102912, v10
    v_and_b32 v9, 1, v1
    v_cmp_eq_u32 s[28:29], 1, v9
    v_and_b32 v9, 2, v1
    v_cmp_eq_u32 s[30:31], 2, v9
    s_lshl_b32 s37, s3, 2
    v_add_u32 v9, s37, v5
    v_mul_u32_u24 v246, 2176, v9
    s_lshl_b32 s26, s20, 4
    s_add_u32 s26, s26, 0x420000
    v_lshlrev_b32 v247, 4, v5
    s_lshl_b32 s27, s20, 11
    s_lshl_b32 s37, s3, 8
    s_add_u32 s27, s27, s37
    s_add_u32 s27, s27, 0x448000
    v_sub_u32 v248, 2047, v230
    s_mov_b32 s14, 0x400000
    s_mov_b32 s15, 0x00020000
    s_mul_i32 s52, s3, 264192
    s_add_u32 s52, s52, 0x210000
    s_add_u32 s53, s52, 16512
    s_add_u32 s54, s52, 33024
    s_add_u32 s55, s52, 49536
    s_mov_b32 s23, s63
    s_getreg_b32 s24, hwreg(HW_REG_XCC_ID)
    s_and_b32 s24, s24, 15
    v_lshlrev_b32 v10, 4, v0
    v_min_u32 v10, 4336, v10
    v_add_u32 v10, 108032, v10
    v_mov_b32 v104, 0
    v_mov_b32 v105, 0
    v_mov_b32 v106, 0
    v_mov_b32 v107, 0
    ds_write_b128 v10, v[104:107]
    s_mov_b32 s58, 0
    s_waitcnt vmcnt(0)
    buffer_load_dwordx2 v[104:105], v228, s[4:7], s52 offen sc1
    buffer_load_dwordx2 v[106:107], v228, s[4:7], s53 offen sc1
    buffer_load_dwordx2 v[108:109], v228, s[4:7], s54 offen sc1
    buffer_load_dwordx2 v[110:111], v228, s[4:7], s55 offen sc1
    ds_read_b128 v[116:119], v231
    ds_read_b128 v[120:123], v231 offset:16
    ds_read_u16_d16_hi v44, v241
    ds_read_u16_d16_hi v45, v232 offset:28
    ds_read_u16_d16_hi v46, v232 offset:26
    ds_read_u16_d16_hi v47, v232 offset:24
    ds_read_u16_d16_hi v48, v232 offset:22
    ds_read_u16_d16_hi v49, v232 offset:20
    ds_read_u16_d16_hi v50, v232 offset:18
    ds_read_u16_d16_hi v51, v232 offset:16
    ds_read_u16_d16_hi v52, v232 offset:14
    ds_read_u16_d16_hi v53, v232 offset:12
    ds_read_u16_d16_hi v54, v232 offset:10
    ds_read_u16_d16_hi v55, v232 offset:8
    ds_read_u16_d16_hi v56, v232 offset:6
    ds_read_u16_d16_hi v57, v232 offset:4
    ds_read_u16_d16_hi v58, v232 offset:2
    ds_read_u16_d16_hi v59, v232 offset:0
    ds_read_u16_d16_hi v28, v233
    v_mul_u32_u24 v13, 2064, v4
    v_subrev_u32 v13, 104960, v13
    v_sub_u32 v9, v231, v13
    v_sub_u32 v10, v233, v13
    v_sub_u32 v11, v241, v13
    v_sub_u32 v12, v232, v13
    s_mov_b32 s36, 0xffff0000
    s_waitcnt lgkmcnt(0)
    ds_read_b128 v[200:203], v9
    ds_read_b128 v[204:207], v9 offset:16
    ds_read_u16_d16 v208, v11
    ds_read_u16_d16_hi v124, v12 offset:28
    ds_read_u16_d16 v209, v12 offset:26
    ds_read_u16_d16_hi v125, v12 offset:24
    ds_read_u16_d16 v210, v12 offset:22
    ds_read_u16_d16_hi v126, v12 offset:20
    ds_read_u16_d16 v211, v12 offset:18
    ds_read_u16_d16_hi v127, v12 offset:16
    ds_read_u16_d16 v212, v12 offset:14
    ds_read_u16_d16_hi v128, v12 offset:12
    ds_read_u16_d16 v213, v12 offset:10
    ds_read_u16_d16_hi v129, v12 offset:8
    ds_read_u16_d16 v214, v12 offset:6
    ds_read_u16_d16_hi v130, v12 offset:4
    ds_read_u16_d16 v215, v12 offset:2
    ds_read_u16_d16_hi v131, v12 offset:0
    ds_read_u16_d16 v13, v10
    v_and_b32 v29, s36, v116
    v_lshlrev_b32 v30, 16, v117
    v_and_b32 v31, s36, v117
    v_lshlrev_b32 v32, 16, v118
    v_and_b32 v33, s36, v118
    v_lshlrev_b32 v34, 16, v119
    v_and_b32 v35, s36, v119
    v_lshlrev_b32 v36, 16, v120
    v_and_b32 v37, s36, v120
    v_lshlrev_b32 v38, 16, v121
    v_and_b32 v39, s36, v121
    v_lshlrev_b32 v40, 16, v122
    v_and_b32 v41, s36, v122
    v_lshlrev_b32 v42, 16, v123
    v_and_b32 v43, s36, v123
    v_cmp_eq_u32 vcc, 1, v4
    v_mov_b32 v9, s42
    s_nop 0
    v_cndmask_b32_e64 v9, 0, v9, vcc
    v_mov_b32 v116, s42
    v_mov_b32 v117, s42
    v_mov_b32 v118, s42
    v_mov_b32 v119, s42
    v_cmp_eq_u32 vcc, 0, v4
    s_waitcnt lgkmcnt(0)
    v_and_or_b32 v200, v200, s36, v13
    v_or_b32 v208, v208, v124
    v_or_b32 v209, v209, v125
    v_or_b32 v210, v210, v126
    v_or_b32 v211, v211, v127
    v_or_b32 v212, v212, v128
    v_or_b32 v213, v213, v129
    v_or_b32 v214, v214, v130
    v_or_b32 v215, v215, v131
    v_cndmask_b32_e64 v200, v9, v200, vcc
    v_cndmask_b32_e64 v201, v9, v201, vcc
    v_cndmask_b32_e64 v202, v9, v202, vcc
    v_cndmask_b32_e64 v203, v9, v203, vcc
    v_cndmask_b32_e64 v204, v9, v204, vcc
    v_cndmask_b32_e64 v205, v9, v205, vcc
    v_cndmask_b32_e64 v206, v9, v206, vcc
    v_cndmask_b32_e64 v207, v9, v207, vcc
    v_cndmask_b32_e64 v208, v9, v208, vcc
    v_cndmask_b32_e64 v209, v9, v209, vcc
    v_cndmask_b32_e64 v210, v9, v210, vcc
    v_cndmask_b32_e64 v211, v9, v211, vcc
    v_cndmask_b32_e64 v212, v9, v212, vcc
    v_cndmask_b32_e64 v213, v9, v213, vcc
    v_cndmask_b32_e64 v214, v9, v214, vcc
    v_cndmask_b32_e64 v215, v9, v215, vcc
    v_mfma_f32_16x16x32_bf16 v[120:123], v[200:203], v[116:119], 0
    v_mfma_f32_16x16x32_bf16 v[120:123], v[204:207], v[116:119], v[120:123]
    v_mfma_f32_16x16x32_bf16 v[120:123], v[208:211], v[116:119], v[120:123]
    v_mfma_f32_16x16x32_bf16 v[120:123], v[212:215], v[116:119], v[120:123]
    s_nop 7
    ds_write_b32 v243, v120 offset:12
    s_branch fz_h2c
fz_h2:
    buffer_load_dwordx2 v[104:105], v228, s[4:7], s52 offen sc1
    buffer_load_dwordx2 v[106:107], v228, s[4:7], s53 offen sc1
    buffer_load_dwordx2 v[108:109], v228, s[4:7], s54 offen sc1
    buffer_load_dwordx2 v[110:111], v228, s[4:7], s55 offen sc1
fz_h2c:
    s_mov_b32 s36, 0x43000000
fz_h2_c0:
    s_waitcnt vmcnt(3)
    v_xor_b32 v104, v236, v104
    v_xor_b32 v105, v237, v105
    v_bitop3_b32 v9, v104, v105, v249 bitop3:0xa8
    v_cmp_ne_u32 vcc, 0, v9
    s_cbranch_vccnz fz_h2_r0
fz_h2_o0:
    v_fma_mix_f32 v28, v104, s36, v28 op_sel:[0,0,0] op_sel_hi:[1,0,0]
    v_fma_mix_f32 v29, v104, s36, v29 op_sel:[1,0,0] op_sel_hi:[1,0,0]
    v_fma_mix_f32 v30, v105, s36, v30 op_sel:[0,0,0] op_sel_hi:[1,0,0]
    v_fma_mix_f32 v31, v105, s36, v31 op_sel:[1,0,0] op_sel_hi:[1,0,0]
    v_mov_b32_dpp v112, v104 row_mirror row_mask:0xf bank_mask:0xf
    v_mov_b32_dpp v113, v105 row_mirror row_mask:0xf bank_mask:0xf
fz_h2_c1:
    s_waitcnt vmcnt(2)
    v_xor_b32 v106, v236, v106
    v_xor_b32 v107, v237, v107
    v_bitop3_b32 v9, v106, v107, v249 bitop3:0xa8
    v_cmp_ne_u32 vcc, 0, v9
    s_cbranch_vccnz fz_h2_r1
fz_h2_o1:
    v_fma_mix_f32 v32, v106, s36, v32 op_sel:[0,0,0] op_sel_hi:[1,0,0]
    v_fma_mix_f32 v33, v106, s36, v33 op_sel:[1,0,0] op_sel_hi:[1,0,0]
    v_fma_mix_f32 v34, v107, s36, v34 op_sel:[0,0,0] op_sel_hi:[1,0,0]
    v_fma_mix_f32 v35, v107, s36, v35 op_sel:[1,0,0] op_sel_hi:[1,0,0]
    v_mov_b32_dpp v114, v106 row_mirror row_mask:0xf bank_mask:0xf
    v_mov_b32_dpp v115, v107 row_mirror row_mask:0xf bank_mask:0xf
fz_h2_c2:
    s_waitcnt vmcnt(1)
    v_xor_b32 v108, v236, v108
    v_xor_b32 v109, v237, v109
    v_bitop3_b32 v9, v108, v109, v249 bitop3:0xa8
    v_cmp_ne_u32 vcc, 0, v9
    s_cbranch_vccnz fz_h2_r2
fz_h2_o2:
    v_fma_mix_f32 v36, v108, s36, v36 op_sel:[0,0,0] op_sel_hi:[1,0,0]
    v_fma_mix_f32 v37, v108, s36, v37 op_sel:[1,0,0] op_sel_hi:[1,0,0]
    v_fma_mix_f32 v38, v109, s36, v38 op_sel:[0,0,0] op_sel_hi:[1,0,0]
    v_fma_mix_f32 v39, v109, s36, v39 op_sel:[1,0,0] op_sel_hi:[1,0,0]
    v_mov_b32_dpp v116, v108 row_mirror row_mask:0xf bank_mask:0xf
    v_mov_b32_dpp v117, v109 row_mirror row_mask:0xf bank_mask:0xf
fz_h2_c3:
    s_waitcnt vmcnt(0)
    v_xor_b32 v110, v236, v110
    v_xor_b32 v111, v237, v111
    v_bitop3_b32 v9, v110, v111, v249 bitop3:0xa8
    v_cmp_ne_u32 vcc, 0, v9
    s_cbranch_vccnz fz_h2_r3
fz_h2_o3:
    v_fma_mix_f32 v40, v110, s36, v40 op_sel:[0,0,0] op_sel_hi:[1,0,0]
    v_fma_mix_f32 v41, v110, s36, v41 op_sel:[1,0,0] op_sel_hi:[1,0,0]
    v_fma_mix_f32 v42, v111, s36, v42 op_sel:[0,0,0] op_sel_hi:[1,0,0]
    v_fma_mix_f32 v43, v111, s36, v43 op_sel:[1,0,0] op_sel_hi:[1,0,0]
    v_mov_b32_dpp v118, v110 row_mirror row_mask:0xf bank_mask:0xf
    v_mov_b32_dpp v119, v111 row_mirror row_mask:0xf bank_mask:0xf
    s_cmp_eq_u32 s2, 66
    s_cbranch_scc1 fz_spec4
fz_spec4back:
    v_cvt_pk_bf16_f32 v120, v28, v29
    v_cvt_pk_bf16_f32 v121, v30, v31
    v_cvt_pk_bf16_f32 v122, v32, v33
    v_cvt_pk_bf16_f32 v123, v34, v35
    v_cvt_pk_bf16_f32 v124, v36, v37
    v_cvt_pk_bf16_f32 v125, v38, v39
    v_cvt_pk_bf16_f32 v126, v40, v41
    v_cvt_pk_bf16_f32 v127, v42, v43
    v_and_b32 v112, v238, v112
    v_mfma_f32_16x16x32_bf16 v[136:139], v[120:123], v[120:123], 0
    v_mfma_f32_16x16x32_bf16 v[140:143], v[200:203], v[120:123], 0
    v_mfma_f32_16x16x32_bf16 v[136:139], v[124:127], v[124:127], v[136:139]
    v_mfma_f32_16x16x32_bf16 v[140:143], v[204:207], v[124:127], v[140:143]
    v_fma_mix_f32 v44, v112, s36, v44 op_sel:[0,0,0] op_sel_hi:[1,0,0]
    v_fma_mix_f32 v45, v112, s36, v45 op_sel:[1,0,0] op_sel_hi:[1,0,0]
    v_fma_mix_f32 v46, v113, s36, v46 op_sel:[0,0,0] op_sel_hi:[1,0,0]
    v_fma_mix_f32 v47, v113, s36, v47 op_sel:[1,0,0] op_sel_hi:[1,0,0]
    v_fma_mix_f32 v48, v114, s36, v48 op_sel:[0,0,0] op_sel_hi:[1,0,0]
    v_fma_mix_f32 v49, v114, s36, v49 op_sel:[1,0,0] op_sel_hi:[1,0,0]
    v_fma_mix_f32 v50, v115, s36, v50 op_sel:[0,0,0] op_sel_hi:[1,0,0]
    v_fma_mix_f32 v51, v115, s36, v51 op_sel:[1,0,0] op_sel_hi:[1,0,0]
    v_fma_mix_f32 v52, v116, s36, v52 op_sel:[0,0,0] op_sel_hi:[1,0,0]
    v_fma_mix_f32 v53, v116, s36, v53 op_sel:[1,0,0] op_sel_hi:[1,0,0]
    v_fma_mix_f32 v54, v117, s36, v54 op_sel:[0,0,0] op_sel_hi:[1,0,0]
    v_fma_mix_f32 v55, v117, s36, v55 op_sel:[1,0,0] op_sel_hi:[1,0,0]
    v_fma_mix_f32 v56, v118, s36, v56 op_sel:[0,0,0] op_sel_hi:[1,0,0]
    v_fma_mix_f32 v57, v118, s36, v57 op_sel:[1,0,0] op_sel_hi:[1,0,0]
    v_fma_mix_f32 v58, v119, s36, v58 op_sel:[0,0,0] op_sel_hi:[1,0,0]
    v_fma_mix_f32 v59, v119, s36, v59 op_sel:[1,0,0] op_sel_hi:[1,0,0]
    v_cvt_pk_bf16_f32 v128, v44, v45
    v_cvt_pk_bf16_f32 v129, v46, v47
    v_cvt_pk_bf16_f32 v130, v48, v49
    v_cvt_pk_bf16_f32 v131, v50, v51
    v_cvt_pk_bf16_f32 v132, v52, v53
    v_cvt_pk_bf16_f32 v133, v54, v55
    v_cvt_pk_bf16_f32 v134, v56, v57
    v_cvt_pk_bf16_f32 v135, v58, v59
    v_mfma_f32_16x16x32_bf16 v[136:139], v[128:131], v[128:131], v[136:139]
    v_mfma_f32_16x16x32_bf16 v[140:143], v[208:211], v[128:131], v[140:143]
    v_mfma_f32_16x16x32_bf16 v[136:139], v[132:135], v[132:135], v[136:139]
    v_mfma_f32_16x16x32_bf16 v[140:143], v[212:215], v[132:135], v[140:143]
    s_nop 6
    v_cndmask_b32_e64 v9, v136, v137, s[28:29]
    v_cndmask_b32_e64 v10, v138, v139, s[28:29]
    ds_write_b64 v243, v[140:141]
    v_cndmask_b32_e64 v9, v9, v10, s[30:31]
    ds_write_b32 v244, v9 offset:8
    s_cmp_gt_u32 s3, 3
    s_cbranch_scc1 fz_lp
    s_setprio 2
fz_lp:
    s_waitcnt lgkmcnt(0)
    s_barrier
    ds_read_b128 v[144:147], v245 offset:0
    ds_read_b128 v[148:151], v245 offset:256
    ds_read_b128 v[152:155], v245 offset:512
    ds_read_b128 v[156:159], v245 offset:768
    s_waitcnt lgkmcnt(2)
    v_pk_add_f32 v[144:145], v[144:145], v[148:149]
    v_pk_add_f32 v[146:147], v[146:147], v[150:151]
    s_waitcnt lgkmcnt(0)
    v_pk_add_f32 v[152:153], v[152:153], v[156:157]
    v_pk_add_f32 v[154:155], v[154:155], v[158:159]
    v_pk_add_f32 v[144:145], v[144:145], v[152:153]
    v_pk_add_f32 v[146:147], v[146:147], v[154:155]
    v_mov_b32 v148, v144
    v_mov_b32 v149, v145
    v_mov_b32 v150, v146
    v_mov_b32 v151, v147
    v_permlane32_swap_b32 v144, v148
    v_permlane32_swap_b32 v145, v149
    v_permlane32_swap_b32 v146, v150
    v_permlane32_swap_b32 v147, v151
    v_pk_add_f32 v[144:145], v[144:145], v[148:149]
    v_pk_add_f32 v[146:147], v[146:147], v[150:151]
    v_mul_f32 v145, 0xba800000, v145
    v_mul_f32 v146, 0x3a800000, v146
    v_fma_f32 v146, -v145, v145, v146
    v_cvt_pk_bf16_f32 v153, 0, v145
    v_cvt_pk_bf16_f32 v146, 0, v146
    v_add_f32 v146, 0x3727c5ac, v146
    v_cvt_pk_bf16_f32 v146, 0, v146
    v_sqrt_f32 v146, v146
    v_fmac_f32 v144, v153, v147
    v_cvt_pk_bf16_f32 v146, 0, v146
    v_rcp_f32 v154, v146
    v_mov_b32 v155, s40
    v_mul_f32 v144, v144, v154
    v_cvt_pk_bf16_f32 v144, 0, v144
    v_ashrrev_i32 v145, 31, v144
    v_or_b32 v145, 0x80000000, v145
    v_bitop3_b32 v152, v144, v145, v242 bitop3:0x28
    v_or_b32 v152, v152, v248
    s_nop 1
    v_max_u32_dpp v144, v152, v152 row_ror:1 row_mask:0xf bank_mask:0xf
    s_nop 1
    v_max_u32_dpp v144, v144, v144 row_ror:2 row_mask:0xf bank_mask:0xf
    s_nop 1
    v_max_u32_dpp v144, v144, v144 row_ror:4 row_mask:0xf bank_mask:0xf
    s_nop 1
    v_max_u32_dpp v144, v144, v144 row_ror:8 row_mask:0xf bank_mask:0xf
    v_cmp_eq_u32 vcc, v144, v152
    v_or_b32 v153, s24, v153
    s_nop 0
    s_mov_b64 exec, vcc
    buffer_store_dwordx4 v[152:155], v246, s[4:7], s26 offen sc1
    s_add_u32 s26, s26, 69632
    buffer_store_dwordx4 v[152:155], v246, s[4:7], s26 offen sc1
    buffer_store_dwordx4 v[120:123], v247, s[4:7], s27 offen offset:0 sc1
    buffer_store_dwordx4 v[124:127], v247, s[4:7], s27 offen offset:64 sc1
    buffer_store_dwordx4 v[128:131], v247, s[4:7], s27 offen offset:128 sc1
    buffer_store_dwordx4 v[132:135], v247, s[4:7], s27 offen offset:192 sc1
    s_mov_b64 exec, -1
    s_setprio 0
    s_ff1_i32_b64 s37, vcc
    v_add_f32 v144, 1.0, v154
    v_and_b32 v146, v242, v153
    v_mul_f32 v146, v146, v154
    v_pk_fma_f32 v[28:29], v[28:29], v[144:145], v[146:147] op_sel_hi:[1,0,0]
    v_pk_fma_f32 v[30:31], v[30:31], v[144:145], v[146:147] op_sel_hi:[1,0,0]
    v_pk_fma_f32 v[32:33], v[32:33], v[144:145], v[146:147] op_sel_hi:[1,0,0]
    v_pk_fma_f32 v[34:35], v[34:35], v[144:145], v[146:147] op_sel_hi:[1,0,0]
    v_pk_fma_f32 v[36:37], v[36:37], v[144:145], v[146:147] op_sel_hi:[1,0,0]
    v_pk_fma_f32 v[38:39], v[38:39], v[144:145], v[146:147] op_sel_hi:[1,0,0]
    v_pk_fma_f32 v[40:41], v[40:41], v[144:145], v[146:147] op_sel_hi:[1,0,0]
    v_pk_fma_f32 v[42:43], v[42:43], v[144:145], v[146:147] op_sel_hi:[1,0,0]
    v_pk_fma_f32 v[44:45], v[44:45], v[144:145], v[146:147] op_sel_hi:[1,0,0]
    v_pk_fma_f32 v[46:47], v[46:47], v[144:145], v[146:147] op_sel_hi:[1,0,0]
    v_pk_fma_f32 v[48:49], v[48:49], v[144:145], v[146:147] op_sel_hi:[1,0,0]
    v_pk_fma_f32 v[50:51], v[50:51], v[144:145], v[146:147] op_sel_hi:[1,0,0]
    v_pk_fma_f32 v[52:53], v[52:53], v[144:145], v[146:147] op_sel_hi:[1,0,0]
    v_pk_fma_f32 v[54:55], v[54:55], v[144:145], v[146:147] op_sel_hi:[1,0,0]
    v_pk_fma_f32 v[56:57], v[56:57], v[144:145], v[146:147] op_sel_hi:[1,0,0]
    v_pk_fma_f32 v[58:59], v[58:59], v[144:145], v[146:147] op_sel_hi:[1,0,0]
    v_cvt_pk_bf16_f32 v104, v28, v29
    v_cvt_pk_bf16_f32 v105, v30, v31
    v_cvt_pk_bf16_f32 v106, v32, v33
    v_cvt_pk_bf16_f32 v107, v34, v35
    v_cvt_pk_bf16_f32 v108, v36, v37
    v_cvt_pk_bf16_f32 v109, v38, v39
    v_cvt_pk_bf16_f32 v110, v40, v41
    v_cvt_pk_bf16_f32 v111, v42, v43
    v_cvt_pk_bf16_f32 v112, v44, v45
    v_cvt_pk_bf16_f32 v113, v46, v47
    v_cvt_pk_bf16_f32 v114, v48, v49
    v_cvt_pk_bf16_f32 v115, v50, v51
    v_cvt_pk_bf16_f32 v116, v52, v53
    v_cvt_pk_bf16_f32 v117, v54, v55
    v_cvt_pk_bf16_f32 v118, v56, v57
    v_cvt_pk_bf16_f32 v119, v58, v59
    ds_write_b128 v231, v[104:107]
    ds_write_b128 v231, v[108:111] offset:16
    s_waitcnt lgkmcnt(0)
    s_barrier
    ds_write_b16 v233, v104
    ds_write_b16 v241, v112
    ds_write_b16_d16_hi v232, v112 offset:28
    ds_write_b16 v232, v113 offset:26
    ds_write_b16_d16_hi v232, v113 offset:24
    ds_write_b16 v232, v114 offset:22
    ds_write_b16_d16_hi v232, v114 offset:20
    ds_write_b16 v232, v115 offset:18
    ds_write_b16_d16_hi v232, v115 offset:16
    ds_write_b16 v232, v116 offset:14
    ds_write_b16_d16_hi v232, v116 offset:12
    ds_write_b16 v232, v117 offset:10
    ds_write_b16_d16_hi v232, v117 offset:8
    ds_write_b16 v232, v118 offset:6
    ds_write_b16_d16_hi v232, v118 offset:4
    ds_write_b16 v232, v119 offset:2
    ds_write_b16_d16_hi v232, v119 offset:0
    s_lshl_b32 s32, s3, 1
    s_add_u32 s33, s32, 1
    v_readlane_b32 s34, v230, s32
    v_readlane_b32 s35, v230, s33
    s_mul_i32 s38, s3, 4128
    v_add_u32 v9, s38, v239
    s_lshl_b32 s34, s34, 11
    s_lshl_b32 s35, s35, 11
    s_waitcnt lgkmcnt(0)
    s_barrier
    ds_read_b128 v[104:107], v9 offset:0
    ds_read_b128 v[108:111], v9 offset:1024
    ds_read_b128 v[112:115], v9 offset:2064
    ds_read_b128 v[116:119], v9 offset:3088
    s_lshr_b32 s59, s37, 1
    s_xor_b32 s18, s59, 1
    s_and_b32 s18, s18, 3
    s_cmp_lt_u32 s23, 112
    s_cselect_b32 s38, s18, 8
    s_cmp_eq_u32 s38, s3
    s_cbranch_scc1 fz_sk1
    s_waitcnt lgkmcnt(0)
    s_cmp_eq_u32 s37, s32
    s_cbranch_scc1 fz_sk0
    buffer_store_dwordx4 v[104:107], v239, s[12:15], s34 offen offset:0 sc1
    buffer_store_dwordx4 v[108:111], v239, s[12:15], s34 offen offset:1024 sc1
fz_sk0:
    s_cmp_eq_u32 s37, s33
    s_cbranch_scc1 fz_sk1
    buffer_store_dwordx4 v[112:115], v239, s[12:15], s35 offen offset:0 sc1
    buffer_store_dwordx4 v[116:119], v239, s[12:15], s35 offen offset:1024 sc1
fz_sk1:
    v_and_b32 v15, 7, v4
    v_mul_u32_u24 v15, 544, v15
    v_lshl_add_u32 v15, v5, 4, v15
    v_add_u32 v15, 108032, v15
    s_lshl_b32 s63, s23, 5
    s_and_b32 s38, s3, 3
    s_mul_i32 s38, s38, 118784
    s_add_u32 s63, s63, s38
    s_add_u32 s63, s63, 0x4c8000
    v_lshrrev_b32 v13, 1, v1
    v_mul_u32_u24 v13, 3712, v13
    v_and_b32 v14, 1, v1
    v_lshl_add_u32 v102, v14, 4, v13
    v_add_u32 v103, 59392, v102
    s_lshl_b32 s38, s20, 5
    s_add_u32 s38, s38, 0x548000
    s_cmp_lt_u32 s3, 4
    s_cselect_b32 s63, s38, s63
    v_mov_b32 v14, 0xffffff00
    s_cmp_eq_u32 s18, s3
    s_cbranch_scc1 fz_act
    s_cmp_lg_u32 s59, s3
    s_cbranch_scc1 fz_f2
    s_and_b32 s38, s20, 15
    s_add_u32 s38, s38, 16
    s_mul_i32 s38, s38, 2176
    s_add_u32 s38, s38, 0x420000
    s_lshr_b32 s52, s20, 4
    s_lshl_b32 s52, s52, 7
    s_and_b32 s53, s20, 7
    s_lshl_b32 s53, s53, 4
    s_add_u32 s52, s52, s53
    s_bfe_u32 s53, s20, 0x10003
    s_lshl_b32 s53, s53, 2
    s_add_u32 s52, s52, s53
    v_and_b32 v2, 1, v1
    v_lshl_add_u32 v2, v2, 3, v5
    v_add_u32 v2, s52, v2
    v_and_b32 v3, 31, v2
    v_lshrrev_b32 v6, 5, v2
    v_cmp_gt_u32 vcc, 16, v6
    v_cmp_lt_u32 s[52:53], 16, v3
    v_cmp_eq_u32 s[54:55], 0, v3
    s_nop 1
    s_and_b64 s[54:55], s[54:55], vcc
    s_or_b64 s[52:53], s[52:53], s[54:55]
    v_cmp_eq_u32 s[54:55], 16, v3
    s_nop 1
    s_andn2_b64 s[54:55], s[54:55], vcc
    s_or_b64 s[52:53], s[52:53], s[54:55]
    v_sub_u32 v7, 1024, v2
    v_cndmask_b32_e64 v7, v2, v7, s[52:53]
    v_mov_b32 v8, 512
    v_cmp_eq_u32 vcc, 1024, v7
    s_nop 1
    v_cndmask_b32_e64 v7, v7, v8, vcc
    v_lshrrev_b32 v8, 5, v7
    v_and_b32 v7, 15, v7
    v_lshrrev_b32 v9, 2, v8
    v_lshlrev_b32 v9, 8, v9
    v_and_b32 v8, 3, v8
    v_lshl_add_u32 v9, v8, 4, v9
    v_lshrrev_b32 v8, 3, v7
    v_lshl_add_u32 v9, v8, 6, v9
    v_and_b32 v7, 7, v7
    v_lshl_add_u32 v9, v7, 1, v9
    v_cndmask_b32_e64 v7, 0, 1, s[52:53]
    v_lshl_add_u32 v9, v7, 7, v9
    v_lshlrev_b32 v2, 1, v2
    v_lshrrev_b32 v3, 1, v1
    v_mul_u32_u24 v3, 32, v3
    v_and_b32 v6, 1, v1
    v_lshl_add_u32 v3, v6, 4, v3
    v_mov_b32 v6, 0x7fffffff
    v_cmp_gt_u32 vcc, 32, v1
    s_nop 1
    v_cndmask_b32_e64 v6, v6, v3, vcc
    v_mov_b32 v7, s48
    v_cndmask_b32_e64 v16, 0, v7, vcc
    v_mov_b32 v7, s49
    v_cndmask_b32_e64 v17, 0, v7, vcc
    v_mov_b32 v7, s50
    v_cndmask_b32_e64 v18, 0, v7, vcc
    v_mov_b32 v7, s51
    v_cndmask_b32_e64 v19, 0, v7, vcc
    s_mul_i32 s52, s20, 3712
    s_add_u32 s52, s52, 0x4c8000
    s_add_u32 s53, s52, 1024
    s_add_u32 s54, s52, 2048
    s_add_u32 s55, s52, 3072
    s_mov_b32 s58, 0
    s_nop 0
fz_k2:
    buffer_load_dwordx4 v[24:27], v239, s[4:7], s38 offen sc1
    buffer_load_dwordx4 v[28:31], v239, s[4:7], s38 offen offset:1024 sc1
    s_waitcnt vmcnt(0)
    v_xor_b32 v32, s40, v27
    v_xor_b32 v33, s40, v31
    v_max_u32 v34, v24, v28
    v_or_b32 v32, v32, v33
    v_cmp_ne_u32 vcc, 0, v32
    s_cbranch_vccnz fz_k2_rt
fz_k2_ok:
    v_max_u32_dpp v34, v34, v34 quad_perm:[1,0,3,2] row_mask:0xf bank_mask:0xf
    s_nop 1
    v_max_u32_dpp v34, v34, v34 quad_perm:[2,3,0,1] row_mask:0xf bank_mask:0xf
    s_nop 1
    v_max_u32_dpp v34, v34, v34 row_half_mirror row_mask:0xf bank_mask:0xf
    s_nop 1
    v_max_u32_dpp v34, v34, v34 row_mirror row_mask:0xf bank_mask:0xf
    s_nop 1
    v_max_u32_dpp v34, v34, v34 row_bcast:15 row_mask:0xa bank_mask:0xf
    s_nop 1
    v_max_u32_dpp v34, v34, v34 row_bcast:31 row_mask:0xc bank_mask:0xf
    s_nop 0
    v_readlane_b32 s36, v34, 63
    s_nop 1
    v_cmp_eq_u32 vcc, s36, v24
    v_cmp_eq_u32 s[56:57], s36, v28
    s_nop 1
    v_cndmask_b32_e64 v25, v25, v29, s[56:57]
    v_cndmask_b32_e64 v26, v26, v30, s[56:57]
    s_cmp_lg_u64 vcc, 0
    s_cselect_b32 s39, 0, 64
    s_or_b64 vcc, vcc, s[56:57]
    s_ff1_i32_b64 s41, vcc
    v_readlane_b32 s42, v25, s41
    v_readlane_b32 s43, v26, s41
    s_add_u32 s39, s39, s41
    s_and_b32 s42, s42, 0xffff0000
    s_cmp_eq_u32 s39, s20
    s_cbranch_scc1 fz_win
    s_bitcmp1_b32 s37, 0
    s_cbranch_scc1 fz_d1
    buffer_store_dwordx4 v[104:107], v239, s[12:15], s34 offen offset:0 sc1
    buffer_store_dwordx4 v[108:111], v239, s[12:15], s34 offen offset:1024 sc1
    s_branch fz_win
fz_d1:
    buffer_store_dwordx4 v[112:115], v239, s[12:15], s35 offen offset:0 sc1
    buffer_store_dwordx4 v[116:119], v239, s[12:15], s35 offen offset:1024 sc1
fz_win:
    s_lshl_b32 s39, s39, 11
    s_add_u32 s39, s39, 0x448000
    s_mov_b32 s58, 0
    s_mov_b32 s41, 0xffff0000
    s_nop 0
fz_c2:
    buffer_load_short_d16_hi v10, v9, s[4:7], s39 offen sc1
    s_waitcnt vmcnt(0)
    v_cmp_eq_u32 vcc, s41, v10
    s_cbranch_vccnz fz_c2_rt
fz_c2_ok:
    v_add_f32 v11, s42, v10
    v_cvt_pk_bf16_f32 v11, 0, v11
    v_mul_f32 v11, s43, v11
    v_cvt_pk_bf16_f32 v11, 0, v11
    s_ashr_i32 s39, s36, 31
    s_not_b32 s39, s39
    s_or_b32 s39, s39, 0x80000000
    s_xor_b32 s39, s36, s39
    s_and_b32 s39, s39, 0xffff0000
    v_mov_b32 v12, s39
    v_mul_f32 v12, 0xbfb8aa3b, v12
    v_exp_f32 v12, v12
    s_nop 0
    v_add_f32 v12, 1.0, v12
    v_rcp_f32 v12, v12
    s_nop 0
    v_cvt_pk_bf16_f32 v12, 0, v12
    s_and_b32 s39, s36, 0xffff
    s_sub_u32 s39, 2047, s39
    s_lshl_b32 s39, s39, 11
    v_mov_b32 v13, 0xff
    s_waitcnt lgkmcnt(0)
fz_f2:
    s_cmp_gt_u32 s23, 111
    s_cbranch_scc1 fz_nof2
    s_barrier
    s_cmp_eq_u32 s59, s3
    s_cselect_b32 s19, 4, s3
    s_cmp_lt_u32 s19, 4
    s_cbranch_scc1 fz_f2d
    ds_read_b128 v[120:123], v15 offset:0
    ds_read_b128 v[124:127], v15 offset:64
    ds_read_b128 v[128:131], v15 offset:128
    ds_read_b128 v[132:135], v15 offset:192
    ds_read_b128 v[136:139], v15 offset:256
    ds_read_b128 v[140:143], v15 offset:320
    ds_read_b128 v[144:147], v15 offset:384
    ds_read_b128 v[148:151], v15 offset:448
    s_waitcnt lgkmcnt(7)
    v_mfma_f32_16x16x32_bf16 v[152:155], v[120:123], v[160:163], 0
    v_mfma_f32_16x16x32_bf16 v[156:159], v[120:123], v[164:167], 0
    s_waitcnt lgkmcnt(6)
    v_mfma_f32_16x16x32_bf16 v[152:155], v[124:127], v[168:171], v[152:155]
    v_mfma_f32_16x16x32_bf16 v[156:159], v[124:127], v[172:175], v[156:159]
    s_waitcnt lgkmcnt(5)
    v_mfma_f32_16x16x32_bf16 v[152:155], v[128:131], v[176:179], v[152:155]
    v_mfma_f32_16x16x32_bf16 v[156:159], v[128:131], v[180:183], v[156:159]
    s_waitcnt lgkmcnt(4)
    v_mfma_f32_16x16x32_bf16 v[152:155], v[132:135], v[184:187], v[152:155]
    v_mfma_f32_16x16x32_bf16 v[156:159], v[132:135], v[188:191], v[156:159]
    s_waitcnt lgkmcnt(3)
    v_mfma_f32_16x16x32_bf16 v[152:155], v[136:139], v[192:195], v[152:155]
    v_mfma_f32_16x16x32_bf16 v[156:159], v[136:139], v[196:199], v[156:159]
    s_waitcnt lgkmcnt(2)
    v_mfma_f32_16x16x32_bf16 v[152:155], v[140:143], v[60:63], v[152:155]
    v_mfma_f32_16x16x32_bf16 v[156:159], v[140:143], v[64:67], v[156:159]
    s_waitcnt lgkmcnt(1)
    v_mfma_f32_16x16x32_bf16 v[152:155], v[144:147], v[68:71], v[152:155]
    v_mfma_f32_16x16x32_bf16 v[156:159], v[144:147], v[88:91], v[156:159]
    s_waitcnt lgkmcnt(0)
    v_mfma_f32_16x16x32_bf16 v[152:155], v[148:151], v[92:95], v[152:155]
    v_mfma_f32_16x16x32_bf16 v[156:159], v[148:151], v[96:99], v[156:159]
    s_mov_b32 exec_hi, 0
    s_nop 5
    v_and_or_b32 v152, v152, v14, s48
    v_and_or_b32 v153, v153, v14, s49
    v_and_or_b32 v154, v154, v14, s50
    v_and_or_b32 v155, v155, v14, s51
    buffer_store_dwordx4 v[152:155], v102, s[4:7], s63 offen sc1
    v_and_or_b32 v156, v156, v14, s48
    v_and_or_b32 v157, v157, v14, s49
    v_and_or_b32 v158, v158, v14, s50
    v_and_or_b32 v159, v159, v14, s51
    buffer_store_dwordx4 v[156:159], v103, s[4:7], s63 offen sc1
fz_f2d:
    s_mov_b32 exec_hi, -1
    s_cmp_eq_u32 s18, s3
    s_cbranch_scc1 fz_late
    s_cmp_lg_u32 s59, s3
    s_cbranch_scc1 fz_xend
    v_mov_b32 v7, 0
    s_waitcnt vmcnt(0)
    s_branch fz_p5_ok
    s_nop 2
fz_nof2:
    s_cmp_lg_u32 s59, s3
    s_cbranch_scc1 fz_xend
    s_mov_b32 s58, 0
    s_and_b32 s41, s20, 63
    s_mul_i32 s41, s41, 32
    s_add_u32 s41, s41, s52
    v_mov_b32 v7, 0
    s_nop 4
fz_p5:
    buffer_load_dword v8, v7, s[4:7], s41 offen sc1
    s_waitcnt vmcnt(0)
    v_and_b32 v8, 0xff, v8
    v_cmp_ne_u32 vcc, s48, v8
    s_cbranch_vccnz fz_p5_rt
fz_p5_ok:
    s_mov_b32 s58, 0
    buffer_load_dwordx4 v[40:43], v3, s[4:7], s52 offen sc1
    buffer_load_dwordx4 v[44:47], v3, s[4:7], s53 offen sc1
    buffer_load_dwordx4 v[48:51], v3, s[4:7], s54 offen sc1
    buffer_load_dwordx4 v[52:55], v6, s[4:7], s55 offen sc1
fz_h5_c0:
    s_waitcnt vmcnt(3)
    v_xor_b32 v40, s48, v40
    v_xor_b32 v41, s49, v41
    v_xor_b32 v42, s50, v42
    v_xor_b32 v43, s51, v43
    v_or3_b32 v8, v40, v41, v42
    v_bitop3_b32 v8, v8, v43, v13 bitop3:0xa8
    v_cmp_ne_u32 vcc, 0, v8
    s_cbranch_vccnz fz_h5_r0
fz_h5_o0:
fz_h5_c1:
    s_waitcnt vmcnt(2)
    v_xor_b32 v44, s48, v44
    v_xor_b32 v45, s49, v45
    v_xor_b32 v46, s50, v46
    v_xor_b32 v47, s51, v47
    v_or3_b32 v8, v44, v45, v46
    v_bitop3_b32 v8, v8, v47, v13 bitop3:0xa8
    v_cmp_ne_u32 vcc, 0, v8
    s_cbranch_vccnz fz_h5_r1
fz_h5_o1:
    v_pk_add_f32 v[40:41], v[40:41], v[44:45]
    v_pk_add_f32 v[42:43], v[42:43], v[46:47]
fz_h5_c2:
    s_waitcnt vmcnt(1)
    v_xor_b32 v48, s48, v48
    v_xor_b32 v49, s49, v49
    v_xor_b32 v50, s50, v50
    v_xor_b32 v51, s51, v51
    v_or3_b32 v8, v48, v49, v50
    v_bitop3_b32 v8, v8, v51, v13 bitop3:0xa8
    v_cmp_ne_u32 vcc, 0, v8
    s_cbranch_vccnz fz_h5_r2
fz_h5_o2:
    v_pk_add_f32 v[40:41], v[40:41], v[48:49]
    v_pk_add_f32 v[42:43], v[42:43], v[50:51]
fz_h5_c3:
    s_waitcnt vmcnt(0)
    v_xor_b32 v52, v16, v52
    v_xor_b32 v53, v17, v53
    v_xor_b32 v54, v18, v54
    v_xor_b32 v55, v19, v55
    v_or3_b32 v8, v52, v53, v54
    v_bitop3_b32 v8, v8, v55, v13 bitop3:0xa8
    v_cmp_ne_u32 vcc, 0, v8
    s_cbranch_vccnz fz_h5_r3
fz_h5_o3:
    v_pk_add_f32 v[40:41], v[40:41], v[52:53]
    v_pk_add_f32 v[42:43], v[42:43], v[54:55]
    s_nop 1
    v_permlane32_swap_b32 v40, v42
    v_permlane32_swap_b32 v41, v43
    v_pk_add_f32 v[40:41], v[40:41], v[42:43]
    s_nop 1
    v_permlane16_swap_b32 v40, v41
    v_add_f32 v40, v40, v41
    s_nop 1
    v_add_f32_dpp v40, v40, v40 quad_perm:[2,3,0,1] row_mask:0xf bank_mask:0xf
    s_nop 1
    v_add_f32_dpp v40, v40, v40 row_ror:4 row_mask:0xf bank_mask:0xf
    s_nop 1
    v_add_f32_dpp v40, v40, v40 row_ror:8 row_mask:0xf bank_mask:0xf
    v_cvt_pk_bf16_f32 v40, 0, v40
    v_mul_f32 v40, v40, v12
    v_cvt_pk_bf16_f32 v40, 0, v40
    v_add_f32 v40, v40, v11
    v_cvt_pk_bf16_f32 v40, 0, v40
    v_add_f32 v40, v40, v10
    v_cvt_pk_bf16_f32 v40, 0, v40
    s_mov_b32 exec_lo, 0x00030003
    s_mov_b32 exec_hi, 0x00030003
    buffer_store_short_d16_hi v40, v2, s[12:15], s39 offen
    s_cmp_lg_u32 s20, 0
    s_cbranch_scc1 fz_xend
    s_mov_b64 exec, 1
    v_mov_b32 v8, s40
    buffer_store_dword v8, v7, s[4:7], 0 offen
fz_xend:
fz_end:
    s_endpgm
fz_late:
    buffer_store_dwordx4 v[104:107], v239, s[12:15], s34 offen offset:0 sc1
    buffer_store_dwordx4 v[108:111], v239, s[12:15], s34 offen offset:1024 sc1
    buffer_store_dwordx4 v[112:115], v239, s[12:15], s35 offen offset:0 sc1
    buffer_store_dwordx4 v[116:119], v239, s[12:15], s35 offen offset:1024 sc1
    s_branch fz_xend
fz_act:
    s_cmp_gt_u32 s23, 111
    s_cbranch_scc1 fz_xend
    v_lshlrev_b32 v2, 2, v1
    v_and_b32 v11, 3, v1
    v_mov_b32 v3, s48
    v_cmp_eq_u32 vcc, 1, v11
    v_mov_b32 v10, s49
    s_nop 0
    v_cndmask_b32_e64 v3, v3, v10, vcc
    v_cmp_eq_u32 vcc, 2, v11
    v_mov_b32 v10, s50
    s_nop 0
    v_cndmask_b32_e64 v3, v3, v10, vcc
    v_cmp_eq_u32 vcc, 3, v11
    v_mov_b32 v10, s51
    s_nop 0
    v_cndmask_b32_e64 v3, v3, v10, vcc
    v_and_b32 v10, 31, v1
    v_lshlrev_b32 v6, 4, v10
    v_lshrrev_b32 v10, 5, v1
    v_mul_u32_u24 v10, 2184, v10
    v_add_u32 v6, v6, v10
    v_add_u32 v6, 108032, v6
    s_lshl_b32 s38, s23, 11
    s_add_u32 s38, s38, 0x488000
    s_mov_b32 s58, 0
fz_h4:
    buffer_load_dword v16, v2, s[4:7], s38 offen offset:0 sc1
    buffer_load_dword v17, v2, s[4:7], s38 offen offset:256 sc1
    buffer_load_dword v18, v2, s[4:7], s38 offen offset:512 sc1
    buffer_load_dword v19, v2, s[4:7], s38 offen offset:768 sc1
    buffer_load_dword v20, v2, s[4:7], s38 offen offset:1024 sc1
    buffer_load_dword v21, v2, s[4:7], s38 offen offset:1280 sc1
    buffer_load_dword v22, v2, s[4:7], s38 offen offset:1536 sc1
    buffer_load_dword v23, v2, s[4:7], s38 offen offset:1792 sc1
    s_waitcnt vmcnt(6)
    v_xor_b32 v16, v3, v16
    v_xor_b32 v17, v3, v17
    v_or3_b32 v10, v16, v17, 0
    v_add_f32 v16, v16, v17
    s_waitcnt vmcnt(4)
    v_xor_b32 v18, v3, v18
    v_xor_b32 v19, v3, v19
    v_or3_b32 v10, v18, v19, v10
    v_add_f32 v18, v18, v19
    v_add_f32 v16, v16, v18
    s_waitcnt vmcnt(2)
    v_xor_b32 v20, v3, v20
    v_xor_b32 v21, v3, v21
    v_or3_b32 v10, v20, v21, v10
    v_add_f32 v20, v20, v21
    s_waitcnt vmcnt(0)
    v_xor_b32 v22, v3, v22
    v_xor_b32 v23, v3, v23
    v_or3_b32 v10, v22, v23, v10
    v_add_f32 v22, v22, v23
    v_add_f32 v20, v20, v22
    v_and_b32 v10, 0xff, v10
    v_add_f32 v8, v16, v20
    v_cmp_ne_u32 vcc, 0, v10
    s_cbranch_vccnz fz_h4_rt
fz_h4_ok:
    v_cvt_pk_bf16_f32 v8, 0, v8
    v_mov_b32 v9, v8
    s_nop 1
    v_permlane32_swap_b32 v8, v9
    v_mul_f32 v10, 0xbfb8aa3b, v8
    v_exp_f32 v10, v10
    s_nop 0
    v_add_f32 v10, 1.0, v10
    v_rcp_f32 v10, v10
    s_nop 0
    v_mul_f32 v8, v8, v10
    v_cvt_pk_bf16_f32 v8, 0, v8
    v_mul_f32 v8, v8, v9
    v_cvt_pk_bf16_f32 v8, 0, v8
    ds_write_b16_d16_hi v6, v8 offset:0
    ds_write_b16_d16_hi v6, v8 offset:546
    ds_write_b16_d16_hi v6, v8 offset:1092
    ds_write_b16_d16_hi v6, v8 offset:1638
    s_waitcnt lgkmcnt(0)
    s_branch fz_f2
fz_ldh:
    s_load_dwordx2 s[12:13], s[0:1], 56
    s_load_dwordx2 s[16:17], s[0:1], 64
    s_mov_b32 s14, 0x700000
    s_mov_b32 s15, 0x00020000
    s_mov_b32 s18, 0x700000
    s_mov_b32 s19, 0x00020000
    s_branch fz_ldback
fz_spec:
    s_cmp_gt_u32 s3, 3
    s_cbranch_scc1 fz_spec_hi
    s_cmp_eq_u32 s3, 0
    s_cselect_b32 s31, 0, s31
    s_cselect_b32 s30, 33024, s30
    s_cmp_eq_u32 s3, 2
    s_cselect_b32 s31, 30960, s31
    s_cselect_b32 s30, 35088, s30
    s_cmp_eq_u32 s3, 3
    s_cselect_b32 s31, 37152, s31
    s_cselect_b32 s30, 39216, s30
    s_branch fz_specback
fz_spec_hi:
    s_mov_b32 m0, s31
    s_nop 0
    buffer_load_dwordx4 v239, s[8:11], s27 offen lds
    buffer_load_dwordx4 v239, s[8:11], s27 offen offset:1024 lds
    s_mov_b32 m0, s30
    s_nop 0
    buffer_load_dwordx4 v239, s[8:11], s28 offen lds
    buffer_load_dwordx4 v239, s[8:11], s28 offen offset:1024 lds
    v_lshlrev_b32 v13, 3, v0
    v_mov_b32 v10, -1
    v_mov_b32 v11, -1
    s_lshl_b32 s32, s20, 11
    s_add_u32 s32, s32, 0x447800
    s_mov_b32 s18, 0x800
    s_mov_b32 s19, 0x00020000
    s_lshl_b32 s33, s24, 10
    s_min_u32 s34, s33, 2048
    s_add_u32 s34, s34, 104960
    s_mov_b32 m0, s34
    buffer_store_dwordx2 v[10:11], v13, s[4:7], s32 offen sc1
    buffer_load_dwordx4 v239, s[16:19], s33 offen lds
    s_cmp_eq_u32 s24, 0
    s_cselect_b32 s31, 8256, s31
    s_cselect_b32 s30, 22704, s30
    s_cselect_b32 s27, 524288, s27
    s_cselect_b32 s28, 3670016, s28
    s_cmp_eq_u32 s24, 1
    s_cselect_b32 s31, 12384, s31
    s_cselect_b32 s30, 18576, s30
    s_cselect_b32 s27, 1572864, s27
    s_cselect_b32 s28, 2621440, s28
    s_cmp_eq_u32 s24, 2
    s_cselect_b32 s31, 41280, s31
    s_cselect_b32 s30, 43344, s30
    s_cselect_b32 s27, 1572864, s27
    s_cselect_b32 s28, 2621440, s28
    s_cmp_eq_u32 s24, 3
    s_cselect_b32 s31, 45408, s31
    s_cselect_b32 s30, 47472, s30
    s_cselect_b32 s27, 524288, s27
    s_cselect_b32 s28, 3670016, s28
    s_mov_b32 s57, 0
    s_branch fz_specback
fz_jb:
    v_cvt_pk_bf16_f32 v128, v104, v105
    v_cvt_pk_bf16_f32 v129, v106, v107
    v_cvt_pk_bf16_f32 v130, v108, v109
    v_cvt_pk_bf16_f32 v131, v110, v111
    v_cvt_pk_bf16_f32 v132, v112, v113
    v_cvt_pk_bf16_f32 v133, v114, v115
    v_cvt_pk_bf16_f32 v134, v116, v117
    v_cvt_pk_bf16_f32 v135, v118, v119
    s_branch fz_jend
fz_bsp0:
    buffer_load_dwordx4 v[160:163], v14, s[64:67], s62 offen offset:0 nt
    buffer_load_dwordx4 v[164:167], v14, s[64:67], s62 offen offset:256 nt
    s_add_u32 s62, s62, 8192
    buffer_load_dwordx4 v[168:171], v14, s[64:67], s62 offen offset:0 nt
    buffer_load_dwordx4 v[172:175], v14, s[64:67], s62 offen offset:256 nt
    s_add_u32 s62, s62, 8192
    buffer_load_dwordx4 v[176:179], v14, s[64:67], s62 offen offset:0 nt
    buffer_load_dwordx4 v[180:183], v14, s[64:67], s62 offen offset:256 nt
    s_add_u32 s62, s62, 8192
    buffer_load_dwordx4 v[184:187], v14, s[64:67], s62 offen offset:0 nt
    buffer_load_dwordx4 v[188:191], v14, s[64:67], s62 offen offset:256 nt
    s_add_u32 s62, s62, 8192
    buffer_load_dwordx4 v[192:195], v14, s[64:67], s62 offen offset:0 nt
    buffer_load_dwordx4 v[196:199], v14, s[64:67], s62 offen offset:256 nt
    s_add_u32 s62, s62, 8192
    buffer_load_dwordx4 v[60:63], v14, s[64:67], s62 offen offset:0 nt
    buffer_load_dwordx4 v[64:67], v14, s[64:67], s62 offen offset:256 nt
    s_add_u32 s62, s62, 8192
    buffer_load_dwordx4 v[68:71], v14, s[64:67], s62 offen offset:0 nt
    buffer_load_dwordx4 v[88:91], v14, s[64:67], s62 offen offset:256 nt
    s_add_u32 s62, s62, 8192
    buffer_load_dwordx4 v[92:95], v14, s[64:67], s62 offen offset:0 nt
    buffer_load_dwordx4 v[96:99], v14, s[64:67], s62 offen offset:256 nt
    s_branch fz_bsp
fz_spec4:
    s_mov_b32 s38, 0x80018001
    s_mov_b32 s39, 0x80018001
    v_cndmask_b32_e64 v112, v112, v104, s[38:39]
    v_cndmask_b32_e64 v113, v113, v105, s[38:39]
    v_cndmask_b32_e64 v114, v114, v106, s[38:39]
    v_cndmask_b32_e64 v115, v115, v107, s[38:39]
    v_cndmask_b32_e64 v116, v116, v108, s[38:39]
    v_cndmask_b32_e64 v117, v117, v109, s[38:39]
    v_cndmask_b32_e64 v118, v118, v110, s[38:39]
    v_cndmask_b32_e64 v119, v119, v111, s[38:39]
    s_branch fz_spec4back
    s_nop 3
fz_nc1:
    s_setprio 0
    s_cmp_lg_u32 s59, 0
    s_cbranch_scc1 ffn_b
    buffer_load_dwordx4 v[176:179], v14, s[64:67], s62 offen offset:0 nt
    buffer_load_dwordx4 v[180:183], v14, s[64:67], s62 offen offset:256 nt
    s_add_u32 s62, s62, 8192
    buffer_load_dwordx4 v[184:187], v14, s[64:67], s62 offen offset:0 nt
    buffer_load_dwordx4 v[188:191], v14, s[64:67], s62 offen offset:256 nt
    s_add_u32 s62, s62, 8192
    buffer_load_dwordx4 v[192:195], v14, s[64:67], s62 offen offset:0 nt
    buffer_load_dwordx4 v[196:199], v14, s[64:67], s62 offen offset:256 nt
    s_add_u32 s62, s62, 8192
    buffer_load_dwordx4 v[60:63], v14, s[64:67], s62 offen offset:0 nt
    buffer_load_dwordx4 v[64:67], v14, s[64:67], s62 offen offset:256 nt
    s_add_u32 s62, s62, 8192
    buffer_load_dwordx4 v[68:71], v14, s[64:67], s62 offen offset:0 nt
    buffer_load_dwordx4 v[88:91], v14, s[64:67], s62 offen offset:256 nt
    s_add_u32 s62, s62, 8192
    buffer_load_dwordx4 v[92:95], v14, s[64:67], s62 offen offset:0 nt
    buffer_load_dwordx4 v[96:99], v14, s[64:67], s62 offen offset:256 nt
    s_mov_b32 m0, s31
    s_nop 0
    buffer_load_dwordx4 v239, s[8:11], s27 offen lds
    buffer_load_dwordx4 v239, s[8:11], s27 offen offset:1024 lds
    s_mov_b32 m0, s30
    s_nop 0
    buffer_load_dwordx4 v239, s[8:11], s28 offen lds
    buffer_load_dwordx4 v239, s[8:11], s28 offen offset:1024 lds
    v_lshlrev_b32 v13, 3, v0
    v_mov_b32 v10, -1
    v_mov_b32 v11, -1
    s_lshl_b32 s32, s20, 11
    s_add_u32 s32, s32, 0x447800
    s_mov_b32 s18, 0x800
    s_mov_b32 s19, 0x00020000
    s_lshl_b32 s33, s24, 10
    s_min_u32 s34, s33, 2048
    s_add_u32 s34, s34, 104960
    s_mov_b32 m0, s34
    buffer_store_dwordx2 v[10:11], v13, s[4:7], s32 offen sc1
    buffer_load_dwordx4 v239, s[16:19], s33 offen lds
    s_waitcnt vmcnt(22)
    v_readfirstlane_b32 s40, v250
    s_nop 1
    s_add_u32 s40, s40, 1
    s_and_b32 s38, s40, 3
    s_and_b32 s39, s40, 15
    s_bfe_u32 s41, s40, 0x20002
    s_lshl_b32 s41, s41, 16
    s_or_b32 s44, s38, s41
    s_bfe_u32 s41, s40, 0x40004
    s_lshl_b32 s41, s41, 4
    s_or_b32 s48, s39, s41
    s_bfe_u32 s41, s40, 0x20004
    s_lshl_b32 s41, s41, 16
    s_or_b32 s45, s38, s41
    s_bfe_u32 s41, s40, 0x40008
    s_lshl_b32 s41, s41, 4
    s_or_b32 s49, s39, s41
    s_bfe_u32 s41, s40, 0x20006
    s_lshl_b32 s41, s41, 16
    s_or_b32 s46, s38, s41
    s_bfe_u32 s41, s40, 0x4000c
    s_lshl_b32 s41, s41, 4
    s_or_b32 s50, s39, s41
    s_bfe_u32 s41, s40, 0x20008
    s_lshl_b32 s41, s41, 16
    s_or_b32 s47, s38, s41
    s_bfe_u32 s41, s40, 0x40010
    s_lshl_b32 s41, s41, 4
    s_or_b32 s51, s39, s41
    s_mov_b32 s38, 0x404
    s_cmp_eq_u32 s2, 66
    s_cselect_b32 s39, 8, 4
    s_cselect_b32 s38, 8, s38
fz_bsp:
    s_setprio 0
    s_mov_b32 s57, 1
    s_cmp_gt_u32 s3, 5
    s_cbranch_scc1 fz_nocq
    s_and_b32 s32, s3, 1
    s_lshl_b32 s33, s32, 2
    s_lshl_b32 s32, s32, 11
    v_and_b32 v8, 3, v4
    v_lshrrev_b32 v9, 2, v4
    v_lshl_add_u32 v8, v8, 3, v9
    v_add_u32 v8, s33, v8
    v_cvt_f32_u32 v8, v8
    v_mul_f32 v8, 0x3d000000, v8
    v_cvt_f32_u32 v9, v5
    v_mul_f32 v9, 4.0, v9
    v_mul_f32 v9, v8, v9
    v_mov_b32 v104, v9
    v_fmamk_f32 v105, v8, 0x3f800000, v9
    v_fmamk_f32 v106, v8, 0x40000000, v9
    v_fmamk_f32 v107, v8, 0x40400000, v9
    v_fmamk_f32 v108, v8, 0x41800000, v9
    v_fmamk_f32 v109, v8, 0x41880000, v9
    v_fmamk_f32 v110, v8, 0x41900000, v9
    v_fmamk_f32 v111, v8, 0x41980000, v9
    v_sin_f32 v112, v104
    v_sin_f32 v113, v105
    v_sin_f32 v114, v106
    v_sin_f32 v115, v107
    v_sin_f32 v116, v108
    v_sin_f32 v117, v109
    v_sin_f32 v118, v110
    v_sin_f32 v119, v111
    v_cos_f32 v104, v104
    v_cos_f32 v105, v105
    v_cos_f32 v106, v106
    v_cos_f32 v107, v107
    v_cos_f32 v108, v108
    v_cos_f32 v109, v109
    v_cos_f32 v110, v110
    v_cos_f32 v111, v111
    v_mul_f32 v104, 0x3d800000, v104
    v_mul_f32 v105, 0x3d800000, v105
    v_mul_f32 v106, 0x3d800000, v106
    v_mul_f32 v107, 0x3d800000, v107
    v_mul_f32 v108, 0x3d800000, v108
    v_mul_f32 v109, 0x3d800000, v109
    v_mul_f32 v110, 0x3d800000, v110
    v_mul_f32 v111, 0x3d800000, v111
    v_mul_f32 v112, 0x3d800000, v112
    v_mul_f32 v113, 0x3d800000, v113
    v_mul_f32 v114, 0x3d800000, v114
    v_mul_f32 v115, 0x3d800000, v115
    v_mul_f32 v116, 0x3d800000, v116
    v_mul_f32 v117, 0x3d800000, v117
    v_mul_f32 v118, 0x3d800000, v118
    v_mul_f32 v119, 0x3d800000, v119
    v_cvt_pk_f16_f32 v128, v104, v105
    v_cvt_pk_f16_f32 v129, v106, v107
    v_cvt_pk_f16_f32 v130, v108, v109
    v_cvt_pk_f16_f32 v131, v110, v111
    v_cvt_pk_f16_f32 v132, v112, v113
    v_cvt_pk_f16_f32 v133, v114, v115
    v_cvt_pk_f16_f32 v134, v116, v117
    v_cvt_pk_f16_f32 v135, v118, v119
    v_add_u32 v8, s32, v6
    ds_write_b128 v8, v[128:131] offset:14336
    ds_write_b128 v8, v[132:135] offset:15360
fz_nocq:
    s_and_b32 s32, s3, 3
    s_lshr_b32 s33, s3, 2
    s_lshl_b32 s33, s33, 4
    s_add_u32 s33, s33, s32
    v_and_b32 v8, 12, v4
    v_bfe_u32 v9, v4, 1, 1
    v_lshl_add_u32 v8, v9, 5, v8
    v_add_u32 v8, s33, v8
    v_cvt_f32_u32 v8, v8
    v_and_b32 v12, 1, v1
    v_cvt_f32_u32 v9, v12
    v_lshlrev_b32 v13, 2, v5
    v_cvt_f32_u32 v10, v13
    v_mul_f32 v11, 0x3c800000, v8
    v_mul_f32 v9, 0x3e800000, v9
    v_fma_f32 v9, v11, v10, v9
    v_mov_b32 v128, v9
    v_fmamk_f32 v129, v11, 0x3f800000, v9
    v_fmamk_f32 v130, v11, 0x40000000, v9
    v_fmamk_f32 v131, v11, 0x40400000, v9
    v_mul_f32 v11, 0x3a000000, v8
    v_lshlrev_b32 v9, 31, v1
    v_xor_b32 v11, v9, v11
    v_mul_f32 v9, v11, v10
    v_mov_b32 v112, v9
    v_fmamk_f32 v113, v11, 0x3f800000, v9
    v_fmamk_f32 v114, v11, 0x40000000, v9
    v_fmamk_f32 v115, v11, 0x40400000, v9
    v_fmamk_f32 v116, v11, 0x41800000, v9
    v_fmamk_f32 v117, v11, 0x41880000, v9
    v_fmamk_f32 v118, v11, 0x41900000, v9
    v_fmamk_f32 v119, v11, 0x41980000, v9
    v_cos_f32 v104, v128
    v_sin_f32 v105, v128
    v_cos_f32 v106, v129
    v_sin_f32 v107, v129
    v_cos_f32 v108, v130
    v_sin_f32 v109, v130
    v_cos_f32 v110, v131
    v_sin_f32 v111, v131
    v_sin_f32 v120, v112
    v_sin_f32 v121, v113
    v_sin_f32 v122, v114
    v_sin_f32 v123, v115
    v_sin_f32 v124, v116
    v_sin_f32 v125, v117
    v_sin_f32 v126, v118
    v_sin_f32 v127, v119
    v_cos_f32 v112, v112
    v_cos_f32 v113, v113
    v_cos_f32 v114, v114
    v_cos_f32 v115, v115
    v_cos_f32 v116, v116
    v_cos_f32 v117, v117
    v_cos_f32 v118, v118
    v_cos_f32 v119, v119
    v_cvt_pk_f16_f32 v16, v104, v105
    v_cvt_pk_f16_f32 v17, v106, v107
    v_cvt_pk_f16_f32 v18, v108, v109
    v_cvt_pk_f16_f32 v19, v110, v111
    v_cvt_pk_f16_f32 v20, v112, v113
    v_cvt_pk_f16_f32 v21, v114, v115
    v_cvt_pk_f16_f32 v22, v116, v117
    v_cvt_pk_f16_f32 v23, v118, v119
    v_cvt_pk_f16_f32 v24, v120, v121
    v_cvt_pk_f16_f32 v25, v122, v123
    v_cvt_pk_f16_f32 v26, v124, v125
    v_cvt_pk_f16_f32 v27, v126, v127
    v_lshrrev_b32 v8, 3, v1
    v_mul_u32_u24 v222, 16512, v8
    v_and_b32 v9, 7, v1
    v_lshl_add_u32 v222, v9, 4, v222
    s_mul_i32 s60, s3, 528384
    s_lshl_b32 s32, s20, 7
    s_add_u32 s60, s60, s32
    s_add_u32 s60, s60, 0x1000
    s_add_u32 s61, s60, 132096
    s_add_u32 s16, s60, 264192
    s_add_u32 s17, s60, 396288
    v_lshlrev_b32 v8, 1, v8
    v_bfe_u32 v9, v1, 2, 1
    v_add_u32 v8, v8, v9
    s_lshl_b32 s32, s3, 2
    s_add_u32 s32, s32, 1
    v_lshl_add_u32 v8, v8, 5, s32
    v_cmp_eq_u32 vcc, 1, v12
    v_bfe_u32 v9, v1, 1, 1
    v_mul_u32_u24 v9, 8256, v9
    v_add_u32 v9, 86400, v9
    s_cmp_eq_u32 s3, 3
    s_cselect_b32 s32, 272, 0
    v_sub_u32 v10, 512, v8
    v_cndmask_b32_e64 v10, v8, v10, vcc
    v_and_b32 v11, 16, v10
    v_lshl_add_u32 v11, v11, 6, v9
    v_lshrrev_b32 v12, 7, v10
    v_lshl_add_u32 v11, v12, 8, v11
    v_and_b32 v12, 15, v10
    v_lshl_add_u32 v11, v12, 4, v11
    v_bfe_u32 v12, v10, 5, 2
    v_lshl_add_u32 v223, v12, 2, v11
    v_add_u32 v8, 1, v8
    v_sub_u32 v10, 512, v8
    v_cndmask_b32_e64 v10, v8, v10, vcc
    v_and_b32 v11, 16, v10
    v_lshl_add_u32 v11, v11, 6, v9
    v_lshrrev_b32 v12, 7, v10
    v_lshl_add_u32 v11, v12, 8, v11
    v_and_b32 v12, 15, v10
    v_lshl_add_u32 v11, v12, 4, v11
    v_bfe_u32 v12, v10, 5, 2
    v_lshl_add_u32 v224, v12, 2, v11
    v_add_u32 v8, 1, v8
    v_sub_u32 v10, 512, v8
    v_cndmask_b32_e64 v10, v8, v10, vcc
    v_and_b32 v11, 16, v10
    v_lshl_add_u32 v11, v11, 6, v9
    v_lshrrev_b32 v12, 7, v10
    v_lshl_add_u32 v11, v12, 8, v11
    v_and_b32 v12, 15, v10
    v_lshl_add_u32 v11, v12, 4, v11
    v_bfe_u32 v12, v10, 5, 2
    v_lshl_add_u32 v100, v12, 2, v11
    v_mul_u32_u24 v10, s32, v3
    v_sub_u32 v8, v8, v10
    v_add_u32 v8, 1, v8
    v_sub_u32 v10, 512, v8
    v_cndmask_b32_e64 v10, v8, v10, vcc
    v_lshrrev_b32 v11, 1, v10
    v_and_b32 v11, 256, v11
    v_sub_u32 v10, v10, v11
    v_and_b32 v11, 16, v10
    v_lshl_add_u32 v11, v11, 6, v9
    v_lshrrev_b32 v12, 7, v10
    v_lshl_add_u32 v11, v12, 8, v11
    v_and_b32 v12, 15, v10
    v_lshl_add_u32 v11, v12, 4, v11
    v_bfe_u32 v12, v10, 5, 2
    v_lshl_add_u32 v101, v12, 2, v11
    s_and_b32 s32, s3, 3
    s_lshl_b32 s32, s32, 11
    s_add_u32 s32, s32, 86400
    v_add_u32 v225, s32, v239
    v_add_u32 v8, s33, v13
    v_sub_u32 v9, 32, v8
    v_min_u32 v9, v8, v9
    v_and_b32 v10, 15, v8
    v_cmp_eq_u32 s[32:33], 0, v10
    v_cmp_lt_u32 s[34:35], 16, v8
    v_lshlrev_b32 v10, 10, v9
    v_subrev_u32 v10, 1024, v10
    v_mov_b32 v11, 15872
    v_cmp_eq_u32 vcc, 0, v8
    s_nop 1
    v_cndmask_b32_e64 v10, v10, v11, vcc
    v_and_b32 v11, 3, v1
    v_lshl_add_u32 v10, v11, 4, v10
    v_lshrrev_b32 v11, 2, v4
    v_lshlrev_b32 v12, 7, v11
    v_sub_u32 v13, 960, v12
    v_cndmask_b32_e64 v13, v12, v13, s[34:35]
    v_add_u32 v226, v10, v13
    s_or_b64 s[34:35], s[34:35], s[32:33]
    v_add_u32 v12, 512, v12
    v_sub_u32 v13, 960, v12
    v_cndmask_b32_e64 v13, v12, v13, s[34:35]
    v_add_u32 v227, v10, v13
    s_mul_i32 s56, s20, 16512
    s_add_u32 s56, s56, 0x210000
    v_mov_b32 v249, 0x30003
    v_mov_b32 v252, s44
    v_mov_b32 v253, s45
    v_mov_b32 v254, s46
    v_mov_b32 v255, s47
    s_waitcnt lgkmcnt(0)
    v_sub_u32 v8, 15, v4
    v_min_u32 v8, v4, v8
    v_and_b32 v9, 1, v8
    v_lshlrev_b32 v9, 5, v9
    v_lshrrev_b32 v10, 1, v8
    v_lshl_add_u32 v9, v10, 9, v9
    v_add_u32 v9, s25, v9
    v_sub_u32 v10, 2048, v9
    v_cmp_lt_u32 s[34:35], 7, v4
    s_nop 1
    v_cndmask_b32_e64 v230, v9, v10, s[34:35]
    v_mov_b32 v9, v4
    v_mov_b32 v10, s20
    s_cmp_lg_u32 s21, 0
    s_cbranch_scc0 fz_spec3b
fz_spec3backb:
    v_lshlrev_b32 v10, 7, v10
    v_lshl_add_u32 v10, v9, 3, v10
    v_mul_u32_u24 v11, 66048, v5
    v_add_u32 v228, v10, v11
    v_and_b32 v9, 1, v9
    v_cmp_eq_u32 vcc, 1, v9
    v_mov_b32 v9, s44
    v_mov_b32 v10, s46
    v_cndmask_b32_e64 v236, v9, v10, vcc
    v_mov_b32 v9, s45
    v_mov_b32 v10, s47
    v_cndmask_b32_e64 v237, v9, v10, vcc
    s_lshl_b32 s32, s3, 2
    v_add_u32 v8, s32, v5
    v_lshlrev_b32 v9, 6, v8
    v_cmp_gt_u32 vcc, 16, v8
    s_nop 1
    v_cndmask_b32_e64 v10, 0, 32, vcc
    v_add_u32 v10, v9, v10
    v_sub_u32 v11, 2048, v10
    v_cmp_eq_u32 vcc, 16, v8
    s_nop 1
    v_cndmask_b32_e64 v11, v11, 0, vcc
    v_mov_b32 v12, 0xffff0000
    v_cndmask_b32_e64 v238, -1, v12, vcc
    v_sub_u32 v12, 2018, v9
    v_mul_u32_u24 v13, 2064, v4
    v_add_u32 v231, v13, v9
    v_add_u32 v232, v13, v12
    v_add_u32 v233, v13, v10
    v_add_u32 v241, v13, v11
    s_lshl_b32 s32, s3, 8
    s_add_u32 s32, s32, 102912
    v_lshlrev_b32 v9, 4, v4
    v_add_u32 v10, s32, v9
    v_add_u32 v11, 107008, v239
    v_cmp_gt_u32 vcc, 16, v1
    s_nop 1
    v_cndmask_b32_e64 v243, v11, v10, vcc
    v_lshrrev_b32 v12, 2, v4
    v_cmp_eq_u32 vcc, v12, v5
    s_nop 1
    v_cndmask_b32_e64 v244, v11, v10, vcc
    v_lshrrev_b32 v12, 5, v1
    v_lshl_add_u32 v10, v12, 10, v9
    v_add_u32 v245, 102912, v10
    v_and_b32 v9, 1, v1
    v_cmp_eq_u32 s[28:29], 1, v9
    v_and_b32 v9, 2, v1
    v_cmp_eq_u32 s[30:31], 2, v9
    s_lshl_b32 s37, s3, 2
    v_add_u32 v9, s37, v5
    v_mul_u32_u24 v246, 2176, v9
    s_lshl_b32 s26, s20, 4
    s_add_u32 s26, s26, 0x420000
    v_lshlrev_b32 v247, 4, v5
    s_lshl_b32 s27, s20, 11
    s_lshl_b32 s37, s3, 8
    s_add_u32 s27, s27, s37
    s_add_u32 s27, s27, 0x448000
    v_sub_u32 v248, 2047, v230
    s_mov_b32 s14, 0x400000
    s_mov_b32 s15, 0x00020000
    s_mul_i32 s52, s3, 264192
    s_add_u32 s52, s52, 0x210000
    s_add_u32 s53, s52, 16512
    s_add_u32 s54, s52, 33024
    s_add_u32 s55, s52, 49536
    s_mov_b32 s23, s63
    s_getreg_b32 s24, hwreg(HW_REG_XCC_ID)
    s_and_b32 s24, s24, 15
    v_lshlrev_b32 v10, 4, v0
    v_min_u32 v10, 4336, v10
    v_add_u32 v10, 108032, v10
    v_mov_b32 v104, 0
    v_mov_b32 v105, 0
    v_mov_b32 v106, 0
    v_mov_b32 v107, 0
    ds_write_b128 v10, v[104:107]
    s_cmp_eq_u32 s2, 66
    s_cbranch_scc1 fz_sz
    s_waitcnt vmcnt(0)
    v_mov_b32 v10, 256
    s_mov_b64 exec, 1
    ds_add_u32 v15, v10
    s_mov_b64 exec, -1
fz_sz:
    ds_read_b32 v10, v15
    s_waitcnt lgkmcnt(0)
    v_cmp_ne_u32 vcc, s38, v10
    s_cbranch_vccnz fz_sz
    ds_read_b128 v[116:119], v231
    ds_read_b128 v[120:123], v231 offset:16
    ds_read_u16_d16_hi v44, v241
    ds_read_u16_d16_hi v45, v232 offset:28
    ds_read_u16_d16_hi v46, v232 offset:26
    ds_read_u16_d16_hi v47, v232 offset:24
    ds_read_u16_d16_hi v48, v232 offset:22
    ds_read_u16_d16_hi v49, v232 offset:20
    ds_read_u16_d16_hi v50, v232 offset:18
    ds_read_u16_d16_hi v51, v232 offset:16
    ds_read_u16_d16_hi v52, v232 offset:14
    ds_read_u16_d16_hi v53, v232 offset:12
    ds_read_u16_d16_hi v54, v232 offset:10
    ds_read_u16_d16_hi v55, v232 offset:8
    ds_read_u16_d16_hi v56, v232 offset:6
    ds_read_u16_d16_hi v57, v232 offset:4
    ds_read_u16_d16_hi v58, v232 offset:2
    ds_read_u16_d16_hi v59, v232 offset:0
    ds_read_u16_d16_hi v28, v233
    v_mul_u32_u24 v13, 2064, v4
    v_subrev_u32 v13, 104960, v13
    v_sub_u32 v9, v231, v13
    v_sub_u32 v10, v233, v13
    v_sub_u32 v11, v241, v13
    v_sub_u32 v12, v232, v13
    s_mov_b32 s36, 0xffff0000
    s_waitcnt lgkmcnt(0)
    ds_read_b128 v[200:203], v9
    ds_read_b128 v[204:207], v9 offset:16
    ds_read_u16_d16 v208, v11
    ds_read_u16_d16_hi v124, v12 offset:28
    ds_read_u16_d16 v209, v12 offset:26
    ds_read_u16_d16_hi v125, v12 offset:24
    ds_read_u16_d16 v210, v12 offset:22
    ds_read_u16_d16_hi v126, v12 offset:20
    ds_read_u16_d16 v211, v12 offset:18
    ds_read_u16_d16_hi v127, v12 offset:16
    ds_read_u16_d16 v212, v12 offset:14
    ds_read_u16_d16_hi v128, v12 offset:12
    ds_read_u16_d16 v213, v12 offset:10
    ds_read_u16_d16_hi v129, v12 offset:8
    ds_read_u16_d16 v214, v12 offset:6
    ds_read_u16_d16_hi v130, v12 offset:4
    ds_read_u16_d16 v215, v12 offset:2
    ds_read_u16_d16_hi v131, v12 offset:0
    ds_read_u16_d16 v13, v10
    v_and_b32 v29, s36, v116
    v_lshlrev_b32 v30, 16, v117
    v_and_b32 v31, s36, v117
    v_lshlrev_b32 v32, 16, v118
    v_and_b32 v33, s36, v118
    v_lshlrev_b32 v34, 16, v119
    v_and_b32 v35, s36, v119
    v_lshlrev_b32 v36, 16, v120
    v_and_b32 v37, s36, v120
    v_lshlrev_b32 v38, 16, v121
    v_and_b32 v39, s36, v121
    v_lshlrev_b32 v40, 16, v122
    v_and_b32 v41, s36, v122
    v_lshlrev_b32 v42, 16, v123
    v_and_b32 v43, s36, v123
    v_cmp_eq_u32 vcc, 1, v4
    v_mov_b32 v9, s42
    s_nop 0
    v_cndmask_b32_e64 v9, 0, v9, vcc
    v_mov_b32 v116, s42
    v_mov_b32 v117, s42
    v_mov_b32 v118, s42
    v_mov_b32 v119, s42
    v_cmp_eq_u32 vcc, 0, v4
    s_waitcnt lgkmcnt(0)
    v_and_or_b32 v200, v200, s36, v13
    v_or_b32 v208, v208, v124
    v_or_b32 v209, v209, v125
    v_or_b32 v210, v210, v126
    v_or_b32 v211, v211, v127
    v_or_b32 v212, v212, v128
    v_or_b32 v213, v213, v129
    v_or_b32 v214, v214, v130
    v_or_b32 v215, v215, v131
    v_cndmask_b32_e64 v200, v9, v200, vcc
    v_cndmask_b32_e64 v201, v9, v201, vcc
    v_cndmask_b32_e64 v202, v9, v202, vcc
    v_cndmask_b32_e64 v203, v9, v203, vcc
    v_cndmask_b32_e64 v204, v9, v204, vcc
    v_cndmask_b32_e64 v205, v9, v205, vcc
    v_cndmask_b32_e64 v206, v9, v206, vcc
    v_cndmask_b32_e64 v207, v9, v207, vcc
    v_cndmask_b32_e64 v208, v9, v208, vcc
    v_cndmask_b32_e64 v209, v9, v209, vcc
    v_cndmask_b32_e64 v210, v9, v210, vcc
    v_cndmask_b32_e64 v211, v9, v211, vcc
    v_cndmask_b32_e64 v212, v9, v212, vcc
    v_cndmask_b32_e64 v213, v9, v213, vcc
    v_cndmask_b32_e64 v214, v9, v214, vcc
    v_cndmask_b32_e64 v215, v9, v215, vcc
    v_mfma_f32_16x16x32_bf16 v[120:123], v[200:203], v[116:119], 0
    v_mfma_f32_16x16x32_bf16 v[120:123], v[204:207], v[116:119], v[120:123]
    v_mfma_f32_16x16x32_bf16 v[120:123], v[208:211], v[116:119], v[120:123]
    v_mfma_f32_16x16x32_bf16 v[120:123], v[212:215], v[116:119], v[120:123]
    s_nop 7
    ds_write_b32 v243, v120 offset:12
    s_waitcnt lgkmcnt(0)
    s_branch fz_hb
    s_nop 0
fz_nc3:
    s_mov_b32 s58, 0
    s_waitcnt vmcnt(0)
    s_branch fz_h2
fz_spec3a:
    v_xor_b32 v11, 1, v4
    v_cndmask_b32_e64 v9, v9, v11, s[34:35]
    v_and_b32 v11, 1, v4
    v_cndmask_b32_e64 v11, 0, v11, s[34:35]
    v_sub_u32 v10, v10, v11
    s_cmp_lg_u32 s22, 0
    s_cbranch_scc1 fz_spec3backa
    v_cmp_eq_u32 vcc, 15, v4
    v_mov_b32 v11, 1024
    v_mov_b32 v12, 124
    v_cndmask_b32_e64 v230, v230, v11, vcc
    v_cndmask_b32_e64 v10, v10, v12, vcc
    v_cndmask_b32_e64 v9, v9, 4, vcc
    v_cmp_eq_u32 vcc, 13, v4
    v_mov_b32 v11, 1536
    v_mov_b32 v12, 124
    v_cndmask_b32_e64 v230, v230, v11, vcc
    v_cndmask_b32_e64 v10, v10, v12, vcc
    v_cndmask_b32_e64 v9, v9, 6, vcc
    v_cmp_eq_u32 vcc, 4, v4
    v_mov_b32 v11, 256
    v_mov_b32 v12, 127
    v_cndmask_b32_e64 v230, v230, v11, vcc
    v_cndmask_b32_e64 v10, v10, v12, vcc
    v_cndmask_b32_e64 v9, v9, 8, vcc
    v_cmp_eq_u32 vcc, 11, v4
    v_mov_b32 v11, 1792
    v_mov_b32 v12, 127
    v_cndmask_b32_e64 v230, v230, v11, vcc
    v_cndmask_b32_e64 v10, v10, v12, vcc
    v_cndmask_b32_e64 v9, v9, 14, vcc
    v_cmp_eq_u32 vcc, 6, v4
    v_mov_b32 v11, 768
    v_mov_b32 v12, 127
    v_cndmask_b32_e64 v230, v230, v11, vcc
    v_cndmask_b32_e64 v10, v10, v12, vcc
    v_cndmask_b32_e64 v9, v9, 10, vcc
    v_cmp_eq_u32 vcc, 9, v4
    v_mov_b32 v11, 1280
    v_mov_b32 v12, 127
    v_cndmask_b32_e64 v230, v230, v11, vcc
    v_cndmask_b32_e64 v10, v10, v12, vcc
    v_cndmask_b32_e64 v9, v9, 12, vcc
    s_nop 4
    s_branch fz_spec3backa
fz_spec3b:
    v_xor_b32 v11, 1, v4
    v_cndmask_b32_e64 v9, v9, v11, s[34:35]
    v_and_b32 v11, 1, v4
    v_cndmask_b32_e64 v11, 0, v11, s[34:35]
    v_sub_u32 v10, v10, v11
    s_cmp_lg_u32 s22, 0
    s_cbranch_scc1 fz_spec3backb
    v_cmp_eq_u32 vcc, 15, v4
    v_mov_b32 v11, 1024
    v_mov_b32 v12, 124
    v_cndmask_b32_e64 v230, v230, v11, vcc
    v_cndmask_b32_e64 v10, v10, v12, vcc
    v_cndmask_b32_e64 v9, v9, 4, vcc
    v_cmp_eq_u32 vcc, 13, v4
    v_mov_b32 v11, 1536
    v_mov_b32 v12, 124
    v_cndmask_b32_e64 v230, v230, v11, vcc
    v_cndmask_b32_e64 v10, v10, v12, vcc
    v_cndmask_b32_e64 v9, v9, 6, vcc
    v_cmp_eq_u32 vcc, 4, v4
    v_mov_b32 v11, 256
    v_mov_b32 v12, 127
    v_cndmask_b32_e64 v230, v230, v11, vcc
    v_cndmask_b32_e64 v10, v10, v12, vcc
    v_cndmask_b32_e64 v9, v9, 8, vcc
    v_cmp_eq_u32 vcc, 11, v4
    v_mov_b32 v11, 1792
    v_mov_b32 v12, 127
    v_cndmask_b32_e64 v230, v230, v11, vcc
    v_cndmask_b32_e64 v10, v10, v12, vcc
    v_cndmask_b32_e64 v9, v9, 14, vcc
    v_cmp_eq_u32 vcc, 6, v4
    v_mov_b32 v11, 768
    v_mov_b32 v12, 127
    v_cndmask_b32_e64 v230, v230, v11, vcc
    v_cndmask_b32_e64 v10, v10, v12, vcc
    v_cndmask_b32_e64 v9, v9, 10, vcc
    v_cmp_eq_u32 vcc, 9, v4
    v_mov_b32 v11, 1280
    v_mov_b32 v12, 127
    v_cndmask_b32_e64 v230, v230, v11, vcc
    v_cndmask_b32_e64 v10, v10, v12, vcc
    v_cndmask_b32_e64 v9, v9, 12, vcc
    s_nop 4
    s_branch fz_spec3backb
    s_nop 0
ffn_b:
    s_waitcnt vmcnt(0)
    v_readfirstlane_b32 s40, v250
    s_nop 1
    s_add_u32 s40, s40, 1
    s_and_b32 s38, s40, 3
    s_and_b32 s39, s40, 15
    s_bfe_u32 s41, s40, 0x20002
    s_lshl_b32 s41, s41, 16
    s_or_b32 s44, s38, s41
    s_bfe_u32 s41, s40, 0x40004
    s_lshl_b32 s41, s41, 4
    s_or_b32 s48, s39, s41
    s_bfe_u32 s41, s40, 0x20004
    s_lshl_b32 s41, s41, 16
    s_or_b32 s45, s38, s41
    s_bfe_u32 s41, s40, 0x40008
    s_lshl_b32 s41, s41, 4
    s_or_b32 s49, s39, s41
    s_bfe_u32 s41, s40, 0x20006
    s_lshl_b32 s41, s41, 16
    s_or_b32 s46, s38, s41
    s_bfe_u32 s41, s40, 0x4000c
    s_lshl_b32 s41, s41, 4
    s_or_b32 s50, s39, s41
    s_bfe_u32 s41, s40, 0x20008
    s_lshl_b32 s41, s41, 16
    s_or_b32 s47, s38, s41
    s_bfe_u32 s41, s40, 0x40010
    s_lshl_b32 s41, s41, 4
    s_or_b32 s51, s39, s41
    s_nop 0
ffn:
    s_add_u32 s36, s2, 4
    s_and_b32 s36, s36, 7
    s_bfe_u32 s37, s2, 0x10006
    s_lshl_b32 s22, s36, 1
    s_add_u32 s22, s22, s37
    s_cmp_lg_u32 s37, 0
    s_cselect_b32 s37, 8, s36
    s_add_u32 s37, s37, 6
    s_cmp_lt_u32 s36, 6
    s_cselect_b32 s22, s22, s37
    s_cmp_gt_u32 s22, 13
    s_cbranch_scc1 fz_xend
    s_bfe_u32 s21, s2, 0x30003
    v_lshrrev_b32 v2, 5, v1
    v_and_b32 v3, 31, v1
    v_lshlrev_b32 v4, 1, v2
    v_xor_b32 v3, v4, v3
    v_mul_u32_u24 v4, 7168, v2
    v_lshl_add_u32 v4, v3, 4, v4
    v_xor_b32 v5, 64, v4
    v_xor_b32 v6, 128, v4
    v_xor_b32 v7, 192, v4
    s_lshl_b32 s23, s21, 7
    s_lshl_b32 s24, s3, 4
    s_add_u32 s23, s23, s24
    s_mul_i32 s23, s23, 7168
    s_lshl_b32 s24, s22, 9
    s_add_u32 s23, s23, s24
    s_lshl_b32 s24, s3, 13
    v_mov_b32 v31, 149552
    v_mov_b32 v10, 0
    ds_write_b32 v31, v10
    s_waitcnt lgkmcnt(0)
    s_setprio 0
    s_barrier
    s_add_u32 s28, s24, 81920
    s_mov_b32 m0, s28
    s_add_u32 s29, s23, 0
    buffer_load_dwordx4 v4, s[12:15], s29 offen nt lds
    s_add_u32 s28, s24, 82944
    s_mov_b32 m0, s28
    s_add_u32 s29, s23, 14336
    buffer_load_dwordx4 v5, s[12:15], s29 offen nt lds
    s_add_u32 s28, s24, 83968
    s_mov_b32 m0, s28
    s_add_u32 s29, s23, 28672
    buffer_load_dwordx4 v4, s[12:15], s29 offen nt lds
    s_add_u32 s28, s24, 84992
    s_mov_b32 m0, s28
    s_add_u32 s29, s23, 43008
    buffer_load_dwordx4 v5, s[12:15], s29 offen nt lds
    s_add_u32 s28, s24, 86016
    s_mov_b32 m0, s28
    s_add_u32 s29, s23, 57344
    buffer_load_dwordx4 v6, s[12:15], s29 offen nt lds
    s_add_u32 s28, s24, 87040
    s_mov_b32 m0, s28
    s_add_u32 s29, s23, 71680
    buffer_load_dwordx4 v7, s[12:15], s29 offen nt lds
    s_add_u32 s28, s24, 88064
    s_mov_b32 m0, s28
    s_add_u32 s29, s23, 86016
    buffer_load_dwordx4 v6, s[12:15], s29 offen nt lds
    s_add_u32 s28, s24, 89088
    s_mov_b32 m0, s28
    s_add_u32 s29, s23, 100352
    buffer_load_dwordx4 v7, s[12:15], s29 offen nt lds
    s_add_u32 s28, s24, 0
    s_mov_b32 m0, s28
    s_add_u32 s29, s23, 0
    buffer_load_dwordx4 v4, s[16:19], s29 offen nt lds
    s_add_u32 s28, s24, 1024
    s_mov_b32 m0, s28
    s_add_u32 s29, s23, 14336
    buffer_load_dwordx4 v5, s[16:19], s29 offen nt lds
    s_add_u32 s28, s24, 2048
    s_mov_b32 m0, s28
    s_add_u32 s29, s23, 28672
    buffer_load_dwordx4 v4, s[16:19], s29 offen nt lds
    s_add_u32 s28, s24, 3072
    s_mov_b32 m0, s28
    s_add_u32 s29, s23, 43008
    buffer_load_dwordx4 v5, s[16:19], s29 offen nt lds
    s_add_u32 s28, s24, 4096
    s_mov_b32 m0, s28
    s_add_u32 s29, s23, 57344
    buffer_load_dwordx4 v6, s[16:19], s29 offen nt lds
    s_add_u32 s28, s24, 5120
    s_mov_b32 m0, s28
    s_add_u32 s29, s23, 71680
    buffer_load_dwordx4 v7, s[16:19], s29 offen nt lds
    s_add_u32 s28, s24, 6144
    s_mov_b32 m0, s28
    s_add_u32 s29, s23, 86016
    buffer_load_dwordx4 v6, s[16:19], s29 offen nt lds
    s_add_u32 s28, s24, 7168
    s_mov_b32 m0, s28
    s_add_u32 s29, s23, 100352
    buffer_load_dwordx4 v7, s[16:19], s29 offen nt lds
    v_lshrrev_b32 v2, 4, v1
    v_and_b32 v3, 15, v1
    v_bfe_u32 v9, v1, 2, 2
    v_lshl_add_u32 v8, v2, 3, v9
    v_lshlrev_b32 v8, 9, v8
    v_and_b32 v10, 1, v2
    v_lshl_add_u32 v10, v10, 2, v9
    s_lshl_b32 s28, s3, 1
    v_xor_b32 v10, s28, v10
    v_lshl_add_u32 v8, v10, 5, v8
    v_and_b32 v10, 3, v1
    v_lshl_add_u32 v8, v10, 3, v8
    v_xor_b32 v12, 32, v8
    v_add_u32 v13, 81920, v8
    v_add_u32 v20, 81920, v12
    v_bfe_u32 v9, v0, 2, 2
    v_lshrrev_b32 v10, 6, v0
    v_lshl_add_u32 v9, v10, 2, v9
    v_bfe_u32 v10, v0, 4, 1
    v_and_b32 v11, 3, v0
    v_lshlrev_b32 v11, 1, v11
    v_lshl_add_u32 v10, v10, 3, v11
    v_lshl_add_u32 v11, v9, 5, v10
    v_add_u32 v17, 1, v11
    v_cmp_eq_u32 vcc, 0, v10
    v_cmp_gt_u32 s[28:29], 16, v9
    s_nop 1
    s_and_b64 vcc, vcc, s[28:29]
    v_cndmask_b32_e64 v14, 0, 16, vcc
    v_add_u32 v16, v11, v14
    v_bfe_u32 v10, v0, 5, 1
    v_cmp_eq_u32 s[28:29], 1, v10
    v_sub_u32 v14, 1024, v16
    v_cmp_eq_u32 vcc, 512, v16
    s_nop 1
    v_cndmask_b32_e64 v14, v14, 0, vcc
    v_cndmask_b32_e64 v16, v16, v14, s[28:29]
    v_sub_u32 v14, 1024, v17
    v_cndmask_b32_e64 v17, v17, v14, s[28:29]
    v_lshlrev_b32 v16, 1, v16
    v_add_u32 v16, 147456, v16
    v_lshlrev_b32 v17, 1, v17
    v_add_u32 v17, 147456, v17
    v_lshlrev_b32 v18, 2, v0
    v_add_u32 v18, 149568, v18
    s_lshl_b32 s28, s21, 8
    s_add_u32 s28, s28, 147456
    v_lshlrev_b32 v19, 4, v2
    v_add_u32 v19, s28, v19
    v_mov_b32 v28, 149504
    v_lshlrev_b32 v29, 4, v1
    s_lshl_b32 s30, s22, 3
    s_add_u32 s30, s30, s3
    s_lshl_b32 s30, s30, 3
    s_add_u32 s30, s30, s21
    s_lshl_b32 s30, s30, 8
    s_add_u32 s30, s30, 0x488000
    v_lshlrev_b32 v30, 4, v2
    v_lshl_add_u32 v30, v3, 6, v30
    v_cmp_eq_u32 s[60:61], 1, v3
    v_cmp_eq_u32 s[62:63], 2, v3
    v_cmp_eq_u32 s[64:65], 3, v3
    v_add_u32 v21, 149568, v29
    v_mov_b32 v197, 0xffffff00
    s_and_b32 s35, s2, 0x47
    s_lshl_b32 s31, s3, 3
    s_add_u32 s35, s35, s31
    s_add_u32 s35, s35, 58
    s_and_b32 s35, s35, 127
    s_getreg_b32 s33, hwreg(HW_REG_XCC_ID)
    s_and_b32 s33, s33, 15
    s_lshr_b32 s31, s35, 5
    s_lshl_b32 s31, s31, 2
    s_add_u32 s31, s31, 149520
    v_mov_b32 v22, s31
    s_lshl_b32 s20, s22, 3
    s_add_u32 s20, s20, s21
    s_and_b32 s34, s20, 15
    s_bfe_u32 s28, s20, 0x10004
    s_lshl_b32 s28, s28, 5
    s_add_u32 s34, s34, s28
    s_mul_i32 s34, s34, 2176
    s_add_u32 s34, s34, 0x420000
    s_waitcnt vmcnt(0)
    s_barrier
    ds_read_b64_tr_b16 v[32:33], v13 offset:0
    ds_read_b64_tr_b16 v[34:35], v13 offset:2048
    ds_read_b64_tr_b16 v[36:37], v13 offset:16384
    ds_read_b64_tr_b16 v[38:39], v13 offset:18432
    ds_read_b64_tr_b16 v[40:41], v13 offset:32768
    ds_read_b64_tr_b16 v[42:43], v13 offset:34816
    ds_read_b64_tr_b16 v[44:45], v13 offset:49152
    ds_read_b64_tr_b16 v[46:47], v13 offset:51200
    s_waitcnt lgkmcnt(0)
    ds_read_b64_tr_b16 v[48:49], v20 offset:0
    ds_read_b64_tr_b16 v[50:51], v20 offset:2048
    ds_read_b64_tr_b16 v[52:53], v20 offset:16384
    ds_read_b64_tr_b16 v[54:55], v20 offset:18432
    ds_read_b64_tr_b16 v[56:57], v20 offset:32768
    ds_read_b64_tr_b16 v[58:59], v20 offset:34816
    ds_read_b64_tr_b16 v[60:61], v20 offset:49152
    ds_read_b64_tr_b16 v[62:63], v20 offset:51200
    s_waitcnt lgkmcnt(0)
    ds_read_b64_tr_b16 v[64:65], v8 offset:0
    ds_read_b64_tr_b16 v[66:67], v8 offset:2048
    ds_read_b64_tr_b16 v[68:69], v8 offset:16384
    ds_read_b64_tr_b16 v[70:71], v8 offset:18432
    ds_read_b64_tr_b16 v[72:73], v8 offset:32768
    ds_read_b64_tr_b16 v[74:75], v8 offset:34816
    ds_read_b64_tr_b16 v[76:77], v8 offset:49152
    ds_read_b64_tr_b16 v[78:79], v8 offset:51200
    s_waitcnt lgkmcnt(0)
    ds_read_b64_tr_b16 v[80:81], v12 offset:0
    ds_read_b64_tr_b16 v[82:83], v12 offset:2048
    ds_read_b64_tr_b16 v[84:85], v12 offset:16384
    ds_read_b64_tr_b16 v[86:87], v12 offset:18432
    ds_read_b64_tr_b16 v[88:89], v12 offset:32768
    ds_read_b64_tr_b16 v[90:91], v12 offset:34816
    ds_read_b64_tr_b16 v[92:93], v12 offset:49152
    ds_read_b64_tr_b16 v[94:95], v12 offset:51200
    s_waitcnt lgkmcnt(0)
    s_cmp_lg_u32 s3, 0
    s_cbranch_scc1 ffn_w3
    s_lshl_b32 s28, s20, 4
    s_add_u32 s28, s28, s34
    v_mov_b32 v10, 34828
    s_nop 4
ffn_p3:
    buffer_load_dword v11, v10, s[4:7], s28 offen sc1
    s_waitcnt vmcnt(0) lgkmcnt(0)
    v_cmp_ne_u32 vcc, s40, v11
    s_cbranch_vccnz ffn_p3_rt
ffn_p3_ok:
    s_mov_b32 s58, 0
    s_nop 2
ffn_k3:
    buffer_load_dwordx4 v[200:203], v29, s[4:7], s34 offen sc1
    buffer_load_dwordx4 v[204:207], v29, s[4:7], s34 offen offset:1024 sc1
    s_waitcnt vmcnt(0)
    v_xor_b32 v208, s40, v203
    v_xor_b32 v209, s40, v207
    v_max_u32 v210, v200, v204
    v_or_b32 v208, v208, v209
    v_cmp_ne_u32 vcc, 0, v208
    s_cbranch_vccnz ffn_k3_rt
ffn_k3_ok:
    v_max_u32_dpp v210, v210, v210 quad_perm:[1,0,3,2] row_mask:0xf bank_mask:0xf
    s_nop 1
    v_max_u32_dpp v210, v210, v210 quad_perm:[2,3,0,1] row_mask:0xf bank_mask:0xf
    s_nop 1
    v_max_u32_dpp v210, v210, v210 row_half_mirror row_mask:0xf bank_mask:0xf
    s_nop 1
    v_max_u32_dpp v210, v210, v210 row_mirror row_mask:0xf bank_mask:0xf
    s_nop 1
    v_max_u32_dpp v210, v210, v210 row_bcast:15 row_mask:0xa bank_mask:0xf
    s_nop 1
    v_max_u32_dpp v210, v210, v210 row_bcast:31 row_mask:0xc bank_mask:0xf
    s_nop 0
    v_readlane_b32 s36, v210, 63
    s_nop 1
    v_cmp_eq_u32 vcc, s36, v200
    v_cmp_eq_u32 s[28:29], s36, v204
    s_nop 0
    s_cmp_lg_u64 vcc, 0
    s_cselect_b32 s39, 0, 64
    s_or_b64 vcc, vcc, s[28:29]
    s_ff1_i32_b64 s41, vcc
    s_add_u32 s39, s39, s41
    s_lshl_b32 s39, s39, 11
    s_add_u32 s39, s39, 0x448000
    s_mov_b32 s58, 0
ffn_c3:
    buffer_load_dwordx4 v[128:131], v29, s[4:7], s39 offen sc1
    buffer_load_dwordx4 v[132:135], v29, s[4:7], s39 offen offset:1024 sc1
    v_and_b32 v10, 15, v201
    v_and_b32 v11, 15, v205
    v_cmp_eq_u32 s[24:25], s33, v10
    v_cmp_eq_u32 s[26:27], s33, v11
    s_nop 0
    v_mov_b32 v212, s24
    v_mov_b32 v213, s25
    v_mov_b32 v214, s26
    v_mov_b32 v215, s27
    v_cndmask_b32_e64 v209, v201, v205, s[28:29]
    v_cndmask_b32_e64 v210, v202, v206, s[28:29]
    v_and_b32 v209, 0xffff0000, v209
    s_mov_b64 s[42:43], vcc
    s_mov_b64 exec, vcc
    ds_write_b128 v28, v[208:211]
    ds_write_b128 v28, v[212:215] offset:16
    s_mov_b64 exec, -1
    s_waitcnt vmcnt(1)
    ds_write_b128 v21, v[128:131]
    v_max3_u32 v10, v128, v129, v130
    s_waitcnt vmcnt(0)
    ds_write_b128 v21, v[132:135] offset:1024
    v_max3_u32 v10, v10, v131, v132
    v_max3_u32 v11, v133, v134, v135
    v_max_u32 v10, v10, v11
    v_cmp_eq_u32 vcc, -1, v10
    s_cbranch_vccnz ffn_c3_rt
ffn_c3_ok:
    s_waitcnt lgkmcnt(0)
    s_nop 2
ffn_w3:
    s_barrier
    ds_read_b32 v11, v18
    ds_read_b128 v[200:203], v28
    ds_read_b32 v203, v22
    s_mov_b32 s28, 0xffff0000
    s_waitcnt lgkmcnt(2)
    v_lshlrev_b32 v14, 16, v11
    v_and_b32 v15, s28, v11
    s_waitcnt lgkmcnt(0)
    v_add_f32 v14, v14, v201
    v_add_f32 v15, v15, v201
    v_cvt_pk_bf16_f32 v14, 0, v14
    v_cvt_pk_bf16_f32 v15, 0, v15
    v_mul_f32 v14, v14, v202
    v_mul_f32 v15, v15, v202
    v_cvt_pk_bf16_f32 v14, v14, v15
    ds_write_b16 v16, v14
    ds_write_b16_d16_hi v17, v14
    v_readfirstlane_b32 s24, v203
    s_waitcnt lgkmcnt(0)
    s_barrier
    ds_read_b128 v[128:131], v19 offset:0
    ds_read_b128 v[132:135], v19 offset:64
    ds_read_b128 v[136:139], v19 offset:128
    ds_read_b128 v[140:143], v19 offset:192
    s_waitcnt lgkmcnt(3)
    v_mfma_f32_16x16x32_bf16 v[192:195], v[32:35], v[128:131], 0
    v_mfma_f32_16x16x32_bf16 v[148:151], v[48:51], v[128:131], 0
    v_mfma_f32_16x16x32_bf16 v[152:155], v[64:67], v[128:131], 0
    v_mfma_f32_16x16x32_bf16 v[156:159], v[80:83], v[128:131], 0
    s_waitcnt lgkmcnt(2)
    v_mfma_f32_16x16x32_bf16 v[192:195], v[36:39], v[132:135], v[192:195]
    v_mfma_f32_16x16x32_bf16 v[148:151], v[52:55], v[132:135], v[148:151]
    v_mfma_f32_16x16x32_bf16 v[152:155], v[68:71], v[132:135], v[152:155]
    v_mfma_f32_16x16x32_bf16 v[156:159], v[84:87], v[132:135], v[156:159]
    s_waitcnt lgkmcnt(1)
    v_mfma_f32_16x16x32_bf16 v[192:195], v[40:43], v[136:139], v[192:195]
    v_mfma_f32_16x16x32_bf16 v[148:151], v[56:59], v[136:139], v[148:151]
    v_mfma_f32_16x16x32_bf16 v[152:155], v[72:75], v[136:139], v[152:155]
    v_mfma_f32_16x16x32_bf16 v[156:159], v[88:91], v[136:139], v[156:159]
    s_waitcnt lgkmcnt(0)
    v_mfma_f32_16x16x32_bf16 v[192:195], v[44:47], v[140:143], v[192:195]
    v_mfma_f32_16x16x32_bf16 v[148:151], v[60:63], v[140:143], v[148:151]
    v_mfma_f32_16x16x32_bf16 v[152:155], v[76:79], v[140:143], v[152:155]
    v_mfma_f32_16x16x32_bf16 v[156:159], v[92:95], v[140:143], v[156:159]
    s_nop 5
    v_cndmask_b32_e64 v192, v192, v148, s[60:61]
    v_cndmask_b32_e64 v193, v193, v149, s[60:61]
    v_cndmask_b32_e64 v194, v194, v150, s[60:61]
    v_cndmask_b32_e64 v195, v195, v151, s[60:61]
    v_cndmask_b32_e64 v192, v192, v152, s[62:63]
    v_cndmask_b32_e64 v193, v193, v153, s[62:63]
    v_cndmask_b32_e64 v194, v194, v154, s[62:63]
    v_cndmask_b32_e64 v195, v195, v155, s[62:63]
    v_cndmask_b32_e64 v192, v192, v156, s[64:65]
    v_cndmask_b32_e64 v193, v193, v157, s[64:65]
    v_cndmask_b32_e64 v194, v194, v158, s[64:65]
    v_cndmask_b32_e64 v195, v195, v159, s[64:65]
    s_mov_b32 exec_lo, 0x000f000f
    s_mov_b32 exec_hi, 0x000f000f
    v_and_or_b32 v192, v192, v197, s48
    v_and_or_b32 v193, v193, v197, s49
    v_and_or_b32 v194, v194, v197, s50
    v_and_or_b32 v195, v195, v197, s51
    s_bitcmp1_b32 s24, s35
    s_cbranch_scc0 ffn_rem
    buffer_store_dwordx4 v[192:195], v30, s[4:7], s30 offen
ffn_fin:
    s_endpgm
ffn_rem:
    buffer_store_dwordx4 v[192:195], v30, s[4:7], s30 offen sc1
    s_branch ffn_fin
ffn_c3_rt:
    s_mov_b64 vcc, s[42:43]
    s_add_u32 s58, s58, 1
    s_cmp_lt_u32 s58, 0x10000
    s_cbranch_scc1 ffn_c3
    s_branch ffn_c3_ok
fz_h1_r0:
    s_add_u32 s58, s58, 1
    s_cmp_gt_u32 s58, 0x10000
    s_cbranch_scc1 fz_h1_o0
    buffer_load_dwordx4 v[104:107], v222, s[4:7], s60 offen sc1
    buffer_load_dwordx4 v[108:111], v222, s[4:7], s61 offen sc1
    buffer_load_dwordx4 v[112:115], v222, s[4:7], s16 offen sc1
    buffer_load_dwordx4 v[116:119], v222, s[4:7], s17 offen sc1
    s_branch fz_h1_c0
fz_h1_r1:
    s_add_u32 s58, s58, 1
    s_cmp_gt_u32 s58, 0x10000
    s_cbranch_scc1 fz_h1_o1
    buffer_load_dwordx4 v[108:111], v222, s[4:7], s61 offen sc1
    buffer_load_dwordx4 v[112:115], v222, s[4:7], s16 offen sc1
    buffer_load_dwordx4 v[116:119], v222, s[4:7], s17 offen sc1
    s_branch fz_h1_c1
fz_h1_r2:
    s_add_u32 s58, s58, 1
    s_cmp_gt_u32 s58, 0x10000
    s_cbranch_scc1 fz_h1_o2
    buffer_load_dwordx4 v[112:115], v222, s[4:7], s16 offen sc1
    buffer_load_dwordx4 v[116:119], v222, s[4:7], s17 offen sc1
    s_branch fz_h1_c2
fz_h1_r3:
    s_add_u32 s58, s58, 1
    s_cmp_gt_u32 s58, 0x10000
    s_cbranch_scc1 fz_h1_o3
    buffer_load_dwordx4 v[116:119], v222, s[4:7], s17 offen sc1
    s_branch fz_h1_c3
fz_h2_r0:
    s_add_u32 s58, s58, 1
    s_cmp_gt_u32 s58, 0x10000
    s_cbranch_scc1 fz_h2_o0
    buffer_load_dwordx2 v[104:105], v228, s[4:7], s52 offen sc1
    buffer_load_dwordx2 v[106:107], v228, s[4:7], s53 offen sc1
    buffer_load_dwordx2 v[108:109], v228, s[4:7], s54 offen sc1
    buffer_load_dwordx2 v[110:111], v228, s[4:7], s55 offen sc1
    s_branch fz_h2_c0
fz_h2_r1:
    s_add_u32 s58, s58, 1
    s_cmp_gt_u32 s58, 0x10000
    s_cbranch_scc1 fz_h2_o1
    buffer_load_dwordx2 v[106:107], v228, s[4:7], s53 offen sc1
    buffer_load_dwordx2 v[108:109], v228, s[4:7], s54 offen sc1
    buffer_load_dwordx2 v[110:111], v228, s[4:7], s55 offen sc1
    s_branch fz_h2_c1
fz_h2_r2:
    s_add_u32 s58, s58, 1
    s_cmp_gt_u32 s58, 0x10000
    s_cbranch_scc1 fz_h2_o2
    buffer_load_dwordx2 v[108:109], v228, s[4:7], s54 offen sc1
    buffer_load_dwordx2 v[110:111], v228, s[4:7], s55 offen sc1
    s_branch fz_h2_c2
fz_h2_r3:
    s_add_u32 s58, s58, 1
    s_cmp_gt_u32 s58, 0x10000
    s_cbranch_scc1 fz_h2_o3
    buffer_load_dwordx2 v[110:111], v228, s[4:7], s55 offen sc1
    s_branch fz_h2_c3
fz_h5_r0:
    s_add_u32 s58, s58, 1
    s_cmp_gt_u32 s58, 0x10000
    s_cbranch_scc1 fz_h5_o0
    buffer_load_dwordx4 v[40:43], v3, s[4:7], s52 offen sc1
    buffer_load_dwordx4 v[44:47], v3, s[4:7], s53 offen sc1
    buffer_load_dwordx4 v[48:51], v3, s[4:7], s54 offen sc1
    buffer_load_dwordx4 v[52:55], v6, s[4:7], s55 offen sc1
    s_branch fz_h5_c0
fz_h5_r1:
    s_add_u32 s58, s58, 1
    s_cmp_gt_u32 s58, 0x10000
    s_cbranch_scc1 fz_h5_o1
    buffer_load_dwordx4 v[44:47], v3, s[4:7], s53 offen sc1
    buffer_load_dwordx4 v[48:51], v3, s[4:7], s54 offen sc1
    buffer_load_dwordx4 v[52:55], v6, s[4:7], s55 offen sc1
    s_branch fz_h5_c1
fz_h5_r2:
    s_add_u32 s58, s58, 1
    s_cmp_gt_u32 s58, 0x10000
    s_cbranch_scc1 fz_h5_o2
    buffer_load_dwordx4 v[48:51], v3, s[4:7], s54 offen sc1
    buffer_load_dwordx4 v[52:55], v6, s[4:7], s55 offen sc1
    s_branch fz_h5_c2
fz_h5_r3:
    s_add_u32 s58, s58, 1
    s_cmp_gt_u32 s58, 0x10000
    s_cbranch_scc1 fz_h5_o3
    buffer_load_dwordx4 v[52:55], v6, s[4:7], s55 offen sc1
    s_branch fz_h5_c3
fz_k2_rt:
    s_add_u32 s58, s58, 1
    s_cmp_lt_u32 s58, 0x10000
    s_cbranch_scc1 fz_k2
    s_branch fz_k2_ok
fz_c2_rt:
    s_add_u32 s58, s58, 1
    s_cmp_lt_u32 s58, 0x10000
    s_cbranch_scc1 fz_c2
    s_branch fz_c2_ok
fz_p5_rt:
    s_add_u32 s58, s58, 1
    s_cmp_lt_u32 s58, 0x10000
    s_cbranch_scc1 fz_p5
    s_branch fz_p5_ok
fz_h4_rt:
    s_add_u32 s58, s58, 1
    s_cmp_lt_u32 s58, 0x10000
    s_cbranch_scc1 fz_h4
    s_branch fz_h4_ok
ffn_p3_rt:
    s_add_u32 s58, s58, 1
    s_cmp_lt_u32 s58, 0x10000
    s_cbranch_scc1 ffn_p3
    s_branch ffn_p3_ok
ffn_k3_rt:
    s_add_u32 s58, s58, 1
    s_cmp_lt_u32 s58, 0x10000
    s_cbranch_scc1 ffn_k3
    s_branch ffn_k3_ok
fz_codeend:
.section .rodata,"a"
.p2align 6
.amdhsa_kernel fz_kernel
  .amdhsa_next_free_vgpr 256
  .amdhsa_next_free_sgpr 102
  .amdhsa_accum_offset 256
  .amdhsa_group_segment_fixed_size 0
  .amdhsa_kernarg_size 104
  .amdhsa_user_sgpr_count 2
  .amdhsa_user_sgpr_kernarg_segment_ptr 1
  .amdhsa_system_sgpr_workgroup_id_x 1
.end_amdhsa_kernel
```

```asm
; @launch kernel=fz_kernel grid=(256,1,1) block=(512,1,1) lds=163840
.amdgcn_target "amdgcn-amd-amdhsa--gfx950"
.text
.globl fz_kernel
.p2align 8
.type fz_kernel,@function
fz_kernel:
    s_load_dwordx2 s[4:5], s[0:1], 96
    s_load_dwordx2 s[8:9], s[0:1], 0
    s_load_dwordx2 s[64:65], s[0:1], 72
    s_cmp_gt_u32 s2, 255
    s_cbranch_scc1 fz_end
    v_lshrrev_b32 v2, 6, v0
    v_and_b32 v1, 63, v0
    s_lshr_b32 s59, s2, 7
    v_readfirstlane_b32 s3, v2
    s_and_b32 s20, s2, 127
    s_cmp_lt_u32 s20, 8
    s_cselect_b32 s20, s3, 0
    s_cmp_lt_u32 s20, 4
    s_cbranch_scc1 fz_pfcback
    s_getpc_b64 s[20:21]
fz_pcb:
    s_sub_u32 s20, s20, fz_pcb-fz_kernel
    s_subb_u32 s21, s21, 0
    v_and_b32 v3, 255, v0
    v_lshlrev_b32 v3, 7, v3
    v_min_u32 v3, fz_codeend-fz_kernel-4, v3
    v_mov_b32 v5, s21
    v_add_co_u32 v4, vcc, s20, v3
    s_nop 1
    v_addc_co_u32 v5, vcc, 0, v5, vcc
    global_load_dword v251, v[4:5], off
fz_pfcback:
    s_cmp_lg_u32 s59, 0
    s_cbranch_scc1 fz_ldh
    s_load_dwordx2 s[12:13], s[0:1], 80
    s_load_dwordx2 s[16:17], s[0:1], 48
fz_ldback:
    s_add_u32 s20, s2, 58
    s_and_b32 s20, s20, 127
    s_lshr_b32 s21, s20, 3
    s_add_u32 s21, s21, 1
    s_and_b32 s22, s20, 7
    s_sub_u32 s23, s20, 124
    s_cmp_ge_u32 s20, 124
    s_cselect_b32 s21, 0, s21
    s_cselect_b32 s22, s23, s22
    s_lshr_b32 s57, s3, 2
    s_or_b32 s23, s57, s59
    s_and_b32 s24, s3, 3
    s_lshl_b32 s25, s22, 6
    s_add_u32 s25, s25, s21
    s_lshl_b32 s26, s23, 5
    s_add_u32 s26, s26, s25
    s_lshl_b32 s27, s24, 9
    s_add_u32 s28, s26, s27
    s_sub_u32 s27, 2048, s27
    s_sub_u32 s27, s27, s26
    s_lshl_b32 s29, s24, 1
    s_add_u32 s29, s29, s23
    s_sub_u32 s30, 15, s29
    s_cmp_lt_u32 s24, 2
    s_cselect_b32 s27, s28, s27
    s_cselect_b32 s31, s29, s30
    s_cselect_b32 s30, s30, s29
    s_sub_u32 s28, 2048, s27
    s_and_b32 s28, s28, 2047
    s_lshl_b32 s27, s27, 11
    s_lshl_b32 s28, s28, 11
    s_mul_i32 s31, s31, 2064
    s_mul_i32 s30, s30, 2064
    v_lshlrev_b32 v239, 4, v1
    s_mov_b32 s10, 0x400000
    s_mov_b32 s11, 0x00020000
    s_mov_b32 s6, 0x690000
    s_mov_b32 s7, 0x00020000
    s_mov_b32 s66, 0x700000
    s_mov_b32 s67, 0x00020000
    s_and_b32 s32, s57, s59
    s_add_u32 s36, s2, 4
    s_and_b32 s36, s36, 7
    s_bfe_u32 s37, s2, 0x10006
    s_lshl_b32 s63, s36, 1
    s_add_u32 s63, s63, s37
    s_cmp_lg_u32 s37, 0
    s_cselect_b32 s37, 8, s36
    s_add_u32 s37, s37, 6
    s_cmp_lt_u32 s36, 6
    s_cselect_b32 s63, s63, s37
    s_lshl_b32 s63, s63, 3
    s_bfe_u32 s37, s2, 0x30003
    s_add_u32 s63, s63, s37
    v_and_b32 v10, 15, v1
    v_lshlrev_b32 v10, 4, v10
    v_lshrrev_b32 v14, 4, v1
    v_lshl_add_u32 v14, v14, 11, v10
    s_lshl_b32 s62, s63, 16
    s_and_b32 s37, s3, 3
    s_lshl_b32 s37, s37, 9
    s_add_u32 s62, s62, s37
    s_mov_b32 s58, 0
    s_waitcnt lgkmcnt(0)
    s_cmp_eq_u32 s2, 66
    s_cbranch_scc1 fz_spec
fz_specback:
    s_cmp_lg_u32 s57, 0
    s_cbranch_scc1 fz_nox
    s_mov_b32 m0, s31
    s_nop 0
    buffer_load_dwordx4 v239, s[8:11], s27 offen lds
    buffer_load_dwordx4 v239, s[8:11], s27 offen offset:1024 lds
    s_mov_b32 m0, s30
    s_nop 0
    buffer_load_dwordx4 v239, s[8:11], s28 offen lds
    buffer_load_dwordx4 v239, s[8:11], s28 offen offset:1024 lds
fz_nox:
    buffer_load_dword v250, off, s[4:7], 0
    s_andn2_b32 s32, s57, s59
    s_cbranch_scc0 fz_nowe
    buffer_load_dwordx4 v[160:163], v14, s[64:67], s62 offen offset:0 nt
    buffer_load_dwordx4 v[164:167], v14, s[64:67], s62 offen offset:256 nt
    s_add_u32 s62, s62, 8192
    buffer_load_dwordx4 v[168:171], v14, s[64:67], s62 offen offset:0 nt
    buffer_load_dwordx4 v[172:175], v14, s[64:67], s62 offen offset:256 nt
    s_add_u32 s62, s62, 8192
fz_nowe:
    s_cmp_eq_u32 s57, 0
    s_cbranch_scc1 fz_np
    s_setprio 1
fz_np:
    v_and_b32 v2, 31, v1
    v_lshrrev_b32 v3, 5, v1
    v_and_b32 v4, 15, v1
    v_lshrrev_b32 v5, 4, v1
    v_add_u32 v6, 49536, v239
    v_lshrrev_b32 v10, 1, v2
    v_and_b32 v8, 9, v10
    v_and_b32 v11, 2, v10
    v_lshl_or_b32 v8, v11, 1, v8
    v_bfe_u32 v11, v10, 2, 1
    v_lshl_or_b32 v8, v11, 1, v8
    v_and_b32 v12, 1, v5
    v_cmp_eq_u32 vcc, 1, v12
    v_lshl_add_u32 v9, v4, 1, 1
    s_nop 0
    v_cndmask_b32_e64 v9, v9, 0, vcc
    s_cmp_lt_u32 s3, 5
    s_cselect_b64 s[32:33], -1, 0
    s_cmp_lt_u32 s3, 3
    s_cselect_b64 s[34:35], -1, 0
    v_cndmask_b32_e64 v9, v9, v2, s[32:33]
    v_cndmask_b32_e64 v8, v9, v8, s[34:35]
    s_mov_b32 s36, 0x3d000000
    s_cmp_gt_u32 s3, 4
    s_cselect_b32 s36, 0x3c800000, s36
    s_sub_u32 s37, s3, 1
    s_cmp_lt_u32 s37, 2
    s_cselect_b32 s36, 0x3a800000, s36
    s_cmp_eq_u32 s3, 0
    s_cselect_b32 s32, 16, 0
    s_cselect_b32 s33, 0x3e800000, 0
    s_cselect_b32 s34, 4.0, 0x41000000
    s_cselect_b32 s35, 0x41000000, 4.0
    v_cmp_eq_u32 vcc, 1, v2
    v_mov_b32 v10, s32
    s_nop 0
    v_cndmask_b32_e64 v10, 0, v10, vcc
    v_add_u32 v8, v8, v10
    v_cvt_f32_u32 v8, v8
    v_mul_f32 v8, s36, v8
    s_cmp_eq_u32 s3, 2
    s_cselect_b32 s32, 0x80000000, 0
    v_lshlrev_b32 v10, 31, v2
    v_and_b32 v10, s32, v10
    v_xor_b32 v8, v10, v8
    v_and_b32 v10, 1, v2
    v_cvt_f32_u32 v10, v10
    v_mul_f32 v10, s33, v10
    s_cmp_eq_u32 s3, 1
    s_cselect_b32 s33, 0x3e800000, 0
    v_mov_b32 v11, s33
    v_cndmask_b32_e64 v10, v10, v11, vcc
    s_cmp_eq_u32 s3, 5
    s_cselect_b32 s33, 0x3e800000, 0
    v_cvt_f32_u32 v12, v12
    v_fma_f32 v10, v12, s33, v10
    s_cmp_eq_u32 s3, 6
    s_cselect_b32 s33, 0x3e800000, 0
    s_cmp_eq_u32 s3, 2
    s_cselect_b32 s33, 0xbe800000, s33
    s_cmp_eq_u32 s3, 4
    s_cselect_b32 s33, 0xbe800000, s33
    v_add_f32 v10, s33, v10
    v_cvt_f32_u32 v11, v3
    v_mul_f32 v11, s35, v11
    v_fma_f32 v9, v8, v11, v10
    v_mul_f32 v10, s34, v8
    v_mul_f32 v11, 0x41800000, v8
    v_mov_b32 v104, v9
    v_fmamk_f32 v105, v8, 0x3f800000, v9
    v_fmamk_f32 v106, v8, 0x40000000, v9
    v_fmamk_f32 v107, v8, 0x40400000, v9
    v_add_f32 v108, v104, v10
    v_add_f32 v109, v105, v10
    v_add_f32 v110, v106, v10
    v_add_f32 v111, v107, v10
    v_add_f32 v112, v104, v11
    v_add_f32 v113, v105, v11
    v_add_f32 v114, v106, v11
    v_add_f32 v115, v107, v11
    v_add_f32 v116, v108, v11
    v_add_f32 v117, v109, v11
    v_add_f32 v118, v110, v11
    v_add_f32 v119, v111, v11
    v_cos_f32 v104, v104
    v_cos_f32 v105, v105
    v_cos_f32 v106, v106
    v_cos_f32 v107, v107
    v_cos_f32 v108, v108
    v_cos_f32 v109, v109
    v_cos_f32 v110, v110
    v_cos_f32 v111, v111
    v_cos_f32 v112, v112
    v_cos_f32 v113, v113
    v_cos_f32 v114, v114
    v_cos_f32 v115, v115
    v_cos_f32 v116, v116
    v_cos_f32 v117, v117
    v_cos_f32 v118, v118
    v_cos_f32 v119, v119
    s_lshl_b32 s32, s3, 11
    v_add_u32 v8, s32, v6
    s_cmp_eq_u32 s3, 0
    s_cbranch_scc1 fz_jb
    v_cvt_pk_f16_f32 v128, v104, v105
    v_cvt_pk_f16_f32 v129, v106, v107
    v_cvt_pk_f16_f32 v130, v108, v109
    v_cvt_pk_f16_f32 v131, v110, v111
    v_cvt_pk_f16_f32 v132, v112, v113
    v_cvt_pk_f16_f32 v133, v114, v115
    v_cvt_pk_f16_f32 v134, v116, v117
    v_cvt_pk_f16_f32 v135, v118, v119
fz_jend:
    ds_write_b128 v8, v[128:131] offset:0
    ds_write_b128 v8, v[132:135] offset:1024
    v_mov_b32 v15, 49520
    v_mov_b32 v10, 0
    ds_write_b32 v15, v10
    s_waitcnt lgkmcnt(0)
    s_barrier
    v_lshlrev_b32 v240, 31, v1
    v_lshrrev_b32 v10, 16, v240
    v_or_b32 v240, v240, v10
    v_mov_b32 v229, 0xfffcfffc
    v_mov_b32 v242, 0xffff0000
    s_mov_b32 s42, 0x3f803f80
    s_cmp_lg_u32 s57, 0
    s_cbranch_scc1 fz_nc1
    ds_read_b128 v[16:19], v6 offset:0
    ds_read_b128 v[20:23], v6 offset:1024
    ds_read_b128 v[24:27], v6 offset:2048
    ds_read_b128 v[28:31], v6 offset:3072
    ds_read_b128 v[32:35], v6 offset:4096
    ds_read_b128 v[36:39], v6 offset:5120
    ds_read_b128 v[40:43], v6 offset:6144
    ds_read_b128 v[44:47], v6 offset:7168
    ds_read_b128 v[48:51], v6 offset:8192
    ds_read_b128 v[52:55], v6 offset:9216
    ds_read_b128 v[56:59], v6 offset:10240
    ds_read_b128 v[60:63], v6 offset:11264
    ds_read_b128 v[64:67], v6 offset:12288
    ds_read_b128 v[68:71], v6 offset:13312
    v_lshlrev_b32 v7, 9, v3
    v_bfe_u32 v10, v1, 2, 2
    v_lshl_add_u32 v7, v10, 6, v7
    v_and_b32 v10, 1, v5
    v_lshl_add_u32 v7, v10, 5, v7
    v_and_b32 v10, 3, v1
    v_lshl_add_u32 v7, v10, 3, v7
    v_add_u32 v7, s31, v7
    v_lshlrev_b32 v8, 9, v3
    v_lshl_add_u32 v8, v2, 1, v8
    v_sub_u32 v9, 2048, v8
    v_and_b32 v9, 2047, v9
    v_add_u32 v9, s30, v9
    s_add_u32 s32, s30, 576
    v_sub_u32 v8, s32, v8
    v_cmp_eq_u32 vcc, 0, v2
    s_nop 1
    v_cndmask_b32_e64 v234, 0, -2.0, vcc
    v_mov_b32 v235, 0x3b27c5ac
    s_lshr_b32 s32, s24, 1
    s_lshl_b32 s32, s32, 6
    s_mul_i32 s33, s3, 2304
    s_add_u32 s32, s32, s33
    s_add_u32 s32, s32, 67968
    v_lshl_add_u32 v10, v3, 1, v1
    v_lshlrev_b32 v10, 4, v10
    v_add_u32 v216, s32, v10
    v_bfe_u32 v10, v0, 2, 1
    v_mul_u32_u24 v10, 34, v10
    v_lshrrev_b32 v11, 4, v0
    v_add_u32 v10, v10, v11
    v_lshlrev_b32 v10, 4, v10
    v_bfe_u32 v11, v0, 3, 1
    v_lshl_add_u32 v10, v11, 3, v10
    v_bfe_u32 v11, v0, 1, 1
    v_lshl_add_u32 v10, v11, 2, v10
    v_and_b32 v12, 1, v0
    s_mov_b32 s33, 9216
    s_cmp_eq_u32 s2, 66
    s_cselect_b32 s32, s33, 0x1b40
    v_mul_lo_u32 v11, v12, s32
    v_add_u32 v217, v10, v11
    v_add_u32 v217, 67968, v217
    s_cselect_b32 s32, s33, 0x940
    v_mul_lo_u32 v11, v12, s32
    v_add_u32 v218, v10, v11
    v_add_u32 v218, 70272, v218
    s_cselect_b32 s32, s33, 0xfffff6c0
    v_mul_lo_u32 v11, v12, s32
    v_add_u32 v219, v10, v11
    v_add_u32 v219, 73792, v219
    s_cselect_b32 s32, s33, 0xffffe4c0
    v_mul_lo_u32 v11, v12, s32
    v_add_u32 v220, v10, v11
    v_add_u32 v220, 76096, v220
    v_lshrrev_b32 v10, 2, v0
    v_and_b32 v11, 3, v0
    v_lshlrev_b32 v11, 4, v11
    v_lshl_add_u32 v221, v10, 7, v11
    s_mul_i32 s52, s20, 16512
    s_lshl_b32 s33, s59, 6
    s_add_u32 s52, s52, s33
    s_add_u32 s52, s52, 0x1000
    s_add_u32 s53, s52, 8192
    v_mov_b32 v160, 0
    v_mov_b32 v161, 0
    v_mov_b32 v162, 0
    v_mov_b32 v163, 0
    s_setprio 3
    s_waitcnt vmcnt(0) lgkmcnt(0)
    ds_read_b64_tr_b16 v[88:89], v7 offset:0
    ds_read_b64_tr_b16 v[90:91], v7 offset:256
    ds_read_b64_tr_b16 v[92:93], v7 offset:1024
    ds_read_b64_tr_b16 v[94:95], v7 offset:1280
    ds_read_u16_d16 v96, v9
    ds_read_u16_d16_hi v136, v8 offset:1408
    ds_read_u16_d16 v97, v8 offset:1344
    ds_read_u16_d16_hi v137, v8 offset:1280
    ds_read_u16_d16 v98, v8 offset:1216
    ds_read_u16_d16_hi v138, v8 offset:1152
    ds_read_u16_d16 v99, v8 offset:1088
    ds_read_u16_d16_hi v139, v8 offset:1024
    s_waitcnt lgkmcnt(8)
    v_mfma_f32_32x32x16_bf16 v[104:119], v[88:91], v[16:19], 0
    v_mfma_f32_32x32x16_bf16 v[104:119], v[92:95], v[20:23], v[104:119]
    ds_read_u16_d16 v100, v8 offset:448
    ds_read_u16_d16_hi v140, v8 offset:384
    ds_read_u16_d16 v101, v8 offset:320
    ds_read_u16_d16_hi v141, v8 offset:256
    ds_read_u16_d16 v102, v8 offset:192
    ds_read_u16_d16_hi v142, v8 offset:128
    ds_read_u16_d16 v103, v8 offset:64
    ds_read_u16_d16_hi v143, v8 offset:0
    v_dot2_f32_bf16 v160, v88, s42, v160
    v_dot2_f32_bf16 v161, v88, v88, v161
    v_dot2_f32_bf16 v160, v89, s42, v160
    v_dot2_f32_bf16 v161, v89, v89, v161
    v_dot2_f32_bf16 v160, v90, s42, v160
    v_dot2_f32_bf16 v161, v90, v90, v161
    v_dot2_f32_bf16 v160, v91, s42, v160
    v_dot2_f32_bf16 v161, v91, v91, v161
    v_dot2_f32_bf16 v160, v92, s42, v160
    v_dot2_f32_bf16 v161, v92, v92, v161
    v_dot2_f32_bf16 v160, v93, s42, v160
    v_dot2_f32_bf16 v161, v93, v93, v161
    v_dot2_f32_bf16 v160, v94, s42, v160
    v_dot2_f32_bf16 v161, v94, v94, v161
    v_dot2_f32_bf16 v160, v95, s42, v160
    v_dot2_f32_bf16 v161, v95, v95, v161
    s_waitcnt lgkmcnt(0)
    v_or_b32 v96, v96, v136
    v_or_b32 v97, v97, v137
    v_or_b32 v98, v98, v138
    v_or_b32 v99, v99, v139
    v_or_b32 v100, v100, v140
    v_or_b32 v101, v101, v141
    v_or_b32 v102, v102, v142
    v_or_b32 v103, v103, v143
    v_mfma_f32_32x32x16_bf16 v[120:135], v[96:99], v[16:19], 0
    s_nop 0
    v_mfma_f32_32x32x16_bf16 v[120:135], v[100:103], v[20:23], v[120:135]
    v_dot2_f32_bf16 v162, v96, s42, v162
    v_dot2_f32_bf16 v163, v96, v96, v163
    v_dot2_f32_bf16 v162, v97, s42, v162
    v_dot2_f32_bf16 v163, v97, v97, v163
    v_dot2_f32_bf16 v162, v98, s42, v162
    v_dot2_f32_bf16 v163, v98, v98, v163
    v_dot2_f32_bf16 v162, v99, s42, v162
    v_dot2_f32_bf16 v163, v99, v99, v163
    v_dot2_f32_bf16 v162, v100, s42, v162
    v_dot2_f32_bf16 v163, v100, v100, v163
    v_dot2_f32_bf16 v162, v101, s42, v162
    v_dot2_f32_bf16 v163, v101, v101, v163
    v_dot2_f32_bf16 v162, v102, s42, v162
    v_dot2_f32_bf16 v163, v102, v102, v163
    v_dot2_f32_bf16 v162, v103, s42, v162
    v_dot2_f32_bf16 v163, v103, v103, v163
    s_nop 1
    v_permlane32_swap_b32 v160, v162
    v_permlane32_swap_b32 v161, v163
    v_add_f32 v160, v160, v162
    v_add_f32 v161, v161, v163
    s_nop 1
    v_permlane16_swap_b32 v160, v161
    v_add_f32 v160, v160, v161
    s_nop 1
    v_add_f32_dpp v160, v160, v160 quad_perm:[1,0,3,2] row_mask:0xf bank_mask:0xf
    s_nop 1
    v_add_f32_dpp v160, v160, v160 quad_perm:[2,3,0,1] row_mask:0xf bank_mask:0xf
    s_nop 1
    v_add_f32_dpp v160, v160, v160 row_half_mirror row_mask:0xf bank_mask:0xf
    s_nop 1
    v_add_f32_dpp v160, v160, v160 row_mirror row_mask:0xf bank_mask:0xf
    s_mov_b32 s43, 0x3e800000
    v_mov_b32 v161, v160
    s_nop 1
    v_permlane16_swap_b32 v160, v161
    v_mul_f32 v160, 0x3c800000, v160
    v_fma_f32 v161, v161, s43, v235
    v_fma_f32 v161, -v160, v160, v161
    v_rsq_f32 v161, v161
    s_nop 0
    v_mul_f32 v160, v160, v161
    v_readlane_b32 s32, v161, 0
    v_readlane_b32 s34, v161, 32
    v_readlane_b32 s36, v160, 0
    v_readlane_b32 s37, v160, 32
    s_nop 0
    v_mul_f32 v164, s36, v234
    v_fmac_f32 v164, s37, v234
    v_pk_fma_f32 v[104:105], v[104:105], s[32:33], v[164:165] op_sel_hi:[1,0,0]
    v_pk_fma_f32 v[106:107], v[106:107], s[32:33], v[164:165] op_sel_hi:[1,0,0]
    v_pk_fma_f32 v[108:109], v[108:109], s[32:33], v[164:165] op_sel_hi:[1,0,0]
    v_pk_fma_f32 v[110:111], v[110:111], s[32:33], v[164:165] op_sel_hi:[1,0,0]
    v_pk_fma_f32 v[112:113], v[112:113], s[32:33], v[164:165] op_sel_hi:[1,0,0]
    v_pk_fma_f32 v[114:115], v[114:115], s[32:33], v[164:165] op_sel_hi:[1,0,0]
    v_pk_fma_f32 v[116:117], v[116:117], s[32:33], v[164:165] op_sel_hi:[1,0,0]
    v_pk_fma_f32 v[118:119], v[118:119], s[32:33], v[164:165] op_sel_hi:[1,0,0]
    v_pk_fma_f32 v[104:105], v[120:121], s[34:35], v[104:105] op_sel_hi:[1,0,1]
    v_pk_fma_f32 v[106:107], v[122:123], s[34:35], v[106:107] op_sel_hi:[1,0,1]
    v_pk_fma_f32 v[108:109], v[124:125], s[34:35], v[108:109] op_sel_hi:[1,0,1]
    v_pk_fma_f32 v[110:111], v[126:127], s[34:35], v[110:111] op_sel_hi:[1,0,1]
    v_pk_fma_f32 v[112:113], v[128:129], s[34:35], v[112:113] op_sel_hi:[1,0,1]
    v_pk_fma_f32 v[114:115], v[130:131], s[34:35], v[114:115] op_sel_hi:[1,0,1]
    v_pk_fma_f32 v[116:117], v[132:133], s[34:35], v[116:117] op_sel_hi:[1,0,1]
    v_pk_fma_f32 v[118:119], v[134:135], s[34:35], v[118:119] op_sel_hi:[1,0,1]
    v_cvt_pk_f16_f32 v136, v104, v105
    v_cvt_pk_f16_f32 v137, v106, v107
    v_cvt_pk_f16_f32 v138, v108, v109
    v_cvt_pk_f16_f32 v139, v110, v111
    v_cvt_pk_f16_f32 v140, v112, v113
    v_cvt_pk_f16_f32 v141, v114, v115
    v_cvt_pk_f16_f32 v142, v116, v117
    v_cvt_pk_f16_f32 v143, v118, v119
    v_mov_b32_dpp v152, v136 quad_perm:[1,0,3,2] row_mask:0xf bank_mask:0xf
    v_mov_b32_dpp v153, v137 quad_perm:[1,0,3,2] row_mask:0xf bank_mask:0xf
    v_mov_b32_dpp v154, v138 quad_perm:[1,0,3,2] row_mask:0xf bank_mask:0xf
    v_mov_b32_dpp v155, v139 quad_perm:[1,0,3,2] row_mask:0xf bank_mask:0xf
    v_mov_b32_dpp v156, v140 quad_perm:[1,0,3,2] row_mask:0xf bank_mask:0xf
    v_mov_b32_dpp v157, v141 quad_perm:[1,0,3,2] row_mask:0xf bank_mask:0xf
    v_mov_b32_dpp v158, v142 quad_perm:[1,0,3,2] row_mask:0xf bank_mask:0xf
    v_mov_b32_dpp v159, v143 quad_perm:[1,0,3,2] row_mask:0xf bank_mask:0xf
    v_pk_mul_f16 v144, v136, v24
    v_pk_mul_f16 v145, v137, v25
    v_pk_mul_f16 v146, v138, v26
    v_pk_mul_f16 v147, v139, v27
    v_pk_mul_f16 v148, v140, v28
    v_pk_mul_f16 v149, v141, v29
    v_pk_mul_f16 v150, v142, v30
    v_pk_mul_f16 v151, v143, v31
    v_mfma_f32_16x16x32_f16 v[120:123], v[136:139], v[56:59], 0
    v_pk_fma_f16 v144, v152, v32, v144
    v_pk_fma_f16 v145, v153, v33, v145
    v_pk_fma_f16 v146, v154, v34, v146
    v_pk_fma_f16 v147, v155, v35, v147
    v_mfma_f32_16x16x32_f16 v[120:123], v[140:143], v[60:63], v[120:123]
    v_pk_fma_f16 v148, v156, v36, v148
    v_pk_fma_f16 v149, v157, v37, v149
    v_pk_fma_f16 v150, v158, v38, v150
    v_pk_fma_f16 v151, v159, v39, v151
    v_mfma_f32_32x32x16_f16 v[104:119], v[144:147], v[40:43], 0
    v_xor_b32_dpp v152, v144, v240 quad_perm:[1,0,3,2] row_mask:0xf bank_mask:0xf
    v_xor_b32_dpp v153, v145, v240 quad_perm:[1,0,3,2] row_mask:0xf bank_mask:0xf
    v_xor_b32_dpp v154, v146, v240 quad_perm:[1,0,3,2] row_mask:0xf bank_mask:0xf
    v_xor_b32_dpp v155, v147, v240 quad_perm:[1,0,3,2] row_mask:0xf bank_mask:0xf
    v_mfma_f32_32x32x16_f16 v[104:119], v[148:151], v[44:47], v[104:119]
    v_xor_b32_dpp v156, v148, v240 quad_perm:[1,0,3,2] row_mask:0xf bank_mask:0xf
    v_xor_b32_dpp v157, v149, v240 quad_perm:[1,0,3,2] row_mask:0xf bank_mask:0xf
    v_xor_b32_dpp v158, v150, v240 quad_perm:[1,0,3,2] row_mask:0xf bank_mask:0xf
    v_xor_b32_dpp v159, v151, v240 quad_perm:[1,0,3,2] row_mask:0xf bank_mask:0xf
    v_mfma_f32_32x32x16_f16 v[104:119], v[152:155], v[48:51], v[104:119]
    s_nop 0
    v_mfma_f32_32x32x16_f16 v[104:119], v[156:159], v[52:55], v[104:119]
    v_mfma_f32_16x16x32_f16 v[124:127], v[136:139], v[64:67], 0
    v_mfma_f32_16x16x32_f16 v[124:127], v[140:143], v[68:71], v[124:127]
    v_readfirstlane_b32 s40, v250
    s_nop 1
    s_add_u32 s40, s40, 1
    s_and_b32 s38, s40, 3
    s_and_b32 s39, s40, 15
    s_bfe_u32 s41, s40, 0x20002
    s_lshl_b32 s41, s41, 16
    s_or_b32 s44, s38, s41
    s_bfe_u32 s41, s40, 0x40004
    s_lshl_b32 s41, s41, 4
    s_or_b32 s48, s39, s41
    s_bfe_u32 s41, s40, 0x20004
    s_lshl_b32 s41, s41, 16
    s_or_b32 s45, s38, s41
    s_bfe_u32 s41, s40, 0x40008
    s_lshl_b32 s41, s41, 4
    s_or_b32 s49, s39, s41
    s_bfe_u32 s41, s40, 0x20006
    s_lshl_b32 s41, s41, 16
    s_or_b32 s46, s38, s41
    s_bfe_u32 s41, s40, 0x4000c
    s_lshl_b32 s41, s41, 4
    s_or_b32 s50, s39, s41
    s_bfe_u32 s41, s40, 0x20008
    s_lshl_b32 s41, s41, 16
    s_or_b32 s47, s38, s41
    s_bfe_u32 s41, s40, 0x40010
    s_lshl_b32 s41, s41, 4
    s_or_b32 s51, s39, s41
    s_mov_b32 s38, 0x404
    s_cmp_eq_u32 s2, 66
    s_cselect_b32 s39, 8, 4
    s_cselect_b32 s38, 8, s38
    s_mov_b64 vcc, 0xffff
    v_cvt_pk_f16_f32 v143, v118, v119
    v_cvt_pk_f16_f32 v142, v116, v117
    v_cvt_pk_f16_f32 v141, v114, v115
    v_cvt_pk_f16_f32 v140, v112, v113
    v_cvt_pk_f16_f32 v139, v110, v111
    v_cvt_pk_f16_f32 v138, v108, v109
    v_cvt_pk_f16_f32 v137, v106, v107
    v_cndmask_b32_e64 v104, v104, v121, vcc
    v_cndmask_b32_e64 v105, v105, v125, vcc
    v_pk_add_f16 v147, v142, v143 op_sel:[0,1] op_sel_hi:[1,0] neg_lo:[0,1]
    v_pk_add_f16 v151, v142, v143 op_sel:[0,1] op_sel_hi:[1,0] neg_hi:[1,0]
    v_pk_add_f16 v146, v140, v141 op_sel:[0,1] op_sel_hi:[1,0] neg_lo:[0,1]
    v_pk_add_f16 v150, v140, v141 op_sel:[0,1] op_sel_hi:[1,0] neg_hi:[1,0]
    v_pk_add_f16 v145, v138, v139 op_sel:[0,1] op_sel_hi:[1,0] neg_lo:[0,1]
    v_pk_add_f16 v149, v138, v139 op_sel:[0,1] op_sel_hi:[1,0] neg_hi:[1,0]
    v_cvt_pk_f16_f32 v136, v104, v105
    v_pk_add_f16 v144, v136, v137 op_sel:[0,1] op_sel_hi:[1,0] neg_lo:[0,1]
    v_pk_add_f16 v148, v136, v137 op_sel:[0,1] op_sel_hi:[1,0] neg_hi:[1,0]
    ds_write_b128 v216, v[144:147]
    ds_write_b128 v216, v[148:151] offset:1152
    s_waitcnt lgkmcnt(0)
    v_mov_b32 v10, 1
    s_mov_b64 exec, 1
    ds_add_u32 v15, v10
    s_mov_b64 exec, -1
    s_cmp_gt_u32 s3, 3
    s_cbranch_scc1 fz_bsp0
fz_sy:
    ds_read_b32 v10, v15
    s_waitcnt lgkmcnt(0)
    v_and_b32 v10, 0xff, v10
    v_cmp_ne_u32 vcc, s39, v10
    s_cbranch_vccnz fz_sy
    ds_read_b32 v104, v217 offset:0
    ds_read_b32 v105, v218 offset:0
    ds_read_b32 v106, v219 offset:0
    ds_read_b32 v107, v220 offset:0
    ds_read_b32 v108, v217 offset:256
    ds_read_b32 v109, v218 offset:256
    ds_read_b32 v110, v219 offset:256
    ds_read_b32 v111, v220 offset:256
    s_waitcnt lgkmcnt(4)
    v_pk_add_f16 v112, v104, v106
    v_pk_add_f16 v114, v105, v107
    v_pk_add_f16 v113, v104, v106 neg_lo:[0,1] neg_hi:[0,1]
    v_pk_add_f16 v115, v105, v107 neg_lo:[0,1] neg_hi:[0,1]
    v_pk_add_f16 v116, v112, v114
    v_pk_add_f16 v118, v112, v114 neg_lo:[0,1] neg_hi:[0,1]
    v_pk_add_f16 v117, v113, v115 op_sel:[0,1] op_sel_hi:[1,0] neg_hi:[0,1]
    v_pk_add_f16 v119, v113, v115 op_sel:[0,1] op_sel_hi:[1,0] neg_lo:[0,1]
    v_add_u32 v116, 0x20002, v116
    v_add_u32 v117, 0x20002, v117
    v_add_u32 v118, 0x20002, v118
    v_add_u32 v119, 0x20002, v119
    v_and_or_b32 v116, v116, v229, s44
    v_and_or_b32 v117, v117, v229, s45
    v_and_or_b32 v118, v118, v229, s46
    v_and_or_b32 v119, v119, v229, s47
    buffer_store_dwordx4 v[116:119], v221, s[4:7], s52 offen sc1
    s_waitcnt lgkmcnt(0)
    v_pk_add_f16 v120, v108, v110
    v_pk_add_f16 v122, v109, v111
    v_pk_add_f16 v121, v108, v110 neg_lo:[0,1] neg_hi:[0,1]
    v_pk_add_f16 v123, v109, v111 neg_lo:[0,1] neg_hi:[0,1]
    v_pk_add_f16 v124, v120, v122
    v_pk_add_f16 v126, v120, v122 neg_lo:[0,1] neg_hi:[0,1]
    v_pk_add_f16 v125, v121, v123 op_sel:[0,1] op_sel_hi:[1,0] neg_hi:[0,1]
    v_pk_add_f16 v127, v121, v123 op_sel:[0,1] op_sel_hi:[1,0] neg_lo:[0,1]
    v_add_u32 v124, 0x20002, v124
    v_add_u32 v125, 0x20002, v125
    v_add_u32 v126, 0x20002, v126
    v_add_u32 v127, 0x20002, v127
    v_and_or_b32 v124, v124, v229, s44
    v_and_or_b32 v125, v125, v229, s45
    v_and_or_b32 v126, v126, v229, s46
    v_and_or_b32 v127, v127, v229, s47
    buffer_store_dwordx4 v[124:127], v221, s[4:7], s53 offen sc1
    s_cmp_lg_u32 s59, 0
    s_cbranch_scc1 ffn
    s_and_b32 s32, s3, 3
    s_lshr_b32 s33, s3, 2
    s_lshl_b32 s33, s33, 4
    s_add_u32 s33, s33, s32
    v_and_b32 v8, 12, v4
    v_bfe_u32 v9, v4, 1, 1
    v_lshl_add_u32 v8, v9, 5, v8
    v_add_u32 v8, s33, v8
    v_cvt_f32_u32 v8, v8
    v_and_b32 v12, 1, v1
    v_cvt_f32_u32 v9, v12
    v_lshlrev_b32 v13, 2, v5
    v_cvt_f32_u32 v10, v13
    v_mul_f32 v11, 0x3c800000, v8
    v_mul_f32 v9, 0x3e800000, v9
    v_fma_f32 v9, v11, v10, v9
    v_mov_b32 v128, v9
    v_fmamk_f32 v129, v11, 0x3f800000, v9
    v_fmamk_f32 v130, v11, 0x40000000, v9
    v_fmamk_f32 v131, v11, 0x40400000, v9
    v_mul_f32 v11, 0x3a000000, v8
    v_lshlrev_b32 v9, 31, v1
    v_xor_b32 v11, v9, v11
    v_mul_f32 v9, v11, v10
    v_mov_b32 v112, v9
    v_fmamk_f32 v113, v11, 0x3f800000, v9
    v_fmamk_f32 v114, v11, 0x40000000, v9
    v_fmamk_f32 v115, v11, 0x40400000, v9
    v_fmamk_f32 v116, v11, 0x41800000, v9
    v_fmamk_f32 v117, v11, 0x41880000, v9
    v_fmamk_f32 v118, v11, 0x41900000, v9
    v_fmamk_f32 v119, v11, 0x41980000, v9
    v_cos_f32 v104, v128
    v_sin_f32 v105, v128
    v_cos_f32 v106, v129
    v_sin_f32 v107, v129
    v_cos_f32 v108, v130
    v_sin_f32 v109, v130
    v_cos_f32 v110, v131
    v_sin_f32 v111, v131
    v_sin_f32 v120, v112
    v_sin_f32 v121, v113
    v_sin_f32 v122, v114
    v_sin_f32 v123, v115
    v_sin_f32 v124, v116
    v_sin_f32 v125, v117
    v_sin_f32 v126, v118
    v_sin_f32 v127, v119
    v_cos_f32 v112, v112
    v_cos_f32 v113, v113
    v_cos_f32 v114, v114
    v_cos_f32 v115, v115
    v_cos_f32 v116, v116
    v_cos_f32 v117, v117
    v_cos_f32 v118, v118
    v_cos_f32 v119, v119
    v_cvt_pk_f16_f32 v16, v104, v105
    v_cvt_pk_f16_f32 v17, v106, v107
    v_cvt_pk_f16_f32 v18, v108, v109
    v_cvt_pk_f16_f32 v19, v110, v111
    v_cvt_pk_f16_f32 v20, v112, v113
    v_cvt_pk_f16_f32 v21, v114, v115
    v_cvt_pk_f16_f32 v22, v116, v117
    v_cvt_pk_f16_f32 v23, v118, v119
    v_cvt_pk_f16_f32 v24, v120, v121
    v_cvt_pk_f16_f32 v25, v122, v123
    v_cvt_pk_f16_f32 v26, v124, v125
    v_cvt_pk_f16_f32 v27, v126, v127
    v_lshrrev_b32 v8, 3, v1
    v_mul_u32_u24 v222, 16512, v8
    v_and_b32 v9, 7, v1
    v_lshl_add_u32 v222, v9, 4, v222
    s_mul_i32 s60, s3, 528384
    s_lshl_b32 s32, s20, 7
    s_add_u32 s60, s60, s32
    s_add_u32 s60, s60, 0x1000
    s_add_u32 s61, s60, 132096
    s_add_u32 s16, s60, 264192
    s_add_u32 s17, s60, 396288
    v_lshlrev_b32 v8, 1, v8
    v_bfe_u32 v9, v1, 2, 1
    v_add_u32 v8, v8, v9
    s_lshl_b32 s32, s3, 2
    s_add_u32 s32, s32, 1
    v_lshl_add_u32 v8, v8, 5, s32
    v_cmp_eq_u32 vcc, 1, v12
    v_bfe_u32 v9, v1, 1, 1
    v_mul_u32_u24 v9, 8256, v9
    v_add_u32 v9, 86400, v9
    s_cmp_eq_u32 s3, 3
    s_cselect_b32 s32, 272, 0
    v_sub_u32 v10, 512, v8
    v_cndmask_b32_e64 v10, v8, v10, vcc
    v_and_b32 v11, 16, v10
    v_lshl_add_u32 v11, v11, 6, v9
    v_lshrrev_b32 v12, 7, v10
    v_lshl_add_u32 v11, v12, 8, v11
    v_and_b32 v12, 15, v10
    v_lshl_add_u32 v11, v12, 4, v11
    v_bfe_u32 v12, v10, 5, 2
    v_lshl_add_u32 v223, v12, 2, v11
    v_add_u32 v8, 1, v8
    v_sub_u32 v10, 512, v8
    v_cndmask_b32_e64 v10, v8, v10, vcc
    v_and_b32 v11, 16, v10
    v_lshl_add_u32 v11, v11, 6, v9
    v_lshrrev_b32 v12, 7, v10
    v_lshl_add_u32 v11, v12, 8, v11
    v_and_b32 v12, 15, v10
    v_lshl_add_u32 v11, v12, 4, v11
    v_bfe_u32 v12, v10, 5, 2
    v_lshl_add_u32 v224, v12, 2, v11
    v_add_u32 v8, 1, v8
    v_sub_u32 v10, 512, v8
    v_cndmask_b32_e64 v10, v8, v10, vcc
    v_and_b32 v11, 16, v10
    v_lshl_add_u32 v11, v11, 6, v9
    v_lshrrev_b32 v12, 7, v10
    v_lshl_add_u32 v11, v12, 8, v11
    v_and_b32 v12, 15, v10
    v_lshl_add_u32 v11, v12, 4, v11
    v_bfe_u32 v12, v10, 5, 2
    v_lshl_add_u32 v100, v12, 2, v11
    v_mul_u32_u24 v10, s32, v3
    v_sub_u32 v8, v8, v10
    v_add_u32 v8, 1, v8
    v_sub_u32 v10, 512, v8
    v_cndmask_b32_e64 v10, v8, v10, vcc
    v_lshrrev_b32 v11, 1, v10
    v_and_b32 v11, 256, v11
    v_sub_u32 v10, v10, v11
    v_and_b32 v11, 16, v10
    v_lshl_add_u32 v11, v11, 6, v9
    v_lshrrev_b32 v12, 7, v10
    v_lshl_add_u32 v11, v12, 8, v11
    v_and_b32 v12, 15, v10
    v_lshl_add_u32 v11, v12, 4, v11
    v_bfe_u32 v12, v10, 5, 2
    v_lshl_add_u32 v101, v12, 2, v11
    s_and_b32 s32, s3, 3
    s_lshl_b32 s32, s32, 11
    s_add_u32 s32, s32, 86400
    v_add_u32 v225, s32, v239
    v_add_u32 v8, s33, v13
    v_sub_u32 v9, 32, v8
    v_min_u32 v9, v8, v9
    v_and_b32 v10, 15, v8
    v_cmp_eq_u32 s[32:33], 0, v10
    v_cmp_lt_u32 s[34:35], 16, v8
    v_lshlrev_b32 v10, 10, v9
    v_subrev_u32 v10, 1024, v10
    v_mov_b32 v11, 15872
    v_cmp_eq_u32 vcc, 0, v8
    s_nop 1
    v_cndmask_b32_e64 v10, v10, v11, vcc
    v_and_b32 v11, 3, v1
    v_lshl_add_u32 v10, v11, 4, v10
    v_lshrrev_b32 v11, 2, v4
    v_lshlrev_b32 v12, 7, v11
    v_sub_u32 v13, 960, v12
    v_cndmask_b32_e64 v13, v12, v13, s[34:35]
    v_add_u32 v226, v10, v13
    s_or_b64 s[34:35], s[34:35], s[32:33]
    v_add_u32 v12, 512, v12
    v_sub_u32 v13, 960, v12
    v_cndmask_b32_e64 v13, v12, v13, s[34:35]
    v_add_u32 v227, v10, v13
    s_mul_i32 s56, s20, 16512
    s_add_u32 s56, s56, 0x210000
    v_mov_b32 v249, 0x30003
    v_mov_b32 v252, s44
    v_mov_b32 v253, s45
    v_mov_b32 v254, s46
    v_mov_b32 v255, s47
    s_waitcnt lgkmcnt(0)
    s_waitcnt vmcnt(0)
    buffer_load_dwordx4 v[104:107], v222, s[4:7], s60 offen sc1
    buffer_load_dwordx4 v[108:111], v222, s[4:7], s61 offen sc1
    buffer_load_dwordx4 v[112:115], v222, s[4:7], s16 offen sc1
    buffer_load_dwordx4 v[116:119], v222, s[4:7], s17 offen sc1
fz_h1_c0:
    s_waitcnt vmcnt(3)
    v_xor_b32 v104, v252, v104
    v_xor_b32 v105, v253, v105
    v_xor_b32 v106, v254, v106
    v_xor_b32 v107, v255, v107
    v_or3_b32 v10, v104, v105, v106
    v_bitop3_b32 v10, v10, v107, v249 bitop3:0xa8
    v_cmp_ne_u32 vcc, 0, v10
    s_cbranch_vccnz fz_h1_r0
fz_h1_o0:
    ds_write_b32 v223, v104 offset:0
    ds_write_b32 v223, v105 offset:2048
    ds_write_b32 v223, v106 offset:4096
    ds_write_b32 v223, v107 offset:6144
fz_h1_c1:
    s_waitcnt vmcnt(2)
    v_xor_b32 v108, v252, v108
    v_xor_b32 v109, v253, v109
    v_xor_b32 v110, v254, v110
    v_xor_b32 v111, v255, v111
    v_or3_b32 v10, v108, v109, v110
    v_bitop3_b32 v10, v10, v111, v249 bitop3:0xa8
    v_cmp_ne_u32 vcc, 0, v10
    s_cbranch_vccnz fz_h1_r1
fz_h1_o1:
    ds_write_b32 v224, v108 offset:0
    ds_write_b32 v224, v109 offset:2048
    ds_write_b32 v224, v110 offset:4096
    ds_write_b32 v224, v111 offset:6144
fz_h1_c2:
    s_waitcnt vmcnt(1)
    v_xor_b32 v112, v252, v112
    v_xor_b32 v113, v253, v113
    v_xor_b32 v114, v254, v114
    v_xor_b32 v115, v255, v115
    v_or3_b32 v10, v112, v113, v114
    v_bitop3_b32 v10, v10, v115, v249 bitop3:0xa8
    v_cmp_ne_u32 vcc, 0, v10
    s_cbranch_vccnz fz_h1_r2
fz_h1_o2:
    ds_write_b32 v100, v112 offset:0
    ds_write_b32 v100, v113 offset:2048
    ds_write_b32 v100, v114 offset:4096
    ds_write_b32 v100, v115 offset:6144
fz_h1_c3:
    s_waitcnt vmcnt(0)
    v_xor_b32 v116, v252, v116
    v_xor_b32 v117, v253, v117
    v_xor_b32 v118, v254, v118
    v_xor_b32 v119, v255, v119
    v_or3_b32 v10, v116, v117, v118
    v_bitop3_b32 v10, v10, v119, v249 bitop3:0xa8
    v_cmp_ne_u32 vcc, 0, v10
    s_cbranch_vccnz fz_h1_r3
fz_h1_o3:
    ds_write_b32 v101, v116 offset:0
    ds_write_b32 v101, v117 offset:2048
    ds_write_b32 v101, v118 offset:4096
    ds_write_b32 v101, v119 offset:6144
    s_waitcnt lgkmcnt(0)
    s_setprio 0
fz_hb:
    s_barrier
    ds_read_b128 v[104:107], v225 offset:0
    ds_read_b128 v[108:111], v225 offset:1024
    ds_read_b128 v[112:115], v225 offset:8256
    ds_read_b128 v[116:119], v225 offset:9280
    ds_read_b128 v[72:75], v6 offset:14336
    ds_read_b128 v[76:79], v6 offset:15360
    ds_read_b128 v[80:83], v6 offset:16384
    ds_read_b128 v[84:87], v6 offset:17408
    s_waitcnt lgkmcnt(7)
    v_mfma_f32_16x16x32_f16 v[120:123], v[104:107], v[16:19], 0
    s_waitcnt lgkmcnt(6)
    v_mfma_f32_16x16x32_f16 v[124:127], v[108:111], v[16:19], 0
    s_waitcnt lgkmcnt(5)
    v_mfma_f32_16x16x32_f16 v[128:131], v[112:115], v[16:19], 0
    s_waitcnt lgkmcnt(4)
    v_mfma_f32_16x16x32_f16 v[132:135], v[116:119], v[16:19], 0
    s_waitcnt lgkmcnt(0)
    s_nop 0
    v_cvt_pk_f16_f32 v136, v120, v121
    v_cvt_pk_f16_f32 v137, v122, v123
    v_cvt_pk_f16_f32 v138, v124, v125
    v_cvt_pk_f16_f32 v139, v126, v127
    v_cvt_pk_f16_f32 v140, v128, v129
    v_cvt_pk_f16_f32 v141, v130, v131
    v_cvt_pk_f16_f32 v142, v132, v133
    v_cvt_pk_f16_f32 v143, v134, v135
    v_pk_mul_f16 v144, v136, v20
    v_pk_mul_f16 v145, v137, v21
    v_pk_mul_f16 v146, v138, v22
    v_pk_mul_f16 v147, v139, v23
    v_mov_b32_dpp v152, v136 quad_perm:[1,0,3,2] row_mask:0xf bank_mask:0xf
    v_mov_b32_dpp v153, v137 quad_perm:[1,0,3,2] row_mask:0xf bank_mask:0xf
    v_mov_b32_dpp v154, v138 quad_perm:[1,0,3,2] row_mask:0xf bank_mask:0xf
    v_mov_b32_dpp v155, v139 quad_perm:[1,0,3,2] row_mask:0xf bank_mask:0xf
    v_pk_fma_f16 v144, v152, v24, v144
    v_pk_fma_f16 v145, v153, v25, v145
    v_pk_fma_f16 v146, v154, v26, v146
    v_pk_fma_f16 v147, v155, v27, v147
    s_nop 1
    v_mfma_f32_16x16x32_f16 v[104:107], v[144:147], v[72:75], 0
    v_mfma_f32_16x16x32_f16 v[108:111], v[144:147], v[80:83], 0
    v_xor_b32_dpp v152, v144, v240 quad_perm:[1,0,3,2] row_mask:0xf bank_mask:0xf
    v_xor_b32_dpp v153, v145, v240 quad_perm:[1,0,3,2] row_mask:0xf bank_mask:0xf
    v_xor_b32_dpp v154, v146, v240 quad_perm:[1,0,3,2] row_mask:0xf bank_mask:0xf
    v_xor_b32_dpp v155, v147, v240 quad_perm:[1,0,3,2] row_mask:0xf bank_mask:0xf
    s_nop 1
    v_mfma_f32_16x16x32_f16 v[104:107], v[152:155], v[76:79], v[104:107]
    v_mfma_f32_16x16x32_f16 v[108:111], v[152:155], v[84:87], v[108:111]
    v_pk_mul_f16 v148, v140, v20
    v_pk_mul_f16 v149, v141, v21
    v_pk_mul_f16 v150, v142, v22
    v_pk_mul_f16 v151, v143, v23
    v_mov_b32_dpp v156, v140 quad_perm:[1,0,3,2] row_mask:0xf bank_mask:0xf
    v_mov_b32_dpp v157, v141 quad_perm:[1,0,3,2] row_mask:0xf bank_mask:0xf
    v_mov_b32_dpp v158, v142 quad_perm:[1,0,3,2] row_mask:0xf bank_mask:0xf
    v_mov_b32_dpp v159, v143 quad_perm:[1,0,3,2] row_mask:0xf bank_mask:0xf
    v_pk_fma_f16 v148, v156, v24, v148
    v_pk_fma_f16 v149, v157, v25, v149
    v_pk_fma_f16 v150, v158, v26, v150
    v_pk_fma_f16 v151, v159, v27, v151
    s_nop 1
    v_mfma_f32_16x16x32_f16 v[112:115], v[148:151], v[72:75], 0
    v_mfma_f32_16x16x32_f16 v[116:119], v[148:151], v[80:83], 0
    v_xor_b32_dpp v156, v148, v240 quad_perm:[1,0,3,2] row_mask:0xf bank_mask:0xf
    v_xor_b32_dpp v157, v149, v240 quad_perm:[1,0,3,2] row_mask:0xf bank_mask:0xf
    v_xor_b32_dpp v158, v150, v240 quad_perm:[1,0,3,2] row_mask:0xf bank_mask:0xf
    v_xor_b32_dpp v159, v151, v240 quad_perm:[1,0,3,2] row_mask:0xf bank_mask:0xf
    s_nop 1
    v_mfma_f32_16x16x32_f16 v[112:115], v[156:159], v[76:79], v[112:115]
    v_mfma_f32_16x16x32_f16 v[116:119], v[156:159], v[84:87], v[116:119]
    v_cvt_pk_f16_f32 v120, v104, v105
    v_cvt_pk_f16_f32 v122, v106, v107
    s_nop 4
    v_cvt_pk_f16_f32 v121, v112, v113
    v_cvt_pk_f16_f32 v123, v114, v115
    v_add_u32 v120, 0x20002, v120
    v_add_u32 v121, 0x20002, v121
    v_add_u32 v122, 0x20002, v122
    v_add_u32 v123, 0x20002, v123
    v_and_or_b32 v120, v120, v229, s44
    v_and_or_b32 v121, v121, v229, s45
    v_and_or_b32 v122, v122, v229, s46
    v_and_or_b32 v123, v123, v229, s47
    buffer_store_dwordx4 v[120:123], v226, s[4:7], s56 offen sc1
    v_cvt_pk_f16_f32 v124, v108, v109
    v_cvt_pk_f16_f32 v126, v110, v111
    v_cvt_pk_f16_f32 v125, v116, v117
    v_cvt_pk_f16_f32 v127, v118, v119
    v_add_u32 v124, 0x20002, v124
    v_add_u32 v125, 0x20002, v125
    v_add_u32 v126, 0x20002, v126
    v_add_u32 v127, 0x20002, v127
    v_and_or_b32 v124, v124, v229, s44
    v_and_or_b32 v125, v125, v229, s45
    v_and_or_b32 v126, v126, v229, s46
    v_and_or_b32 v127, v127, v229, s47
    buffer_store_dwordx4 v[124:127], v227, s[4:7], s56 offen sc1
    s_cmp_lg_u32 s57, 0
    s_cbranch_scc1 fz_nc3
    v_sub_u32 v8, 15, v4
    v_min_u32 v8, v4, v8
    v_and_b32 v9, 1, v8
    v_lshlrev_b32 v9, 5, v9
    v_lshrrev_b32 v10, 1, v8
    v_lshl_add_u32 v9, v10, 9, v9
    v_add_u32 v9, s25, v9
    v_sub_u32 v10, 2048, v9
    v_cmp_lt_u32 s[34:35], 7, v4
    s_nop 1
    v_cndmask_b32_e64 v230, v9, v10, s[34:35]
    v_mov_b32 v9, v4
    v_mov_b32 v10, s20
    s_cmp_lg_u32 s21, 0
    s_cbranch_scc0 fz_spec3a
fz_spec3backa:
    v_lshlrev_b32 v10, 7, v10
    v_lshl_add_u32 v10, v9, 3, v10
    v_mul_u32_u24 v11, 66048, v5
    v_add_u32 v228, v10, v11
    v_and_b32 v9, 1, v9
    v_cmp_eq_u32 vcc, 1, v9
    v_mov_b32 v9, s44
    v_mov_b32 v10, s46
    v_cndmask_b32_e64 v236, v9, v10, vcc
    v_mov_b32 v9, s45
    v_mov_b32 v10, s47
    v_cndmask_b32_e64 v237, v9, v10, vcc
    s_lshl_b32 s32, s3, 2
    v_add_u32 v8, s32, v5
    v_lshlrev_b32 v9, 6, v8
    v_cmp_gt_u32 vcc, 16, v8
    s_nop 1
    v_cndmask_b32_e64 v10, 0, 32, vcc
    v_add_u32 v10, v9, v10
    v_sub_u32 v11, 2048, v10
    v_cmp_eq_u32 vcc, 16, v8
    s_nop 1
    v_cndmask_b32_e64 v11, v11, 0, vcc
    v_mov_b32 v12, 0xffff0000
    v_cndmask_b32_e64 v238, -1, v12, vcc
    v_sub_u32 v12, 2018, v9
    v_mul_u32_u24 v13, 2064, v4
    v_add_u32 v231, v13, v9
    v_add_u32 v232, v13, v12
    v_add_u32 v233, v13, v10
    v_add_u32 v241, v13, v11
    s_lshl_b32 s32, s3, 8
    s_add_u32 s32, s32, 102912
    v_lshlrev_b32 v9, 4, v4
    v_add_u32 v10, s32, v9
    v_add_u32 v11, 107008, v239
    v_cmp_gt_u32 vcc, 16, v1
    s_nop 1
    v_cndmask_b32_e64 v243, v11, v10, vcc
    v_lshrrev_b32 v12, 2, v4
    v_cmp_eq_u32 vcc, v12, v5
    s_nop 1
    v_cndmask_b32_e64 v244, v11, v10, vcc
    v_lshrrev_b32 v12, 5, v1
    v_lshl_add_u32 v10, v12, 10, v9
    v_add_u32 v245, 102912, v10
    v_and_b32 v9, 1, v1
    v_cmp_eq_u32 s[28:29], 1, v9
    v_and_b32 v9, 2, v1
    v_cmp_eq_u32 s[30:31], 2, v9
    s_lshl_b32 s37, s3, 2
    v_add_u32 v9, s37, v5
    v_mul_u32_u24 v246, 2176, v9
    s_lshl_b32 s26, s20, 4
    s_add_u32 s26, s26, 0x580000
    v_lshlrev_b32 v247, 4, v5
    s_lshl_b32 s27, s20, 11
    s_lshl_b32 s37, s3, 8
    s_add_u32 s27, s27, s37
    s_add_u32 s27, s27, 0x448000
    v_sub_u32 v248, 2047, v230
    s_mov_b32 s14, 0x400000
    s_mov_b32 s15, 0x00020000
    s_mul_i32 s52, s3, 264192
    s_add_u32 s52, s52, 0x210000
    s_add_u32 s53, s52, 16512
    s_add_u32 s54, s52, 33024
    s_add_u32 s55, s52, 49536
    s_mov_b32 s23, s63
    s_getreg_b32 s24, hwreg(HW_REG_XCC_ID)
    s_and_b32 s24, s24, 15
    v_lshlrev_b32 v10, 4, v0
    v_min_u32 v10, 4336, v10
    v_add_u32 v10, 108032, v10
    v_mov_b32 v104, 0
    v_mov_b32 v105, 0
    v_mov_b32 v106, 0
    v_mov_b32 v107, 0
    ds_write_b128 v10, v[104:107]
    s_mov_b32 s58, 0
    s_waitcnt vmcnt(0)
    buffer_load_dwordx2 v[104:105], v228, s[4:7], s52 offen sc1
    buffer_load_dwordx2 v[106:107], v228, s[4:7], s53 offen sc1
    buffer_load_dwordx2 v[108:109], v228, s[4:7], s54 offen sc1
    buffer_load_dwordx2 v[110:111], v228, s[4:7], s55 offen sc1
    ds_read_b128 v[116:119], v231
    ds_read_b128 v[120:123], v231 offset:16
    ds_read_u16_d16_hi v44, v241
    ds_read_u16_d16_hi v45, v232 offset:28
    ds_read_u16_d16_hi v46, v232 offset:26
    ds_read_u16_d16_hi v47, v232 offset:24
    ds_read_u16_d16_hi v48, v232 offset:22
    ds_read_u16_d16_hi v49, v232 offset:20
    ds_read_u16_d16_hi v50, v232 offset:18
    ds_read_u16_d16_hi v51, v232 offset:16
    ds_read_u16_d16_hi v52, v232 offset:14
    ds_read_u16_d16_hi v53, v232 offset:12
    ds_read_u16_d16_hi v54, v232 offset:10
    ds_read_u16_d16_hi v55, v232 offset:8
    ds_read_u16_d16_hi v56, v232 offset:6
    ds_read_u16_d16_hi v57, v232 offset:4
    ds_read_u16_d16_hi v58, v232 offset:2
    ds_read_u16_d16_hi v59, v232 offset:0
    ds_read_u16_d16_hi v28, v233
    v_mul_u32_u24 v13, 2064, v4
    v_subrev_u32 v13, 104960, v13
    v_sub_u32 v9, v231, v13
    v_sub_u32 v10, v233, v13
    v_sub_u32 v11, v241, v13
    v_sub_u32 v12, v232, v13
    s_mov_b32 s36, 0xffff0000
    s_waitcnt lgkmcnt(0)
    ds_read_b128 v[200:203], v9
    ds_read_b128 v[204:207], v9 offset:16
    ds_read_u16_d16 v208, v11
    ds_read_u16_d16_hi v124, v12 offset:28
    ds_read_u16_d16 v209, v12 offset:26
    ds_read_u16_d16_hi v125, v12 offset:24
    ds_read_u16_d16 v210, v12 offset:22
    ds_read_u16_d16_hi v126, v12 offset:20
    ds_read_u16_d16 v211, v12 offset:18
    ds_read_u16_d16_hi v127, v12 offset:16
    ds_read_u16_d16 v212, v12 offset:14
    ds_read_u16_d16_hi v128, v12 offset:12
    ds_read_u16_d16 v213, v12 offset:10
    ds_read_u16_d16_hi v129, v12 offset:8
    ds_read_u16_d16 v214, v12 offset:6
    ds_read_u16_d16_hi v130, v12 offset:4
    ds_read_u16_d16 v215, v12 offset:2
    ds_read_u16_d16_hi v131, v12 offset:0
    ds_read_u16_d16 v13, v10
    v_and_b32 v29, s36, v116
    v_lshlrev_b32 v30, 16, v117
    v_and_b32 v31, s36, v117
    v_lshlrev_b32 v32, 16, v118
    v_and_b32 v33, s36, v118
    v_lshlrev_b32 v34, 16, v119
    v_and_b32 v35, s36, v119
    v_lshlrev_b32 v36, 16, v120
    v_and_b32 v37, s36, v120
    v_lshlrev_b32 v38, 16, v121
    v_and_b32 v39, s36, v121
    v_lshlrev_b32 v40, 16, v122
    v_and_b32 v41, s36, v122
    v_lshlrev_b32 v42, 16, v123
    v_and_b32 v43, s36, v123
    v_cmp_eq_u32 vcc, 1, v4
    v_mov_b32 v9, s42
    s_nop 0
    v_cndmask_b32_e64 v9, 0, v9, vcc
    v_mov_b32 v116, s42
    v_mov_b32 v117, s42
    v_mov_b32 v118, s42
    v_mov_b32 v119, s42
    v_cmp_eq_u32 vcc, 0, v4
    s_waitcnt lgkmcnt(0)
    v_and_or_b32 v200, v200, s36, v13
    v_or_b32 v208, v208, v124
    v_or_b32 v209, v209, v125
    v_or_b32 v210, v210, v126
    v_or_b32 v211, v211, v127
    v_or_b32 v212, v212, v128
    v_or_b32 v213, v213, v129
    v_or_b32 v214, v214, v130
    v_or_b32 v215, v215, v131
    v_cndmask_b32_e64 v200, v9, v200, vcc
    v_cndmask_b32_e64 v201, v9, v201, vcc
    v_cndmask_b32_e64 v202, v9, v202, vcc
    v_cndmask_b32_e64 v203, v9, v203, vcc
    v_cndmask_b32_e64 v204, v9, v204, vcc
    v_cndmask_b32_e64 v205, v9, v205, vcc
    v_cndmask_b32_e64 v206, v9, v206, vcc
    v_cndmask_b32_e64 v207, v9, v207, vcc
    v_cndmask_b32_e64 v208, v9, v208, vcc
    v_cndmask_b32_e64 v209, v9, v209, vcc
    v_cndmask_b32_e64 v210, v9, v210, vcc
    v_cndmask_b32_e64 v211, v9, v211, vcc
    v_cndmask_b32_e64 v212, v9, v212, vcc
    v_cndmask_b32_e64 v213, v9, v213, vcc
    v_cndmask_b32_e64 v214, v9, v214, vcc
    v_cndmask_b32_e64 v215, v9, v215, vcc
    v_mfma_f32_16x16x32_bf16 v[120:123], v[200:203], v[116:119], 0
    v_mfma_f32_16x16x32_bf16 v[120:123], v[204:207], v[116:119], v[120:123]
    v_mfma_f32_16x16x32_bf16 v[120:123], v[208:211], v[116:119], v[120:123]
    v_mfma_f32_16x16x32_bf16 v[120:123], v[212:215], v[116:119], v[120:123]
    s_nop 7
    ds_write_b32 v243, v120 offset:12
    s_branch fz_h2c
fz_h2:
    buffer_load_dwordx2 v[104:105], v228, s[4:7], s52 offen sc1
    buffer_load_dwordx2 v[106:107], v228, s[4:7], s53 offen sc1
    buffer_load_dwordx2 v[108:109], v228, s[4:7], s54 offen sc1
    buffer_load_dwordx2 v[110:111], v228, s[4:7], s55 offen sc1
fz_h2c:
    s_mov_b32 s36, 0x43000000
fz_h2_c0:
    s_waitcnt vmcnt(3)
    v_xor_b32 v104, v236, v104
    v_xor_b32 v105, v237, v105
    v_bitop3_b32 v9, v104, v105, v249 bitop3:0xa8
    v_cmp_ne_u32 vcc, 0, v9
    s_cbranch_vccnz fz_h2_r0
fz_h2_o0:
    v_fma_mix_f32 v28, v104, s36, v28 op_sel:[0,0,0] op_sel_hi:[1,0,0]
    v_fma_mix_f32 v29, v104, s36, v29 op_sel:[1,0,0] op_sel_hi:[1,0,0]
    v_fma_mix_f32 v30, v105, s36, v30 op_sel:[0,0,0] op_sel_hi:[1,0,0]
    v_fma_mix_f32 v31, v105, s36, v31 op_sel:[1,0,0] op_sel_hi:[1,0,0]
    v_mov_b32_dpp v112, v104 row_mirror row_mask:0xf bank_mask:0xf
    v_mov_b32_dpp v113, v105 row_mirror row_mask:0xf bank_mask:0xf
fz_h2_c1:
    s_waitcnt vmcnt(2)
    v_xor_b32 v106, v236, v106
    v_xor_b32 v107, v237, v107
    v_bitop3_b32 v9, v106, v107, v249 bitop3:0xa8
    v_cmp_ne_u32 vcc, 0, v9
    s_cbranch_vccnz fz_h2_r1
fz_h2_o1:
    v_fma_mix_f32 v32, v106, s36, v32 op_sel:[0,0,0] op_sel_hi:[1,0,0]
    v_fma_mix_f32 v33, v106, s36, v33 op_sel:[1,0,0] op_sel_hi:[1,0,0]
    v_fma_mix_f32 v34, v107, s36, v34 op_sel:[0,0,0] op_sel_hi:[1,0,0]
    v_fma_mix_f32 v35, v107, s36, v35 op_sel:[1,0,0] op_sel_hi:[1,0,0]
    v_mov_b32_dpp v114, v106 row_mirror row_mask:0xf bank_mask:0xf
    v_mov_b32_dpp v115, v107 row_mirror row_mask:0xf bank_mask:0xf
fz_h2_c2:
    s_waitcnt vmcnt(1)
    v_xor_b32 v108, v236, v108
    v_xor_b32 v109, v237, v109
    v_bitop3_b32 v9, v108, v109, v249 bitop3:0xa8
    v_cmp_ne_u32 vcc, 0, v9
    s_cbranch_vccnz fz_h2_r2
fz_h2_o2:
    v_fma_mix_f32 v36, v108, s36, v36 op_sel:[0,0,0] op_sel_hi:[1,0,0]
    v_fma_mix_f32 v37, v108, s36, v37 op_sel:[1,0,0] op_sel_hi:[1,0,0]
    v_fma_mix_f32 v38, v109, s36, v38 op_sel:[0,0,0] op_sel_hi:[1,0,0]
    v_fma_mix_f32 v39, v109, s36, v39 op_sel:[1,0,0] op_sel_hi:[1,0,0]
    v_mov_b32_dpp v116, v108 row_mirror row_mask:0xf bank_mask:0xf
    v_mov_b32_dpp v117, v109 row_mirror row_mask:0xf bank_mask:0xf
fz_h2_c3:
    s_waitcnt vmcnt(0)
    v_xor_b32 v110, v236, v110
    v_xor_b32 v111, v237, v111
    v_bitop3_b32 v9, v110, v111, v249 bitop3:0xa8
    v_cmp_ne_u32 vcc, 0, v9
    s_cbranch_vccnz fz_h2_r3
fz_h2_o3:
    v_fma_mix_f32 v40, v110, s36, v40 op_sel:[0,0,0] op_sel_hi:[1,0,0]
    v_fma_mix_f32 v41, v110, s36, v41 op_sel:[1,0,0] op_sel_hi:[1,0,0]
    v_fma_mix_f32 v42, v111, s36, v42 op_sel:[0,0,0] op_sel_hi:[1,0,0]
    v_fma_mix_f32 v43, v111, s36, v43 op_sel:[1,0,0] op_sel_hi:[1,0,0]
    v_mov_b32_dpp v118, v110 row_mirror row_mask:0xf bank_mask:0xf
    v_mov_b32_dpp v119, v111 row_mirror row_mask:0xf bank_mask:0xf
    s_cmp_eq_u32 s2, 66
    s_cbranch_scc1 fz_spec4
fz_spec4back:
    v_cvt_pk_bf16_f32 v120, v28, v29
    v_cvt_pk_bf16_f32 v121, v30, v31
    v_cvt_pk_bf16_f32 v122, v32, v33
    v_cvt_pk_bf16_f32 v123, v34, v35
    v_cvt_pk_bf16_f32 v124, v36, v37
    v_cvt_pk_bf16_f32 v125, v38, v39
    v_cvt_pk_bf16_f32 v126, v40, v41
    v_cvt_pk_bf16_f32 v127, v42, v43
    v_and_b32 v112, v238, v112
    v_mfma_f32_16x16x32_bf16 v[136:139], v[120:123], v[120:123], 0
    v_mfma_f32_16x16x32_bf16 v[140:143], v[200:203], v[120:123], 0
    v_mfma_f32_16x16x32_bf16 v[136:139], v[124:127], v[124:127], v[136:139]
    v_mfma_f32_16x16x32_bf16 v[140:143], v[204:207], v[124:127], v[140:143]
    v_fma_mix_f32 v44, v112, s36, v44 op_sel:[0,0,0] op_sel_hi:[1,0,0]
    v_fma_mix_f32 v45, v112, s36, v45 op_sel:[1,0,0] op_sel_hi:[1,0,0]
    v_fma_mix_f32 v46, v113, s36, v46 op_sel:[0,0,0] op_sel_hi:[1,0,0]
    v_fma_mix_f32 v47, v113, s36, v47 op_sel:[1,0,0] op_sel_hi:[1,0,0]
    v_fma_mix_f32 v48, v114, s36, v48 op_sel:[0,0,0] op_sel_hi:[1,0,0]
    v_fma_mix_f32 v49, v114, s36, v49 op_sel:[1,0,0] op_sel_hi:[1,0,0]
    v_fma_mix_f32 v50, v115, s36, v50 op_sel:[0,0,0] op_sel_hi:[1,0,0]
    v_fma_mix_f32 v51, v115, s36, v51 op_sel:[1,0,0] op_sel_hi:[1,0,0]
    v_fma_mix_f32 v52, v116, s36, v52 op_sel:[0,0,0] op_sel_hi:[1,0,0]
    v_fma_mix_f32 v53, v116, s36, v53 op_sel:[1,0,0] op_sel_hi:[1,0,0]
    v_fma_mix_f32 v54, v117, s36, v54 op_sel:[0,0,0] op_sel_hi:[1,0,0]
    v_fma_mix_f32 v55, v117, s36, v55 op_sel:[1,0,0] op_sel_hi:[1,0,0]
    v_fma_mix_f32 v56, v118, s36, v56 op_sel:[0,0,0] op_sel_hi:[1,0,0]
    v_fma_mix_f32 v57, v118, s36, v57 op_sel:[1,0,0] op_sel_hi:[1,0,0]
    v_fma_mix_f32 v58, v119, s36, v58 op_sel:[0,0,0] op_sel_hi:[1,0,0]
    v_fma_mix_f32 v59, v119, s36, v59 op_sel:[1,0,0] op_sel_hi:[1,0,0]
    v_cvt_pk_bf16_f32 v128, v44, v45
    v_cvt_pk_bf16_f32 v129, v46, v47
    v_cvt_pk_bf16_f32 v130, v48, v49
    v_cvt_pk_bf16_f32 v131, v50, v51
    v_cvt_pk_bf16_f32 v132, v52, v53
    v_cvt_pk_bf16_f32 v133, v54, v55
    v_cvt_pk_bf16_f32 v134, v56, v57
    v_cvt_pk_bf16_f32 v135, v58, v59
    v_mfma_f32_16x16x32_bf16 v[136:139], v[128:131], v[128:131], v[136:139]
    v_mfma_f32_16x16x32_bf16 v[140:143], v[208:211], v[128:131], v[140:143]
    v_mfma_f32_16x16x32_bf16 v[136:139], v[132:135], v[132:135], v[136:139]
    v_mfma_f32_16x16x32_bf16 v[140:143], v[212:215], v[132:135], v[140:143]
    s_nop 6
    v_cndmask_b32_e64 v9, v136, v137, s[28:29]
    v_cndmask_b32_e64 v10, v138, v139, s[28:29]
    ds_write_b64 v243, v[140:141]
    v_cndmask_b32_e64 v9, v9, v10, s[30:31]
    ds_write_b32 v244, v9 offset:8
    s_cmp_gt_u32 s3, 3
    s_cbranch_scc1 fz_lp
    s_setprio 2
fz_lp:
    s_waitcnt lgkmcnt(0)
    s_barrier
    ds_read_b128 v[144:147], v245 offset:0
    ds_read_b128 v[148:151], v245 offset:256
    ds_read_b128 v[152:155], v245 offset:512
    ds_read_b128 v[156:159], v245 offset:768
    s_waitcnt lgkmcnt(2)
    v_pk_add_f32 v[144:145], v[144:145], v[148:149]
    v_pk_add_f32 v[146:147], v[146:147], v[150:151]
    s_waitcnt lgkmcnt(0)
    v_pk_add_f32 v[152:153], v[152:153], v[156:157]
    v_pk_add_f32 v[154:155], v[154:155], v[158:159]
    v_pk_add_f32 v[144:145], v[144:145], v[152:153]
    v_pk_add_f32 v[146:147], v[146:147], v[154:155]
    v_mov_b32 v148, v144
    v_mov_b32 v149, v145
    v_mov_b32 v150, v146
    v_mov_b32 v151, v147
    v_permlane32_swap_b32 v144, v148
    v_permlane32_swap_b32 v145, v149
    v_permlane32_swap_b32 v146, v150
    v_permlane32_swap_b32 v147, v151
    v_pk_add_f32 v[144:145], v[144:145], v[148:149]
    v_pk_add_f32 v[146:147], v[146:147], v[150:151]
    v_mul_f32 v145, 0xba800000, v145
    v_mul_f32 v146, 0x3a800000, v146
    v_fma_f32 v146, -v145, v145, v146
    v_cvt_pk_bf16_f32 v153, 0, v145
    v_cvt_pk_bf16_f32 v146, 0, v146
    v_add_f32 v146, 0x3727c5ac, v146
    v_cvt_pk_bf16_f32 v146, 0, v146
    v_sqrt_f32 v146, v146
    v_fmac_f32 v144, v153, v147
    v_cvt_pk_bf16_f32 v146, 0, v146
    v_rcp_f32 v154, v146
    v_mov_b32 v155, s40
    v_mul_f32 v144, v144, v154
    v_cvt_pk_bf16_f32 v144, 0, v144
    v_ashrrev_i32 v145, 31, v144
    v_or_b32 v145, 0x80000000, v145
    v_bitop3_b32 v152, v144, v145, v242 bitop3:0x28
    v_or_b32 v152, v152, v248
    s_nop 1
    v_max_u32_dpp v144, v152, v152 row_ror:1 row_mask:0xf bank_mask:0xf
    s_nop 1
    v_max_u32_dpp v144, v144, v144 row_ror:2 row_mask:0xf bank_mask:0xf
    s_nop 1
    v_max_u32_dpp v144, v144, v144 row_ror:4 row_mask:0xf bank_mask:0xf
    s_nop 1
    v_max_u32_dpp v144, v144, v144 row_ror:8 row_mask:0xf bank_mask:0xf
    v_cmp_eq_u32 vcc, v144, v152
    v_or_b32 v153, s24, v153
    s_nop 0
    s_mov_b64 exec, vcc
    buffer_store_dwordx4 v[152:155], v246, s[4:7], s26 offen sc1
    s_add_u32 s26, s26, 69632
    buffer_store_dwordx4 v[152:155], v246, s[4:7], s26 offen sc1
    buffer_store_dwordx4 v[120:123], v247, s[4:7], s27 offen offset:0 sc1
    buffer_store_dwordx4 v[124:127], v247, s[4:7], s27 offen offset:64 sc1
    buffer_store_dwordx4 v[128:131], v247, s[4:7], s27 offen offset:128 sc1
    buffer_store_dwordx4 v[132:135], v247, s[4:7], s27 offen offset:192 sc1
    s_mov_b64 exec, -1
    s_setprio 0
    s_ff1_i32_b64 s37, vcc
    v_add_f32 v144, 1.0, v154
    v_and_b32 v146, v242, v153
    v_mul_f32 v146, v146, v154
    v_pk_fma_f32 v[28:29], v[28:29], v[144:145], v[146:147] op_sel_hi:[1,0,0]
    v_pk_fma_f32 v[30:31], v[30:31], v[144:145], v[146:147] op_sel_hi:[1,0,0]
    v_pk_fma_f32 v[32:33], v[32:33], v[144:145], v[146:147] op_sel_hi:[1,0,0]
    v_pk_fma_f32 v[34:35], v[34:35], v[144:145], v[146:147] op_sel_hi:[1,0,0]
    v_pk_fma_f32 v[36:37], v[36:37], v[144:145], v[146:147] op_sel_hi:[1,0,0]
    v_pk_fma_f32 v[38:39], v[38:39], v[144:145], v[146:147] op_sel_hi:[1,0,0]
    v_pk_fma_f32 v[40:41], v[40:41], v[144:145], v[146:147] op_sel_hi:[1,0,0]
    v_pk_fma_f32 v[42:43], v[42:43], v[144:145], v[146:147] op_sel_hi:[1,0,0]
    v_pk_fma_f32 v[44:45], v[44:45], v[144:145], v[146:147] op_sel_hi:[1,0,0]
    v_pk_fma_f32 v[46:47], v[46:47], v[144:145], v[146:147] op_sel_hi:[1,0,0]
    v_pk_fma_f32 v[48:49], v[48:49], v[144:145], v[146:147] op_sel_hi:[1,0,0]
    v_pk_fma_f32 v[50:51], v[50:51], v[144:145], v[146:147] op_sel_hi:[1,0,0]
    v_pk_fma_f32 v[52:53], v[52:53], v[144:145], v[146:147] op_sel_hi:[1,0,0]
    v_pk_fma_f32 v[54:55], v[54:55], v[144:145], v[146:147] op_sel_hi:[1,0,0]
    v_pk_fma_f32 v[56:57], v[56:57], v[144:145], v[146:147] op_sel_hi:[1,0,0]
    v_pk_fma_f32 v[58:59], v[58:59], v[144:145], v[146:147] op_sel_hi:[1,0,0]
    v_cvt_pk_bf16_f32 v104, v28, v29
    v_cvt_pk_bf16_f32 v105, v30, v31
    v_cvt_pk_bf16_f32 v106, v32, v33
    v_cvt_pk_bf16_f32 v107, v34, v35
    v_cvt_pk_bf16_f32 v108, v36, v37
    v_cvt_pk_bf16_f32 v109, v38, v39
    v_cvt_pk_bf16_f32 v110, v40, v41
    v_cvt_pk_bf16_f32 v111, v42, v43
    v_cvt_pk_bf16_f32 v112, v44, v45
    v_cvt_pk_bf16_f32 v113, v46, v47
    v_cvt_pk_bf16_f32 v114, v48, v49
    v_cvt_pk_bf16_f32 v115, v50, v51
    v_cvt_pk_bf16_f32 v116, v52, v53
    v_cvt_pk_bf16_f32 v117, v54, v55
    v_cvt_pk_bf16_f32 v118, v56, v57
    v_cvt_pk_bf16_f32 v119, v58, v59
    ds_write_b128 v231, v[104:107]
    ds_write_b128 v231, v[108:111] offset:16
    s_waitcnt lgkmcnt(0)
    s_barrier
    ds_write_b16 v233, v104
    ds_write_b16 v241, v112
    ds_write_b16_d16_hi v232, v112 offset:28
    ds_write_b16 v232, v113 offset:26
    ds_write_b16_d16_hi v232, v113 offset:24
    ds_write_b16 v232, v114 offset:22
    ds_write_b16_d16_hi v232, v114 offset:20
    ds_write_b16 v232, v115 offset:18
    ds_write_b16_d16_hi v232, v115 offset:16
    ds_write_b16 v232, v116 offset:14
    ds_write_b16_d16_hi v232, v116 offset:12
    ds_write_b16 v232, v117 offset:10
    ds_write_b16_d16_hi v232, v117 offset:8
    ds_write_b16 v232, v118 offset:6
    ds_write_b16_d16_hi v232, v118 offset:4
    ds_write_b16 v232, v119 offset:2
    ds_write_b16_d16_hi v232, v119 offset:0
    s_lshl_b32 s32, s3, 1
    s_add_u32 s33, s32, 1
    v_readlane_b32 s34, v230, s32
    v_readlane_b32 s35, v230, s33
    s_mul_i32 s38, s3, 4128
    v_add_u32 v9, s38, v239
    s_lshl_b32 s34, s34, 11
    s_lshl_b32 s35, s35, 11
    s_waitcnt lgkmcnt(0)
    s_barrier
    ds_read_b128 v[104:107], v9 offset:0
    ds_read_b128 v[108:111], v9 offset:1024
    ds_read_b128 v[112:115], v9 offset:2064
    ds_read_b128 v[116:119], v9 offset:3088
    s_lshr_b32 s59, s37, 1
    s_xor_b32 s18, s59, 1
    s_and_b32 s18, s18, 3
    s_cmp_lt_u32 s23, 112
    s_cselect_b32 s38, s18, 8
    s_cmp_eq_u32 s38, s3
    s_cbranch_scc1 fz_sk1
    s_waitcnt lgkmcnt(0)
    s_cmp_eq_u32 s37, s32
    s_cbranch_scc1 fz_sk0
    buffer_store_dwordx4 v[104:107], v239, s[12:15], s34 offen offset:0 sc1
    buffer_store_dwordx4 v[108:111], v239, s[12:15], s34 offen offset:1024 sc1
fz_sk0:
    s_cmp_eq_u32 s37, s33
    s_cbranch_scc1 fz_sk1
    buffer_store_dwordx4 v[112:115], v239, s[12:15], s35 offen offset:0 sc1
    buffer_store_dwordx4 v[116:119], v239, s[12:15], s35 offen offset:1024 sc1
fz_sk1:
    v_and_b32 v15, 7, v4
    v_mul_u32_u24 v15, 544, v15
    v_lshl_add_u32 v15, v5, 4, v15
    v_add_u32 v15, 108032, v15
    s_lshl_b32 s63, s23, 5
    s_and_b32 s38, s3, 3
    s_mul_i32 s38, s38, 118784
    s_add_u32 s63, s63, s38
    s_add_u32 s63, s63, 0x4c8000
    v_lshrrev_b32 v13, 1, v1
    v_mul_u32_u24 v13, 3712, v13
    v_and_b32 v14, 1, v1
    v_lshl_add_u32 v102, v14, 4, v13
    v_add_u32 v103, 59392, v102
    s_lshl_b32 s38, s20, 5
    s_add_u32 s38, s38, 0x548000
    s_cmp_lt_u32 s3, 4
    s_cselect_b32 s63, s38, s63
    v_mov_b32 v14, 0xffffff00
    s_cmp_eq_u32 s18, s3
    s_cbranch_scc1 fz_act
    s_cmp_lg_u32 s59, s3
    s_cbranch_scc1 fz_f2
    s_and_b32 s38, s20, 15
    s_add_u32 s38, s38, 16
    s_mul_i32 s38, s38, 2176
    s_add_u32 s38, s38, 0x580000
    s_lshr_b32 s52, s20, 4
    s_lshl_b32 s52, s52, 7
    s_and_b32 s53, s20, 7
    s_lshl_b32 s53, s53, 4
    s_add_u32 s52, s52, s53
    s_bfe_u32 s53, s20, 0x10003
    s_lshl_b32 s53, s53, 2
    s_add_u32 s52, s52, s53
    v_and_b32 v2, 1, v1
    v_lshl_add_u32 v2, v2, 3, v5
    v_add_u32 v2, s52, v2
    v_and_b32 v3, 31, v2
    v_lshrrev_b32 v6, 5, v2
    v_cmp_gt_u32 vcc, 16, v6
    v_cmp_lt_u32 s[52:53], 16, v3
    v_cmp_eq_u32 s[54:55], 0, v3
    s_nop 1
    s_and_b64 s[54:55], s[54:55], vcc
    s_or_b64 s[52:53], s[52:53], s[54:55]
    v_cmp_eq_u32 s[54:55], 16, v3
    s_nop 1
    s_andn2_b64 s[54:55], s[54:55], vcc
    s_or_b64 s[52:53], s[52:53], s[54:55]
    v_sub_u32 v7, 1024, v2
    v_cndmask_b32_e64 v7, v2, v7, s[52:53]
    v_mov_b32 v8, 512
    v_cmp_eq_u32 vcc, 1024, v7
    s_nop 1
    v_cndmask_b32_e64 v7, v7, v8, vcc
    v_lshrrev_b32 v8, 5, v7
    v_and_b32 v7, 15, v7
    v_lshrrev_b32 v9, 2, v8
    v_lshlrev_b32 v9, 8, v9
    v_and_b32 v8, 3, v8
    v_lshl_add_u32 v9, v8, 4, v9
    v_lshrrev_b32 v8, 3, v7
    v_lshl_add_u32 v9, v8, 6, v9
    v_and_b32 v7, 7, v7
    v_lshl_add_u32 v9, v7, 1, v9
    v_cndmask_b32_e64 v7, 0, 1, s[52:53]
    v_lshl_add_u32 v9, v7, 7, v9
    v_lshlrev_b32 v2, 1, v2
    v_lshrrev_b32 v3, 1, v1
    v_mul_u32_u24 v3, 32, v3
    v_and_b32 v6, 1, v1
    v_lshl_add_u32 v3, v6, 4, v3
    v_mov_b32 v6, 0x7fffffff
    v_cmp_gt_u32 vcc, 32, v1
    s_nop 1
    v_cndmask_b32_e64 v6, v6, v3, vcc
    v_mov_b32 v7, s48
    v_cndmask_b32_e64 v16, 0, v7, vcc
    v_mov_b32 v7, s49
    v_cndmask_b32_e64 v17, 0, v7, vcc
    v_mov_b32 v7, s50
    v_cndmask_b32_e64 v18, 0, v7, vcc
    v_mov_b32 v7, s51
    v_cndmask_b32_e64 v19, 0, v7, vcc
    s_mul_i32 s52, s20, 3712
    s_add_u32 s52, s52, 0x4c8000
    s_add_u32 s53, s52, 1024
    s_add_u32 s54, s52, 2048
    s_add_u32 s55, s52, 3072
    v_lshlrev_b32 v20, 4, v1
    v_add_u32 v21, 1024, v20
    s_mov_b32 s58, 0
    s_nop 3
fz_k2:
    buffer_load_dwordx4 v[24:27], v20, s[4:7], s38 offen sc1
    buffer_load_dwordx4 v[28:31], v21, s[4:7], s38 offen sc1
    s_waitcnt vmcnt(0)
    v_xor_b32 v32, s40, v27
    v_xor_b32 v33, s40, v31
    v_max_u32 v34, v24, v28
    v_or_b32 v32, v32, v33
    v_cmp_ne_u32 vcc, 0, v32
    s_cbranch_vccnz fz_k2_rt
fz_k2_ok:
    v_max_u32_dpp v34, v34, v34 quad_perm:[1,0,3,2] row_mask:0xf bank_mask:0xf
    s_nop 1
    v_max_u32_dpp v34, v34, v34 quad_perm:[2,3,0,1] row_mask:0xf bank_mask:0xf
    s_nop 1
    v_max_u32_dpp v34, v34, v34 row_half_mirror row_mask:0xf bank_mask:0xf
    s_nop 1
    v_max_u32_dpp v34, v34, v34 row_mirror row_mask:0xf bank_mask:0xf
    s_nop 1
    v_max_u32_dpp v34, v34, v34 row_bcast:15 row_mask:0xa bank_mask:0xf
    s_nop 1
    v_max_u32_dpp v34, v34, v34 row_bcast:31 row_mask:0xc bank_mask:0xf
    s_nop 0
    v_readlane_b32 s36, v34, 63
    s_nop 1
    v_cmp_eq_u32 vcc, s36, v24
    v_cmp_eq_u32 s[56:57], s36, v28
    s_nop 1
    v_cndmask_b32_e64 v25, v25, v29, s[56:57]
    v_cndmask_b32_e64 v26, v26, v30, s[56:57]
    s_cmp_lg_u64 vcc, 0
    s_cselect_b32 s39, 0, 64
    s_or_b64 vcc, vcc, s[56:57]
    s_ff1_i32_b64 s41, vcc
    v_readlane_b32 s42, v25, s41
    v_readlane_b32 s43, v26, s41
    s_add_u32 s39, s39, s41
    s_and_b32 s42, s42, 0xffff0000
    s_cmp_eq_u32 s39, s20
    s_cbranch_scc1 fz_win
    s_bitcmp1_b32 s37, 0
    s_cbranch_scc1 fz_d1
    buffer_store_dwordx4 v[104:107], v239, s[12:15], s34 offen offset:0 sc1
    buffer_store_dwordx4 v[108:111], v239, s[12:15], s34 offen offset:1024 sc1
    s_branch fz_win
fz_d1:
    buffer_store_dwordx4 v[112:115], v239, s[12:15], s35 offen offset:0 sc1
    buffer_store_dwordx4 v[116:119], v239, s[12:15], s35 offen offset:1024 sc1
fz_win:
    s_lshl_b32 s39, s39, 11
    s_add_u32 s39, s39, 0x448000
    s_mov_b32 s58, 0
    s_mov_b32 s41, 0xffff0000
    s_nop 0
fz_c2:
    buffer_load_short_d16_hi v10, v9, s[4:7], s39 offen sc1
    s_waitcnt vmcnt(0)
    v_cmp_eq_u32 vcc, s41, v10
    s_cbranch_vccnz fz_c2_rt
fz_c2_ok:
    v_add_f32 v11, s42, v10
    v_cvt_pk_bf16_f32 v11, 0, v11
    v_mul_f32 v11, s43, v11
    v_cvt_pk_bf16_f32 v11, 0, v11
    s_ashr_i32 s39, s36, 31
    s_not_b32 s39, s39
    s_or_b32 s39, s39, 0x80000000
    s_xor_b32 s39, s36, s39
    s_and_b32 s39, s39, 0xffff0000
    v_mov_b32 v12, s39
    v_mul_f32 v12, 0xbfb8aa3b, v12
    v_exp_f32 v12, v12
    s_nop 0
    v_add_f32 v12, 1.0, v12
    v_rcp_f32 v12, v12
    s_nop 0
    v_cvt_pk_bf16_f32 v12, 0, v12
    s_and_b32 s39, s36, 0xffff
    s_sub_u32 s39, 2047, s39
    s_lshl_b32 s39, s39, 11
    v_mov_b32 v13, 0xff
    s_waitcnt lgkmcnt(0)
fz_f2:
    s_cmp_gt_u32 s23, 111
    s_cbranch_scc1 fz_nof2
    s_barrier
    s_cmp_eq_u32 s59, s3
    s_cselect_b32 s19, 4, s3
    s_cmp_lt_u32 s19, 4
    s_cbranch_scc1 fz_f2d
    ds_read_b128 v[120:123], v15 offset:0
    ds_read_b128 v[124:127], v15 offset:64
    ds_read_b128 v[128:131], v15 offset:128
    ds_read_b128 v[132:135], v15 offset:192
    ds_read_b128 v[136:139], v15 offset:256
    ds_read_b128 v[140:143], v15 offset:320
    ds_read_b128 v[144:147], v15 offset:384
    ds_read_b128 v[148:151], v15 offset:448
    s_waitcnt lgkmcnt(7)
    v_mfma_f32_16x16x32_bf16 v[152:155], v[120:123], v[160:163], 0
    v_mfma_f32_16x16x32_bf16 v[156:159], v[120:123], v[164:167], 0
    s_waitcnt lgkmcnt(6)
    v_mfma_f32_16x16x32_bf16 v[152:155], v[124:127], v[168:171], v[152:155]
    v_mfma_f32_16x16x32_bf16 v[156:159], v[124:127], v[172:175], v[156:159]
    s_waitcnt lgkmcnt(5)
    v_mfma_f32_16x16x32_bf16 v[152:155], v[128:131], v[176:179], v[152:155]
    v_mfma_f32_16x16x32_bf16 v[156:159], v[128:131], v[180:183], v[156:159]
    s_waitcnt lgkmcnt(4)
    v_mfma_f32_16x16x32_bf16 v[152:155], v[132:135], v[184:187], v[152:155]
    v_mfma_f32_16x16x32_bf16 v[156:159], v[132:135], v[188:191], v[156:159]
    s_waitcnt lgkmcnt(3)
    v_mfma_f32_16x16x32_bf16 v[152:155], v[136:139], v[192:195], v[152:155]
    v_mfma_f32_16x16x32_bf16 v[156:159], v[136:139], v[196:199], v[156:159]
    s_waitcnt lgkmcnt(2)
    v_mfma_f32_16x16x32_bf16 v[152:155], v[140:143], v[60:63], v[152:155]
    v_mfma_f32_16x16x32_bf16 v[156:159], v[140:143], v[64:67], v[156:159]
    s_waitcnt lgkmcnt(1)
    v_mfma_f32_16x16x32_bf16 v[152:155], v[144:147], v[68:71], v[152:155]
    v_mfma_f32_16x16x32_bf16 v[156:159], v[144:147], v[88:91], v[156:159]
    s_waitcnt lgkmcnt(0)
    v_mfma_f32_16x16x32_bf16 v[152:155], v[148:151], v[92:95], v[152:155]
    v_mfma_f32_16x16x32_bf16 v[156:159], v[148:151], v[96:99], v[156:159]
    s_mov_b32 exec_hi, 0
    s_nop 5
    v_and_or_b32 v152, v152, v14, s48
    v_and_or_b32 v153, v153, v14, s49
    v_and_or_b32 v154, v154, v14, s50
    v_and_or_b32 v155, v155, v14, s51
    buffer_store_dwordx4 v[152:155], v102, s[4:7], s63 offen sc1
    v_and_or_b32 v156, v156, v14, s48
    v_and_or_b32 v157, v157, v14, s49
    v_and_or_b32 v158, v158, v14, s50
    v_and_or_b32 v159, v159, v14, s51
    buffer_store_dwordx4 v[156:159], v103, s[4:7], s63 offen sc1
fz_f2d:
    s_mov_b32 exec_hi, -1
    s_cmp_eq_u32 s18, s3
    s_cbranch_scc1 fz_late
    s_cmp_lg_u32 s59, s3
    s_cbranch_scc1 fz_xend
    v_mov_b32 v7, 0
    s_waitcnt vmcnt(0)
    s_branch fz_p5_ok
    s_nop 2
fz_nof2:
    s_cmp_lg_u32 s59, s3
    s_cbranch_scc1 fz_xend
    s_mov_b32 s58, 0
    s_and_b32 s41, s20, 63
    s_mul_i32 s41, s41, 32
    s_add_u32 s41, s41, s52
    v_mov_b32 v7, 0
    s_nop 4
fz_p5:
    buffer_load_dword v8, v7, s[4:7], s41 offen sc1
    s_waitcnt vmcnt(0)
    v_and_b32 v8, 0xff, v8
    v_cmp_ne_u32 vcc, s48, v8
    s_cbranch_vccnz fz_p5_rt
fz_p5_ok:
    s_mov_b32 s58, 0
    buffer_load_dwordx4 v[40:43], v3, s[4:7], s52 offen sc1
    buffer_load_dwordx4 v[44:47], v3, s[4:7], s53 offen sc1
    buffer_load_dwordx4 v[48:51], v3, s[4:7], s54 offen sc1
    buffer_load_dwordx4 v[52:55], v6, s[4:7], s55 offen sc1
fz_h5_c0:
    s_waitcnt vmcnt(3)
    v_xor_b32 v40, s48, v40
    v_xor_b32 v41, s49, v41
    v_xor_b32 v42, s50, v42
    v_xor_b32 v43, s51, v43
    v_or3_b32 v8, v40, v41, v42
    v_bitop3_b32 v8, v8, v43, v13 bitop3:0xa8
    v_cmp_ne_u32 vcc, 0, v8
    s_cbranch_vccnz fz_h5_r0
fz_h5_o0:
fz_h5_c1:
    s_waitcnt vmcnt(2)
    v_xor_b32 v44, s48, v44
    v_xor_b32 v45, s49, v45
    v_xor_b32 v46, s50, v46
    v_xor_b32 v47, s51, v47
    v_or3_b32 v8, v44, v45, v46
    v_bitop3_b32 v8, v8, v47, v13 bitop3:0xa8
    v_cmp_ne_u32 vcc, 0, v8
    s_cbranch_vccnz fz_h5_r1
fz_h5_o1:
    v_pk_add_f32 v[40:41], v[40:41], v[44:45]
    v_pk_add_f32 v[42:43], v[42:43], v[46:47]
fz_h5_c2:
    s_waitcnt vmcnt(1)
    v_xor_b32 v48, s48, v48
    v_xor_b32 v49, s49, v49
    v_xor_b32 v50, s50, v50
    v_xor_b32 v51, s51, v51
    v_or3_b32 v8, v48, v49, v50
    v_bitop3_b32 v8, v8, v51, v13 bitop3:0xa8
    v_cmp_ne_u32 vcc, 0, v8
    s_cbranch_vccnz fz_h5_r2
fz_h5_o2:
    v_pk_add_f32 v[40:41], v[40:41], v[48:49]
    v_pk_add_f32 v[42:43], v[42:43], v[50:51]
fz_h5_c3:
    s_waitcnt vmcnt(0)
    v_xor_b32 v52, v16, v52
    v_xor_b32 v53, v17, v53
    v_xor_b32 v54, v18, v54
    v_xor_b32 v55, v19, v55
    v_or3_b32 v8, v52, v53, v54
    v_bitop3_b32 v8, v8, v55, v13 bitop3:0xa8
    v_cmp_ne_u32 vcc, 0, v8
    s_cbranch_vccnz fz_h5_r3
fz_h5_o3:
    v_pk_add_f32 v[40:41], v[40:41], v[52:53]
    v_pk_add_f32 v[42:43], v[42:43], v[54:55]
    s_nop 1
    v_permlane32_swap_b32 v40, v42
    v_permlane32_swap_b32 v41, v43
    v_pk_add_f32 v[40:41], v[40:41], v[42:43]
    s_nop 1
    v_permlane16_swap_b32 v40, v41
    v_add_f32 v40, v40, v41
    s_nop 1
    v_add_f32_dpp v40, v40, v40 quad_perm:[2,3,0,1] row_mask:0xf bank_mask:0xf
    s_nop 1
    v_add_f32_dpp v40, v40, v40 row_ror:4 row_mask:0xf bank_mask:0xf
    s_nop 1
    v_add_f32_dpp v40, v40, v40 row_ror:8 row_mask:0xf bank_mask:0xf
    v_cvt_pk_bf16_f32 v40, 0, v40
    v_mul_f32 v40, v40, v12
    v_cvt_pk_bf16_f32 v40, 0, v40
    v_add_f32 v40, v40, v11
    v_cvt_pk_bf16_f32 v40, 0, v40
    v_add_f32 v40, v40, v10
    v_cvt_pk_bf16_f32 v40, 0, v40
    s_mov_b32 exec_lo, 0x00030003
    s_mov_b32 exec_hi, 0x00030003
    buffer_store_short_d16_hi v40, v2, s[12:15], s39 offen
    s_cmp_lg_u32 s20, 0
    s_cbranch_scc1 fz_xend
    s_mov_b64 exec, 1
    v_mov_b32 v8, s40
    buffer_store_dword v8, v7, s[4:7], 0 offen
fz_xend:
fz_end:
    s_endpgm
fz_late:
    buffer_store_dwordx4 v[104:107], v239, s[12:15], s34 offen offset:0 sc1
    buffer_store_dwordx4 v[108:111], v239, s[12:15], s34 offen offset:1024 sc1
    buffer_store_dwordx4 v[112:115], v239, s[12:15], s35 offen offset:0 sc1
    buffer_store_dwordx4 v[116:119], v239, s[12:15], s35 offen offset:1024 sc1
    s_branch fz_xend
fz_act:
    s_cmp_gt_u32 s23, 111
    s_cbranch_scc1 fz_xend
    v_lshlrev_b32 v2, 2, v1
    v_and_b32 v11, 3, v1
    v_mov_b32 v3, s48
    v_cmp_eq_u32 vcc, 1, v11
    v_mov_b32 v10, s49
    s_nop 0
    v_cndmask_b32_e64 v3, v3, v10, vcc
    v_cmp_eq_u32 vcc, 2, v11
    v_mov_b32 v10, s50
    s_nop 0
    v_cndmask_b32_e64 v3, v3, v10, vcc
    v_cmp_eq_u32 vcc, 3, v11
    v_mov_b32 v10, s51
    s_nop 0
    v_cndmask_b32_e64 v3, v3, v10, vcc
    v_and_b32 v10, 31, v1
    v_lshlrev_b32 v6, 4, v10
    v_lshrrev_b32 v10, 5, v1
    v_mul_u32_u24 v10, 2184, v10
    v_add_u32 v6, v6, v10
    v_add_u32 v6, 108032, v6
    s_lshl_b32 s38, s23, 11
    s_add_u32 s38, s38, 0x488000
    s_mov_b32 s58, 0
fz_h4:
    buffer_load_dword v16, v2, s[4:7], s38 offen offset:0 sc1
    buffer_load_dword v17, v2, s[4:7], s38 offen offset:256 sc1
    buffer_load_dword v18, v2, s[4:7], s38 offen offset:512 sc1
    buffer_load_dword v19, v2, s[4:7], s38 offen offset:768 sc1
    buffer_load_dword v20, v2, s[4:7], s38 offen offset:1024 sc1
    buffer_load_dword v21, v2, s[4:7], s38 offen offset:1280 sc1
    buffer_load_dword v22, v2, s[4:7], s38 offen offset:1536 sc1
    buffer_load_dword v23, v2, s[4:7], s38 offen offset:1792 sc1
    s_waitcnt vmcnt(6)
    v_xor_b32 v16, v3, v16
    v_xor_b32 v17, v3, v17
    v_or3_b32 v10, v16, v17, 0
    v_add_f32 v16, v16, v17
    s_waitcnt vmcnt(4)
    v_xor_b32 v18, v3, v18
    v_xor_b32 v19, v3, v19
    v_or3_b32 v10, v18, v19, v10
    v_add_f32 v18, v18, v19
    v_add_f32 v16, v16, v18
    s_waitcnt vmcnt(2)
    v_xor_b32 v20, v3, v20
    v_xor_b32 v21, v3, v21
    v_or3_b32 v10, v20, v21, v10
    v_add_f32 v20, v20, v21
    s_waitcnt vmcnt(0)
    v_xor_b32 v22, v3, v22
    v_xor_b32 v23, v3, v23
    v_or3_b32 v10, v22, v23, v10
    v_add_f32 v22, v22, v23
    v_add_f32 v20, v20, v22
    v_and_b32 v10, 0xff, v10
    v_add_f32 v8, v16, v20
    v_cmp_ne_u32 vcc, 0, v10
    s_cbranch_vccnz fz_h4_rt
fz_h4_ok:
    v_cvt_pk_bf16_f32 v8, 0, v8
    v_mov_b32 v9, v8
    s_nop 1
    v_permlane32_swap_b32 v8, v9
    v_mul_f32 v10, 0xbfb8aa3b, v8
    v_exp_f32 v10, v10
    s_nop 0
    v_add_f32 v10, 1.0, v10
    v_rcp_f32 v10, v10
    s_nop 0
    v_mul_f32 v8, v8, v10
    v_cvt_pk_bf16_f32 v8, 0, v8
    v_mul_f32 v8, v8, v9
    v_cvt_pk_bf16_f32 v8, 0, v8
    ds_write_b16_d16_hi v6, v8 offset:0
    ds_write_b16_d16_hi v6, v8 offset:546
    ds_write_b16_d16_hi v6, v8 offset:1092
    ds_write_b16_d16_hi v6, v8 offset:1638
    s_waitcnt lgkmcnt(0)
    s_branch fz_f2
fz_ldh:
    s_load_dwordx2 s[12:13], s[0:1], 56
    s_load_dwordx2 s[16:17], s[0:1], 64
    s_mov_b32 s14, 0x700000
    s_mov_b32 s15, 0x00020000
    s_mov_b32 s18, 0x700000
    s_mov_b32 s19, 0x00020000
    s_branch fz_ldback
fz_spec:
    s_cmp_gt_u32 s3, 3
    s_cbranch_scc1 fz_spec_hi
    s_cmp_eq_u32 s3, 0
    s_cselect_b32 s31, 0, s31
    s_cselect_b32 s30, 33024, s30
    s_cmp_eq_u32 s3, 2
    s_cselect_b32 s31, 30960, s31
    s_cselect_b32 s30, 35088, s30
    s_cmp_eq_u32 s3, 3
    s_cselect_b32 s31, 37152, s31
    s_cselect_b32 s30, 39216, s30
    s_branch fz_specback
fz_spec_hi:
    s_mov_b32 m0, s31
    s_nop 0
    buffer_load_dwordx4 v239, s[8:11], s27 offen lds
    buffer_load_dwordx4 v239, s[8:11], s27 offen offset:1024 lds
    s_mov_b32 m0, s30
    s_nop 0
    buffer_load_dwordx4 v239, s[8:11], s28 offen lds
    buffer_load_dwordx4 v239, s[8:11], s28 offen offset:1024 lds
    v_lshlrev_b32 v13, 3, v0
    v_mov_b32 v10, -1
    v_mov_b32 v11, -1
    s_lshl_b32 s32, s20, 11
    s_add_u32 s32, s32, 0x447800
    s_mov_b32 s18, 0x800
    s_mov_b32 s19, 0x00020000
    s_lshl_b32 s33, s24, 10
    s_min_u32 s34, s33, 2048
    s_add_u32 s34, s34, 104960
    s_mov_b32 m0, s34
    buffer_store_dwordx2 v[10:11], v13, s[4:7], s32 offen sc1
    buffer_load_dwordx4 v239, s[16:19], s33 offen lds
    s_cmp_eq_u32 s24, 0
    s_cselect_b32 s31, 8256, s31
    s_cselect_b32 s30, 22704, s30
    s_cselect_b32 s27, 524288, s27
    s_cselect_b32 s28, 3670016, s28
    s_cmp_eq_u32 s24, 1
    s_cselect_b32 s31, 12384, s31
    s_cselect_b32 s30, 18576, s30
    s_cselect_b32 s27, 1572864, s27
    s_cselect_b32 s28, 2621440, s28
    s_cmp_eq_u32 s24, 2
    s_cselect_b32 s31, 41280, s31
    s_cselect_b32 s30, 43344, s30
    s_cselect_b32 s27, 1572864, s27
    s_cselect_b32 s28, 2621440, s28
    s_cmp_eq_u32 s24, 3
    s_cselect_b32 s31, 45408, s31
    s_cselect_b32 s30, 47472, s30
    s_cselect_b32 s27, 524288, s27
    s_cselect_b32 s28, 3670016, s28
    s_mov_b32 s57, 0
    s_branch fz_specback
fz_jb:
    v_cvt_pk_bf16_f32 v128, v104, v105
    v_cvt_pk_bf16_f32 v129, v106, v107
    v_cvt_pk_bf16_f32 v130, v108, v109
    v_cvt_pk_bf16_f32 v131, v110, v111
    v_cvt_pk_bf16_f32 v132, v112, v113
    v_cvt_pk_bf16_f32 v133, v114, v115
    v_cvt_pk_bf16_f32 v134, v116, v117
    v_cvt_pk_bf16_f32 v135, v118, v119
    s_branch fz_jend
fz_bsp0:
    buffer_load_dwordx4 v[160:163], v14, s[64:67], s62 offen offset:0 nt
    buffer_load_dwordx4 v[164:167], v14, s[64:67], s62 offen offset:256 nt
    s_add_u32 s62, s62, 8192
    buffer_load_dwordx4 v[168:171], v14, s[64:67], s62 offen offset:0 nt
    buffer_load_dwordx4 v[172:175], v14, s[64:67], s62 offen offset:256 nt
    s_add_u32 s62, s62, 8192
    buffer_load_dwordx4 v[176:179], v14, s[64:67], s62 offen offset:0 nt
    buffer_load_dwordx4 v[180:183], v14, s[64:67], s62 offen offset:256 nt
    s_add_u32 s62, s62, 8192
    buffer_load_dwordx4 v[184:187], v14, s[64:67], s62 offen offset:0 nt
    buffer_load_dwordx4 v[188:191], v14, s[64:67], s62 offen offset:256 nt
    s_add_u32 s62, s62, 8192
    buffer_load_dwordx4 v[192:195], v14, s[64:67], s62 offen offset:0 nt
    buffer_load_dwordx4 v[196:199], v14, s[64:67], s62 offen offset:256 nt
    s_add_u32 s62, s62, 8192
    buffer_load_dwordx4 v[60:63], v14, s[64:67], s62 offen offset:0 nt
    buffer_load_dwordx4 v[64:67], v14, s[64:67], s62 offen offset:256 nt
    s_add_u32 s62, s62, 8192
    buffer_load_dwordx4 v[68:71], v14, s[64:67], s62 offen offset:0 nt
    buffer_load_dwordx4 v[88:91], v14, s[64:67], s62 offen offset:256 nt
    s_add_u32 s62, s62, 8192
    buffer_load_dwordx4 v[92:95], v14, s[64:67], s62 offen offset:0 nt
    buffer_load_dwordx4 v[96:99], v14, s[64:67], s62 offen offset:256 nt
    s_branch fz_bsp
fz_spec4:
    s_mov_b32 s38, 0x80018001
    s_mov_b32 s39, 0x80018001
    v_cndmask_b32_e64 v112, v112, v104, s[38:39]
    v_cndmask_b32_e64 v113, v113, v105, s[38:39]
    v_cndmask_b32_e64 v114, v114, v106, s[38:39]
    v_cndmask_b32_e64 v115, v115, v107, s[38:39]
    v_cndmask_b32_e64 v116, v116, v108, s[38:39]
    v_cndmask_b32_e64 v117, v117, v109, s[38:39]
    v_cndmask_b32_e64 v118, v118, v110, s[38:39]
    v_cndmask_b32_e64 v119, v119, v111, s[38:39]
    s_branch fz_spec4back
    s_nop 3
fz_nc1:
    s_setprio 0
    s_cmp_lg_u32 s59, 0
    s_cbranch_scc1 ffn_b
    buffer_load_dwordx4 v[176:179], v14, s[64:67], s62 offen offset:0 nt
    buffer_load_dwordx4 v[180:183], v14, s[64:67], s62 offen offset:256 nt
    s_add_u32 s62, s62, 8192
    buffer_load_dwordx4 v[184:187], v14, s[64:67], s62 offen offset:0 nt
    buffer_load_dwordx4 v[188:191], v14, s[64:67], s62 offen offset:256 nt
    s_add_u32 s62, s62, 8192
    buffer_load_dwordx4 v[192:195], v14, s[64:67], s62 offen offset:0 nt
    buffer_load_dwordx4 v[196:199], v14, s[64:67], s62 offen offset:256 nt
    s_add_u32 s62, s62, 8192
    buffer_load_dwordx4 v[60:63], v14, s[64:67], s62 offen offset:0 nt
    buffer_load_dwordx4 v[64:67], v14, s[64:67], s62 offen offset:256 nt
    s_add_u32 s62, s62, 8192
    buffer_load_dwordx4 v[68:71], v14, s[64:67], s62 offen offset:0 nt
    buffer_load_dwordx4 v[88:91], v14, s[64:67], s62 offen offset:256 nt
    s_add_u32 s62, s62, 8192
    buffer_load_dwordx4 v[92:95], v14, s[64:67], s62 offen offset:0 nt
    buffer_load_dwordx4 v[96:99], v14, s[64:67], s62 offen offset:256 nt
    s_mov_b32 m0, s31
    s_nop 0
    buffer_load_dwordx4 v239, s[8:11], s27 offen lds
    buffer_load_dwordx4 v239, s[8:11], s27 offen offset:1024 lds
    s_mov_b32 m0, s30
    s_nop 0
    buffer_load_dwordx4 v239, s[8:11], s28 offen lds
    buffer_load_dwordx4 v239, s[8:11], s28 offen offset:1024 lds
    v_lshlrev_b32 v13, 3, v0
    v_mov_b32 v10, -1
    v_mov_b32 v11, -1
    s_lshl_b32 s32, s20, 11
    s_add_u32 s32, s32, 0x447800
    s_mov_b32 s18, 0x800
    s_mov_b32 s19, 0x00020000
    s_lshl_b32 s33, s24, 10
    s_min_u32 s34, s33, 2048
    s_add_u32 s34, s34, 104960
    s_mov_b32 m0, s34
    buffer_store_dwordx2 v[10:11], v13, s[4:7], s32 offen sc1
    buffer_load_dwordx4 v239, s[16:19], s33 offen lds
    s_waitcnt vmcnt(22)
    v_readfirstlane_b32 s40, v250
    s_nop 1
    s_add_u32 s40, s40, 1
    s_and_b32 s38, s40, 3
    s_and_b32 s39, s40, 15
    s_bfe_u32 s41, s40, 0x20002
    s_lshl_b32 s41, s41, 16
    s_or_b32 s44, s38, s41
    s_bfe_u32 s41, s40, 0x40004
    s_lshl_b32 s41, s41, 4
    s_or_b32 s48, s39, s41
    s_bfe_u32 s41, s40, 0x20004
    s_lshl_b32 s41, s41, 16
    s_or_b32 s45, s38, s41
    s_bfe_u32 s41, s40, 0x40008
    s_lshl_b32 s41, s41, 4
    s_or_b32 s49, s39, s41
    s_bfe_u32 s41, s40, 0x20006
    s_lshl_b32 s41, s41, 16
    s_or_b32 s46, s38, s41
    s_bfe_u32 s41, s40, 0x4000c
    s_lshl_b32 s41, s41, 4
    s_or_b32 s50, s39, s41
    s_bfe_u32 s41, s40, 0x20008
    s_lshl_b32 s41, s41, 16
    s_or_b32 s47, s38, s41
    s_bfe_u32 s41, s40, 0x40010
    s_lshl_b32 s41, s41, 4
    s_or_b32 s51, s39, s41
    s_mov_b32 s38, 0x404
    s_cmp_eq_u32 s2, 66
    s_cselect_b32 s39, 8, 4
    s_cselect_b32 s38, 8, s38
fz_bsp:
    s_setprio 0
    s_mov_b32 s57, 1
    s_cmp_gt_u32 s3, 5
    s_cbranch_scc1 fz_nocq
    s_and_b32 s32, s3, 1
    s_lshl_b32 s33, s32, 2
    s_lshl_b32 s32, s32, 11
    v_and_b32 v8, 3, v4
    v_lshrrev_b32 v9, 2, v4
    v_lshl_add_u32 v8, v8, 3, v9
    v_add_u32 v8, s33, v8
    v_cvt_f32_u32 v8, v8
    v_mul_f32 v8, 0x3d000000, v8
    v_cvt_f32_u32 v9, v5
    v_mul_f32 v9, 4.0, v9
    v_mul_f32 v9, v8, v9
    v_mov_b32 v104, v9
    v_fmamk_f32 v105, v8, 0x3f800000, v9
    v_fmamk_f32 v106, v8, 0x40000000, v9
    v_fmamk_f32 v107, v8, 0x40400000, v9
    v_fmamk_f32 v108, v8, 0x41800000, v9
    v_fmamk_f32 v109, v8, 0x41880000, v9
    v_fmamk_f32 v110, v8, 0x41900000, v9
    v_fmamk_f32 v111, v8, 0x41980000, v9
    v_sin_f32 v112, v104
    v_sin_f32 v113, v105
    v_sin_f32 v114, v106
    v_sin_f32 v115, v107
    v_sin_f32 v116, v108
    v_sin_f32 v117, v109
    v_sin_f32 v118, v110
    v_sin_f32 v119, v111
    v_cos_f32 v104, v104
    v_cos_f32 v105, v105
    v_cos_f32 v106, v106
    v_cos_f32 v107, v107
    v_cos_f32 v108, v108
    v_cos_f32 v109, v109
    v_cos_f32 v110, v110
    v_cos_f32 v111, v111
    v_mul_f32 v104, 0x3d800000, v104
    v_mul_f32 v105, 0x3d800000, v105
    v_mul_f32 v106, 0x3d800000, v106
    v_mul_f32 v107, 0x3d800000, v107
    v_mul_f32 v108, 0x3d800000, v108
    v_mul_f32 v109, 0x3d800000, v109
    v_mul_f32 v110, 0x3d800000, v110
    v_mul_f32 v111, 0x3d800000, v111
    v_mul_f32 v112, 0x3d800000, v112
    v_mul_f32 v113, 0x3d800000, v113
    v_mul_f32 v114, 0x3d800000, v114
    v_mul_f32 v115, 0x3d800000, v115
    v_mul_f32 v116, 0x3d800000, v116
    v_mul_f32 v117, 0x3d800000, v117
    v_mul_f32 v118, 0x3d800000, v118
    v_mul_f32 v119, 0x3d800000, v119
    v_cvt_pk_f16_f32 v128, v104, v105
    v_cvt_pk_f16_f32 v129, v106, v107
    v_cvt_pk_f16_f32 v130, v108, v109
    v_cvt_pk_f16_f32 v131, v110, v111
    v_cvt_pk_f16_f32 v132, v112, v113
    v_cvt_pk_f16_f32 v133, v114, v115
    v_cvt_pk_f16_f32 v134, v116, v117
    v_cvt_pk_f16_f32 v135, v118, v119
    v_add_u32 v8, s32, v6
    ds_write_b128 v8, v[128:131] offset:14336
    ds_write_b128 v8, v[132:135] offset:15360
fz_nocq:
    s_and_b32 s32, s3, 3
    s_lshr_b32 s33, s3, 2
    s_lshl_b32 s33, s33, 4
    s_add_u32 s33, s33, s32
    v_and_b32 v8, 12, v4
    v_bfe_u32 v9, v4, 1, 1
    v_lshl_add_u32 v8, v9, 5, v8
    v_add_u32 v8, s33, v8
    v_cvt_f32_u32 v8, v8
    v_and_b32 v12, 1, v1
    v_cvt_f32_u32 v9, v12
    v_lshlrev_b32 v13, 2, v5
    v_cvt_f32_u32 v10, v13
    v_mul_f32 v11, 0x3c800000, v8
    v_mul_f32 v9, 0x3e800000, v9
    v_fma_f32 v9, v11, v10, v9
    v_mov_b32 v128, v9
    v_fmamk_f32 v129, v11, 0x3f800000, v9
    v_fmamk_f32 v130, v11, 0x40000000, v9
    v_fmamk_f32 v131, v11, 0x40400000, v9
    v_mul_f32 v11, 0x3a000000, v8
    v_lshlrev_b32 v9, 31, v1
    v_xor_b32 v11, v9, v11
    v_mul_f32 v9, v11, v10
    v_mov_b32 v112, v9
    v_fmamk_f32 v113, v11, 0x3f800000, v9
    v_fmamk_f32 v114, v11, 0x40000000, v9
    v_fmamk_f32 v115, v11, 0x40400000, v9
    v_fmamk_f32 v116, v11, 0x41800000, v9
    v_fmamk_f32 v117, v11, 0x41880000, v9
    v_fmamk_f32 v118, v11, 0x41900000, v9
    v_fmamk_f32 v119, v11, 0x41980000, v9
    v_cos_f32 v104, v128
    v_sin_f32 v105, v128
    v_cos_f32 v106, v129
    v_sin_f32 v107, v129
    v_cos_f32 v108, v130
    v_sin_f32 v109, v130
    v_cos_f32 v110, v131
    v_sin_f32 v111, v131
    v_sin_f32 v120, v112
    v_sin_f32 v121, v113
    v_sin_f32 v122, v114
    v_sin_f32 v123, v115
    v_sin_f32 v124, v116
    v_sin_f32 v125, v117
    v_sin_f32 v126, v118
    v_sin_f32 v127, v119
    v_cos_f32 v112, v112
    v_cos_f32 v113, v113
    v_cos_f32 v114, v114
    v_cos_f32 v115, v115
    v_cos_f32 v116, v116
    v_cos_f32 v117, v117
    v_cos_f32 v118, v118
    v_cos_f32 v119, v119
    v_cvt_pk_f16_f32 v16, v104, v105
    v_cvt_pk_f16_f32 v17, v106, v107
    v_cvt_pk_f16_f32 v18, v108, v109
    v_cvt_pk_f16_f32 v19, v110, v111
    v_cvt_pk_f16_f32 v20, v112, v113
    v_cvt_pk_f16_f32 v21, v114, v115
    v_cvt_pk_f16_f32 v22, v116, v117
    v_cvt_pk_f16_f32 v23, v118, v119
    v_cvt_pk_f16_f32 v24, v120, v121
    v_cvt_pk_f16_f32 v25, v122, v123
    v_cvt_pk_f16_f32 v26, v124, v125
    v_cvt_pk_f16_f32 v27, v126, v127
    v_lshrrev_b32 v8, 3, v1
    v_mul_u32_u24 v222, 16512, v8
    v_and_b32 v9, 7, v1
    v_lshl_add_u32 v222, v9, 4, v222
    s_mul_i32 s60, s3, 528384
    s_lshl_b32 s32, s20, 7
    s_add_u32 s60, s60, s32
    s_add_u32 s60, s60, 0x1000
    s_add_u32 s61, s60, 132096
    s_add_u32 s16, s60, 264192
    s_add_u32 s17, s60, 396288
    v_lshlrev_b32 v8, 1, v8
    v_bfe_u32 v9, v1, 2, 1
    v_add_u32 v8, v8, v9
    s_lshl_b32 s32, s3, 2
    s_add_u32 s32, s32, 1
    v_lshl_add_u32 v8, v8, 5, s32
    v_cmp_eq_u32 vcc, 1, v12
    v_bfe_u32 v9, v1, 1, 1
    v_mul_u32_u24 v9, 8256, v9
    v_add_u32 v9, 86400, v9
    s_cmp_eq_u32 s3, 3
    s_cselect_b32 s32, 272, 0
    v_sub_u32 v10, 512, v8
    v_cndmask_b32_e64 v10, v8, v10, vcc
    v_and_b32 v11, 16, v10
    v_lshl_add_u32 v11, v11, 6, v9
    v_lshrrev_b32 v12, 7, v10
    v_lshl_add_u32 v11, v12, 8, v11
    v_and_b32 v12, 15, v10
    v_lshl_add_u32 v11, v12, 4, v11
    v_bfe_u32 v12, v10, 5, 2
    v_lshl_add_u32 v223, v12, 2, v11
    v_add_u32 v8, 1, v8
    v_sub_u32 v10, 512, v8
    v_cndmask_b32_e64 v10, v8, v10, vcc
    v_and_b32 v11, 16, v10
    v_lshl_add_u32 v11, v11, 6, v9
    v_lshrrev_b32 v12, 7, v10
    v_lshl_add_u32 v11, v12, 8, v11
    v_and_b32 v12, 15, v10
    v_lshl_add_u32 v11, v12, 4, v11
    v_bfe_u32 v12, v10, 5, 2
    v_lshl_add_u32 v224, v12, 2, v11
    v_add_u32 v8, 1, v8
    v_sub_u32 v10, 512, v8
    v_cndmask_b32_e64 v10, v8, v10, vcc
    v_and_b32 v11, 16, v10
    v_lshl_add_u32 v11, v11, 6, v9
    v_lshrrev_b32 v12, 7, v10
    v_lshl_add_u32 v11, v12, 8, v11
    v_and_b32 v12, 15, v10
    v_lshl_add_u32 v11, v12, 4, v11
    v_bfe_u32 v12, v10, 5, 2
    v_lshl_add_u32 v100, v12, 2, v11
    v_mul_u32_u24 v10, s32, v3
    v_sub_u32 v8, v8, v10
    v_add_u32 v8, 1, v8
    v_sub_u32 v10, 512, v8
    v_cndmask_b32_e64 v10, v8, v10, vcc
    v_lshrrev_b32 v11, 1, v10
    v_and_b32 v11, 256, v11
    v_sub_u32 v10, v10, v11
    v_and_b32 v11, 16, v10
    v_lshl_add_u32 v11, v11, 6, v9
    v_lshrrev_b32 v12, 7, v10
    v_lshl_add_u32 v11, v12, 8, v11
    v_and_b32 v12, 15, v10
    v_lshl_add_u32 v11, v12, 4, v11
    v_bfe_u32 v12, v10, 5, 2
    v_lshl_add_u32 v101, v12, 2, v11
    s_and_b32 s32, s3, 3
    s_lshl_b32 s32, s32, 11
    s_add_u32 s32, s32, 86400
    v_add_u32 v225, s32, v239
    v_add_u32 v8, s33, v13
    v_sub_u32 v9, 32, v8
    v_min_u32 v9, v8, v9
    v_and_b32 v10, 15, v8
    v_cmp_eq_u32 s[32:33], 0, v10
    v_cmp_lt_u32 s[34:35], 16, v8
    v_lshlrev_b32 v10, 10, v9
    v_subrev_u32 v10, 1024, v10
    v_mov_b32 v11, 15872
    v_cmp_eq_u32 vcc, 0, v8
    s_nop 1
    v_cndmask_b32_e64 v10, v10, v11, vcc
    v_and_b32 v11, 3, v1
    v_lshl_add_u32 v10, v11, 4, v10
    v_lshrrev_b32 v11, 2, v4
    v_lshlrev_b32 v12, 7, v11
    v_sub_u32 v13, 960, v12
    v_cndmask_b32_e64 v13, v12, v13, s[34:35]
    v_add_u32 v226, v10, v13
    s_or_b64 s[34:35], s[34:35], s[32:33]
    v_add_u32 v12, 512, v12
    v_sub_u32 v13, 960, v12
    v_cndmask_b32_e64 v13, v12, v13, s[34:35]
    v_add_u32 v227, v10, v13
    s_mul_i32 s56, s20, 16512
    s_add_u32 s56, s56, 0x210000
    v_mov_b32 v249, 0x30003
    v_mov_b32 v252, s44
    v_mov_b32 v253, s45
    v_mov_b32 v254, s46
    v_mov_b32 v255, s47
    s_waitcnt lgkmcnt(0)
    v_sub_u32 v8, 15, v4
    v_min_u32 v8, v4, v8
    v_and_b32 v9, 1, v8
    v_lshlrev_b32 v9, 5, v9
    v_lshrrev_b32 v10, 1, v8
    v_lshl_add_u32 v9, v10, 9, v9
    v_add_u32 v9, s25, v9
    v_sub_u32 v10, 2048, v9
    v_cmp_lt_u32 s[34:35], 7, v4
    s_nop 1
    v_cndmask_b32_e64 v230, v9, v10, s[34:35]
    v_mov_b32 v9, v4
    v_mov_b32 v10, s20
    s_cmp_lg_u32 s21, 0
    s_cbranch_scc0 fz_spec3b
fz_spec3backb:
    v_lshlrev_b32 v10, 7, v10
    v_lshl_add_u32 v10, v9, 3, v10
    v_mul_u32_u24 v11, 66048, v5
    v_add_u32 v228, v10, v11
    v_and_b32 v9, 1, v9
    v_cmp_eq_u32 vcc, 1, v9
    v_mov_b32 v9, s44
    v_mov_b32 v10, s46
    v_cndmask_b32_e64 v236, v9, v10, vcc
    v_mov_b32 v9, s45
    v_mov_b32 v10, s47
    v_cndmask_b32_e64 v237, v9, v10, vcc
    s_lshl_b32 s32, s3, 2
    v_add_u32 v8, s32, v5
    v_lshlrev_b32 v9, 6, v8
    v_cmp_gt_u32 vcc, 16, v8
    s_nop 1
    v_cndmask_b32_e64 v10, 0, 32, vcc
    v_add_u32 v10, v9, v10
    v_sub_u32 v11, 2048, v10
    v_cmp_eq_u32 vcc, 16, v8
    s_nop 1
    v_cndmask_b32_e64 v11, v11, 0, vcc
    v_mov_b32 v12, 0xffff0000
    v_cndmask_b32_e64 v238, -1, v12, vcc
    v_sub_u32 v12, 2018, v9
    v_mul_u32_u24 v13, 2064, v4
    v_add_u32 v231, v13, v9
    v_add_u32 v232, v13, v12
    v_add_u32 v233, v13, v10
    v_add_u32 v241, v13, v11
    s_lshl_b32 s32, s3, 8
    s_add_u32 s32, s32, 102912
    v_lshlrev_b32 v9, 4, v4
    v_add_u32 v10, s32, v9
    v_add_u32 v11, 107008, v239
    v_cmp_gt_u32 vcc, 16, v1
    s_nop 1
    v_cndmask_b32_e64 v243, v11, v10, vcc
    v_lshrrev_b32 v12, 2, v4
    v_cmp_eq_u32 vcc, v12, v5
    s_nop 1
    v_cndmask_b32_e64 v244, v11, v10, vcc
    v_lshrrev_b32 v12, 5, v1
    v_lshl_add_u32 v10, v12, 10, v9
    v_add_u32 v245, 102912, v10
    v_and_b32 v9, 1, v1
    v_cmp_eq_u32 s[28:29], 1, v9
    v_and_b32 v9, 2, v1
    v_cmp_eq_u32 s[30:31], 2, v9
    s_lshl_b32 s37, s3, 2
    v_add_u32 v9, s37, v5
    v_mul_u32_u24 v246, 2176, v9
    s_lshl_b32 s26, s20, 4
    s_add_u32 s26, s26, 0x580000
    v_lshlrev_b32 v247, 4, v5
    s_lshl_b32 s27, s20, 11
    s_lshl_b32 s37, s3, 8
    s_add_u32 s27, s27, s37
    s_add_u32 s27, s27, 0x448000
    v_sub_u32 v248, 2047, v230
    s_mov_b32 s14, 0x400000
    s_mov_b32 s15, 0x00020000
    s_mul_i32 s52, s3, 264192
    s_add_u32 s52, s52, 0x210000
    s_add_u32 s53, s52, 16512
    s_add_u32 s54, s52, 33024
    s_add_u32 s55, s52, 49536
    s_mov_b32 s23, s63
    s_getreg_b32 s24, hwreg(HW_REG_XCC_ID)
    s_and_b32 s24, s24, 15
    v_lshlrev_b32 v10, 4, v0
    v_min_u32 v10, 4336, v10
    v_add_u32 v10, 108032, v10
    v_mov_b32 v104, 0
    v_mov_b32 v105, 0
    v_mov_b32 v106, 0
    v_mov_b32 v107, 0
    ds_write_b128 v10, v[104:107]
    s_cmp_eq_u32 s2, 66
    s_cbranch_scc1 fz_sz
    s_waitcnt vmcnt(0)
    v_mov_b32 v10, 256
    s_mov_b64 exec, 1
    ds_add_u32 v15, v10
    s_mov_b64 exec, -1
fz_sz:
    ds_read_b32 v10, v15
    s_waitcnt lgkmcnt(0)
    v_cmp_ne_u32 vcc, s38, v10
    s_cbranch_vccnz fz_sz
    ds_read_b128 v[116:119], v231
    ds_read_b128 v[120:123], v231 offset:16
    ds_read_u16_d16_hi v44, v241
    ds_read_u16_d16_hi v45, v232 offset:28
    ds_read_u16_d16_hi v46, v232 offset:26
    ds_read_u16_d16_hi v47, v232 offset:24
    ds_read_u16_d16_hi v48, v232 offset:22
    ds_read_u16_d16_hi v49, v232 offset:20
    ds_read_u16_d16_hi v50, v232 offset:18
    ds_read_u16_d16_hi v51, v232 offset:16
    ds_read_u16_d16_hi v52, v232 offset:14
    ds_read_u16_d16_hi v53, v232 offset:12
    ds_read_u16_d16_hi v54, v232 offset:10
    ds_read_u16_d16_hi v55, v232 offset:8
    ds_read_u16_d16_hi v56, v232 offset:6
    ds_read_u16_d16_hi v57, v232 offset:4
    ds_read_u16_d16_hi v58, v232 offset:2
    ds_read_u16_d16_hi v59, v232 offset:0
    ds_read_u16_d16_hi v28, v233
    v_mul_u32_u24 v13, 2064, v4
    v_subrev_u32 v13, 104960, v13
    v_sub_u32 v9, v231, v13
    v_sub_u32 v10, v233, v13
    v_sub_u32 v11, v241, v13
    v_sub_u32 v12, v232, v13
    s_mov_b32 s36, 0xffff0000
    s_waitcnt lgkmcnt(0)
    ds_read_b128 v[200:203], v9
    ds_read_b128 v[204:207], v9 offset:16
    ds_read_u16_d16 v208, v11
    ds_read_u16_d16_hi v124, v12 offset:28
    ds_read_u16_d16 v209, v12 offset:26
    ds_read_u16_d16_hi v125, v12 offset:24
    ds_read_u16_d16 v210, v12 offset:22
    ds_read_u16_d16_hi v126, v12 offset:20
    ds_read_u16_d16 v211, v12 offset:18
    ds_read_u16_d16_hi v127, v12 offset:16
    ds_read_u16_d16 v212, v12 offset:14
    ds_read_u16_d16_hi v128, v12 offset:12
    ds_read_u16_d16 v213, v12 offset:10
    ds_read_u16_d16_hi v129, v12 offset:8
    ds_read_u16_d16 v214, v12 offset:6
    ds_read_u16_d16_hi v130, v12 offset:4
    ds_read_u16_d16 v215, v12 offset:2
    ds_read_u16_d16_hi v131, v12 offset:0
    ds_read_u16_d16 v13, v10
    v_and_b32 v29, s36, v116
    v_lshlrev_b32 v30, 16, v117
    v_and_b32 v31, s36, v117
    v_lshlrev_b32 v32, 16, v118
    v_and_b32 v33, s36, v118
    v_lshlrev_b32 v34, 16, v119
    v_and_b32 v35, s36, v119
    v_lshlrev_b32 v36, 16, v120
    v_and_b32 v37, s36, v120
    v_lshlrev_b32 v38, 16, v121
    v_and_b32 v39, s36, v121
    v_lshlrev_b32 v40, 16, v122
    v_and_b32 v41, s36, v122
    v_lshlrev_b32 v42, 16, v123
    v_and_b32 v43, s36, v123
    v_cmp_eq_u32 vcc, 1, v4
    v_mov_b32 v9, s42
    s_nop 0
    v_cndmask_b32_e64 v9, 0, v9, vcc
    v_mov_b32 v116, s42
    v_mov_b32 v117, s42
    v_mov_b32 v118, s42
    v_mov_b32 v119, s42
    v_cmp_eq_u32 vcc, 0, v4
    s_waitcnt lgkmcnt(0)
    v_and_or_b32 v200, v200, s36, v13
    v_or_b32 v208, v208, v124
    v_or_b32 v209, v209, v125
    v_or_b32 v210, v210, v126
    v_or_b32 v211, v211, v127
    v_or_b32 v212, v212, v128
    v_or_b32 v213, v213, v129
    v_or_b32 v214, v214, v130
    v_or_b32 v215, v215, v131
    v_cndmask_b32_e64 v200, v9, v200, vcc
    v_cndmask_b32_e64 v201, v9, v201, vcc
    v_cndmask_b32_e64 v202, v9, v202, vcc
    v_cndmask_b32_e64 v203, v9, v203, vcc
    v_cndmask_b32_e64 v204, v9, v204, vcc
    v_cndmask_b32_e64 v205, v9, v205, vcc
    v_cndmask_b32_e64 v206, v9, v206, vcc
    v_cndmask_b32_e64 v207, v9, v207, vcc
    v_cndmask_b32_e64 v208, v9, v208, vcc
    v_cndmask_b32_e64 v209, v9, v209, vcc
    v_cndmask_b32_e64 v210, v9, v210, vcc
    v_cndmask_b32_e64 v211, v9, v211, vcc
    v_cndmask_b32_e64 v212, v9, v212, vcc
    v_cndmask_b32_e64 v213, v9, v213, vcc
    v_cndmask_b32_e64 v214, v9, v214, vcc
    v_cndmask_b32_e64 v215, v9, v215, vcc
    v_mfma_f32_16x16x32_bf16 v[120:123], v[200:203], v[116:119], 0
    v_mfma_f32_16x16x32_bf16 v[120:123], v[204:207], v[116:119], v[120:123]
    v_mfma_f32_16x16x32_bf16 v[120:123], v[208:211], v[116:119], v[120:123]
    v_mfma_f32_16x16x32_bf16 v[120:123], v[212:215], v[116:119], v[120:123]
    s_nop 7
    ds_write_b32 v243, v120 offset:12
    s_waitcnt lgkmcnt(0)
    s_branch fz_hb
    s_nop 0
fz_nc3:
    s_mov_b32 s58, 0
    s_waitcnt vmcnt(0)
    s_branch fz_h2
fz_spec3a:
    v_xor_b32 v11, 1, v4
    v_cndmask_b32_e64 v9, v9, v11, s[34:35]
    v_and_b32 v11, 1, v4
    v_cndmask_b32_e64 v11, 0, v11, s[34:35]
    v_sub_u32 v10, v10, v11
    s_cmp_lg_u32 s22, 0
    s_cbranch_scc1 fz_spec3backa
    v_cmp_eq_u32 vcc, 15, v4
    v_mov_b32 v11, 1024
    v_mov_b32 v12, 124
    v_cndmask_b32_e64 v230, v230, v11, vcc
    v_cndmask_b32_e64 v10, v10, v12, vcc
    v_cndmask_b32_e64 v9, v9, 4, vcc
    v_cmp_eq_u32 vcc, 13, v4
    v_mov_b32 v11, 1536
    v_mov_b32 v12, 124
    v_cndmask_b32_e64 v230, v230, v11, vcc
    v_cndmask_b32_e64 v10, v10, v12, vcc
    v_cndmask_b32_e64 v9, v9, 6, vcc
    v_cmp_eq_u32 vcc, 4, v4
    v_mov_b32 v11, 256
    v_mov_b32 v12, 127
    v_cndmask_b32_e64 v230, v230, v11, vcc
    v_cndmask_b32_e64 v10, v10, v12, vcc
    v_cndmask_b32_e64 v9, v9, 8, vcc
    v_cmp_eq_u32 vcc, 11, v4
    v_mov_b32 v11, 1792
    v_mov_b32 v12, 127
    v_cndmask_b32_e64 v230, v230, v11, vcc
    v_cndmask_b32_e64 v10, v10, v12, vcc
    v_cndmask_b32_e64 v9, v9, 14, vcc
    v_cmp_eq_u32 vcc, 6, v4
    v_mov_b32 v11, 768
    v_mov_b32 v12, 127
    v_cndmask_b32_e64 v230, v230, v11, vcc
    v_cndmask_b32_e64 v10, v10, v12, vcc
    v_cndmask_b32_e64 v9, v9, 10, vcc
    v_cmp_eq_u32 vcc, 9, v4
    v_mov_b32 v11, 1280
    v_mov_b32 v12, 127
    v_cndmask_b32_e64 v230, v230, v11, vcc
    v_cndmask_b32_e64 v10, v10, v12, vcc
    v_cndmask_b32_e64 v9, v9, 12, vcc
    s_nop 4
    s_branch fz_spec3backa
fz_spec3b:
    v_xor_b32 v11, 1, v4
    v_cndmask_b32_e64 v9, v9, v11, s[34:35]
    v_and_b32 v11, 1, v4
    v_cndmask_b32_e64 v11, 0, v11, s[34:35]
    v_sub_u32 v10, v10, v11
    s_cmp_lg_u32 s22, 0
    s_cbranch_scc1 fz_spec3backb
    v_cmp_eq_u32 vcc, 15, v4
    v_mov_b32 v11, 1024
    v_mov_b32 v12, 124
    v_cndmask_b32_e64 v230, v230, v11, vcc
    v_cndmask_b32_e64 v10, v10, v12, vcc
    v_cndmask_b32_e64 v9, v9, 4, vcc
    v_cmp_eq_u32 vcc, 13, v4
    v_mov_b32 v11, 1536
    v_mov_b32 v12, 124
    v_cndmask_b32_e64 v230, v230, v11, vcc
    v_cndmask_b32_e64 v10, v10, v12, vcc
    v_cndmask_b32_e64 v9, v9, 6, vcc
    v_cmp_eq_u32 vcc, 4, v4
    v_mov_b32 v11, 256
    v_mov_b32 v12, 127
    v_cndmask_b32_e64 v230, v230, v11, vcc
    v_cndmask_b32_e64 v10, v10, v12, vcc
    v_cndmask_b32_e64 v9, v9, 8, vcc
    v_cmp_eq_u32 vcc, 11, v4
    v_mov_b32 v11, 1792
    v_mov_b32 v12, 127
    v_cndmask_b32_e64 v230, v230, v11, vcc
    v_cndmask_b32_e64 v10, v10, v12, vcc
    v_cndmask_b32_e64 v9, v9, 14, vcc
    v_cmp_eq_u32 vcc, 6, v4
    v_mov_b32 v11, 768
    v_mov_b32 v12, 127
    v_cndmask_b32_e64 v230, v230, v11, vcc
    v_cndmask_b32_e64 v10, v10, v12, vcc
    v_cndmask_b32_e64 v9, v9, 10, vcc
    v_cmp_eq_u32 vcc, 9, v4
    v_mov_b32 v11, 1280
    v_mov_b32 v12, 127
    v_cndmask_b32_e64 v230, v230, v11, vcc
    v_cndmask_b32_e64 v10, v10, v12, vcc
    v_cndmask_b32_e64 v9, v9, 12, vcc
    s_nop 4
    s_branch fz_spec3backb
    s_nop 0
ffn_b:
    s_waitcnt vmcnt(0)
    v_readfirstlane_b32 s40, v250
    s_nop 1
    s_add_u32 s40, s40, 1
    s_and_b32 s38, s40, 3
    s_and_b32 s39, s40, 15
    s_bfe_u32 s41, s40, 0x20002
    s_lshl_b32 s41, s41, 16
    s_or_b32 s44, s38, s41
    s_bfe_u32 s41, s40, 0x40004
    s_lshl_b32 s41, s41, 4
    s_or_b32 s48, s39, s41
    s_bfe_u32 s41, s40, 0x20004
    s_lshl_b32 s41, s41, 16
    s_or_b32 s45, s38, s41
    s_bfe_u32 s41, s40, 0x40008
    s_lshl_b32 s41, s41, 4
    s_or_b32 s49, s39, s41
    s_bfe_u32 s41, s40, 0x20006
    s_lshl_b32 s41, s41, 16
    s_or_b32 s46, s38, s41
    s_bfe_u32 s41, s40, 0x4000c
    s_lshl_b32 s41, s41, 4
    s_or_b32 s50, s39, s41
    s_bfe_u32 s41, s40, 0x20008
    s_lshl_b32 s41, s41, 16
    s_or_b32 s47, s38, s41
    s_bfe_u32 s41, s40, 0x40010
    s_lshl_b32 s41, s41, 4
    s_or_b32 s51, s39, s41
    s_nop 0
ffn:
    s_add_u32 s36, s2, 4
    s_and_b32 s36, s36, 7
    s_bfe_u32 s37, s2, 0x10006
    s_lshl_b32 s22, s36, 1
    s_add_u32 s22, s22, s37
    s_cmp_lg_u32 s37, 0
    s_cselect_b32 s37, 8, s36
    s_add_u32 s37, s37, 6
    s_cmp_lt_u32 s36, 6
    s_cselect_b32 s22, s22, s37
    s_cmp_gt_u32 s22, 13
    s_cbranch_scc1 fz_xend
    s_bfe_u32 s21, s2, 0x30003
    v_lshrrev_b32 v2, 5, v1
    v_and_b32 v3, 31, v1
    v_lshlrev_b32 v4, 1, v2
    v_xor_b32 v3, v4, v3
    v_mul_u32_u24 v4, 7168, v2
    v_lshl_add_u32 v4, v3, 4, v4
    v_xor_b32 v5, 64, v4
    v_xor_b32 v6, 128, v4
    v_xor_b32 v7, 192, v4
    s_lshl_b32 s23, s21, 7
    s_lshl_b32 s24, s3, 4
    s_add_u32 s23, s23, s24
    s_mul_i32 s23, s23, 7168
    s_lshl_b32 s24, s22, 9
    s_add_u32 s23, s23, s24
    s_lshl_b32 s24, s3, 13
    v_mov_b32 v31, 149552
    v_mov_b32 v10, 0
    ds_write_b32 v31, v10
    s_waitcnt lgkmcnt(0)
    s_setprio 0
    s_barrier
    s_add_u32 s28, s24, 81920
    s_mov_b32 m0, s28
    s_add_u32 s29, s23, 0
    buffer_load_dwordx4 v4, s[12:15], s29 offen nt lds
    s_add_u32 s28, s24, 82944
    s_mov_b32 m0, s28
    s_add_u32 s29, s23, 14336
    buffer_load_dwordx4 v5, s[12:15], s29 offen nt lds
    s_add_u32 s28, s24, 83968
    s_mov_b32 m0, s28
    s_add_u32 s29, s23, 28672
    buffer_load_dwordx4 v4, s[12:15], s29 offen nt lds
    s_add_u32 s28, s24, 84992
    s_mov_b32 m0, s28
    s_add_u32 s29, s23, 43008
    buffer_load_dwordx4 v5, s[12:15], s29 offen nt lds
    s_add_u32 s28, s24, 86016
    s_mov_b32 m0, s28
    s_add_u32 s29, s23, 57344
    buffer_load_dwordx4 v6, s[12:15], s29 offen nt lds
    s_add_u32 s28, s24, 87040
    s_mov_b32 m0, s28
    s_add_u32 s29, s23, 71680
    buffer_load_dwordx4 v7, s[12:15], s29 offen nt lds
    s_add_u32 s28, s24, 88064
    s_mov_b32 m0, s28
    s_add_u32 s29, s23, 86016
    buffer_load_dwordx4 v6, s[12:15], s29 offen nt lds
    s_add_u32 s28, s24, 89088
    s_mov_b32 m0, s28
    s_add_u32 s29, s23, 100352
    buffer_load_dwordx4 v7, s[12:15], s29 offen nt lds
    s_add_u32 s28, s24, 0
    s_mov_b32 m0, s28
    s_add_u32 s29, s23, 0
    buffer_load_dwordx4 v4, s[16:19], s29 offen nt lds
    s_add_u32 s28, s24, 1024
    s_mov_b32 m0, s28
    s_add_u32 s29, s23, 14336
    buffer_load_dwordx4 v5, s[16:19], s29 offen nt lds
    s_add_u32 s28, s24, 2048
    s_mov_b32 m0, s28
    s_add_u32 s29, s23, 28672
    buffer_load_dwordx4 v4, s[16:19], s29 offen nt lds
    s_add_u32 s28, s24, 3072
    s_mov_b32 m0, s28
    s_add_u32 s29, s23, 43008
    buffer_load_dwordx4 v5, s[16:19], s29 offen nt lds
    s_add_u32 s28, s24, 4096
    s_mov_b32 m0, s28
    s_add_u32 s29, s23, 57344
    buffer_load_dwordx4 v6, s[16:19], s29 offen nt lds
    s_add_u32 s28, s24, 5120
    s_mov_b32 m0, s28
    s_add_u32 s29, s23, 71680
    buffer_load_dwordx4 v7, s[16:19], s29 offen nt lds
    s_add_u32 s28, s24, 6144
    s_mov_b32 m0, s28
    s_add_u32 s29, s23, 86016
    buffer_load_dwordx4 v6, s[16:19], s29 offen nt lds
    s_add_u32 s28, s24, 7168
    s_mov_b32 m0, s28
    s_add_u32 s29, s23, 100352
    buffer_load_dwordx4 v7, s[16:19], s29 offen nt lds
    v_lshrrev_b32 v2, 4, v1
    v_and_b32 v3, 15, v1
    v_bfe_u32 v9, v1, 2, 2
    v_lshl_add_u32 v8, v2, 3, v9
    v_lshlrev_b32 v8, 9, v8
    v_and_b32 v10, 1, v2
    v_lshl_add_u32 v10, v10, 2, v9
    s_lshl_b32 s28, s3, 1
    v_xor_b32 v10, s28, v10
    v_lshl_add_u32 v8, v10, 5, v8
    v_and_b32 v10, 3, v1
    v_lshl_add_u32 v8, v10, 3, v8
    v_xor_b32 v12, 32, v8
    v_add_u32 v13, 81920, v8
    v_add_u32 v20, 81920, v12
    v_bfe_u32 v9, v0, 2, 2
    v_lshrrev_b32 v10, 6, v0
    v_lshl_add_u32 v9, v10, 2, v9
    v_bfe_u32 v10, v0, 4, 1
    v_and_b32 v11, 3, v0
    v_lshlrev_b32 v11, 1, v11
    v_lshl_add_u32 v10, v10, 3, v11
    v_lshl_add_u32 v11, v9, 5, v10
    v_add_u32 v17, 1, v11
    v_cmp_eq_u32 vcc, 0, v10
    v_cmp_gt_u32 s[28:29], 16, v9
    s_nop 1
    s_and_b64 vcc, vcc, s[28:29]
    v_cndmask_b32_e64 v14, 0, 16, vcc
    v_add_u32 v16, v11, v14
    v_bfe_u32 v10, v0, 5, 1
    v_cmp_eq_u32 s[28:29], 1, v10
    v_sub_u32 v14, 1024, v16
    v_cmp_eq_u32 vcc, 512, v16
    s_nop 1
    v_cndmask_b32_e64 v14, v14, 0, vcc
    v_cndmask_b32_e64 v16, v16, v14, s[28:29]
    v_sub_u32 v14, 1024, v17
    v_cndmask_b32_e64 v17, v17, v14, s[28:29]
    v_lshlrev_b32 v16, 1, v16
    v_add_u32 v16, 147456, v16
    v_lshlrev_b32 v17, 1, v17
    v_add_u32 v17, 147456, v17
    v_lshlrev_b32 v18, 2, v0
    v_add_u32 v18, 149568, v18
    s_lshl_b32 s28, s21, 8
    s_add_u32 s28, s28, 147456
    v_lshlrev_b32 v19, 4, v2
    v_add_u32 v19, s28, v19
    v_mov_b32 v28, 149504
    v_lshlrev_b32 v29, 4, v1
    s_lshl_b32 s30, s22, 3
    s_add_u32 s30, s30, s3
    s_lshl_b32 s30, s30, 3
    s_add_u32 s30, s30, s21
    s_lshl_b32 s30, s30, 8
    s_add_u32 s30, s30, 0x488000
    v_lshlrev_b32 v30, 4, v2
    v_lshl_add_u32 v30, v3, 6, v30
    v_cmp_eq_u32 s[60:61], 1, v3
    v_cmp_eq_u32 s[62:63], 2, v3
    v_cmp_eq_u32 s[64:65], 3, v3
    v_add_u32 v21, 149568, v29
    v_mov_b32 v197, 0xffffff00
    s_and_b32 s35, s2, 0x47
    s_lshl_b32 s31, s3, 3
    s_add_u32 s35, s35, s31
    s_add_u32 s35, s35, 58
    s_and_b32 s35, s35, 127
    s_getreg_b32 s33, hwreg(HW_REG_XCC_ID)
    s_and_b32 s33, s33, 15
    s_lshr_b32 s31, s35, 5
    s_lshl_b32 s31, s31, 2
    s_add_u32 s31, s31, 149520
    v_mov_b32 v22, s31
    s_lshl_b32 s20, s22, 3
    s_add_u32 s20, s20, s21
    s_and_b32 s34, s20, 15
    s_bfe_u32 s28, s20, 0x10004
    s_lshl_b32 s28, s28, 5
    s_add_u32 s34, s34, s28
    s_mul_i32 s34, s34, 2176
    s_add_u32 s34, s34, 0x580000
    s_waitcnt vmcnt(0)
    s_barrier
    ds_read_b64_tr_b16 v[32:33], v13 offset:0
    ds_read_b64_tr_b16 v[34:35], v13 offset:2048
    ds_read_b64_tr_b16 v[36:37], v13 offset:16384
    ds_read_b64_tr_b16 v[38:39], v13 offset:18432
    ds_read_b64_tr_b16 v[40:41], v13 offset:32768
    ds_read_b64_tr_b16 v[42:43], v13 offset:34816
    ds_read_b64_tr_b16 v[44:45], v13 offset:49152
    ds_read_b64_tr_b16 v[46:47], v13 offset:51200
    s_waitcnt lgkmcnt(0)
    ds_read_b64_tr_b16 v[48:49], v20 offset:0
    ds_read_b64_tr_b16 v[50:51], v20 offset:2048
    ds_read_b64_tr_b16 v[52:53], v20 offset:16384
    ds_read_b64_tr_b16 v[54:55], v20 offset:18432
    ds_read_b64_tr_b16 v[56:57], v20 offset:32768
    ds_read_b64_tr_b16 v[58:59], v20 offset:34816
    ds_read_b64_tr_b16 v[60:61], v20 offset:49152
    ds_read_b64_tr_b16 v[62:63], v20 offset:51200
    s_waitcnt lgkmcnt(0)
    ds_read_b64_tr_b16 v[64:65], v8 offset:0
    ds_read_b64_tr_b16 v[66:67], v8 offset:2048
    ds_read_b64_tr_b16 v[68:69], v8 offset:16384
    ds_read_b64_tr_b16 v[70:71], v8 offset:18432
    ds_read_b64_tr_b16 v[72:73], v8 offset:32768
    ds_read_b64_tr_b16 v[74:75], v8 offset:34816
    ds_read_b64_tr_b16 v[76:77], v8 offset:49152
    ds_read_b64_tr_b16 v[78:79], v8 offset:51200
    s_waitcnt lgkmcnt(0)
    ds_read_b64_tr_b16 v[80:81], v12 offset:0
    ds_read_b64_tr_b16 v[82:83], v12 offset:2048
    ds_read_b64_tr_b16 v[84:85], v12 offset:16384
    ds_read_b64_tr_b16 v[86:87], v12 offset:18432
    ds_read_b64_tr_b16 v[88:89], v12 offset:32768
    ds_read_b64_tr_b16 v[90:91], v12 offset:34816
    ds_read_b64_tr_b16 v[92:93], v12 offset:49152
    ds_read_b64_tr_b16 v[94:95], v12 offset:51200
    s_waitcnt lgkmcnt(0)
    s_cmp_lg_u32 s3, 0
    s_cbranch_scc1 ffn_w3
    v_lshlrev_b32 v23, 4, v1
    v_add_u32 v24, 1024, v23
    s_lshl_b32 s28, s20, 4
    s_add_u32 s28, s28, s34
    v_mov_b32 v10, 34828
    s_nop 4
ffn_p3:
    buffer_load_dword v11, v10, s[4:7], s28 offen sc1
    s_waitcnt vmcnt(0) lgkmcnt(0)
    v_cmp_ne_u32 vcc, s40, v11
    s_cbranch_vccnz ffn_p3_rt
ffn_p3_ok:
    s_mov_b32 s58, 0
    s_mov_b32 s54, -1
    s_nop 1
ffn_k3:
    buffer_load_dwordx4 v[200:203], v23, s[4:7], s34 offen sc1
    buffer_load_dwordx4 v[204:207], v24, s[4:7], s34 offen sc1
    s_waitcnt vmcnt(0)
    v_cmp_eq_u32 s[24:25], s40, v203
    v_cmp_eq_u32 s[26:27], s40, v207
    s_nop 0
    v_cndmask_b32_e64 v200, 0, v200, s[24:25]
    v_cndmask_b32_e64 v204, 0, v204, s[26:27]
    v_max_u32 v210, v200, v204
    s_nop 1
    v_max_u32_dpp v210, v210, v210 quad_perm:[1,0,3,2] row_mask:0xf bank_mask:0xf
    s_nop 1
    v_max_u32_dpp v210, v210, v210 quad_perm:[2,3,0,1] row_mask:0xf bank_mask:0xf
    s_nop 1
    v_max_u32_dpp v210, v210, v210 row_half_mirror row_mask:0xf bank_mask:0xf
    s_nop 1
    v_max_u32_dpp v210, v210, v210 row_mirror row_mask:0xf bank_mask:0xf
    s_nop 1
    v_max_u32_dpp v210, v210, v210 row_bcast:15 row_mask:0xa bank_mask:0xf
    s_nop 1
    v_max_u32_dpp v210, v210, v210 row_bcast:31 row_mask:0xc bank_mask:0xf
    s_and_b64 s[52:53], s[24:25], s[26:27]
    v_readlane_b32 s36, v210, 63
    s_nop 1
    v_cmp_eq_u32 vcc, s36, v200
    v_cmp_eq_u32 s[28:29], s36, v204
    s_nop 0
    s_cmp_lg_u64 vcc, 0
    s_cselect_b32 s39, 0, 64
    s_or_b64 vcc, vcc, s[28:29]
    s_ff1_i32_b64 s41, vcc
    s_add_u32 s39, s39, s41
    s_lshl_b32 s39, s39, 11
    s_add_u32 s39, s39, 0x448000
    s_cmp_eq_u32 s39, s54
    s_cbranch_scc1 ffn_c3h
    buffer_load_dwordx4 v[128:131], v29, s[4:7], s39 offen sc1
    buffer_load_dwordx4 v[132:135], v29, s[4:7], s39 offen offset:1024 sc1
ffn_c3h:
    s_cmp_lg_u64 s[52:53], -1
    s_cbranch_scc1 ffn_k3_rt
ffn_k3_ok:
    s_mov_b32 s58, 0
ffn_c3d:
    v_and_b32 v10, 15, v201
    v_and_b32 v11, 15, v205
    v_cmp_eq_u32 s[24:25], s33, v10
    v_cmp_eq_u32 s[26:27], s33, v11
    s_nop 0
    v_mov_b32 v212, s24
    v_mov_b32 v213, s25
    v_mov_b32 v214, s26
    v_mov_b32 v215, s27
    v_cndmask_b32_e64 v209, v201, v205, s[28:29]
    v_cndmask_b32_e64 v210, v202, v206, s[28:29]
    v_and_b32 v209, 0xffff0000, v209
    s_mov_b64 s[42:43], vcc
    s_mov_b64 exec, vcc
    ds_write_b128 v28, v[208:211]
    ds_write_b128 v28, v[212:215] offset:16
    s_mov_b64 exec, -1
    s_waitcnt vmcnt(1)
    ds_write_b128 v21, v[128:131]
    v_max3_u32 v10, v128, v129, v130
    s_waitcnt vmcnt(0)
    ds_write_b128 v21, v[132:135] offset:1024
    v_max3_u32 v10, v10, v131, v132
    v_max3_u32 v11, v133, v134, v135
    v_max_u32 v10, v10, v11
    v_cmp_eq_u32 vcc, -1, v10
    s_cbranch_vccnz ffn_c3_rt
ffn_c3_ok:
    s_waitcnt lgkmcnt(0)
    s_nop 2
ffn_w3:
    s_barrier
    ds_read_b32 v11, v18
    ds_read_b128 v[200:203], v28
    ds_read_b32 v203, v22
    s_mov_b32 s28, 0xffff0000
    s_waitcnt lgkmcnt(2)
    v_lshlrev_b32 v14, 16, v11
    v_and_b32 v15, s28, v11
    s_waitcnt lgkmcnt(0)
    v_add_f32 v14, v14, v201
    v_add_f32 v15, v15, v201
    v_cvt_pk_bf16_f32 v14, 0, v14
    v_cvt_pk_bf16_f32 v15, 0, v15
    v_mul_f32 v14, v14, v202
    v_mul_f32 v15, v15, v202
    v_cvt_pk_bf16_f32 v14, v14, v15
    ds_write_b16 v16, v14
    ds_write_b16_d16_hi v17, v14
    v_readfirstlane_b32 s24, v203
    s_waitcnt lgkmcnt(0)
    s_barrier
    ds_read_b128 v[128:131], v19 offset:0
    ds_read_b128 v[132:135], v19 offset:64
    ds_read_b128 v[136:139], v19 offset:128
    ds_read_b128 v[140:143], v19 offset:192
    s_waitcnt lgkmcnt(3)
    v_mfma_f32_16x16x32_bf16 v[192:195], v[32:35], v[128:131], 0
    v_mfma_f32_16x16x32_bf16 v[148:151], v[48:51], v[128:131], 0
    v_mfma_f32_16x16x32_bf16 v[152:155], v[64:67], v[128:131], 0
    v_mfma_f32_16x16x32_bf16 v[156:159], v[80:83], v[128:131], 0
    s_waitcnt lgkmcnt(2)
    v_mfma_f32_16x16x32_bf16 v[192:195], v[36:39], v[132:135], v[192:195]
    v_mfma_f32_16x16x32_bf16 v[148:151], v[52:55], v[132:135], v[148:151]
    v_mfma_f32_16x16x32_bf16 v[152:155], v[68:71], v[132:135], v[152:155]
    v_mfma_f32_16x16x32_bf16 v[156:159], v[84:87], v[132:135], v[156:159]
    s_waitcnt lgkmcnt(1)
    v_mfma_f32_16x16x32_bf16 v[192:195], v[40:43], v[136:139], v[192:195]
    v_mfma_f32_16x16x32_bf16 v[148:151], v[56:59], v[136:139], v[148:151]
    v_mfma_f32_16x16x32_bf16 v[152:155], v[72:75], v[136:139], v[152:155]
    v_mfma_f32_16x16x32_bf16 v[156:159], v[88:91], v[136:139], v[156:159]
    s_waitcnt lgkmcnt(0)
    v_mfma_f32_16x16x32_bf16 v[192:195], v[44:47], v[140:143], v[192:195]
    v_mfma_f32_16x16x32_bf16 v[148:151], v[60:63], v[140:143], v[148:151]
    v_mfma_f32_16x16x32_bf16 v[152:155], v[76:79], v[140:143], v[152:155]
    v_mfma_f32_16x16x32_bf16 v[156:159], v[92:95], v[140:143], v[156:159]
    s_nop 5
    v_cndmask_b32_e64 v192, v192, v148, s[60:61]
    v_cndmask_b32_e64 v193, v193, v149, s[60:61]
    v_cndmask_b32_e64 v194, v194, v150, s[60:61]
    v_cndmask_b32_e64 v195, v195, v151, s[60:61]
    v_cndmask_b32_e64 v192, v192, v152, s[62:63]
    v_cndmask_b32_e64 v193, v193, v153, s[62:63]
    v_cndmask_b32_e64 v194, v194, v154, s[62:63]
    v_cndmask_b32_e64 v195, v195, v155, s[62:63]
    v_cndmask_b32_e64 v192, v192, v156, s[64:65]
    v_cndmask_b32_e64 v193, v193, v157, s[64:65]
    v_cndmask_b32_e64 v194, v194, v158, s[64:65]
    v_cndmask_b32_e64 v195, v195, v159, s[64:65]
    s_mov_b32 exec_lo, 0x000f000f
    s_mov_b32 exec_hi, 0x000f000f
    v_and_or_b32 v192, v192, v197, s48
    v_and_or_b32 v193, v193, v197, s49
    v_and_or_b32 v194, v194, v197, s50
    v_and_or_b32 v195, v195, v197, s51
    s_bitcmp1_b32 s24, s35
    s_cbranch_scc0 ffn_rem
    buffer_store_dwordx4 v[192:195], v30, s[4:7], s30 offen
ffn_fin:
    s_endpgm
ffn_rem:
    buffer_store_dwordx4 v[192:195], v30, s[4:7], s30 offen sc1
    s_branch ffn_fin
ffn_c3_rt:
    s_mov_b64 vcc, s[42:43]
    s_add_u32 s58, s58, 1
    s_cmp_gt_u32 s58, 0x10000
    s_cbranch_scc1 ffn_c3_ok
    buffer_load_dwordx4 v[128:131], v29, s[4:7], s39 offen sc1
    buffer_load_dwordx4 v[132:135], v29, s[4:7], s39 offen offset:1024 sc1
    s_branch ffn_c3d
ffn_k3_rt:
    s_cmp_lg_u32 s36, 0
    s_cselect_b32 s54, s39, -1
    s_add_u32 s58, s58, 1
    s_cmp_lt_u32 s58, 0x10000
    s_cbranch_scc1 ffn_k3
    s_branch ffn_k3_ok
fz_h1_r0:
    s_add_u32 s58, s58, 1
    s_cmp_gt_u32 s58, 0x10000
    s_cbranch_scc1 fz_h1_o0
    buffer_load_dwordx4 v[104:107], v222, s[4:7], s60 offen sc1
    buffer_load_dwordx4 v[108:111], v222, s[4:7], s61 offen sc1
    buffer_load_dwordx4 v[112:115], v222, s[4:7], s16 offen sc1
    buffer_load_dwordx4 v[116:119], v222, s[4:7], s17 offen sc1
    s_branch fz_h1_c0
fz_h1_r1:
    s_add_u32 s58, s58, 1
    s_cmp_gt_u32 s58, 0x10000
    s_cbranch_scc1 fz_h1_o1
    buffer_load_dwordx4 v[108:111], v222, s[4:7], s61 offen sc1
    buffer_load_dwordx4 v[112:115], v222, s[4:7], s16 offen sc1
    buffer_load_dwordx4 v[116:119], v222, s[4:7], s17 offen sc1
    s_branch fz_h1_c1
fz_h1_r2:
    s_add_u32 s58, s58, 1
    s_cmp_gt_u32 s58, 0x10000
    s_cbranch_scc1 fz_h1_o2
    buffer_load_dwordx4 v[112:115], v222, s[4:7], s16 offen sc1
    buffer_load_dwordx4 v[116:119], v222, s[4:7], s17 offen sc1
    s_branch fz_h1_c2
fz_h1_r3:
    s_add_u32 s58, s58, 1
    s_cmp_gt_u32 s58, 0x10000
    s_cbranch_scc1 fz_h1_o3
    buffer_load_dwordx4 v[116:119], v222, s[4:7], s17 offen sc1
    s_branch fz_h1_c3
fz_h2_r0:
    s_add_u32 s58, s58, 1
    s_cmp_gt_u32 s58, 0x10000
    s_cbranch_scc1 fz_h2_o0
    buffer_load_dwordx2 v[104:105], v228, s[4:7], s52 offen sc1
    buffer_load_dwordx2 v[106:107], v228, s[4:7], s53 offen sc1
    buffer_load_dwordx2 v[108:109], v228, s[4:7], s54 offen sc1
    buffer_load_dwordx2 v[110:111], v228, s[4:7], s55 offen sc1
    s_branch fz_h2_c0
fz_h2_r1:
    s_add_u32 s58, s58, 1
    s_cmp_gt_u32 s58, 0x10000
    s_cbranch_scc1 fz_h2_o1
    buffer_load_dwordx2 v[106:107], v228, s[4:7], s53 offen sc1
    buffer_load_dwordx2 v[108:109], v228, s[4:7], s54 offen sc1
    buffer_load_dwordx2 v[110:111], v228, s[4:7], s55 offen sc1
    s_branch fz_h2_c1
fz_h2_r2:
    s_add_u32 s58, s58, 1
    s_cmp_gt_u32 s58, 0x10000
    s_cbranch_scc1 fz_h2_o2
    buffer_load_dwordx2 v[108:109], v228, s[4:7], s54 offen sc1
    buffer_load_dwordx2 v[110:111], v228, s[4:7], s55 offen sc1
    s_branch fz_h2_c2
fz_h2_r3:
    s_add_u32 s58, s58, 1
    s_cmp_gt_u32 s58, 0x10000
    s_cbranch_scc1 fz_h2_o3
    buffer_load_dwordx2 v[110:111], v228, s[4:7], s55 offen sc1
    s_branch fz_h2_c3
fz_h5_r0:
    s_add_u32 s58, s58, 1
    s_cmp_gt_u32 s58, 0x10000
    s_cbranch_scc1 fz_h5_o0
    buffer_load_dwordx4 v[40:43], v3, s[4:7], s52 offen sc1
    buffer_load_dwordx4 v[44:47], v3, s[4:7], s53 offen sc1
    buffer_load_dwordx4 v[48:51], v3, s[4:7], s54 offen sc1
    buffer_load_dwordx4 v[52:55], v6, s[4:7], s55 offen sc1
    s_branch fz_h5_c0
fz_h5_r1:
    s_add_u32 s58, s58, 1
    s_cmp_gt_u32 s58, 0x10000
    s_cbranch_scc1 fz_h5_o1
    buffer_load_dwordx4 v[44:47], v3, s[4:7], s53 offen sc1
    buffer_load_dwordx4 v[48:51], v3, s[4:7], s54 offen sc1
    buffer_load_dwordx4 v[52:55], v6, s[4:7], s55 offen sc1
    s_branch fz_h5_c1
fz_h5_r2:
    s_add_u32 s58, s58, 1
    s_cmp_gt_u32 s58, 0x10000
    s_cbranch_scc1 fz_h5_o2
    buffer_load_dwordx4 v[48:51], v3, s[4:7], s54 offen sc1
    buffer_load_dwordx4 v[52:55], v6, s[4:7], s55 offen sc1
    s_branch fz_h5_c2
fz_h5_r3:
    s_add_u32 s58, s58, 1
    s_cmp_gt_u32 s58, 0x10000
    s_cbranch_scc1 fz_h5_o3
    buffer_load_dwordx4 v[52:55], v6, s[4:7], s55 offen sc1
    s_branch fz_h5_c3
fz_k2_rt:
    s_add_u32 s58, s58, 1
    s_cmp_lt_u32 s58, 0x10000
    s_cbranch_scc1 fz_k2
    s_branch fz_k2_ok
fz_c2_rt:
    s_add_u32 s58, s58, 1
    s_cmp_lt_u32 s58, 0x10000
    s_cbranch_scc1 fz_c2
    s_branch fz_c2_ok
fz_p5_rt:
    s_add_u32 s58, s58, 1
    s_cmp_lt_u32 s58, 0x10000
    s_cbranch_scc1 fz_p5
    s_branch fz_p5_ok
fz_h4_rt:
    s_add_u32 s58, s58, 1
    s_cmp_lt_u32 s58, 0x10000
    s_cbranch_scc1 fz_h4
    s_branch fz_h4_ok
ffn_p3_rt:
    s_add_u32 s58, s58, 1
    s_cmp_lt_u32 s58, 0x10000
    s_cbranch_scc1 ffn_p3
    s_branch ffn_p3_ok
fz_codeend:
.section .rodata,"a"
.p2align 6
.amdhsa_kernel fz_kernel
  .amdhsa_next_free_vgpr 256
  .amdhsa_next_free_sgpr 102
  .amdhsa_accum_offset 256
  .amdhsa_group_segment_fixed_size 0
  .amdhsa_kernarg_size 104
  .amdhsa_user_sgpr_count 2
  .amdhsa_user_sgpr_kernarg_segment_ptr 1
  .amdhsa_system_sgpr_workgroup_id_x 1
.end_amdhsa_kernel
```

```asm
; @launch kernel=fz_kernel grid=(256,1,1) block=(512,1,1) lds=163840
.amdgcn_target "amdgcn-amd-amdhsa--gfx950"
.text
.globl fz_kernel
.p2align 8
.type fz_kernel,@function
fz_kernel:
    s_load_dwordx2 s[4:5], s[0:1], 96
    s_load_dwordx2 s[8:9], s[0:1], 0
    s_load_dwordx2 s[64:65], s[0:1], 72
    s_cmp_gt_u32 s2, 255
    s_cbranch_scc1 fz_end
    v_lshrrev_b32 v2, 6, v0
    v_and_b32 v1, 63, v0
    s_lshr_b32 s59, s2, 7
    v_readfirstlane_b32 s3, v2
    s_and_b32 s20, s2, 127
    s_cmp_lt_u32 s20, 8
    s_cselect_b32 s20, s3, 0
    s_cmp_lt_u32 s20, 4
    s_cbranch_scc1 fz_pfcback
    s_getpc_b64 s[20:21]
fz_pcb:
    s_sub_u32 s20, s20, fz_pcb-fz_kernel
    s_subb_u32 s21, s21, 0
    v_and_b32 v3, 255, v0
    v_lshlrev_b32 v3, 7, v3
    v_min_u32 v3, fz_codeend-fz_kernel-4, v3
    v_mov_b32 v5, s21
    v_add_co_u32 v4, vcc, s20, v3
    s_nop 1
    v_addc_co_u32 v5, vcc, 0, v5, vcc
    global_load_dword v251, v[4:5], off
fz_pfcback:
    s_cmp_lg_u32 s59, 0
    s_cbranch_scc1 fz_ldh
    s_load_dwordx2 s[12:13], s[0:1], 80
    s_load_dwordx2 s[16:17], s[0:1], 48
fz_ldback:
    s_add_u32 s20, s2, 58
    s_and_b32 s20, s20, 127
    s_lshr_b32 s21, s20, 3
    s_add_u32 s21, s21, 1
    s_and_b32 s22, s20, 7
    s_sub_u32 s23, s20, 124
    s_cmp_ge_u32 s20, 124
    s_cselect_b32 s21, 0, s21
    s_cselect_b32 s22, s23, s22
    s_lshr_b32 s57, s3, 2
    s_or_b32 s23, s57, s59
    s_and_b32 s24, s3, 3
    s_lshl_b32 s25, s22, 6
    s_add_u32 s25, s25, s21
    s_lshl_b32 s26, s23, 5
    s_add_u32 s26, s26, s25
    s_lshl_b32 s27, s24, 9
    s_add_u32 s28, s26, s27
    s_sub_u32 s27, 2048, s27
    s_sub_u32 s27, s27, s26
    s_lshl_b32 s29, s24, 1
    s_add_u32 s29, s29, s23
    s_sub_u32 s30, 15, s29
    s_cmp_lt_u32 s24, 2
    s_cselect_b32 s27, s28, s27
    s_cselect_b32 s31, s29, s30
    s_cselect_b32 s30, s30, s29
    s_sub_u32 s28, 2048, s27
    s_and_b32 s28, s28, 2047
    s_lshl_b32 s27, s27, 11
    s_lshl_b32 s28, s28, 11
    s_mul_i32 s31, s31, 2064
    s_mul_i32 s30, s30, 2064
    v_lshlrev_b32 v239, 4, v1
    s_mov_b32 s10, 0x400000
    s_mov_b32 s11, 0x00020000
    s_mov_b32 s6, 0x690000
    s_mov_b32 s7, 0x00020000
    s_mov_b32 s66, 0x700000
    s_mov_b32 s67, 0x00020000
    s_and_b32 s32, s57, s59
    s_add_u32 s36, s2, 4
    s_and_b32 s36, s36, 7
    s_bfe_u32 s37, s2, 0x10006
    s_lshl_b32 s63, s36, 1
    s_add_u32 s63, s63, s37
    s_cmp_lg_u32 s37, 0
    s_cselect_b32 s37, 8, s36
    s_add_u32 s37, s37, 6
    s_cmp_lt_u32 s36, 6
    s_cselect_b32 s63, s63, s37
    s_lshl_b32 s63, s63, 3
    s_bfe_u32 s37, s2, 0x30003
    s_add_u32 s63, s63, s37
    v_and_b32 v10, 15, v1
    v_lshlrev_b32 v10, 4, v10
    v_lshrrev_b32 v14, 4, v1
    v_lshl_add_u32 v14, v14, 11, v10
    s_lshl_b32 s62, s63, 16
    s_and_b32 s37, s3, 3
    s_lshl_b32 s37, s37, 9
    s_add_u32 s62, s62, s37
    s_mov_b32 s58, 0
    s_waitcnt lgkmcnt(0)
    s_cmp_eq_u32 s2, 66
    s_cbranch_scc1 fz_spec
fz_specback:
    s_cmp_lg_u32 s57, 0
    s_cbranch_scc1 fz_nox
    s_mov_b32 m0, s31
    s_nop 0
    buffer_load_dwordx4 v239, s[8:11], s27 offen lds
    buffer_load_dwordx4 v239, s[8:11], s27 offen offset:1024 lds
    s_mov_b32 m0, s30
    s_nop 0
    buffer_load_dwordx4 v239, s[8:11], s28 offen lds
    buffer_load_dwordx4 v239, s[8:11], s28 offen offset:1024 lds
fz_nox:
    buffer_load_dword v250, off, s[4:7], 0
    s_andn2_b32 s32, s57, s59
    s_cbranch_scc0 fz_nowe
    buffer_load_dwordx4 v[160:163], v14, s[64:67], s62 offen offset:0 nt
    buffer_load_dwordx4 v[164:167], v14, s[64:67], s62 offen offset:256 nt
    s_add_u32 s62, s62, 8192
    buffer_load_dwordx4 v[168:171], v14, s[64:67], s62 offen offset:0 nt
    buffer_load_dwordx4 v[172:175], v14, s[64:67], s62 offen offset:256 nt
    s_add_u32 s62, s62, 8192
fz_nowe:
    s_cmp_eq_u32 s57, 0
    s_cbranch_scc1 fz_np
    s_setprio 1
fz_np:
    v_and_b32 v2, 31, v1
    v_lshrrev_b32 v3, 5, v1
    v_and_b32 v4, 15, v1
    v_lshrrev_b32 v5, 4, v1
    v_add_u32 v6, 49536, v239
    v_lshrrev_b32 v10, 1, v2
    v_and_b32 v8, 9, v10
    v_and_b32 v11, 2, v10
    v_lshl_or_b32 v8, v11, 1, v8
    v_bfe_u32 v11, v10, 2, 1
    v_lshl_or_b32 v8, v11, 1, v8
    v_and_b32 v12, 1, v5
    v_cmp_eq_u32 vcc, 1, v12
    v_lshl_add_u32 v9, v4, 1, 1
    s_nop 0
    v_cndmask_b32_e64 v9, v9, 0, vcc
    s_cmp_lt_u32 s3, 5
    s_cselect_b64 s[32:33], -1, 0
    s_cmp_lt_u32 s3, 3
    s_cselect_b64 s[34:35], -1, 0
    v_cndmask_b32_e64 v9, v9, v2, s[32:33]
    v_cndmask_b32_e64 v8, v9, v8, s[34:35]
    s_mov_b32 s36, 0x3d000000
    s_cmp_gt_u32 s3, 4
    s_cselect_b32 s36, 0x3c800000, s36
    s_sub_u32 s37, s3, 1
    s_cmp_lt_u32 s37, 2
    s_cselect_b32 s36, 0x3a800000, s36
    s_cmp_eq_u32 s3, 0
    s_cselect_b32 s32, 16, 0
    s_cselect_b32 s33, 0x3e800000, 0
    s_cselect_b32 s34, 4.0, 0x41000000
    s_cselect_b32 s35, 0x41000000, 4.0
    v_cmp_eq_u32 vcc, 1, v2
    v_mov_b32 v10, s32
    s_nop 0
    v_cndmask_b32_e64 v10, 0, v10, vcc
    v_add_u32 v8, v8, v10
    v_cvt_f32_u32 v8, v8
    v_mul_f32 v8, s36, v8
    s_cmp_eq_u32 s3, 2
    s_cselect_b32 s32, 0x80000000, 0
    v_lshlrev_b32 v10, 31, v2
    v_and_b32 v10, s32, v10
    v_xor_b32 v8, v10, v8
    v_and_b32 v10, 1, v2
    v_cvt_f32_u32 v10, v10
    v_mul_f32 v10, s33, v10
    s_cmp_eq_u32 s3, 1
    s_cselect_b32 s33, 0x3e800000, 0
    v_mov_b32 v11, s33
    v_cndmask_b32_e64 v10, v10, v11, vcc
    s_cmp_eq_u32 s3, 5
    s_cselect_b32 s33, 0x3e800000, 0
    v_cvt_f32_u32 v12, v12
    v_fma_f32 v10, v12, s33, v10
    s_cmp_eq_u32 s3, 6
    s_cselect_b32 s33, 0x3e800000, 0
    s_cmp_eq_u32 s3, 2
    s_cselect_b32 s33, 0xbe800000, s33
    s_cmp_eq_u32 s3, 4
    s_cselect_b32 s33, 0xbe800000, s33
    v_add_f32 v10, s33, v10
    v_cvt_f32_u32 v11, v3
    v_mul_f32 v11, s35, v11
    v_fma_f32 v9, v8, v11, v10
    v_mul_f32 v10, s34, v8
    v_mul_f32 v11, 0x41800000, v8
    v_mov_b32 v104, v9
    v_fmamk_f32 v105, v8, 0x3f800000, v9
    v_fmamk_f32 v106, v8, 0x40000000, v9
    v_fmamk_f32 v107, v8, 0x40400000, v9
    v_add_f32 v108, v104, v10
    v_add_f32 v109, v105, v10
    v_add_f32 v110, v106, v10
    v_add_f32 v111, v107, v10
    v_add_f32 v112, v104, v11
    v_add_f32 v113, v105, v11
    v_add_f32 v114, v106, v11
    v_add_f32 v115, v107, v11
    v_add_f32 v116, v108, v11
    v_add_f32 v117, v109, v11
    v_add_f32 v118, v110, v11
    v_add_f32 v119, v111, v11
    v_cos_f32 v104, v104
    v_cos_f32 v105, v105
    v_cos_f32 v106, v106
    v_cos_f32 v107, v107
    v_cos_f32 v108, v108
    v_cos_f32 v109, v109
    v_cos_f32 v110, v110
    v_cos_f32 v111, v111
    v_cos_f32 v112, v112
    v_cos_f32 v113, v113
    v_cos_f32 v114, v114
    v_cos_f32 v115, v115
    v_cos_f32 v116, v116
    v_cos_f32 v117, v117
    v_cos_f32 v118, v118
    v_cos_f32 v119, v119
    s_lshl_b32 s32, s3, 11
    v_add_u32 v8, s32, v6
    s_cmp_eq_u32 s3, 0
    s_cbranch_scc1 fz_jb
    v_cvt_pk_f16_f32 v128, v104, v105
    v_cvt_pk_f16_f32 v129, v106, v107
    v_cvt_pk_f16_f32 v130, v108, v109
    v_cvt_pk_f16_f32 v131, v110, v111
    v_cvt_pk_f16_f32 v132, v112, v113
    v_cvt_pk_f16_f32 v133, v114, v115
    v_cvt_pk_f16_f32 v134, v116, v117
    v_cvt_pk_f16_f32 v135, v118, v119
fz_jend:
    ds_write_b128 v8, v[128:131] offset:0
    ds_write_b128 v8, v[132:135] offset:1024
    v_mov_b32 v15, 49520
    v_mov_b32 v10, 0
    ds_write_b32 v15, v10
    s_waitcnt lgkmcnt(0)
    s_barrier
    v_lshlrev_b32 v240, 31, v1
    v_lshrrev_b32 v10, 16, v240
    v_or_b32 v240, v240, v10
    v_mov_b32 v229, 0xfffcfffc
    v_mov_b32 v242, 0xffff0000
    s_mov_b32 s42, 0x3f803f80
    s_cmp_lg_u32 s57, 0
    s_cbranch_scc1 fz_nc1
    ds_read_b128 v[16:19], v6 offset:0
    ds_read_b128 v[20:23], v6 offset:1024
    ds_read_b128 v[24:27], v6 offset:2048
    ds_read_b128 v[28:31], v6 offset:3072
    ds_read_b128 v[32:35], v6 offset:4096
    ds_read_b128 v[36:39], v6 offset:5120
    ds_read_b128 v[40:43], v6 offset:6144
    ds_read_b128 v[44:47], v6 offset:7168
    ds_read_b128 v[48:51], v6 offset:8192
    ds_read_b128 v[52:55], v6 offset:9216
    ds_read_b128 v[56:59], v6 offset:10240
    ds_read_b128 v[60:63], v6 offset:11264
    ds_read_b128 v[64:67], v6 offset:12288
    ds_read_b128 v[68:71], v6 offset:13312
    v_lshlrev_b32 v7, 9, v3
    v_bfe_u32 v10, v1, 2, 2
    v_lshl_add_u32 v7, v10, 6, v7
    v_and_b32 v10, 1, v5
    v_lshl_add_u32 v7, v10, 5, v7
    v_and_b32 v10, 3, v1
    v_lshl_add_u32 v7, v10, 3, v7
    v_add_u32 v7, s31, v7
    v_lshlrev_b32 v8, 9, v3
    v_lshl_add_u32 v8, v2, 1, v8
    v_sub_u32 v9, 2048, v8
    v_and_b32 v9, 2047, v9
    v_add_u32 v9, s30, v9
    s_add_u32 s32, s30, 576
    v_sub_u32 v8, s32, v8
    v_cmp_eq_u32 vcc, 0, v2
    s_nop 1
    v_cndmask_b32_e64 v234, 0, -2.0, vcc
    v_mov_b32 v235, 0x3b27c5ac
    s_lshr_b32 s32, s24, 1
    s_lshl_b32 s32, s32, 6
    s_mul_i32 s33, s3, 2304
    s_add_u32 s32, s32, s33
    s_add_u32 s32, s32, 67968
    v_lshl_add_u32 v10, v3, 1, v1
    v_lshlrev_b32 v10, 4, v10
    v_add_u32 v216, s32, v10
    v_bfe_u32 v10, v0, 2, 1
    v_mul_u32_u24 v10, 34, v10
    v_lshrrev_b32 v11, 4, v0
    v_add_u32 v10, v10, v11
    v_lshlrev_b32 v10, 4, v10
    v_bfe_u32 v11, v0, 3, 1
    v_lshl_add_u32 v10, v11, 3, v10
    v_bfe_u32 v11, v0, 1, 1
    v_lshl_add_u32 v10, v11, 2, v10
    v_and_b32 v12, 1, v0
    s_mov_b32 s33, 9216
    s_cmp_eq_u32 s2, 66
    s_cselect_b32 s32, s33, 0x1b40
    v_mul_lo_u32 v11, v12, s32
    v_add_u32 v217, v10, v11
    v_add_u32 v217, 67968, v217
    s_cselect_b32 s32, s33, 0x940
    v_mul_lo_u32 v11, v12, s32
    v_add_u32 v218, v10, v11
    v_add_u32 v218, 70272, v218
    s_cselect_b32 s32, s33, 0xfffff6c0
    v_mul_lo_u32 v11, v12, s32
    v_add_u32 v219, v10, v11
    v_add_u32 v219, 73792, v219
    s_cselect_b32 s32, s33, 0xffffe4c0
    v_mul_lo_u32 v11, v12, s32
    v_add_u32 v220, v10, v11
    v_add_u32 v220, 76096, v220
    v_lshrrev_b32 v10, 2, v0
    v_and_b32 v11, 3, v0
    v_lshlrev_b32 v11, 4, v11
    v_lshl_add_u32 v221, v10, 7, v11
    s_mul_i32 s52, s20, 16512
    s_lshl_b32 s33, s59, 6
    s_add_u32 s52, s52, s33
    s_add_u32 s52, s52, 0x1000
    s_add_u32 s53, s52, 8192
    v_mov_b32 v160, 0
    v_mov_b32 v161, 0
    v_mov_b32 v162, 0
    v_mov_b32 v163, 0
    s_setprio 3
    s_waitcnt vmcnt(0) lgkmcnt(0)
    ds_read_b64_tr_b16 v[88:89], v7 offset:0
    ds_read_b64_tr_b16 v[90:91], v7 offset:256
    ds_read_b64_tr_b16 v[92:93], v7 offset:1024
    ds_read_b64_tr_b16 v[94:95], v7 offset:1280
    ds_read_u16_d16 v96, v9
    ds_read_u16_d16_hi v136, v8 offset:1408
    ds_read_u16_d16 v97, v8 offset:1344
    ds_read_u16_d16_hi v137, v8 offset:1280
    ds_read_u16_d16 v98, v8 offset:1216
    ds_read_u16_d16_hi v138, v8 offset:1152
    ds_read_u16_d16 v99, v8 offset:1088
    ds_read_u16_d16_hi v139, v8 offset:1024
    s_waitcnt lgkmcnt(8)
    v_mfma_f32_32x32x16_bf16 v[104:119], v[88:91], v[16:19], 0
    v_mfma_f32_32x32x16_bf16 v[104:119], v[92:95], v[20:23], v[104:119]
    ds_read_u16_d16 v100, v8 offset:448
    ds_read_u16_d16_hi v140, v8 offset:384
    ds_read_u16_d16 v101, v8 offset:320
    ds_read_u16_d16_hi v141, v8 offset:256
    ds_read_u16_d16 v102, v8 offset:192
    ds_read_u16_d16_hi v142, v8 offset:128
    ds_read_u16_d16 v103, v8 offset:64
    ds_read_u16_d16_hi v143, v8 offset:0
    v_dot2_f32_bf16 v160, v88, s42, v160
    v_dot2_f32_bf16 v161, v88, v88, v161
    v_dot2_f32_bf16 v160, v89, s42, v160
    v_dot2_f32_bf16 v161, v89, v89, v161
    v_dot2_f32_bf16 v160, v90, s42, v160
    v_dot2_f32_bf16 v161, v90, v90, v161
    v_dot2_f32_bf16 v160, v91, s42, v160
    v_dot2_f32_bf16 v161, v91, v91, v161
    v_dot2_f32_bf16 v160, v92, s42, v160
    v_dot2_f32_bf16 v161, v92, v92, v161
    v_dot2_f32_bf16 v160, v93, s42, v160
    v_dot2_f32_bf16 v161, v93, v93, v161
    v_dot2_f32_bf16 v160, v94, s42, v160
    v_dot2_f32_bf16 v161, v94, v94, v161
    v_dot2_f32_bf16 v160, v95, s42, v160
    v_dot2_f32_bf16 v161, v95, v95, v161
    s_waitcnt lgkmcnt(0)
    v_or_b32 v96, v96, v136
    v_or_b32 v97, v97, v137
    v_or_b32 v98, v98, v138
    v_or_b32 v99, v99, v139
    v_or_b32 v100, v100, v140
    v_or_b32 v101, v101, v141
    v_or_b32 v102, v102, v142
    v_or_b32 v103, v103, v143
    v_mfma_f32_32x32x16_bf16 v[120:135], v[96:99], v[16:19], 0
    s_nop 0
    v_mfma_f32_32x32x16_bf16 v[120:135], v[100:103], v[20:23], v[120:135]
    v_dot2_f32_bf16 v162, v96, s42, v162
    v_dot2_f32_bf16 v163, v96, v96, v163
    v_dot2_f32_bf16 v162, v97, s42, v162
    v_dot2_f32_bf16 v163, v97, v97, v163
    v_dot2_f32_bf16 v162, v98, s42, v162
    v_dot2_f32_bf16 v163, v98, v98, v163
    v_dot2_f32_bf16 v162, v99, s42, v162
    v_dot2_f32_bf16 v163, v99, v99, v163
    v_dot2_f32_bf16 v162, v100, s42, v162
    v_dot2_f32_bf16 v163, v100, v100, v163
    v_dot2_f32_bf16 v162, v101, s42, v162
    v_dot2_f32_bf16 v163, v101, v101, v163
    v_dot2_f32_bf16 v162, v102, s42, v162
    v_dot2_f32_bf16 v163, v102, v102, v163
    v_dot2_f32_bf16 v162, v103, s42, v162
    v_dot2_f32_bf16 v163, v103, v103, v163
    s_nop 1
    v_permlane32_swap_b32 v160, v162
    v_permlane32_swap_b32 v161, v163
    v_add_f32 v160, v160, v162
    v_add_f32 v161, v161, v163
    s_nop 1
    v_permlane16_swap_b32 v160, v161
    v_add_f32 v160, v160, v161
    s_nop 1
    v_add_f32_dpp v160, v160, v160 quad_perm:[1,0,3,2] row_mask:0xf bank_mask:0xf
    s_nop 1
    v_add_f32_dpp v160, v160, v160 quad_perm:[2,3,0,1] row_mask:0xf bank_mask:0xf
    s_nop 1
    v_add_f32_dpp v160, v160, v160 row_half_mirror row_mask:0xf bank_mask:0xf
    s_nop 1
    v_add_f32_dpp v160, v160, v160 row_mirror row_mask:0xf bank_mask:0xf
    s_mov_b32 s43, 0x3e800000
    v_mov_b32 v161, v160
    s_nop 1
    v_permlane16_swap_b32 v160, v161
    v_mul_f32 v160, 0x3c800000, v160
    v_fma_f32 v161, v161, s43, v235
    v_fma_f32 v161, -v160, v160, v161
    v_rsq_f32 v161, v161
    s_nop 0
    v_mul_f32 v160, v160, v161
    v_readlane_b32 s32, v161, 0
    v_readlane_b32 s34, v161, 32
    v_readlane_b32 s36, v160, 0
    v_readlane_b32 s37, v160, 32
    s_nop 0
    v_mul_f32 v164, s36, v234
    v_fmac_f32 v164, s37, v234
    v_pk_fma_f32 v[104:105], v[104:105], s[32:33], v[164:165] op_sel_hi:[1,0,0]
    v_pk_fma_f32 v[106:107], v[106:107], s[32:33], v[164:165] op_sel_hi:[1,0,0]
    v_pk_fma_f32 v[108:109], v[108:109], s[32:33], v[164:165] op_sel_hi:[1,0,0]
    v_pk_fma_f32 v[110:111], v[110:111], s[32:33], v[164:165] op_sel_hi:[1,0,0]
    v_pk_fma_f32 v[112:113], v[112:113], s[32:33], v[164:165] op_sel_hi:[1,0,0]
    v_pk_fma_f32 v[114:115], v[114:115], s[32:33], v[164:165] op_sel_hi:[1,0,0]
    v_pk_fma_f32 v[116:117], v[116:117], s[32:33], v[164:165] op_sel_hi:[1,0,0]
    v_pk_fma_f32 v[118:119], v[118:119], s[32:33], v[164:165] op_sel_hi:[1,0,0]
    v_pk_fma_f32 v[104:105], v[120:121], s[34:35], v[104:105] op_sel_hi:[1,0,1]
    v_pk_fma_f32 v[106:107], v[122:123], s[34:35], v[106:107] op_sel_hi:[1,0,1]
    v_pk_fma_f32 v[108:109], v[124:125], s[34:35], v[108:109] op_sel_hi:[1,0,1]
    v_pk_fma_f32 v[110:111], v[126:127], s[34:35], v[110:111] op_sel_hi:[1,0,1]
    v_pk_fma_f32 v[112:113], v[128:129], s[34:35], v[112:113] op_sel_hi:[1,0,1]
    v_pk_fma_f32 v[114:115], v[130:131], s[34:35], v[114:115] op_sel_hi:[1,0,1]
    v_pk_fma_f32 v[116:117], v[132:133], s[34:35], v[116:117] op_sel_hi:[1,0,1]
    v_pk_fma_f32 v[118:119], v[134:135], s[34:35], v[118:119] op_sel_hi:[1,0,1]
    v_cvt_pk_f16_f32 v136, v104, v105
    v_cvt_pk_f16_f32 v137, v106, v107
    v_cvt_pk_f16_f32 v138, v108, v109
    v_cvt_pk_f16_f32 v139, v110, v111
    v_cvt_pk_f16_f32 v140, v112, v113
    v_cvt_pk_f16_f32 v141, v114, v115
    v_cvt_pk_f16_f32 v142, v116, v117
    v_cvt_pk_f16_f32 v143, v118, v119
    v_mov_b32_dpp v152, v136 quad_perm:[1,0,3,2] row_mask:0xf bank_mask:0xf
    v_mov_b32_dpp v153, v137 quad_perm:[1,0,3,2] row_mask:0xf bank_mask:0xf
    v_mov_b32_dpp v154, v138 quad_perm:[1,0,3,2] row_mask:0xf bank_mask:0xf
    v_mov_b32_dpp v155, v139 quad_perm:[1,0,3,2] row_mask:0xf bank_mask:0xf
    v_mov_b32_dpp v156, v140 quad_perm:[1,0,3,2] row_mask:0xf bank_mask:0xf
    v_mov_b32_dpp v157, v141 quad_perm:[1,0,3,2] row_mask:0xf bank_mask:0xf
    v_mov_b32_dpp v158, v142 quad_perm:[1,0,3,2] row_mask:0xf bank_mask:0xf
    v_mov_b32_dpp v159, v143 quad_perm:[1,0,3,2] row_mask:0xf bank_mask:0xf
    v_pk_mul_f16 v144, v136, v24
    v_pk_mul_f16 v145, v137, v25
    v_pk_mul_f16 v146, v138, v26
    v_pk_mul_f16 v147, v139, v27
    v_pk_mul_f16 v148, v140, v28
    v_pk_mul_f16 v149, v141, v29
    v_pk_mul_f16 v150, v142, v30
    v_pk_mul_f16 v151, v143, v31
    v_mfma_f32_16x16x32_f16 v[120:123], v[136:139], v[56:59], 0
    v_pk_fma_f16 v144, v152, v32, v144
    v_pk_fma_f16 v145, v153, v33, v145
    v_pk_fma_f16 v146, v154, v34, v146
    v_pk_fma_f16 v147, v155, v35, v147
    v_mfma_f32_16x16x32_f16 v[120:123], v[140:143], v[60:63], v[120:123]
    v_pk_fma_f16 v148, v156, v36, v148
    v_pk_fma_f16 v149, v157, v37, v149
    v_pk_fma_f16 v150, v158, v38, v150
    v_pk_fma_f16 v151, v159, v39, v151
    v_mfma_f32_32x32x16_f16 v[104:119], v[144:147], v[40:43], 0
    v_xor_b32_dpp v152, v144, v240 quad_perm:[1,0,3,2] row_mask:0xf bank_mask:0xf
    v_xor_b32_dpp v153, v145, v240 quad_perm:[1,0,3,2] row_mask:0xf bank_mask:0xf
    v_xor_b32_dpp v154, v146, v240 quad_perm:[1,0,3,2] row_mask:0xf bank_mask:0xf
    v_xor_b32_dpp v155, v147, v240 quad_perm:[1,0,3,2] row_mask:0xf bank_mask:0xf
    v_mfma_f32_32x32x16_f16 v[104:119], v[148:151], v[44:47], v[104:119]
    v_xor_b32_dpp v156, v148, v240 quad_perm:[1,0,3,2] row_mask:0xf bank_mask:0xf
    v_xor_b32_dpp v157, v149, v240 quad_perm:[1,0,3,2] row_mask:0xf bank_mask:0xf
    v_xor_b32_dpp v158, v150, v240 quad_perm:[1,0,3,2] row_mask:0xf bank_mask:0xf
    v_xor_b32_dpp v159, v151, v240 quad_perm:[1,0,3,2] row_mask:0xf bank_mask:0xf
    v_mfma_f32_32x32x16_f16 v[104:119], v[152:155], v[48:51], v[104:119]
    s_nop 0
    v_mfma_f32_32x32x16_f16 v[104:119], v[156:159], v[52:55], v[104:119]
    v_mfma_f32_16x16x32_f16 v[124:127], v[136:139], v[64:67], 0
    v_mfma_f32_16x16x32_f16 v[124:127], v[140:143], v[68:71], v[124:127]
    v_readfirstlane_b32 s40, v250
    s_nop 1
    s_add_u32 s40, s40, 1
    s_and_b32 s38, s40, 3
    s_and_b32 s39, s40, 15
    s_bfe_u32 s41, s40, 0x20002
    s_lshl_b32 s41, s41, 16
    s_or_b32 s44, s38, s41
    s_bfe_u32 s41, s40, 0x40004
    s_lshl_b32 s41, s41, 4
    s_or_b32 s48, s39, s41
    s_bfe_u32 s41, s40, 0x20004
    s_lshl_b32 s41, s41, 16
    s_or_b32 s45, s38, s41
    s_bfe_u32 s41, s40, 0x40008
    s_lshl_b32 s41, s41, 4
    s_or_b32 s49, s39, s41
    s_bfe_u32 s41, s40, 0x20006
    s_lshl_b32 s41, s41, 16
    s_or_b32 s46, s38, s41
    s_bfe_u32 s41, s40, 0x4000c
    s_lshl_b32 s41, s41, 4
    s_or_b32 s50, s39, s41
    s_bfe_u32 s41, s40, 0x20008
    s_lshl_b32 s41, s41, 16
    s_or_b32 s47, s38, s41
    s_bfe_u32 s41, s40, 0x40010
    s_lshl_b32 s41, s41, 4
    s_or_b32 s51, s39, s41
    s_mov_b32 s38, 0x404
    s_cmp_eq_u32 s2, 66
    s_cselect_b32 s39, 8, 4
    s_cselect_b32 s38, 8, s38
    s_mov_b64 vcc, 0xffff
    v_cvt_pk_f16_f32 v143, v118, v119
    v_cvt_pk_f16_f32 v142, v116, v117
    v_cvt_pk_f16_f32 v141, v114, v115
    v_cvt_pk_f16_f32 v140, v112, v113
    v_cvt_pk_f16_f32 v139, v110, v111
    v_cvt_pk_f16_f32 v138, v108, v109
    v_cvt_pk_f16_f32 v137, v106, v107
    v_cndmask_b32_e64 v104, v104, v121, vcc
    v_cndmask_b32_e64 v105, v105, v125, vcc
    v_pk_add_f16 v147, v142, v143 op_sel:[0,1] op_sel_hi:[1,0] neg_lo:[0,1]
    v_pk_add_f16 v151, v142, v143 op_sel:[0,1] op_sel_hi:[1,0] neg_hi:[1,0]
    v_pk_add_f16 v146, v140, v141 op_sel:[0,1] op_sel_hi:[1,0] neg_lo:[0,1]
    v_pk_add_f16 v150, v140, v141 op_sel:[0,1] op_sel_hi:[1,0] neg_hi:[1,0]
    v_pk_add_f16 v145, v138, v139 op_sel:[0,1] op_sel_hi:[1,0] neg_lo:[0,1]
    v_pk_add_f16 v149, v138, v139 op_sel:[0,1] op_sel_hi:[1,0] neg_hi:[1,0]
    v_cvt_pk_f16_f32 v136, v104, v105
    v_pk_add_f16 v144, v136, v137 op_sel:[0,1] op_sel_hi:[1,0] neg_lo:[0,1]
    v_pk_add_f16 v148, v136, v137 op_sel:[0,1] op_sel_hi:[1,0] neg_hi:[1,0]
    ds_write_b128 v216, v[144:147]
    ds_write_b128 v216, v[148:151] offset:1152
    s_waitcnt lgkmcnt(0)
    v_mov_b32 v10, 1
    s_mov_b64 exec, 1
    ds_add_u32 v15, v10
    s_mov_b64 exec, -1
    s_cmp_gt_u32 s3, 3
    s_cbranch_scc1 fz_bsp0
fz_sy:
    ds_read_b32 v10, v15
    s_waitcnt lgkmcnt(0)
    v_and_b32 v10, 0xff, v10
    v_cmp_ne_u32 vcc, s39, v10
    s_cbranch_vccnz fz_sy
    ds_read_b32 v104, v217 offset:0
    ds_read_b32 v105, v218 offset:0
    ds_read_b32 v106, v219 offset:0
    ds_read_b32 v107, v220 offset:0
    ds_read_b32 v108, v217 offset:256
    ds_read_b32 v109, v218 offset:256
    ds_read_b32 v110, v219 offset:256
    ds_read_b32 v111, v220 offset:256
    s_waitcnt lgkmcnt(4)
    v_pk_add_f16 v112, v104, v106
    v_pk_add_f16 v114, v105, v107
    v_pk_add_f16 v113, v104, v106 neg_lo:[0,1] neg_hi:[0,1]
    v_pk_add_f16 v115, v105, v107 neg_lo:[0,1] neg_hi:[0,1]
    v_pk_add_f16 v116, v112, v114
    v_pk_add_f16 v118, v112, v114 neg_lo:[0,1] neg_hi:[0,1]
    v_pk_add_f16 v117, v113, v115 op_sel:[0,1] op_sel_hi:[1,0] neg_hi:[0,1]
    v_pk_add_f16 v119, v113, v115 op_sel:[0,1] op_sel_hi:[1,0] neg_lo:[0,1]
    v_add_u32 v116, 0x20002, v116
    v_add_u32 v117, 0x20002, v117
    v_add_u32 v118, 0x20002, v118
    v_add_u32 v119, 0x20002, v119
    v_and_or_b32 v116, v116, v229, s44
    v_and_or_b32 v117, v117, v229, s45
    v_and_or_b32 v118, v118, v229, s46
    v_and_or_b32 v119, v119, v229, s47
    buffer_store_dwordx4 v[116:119], v221, s[4:7], s52 offen sc1
    s_waitcnt lgkmcnt(0)
    v_pk_add_f16 v120, v108, v110
    v_pk_add_f16 v122, v109, v111
    v_pk_add_f16 v121, v108, v110 neg_lo:[0,1] neg_hi:[0,1]
    v_pk_add_f16 v123, v109, v111 neg_lo:[0,1] neg_hi:[0,1]
    v_pk_add_f16 v124, v120, v122
    v_pk_add_f16 v126, v120, v122 neg_lo:[0,1] neg_hi:[0,1]
    v_pk_add_f16 v125, v121, v123 op_sel:[0,1] op_sel_hi:[1,0] neg_hi:[0,1]
    v_pk_add_f16 v127, v121, v123 op_sel:[0,1] op_sel_hi:[1,0] neg_lo:[0,1]
    v_add_u32 v124, 0x20002, v124
    v_add_u32 v125, 0x20002, v125
    v_add_u32 v126, 0x20002, v126
    v_add_u32 v127, 0x20002, v127
    v_and_or_b32 v124, v124, v229, s44
    v_and_or_b32 v125, v125, v229, s45
    v_and_or_b32 v126, v126, v229, s46
    v_and_or_b32 v127, v127, v229, s47
    buffer_store_dwordx4 v[124:127], v221, s[4:7], s53 offen sc1
    s_cmp_lg_u32 s59, 0
    s_cbranch_scc1 ffn
    s_and_b32 s32, s3, 3
    s_lshr_b32 s33, s3, 2
    s_lshl_b32 s33, s33, 4
    s_add_u32 s33, s33, s32
    v_and_b32 v8, 12, v4
    v_bfe_u32 v9, v4, 1, 1
    v_lshl_add_u32 v8, v9, 5, v8
    v_add_u32 v8, s33, v8
    v_cvt_f32_u32 v8, v8
    v_and_b32 v12, 1, v1
    v_cvt_f32_u32 v9, v12
    v_lshlrev_b32 v13, 2, v5
    v_cvt_f32_u32 v10, v13
    v_mul_f32 v11, 0x3c800000, v8
    v_mul_f32 v9, 0x3e800000, v9
    v_fma_f32 v9, v11, v10, v9
    v_mov_b32 v128, v9
    v_fmamk_f32 v129, v11, 0x3f800000, v9
    v_fmamk_f32 v130, v11, 0x40000000, v9
    v_fmamk_f32 v131, v11, 0x40400000, v9
    v_mul_f32 v11, 0x3a000000, v8
    v_lshlrev_b32 v9, 31, v1
    v_xor_b32 v11, v9, v11
    v_mul_f32 v9, v11, v10
    v_mov_b32 v112, v9
    v_fmamk_f32 v113, v11, 0x3f800000, v9
    v_fmamk_f32 v114, v11, 0x40000000, v9
    v_fmamk_f32 v115, v11, 0x40400000, v9
    v_fmamk_f32 v116, v11, 0x41800000, v9
    v_fmamk_f32 v117, v11, 0x41880000, v9
    v_fmamk_f32 v118, v11, 0x41900000, v9
    v_fmamk_f32 v119, v11, 0x41980000, v9
    v_cos_f32 v104, v128
    v_sin_f32 v105, v128
    v_cos_f32 v106, v129
    v_sin_f32 v107, v129
    v_cos_f32 v108, v130
    v_sin_f32 v109, v130
    v_cos_f32 v110, v131
    v_sin_f32 v111, v131
    v_sin_f32 v120, v112
    v_sin_f32 v121, v113
    v_sin_f32 v122, v114
    v_sin_f32 v123, v115
    v_sin_f32 v124, v116
    v_sin_f32 v125, v117
    v_sin_f32 v126, v118
    v_sin_f32 v127, v119
    v_cos_f32 v112, v112
    v_cos_f32 v113, v113
    v_cos_f32 v114, v114
    v_cos_f32 v115, v115
    v_cos_f32 v116, v116
    v_cos_f32 v117, v117
    v_cos_f32 v118, v118
    v_cos_f32 v119, v119
    v_cvt_pk_f16_f32 v16, v104, v105
    v_cvt_pk_f16_f32 v17, v106, v107
    v_cvt_pk_f16_f32 v18, v108, v109
    v_cvt_pk_f16_f32 v19, v110, v111
    v_cvt_pk_f16_f32 v20, v112, v113
    v_cvt_pk_f16_f32 v21, v114, v115
    v_cvt_pk_f16_f32 v22, v116, v117
    v_cvt_pk_f16_f32 v23, v118, v119
    v_cvt_pk_f16_f32 v24, v120, v121
    v_cvt_pk_f16_f32 v25, v122, v123
    v_cvt_pk_f16_f32 v26, v124, v125
    v_cvt_pk_f16_f32 v27, v126, v127
    v_lshrrev_b32 v8, 3, v1
    v_mul_u32_u24 v222, 16512, v8
    v_and_b32 v9, 7, v1
    v_lshl_add_u32 v222, v9, 4, v222
    s_mul_i32 s60, s3, 528384
    s_lshl_b32 s32, s20, 7
    s_add_u32 s60, s60, s32
    s_add_u32 s60, s60, 0x1000
    s_add_u32 s61, s60, 132096
    s_add_u32 s16, s60, 264192
    s_add_u32 s17, s60, 396288
    v_lshlrev_b32 v8, 1, v8
    v_bfe_u32 v9, v1, 2, 1
    v_add_u32 v8, v8, v9
    s_lshl_b32 s32, s3, 2
    s_add_u32 s32, s32, 1
    v_lshl_add_u32 v8, v8, 5, s32
    v_cmp_eq_u32 vcc, 1, v12
    v_bfe_u32 v9, v1, 1, 1
    v_mul_u32_u24 v9, 8256, v9
    v_add_u32 v9, 86400, v9
    s_cmp_eq_u32 s3, 3
    s_cselect_b32 s32, 272, 0
    v_sub_u32 v10, 512, v8
    v_cndmask_b32_e64 v10, v8, v10, vcc
    v_and_b32 v11, 16, v10
    v_lshl_add_u32 v11, v11, 6, v9
    v_lshrrev_b32 v12, 7, v10
    v_lshl_add_u32 v11, v12, 8, v11
    v_and_b32 v12, 15, v10
    v_lshl_add_u32 v11, v12, 4, v11
    v_bfe_u32 v12, v10, 5, 2
    v_lshl_add_u32 v223, v12, 2, v11
    v_add_u32 v8, 1, v8
    v_sub_u32 v10, 512, v8
    v_cndmask_b32_e64 v10, v8, v10, vcc
    v_and_b32 v11, 16, v10
    v_lshl_add_u32 v11, v11, 6, v9
    v_lshrrev_b32 v12, 7, v10
    v_lshl_add_u32 v11, v12, 8, v11
    v_and_b32 v12, 15, v10
    v_lshl_add_u32 v11, v12, 4, v11
    v_bfe_u32 v12, v10, 5, 2
    v_lshl_add_u32 v224, v12, 2, v11
    v_add_u32 v8, 1, v8
    v_sub_u32 v10, 512, v8
    v_cndmask_b32_e64 v10, v8, v10, vcc
    v_and_b32 v11, 16, v10
    v_lshl_add_u32 v11, v11, 6, v9
    v_lshrrev_b32 v12, 7, v10
    v_lshl_add_u32 v11, v12, 8, v11
    v_and_b32 v12, 15, v10
    v_lshl_add_u32 v11, v12, 4, v11
    v_bfe_u32 v12, v10, 5, 2
    v_lshl_add_u32 v100, v12, 2, v11
    v_mul_u32_u24 v10, s32, v3
    v_sub_u32 v8, v8, v10
    v_add_u32 v8, 1, v8
    v_sub_u32 v10, 512, v8
    v_cndmask_b32_e64 v10, v8, v10, vcc
    v_lshrrev_b32 v11, 1, v10
    v_and_b32 v11, 256, v11
    v_sub_u32 v10, v10, v11
    v_and_b32 v11, 16, v10
    v_lshl_add_u32 v11, v11, 6, v9
    v_lshrrev_b32 v12, 7, v10
    v_lshl_add_u32 v11, v12, 8, v11
    v_and_b32 v12, 15, v10
    v_lshl_add_u32 v11, v12, 4, v11
    v_bfe_u32 v12, v10, 5, 2
    v_lshl_add_u32 v101, v12, 2, v11
    s_and_b32 s32, s3, 3
    s_lshl_b32 s32, s32, 11
    s_add_u32 s32, s32, 86400
    v_add_u32 v225, s32, v239
    v_add_u32 v8, s33, v13
    v_sub_u32 v9, 32, v8
    v_min_u32 v9, v8, v9
    v_and_b32 v10, 15, v8
    v_cmp_eq_u32 s[32:33], 0, v10
    v_cmp_lt_u32 s[34:35], 16, v8
    v_lshlrev_b32 v10, 10, v9
    v_subrev_u32 v10, 1024, v10
    v_mov_b32 v11, 15872
    v_cmp_eq_u32 vcc, 0, v8
    s_nop 1
    v_cndmask_b32_e64 v10, v10, v11, vcc
    v_and_b32 v11, 3, v1
    v_lshl_add_u32 v10, v11, 4, v10
    v_lshrrev_b32 v11, 2, v4
    v_lshlrev_b32 v12, 7, v11
    v_sub_u32 v13, 960, v12
    v_cndmask_b32_e64 v13, v12, v13, s[34:35]
    v_add_u32 v226, v10, v13
    s_or_b64 s[34:35], s[34:35], s[32:33]
    v_add_u32 v12, 512, v12
    v_sub_u32 v13, 960, v12
    v_cndmask_b32_e64 v13, v12, v13, s[34:35]
    v_add_u32 v227, v10, v13
    s_mul_i32 s56, s20, 16512
    s_add_u32 s56, s56, 0x210000
    v_mov_b32 v249, 0x30003
    v_mov_b32 v252, s44
    v_mov_b32 v253, s45
    v_mov_b32 v254, s46
    v_mov_b32 v255, s47
    s_waitcnt lgkmcnt(0)
    s_waitcnt vmcnt(0)
    buffer_load_dwordx4 v[104:107], v222, s[4:7], s60 offen sc1
    buffer_load_dwordx4 v[108:111], v222, s[4:7], s61 offen sc1
    buffer_load_dwordx4 v[112:115], v222, s[4:7], s16 offen sc1
    buffer_load_dwordx4 v[116:119], v222, s[4:7], s17 offen sc1
fz_h1_c0:
    s_waitcnt vmcnt(3)
    v_xor_b32 v104, v252, v104
    v_xor_b32 v105, v253, v105
    v_xor_b32 v106, v254, v106
    v_xor_b32 v107, v255, v107
    v_or3_b32 v10, v104, v105, v106
    v_bitop3_b32 v10, v10, v107, v249 bitop3:0xa8
    v_cmp_ne_u32 vcc, 0, v10
    s_cbranch_vccnz fz_h1_r0
fz_h1_o0:
    ds_write_b32 v223, v104 offset:0
    ds_write_b32 v223, v105 offset:2048
    ds_write_b32 v223, v106 offset:4096
    ds_write_b32 v223, v107 offset:6144
fz_h1_c1:
    s_waitcnt vmcnt(2)
    v_xor_b32 v108, v252, v108
    v_xor_b32 v109, v253, v109
    v_xor_b32 v110, v254, v110
    v_xor_b32 v111, v255, v111
    v_or3_b32 v10, v108, v109, v110
    v_bitop3_b32 v10, v10, v111, v249 bitop3:0xa8
    v_cmp_ne_u32 vcc, 0, v10
    s_cbranch_vccnz fz_h1_r1
fz_h1_o1:
    ds_write_b32 v224, v108 offset:0
    ds_write_b32 v224, v109 offset:2048
    ds_write_b32 v224, v110 offset:4096
    ds_write_b32 v224, v111 offset:6144
fz_h1_c2:
    s_waitcnt vmcnt(1)
    v_xor_b32 v112, v252, v112
    v_xor_b32 v113, v253, v113
    v_xor_b32 v114, v254, v114
    v_xor_b32 v115, v255, v115
    v_or3_b32 v10, v112, v113, v114
    v_bitop3_b32 v10, v10, v115, v249 bitop3:0xa8
    v_cmp_ne_u32 vcc, 0, v10
    s_cbranch_vccnz fz_h1_r2
fz_h1_o2:
    ds_write_b32 v100, v112 offset:0
    ds_write_b32 v100, v113 offset:2048
    ds_write_b32 v100, v114 offset:4096
    ds_write_b32 v100, v115 offset:6144
fz_h1_c3:
    s_waitcnt vmcnt(0)
    v_xor_b32 v116, v252, v116
    v_xor_b32 v117, v253, v117
    v_xor_b32 v118, v254, v118
    v_xor_b32 v119, v255, v119
    v_or3_b32 v10, v116, v117, v118
    v_bitop3_b32 v10, v10, v119, v249 bitop3:0xa8
    v_cmp_ne_u32 vcc, 0, v10
    s_cbranch_vccnz fz_h1_r3
fz_h1_o3:
    ds_write_b32 v101, v116 offset:0
    ds_write_b32 v101, v117 offset:2048
    ds_write_b32 v101, v118 offset:4096
    ds_write_b32 v101, v119 offset:6144
    s_waitcnt lgkmcnt(0)
    s_setprio 0
fz_hb:
    s_barrier
    ds_read_b128 v[104:107], v225 offset:0
    ds_read_b128 v[108:111], v225 offset:1024
    ds_read_b128 v[112:115], v225 offset:8256
    ds_read_b128 v[116:119], v225 offset:9280
    ds_read_b128 v[72:75], v6 offset:14336
    ds_read_b128 v[76:79], v6 offset:15360
    ds_read_b128 v[80:83], v6 offset:16384
    ds_read_b128 v[84:87], v6 offset:17408
    s_waitcnt lgkmcnt(7)
    v_mfma_f32_16x16x32_f16 v[120:123], v[104:107], v[16:19], 0
    s_waitcnt lgkmcnt(6)
    v_mfma_f32_16x16x32_f16 v[124:127], v[108:111], v[16:19], 0
    s_waitcnt lgkmcnt(5)
    v_mfma_f32_16x16x32_f16 v[128:131], v[112:115], v[16:19], 0
    s_waitcnt lgkmcnt(4)
    v_mfma_f32_16x16x32_f16 v[132:135], v[116:119], v[16:19], 0
    s_waitcnt lgkmcnt(0)
    s_nop 0
    v_cvt_pk_f16_f32 v136, v120, v121
    v_cvt_pk_f16_f32 v137, v122, v123
    v_cvt_pk_f16_f32 v138, v124, v125
    v_cvt_pk_f16_f32 v139, v126, v127
    v_cvt_pk_f16_f32 v140, v128, v129
    v_cvt_pk_f16_f32 v141, v130, v131
    v_cvt_pk_f16_f32 v142, v132, v133
    v_cvt_pk_f16_f32 v143, v134, v135
    v_pk_mul_f16 v144, v136, v20
    v_pk_mul_f16 v145, v137, v21
    v_pk_mul_f16 v146, v138, v22
    v_pk_mul_f16 v147, v139, v23
    v_mov_b32_dpp v152, v136 quad_perm:[1,0,3,2] row_mask:0xf bank_mask:0xf
    v_mov_b32_dpp v153, v137 quad_perm:[1,0,3,2] row_mask:0xf bank_mask:0xf
    v_mov_b32_dpp v154, v138 quad_perm:[1,0,3,2] row_mask:0xf bank_mask:0xf
    v_mov_b32_dpp v155, v139 quad_perm:[1,0,3,2] row_mask:0xf bank_mask:0xf
    v_pk_fma_f16 v144, v152, v24, v144
    v_pk_fma_f16 v145, v153, v25, v145
    v_pk_fma_f16 v146, v154, v26, v146
    v_pk_fma_f16 v147, v155, v27, v147
    s_nop 1
    v_mfma_f32_16x16x32_f16 v[104:107], v[144:147], v[72:75], 0
    v_mfma_f32_16x16x32_f16 v[108:111], v[144:147], v[80:83], 0
    v_xor_b32_dpp v152, v144, v240 quad_perm:[1,0,3,2] row_mask:0xf bank_mask:0xf
    v_xor_b32_dpp v153, v145, v240 quad_perm:[1,0,3,2] row_mask:0xf bank_mask:0xf
    v_xor_b32_dpp v154, v146, v240 quad_perm:[1,0,3,2] row_mask:0xf bank_mask:0xf
    v_xor_b32_dpp v155, v147, v240 quad_perm:[1,0,3,2] row_mask:0xf bank_mask:0xf
    s_nop 1
    v_mfma_f32_16x16x32_f16 v[104:107], v[152:155], v[76:79], v[104:107]
    v_mfma_f32_16x16x32_f16 v[108:111], v[152:155], v[84:87], v[108:111]
    v_pk_mul_f16 v148, v140, v20
    v_pk_mul_f16 v149, v141, v21
    v_pk_mul_f16 v150, v142, v22
    v_pk_mul_f16 v151, v143, v23
    v_mov_b32_dpp v156, v140 quad_perm:[1,0,3,2] row_mask:0xf bank_mask:0xf
    v_mov_b32_dpp v157, v141 quad_perm:[1,0,3,2] row_mask:0xf bank_mask:0xf
    v_mov_b32_dpp v158, v142 quad_perm:[1,0,3,2] row_mask:0xf bank_mask:0xf
    v_mov_b32_dpp v159, v143 quad_perm:[1,0,3,2] row_mask:0xf bank_mask:0xf
    v_pk_fma_f16 v148, v156, v24, v148
    v_pk_fma_f16 v149, v157, v25, v149
    v_pk_fma_f16 v150, v158, v26, v150
    v_pk_fma_f16 v151, v159, v27, v151
    s_nop 1
    v_mfma_f32_16x16x32_f16 v[112:115], v[148:151], v[72:75], 0
    v_mfma_f32_16x16x32_f16 v[116:119], v[148:151], v[80:83], 0
    v_xor_b32_dpp v156, v148, v240 quad_perm:[1,0,3,2] row_mask:0xf bank_mask:0xf
    v_xor_b32_dpp v157, v149, v240 quad_perm:[1,0,3,2] row_mask:0xf bank_mask:0xf
    v_xor_b32_dpp v158, v150, v240 quad_perm:[1,0,3,2] row_mask:0xf bank_mask:0xf
    v_xor_b32_dpp v159, v151, v240 quad_perm:[1,0,3,2] row_mask:0xf bank_mask:0xf
    s_nop 1
    v_mfma_f32_16x16x32_f16 v[112:115], v[156:159], v[76:79], v[112:115]
    v_mfma_f32_16x16x32_f16 v[116:119], v[156:159], v[84:87], v[116:119]
    v_cvt_pk_f16_f32 v120, v104, v105
    v_cvt_pk_f16_f32 v122, v106, v107
    s_nop 4
    v_cvt_pk_f16_f32 v121, v112, v113
    v_cvt_pk_f16_f32 v123, v114, v115
    v_add_u32 v120, 0x20002, v120
    v_add_u32 v121, 0x20002, v121
    v_add_u32 v122, 0x20002, v122
    v_add_u32 v123, 0x20002, v123
    v_and_or_b32 v120, v120, v229, s44
    v_and_or_b32 v121, v121, v229, s45
    v_and_or_b32 v122, v122, v229, s46
    v_and_or_b32 v123, v123, v229, s47
    buffer_store_dwordx4 v[120:123], v226, s[4:7], s56 offen sc1
    v_cvt_pk_f16_f32 v124, v108, v109
    v_cvt_pk_f16_f32 v126, v110, v111
    v_cvt_pk_f16_f32 v125, v116, v117
    v_cvt_pk_f16_f32 v127, v118, v119
    v_add_u32 v124, 0x20002, v124
    v_add_u32 v125, 0x20002, v125
    v_add_u32 v126, 0x20002, v126
    v_add_u32 v127, 0x20002, v127
    v_and_or_b32 v124, v124, v229, s44
    v_and_or_b32 v125, v125, v229, s45
    v_and_or_b32 v126, v126, v229, s46
    v_and_or_b32 v127, v127, v229, s47
    buffer_store_dwordx4 v[124:127], v227, s[4:7], s56 offen sc1
    s_cmp_lg_u32 s57, 0
    s_cbranch_scc1 fz_nc3
    v_sub_u32 v8, 15, v4
    v_min_u32 v8, v4, v8
    v_and_b32 v9, 1, v8
    v_lshlrev_b32 v9, 5, v9
    v_lshrrev_b32 v10, 1, v8
    v_lshl_add_u32 v9, v10, 9, v9
    v_add_u32 v9, s25, v9
    v_sub_u32 v10, 2048, v9
    v_cmp_lt_u32 s[34:35], 7, v4
    s_nop 1
    v_cndmask_b32_e64 v230, v9, v10, s[34:35]
    v_mov_b32 v9, v4
    v_mov_b32 v10, s20
    s_cmp_lg_u32 s21, 0
    s_cbranch_scc0 fz_spec3a
fz_spec3backa:
    v_lshlrev_b32 v10, 7, v10
    v_lshl_add_u32 v10, v9, 3, v10
    v_mul_u32_u24 v11, 66048, v5
    v_add_u32 v228, v10, v11
    v_and_b32 v9, 1, v9
    v_cmp_eq_u32 vcc, 1, v9
    v_mov_b32 v9, s44
    v_mov_b32 v10, s46
    v_cndmask_b32_e64 v236, v9, v10, vcc
    v_mov_b32 v9, s45
    v_mov_b32 v10, s47
    v_cndmask_b32_e64 v237, v9, v10, vcc
    s_lshl_b32 s32, s3, 2
    v_add_u32 v8, s32, v5
    v_lshlrev_b32 v9, 6, v8
    v_cmp_gt_u32 vcc, 16, v8
    s_nop 1
    v_cndmask_b32_e64 v10, 0, 32, vcc
    v_add_u32 v10, v9, v10
    v_sub_u32 v11, 2048, v10
    v_cmp_eq_u32 vcc, 16, v8
    s_nop 1
    v_cndmask_b32_e64 v11, v11, 0, vcc
    v_mov_b32 v12, 0xffff0000
    v_cndmask_b32_e64 v238, -1, v12, vcc
    v_sub_u32 v12, 2018, v9
    v_mul_u32_u24 v13, 2064, v4
    v_add_u32 v231, v13, v9
    v_add_u32 v232, v13, v12
    v_add_u32 v233, v13, v10
    v_add_u32 v241, v13, v11
    s_lshl_b32 s32, s3, 8
    s_add_u32 s32, s32, 102912
    v_lshlrev_b32 v9, 4, v4
    v_add_u32 v10, s32, v9
    v_add_u32 v11, 107008, v239
    v_cmp_gt_u32 vcc, 16, v1
    s_nop 1
    v_cndmask_b32_e64 v243, v11, v10, vcc
    v_lshrrev_b32 v12, 2, v4
    v_cmp_eq_u32 vcc, v12, v5
    s_nop 1
    v_cndmask_b32_e64 v244, v11, v10, vcc
    v_lshrrev_b32 v12, 5, v1
    v_lshl_add_u32 v10, v12, 10, v9
    v_add_u32 v245, 102912, v10
    v_and_b32 v9, 1, v1
    v_cmp_eq_u32 s[28:29], 1, v9
    v_and_b32 v9, 2, v1
    v_cmp_eq_u32 s[30:31], 2, v9
    s_lshl_b32 s37, s3, 2
    v_add_u32 v9, s37, v5
    v_mul_u32_u24 v246, 2176, v9
    s_lshl_b32 s26, s20, 4
    s_add_u32 s26, s26, 0x580000
    v_lshlrev_b32 v247, 4, v5
    s_lshl_b32 s27, s20, 11
    s_lshl_b32 s37, s3, 8
    s_add_u32 s27, s27, s37
    s_add_u32 s27, s27, 0x448000
    v_sub_u32 v248, 2047, v230
    s_mov_b32 s14, 0x400000
    s_mov_b32 s15, 0x00020000
    s_mul_i32 s52, s3, 264192
    s_add_u32 s52, s52, 0x210000
    s_add_u32 s53, s52, 16512
    s_add_u32 s54, s52, 33024
    s_add_u32 s55, s52, 49536
    s_mov_b32 s23, s63
    s_getreg_b32 s24, hwreg(HW_REG_XCC_ID)
    s_and_b32 s24, s24, 15
    v_lshlrev_b32 v10, 4, v0
    v_min_u32 v10, 4336, v10
    v_add_u32 v10, 108032, v10
    v_mov_b32 v104, 0
    v_mov_b32 v105, 0
    v_mov_b32 v106, 0
    v_mov_b32 v107, 0
    ds_write_b128 v10, v[104:107]
    s_mov_b32 s58, 0
    s_waitcnt vmcnt(0)
    buffer_load_dwordx2 v[104:105], v228, s[4:7], s52 offen sc1
    buffer_load_dwordx2 v[106:107], v228, s[4:7], s53 offen sc1
    buffer_load_dwordx2 v[108:109], v228, s[4:7], s54 offen sc1
    buffer_load_dwordx2 v[110:111], v228, s[4:7], s55 offen sc1
    ds_read_b128 v[116:119], v231
    ds_read_b128 v[120:123], v231 offset:16
    ds_read_u16_d16_hi v44, v241
    ds_read_u16_d16_hi v45, v232 offset:28
    ds_read_u16_d16_hi v46, v232 offset:26
    ds_read_u16_d16_hi v47, v232 offset:24
    ds_read_u16_d16_hi v48, v232 offset:22
    ds_read_u16_d16_hi v49, v232 offset:20
    ds_read_u16_d16_hi v50, v232 offset:18
    ds_read_u16_d16_hi v51, v232 offset:16
    ds_read_u16_d16_hi v52, v232 offset:14
    ds_read_u16_d16_hi v53, v232 offset:12
    ds_read_u16_d16_hi v54, v232 offset:10
    ds_read_u16_d16_hi v55, v232 offset:8
    ds_read_u16_d16_hi v56, v232 offset:6
    ds_read_u16_d16_hi v57, v232 offset:4
    ds_read_u16_d16_hi v58, v232 offset:2
    ds_read_u16_d16_hi v59, v232 offset:0
    ds_read_u16_d16_hi v28, v233
    v_mul_u32_u24 v13, 2064, v4
    v_subrev_u32 v13, 104960, v13
    v_sub_u32 v9, v231, v13
    v_sub_u32 v10, v233, v13
    v_sub_u32 v11, v241, v13
    v_sub_u32 v12, v232, v13
    s_mov_b32 s36, 0xffff0000
    s_waitcnt lgkmcnt(0)
    ds_read_b128 v[200:203], v9
    ds_read_b128 v[204:207], v9 offset:16
    ds_read_u16_d16 v208, v11
    ds_read_u16_d16_hi v124, v12 offset:28
    ds_read_u16_d16 v209, v12 offset:26
    ds_read_u16_d16_hi v125, v12 offset:24
    ds_read_u16_d16 v210, v12 offset:22
    ds_read_u16_d16_hi v126, v12 offset:20
    ds_read_u16_d16 v211, v12 offset:18
    ds_read_u16_d16_hi v127, v12 offset:16
    ds_read_u16_d16 v212, v12 offset:14
    ds_read_u16_d16_hi v128, v12 offset:12
    ds_read_u16_d16 v213, v12 offset:10
    ds_read_u16_d16_hi v129, v12 offset:8
    ds_read_u16_d16 v214, v12 offset:6
    ds_read_u16_d16_hi v130, v12 offset:4
    ds_read_u16_d16 v215, v12 offset:2
    ds_read_u16_d16_hi v131, v12 offset:0
    ds_read_u16_d16 v13, v10
    v_and_b32 v29, s36, v116
    v_lshlrev_b32 v30, 16, v117
    v_and_b32 v31, s36, v117
    v_lshlrev_b32 v32, 16, v118
    v_and_b32 v33, s36, v118
    v_lshlrev_b32 v34, 16, v119
    v_and_b32 v35, s36, v119
    v_lshlrev_b32 v36, 16, v120
    v_and_b32 v37, s36, v120
    v_lshlrev_b32 v38, 16, v121
    v_and_b32 v39, s36, v121
    v_lshlrev_b32 v40, 16, v122
    v_and_b32 v41, s36, v122
    v_lshlrev_b32 v42, 16, v123
    v_and_b32 v43, s36, v123
    v_cmp_eq_u32 vcc, 1, v4
    v_mov_b32 v9, s42
    s_nop 0
    v_cndmask_b32_e64 v9, 0, v9, vcc
    v_mov_b32 v116, s42
    v_mov_b32 v117, s42
    v_mov_b32 v118, s42
    v_mov_b32 v119, s42
    v_cmp_eq_u32 vcc, 0, v4
    s_waitcnt lgkmcnt(0)
    v_and_or_b32 v200, v200, s36, v13
    v_or_b32 v208, v208, v124
    v_or_b32 v209, v209, v125
    v_or_b32 v210, v210, v126
    v_or_b32 v211, v211, v127
    v_or_b32 v212, v212, v128
    v_or_b32 v213, v213, v129
    v_or_b32 v214, v214, v130
    v_or_b32 v215, v215, v131
    v_cndmask_b32_e64 v200, v9, v200, vcc
    v_cndmask_b32_e64 v201, v9, v201, vcc
    v_cndmask_b32_e64 v202, v9, v202, vcc
    v_cndmask_b32_e64 v203, v9, v203, vcc
    v_cndmask_b32_e64 v204, v9, v204, vcc
    v_cndmask_b32_e64 v205, v9, v205, vcc
    v_cndmask_b32_e64 v206, v9, v206, vcc
    v_cndmask_b32_e64 v207, v9, v207, vcc
    v_cndmask_b32_e64 v208, v9, v208, vcc
    v_cndmask_b32_e64 v209, v9, v209, vcc
    v_cndmask_b32_e64 v210, v9, v210, vcc
    v_cndmask_b32_e64 v211, v9, v211, vcc
    v_cndmask_b32_e64 v212, v9, v212, vcc
    v_cndmask_b32_e64 v213, v9, v213, vcc
    v_cndmask_b32_e64 v214, v9, v214, vcc
    v_cndmask_b32_e64 v215, v9, v215, vcc
    v_mfma_f32_16x16x32_bf16 v[120:123], v[200:203], v[116:119], 0
    v_mfma_f32_16x16x32_bf16 v[120:123], v[204:207], v[116:119], v[120:123]
    v_mfma_f32_16x16x32_bf16 v[120:123], v[208:211], v[116:119], v[120:123]
    v_mfma_f32_16x16x32_bf16 v[120:123], v[212:215], v[116:119], v[120:123]
    s_nop 7
    ds_write_b32 v243, v120 offset:12
    s_branch fz_h2c
fz_h2:
    buffer_load_dwordx2 v[104:105], v228, s[4:7], s52 offen sc1
    buffer_load_dwordx2 v[106:107], v228, s[4:7], s53 offen sc1
    buffer_load_dwordx2 v[108:109], v228, s[4:7], s54 offen sc1
    buffer_load_dwordx2 v[110:111], v228, s[4:7], s55 offen sc1
fz_h2c:
    s_mov_b32 s36, 0x43000000
fz_h2_c0:
    s_waitcnt vmcnt(3)
    v_xor_b32 v104, v236, v104
    v_xor_b32 v105, v237, v105
    v_bitop3_b32 v9, v104, v105, v249 bitop3:0xa8
    v_cmp_ne_u32 vcc, 0, v9
    s_cbranch_vccnz fz_h2_r0
fz_h2_o0:
    v_fma_mix_f32 v28, v104, s36, v28 op_sel:[0,0,0] op_sel_hi:[1,0,0]
    v_fma_mix_f32 v29, v104, s36, v29 op_sel:[1,0,0] op_sel_hi:[1,0,0]
    v_fma_mix_f32 v30, v105, s36, v30 op_sel:[0,0,0] op_sel_hi:[1,0,0]
    v_fma_mix_f32 v31, v105, s36, v31 op_sel:[1,0,0] op_sel_hi:[1,0,0]
    v_mov_b32_dpp v112, v104 row_mirror row_mask:0xf bank_mask:0xf
    v_mov_b32_dpp v113, v105 row_mirror row_mask:0xf bank_mask:0xf
fz_h2_c1:
    s_waitcnt vmcnt(2)
    v_xor_b32 v106, v236, v106
    v_xor_b32 v107, v237, v107
    v_bitop3_b32 v9, v106, v107, v249 bitop3:0xa8
    v_cmp_ne_u32 vcc, 0, v9
    s_cbranch_vccnz fz_h2_r1
fz_h2_o1:
    v_fma_mix_f32 v32, v106, s36, v32 op_sel:[0,0,0] op_sel_hi:[1,0,0]
    v_fma_mix_f32 v33, v106, s36, v33 op_sel:[1,0,0] op_sel_hi:[1,0,0]
    v_fma_mix_f32 v34, v107, s36, v34 op_sel:[0,0,0] op_sel_hi:[1,0,0]
    v_fma_mix_f32 v35, v107, s36, v35 op_sel:[1,0,0] op_sel_hi:[1,0,0]
    v_mov_b32_dpp v114, v106 row_mirror row_mask:0xf bank_mask:0xf
    v_mov_b32_dpp v115, v107 row_mirror row_mask:0xf bank_mask:0xf
fz_h2_c2:
    s_waitcnt vmcnt(1)
    v_xor_b32 v108, v236, v108
    v_xor_b32 v109, v237, v109
    v_bitop3_b32 v9, v108, v109, v249 bitop3:0xa8
    v_cmp_ne_u32 vcc, 0, v9
    s_cbranch_vccnz fz_h2_r2
fz_h2_o2:
    v_fma_mix_f32 v36, v108, s36, v36 op_sel:[0,0,0] op_sel_hi:[1,0,0]
    v_fma_mix_f32 v37, v108, s36, v37 op_sel:[1,0,0] op_sel_hi:[1,0,0]
    v_fma_mix_f32 v38, v109, s36, v38 op_sel:[0,0,0] op_sel_hi:[1,0,0]
    v_fma_mix_f32 v39, v109, s36, v39 op_sel:[1,0,0] op_sel_hi:[1,0,0]
    v_mov_b32_dpp v116, v108 row_mirror row_mask:0xf bank_mask:0xf
    v_mov_b32_dpp v117, v109 row_mirror row_mask:0xf bank_mask:0xf
fz_h2_c3:
    s_waitcnt vmcnt(0)
    v_xor_b32 v110, v236, v110
    v_xor_b32 v111, v237, v111
    v_bitop3_b32 v9, v110, v111, v249 bitop3:0xa8
    v_cmp_ne_u32 vcc, 0, v9
    s_cbranch_vccnz fz_h2_r3
fz_h2_o3:
    v_fma_mix_f32 v40, v110, s36, v40 op_sel:[0,0,0] op_sel_hi:[1,0,0]
    v_fma_mix_f32 v41, v110, s36, v41 op_sel:[1,0,0] op_sel_hi:[1,0,0]
    v_fma_mix_f32 v42, v111, s36, v42 op_sel:[0,0,0] op_sel_hi:[1,0,0]
    v_fma_mix_f32 v43, v111, s36, v43 op_sel:[1,0,0] op_sel_hi:[1,0,0]
    v_mov_b32_dpp v118, v110 row_mirror row_mask:0xf bank_mask:0xf
    v_mov_b32_dpp v119, v111 row_mirror row_mask:0xf bank_mask:0xf
    s_cmp_eq_u32 s2, 66
    s_cbranch_scc1 fz_spec4
fz_spec4back:
    v_cvt_pk_bf16_f32 v120, v28, v29
    v_cvt_pk_bf16_f32 v121, v30, v31
    v_cvt_pk_bf16_f32 v122, v32, v33
    v_cvt_pk_bf16_f32 v123, v34, v35
    v_cvt_pk_bf16_f32 v124, v36, v37
    v_cvt_pk_bf16_f32 v125, v38, v39
    v_cvt_pk_bf16_f32 v126, v40, v41
    v_cvt_pk_bf16_f32 v127, v42, v43
    v_and_b32 v112, v238, v112
    v_mfma_f32_16x16x32_bf16 v[136:139], v[120:123], v[120:123], 0
    v_mfma_f32_16x16x32_bf16 v[140:143], v[200:203], v[120:123], 0
    v_mfma_f32_16x16x32_bf16 v[136:139], v[124:127], v[124:127], v[136:139]
    v_mfma_f32_16x16x32_bf16 v[140:143], v[204:207], v[124:127], v[140:143]
    v_fma_mix_f32 v44, v112, s36, v44 op_sel:[0,0,0] op_sel_hi:[1,0,0]
    v_fma_mix_f32 v45, v112, s36, v45 op_sel:[1,0,0] op_sel_hi:[1,0,0]
    v_fma_mix_f32 v46, v113, s36, v46 op_sel:[0,0,0] op_sel_hi:[1,0,0]
    v_fma_mix_f32 v47, v113, s36, v47 op_sel:[1,0,0] op_sel_hi:[1,0,0]
    v_fma_mix_f32 v48, v114, s36, v48 op_sel:[0,0,0] op_sel_hi:[1,0,0]
    v_fma_mix_f32 v49, v114, s36, v49 op_sel:[1,0,0] op_sel_hi:[1,0,0]
    v_fma_mix_f32 v50, v115, s36, v50 op_sel:[0,0,0] op_sel_hi:[1,0,0]
    v_fma_mix_f32 v51, v115, s36, v51 op_sel:[1,0,0] op_sel_hi:[1,0,0]
    v_fma_mix_f32 v52, v116, s36, v52 op_sel:[0,0,0] op_sel_hi:[1,0,0]
    v_fma_mix_f32 v53, v116, s36, v53 op_sel:[1,0,0] op_sel_hi:[1,0,0]
    v_fma_mix_f32 v54, v117, s36, v54 op_sel:[0,0,0] op_sel_hi:[1,0,0]
    v_fma_mix_f32 v55, v117, s36, v55 op_sel:[1,0,0] op_sel_hi:[1,0,0]
    v_fma_mix_f32 v56, v118, s36, v56 op_sel:[0,0,0] op_sel_hi:[1,0,0]
    v_fma_mix_f32 v57, v118, s36, v57 op_sel:[1,0,0] op_sel_hi:[1,0,0]
    v_fma_mix_f32 v58, v119, s36, v58 op_sel:[0,0,0] op_sel_hi:[1,0,0]
    v_fma_mix_f32 v59, v119, s36, v59 op_sel:[1,0,0] op_sel_hi:[1,0,0]
    v_cvt_pk_bf16_f32 v128, v44, v45
    v_cvt_pk_bf16_f32 v129, v46, v47
    v_cvt_pk_bf16_f32 v130, v48, v49
    v_cvt_pk_bf16_f32 v131, v50, v51
    v_cvt_pk_bf16_f32 v132, v52, v53
    v_cvt_pk_bf16_f32 v133, v54, v55
    v_cvt_pk_bf16_f32 v134, v56, v57
    v_cvt_pk_bf16_f32 v135, v58, v59
    v_mfma_f32_16x16x32_bf16 v[136:139], v[128:131], v[128:131], v[136:139]
    v_mfma_f32_16x16x32_bf16 v[140:143], v[208:211], v[128:131], v[140:143]
    v_mfma_f32_16x16x32_bf16 v[136:139], v[132:135], v[132:135], v[136:139]
    v_mfma_f32_16x16x32_bf16 v[140:143], v[212:215], v[132:135], v[140:143]
    s_nop 6
    v_cndmask_b32_e64 v9, v136, v137, s[28:29]
    v_cndmask_b32_e64 v10, v138, v139, s[28:29]
    ds_write_b64 v243, v[140:141]
    v_cndmask_b32_e64 v9, v9, v10, s[30:31]
    ds_write_b32 v244, v9 offset:8
    s_cmp_gt_u32 s3, 3
    s_cbranch_scc1 fz_lp
    s_setprio 2
fz_lp:
    s_waitcnt lgkmcnt(0)
    s_barrier
    ds_read_b128 v[144:147], v245 offset:0
    ds_read_b128 v[148:151], v245 offset:256
    ds_read_b128 v[152:155], v245 offset:512
    ds_read_b128 v[156:159], v245 offset:768
    s_waitcnt lgkmcnt(2)
    v_pk_add_f32 v[144:145], v[144:145], v[148:149]
    v_pk_add_f32 v[146:147], v[146:147], v[150:151]
    s_waitcnt lgkmcnt(0)
    v_pk_add_f32 v[152:153], v[152:153], v[156:157]
    v_pk_add_f32 v[154:155], v[154:155], v[158:159]
    v_pk_add_f32 v[144:145], v[144:145], v[152:153]
    v_pk_add_f32 v[146:147], v[146:147], v[154:155]
    v_mov_b32 v148, v144
    v_mov_b32 v149, v145
    v_mov_b32 v150, v146
    v_mov_b32 v151, v147
    v_permlane32_swap_b32 v144, v148
    v_permlane32_swap_b32 v145, v149
    v_permlane32_swap_b32 v146, v150
    v_permlane32_swap_b32 v147, v151
    v_pk_add_f32 v[144:145], v[144:145], v[148:149]
    v_pk_add_f32 v[146:147], v[146:147], v[150:151]
    v_mul_f32 v145, 0xba800000, v145
    v_mul_f32 v146, 0x3a800000, v146
    v_fma_f32 v146, -v145, v145, v146
    v_cvt_pk_bf16_f32 v153, 0, v145
    v_cvt_pk_bf16_f32 v146, 0, v146
    v_add_f32 v146, 0x3727c5ac, v146
    v_cvt_pk_bf16_f32 v146, 0, v146
    v_sqrt_f32 v146, v146
    v_fmac_f32 v144, v153, v147
    v_cvt_pk_bf16_f32 v146, 0, v146
    v_rcp_f32 v154, v146
    v_mov_b32 v155, s40
    v_mul_f32 v144, v144, v154
    v_cvt_pk_bf16_f32 v144, 0, v144
    v_ashrrev_i32 v145, 31, v144
    v_or_b32 v145, 0x80000000, v145
    v_bitop3_b32 v152, v144, v145, v242 bitop3:0x28
    v_or_b32 v152, v152, v248
    s_nop 1
    v_max_u32_dpp v144, v152, v152 row_ror:1 row_mask:0xf bank_mask:0xf
    s_nop 1
    v_max_u32_dpp v144, v144, v144 row_ror:2 row_mask:0xf bank_mask:0xf
    s_nop 1
    v_max_u32_dpp v144, v144, v144 row_ror:4 row_mask:0xf bank_mask:0xf
    s_nop 1
    v_max_u32_dpp v144, v144, v144 row_ror:8 row_mask:0xf bank_mask:0xf
    v_cmp_eq_u32 vcc, v144, v152
    v_or_b32 v153, s24, v153
    s_nop 0
    s_mov_b64 exec, vcc
    buffer_store_dwordx4 v[152:155], v246, s[4:7], s26 offen sc1
    s_add_u32 s26, s26, 69632
    buffer_store_dwordx4 v[152:155], v246, s[4:7], s26 offen sc1
    buffer_store_dwordx4 v[120:123], v247, s[4:7], s27 offen offset:0 sc1
    buffer_store_dwordx4 v[124:127], v247, s[4:7], s27 offen offset:64 sc1
    buffer_store_dwordx4 v[128:131], v247, s[4:7], s27 offen offset:128 sc1
    buffer_store_dwordx4 v[132:135], v247, s[4:7], s27 offen offset:192 sc1
    s_mov_b64 exec, -1
    s_setprio 0
    s_ff1_i32_b64 s37, vcc
    v_add_f32 v144, 1.0, v154
    v_and_b32 v146, v242, v153
    v_mul_f32 v146, v146, v154
    v_pk_fma_f32 v[28:29], v[28:29], v[144:145], v[146:147] op_sel_hi:[1,0,0]
    v_pk_fma_f32 v[30:31], v[30:31], v[144:145], v[146:147] op_sel_hi:[1,0,0]
    v_pk_fma_f32 v[32:33], v[32:33], v[144:145], v[146:147] op_sel_hi:[1,0,0]
    v_pk_fma_f32 v[34:35], v[34:35], v[144:145], v[146:147] op_sel_hi:[1,0,0]
    v_pk_fma_f32 v[36:37], v[36:37], v[144:145], v[146:147] op_sel_hi:[1,0,0]
    v_pk_fma_f32 v[38:39], v[38:39], v[144:145], v[146:147] op_sel_hi:[1,0,0]
    v_pk_fma_f32 v[40:41], v[40:41], v[144:145], v[146:147] op_sel_hi:[1,0,0]
    v_pk_fma_f32 v[42:43], v[42:43], v[144:145], v[146:147] op_sel_hi:[1,0,0]
    v_pk_fma_f32 v[44:45], v[44:45], v[144:145], v[146:147] op_sel_hi:[1,0,0]
    v_pk_fma_f32 v[46:47], v[46:47], v[144:145], v[146:147] op_sel_hi:[1,0,0]
    v_pk_fma_f32 v[48:49], v[48:49], v[144:145], v[146:147] op_sel_hi:[1,0,0]
    v_pk_fma_f32 v[50:51], v[50:51], v[144:145], v[146:147] op_sel_hi:[1,0,0]
    v_pk_fma_f32 v[52:53], v[52:53], v[144:145], v[146:147] op_sel_hi:[1,0,0]
    v_pk_fma_f32 v[54:55], v[54:55], v[144:145], v[146:147] op_sel_hi:[1,0,0]
    v_pk_fma_f32 v[56:57], v[56:57], v[144:145], v[146:147] op_sel_hi:[1,0,0]
    v_pk_fma_f32 v[58:59], v[58:59], v[144:145], v[146:147] op_sel_hi:[1,0,0]
    v_cvt_pk_bf16_f32 v104, v28, v29
    v_cvt_pk_bf16_f32 v105, v30, v31
    v_cvt_pk_bf16_f32 v106, v32, v33
    v_cvt_pk_bf16_f32 v107, v34, v35
    v_cvt_pk_bf16_f32 v108, v36, v37
    v_cvt_pk_bf16_f32 v109, v38, v39
    v_cvt_pk_bf16_f32 v110, v40, v41
    v_cvt_pk_bf16_f32 v111, v42, v43
    v_cvt_pk_bf16_f32 v112, v44, v45
    v_cvt_pk_bf16_f32 v113, v46, v47
    v_cvt_pk_bf16_f32 v114, v48, v49
    v_cvt_pk_bf16_f32 v115, v50, v51
    v_cvt_pk_bf16_f32 v116, v52, v53
    v_cvt_pk_bf16_f32 v117, v54, v55
    v_cvt_pk_bf16_f32 v118, v56, v57
    v_cvt_pk_bf16_f32 v119, v58, v59
    ds_write_b128 v231, v[104:107]
    ds_write_b128 v231, v[108:111] offset:16
    s_waitcnt lgkmcnt(0)
    s_barrier
    s_cmp_lt_u32 s3, 4
    s_cbranch_scc1 fz_now4
    buffer_load_dwordx4 v[192:195], v14, s[64:67], s62 offen offset:0 nt
    buffer_load_dwordx4 v[196:199], v14, s[64:67], s62 offen offset:256 nt
    s_add_u32 s62, s62, 8192
    buffer_load_dwordx4 v[60:63], v14, s[64:67], s62 offen offset:0 nt
    buffer_load_dwordx4 v[64:67], v14, s[64:67], s62 offen offset:256 nt
    s_add_u32 s62, s62, 8192
    buffer_load_dwordx4 v[68:71], v14, s[64:67], s62 offen offset:0 nt
    buffer_load_dwordx4 v[88:91], v14, s[64:67], s62 offen offset:256 nt
    s_add_u32 s62, s62, 8192
    buffer_load_dwordx4 v[92:95], v14, s[64:67], s62 offen offset:0 nt
    buffer_load_dwordx4 v[96:99], v14, s[64:67], s62 offen offset:256 nt
fz_now4:
    ds_write_b16 v233, v104
    ds_write_b16 v241, v112
    ds_write_b16_d16_hi v232, v112 offset:28
    ds_write_b16 v232, v113 offset:26
    ds_write_b16_d16_hi v232, v113 offset:24
    ds_write_b16 v232, v114 offset:22
    ds_write_b16_d16_hi v232, v114 offset:20
    ds_write_b16 v232, v115 offset:18
    ds_write_b16_d16_hi v232, v115 offset:16
    ds_write_b16 v232, v116 offset:14
    ds_write_b16_d16_hi v232, v116 offset:12
    ds_write_b16 v232, v117 offset:10
    ds_write_b16_d16_hi v232, v117 offset:8
    ds_write_b16 v232, v118 offset:6
    ds_write_b16_d16_hi v232, v118 offset:4
    ds_write_b16 v232, v119 offset:2
    ds_write_b16_d16_hi v232, v119 offset:0
    s_lshl_b32 s32, s3, 1
    s_add_u32 s33, s32, 1
    v_readlane_b32 s34, v230, s32
    v_readlane_b32 s35, v230, s33
    s_mul_i32 s38, s3, 4128
    v_add_u32 v9, s38, v239
    s_lshl_b32 s34, s34, 11
    s_lshl_b32 s35, s35, 11
    s_waitcnt lgkmcnt(0)
    s_barrier
    ds_read_b128 v[104:107], v9 offset:0
    ds_read_b128 v[108:111], v9 offset:1024
    ds_read_b128 v[112:115], v9 offset:2064
    ds_read_b128 v[116:119], v9 offset:3088
    s_lshr_b32 s59, s37, 1
    s_xor_b32 s18, s59, 1
    s_and_b32 s18, s18, 3
    s_cmp_lt_u32 s23, 112
    s_cselect_b32 s38, s18, 8
    s_cmp_eq_u32 s38, s3
    s_cbranch_scc1 fz_sk1
    s_waitcnt lgkmcnt(0)
    s_cmp_eq_u32 s37, s32
    s_cbranch_scc1 fz_sk0
    buffer_store_dwordx4 v[104:107], v239, s[12:15], s34 offen offset:0 sc1
    buffer_store_dwordx4 v[108:111], v239, s[12:15], s34 offen offset:1024 sc1
fz_sk0:
    s_cmp_eq_u32 s37, s33
    s_cbranch_scc1 fz_sk1
    buffer_store_dwordx4 v[112:115], v239, s[12:15], s35 offen offset:0 sc1
    buffer_store_dwordx4 v[116:119], v239, s[12:15], s35 offen offset:1024 sc1
fz_sk1:
    v_and_b32 v15, 7, v4
    v_mul_u32_u24 v15, 544, v15
    v_lshl_add_u32 v15, v5, 4, v15
    v_add_u32 v15, 108032, v15
    s_lshl_b32 s63, s23, 5
    s_and_b32 s38, s3, 3
    s_mul_i32 s38, s38, 118784
    s_add_u32 s63, s63, s38
    s_add_u32 s63, s63, 0x4c8000
    v_lshrrev_b32 v13, 1, v1
    v_mul_u32_u24 v13, 3712, v13
    v_and_b32 v14, 1, v1
    v_lshl_add_u32 v102, v14, 4, v13
    v_add_u32 v103, 59392, v102
    s_lshl_b32 s38, s20, 5
    s_add_u32 s38, s38, 0x548000
    s_cmp_lt_u32 s3, 4
    s_cselect_b32 s63, s38, s63
    v_mov_b32 v14, 0xffffff00
    s_cmp_eq_u32 s18, s3
    s_cbranch_scc1 fz_act
    s_cmp_lg_u32 s59, s3
    s_cbranch_scc1 fz_f2
    s_and_b32 s38, s20, 15
    s_add_u32 s38, s38, 16
    s_mul_i32 s38, s38, 2176
    s_add_u32 s38, s38, 0x580000
    s_lshr_b32 s52, s20, 4
    s_lshl_b32 s52, s52, 7
    s_and_b32 s53, s20, 7
    s_lshl_b32 s53, s53, 4
    s_add_u32 s52, s52, s53
    s_bfe_u32 s53, s20, 0x10003
    s_lshl_b32 s53, s53, 2
    s_add_u32 s52, s52, s53
    v_and_b32 v2, 1, v1
    v_lshl_add_u32 v2, v2, 3, v5
    v_add_u32 v2, s52, v2
    v_and_b32 v3, 31, v2
    v_lshrrev_b32 v6, 5, v2
    v_cmp_gt_u32 vcc, 16, v6
    v_cmp_lt_u32 s[52:53], 16, v3
    v_cmp_eq_u32 s[54:55], 0, v3
    s_nop 1
    s_and_b64 s[54:55], s[54:55], vcc
    s_or_b64 s[52:53], s[52:53], s[54:55]
    v_cmp_eq_u32 s[54:55], 16, v3
    s_nop 1
    s_andn2_b64 s[54:55], s[54:55], vcc
    s_or_b64 s[52:53], s[52:53], s[54:55]
    v_sub_u32 v7, 1024, v2
    v_cndmask_b32_e64 v7, v2, v7, s[52:53]
    v_mov_b32 v8, 512
    v_cmp_eq_u32 vcc, 1024, v7
    s_nop 1
    v_cndmask_b32_e64 v7, v7, v8, vcc
    v_lshrrev_b32 v8, 5, v7
    v_and_b32 v7, 15, v7
    v_lshrrev_b32 v9, 2, v8
    v_lshlrev_b32 v9, 8, v9
    v_and_b32 v8, 3, v8
    v_lshl_add_u32 v9, v8, 4, v9
    v_lshrrev_b32 v8, 3, v7
    v_lshl_add_u32 v9, v8, 6, v9
    v_and_b32 v7, 7, v7
    v_lshl_add_u32 v9, v7, 1, v9
    v_cndmask_b32_e64 v7, 0, 1, s[52:53]
    v_lshl_add_u32 v9, v7, 7, v9
    v_lshlrev_b32 v2, 1, v2
    v_lshrrev_b32 v3, 1, v1
    v_mul_u32_u24 v3, 32, v3
    v_and_b32 v6, 1, v1
    v_lshl_add_u32 v3, v6, 4, v3
    v_mov_b32 v6, 0x7fffffff
    v_cmp_gt_u32 vcc, 32, v1
    s_nop 1
    v_cndmask_b32_e64 v6, v6, v3, vcc
    v_mov_b32 v7, s48
    v_cndmask_b32_e64 v16, 0, v7, vcc
    v_mov_b32 v7, s49
    v_cndmask_b32_e64 v17, 0, v7, vcc
    v_mov_b32 v7, s50
    v_cndmask_b32_e64 v18, 0, v7, vcc
    v_mov_b32 v7, s51
    v_cndmask_b32_e64 v19, 0, v7, vcc
    s_mul_i32 s52, s20, 3712
    s_add_u32 s52, s52, 0x4c8000
    s_add_u32 s53, s52, 1024
    s_add_u32 s54, s52, 2048
    s_add_u32 s55, s52, 3072
    v_lshlrev_b32 v20, 4, v1
    v_add_u32 v21, 1024, v20
    s_mov_b32 s58, 0
    s_nop 3
fz_k2:
    buffer_load_dwordx4 v[24:27], v20, s[4:7], s38 offen sc1
    buffer_load_dwordx4 v[28:31], v21, s[4:7], s38 offen sc1
    s_waitcnt vmcnt(0)
    v_xor_b32 v32, s40, v27
    v_xor_b32 v33, s40, v31
    v_max_u32 v34, v24, v28
    v_or_b32 v32, v32, v33
    v_cmp_ne_u32 vcc, 0, v32
    s_cbranch_vccnz fz_k2_rt
fz_k2_ok:
    v_max_u32_dpp v34, v34, v34 quad_perm:[1,0,3,2] row_mask:0xf bank_mask:0xf
    s_nop 1
    v_max_u32_dpp v34, v34, v34 quad_perm:[2,3,0,1] row_mask:0xf bank_mask:0xf
    s_nop 1
    v_max_u32_dpp v34, v34, v34 row_half_mirror row_mask:0xf bank_mask:0xf
    s_nop 1
    v_max_u32_dpp v34, v34, v34 row_mirror row_mask:0xf bank_mask:0xf
    s_nop 1
    v_max_u32_dpp v34, v34, v34 row_bcast:15 row_mask:0xa bank_mask:0xf
    s_nop 1
    v_max_u32_dpp v34, v34, v34 row_bcast:31 row_mask:0xc bank_mask:0xf
    s_nop 0
    v_readlane_b32 s36, v34, 63
    s_nop 1
    v_cmp_eq_u32 vcc, s36, v24
    v_cmp_eq_u32 s[56:57], s36, v28
    s_nop 1
    v_cndmask_b32_e64 v25, v25, v29, s[56:57]
    v_cndmask_b32_e64 v26, v26, v30, s[56:57]
    s_cmp_lg_u64 vcc, 0
    s_cselect_b32 s39, 0, 64
    s_or_b64 vcc, vcc, s[56:57]
    s_ff1_i32_b64 s41, vcc
    v_readlane_b32 s42, v25, s41
    v_readlane_b32 s43, v26, s41
    s_add_u32 s39, s39, s41
    s_and_b32 s42, s42, 0xffff0000
    s_cmp_eq_u32 s39, s20
    s_cbranch_scc1 fz_win
    s_bitcmp1_b32 s37, 0
    s_cbranch_scc1 fz_d1
    buffer_store_dwordx4 v[104:107], v239, s[12:15], s34 offen offset:0 sc1
    buffer_store_dwordx4 v[108:111], v239, s[12:15], s34 offen offset:1024 sc1
    s_branch fz_win
fz_d1:
    buffer_store_dwordx4 v[112:115], v239, s[12:15], s35 offen offset:0 sc1
    buffer_store_dwordx4 v[116:119], v239, s[12:15], s35 offen offset:1024 sc1
fz_win:
    s_lshl_b32 s39, s39, 11
    s_add_u32 s39, s39, 0x448000
    s_mov_b32 s58, 0
    s_mov_b32 s41, 0xffff0000
    s_nop 0
fz_c2:
    buffer_load_short_d16_hi v10, v9, s[4:7], s39 offen sc1
    s_waitcnt vmcnt(0)
    v_cmp_eq_u32 vcc, s41, v10
    s_cbranch_vccnz fz_c2_rt
fz_c2_ok:
    v_add_f32 v11, s42, v10
    v_cvt_pk_bf16_f32 v11, 0, v11
    v_mul_f32 v11, s43, v11
    v_cvt_pk_bf16_f32 v11, 0, v11
    s_ashr_i32 s39, s36, 31
    s_not_b32 s39, s39
    s_or_b32 s39, s39, 0x80000000
    s_xor_b32 s39, s36, s39
    s_and_b32 s39, s39, 0xffff0000
    v_mov_b32 v12, s39
    v_mul_f32 v12, 0xbfb8aa3b, v12
    v_exp_f32 v12, v12
    s_nop 0
    v_add_f32 v12, 1.0, v12
    v_rcp_f32 v12, v12
    s_nop 0
    v_cvt_pk_bf16_f32 v12, 0, v12
    s_and_b32 s39, s36, 0xffff
    s_sub_u32 s39, 2047, s39
    s_lshl_b32 s39, s39, 11
    v_mov_b32 v13, 0xff
    s_waitcnt lgkmcnt(0)
fz_f2:
    s_cmp_gt_u32 s23, 111
    s_cbranch_scc1 fz_nof2
    s_barrier
    s_cmp_eq_u32 s59, s3
    s_cselect_b32 s19, 4, s3
    s_cmp_lt_u32 s19, 4
    s_cbranch_scc1 fz_f2d
    ds_read_b128 v[120:123], v15 offset:0
    ds_read_b128 v[124:127], v15 offset:64
    ds_read_b128 v[128:131], v15 offset:128
    ds_read_b128 v[132:135], v15 offset:192
    ds_read_b128 v[136:139], v15 offset:256
    ds_read_b128 v[140:143], v15 offset:320
    ds_read_b128 v[144:147], v15 offset:384
    ds_read_b128 v[148:151], v15 offset:448
    s_waitcnt vmcnt(2)
    s_waitcnt lgkmcnt(7)
    v_mfma_f32_16x16x32_bf16 v[152:155], v[120:123], v[160:163], 0
    v_mfma_f32_16x16x32_bf16 v[156:159], v[120:123], v[164:167], 0
    s_waitcnt lgkmcnt(6)
    v_mfma_f32_16x16x32_bf16 v[152:155], v[124:127], v[168:171], v[152:155]
    v_mfma_f32_16x16x32_bf16 v[156:159], v[124:127], v[172:175], v[156:159]
    s_waitcnt lgkmcnt(5)
    v_mfma_f32_16x16x32_bf16 v[152:155], v[128:131], v[176:179], v[152:155]
    v_mfma_f32_16x16x32_bf16 v[156:159], v[128:131], v[180:183], v[156:159]
    s_waitcnt lgkmcnt(4)
    v_mfma_f32_16x16x32_bf16 v[152:155], v[132:135], v[184:187], v[152:155]
    v_mfma_f32_16x16x32_bf16 v[156:159], v[132:135], v[188:191], v[156:159]
    s_waitcnt lgkmcnt(3)
    v_mfma_f32_16x16x32_bf16 v[152:155], v[136:139], v[192:195], v[152:155]
    v_mfma_f32_16x16x32_bf16 v[156:159], v[136:139], v[196:199], v[156:159]
    s_waitcnt lgkmcnt(2)
    v_mfma_f32_16x16x32_bf16 v[152:155], v[140:143], v[60:63], v[152:155]
    v_mfma_f32_16x16x32_bf16 v[156:159], v[140:143], v[64:67], v[156:159]
    s_waitcnt lgkmcnt(1)
    v_mfma_f32_16x16x32_bf16 v[152:155], v[144:147], v[68:71], v[152:155]
    v_mfma_f32_16x16x32_bf16 v[156:159], v[144:147], v[88:91], v[156:159]
    s_waitcnt lgkmcnt(0)
    v_mfma_f32_16x16x32_bf16 v[152:155], v[148:151], v[92:95], v[152:155]
    v_mfma_f32_16x16x32_bf16 v[156:159], v[148:151], v[96:99], v[156:159]
    s_mov_b32 exec_hi, 0
    s_nop 5
    v_and_or_b32 v152, v152, v14, s48
    v_and_or_b32 v153, v153, v14, s49
    v_and_or_b32 v154, v154, v14, s50
    v_and_or_b32 v155, v155, v14, s51
    buffer_store_dwordx4 v[152:155], v102, s[4:7], s63 offen sc1
    v_and_or_b32 v156, v156, v14, s48
    v_and_or_b32 v157, v157, v14, s49
    v_and_or_b32 v158, v158, v14, s50
    v_and_or_b32 v159, v159, v14, s51
    buffer_store_dwordx4 v[156:159], v103, s[4:7], s63 offen sc1
fz_f2d:
    s_mov_b32 exec_hi, -1
    s_cmp_eq_u32 s18, s3
    s_cbranch_scc1 fz_late
    s_cmp_lg_u32 s59, s3
    s_cbranch_scc1 fz_xend
    v_mov_b32 v7, 0
    s_waitcnt vmcnt(0)
    s_branch fz_p5_ok
    s_nop 2
fz_nof2:
    s_cmp_lg_u32 s59, s3
    s_cbranch_scc1 fz_xend
    s_mov_b32 s58, 0
    s_and_b32 s41, s20, 63
    s_mul_i32 s41, s41, 32
    s_add_u32 s41, s41, s52
    v_mov_b32 v7, 0
    s_nop 4
fz_p5:
    buffer_load_dword v8, v7, s[4:7], s41 offen sc1
    s_waitcnt vmcnt(0)
    v_and_b32 v8, 0xff, v8
    v_cmp_ne_u32 vcc, s48, v8
    s_cbranch_vccnz fz_p5_rt
fz_p5_ok:
    s_mov_b32 s58, 0
    buffer_load_dwordx4 v[40:43], v3, s[4:7], s52 offen sc1
    buffer_load_dwordx4 v[44:47], v3, s[4:7], s53 offen sc1
    buffer_load_dwordx4 v[48:51], v3, s[4:7], s54 offen sc1
    buffer_load_dwordx4 v[52:55], v6, s[4:7], s55 offen sc1
fz_h5_c0:
    s_waitcnt vmcnt(3)
    v_xor_b32 v40, s48, v40
    v_xor_b32 v41, s49, v41
    v_xor_b32 v42, s50, v42
    v_xor_b32 v43, s51, v43
    v_or3_b32 v8, v40, v41, v42
    v_bitop3_b32 v8, v8, v43, v13 bitop3:0xa8
    v_cmp_ne_u32 vcc, 0, v8
    s_cbranch_vccnz fz_h5_r0
fz_h5_o0:
fz_h5_c1:
    s_waitcnt vmcnt(2)
    v_xor_b32 v44, s48, v44
    v_xor_b32 v45, s49, v45
    v_xor_b32 v46, s50, v46
    v_xor_b32 v47, s51, v47
    v_or3_b32 v8, v44, v45, v46
    v_bitop3_b32 v8, v8, v47, v13 bitop3:0xa8
    v_cmp_ne_u32 vcc, 0, v8
    s_cbranch_vccnz fz_h5_r1
fz_h5_o1:
    v_pk_add_f32 v[40:41], v[40:41], v[44:45]
    v_pk_add_f32 v[42:43], v[42:43], v[46:47]
fz_h5_c2:
    s_waitcnt vmcnt(1)
    v_xor_b32 v48, s48, v48
    v_xor_b32 v49, s49, v49
    v_xor_b32 v50, s50, v50
    v_xor_b32 v51, s51, v51
    v_or3_b32 v8, v48, v49, v50
    v_bitop3_b32 v8, v8, v51, v13 bitop3:0xa8
    v_cmp_ne_u32 vcc, 0, v8
    s_cbranch_vccnz fz_h5_r2
fz_h5_o2:
    v_pk_add_f32 v[40:41], v[40:41], v[48:49]
    v_pk_add_f32 v[42:43], v[42:43], v[50:51]
fz_h5_c3:
    s_waitcnt vmcnt(0)
    v_xor_b32 v52, v16, v52
    v_xor_b32 v53, v17, v53
    v_xor_b32 v54, v18, v54
    v_xor_b32 v55, v19, v55
    v_or3_b32 v8, v52, v53, v54
    v_bitop3_b32 v8, v8, v55, v13 bitop3:0xa8
    v_cmp_ne_u32 vcc, 0, v8
    s_cbranch_vccnz fz_h5_r3
fz_h5_o3:
    v_pk_add_f32 v[40:41], v[40:41], v[52:53]
    v_pk_add_f32 v[42:43], v[42:43], v[54:55]
    s_nop 1
    v_permlane32_swap_b32 v40, v42
    v_permlane32_swap_b32 v41, v43
    v_pk_add_f32 v[40:41], v[40:41], v[42:43]
    s_nop 1
    v_permlane16_swap_b32 v40, v41
    v_add_f32 v40, v40, v41
    s_nop 1
    v_add_f32_dpp v40, v40, v40 quad_perm:[2,3,0,1] row_mask:0xf bank_mask:0xf
    s_nop 1
    v_add_f32_dpp v40, v40, v40 row_ror:4 row_mask:0xf bank_mask:0xf
    s_nop 1
    v_add_f32_dpp v40, v40, v40 row_ror:8 row_mask:0xf bank_mask:0xf
    v_cvt_pk_bf16_f32 v40, 0, v40
    v_mul_f32 v40, v40, v12
    v_cvt_pk_bf16_f32 v40, 0, v40
    v_add_f32 v40, v40, v11
    v_cvt_pk_bf16_f32 v40, 0, v40
    v_add_f32 v40, v40, v10
    v_cvt_pk_bf16_f32 v40, 0, v40
    s_mov_b32 exec_lo, 0x00030003
    s_mov_b32 exec_hi, 0x00030003
    buffer_store_short_d16_hi v40, v2, s[12:15], s39 offen
    s_cmp_lg_u32 s20, 0
    s_cbranch_scc1 fz_xend
    s_mov_b64 exec, 1
    v_mov_b32 v8, s40
    buffer_store_dword v8, v7, s[4:7], 0 offen
fz_xend:
fz_end:
    s_endpgm
fz_late:
    buffer_store_dwordx4 v[104:107], v239, s[12:15], s34 offen offset:0 sc1
    buffer_store_dwordx4 v[108:111], v239, s[12:15], s34 offen offset:1024 sc1
    buffer_store_dwordx4 v[112:115], v239, s[12:15], s35 offen offset:0 sc1
    buffer_store_dwordx4 v[116:119], v239, s[12:15], s35 offen offset:1024 sc1
    s_branch fz_xend
fz_act:
    s_cmp_gt_u32 s23, 111
    s_cbranch_scc1 fz_xend
    v_lshlrev_b32 v2, 2, v1
    v_and_b32 v11, 3, v1
    v_mov_b32 v3, s48
    v_cmp_eq_u32 vcc, 1, v11
    v_mov_b32 v10, s49
    s_nop 0
    v_cndmask_b32_e64 v3, v3, v10, vcc
    v_cmp_eq_u32 vcc, 2, v11
    v_mov_b32 v10, s50
    s_nop 0
    v_cndmask_b32_e64 v3, v3, v10, vcc
    v_cmp_eq_u32 vcc, 3, v11
    v_mov_b32 v10, s51
    s_nop 0
    v_cndmask_b32_e64 v3, v3, v10, vcc
    v_and_b32 v10, 31, v1
    v_lshlrev_b32 v6, 4, v10
    v_lshrrev_b32 v10, 5, v1
    v_mul_u32_u24 v10, 2184, v10
    v_add_u32 v6, v6, v10
    v_add_u32 v6, 108032, v6
    s_lshl_b32 s38, s23, 11
    s_add_u32 s38, s38, 0x488000
    s_mov_b32 s58, 0
fz_h4:
    buffer_load_dword v16, v2, s[4:7], s38 offen offset:0 sc1
    buffer_load_dword v17, v2, s[4:7], s38 offen offset:256 sc1
    buffer_load_dword v18, v2, s[4:7], s38 offen offset:512 sc1
    buffer_load_dword v19, v2, s[4:7], s38 offen offset:768 sc1
    buffer_load_dword v20, v2, s[4:7], s38 offen offset:1024 sc1
    buffer_load_dword v21, v2, s[4:7], s38 offen offset:1280 sc1
    buffer_load_dword v22, v2, s[4:7], s38 offen offset:1536 sc1
    buffer_load_dword v23, v2, s[4:7], s38 offen offset:1792 sc1
    s_waitcnt vmcnt(6)
    v_xor_b32 v16, v3, v16
    v_xor_b32 v17, v3, v17
    v_or3_b32 v10, v16, v17, 0
    v_add_f32 v16, v16, v17
    s_waitcnt vmcnt(4)
    v_xor_b32 v18, v3, v18
    v_xor_b32 v19, v3, v19
    v_or3_b32 v10, v18, v19, v10
    v_add_f32 v18, v18, v19
    v_add_f32 v16, v16, v18
    s_waitcnt vmcnt(2)
    v_xor_b32 v20, v3, v20
    v_xor_b32 v21, v3, v21
    v_or3_b32 v10, v20, v21, v10
    v_add_f32 v20, v20, v21
    s_waitcnt vmcnt(0)
    v_xor_b32 v22, v3, v22
    v_xor_b32 v23, v3, v23
    v_or3_b32 v10, v22, v23, v10
    v_add_f32 v22, v22, v23
    v_add_f32 v20, v20, v22
    v_and_b32 v10, 0xff, v10
    v_add_f32 v8, v16, v20
    v_cmp_ne_u32 vcc, 0, v10
    s_cbranch_vccnz fz_h4_rt
fz_h4_ok:
    v_cvt_pk_bf16_f32 v8, 0, v8
    v_mov_b32 v9, v8
    s_nop 1
    v_permlane32_swap_b32 v8, v9
    v_mul_f32 v10, 0xbfb8aa3b, v8
    v_exp_f32 v10, v10
    s_nop 0
    v_add_f32 v10, 1.0, v10
    v_rcp_f32 v10, v10
    s_nop 0
    v_mul_f32 v8, v8, v10
    v_cvt_pk_bf16_f32 v8, 0, v8
    v_mul_f32 v8, v8, v9
    v_cvt_pk_bf16_f32 v8, 0, v8
    ds_write_b16_d16_hi v6, v8 offset:0
    ds_write_b16_d16_hi v6, v8 offset:546
    ds_write_b16_d16_hi v6, v8 offset:1092
    ds_write_b16_d16_hi v6, v8 offset:1638
    s_waitcnt lgkmcnt(0)
    s_branch fz_f2
fz_ldh:
    s_load_dwordx2 s[12:13], s[0:1], 56
    s_load_dwordx2 s[16:17], s[0:1], 64
    s_mov_b32 s14, 0x700000
    s_mov_b32 s15, 0x00020000
    s_mov_b32 s18, 0x700000
    s_mov_b32 s19, 0x00020000
    s_branch fz_ldback
fz_spec:
    s_cmp_gt_u32 s3, 3
    s_cbranch_scc1 fz_spec_hi
    s_cmp_eq_u32 s3, 0
    s_cselect_b32 s31, 0, s31
    s_cselect_b32 s30, 33024, s30
    s_cmp_eq_u32 s3, 2
    s_cselect_b32 s31, 30960, s31
    s_cselect_b32 s30, 35088, s30
    s_cmp_eq_u32 s3, 3
    s_cselect_b32 s31, 37152, s31
    s_cselect_b32 s30, 39216, s30
    s_branch fz_specback
fz_spec_hi:
    s_mov_b32 m0, s31
    s_nop 0
    buffer_load_dwordx4 v239, s[8:11], s27 offen lds
    buffer_load_dwordx4 v239, s[8:11], s27 offen offset:1024 lds
    s_mov_b32 m0, s30
    s_nop 0
    buffer_load_dwordx4 v239, s[8:11], s28 offen lds
    buffer_load_dwordx4 v239, s[8:11], s28 offen offset:1024 lds
    v_lshlrev_b32 v13, 3, v0
    v_mov_b32 v10, -1
    v_mov_b32 v11, -1
    s_lshl_b32 s32, s20, 11
    s_add_u32 s32, s32, 0x447800
    s_mov_b32 s18, 0x800
    s_mov_b32 s19, 0x00020000
    s_lshl_b32 s33, s24, 10
    s_min_u32 s34, s33, 2048
    s_add_u32 s34, s34, 104960
    s_mov_b32 m0, s34
    buffer_store_dwordx2 v[10:11], v13, s[4:7], s32 offen sc1
    buffer_load_dwordx4 v239, s[16:19], s33 offen lds
    s_cmp_eq_u32 s24, 0
    s_cselect_b32 s31, 8256, s31
    s_cselect_b32 s30, 22704, s30
    s_cselect_b32 s27, 524288, s27
    s_cselect_b32 s28, 3670016, s28
    s_cmp_eq_u32 s24, 1
    s_cselect_b32 s31, 12384, s31
    s_cselect_b32 s30, 18576, s30
    s_cselect_b32 s27, 1572864, s27
    s_cselect_b32 s28, 2621440, s28
    s_cmp_eq_u32 s24, 2
    s_cselect_b32 s31, 41280, s31
    s_cselect_b32 s30, 43344, s30
    s_cselect_b32 s27, 1572864, s27
    s_cselect_b32 s28, 2621440, s28
    s_cmp_eq_u32 s24, 3
    s_cselect_b32 s31, 45408, s31
    s_cselect_b32 s30, 47472, s30
    s_cselect_b32 s27, 524288, s27
    s_cselect_b32 s28, 3670016, s28
    s_mov_b32 s57, 0
    s_branch fz_specback
fz_jb:
    v_cvt_pk_bf16_f32 v128, v104, v105
    v_cvt_pk_bf16_f32 v129, v106, v107
    v_cvt_pk_bf16_f32 v130, v108, v109
    v_cvt_pk_bf16_f32 v131, v110, v111
    v_cvt_pk_bf16_f32 v132, v112, v113
    v_cvt_pk_bf16_f32 v133, v114, v115
    v_cvt_pk_bf16_f32 v134, v116, v117
    v_cvt_pk_bf16_f32 v135, v118, v119
    s_branch fz_jend
fz_bsp0:
    buffer_load_dwordx4 v[160:163], v14, s[64:67], s62 offen offset:0 nt
    buffer_load_dwordx4 v[164:167], v14, s[64:67], s62 offen offset:256 nt
    s_add_u32 s62, s62, 8192
    buffer_load_dwordx4 v[168:171], v14, s[64:67], s62 offen offset:0 nt
    buffer_load_dwordx4 v[172:175], v14, s[64:67], s62 offen offset:256 nt
    s_add_u32 s62, s62, 8192
    buffer_load_dwordx4 v[176:179], v14, s[64:67], s62 offen offset:0 nt
    buffer_load_dwordx4 v[180:183], v14, s[64:67], s62 offen offset:256 nt
    s_add_u32 s62, s62, 8192
    buffer_load_dwordx4 v[184:187], v14, s[64:67], s62 offen offset:0 nt
    buffer_load_dwordx4 v[188:191], v14, s[64:67], s62 offen offset:256 nt
    s_add_u32 s62, s62, 8192
    s_branch fz_bsp
fz_spec4:
    s_mov_b32 s38, 0x80018001
    s_mov_b32 s39, 0x80018001
    v_cndmask_b32_e64 v112, v112, v104, s[38:39]
    v_cndmask_b32_e64 v113, v113, v105, s[38:39]
    v_cndmask_b32_e64 v114, v114, v106, s[38:39]
    v_cndmask_b32_e64 v115, v115, v107, s[38:39]
    v_cndmask_b32_e64 v116, v116, v108, s[38:39]
    v_cndmask_b32_e64 v117, v117, v109, s[38:39]
    v_cndmask_b32_e64 v118, v118, v110, s[38:39]
    v_cndmask_b32_e64 v119, v119, v111, s[38:39]
    s_branch fz_spec4back
    s_nop 3
fz_nc1:
    s_setprio 0
    s_cmp_lg_u32 s59, 0
    s_cbranch_scc1 ffn_b
    buffer_load_dwordx4 v[176:179], v14, s[64:67], s62 offen offset:0 nt
    buffer_load_dwordx4 v[180:183], v14, s[64:67], s62 offen offset:256 nt
    s_add_u32 s62, s62, 8192
    buffer_load_dwordx4 v[184:187], v14, s[64:67], s62 offen offset:0 nt
    buffer_load_dwordx4 v[188:191], v14, s[64:67], s62 offen offset:256 nt
    s_add_u32 s62, s62, 8192
    s_mov_b32 m0, s31
    s_nop 0
    buffer_load_dwordx4 v239, s[8:11], s27 offen lds
    buffer_load_dwordx4 v239, s[8:11], s27 offen offset:1024 lds
    s_mov_b32 m0, s30
    s_nop 0
    buffer_load_dwordx4 v239, s[8:11], s28 offen lds
    buffer_load_dwordx4 v239, s[8:11], s28 offen offset:1024 lds
    v_lshlrev_b32 v13, 3, v0
    v_mov_b32 v10, -1
    v_mov_b32 v11, -1
    s_lshl_b32 s32, s20, 11
    s_add_u32 s32, s32, 0x447800
    s_mov_b32 s18, 0x800
    s_mov_b32 s19, 0x00020000
    s_lshl_b32 s33, s24, 10
    s_min_u32 s34, s33, 2048
    s_add_u32 s34, s34, 104960
    s_mov_b32 m0, s34
    buffer_store_dwordx2 v[10:11], v13, s[4:7], s32 offen sc1
    buffer_load_dwordx4 v239, s[16:19], s33 offen lds
    s_waitcnt vmcnt(14)
    v_readfirstlane_b32 s40, v250
    s_nop 1
    s_add_u32 s40, s40, 1
    s_and_b32 s38, s40, 3
    s_and_b32 s39, s40, 15
    s_bfe_u32 s41, s40, 0x20002
    s_lshl_b32 s41, s41, 16
    s_or_b32 s44, s38, s41
    s_bfe_u32 s41, s40, 0x40004
    s_lshl_b32 s41, s41, 4
    s_or_b32 s48, s39, s41
    s_bfe_u32 s41, s40, 0x20004
    s_lshl_b32 s41, s41, 16
    s_or_b32 s45, s38, s41
    s_bfe_u32 s41, s40, 0x40008
    s_lshl_b32 s41, s41, 4
    s_or_b32 s49, s39, s41
    s_bfe_u32 s41, s40, 0x20006
    s_lshl_b32 s41, s41, 16
    s_or_b32 s46, s38, s41
    s_bfe_u32 s41, s40, 0x4000c
    s_lshl_b32 s41, s41, 4
    s_or_b32 s50, s39, s41
    s_bfe_u32 s41, s40, 0x20008
    s_lshl_b32 s41, s41, 16
    s_or_b32 s47, s38, s41
    s_bfe_u32 s41, s40, 0x40010
    s_lshl_b32 s41, s41, 4
    s_or_b32 s51, s39, s41
    s_mov_b32 s38, 0x404
    s_cmp_eq_u32 s2, 66
    s_cselect_b32 s39, 8, 4
    s_cselect_b32 s38, 8, s38
fz_bsp:
    s_setprio 0
    s_mov_b32 s57, 1
    s_cmp_gt_u32 s3, 5
    s_cbranch_scc1 fz_nocq
    s_and_b32 s32, s3, 1
    s_lshl_b32 s33, s32, 2
    s_lshl_b32 s32, s32, 11
    v_and_b32 v8, 3, v4
    v_lshrrev_b32 v9, 2, v4
    v_lshl_add_u32 v8, v8, 3, v9
    v_add_u32 v8, s33, v8
    v_cvt_f32_u32 v8, v8
    v_mul_f32 v8, 0x3d000000, v8
    v_cvt_f32_u32 v9, v5
    v_mul_f32 v9, 4.0, v9
    v_mul_f32 v9, v8, v9
    v_mov_b32 v104, v9
    v_fmamk_f32 v105, v8, 0x3f800000, v9
    v_fmamk_f32 v106, v8, 0x40000000, v9
    v_fmamk_f32 v107, v8, 0x40400000, v9
    v_fmamk_f32 v108, v8, 0x41800000, v9
    v_fmamk_f32 v109, v8, 0x41880000, v9
    v_fmamk_f32 v110, v8, 0x41900000, v9
    v_fmamk_f32 v111, v8, 0x41980000, v9
    v_sin_f32 v112, v104
    v_sin_f32 v113, v105
    v_sin_f32 v114, v106
    v_sin_f32 v115, v107
    v_sin_f32 v116, v108
    v_sin_f32 v117, v109
    v_sin_f32 v118, v110
    v_sin_f32 v119, v111
    v_cos_f32 v104, v104
    v_cos_f32 v105, v105
    v_cos_f32 v106, v106
    v_cos_f32 v107, v107
    v_cos_f32 v108, v108
    v_cos_f32 v109, v109
    v_cos_f32 v110, v110
    v_cos_f32 v111, v111
    v_mul_f32 v104, 0x3d800000, v104
    v_mul_f32 v105, 0x3d800000, v105
    v_mul_f32 v106, 0x3d800000, v106
    v_mul_f32 v107, 0x3d800000, v107
    v_mul_f32 v108, 0x3d800000, v108
    v_mul_f32 v109, 0x3d800000, v109
    v_mul_f32 v110, 0x3d800000, v110
    v_mul_f32 v111, 0x3d800000, v111
    v_mul_f32 v112, 0x3d800000, v112
    v_mul_f32 v113, 0x3d800000, v113
    v_mul_f32 v114, 0x3d800000, v114
    v_mul_f32 v115, 0x3d800000, v115
    v_mul_f32 v116, 0x3d800000, v116
    v_mul_f32 v117, 0x3d800000, v117
    v_mul_f32 v118, 0x3d800000, v118
    v_mul_f32 v119, 0x3d800000, v119
    v_cvt_pk_f16_f32 v128, v104, v105
    v_cvt_pk_f16_f32 v129, v106, v107
    v_cvt_pk_f16_f32 v130, v108, v109
    v_cvt_pk_f16_f32 v131, v110, v111
    v_cvt_pk_f16_f32 v132, v112, v113
    v_cvt_pk_f16_f32 v133, v114, v115
    v_cvt_pk_f16_f32 v134, v116, v117
    v_cvt_pk_f16_f32 v135, v118, v119
    v_add_u32 v8, s32, v6
    ds_write_b128 v8, v[128:131] offset:14336
    ds_write_b128 v8, v[132:135] offset:15360
fz_nocq:
    s_and_b32 s32, s3, 3
    s_lshr_b32 s33, s3, 2
    s_lshl_b32 s33, s33, 4
    s_add_u32 s33, s33, s32
    v_and_b32 v8, 12, v4
    v_bfe_u32 v9, v4, 1, 1
    v_lshl_add_u32 v8, v9, 5, v8
    v_add_u32 v8, s33, v8
    v_cvt_f32_u32 v8, v8
    v_and_b32 v12, 1, v1
    v_cvt_f32_u32 v9, v12
    v_lshlrev_b32 v13, 2, v5
    v_cvt_f32_u32 v10, v13
    v_mul_f32 v11, 0x3c800000, v8
    v_mul_f32 v9, 0x3e800000, v9
    v_fma_f32 v9, v11, v10, v9
    v_mov_b32 v128, v9
    v_fmamk_f32 v129, v11, 0x3f800000, v9
    v_fmamk_f32 v130, v11, 0x40000000, v9
    v_fmamk_f32 v131, v11, 0x40400000, v9
    v_mul_f32 v11, 0x3a000000, v8
    v_lshlrev_b32 v9, 31, v1
    v_xor_b32 v11, v9, v11
    v_mul_f32 v9, v11, v10
    v_mov_b32 v112, v9
    v_fmamk_f32 v113, v11, 0x3f800000, v9
    v_fmamk_f32 v114, v11, 0x40000000, v9
    v_fmamk_f32 v115, v11, 0x40400000, v9
    v_fmamk_f32 v116, v11, 0x41800000, v9
    v_fmamk_f32 v117, v11, 0x41880000, v9
    v_fmamk_f32 v118, v11, 0x41900000, v9
    v_fmamk_f32 v119, v11, 0x41980000, v9
    v_cos_f32 v104, v128
    v_sin_f32 v105, v128
    v_cos_f32 v106, v129
    v_sin_f32 v107, v129
    v_cos_f32 v108, v130
    v_sin_f32 v109, v130
    v_cos_f32 v110, v131
    v_sin_f32 v111, v131
    v_sin_f32 v120, v112
    v_sin_f32 v121, v113
    v_sin_f32 v122, v114
    v_sin_f32 v123, v115
    v_sin_f32 v124, v116
    v_sin_f32 v125, v117
    v_sin_f32 v126, v118
    v_sin_f32 v127, v119
    v_cos_f32 v112, v112
    v_cos_f32 v113, v113
    v_cos_f32 v114, v114
    v_cos_f32 v115, v115
    v_cos_f32 v116, v116
    v_cos_f32 v117, v117
    v_cos_f32 v118, v118
    v_cos_f32 v119, v119
    v_cvt_pk_f16_f32 v16, v104, v105
    v_cvt_pk_f16_f32 v17, v106, v107
    v_cvt_pk_f16_f32 v18, v108, v109
    v_cvt_pk_f16_f32 v19, v110, v111
    v_cvt_pk_f16_f32 v20, v112, v113
    v_cvt_pk_f16_f32 v21, v114, v115
    v_cvt_pk_f16_f32 v22, v116, v117
    v_cvt_pk_f16_f32 v23, v118, v119
    v_cvt_pk_f16_f32 v24, v120, v121
    v_cvt_pk_f16_f32 v25, v122, v123
    v_cvt_pk_f16_f32 v26, v124, v125
    v_cvt_pk_f16_f32 v27, v126, v127
    v_lshrrev_b32 v8, 3, v1
    v_mul_u32_u24 v222, 16512, v8
    v_and_b32 v9, 7, v1
    v_lshl_add_u32 v222, v9, 4, v222
    s_mul_i32 s60, s3, 528384
    s_lshl_b32 s32, s20, 7
    s_add_u32 s60, s60, s32
    s_add_u32 s60, s60, 0x1000
    s_add_u32 s61, s60, 132096
    s_add_u32 s16, s60, 264192
    s_add_u32 s17, s60, 396288
    v_lshlrev_b32 v8, 1, v8
    v_bfe_u32 v9, v1, 2, 1
    v_add_u32 v8, v8, v9
    s_lshl_b32 s32, s3, 2
    s_add_u32 s32, s32, 1
    v_lshl_add_u32 v8, v8, 5, s32
    v_cmp_eq_u32 vcc, 1, v12
    v_bfe_u32 v9, v1, 1, 1
    v_mul_u32_u24 v9, 8256, v9
    v_add_u32 v9, 86400, v9
    s_cmp_eq_u32 s3, 3
    s_cselect_b32 s32, 272, 0
    v_sub_u32 v10, 512, v8
    v_cndmask_b32_e64 v10, v8, v10, vcc
    v_and_b32 v11, 16, v10
    v_lshl_add_u32 v11, v11, 6, v9
    v_lshrrev_b32 v12, 7, v10
    v_lshl_add_u32 v11, v12, 8, v11
    v_and_b32 v12, 15, v10
    v_lshl_add_u32 v11, v12, 4, v11
    v_bfe_u32 v12, v10, 5, 2
    v_lshl_add_u32 v223, v12, 2, v11
    v_add_u32 v8, 1, v8
    v_sub_u32 v10, 512, v8
    v_cndmask_b32_e64 v10, v8, v10, vcc
    v_and_b32 v11, 16, v10
    v_lshl_add_u32 v11, v11, 6, v9
    v_lshrrev_b32 v12, 7, v10
    v_lshl_add_u32 v11, v12, 8, v11
    v_and_b32 v12, 15, v10
    v_lshl_add_u32 v11, v12, 4, v11
    v_bfe_u32 v12, v10, 5, 2
    v_lshl_add_u32 v224, v12, 2, v11
    v_add_u32 v8, 1, v8
    v_sub_u32 v10, 512, v8
    v_cndmask_b32_e64 v10, v8, v10, vcc
    v_and_b32 v11, 16, v10
    v_lshl_add_u32 v11, v11, 6, v9
    v_lshrrev_b32 v12, 7, v10
    v_lshl_add_u32 v11, v12, 8, v11
    v_and_b32 v12, 15, v10
    v_lshl_add_u32 v11, v12, 4, v11
    v_bfe_u32 v12, v10, 5, 2
    v_lshl_add_u32 v100, v12, 2, v11
    v_mul_u32_u24 v10, s32, v3
    v_sub_u32 v8, v8, v10
    v_add_u32 v8, 1, v8
    v_sub_u32 v10, 512, v8
    v_cndmask_b32_e64 v10, v8, v10, vcc
    v_lshrrev_b32 v11, 1, v10
    v_and_b32 v11, 256, v11
    v_sub_u32 v10, v10, v11
    v_and_b32 v11, 16, v10
    v_lshl_add_u32 v11, v11, 6, v9
    v_lshrrev_b32 v12, 7, v10
    v_lshl_add_u32 v11, v12, 8, v11
    v_and_b32 v12, 15, v10
    v_lshl_add_u32 v11, v12, 4, v11
    v_bfe_u32 v12, v10, 5, 2
    v_lshl_add_u32 v101, v12, 2, v11
    s_and_b32 s32, s3, 3
    s_lshl_b32 s32, s32, 11
    s_add_u32 s32, s32, 86400
    v_add_u32 v225, s32, v239
    v_add_u32 v8, s33, v13
    v_sub_u32 v9, 32, v8
    v_min_u32 v9, v8, v9
    v_and_b32 v10, 15, v8
    v_cmp_eq_u32 s[32:33], 0, v10
    v_cmp_lt_u32 s[34:35], 16, v8
    v_lshlrev_b32 v10, 10, v9
    v_subrev_u32 v10, 1024, v10
    v_mov_b32 v11, 15872
    v_cmp_eq_u32 vcc, 0, v8
    s_nop 1
    v_cndmask_b32_e64 v10, v10, v11, vcc
    v_and_b32 v11, 3, v1
    v_lshl_add_u32 v10, v11, 4, v10
    v_lshrrev_b32 v11, 2, v4
    v_lshlrev_b32 v12, 7, v11
    v_sub_u32 v13, 960, v12
    v_cndmask_b32_e64 v13, v12, v13, s[34:35]
    v_add_u32 v226, v10, v13
    s_or_b64 s[34:35], s[34:35], s[32:33]
    v_add_u32 v12, 512, v12
    v_sub_u32 v13, 960, v12
    v_cndmask_b32_e64 v13, v12, v13, s[34:35]
    v_add_u32 v227, v10, v13
    s_mul_i32 s56, s20, 16512
    s_add_u32 s56, s56, 0x210000
    v_mov_b32 v249, 0x30003
    v_mov_b32 v252, s44
    v_mov_b32 v253, s45
    v_mov_b32 v254, s46
    v_mov_b32 v255, s47
    s_waitcnt lgkmcnt(0)
    v_sub_u32 v8, 15, v4
    v_min_u32 v8, v4, v8
    v_and_b32 v9, 1, v8
    v_lshlrev_b32 v9, 5, v9
    v_lshrrev_b32 v10, 1, v8
    v_lshl_add_u32 v9, v10, 9, v9
    v_add_u32 v9, s25, v9
    v_sub_u32 v10, 2048, v9
    v_cmp_lt_u32 s[34:35], 7, v4
    s_nop 1
    v_cndmask_b32_e64 v230, v9, v10, s[34:35]
    v_mov_b32 v9, v4
    v_mov_b32 v10, s20
    s_cmp_lg_u32 s21, 0
    s_cbranch_scc0 fz_spec3b
fz_spec3backb:
    v_lshlrev_b32 v10, 7, v10
    v_lshl_add_u32 v10, v9, 3, v10
    v_mul_u32_u24 v11, 66048, v5
    v_add_u32 v228, v10, v11
    v_and_b32 v9, 1, v9
    v_cmp_eq_u32 vcc, 1, v9
    v_mov_b32 v9, s44
    v_mov_b32 v10, s46
    v_cndmask_b32_e64 v236, v9, v10, vcc
    v_mov_b32 v9, s45
    v_mov_b32 v10, s47
    v_cndmask_b32_e64 v237, v9, v10, vcc
    s_lshl_b32 s32, s3, 2
    v_add_u32 v8, s32, v5
    v_lshlrev_b32 v9, 6, v8
    v_cmp_gt_u32 vcc, 16, v8
    s_nop 1
    v_cndmask_b32_e64 v10, 0, 32, vcc
    v_add_u32 v10, v9, v10
    v_sub_u32 v11, 2048, v10
    v_cmp_eq_u32 vcc, 16, v8
    s_nop 1
    v_cndmask_b32_e64 v11, v11, 0, vcc
    v_mov_b32 v12, 0xffff0000
    v_cndmask_b32_e64 v238, -1, v12, vcc
    v_sub_u32 v12, 2018, v9
    v_mul_u32_u24 v13, 2064, v4
    v_add_u32 v231, v13, v9
    v_add_u32 v232, v13, v12
    v_add_u32 v233, v13, v10
    v_add_u32 v241, v13, v11
    s_lshl_b32 s32, s3, 8
    s_add_u32 s32, s32, 102912
    v_lshlrev_b32 v9, 4, v4
    v_add_u32 v10, s32, v9
    v_add_u32 v11, 107008, v239
    v_cmp_gt_u32 vcc, 16, v1
    s_nop 1
    v_cndmask_b32_e64 v243, v11, v10, vcc
    v_lshrrev_b32 v12, 2, v4
    v_cmp_eq_u32 vcc, v12, v5
    s_nop 1
    v_cndmask_b32_e64 v244, v11, v10, vcc
    v_lshrrev_b32 v12, 5, v1
    v_lshl_add_u32 v10, v12, 10, v9
    v_add_u32 v245, 102912, v10
    v_and_b32 v9, 1, v1
    v_cmp_eq_u32 s[28:29], 1, v9
    v_and_b32 v9, 2, v1
    v_cmp_eq_u32 s[30:31], 2, v9
    s_lshl_b32 s37, s3, 2
    v_add_u32 v9, s37, v5
    v_mul_u32_u24 v246, 2176, v9
    s_lshl_b32 s26, s20, 4
    s_add_u32 s26, s26, 0x580000
    v_lshlrev_b32 v247, 4, v5
    s_lshl_b32 s27, s20, 11
    s_lshl_b32 s37, s3, 8
    s_add_u32 s27, s27, s37
    s_add_u32 s27, s27, 0x448000
    v_sub_u32 v248, 2047, v230
    s_mov_b32 s14, 0x400000
    s_mov_b32 s15, 0x00020000
    s_mul_i32 s52, s3, 264192
    s_add_u32 s52, s52, 0x210000
    s_add_u32 s53, s52, 16512
    s_add_u32 s54, s52, 33024
    s_add_u32 s55, s52, 49536
    s_mov_b32 s23, s63
    s_getreg_b32 s24, hwreg(HW_REG_XCC_ID)
    s_and_b32 s24, s24, 15
    v_lshlrev_b32 v10, 4, v0
    v_min_u32 v10, 4336, v10
    v_add_u32 v10, 108032, v10
    v_mov_b32 v104, 0
    v_mov_b32 v105, 0
    v_mov_b32 v106, 0
    v_mov_b32 v107, 0
    ds_write_b128 v10, v[104:107]
    s_cmp_eq_u32 s2, 66
    s_cbranch_scc1 fz_sz
    s_waitcnt vmcnt(0)
    v_mov_b32 v10, 256
    s_mov_b64 exec, 1
    ds_add_u32 v15, v10
    s_mov_b64 exec, -1
fz_sz:
    ds_read_b32 v10, v15
    s_waitcnt lgkmcnt(0)
    v_cmp_ne_u32 vcc, s38, v10
    s_cbranch_vccnz fz_sz
    ds_read_b128 v[116:119], v231
    ds_read_b128 v[120:123], v231 offset:16
    ds_read_u16_d16_hi v44, v241
    ds_read_u16_d16_hi v45, v232 offset:28
    ds_read_u16_d16_hi v46, v232 offset:26
    ds_read_u16_d16_hi v47, v232 offset:24
    ds_read_u16_d16_hi v48, v232 offset:22
    ds_read_u16_d16_hi v49, v232 offset:20
    ds_read_u16_d16_hi v50, v232 offset:18
    ds_read_u16_d16_hi v51, v232 offset:16
    ds_read_u16_d16_hi v52, v232 offset:14
    ds_read_u16_d16_hi v53, v232 offset:12
    ds_read_u16_d16_hi v54, v232 offset:10
    ds_read_u16_d16_hi v55, v232 offset:8
    ds_read_u16_d16_hi v56, v232 offset:6
    ds_read_u16_d16_hi v57, v232 offset:4
    ds_read_u16_d16_hi v58, v232 offset:2
    ds_read_u16_d16_hi v59, v232 offset:0
    ds_read_u16_d16_hi v28, v233
    v_mul_u32_u24 v13, 2064, v4
    v_subrev_u32 v13, 104960, v13
    v_sub_u32 v9, v231, v13
    v_sub_u32 v10, v233, v13
    v_sub_u32 v11, v241, v13
    v_sub_u32 v12, v232, v13
    s_mov_b32 s36, 0xffff0000
    s_waitcnt lgkmcnt(0)
    ds_read_b128 v[200:203], v9
    ds_read_b128 v[204:207], v9 offset:16
    ds_read_u16_d16 v208, v11
    ds_read_u16_d16_hi v124, v12 offset:28
    ds_read_u16_d16 v209, v12 offset:26
    ds_read_u16_d16_hi v125, v12 offset:24
    ds_read_u16_d16 v210, v12 offset:22
    ds_read_u16_d16_hi v126, v12 offset:20
    ds_read_u16_d16 v211, v12 offset:18
    ds_read_u16_d16_hi v127, v12 offset:16
    ds_read_u16_d16 v212, v12 offset:14
    ds_read_u16_d16_hi v128, v12 offset:12
    ds_read_u16_d16 v213, v12 offset:10
    ds_read_u16_d16_hi v129, v12 offset:8
    ds_read_u16_d16 v214, v12 offset:6
    ds_read_u16_d16_hi v130, v12 offset:4
    ds_read_u16_d16 v215, v12 offset:2
    ds_read_u16_d16_hi v131, v12 offset:0
    ds_read_u16_d16 v13, v10
    v_and_b32 v29, s36, v116
    v_lshlrev_b32 v30, 16, v117
    v_and_b32 v31, s36, v117
    v_lshlrev_b32 v32, 16, v118
    v_and_b32 v33, s36, v118
    v_lshlrev_b32 v34, 16, v119
    v_and_b32 v35, s36, v119
    v_lshlrev_b32 v36, 16, v120
    v_and_b32 v37, s36, v120
    v_lshlrev_b32 v38, 16, v121
    v_and_b32 v39, s36, v121
    v_lshlrev_b32 v40, 16, v122
    v_and_b32 v41, s36, v122
    v_lshlrev_b32 v42, 16, v123
    v_and_b32 v43, s36, v123
    v_cmp_eq_u32 vcc, 1, v4
    v_mov_b32 v9, s42
    s_nop 0
    v_cndmask_b32_e64 v9, 0, v9, vcc
    v_mov_b32 v116, s42
    v_mov_b32 v117, s42
    v_mov_b32 v118, s42
    v_mov_b32 v119, s42
    v_cmp_eq_u32 vcc, 0, v4
    s_waitcnt lgkmcnt(0)
    v_and_or_b32 v200, v200, s36, v13
    v_or_b32 v208, v208, v124
    v_or_b32 v209, v209, v125
    v_or_b32 v210, v210, v126
    v_or_b32 v211, v211, v127
    v_or_b32 v212, v212, v128
    v_or_b32 v213, v213, v129
    v_or_b32 v214, v214, v130
    v_or_b32 v215, v215, v131
    v_cndmask_b32_e64 v200, v9, v200, vcc
    v_cndmask_b32_e64 v201, v9, v201, vcc
    v_cndmask_b32_e64 v202, v9, v202, vcc
    v_cndmask_b32_e64 v203, v9, v203, vcc
    v_cndmask_b32_e64 v204, v9, v204, vcc
    v_cndmask_b32_e64 v205, v9, v205, vcc
    v_cndmask_b32_e64 v206, v9, v206, vcc
    v_cndmask_b32_e64 v207, v9, v207, vcc
    v_cndmask_b32_e64 v208, v9, v208, vcc
    v_cndmask_b32_e64 v209, v9, v209, vcc
    v_cndmask_b32_e64 v210, v9, v210, vcc
    v_cndmask_b32_e64 v211, v9, v211, vcc
    v_cndmask_b32_e64 v212, v9, v212, vcc
    v_cndmask_b32_e64 v213, v9, v213, vcc
    v_cndmask_b32_e64 v214, v9, v214, vcc
    v_cndmask_b32_e64 v215, v9, v215, vcc
    v_mfma_f32_16x16x32_bf16 v[120:123], v[200:203], v[116:119], 0
    v_mfma_f32_16x16x32_bf16 v[120:123], v[204:207], v[116:119], v[120:123]
    v_mfma_f32_16x16x32_bf16 v[120:123], v[208:211], v[116:119], v[120:123]
    v_mfma_f32_16x16x32_bf16 v[120:123], v[212:215], v[116:119], v[120:123]
    s_nop 7
    ds_write_b32 v243, v120 offset:12
    s_waitcnt lgkmcnt(0)
    s_branch fz_hb
    s_nop 0
fz_nc3:
    s_mov_b32 s58, 0
    s_waitcnt vmcnt(0)
    s_branch fz_h2
fz_spec3a:
    v_xor_b32 v11, 1, v4
    v_cndmask_b32_e64 v9, v9, v11, s[34:35]
    v_and_b32 v11, 1, v4
    v_cndmask_b32_e64 v11, 0, v11, s[34:35]
    v_sub_u32 v10, v10, v11
    s_cmp_lg_u32 s22, 0
    s_cbranch_scc1 fz_spec3backa
    v_cmp_eq_u32 vcc, 15, v4
    v_mov_b32 v11, 1024
    v_mov_b32 v12, 124
    v_cndmask_b32_e64 v230, v230, v11, vcc
    v_cndmask_b32_e64 v10, v10, v12, vcc
    v_cndmask_b32_e64 v9, v9, 4, vcc
    v_cmp_eq_u32 vcc, 13, v4
    v_mov_b32 v11, 1536
    v_mov_b32 v12, 124
    v_cndmask_b32_e64 v230, v230, v11, vcc
    v_cndmask_b32_e64 v10, v10, v12, vcc
    v_cndmask_b32_e64 v9, v9, 6, vcc
    v_cmp_eq_u32 vcc, 4, v4
    v_mov_b32 v11, 256
    v_mov_b32 v12, 127
    v_cndmask_b32_e64 v230, v230, v11, vcc
    v_cndmask_b32_e64 v10, v10, v12, vcc
    v_cndmask_b32_e64 v9, v9, 8, vcc
    v_cmp_eq_u32 vcc, 11, v4
    v_mov_b32 v11, 1792
    v_mov_b32 v12, 127
    v_cndmask_b32_e64 v230, v230, v11, vcc
    v_cndmask_b32_e64 v10, v10, v12, vcc
    v_cndmask_b32_e64 v9, v9, 14, vcc
    v_cmp_eq_u32 vcc, 6, v4
    v_mov_b32 v11, 768
    v_mov_b32 v12, 127
    v_cndmask_b32_e64 v230, v230, v11, vcc
    v_cndmask_b32_e64 v10, v10, v12, vcc
    v_cndmask_b32_e64 v9, v9, 10, vcc
    v_cmp_eq_u32 vcc, 9, v4
    v_mov_b32 v11, 1280
    v_mov_b32 v12, 127
    v_cndmask_b32_e64 v230, v230, v11, vcc
    v_cndmask_b32_e64 v10, v10, v12, vcc
    v_cndmask_b32_e64 v9, v9, 12, vcc
    s_nop 4
    s_branch fz_spec3backa
fz_spec3b:
    v_xor_b32 v11, 1, v4
    v_cndmask_b32_e64 v9, v9, v11, s[34:35]
    v_and_b32 v11, 1, v4
    v_cndmask_b32_e64 v11, 0, v11, s[34:35]
    v_sub_u32 v10, v10, v11
    s_cmp_lg_u32 s22, 0
    s_cbranch_scc1 fz_spec3backb
    v_cmp_eq_u32 vcc, 15, v4
    v_mov_b32 v11, 1024
    v_mov_b32 v12, 124
    v_cndmask_b32_e64 v230, v230, v11, vcc
    v_cndmask_b32_e64 v10, v10, v12, vcc
    v_cndmask_b32_e64 v9, v9, 4, vcc
    v_cmp_eq_u32 vcc, 13, v4
    v_mov_b32 v11, 1536
    v_mov_b32 v12, 124
    v_cndmask_b32_e64 v230, v230, v11, vcc
    v_cndmask_b32_e64 v10, v10, v12, vcc
    v_cndmask_b32_e64 v9, v9, 6, vcc
    v_cmp_eq_u32 vcc, 4, v4
    v_mov_b32 v11, 256
    v_mov_b32 v12, 127
    v_cndmask_b32_e64 v230, v230, v11, vcc
    v_cndmask_b32_e64 v10, v10, v12, vcc
    v_cndmask_b32_e64 v9, v9, 8, vcc
    v_cmp_eq_u32 vcc, 11, v4
    v_mov_b32 v11, 1792
    v_mov_b32 v12, 127
    v_cndmask_b32_e64 v230, v230, v11, vcc
    v_cndmask_b32_e64 v10, v10, v12, vcc
    v_cndmask_b32_e64 v9, v9, 14, vcc
    v_cmp_eq_u32 vcc, 6, v4
    v_mov_b32 v11, 768
    v_mov_b32 v12, 127
    v_cndmask_b32_e64 v230, v230, v11, vcc
    v_cndmask_b32_e64 v10, v10, v12, vcc
    v_cndmask_b32_e64 v9, v9, 10, vcc
    v_cmp_eq_u32 vcc, 9, v4
    v_mov_b32 v11, 1280
    v_mov_b32 v12, 127
    v_cndmask_b32_e64 v230, v230, v11, vcc
    v_cndmask_b32_e64 v10, v10, v12, vcc
    v_cndmask_b32_e64 v9, v9, 12, vcc
    s_nop 4
    s_branch fz_spec3backb
    s_nop 0
ffn_b:
    s_waitcnt vmcnt(0)
    v_readfirstlane_b32 s40, v250
    s_nop 1
    s_add_u32 s40, s40, 1
    s_and_b32 s38, s40, 3
    s_and_b32 s39, s40, 15
    s_bfe_u32 s41, s40, 0x20002
    s_lshl_b32 s41, s41, 16
    s_or_b32 s44, s38, s41
    s_bfe_u32 s41, s40, 0x40004
    s_lshl_b32 s41, s41, 4
    s_or_b32 s48, s39, s41
    s_bfe_u32 s41, s40, 0x20004
    s_lshl_b32 s41, s41, 16
    s_or_b32 s45, s38, s41
    s_bfe_u32 s41, s40, 0x40008
    s_lshl_b32 s41, s41, 4
    s_or_b32 s49, s39, s41
    s_bfe_u32 s41, s40, 0x20006
    s_lshl_b32 s41, s41, 16
    s_or_b32 s46, s38, s41
    s_bfe_u32 s41, s40, 0x4000c
    s_lshl_b32 s41, s41, 4
    s_or_b32 s50, s39, s41
    s_bfe_u32 s41, s40, 0x20008
    s_lshl_b32 s41, s41, 16
    s_or_b32 s47, s38, s41
    s_bfe_u32 s41, s40, 0x40010
    s_lshl_b32 s41, s41, 4
    s_or_b32 s51, s39, s41
    s_nop 0
ffn:
    s_add_u32 s36, s2, 4
    s_and_b32 s36, s36, 7
    s_bfe_u32 s37, s2, 0x10006
    s_lshl_b32 s22, s36, 1
    s_add_u32 s22, s22, s37
    s_cmp_lg_u32 s37, 0
    s_cselect_b32 s37, 8, s36
    s_add_u32 s37, s37, 6
    s_cmp_lt_u32 s36, 6
    s_cselect_b32 s22, s22, s37
    s_cmp_gt_u32 s22, 13
    s_cbranch_scc1 fz_xend
    s_bfe_u32 s21, s2, 0x30003
    v_lshrrev_b32 v2, 5, v1
    v_and_b32 v3, 31, v1
    v_lshlrev_b32 v4, 1, v2
    v_xor_b32 v3, v4, v3
    v_mul_u32_u24 v4, 7168, v2
    v_lshl_add_u32 v4, v3, 4, v4
    v_xor_b32 v5, 64, v4
    v_xor_b32 v6, 128, v4
    v_xor_b32 v7, 192, v4
    s_lshl_b32 s23, s21, 7
    s_lshl_b32 s24, s3, 4
    s_add_u32 s23, s23, s24
    s_mul_i32 s23, s23, 7168
    s_lshl_b32 s24, s22, 9
    s_add_u32 s23, s23, s24
    s_lshl_b32 s24, s3, 13
    v_mov_b32 v31, 149552
    v_mov_b32 v10, 0
    ds_write_b32 v31, v10
    s_waitcnt lgkmcnt(0)
    s_setprio 0
    s_barrier
    s_add_u32 s28, s24, 81920
    s_mov_b32 m0, s28
    s_add_u32 s29, s23, 0
    buffer_load_dwordx4 v4, s[12:15], s29 offen nt lds
    s_add_u32 s28, s24, 82944
    s_mov_b32 m0, s28
    s_add_u32 s29, s23, 14336
    buffer_load_dwordx4 v5, s[12:15], s29 offen nt lds
    s_add_u32 s28, s24, 83968
    s_mov_b32 m0, s28
    s_add_u32 s29, s23, 28672
    buffer_load_dwordx4 v4, s[12:15], s29 offen nt lds
    s_add_u32 s28, s24, 84992
    s_mov_b32 m0, s28
    s_add_u32 s29, s23, 43008
    buffer_load_dwordx4 v5, s[12:15], s29 offen nt lds
    s_add_u32 s28, s24, 86016
    s_mov_b32 m0, s28
    s_add_u32 s29, s23, 57344
    buffer_load_dwordx4 v6, s[12:15], s29 offen nt lds
    s_add_u32 s28, s24, 87040
    s_mov_b32 m0, s28
    s_add_u32 s29, s23, 71680
    buffer_load_dwordx4 v7, s[12:15], s29 offen nt lds
    s_add_u32 s28, s24, 88064
    s_mov_b32 m0, s28
    s_add_u32 s29, s23, 86016
    buffer_load_dwordx4 v6, s[12:15], s29 offen nt lds
    s_add_u32 s28, s24, 89088
    s_mov_b32 m0, s28
    s_add_u32 s29, s23, 100352
    buffer_load_dwordx4 v7, s[12:15], s29 offen nt lds
    s_add_u32 s28, s24, 0
    s_mov_b32 m0, s28
    s_add_u32 s29, s23, 0
    buffer_load_dwordx4 v4, s[16:19], s29 offen nt lds
    s_add_u32 s28, s24, 1024
    s_mov_b32 m0, s28
    s_add_u32 s29, s23, 14336
    buffer_load_dwordx4 v5, s[16:19], s29 offen nt lds
    s_add_u32 s28, s24, 2048
    s_mov_b32 m0, s28
    s_add_u32 s29, s23, 28672
    buffer_load_dwordx4 v4, s[16:19], s29 offen nt lds
    s_add_u32 s28, s24, 3072
    s_mov_b32 m0, s28
    s_add_u32 s29, s23, 43008
    buffer_load_dwordx4 v5, s[16:19], s29 offen nt lds
    s_add_u32 s28, s24, 4096
    s_mov_b32 m0, s28
    s_add_u32 s29, s23, 57344
    buffer_load_dwordx4 v6, s[16:19], s29 offen nt lds
    s_add_u32 s28, s24, 5120
    s_mov_b32 m0, s28
    s_add_u32 s29, s23, 71680
    buffer_load_dwordx4 v7, s[16:19], s29 offen nt lds
    s_add_u32 s28, s24, 6144
    s_mov_b32 m0, s28
    s_add_u32 s29, s23, 86016
    buffer_load_dwordx4 v6, s[16:19], s29 offen nt lds
    s_add_u32 s28, s24, 7168
    s_mov_b32 m0, s28
    s_add_u32 s29, s23, 100352
    buffer_load_dwordx4 v7, s[16:19], s29 offen nt lds
    v_lshrrev_b32 v2, 4, v1
    v_and_b32 v3, 15, v1
    v_bfe_u32 v9, v1, 2, 2
    v_lshl_add_u32 v8, v2, 3, v9
    v_lshlrev_b32 v8, 9, v8
    v_and_b32 v10, 1, v2
    v_lshl_add_u32 v10, v10, 2, v9
    s_lshl_b32 s28, s3, 1
    v_xor_b32 v10, s28, v10
    v_lshl_add_u32 v8, v10, 5, v8
    v_and_b32 v10, 3, v1
    v_lshl_add_u32 v8, v10, 3, v8
    v_xor_b32 v12, 32, v8
    v_add_u32 v13, 81920, v8
    v_add_u32 v20, 81920, v12
    v_bfe_u32 v9, v0, 2, 2
    v_lshrrev_b32 v10, 6, v0
    v_lshl_add_u32 v9, v10, 2, v9
    v_bfe_u32 v10, v0, 4, 1
    v_and_b32 v11, 3, v0
    v_lshlrev_b32 v11, 1, v11
    v_lshl_add_u32 v10, v10, 3, v11
    v_lshl_add_u32 v11, v9, 5, v10
    v_add_u32 v17, 1, v11
    v_cmp_eq_u32 vcc, 0, v10
    v_cmp_gt_u32 s[28:29], 16, v9
    s_nop 1
    s_and_b64 vcc, vcc, s[28:29]
    v_cndmask_b32_e64 v14, 0, 16, vcc
    v_add_u32 v16, v11, v14
    v_bfe_u32 v10, v0, 5, 1
    v_cmp_eq_u32 s[28:29], 1, v10
    v_sub_u32 v14, 1024, v16
    v_cmp_eq_u32 vcc, 512, v16
    s_nop 1
    v_cndmask_b32_e64 v14, v14, 0, vcc
    v_cndmask_b32_e64 v16, v16, v14, s[28:29]
    v_sub_u32 v14, 1024, v17
    v_cndmask_b32_e64 v17, v17, v14, s[28:29]
    v_lshlrev_b32 v16, 1, v16
    v_add_u32 v16, 147456, v16
    v_lshlrev_b32 v17, 1, v17
    v_add_u32 v17, 147456, v17
    v_lshlrev_b32 v18, 2, v0
    v_add_u32 v18, 149568, v18
    s_lshl_b32 s28, s21, 8
    s_add_u32 s28, s28, 147456
    v_lshlrev_b32 v19, 4, v2
    v_add_u32 v19, s28, v19
    v_mov_b32 v28, 149504
    v_lshlrev_b32 v29, 4, v1
    s_lshl_b32 s30, s22, 3
    s_add_u32 s30, s30, s3
    s_lshl_b32 s30, s30, 3
    s_add_u32 s30, s30, s21
    s_lshl_b32 s30, s30, 8
    s_add_u32 s30, s30, 0x488000
    v_lshlrev_b32 v30, 4, v2
    v_lshl_add_u32 v30, v3, 6, v30
    v_cmp_eq_u32 s[60:61], 1, v3
    v_cmp_eq_u32 s[62:63], 2, v3
    v_cmp_eq_u32 s[64:65], 3, v3
    v_add_u32 v21, 149568, v29
    v_mov_b32 v197, 0xffffff00
    s_and_b32 s35, s2, 0x47
    s_lshl_b32 s31, s3, 3
    s_add_u32 s35, s35, s31
    s_add_u32 s35, s35, 58
    s_and_b32 s35, s35, 127
    s_getreg_b32 s33, hwreg(HW_REG_XCC_ID)
    s_and_b32 s33, s33, 15
    s_lshr_b32 s31, s35, 5
    s_lshl_b32 s31, s31, 2
    s_add_u32 s31, s31, 149520
    v_mov_b32 v22, s31
    s_lshl_b32 s20, s22, 3
    s_add_u32 s20, s20, s21
    s_and_b32 s34, s20, 15
    s_bfe_u32 s28, s20, 0x10004
    s_lshl_b32 s28, s28, 5
    s_add_u32 s34, s34, s28
    s_mul_i32 s34, s34, 2176
    s_add_u32 s34, s34, 0x580000
    s_waitcnt vmcnt(0)
    s_barrier
    ds_read_b64_tr_b16 v[32:33], v13 offset:0
    ds_read_b64_tr_b16 v[34:35], v13 offset:2048
    ds_read_b64_tr_b16 v[36:37], v13 offset:16384
    ds_read_b64_tr_b16 v[38:39], v13 offset:18432
    ds_read_b64_tr_b16 v[40:41], v13 offset:32768
    ds_read_b64_tr_b16 v[42:43], v13 offset:34816
    ds_read_b64_tr_b16 v[44:45], v13 offset:49152
    ds_read_b64_tr_b16 v[46:47], v13 offset:51200
    s_waitcnt lgkmcnt(0)
    ds_read_b64_tr_b16 v[48:49], v20 offset:0
    ds_read_b64_tr_b16 v[50:51], v20 offset:2048
    ds_read_b64_tr_b16 v[52:53], v20 offset:16384
    ds_read_b64_tr_b16 v[54:55], v20 offset:18432
    ds_read_b64_tr_b16 v[56:57], v20 offset:32768
    ds_read_b64_tr_b16 v[58:59], v20 offset:34816
    ds_read_b64_tr_b16 v[60:61], v20 offset:49152
    ds_read_b64_tr_b16 v[62:63], v20 offset:51200
    s_waitcnt lgkmcnt(0)
    ds_read_b64_tr_b16 v[64:65], v8 offset:0
    ds_read_b64_tr_b16 v[66:67], v8 offset:2048
    ds_read_b64_tr_b16 v[68:69], v8 offset:16384
    ds_read_b64_tr_b16 v[70:71], v8 offset:18432
    ds_read_b64_tr_b16 v[72:73], v8 offset:32768
    ds_read_b64_tr_b16 v[74:75], v8 offset:34816
    ds_read_b64_tr_b16 v[76:77], v8 offset:49152
    ds_read_b64_tr_b16 v[78:79], v8 offset:51200
    s_waitcnt lgkmcnt(0)
    ds_read_b64_tr_b16 v[80:81], v12 offset:0
    ds_read_b64_tr_b16 v[82:83], v12 offset:2048
    ds_read_b64_tr_b16 v[84:85], v12 offset:16384
    ds_read_b64_tr_b16 v[86:87], v12 offset:18432
    ds_read_b64_tr_b16 v[88:89], v12 offset:32768
    ds_read_b64_tr_b16 v[90:91], v12 offset:34816
    ds_read_b64_tr_b16 v[92:93], v12 offset:49152
    ds_read_b64_tr_b16 v[94:95], v12 offset:51200
    s_waitcnt lgkmcnt(0)
    s_cmp_lg_u32 s3, 0
    s_cbranch_scc1 ffn_w3
    v_lshlrev_b32 v23, 4, v1
    v_add_u32 v24, 1024, v23
    s_lshl_b32 s28, s20, 4
    s_add_u32 s28, s28, s34
    v_mov_b32 v10, 34828
    s_nop 4
ffn_p3:
    buffer_load_dword v11, v10, s[4:7], s28 offen sc1
    s_waitcnt vmcnt(0) lgkmcnt(0)
    v_cmp_ne_u32 vcc, s40, v11
    s_cbranch_vccnz ffn_p3_rt
ffn_p3_ok:
    s_mov_b32 s58, 0
    s_mov_b32 s54, -1
    s_nop 1
ffn_k3:
    buffer_load_dwordx4 v[200:203], v23, s[4:7], s34 offen sc1
    buffer_load_dwordx4 v[204:207], v24, s[4:7], s34 offen sc1
    s_waitcnt vmcnt(0)
    v_cmp_eq_u32 s[24:25], s40, v203
    v_cmp_eq_u32 s[26:27], s40, v207
    s_nop 0
    v_cndmask_b32_e64 v200, 0, v200, s[24:25]
    v_cndmask_b32_e64 v204, 0, v204, s[26:27]
    v_max_u32 v210, v200, v204
    s_nop 1
    v_max_u32_dpp v210, v210, v210 quad_perm:[1,0,3,2] row_mask:0xf bank_mask:0xf
    s_nop 1
    v_max_u32_dpp v210, v210, v210 quad_perm:[2,3,0,1] row_mask:0xf bank_mask:0xf
    s_nop 1
    v_max_u32_dpp v210, v210, v210 row_half_mirror row_mask:0xf bank_mask:0xf
    s_nop 1
    v_max_u32_dpp v210, v210, v210 row_mirror row_mask:0xf bank_mask:0xf
    s_nop 1
    v_max_u32_dpp v210, v210, v210 row_bcast:15 row_mask:0xa bank_mask:0xf
    s_nop 1
    v_max_u32_dpp v210, v210, v210 row_bcast:31 row_mask:0xc bank_mask:0xf
    s_and_b64 s[52:53], s[24:25], s[26:27]
    v_readlane_b32 s36, v210, 63
    s_nop 1
    v_cmp_eq_u32 vcc, s36, v200
    v_cmp_eq_u32 s[28:29], s36, v204
    s_nop 0
    s_cmp_lg_u64 vcc, 0
    s_cselect_b32 s39, 0, 64
    s_or_b64 vcc, vcc, s[28:29]
    s_ff1_i32_b64 s41, vcc
    s_add_u32 s39, s39, s41
    s_lshl_b32 s39, s39, 11
    s_add_u32 s39, s39, 0x448000
    s_cmp_eq_u32 s39, s54
    s_cbranch_scc1 ffn_c3h
    buffer_load_dwordx4 v[128:131], v29, s[4:7], s39 offen sc1
    buffer_load_dwordx4 v[132:135], v29, s[4:7], s39 offen offset:1024 sc1
ffn_c3h:
    s_cmp_lg_u64 s[52:53], -1
    s_cbranch_scc1 ffn_k3_rt
ffn_k3_ok:
    s_mov_b32 s58, 0
ffn_c3d:
    v_and_b32 v10, 15, v201
    v_and_b32 v11, 15, v205
    v_cmp_eq_u32 s[24:25], s33, v10
    v_cmp_eq_u32 s[26:27], s33, v11
    s_nop 0
    v_mov_b32 v212, s24
    v_mov_b32 v213, s25
    v_mov_b32 v214, s26
    v_mov_b32 v215, s27
    v_cndmask_b32_e64 v209, v201, v205, s[28:29]
    v_cndmask_b32_e64 v210, v202, v206, s[28:29]
    v_and_b32 v209, 0xffff0000, v209
    s_mov_b64 s[42:43], vcc
    s_mov_b64 exec, vcc
    ds_write_b128 v28, v[208:211]
    ds_write_b128 v28, v[212:215] offset:16
    s_mov_b64 exec, -1
    s_waitcnt vmcnt(1)
    ds_write_b128 v21, v[128:131]
    v_max3_u32 v10, v128, v129, v130
    s_waitcnt vmcnt(0)
    ds_write_b128 v21, v[132:135] offset:1024
    v_max3_u32 v10, v10, v131, v132
    v_max3_u32 v11, v133, v134, v135
    v_max_u32 v10, v10, v11
    v_cmp_eq_u32 vcc, -1, v10
    s_cbranch_vccnz ffn_c3_rt
ffn_c3_ok:
    s_waitcnt lgkmcnt(0)
    s_nop 2
ffn_w3:
    s_barrier
    ds_read_b32 v11, v18
    ds_read_b128 v[200:203], v28
    ds_read_b32 v203, v22
    s_mov_b32 s28, 0xffff0000
    s_waitcnt lgkmcnt(2)
    v_lshlrev_b32 v14, 16, v11
    v_and_b32 v15, s28, v11
    s_waitcnt lgkmcnt(0)
    v_add_f32 v14, v14, v201
    v_add_f32 v15, v15, v201
    v_cvt_pk_bf16_f32 v14, 0, v14
    v_cvt_pk_bf16_f32 v15, 0, v15
    v_mul_f32 v14, v14, v202
    v_mul_f32 v15, v15, v202
    v_cvt_pk_bf16_f32 v14, v14, v15
    ds_write_b16 v16, v14
    ds_write_b16_d16_hi v17, v14
    v_readfirstlane_b32 s24, v203
    s_waitcnt lgkmcnt(0)
    s_barrier
    ds_read_b128 v[128:131], v19 offset:0
    ds_read_b128 v[132:135], v19 offset:64
    ds_read_b128 v[136:139], v19 offset:128
    ds_read_b128 v[140:143], v19 offset:192
    s_waitcnt lgkmcnt(3)
    v_mfma_f32_16x16x32_bf16 v[192:195], v[32:35], v[128:131], 0
    v_mfma_f32_16x16x32_bf16 v[148:151], v[48:51], v[128:131], 0
    v_mfma_f32_16x16x32_bf16 v[152:155], v[64:67], v[128:131], 0
    v_mfma_f32_16x16x32_bf16 v[156:159], v[80:83], v[128:131], 0
    s_waitcnt lgkmcnt(2)
    v_mfma_f32_16x16x32_bf16 v[192:195], v[36:39], v[132:135], v[192:195]
    v_mfma_f32_16x16x32_bf16 v[148:151], v[52:55], v[132:135], v[148:151]
    v_mfma_f32_16x16x32_bf16 v[152:155], v[68:71], v[132:135], v[152:155]
    v_mfma_f32_16x16x32_bf16 v[156:159], v[84:87], v[132:135], v[156:159]
    s_waitcnt lgkmcnt(1)
    v_mfma_f32_16x16x32_bf16 v[192:195], v[40:43], v[136:139], v[192:195]
    v_mfma_f32_16x16x32_bf16 v[148:151], v[56:59], v[136:139], v[148:151]
    v_mfma_f32_16x16x32_bf16 v[152:155], v[72:75], v[136:139], v[152:155]
    v_mfma_f32_16x16x32_bf16 v[156:159], v[88:91], v[136:139], v[156:159]
    s_waitcnt lgkmcnt(0)
    v_mfma_f32_16x16x32_bf16 v[192:195], v[44:47], v[140:143], v[192:195]
    v_mfma_f32_16x16x32_bf16 v[148:151], v[60:63], v[140:143], v[148:151]
    v_mfma_f32_16x16x32_bf16 v[152:155], v[76:79], v[140:143], v[152:155]
    v_mfma_f32_16x16x32_bf16 v[156:159], v[92:95], v[140:143], v[156:159]
    s_nop 5
    v_cndmask_b32_e64 v192, v192, v148, s[60:61]
    v_cndmask_b32_e64 v193, v193, v149, s[60:61]
    v_cndmask_b32_e64 v194, v194, v150, s[60:61]
    v_cndmask_b32_e64 v195, v195, v151, s[60:61]
    v_cndmask_b32_e64 v192, v192, v152, s[62:63]
    v_cndmask_b32_e64 v193, v193, v153, s[62:63]
    v_cndmask_b32_e64 v194, v194, v154, s[62:63]
    v_cndmask_b32_e64 v195, v195, v155, s[62:63]
    v_cndmask_b32_e64 v192, v192, v156, s[64:65]
    v_cndmask_b32_e64 v193, v193, v157, s[64:65]
    v_cndmask_b32_e64 v194, v194, v158, s[64:65]
    v_cndmask_b32_e64 v195, v195, v159, s[64:65]
    s_mov_b32 exec_lo, 0x000f000f
    s_mov_b32 exec_hi, 0x000f000f
    v_and_or_b32 v192, v192, v197, s48
    v_and_or_b32 v193, v193, v197, s49
    v_and_or_b32 v194, v194, v197, s50
    v_and_or_b32 v195, v195, v197, s51
    s_bitcmp1_b32 s24, s35
    s_cbranch_scc0 ffn_rem
    buffer_store_dwordx4 v[192:195], v30, s[4:7], s30 offen
ffn_fin:
    s_endpgm
ffn_rem:
    buffer_store_dwordx4 v[192:195], v30, s[4:7], s30 offen sc1
    s_branch ffn_fin
ffn_c3_rt:
    s_mov_b64 vcc, s[42:43]
    s_add_u32 s58, s58, 1
    s_cmp_gt_u32 s58, 0x10000
    s_cbranch_scc1 ffn_c3_ok
    buffer_load_dwordx4 v[128:131], v29, s[4:7], s39 offen sc1
    buffer_load_dwordx4 v[132:135], v29, s[4:7], s39 offen offset:1024 sc1
    s_branch ffn_c3d
ffn_k3_rt:
    s_cmp_lg_u32 s36, 0
    s_cselect_b32 s54, s39, -1
    s_add_u32 s58, s58, 1
    s_cmp_lt_u32 s58, 0x10000
    s_cbranch_scc1 ffn_k3
    s_branch ffn_k3_ok
fz_h1_r0:
    s_add_u32 s58, s58, 1
    s_cmp_gt_u32 s58, 0x10000
    s_cbranch_scc1 fz_h1_o0
    buffer_load_dwordx4 v[104:107], v222, s[4:7], s60 offen sc1
    buffer_load_dwordx4 v[108:111], v222, s[4:7], s61 offen sc1
    buffer_load_dwordx4 v[112:115], v222, s[4:7], s16 offen sc1
    buffer_load_dwordx4 v[116:119], v222, s[4:7], s17 offen sc1
    s_branch fz_h1_c0
fz_h1_r1:
    s_add_u32 s58, s58, 1
    s_cmp_gt_u32 s58, 0x10000
    s_cbranch_scc1 fz_h1_o1
    buffer_load_dwordx4 v[108:111], v222, s[4:7], s61 offen sc1
    buffer_load_dwordx4 v[112:115], v222, s[4:7], s16 offen sc1
    buffer_load_dwordx4 v[116:119], v222, s[4:7], s17 offen sc1
    s_branch fz_h1_c1
fz_h1_r2:
    s_add_u32 s58, s58, 1
    s_cmp_gt_u32 s58, 0x10000
    s_cbranch_scc1 fz_h1_o2
    buffer_load_dwordx4 v[112:115], v222, s[4:7], s16 offen sc1
    buffer_load_dwordx4 v[116:119], v222, s[4:7], s17 offen sc1
    s_branch fz_h1_c2
fz_h1_r3:
    s_add_u32 s58, s58, 1
    s_cmp_gt_u32 s58, 0x10000
    s_cbranch_scc1 fz_h1_o3
    buffer_load_dwordx4 v[116:119], v222, s[4:7], s17 offen sc1
    s_branch fz_h1_c3
fz_h2_r0:
    s_add_u32 s58, s58, 1
    s_cmp_gt_u32 s58, 0x10000
    s_cbranch_scc1 fz_h2_o0
    buffer_load_dwordx2 v[104:105], v228, s[4:7], s52 offen sc1
    buffer_load_dwordx2 v[106:107], v228, s[4:7], s53 offen sc1
    buffer_load_dwordx2 v[108:109], v228, s[4:7], s54 offen sc1
    buffer_load_dwordx2 v[110:111], v228, s[4:7], s55 offen sc1
    s_branch fz_h2_c0
fz_h2_r1:
    s_add_u32 s58, s58, 1
    s_cmp_gt_u32 s58, 0x10000
    s_cbranch_scc1 fz_h2_o1
    buffer_load_dwordx2 v[106:107], v228, s[4:7], s53 offen sc1
    buffer_load_dwordx2 v[108:109], v228, s[4:7], s54 offen sc1
    buffer_load_dwordx2 v[110:111], v228, s[4:7], s55 offen sc1
    s_branch fz_h2_c1
fz_h2_r2:
    s_add_u32 s58, s58, 1
    s_cmp_gt_u32 s58, 0x10000
    s_cbranch_scc1 fz_h2_o2
    buffer_load_dwordx2 v[108:109], v228, s[4:7], s54 offen sc1
    buffer_load_dwordx2 v[110:111], v228, s[4:7], s55 offen sc1
    s_branch fz_h2_c2
fz_h2_r3:
    s_add_u32 s58, s58, 1
    s_cmp_gt_u32 s58, 0x10000
    s_cbranch_scc1 fz_h2_o3
    buffer_load_dwordx2 v[110:111], v228, s[4:7], s55 offen sc1
    s_branch fz_h2_c3
fz_h5_r0:
    s_add_u32 s58, s58, 1
    s_cmp_gt_u32 s58, 0x10000
    s_cbranch_scc1 fz_h5_o0
    buffer_load_dwordx4 v[40:43], v3, s[4:7], s52 offen sc1
    buffer_load_dwordx4 v[44:47], v3, s[4:7], s53 offen sc1
    buffer_load_dwordx4 v[48:51], v3, s[4:7], s54 offen sc1
    buffer_load_dwordx4 v[52:55], v6, s[4:7], s55 offen sc1
    s_branch fz_h5_c0
fz_h5_r1:
    s_add_u32 s58, s58, 1
    s_cmp_gt_u32 s58, 0x10000
    s_cbranch_scc1 fz_h5_o1
    buffer_load_dwordx4 v[44:47], v3, s[4:7], s53 offen sc1
    buffer_load_dwordx4 v[48:51], v3, s[4:7], s54 offen sc1
    buffer_load_dwordx4 v[52:55], v6, s[4:7], s55 offen sc1
    s_branch fz_h5_c1
fz_h5_r2:
    s_add_u32 s58, s58, 1
    s_cmp_gt_u32 s58, 0x10000
    s_cbranch_scc1 fz_h5_o2
    buffer_load_dwordx4 v[48:51], v3, s[4:7], s54 offen sc1
    buffer_load_dwordx4 v[52:55], v6, s[4:7], s55 offen sc1
    s_branch fz_h5_c2
fz_h5_r3:
    s_add_u32 s58, s58, 1
    s_cmp_gt_u32 s58, 0x10000
    s_cbranch_scc1 fz_h5_o3
    buffer_load_dwordx4 v[52:55], v6, s[4:7], s55 offen sc1
    s_branch fz_h5_c3
fz_k2_rt:
    s_add_u32 s58, s58, 1
    s_cmp_lt_u32 s58, 0x10000
    s_cbranch_scc1 fz_k2
    s_branch fz_k2_ok
fz_c2_rt:
    s_add_u32 s58, s58, 1
    s_cmp_lt_u32 s58, 0x10000
    s_cbranch_scc1 fz_c2
    s_branch fz_c2_ok
fz_p5_rt:
    s_add_u32 s58, s58, 1
    s_cmp_lt_u32 s58, 0x10000
    s_cbranch_scc1 fz_p5
    s_branch fz_p5_ok
fz_h4_rt:
    s_add_u32 s58, s58, 1
    s_cmp_lt_u32 s58, 0x10000
    s_cbranch_scc1 fz_h4
    s_branch fz_h4_ok
ffn_p3_rt:
    s_add_u32 s58, s58, 1
    s_cmp_lt_u32 s58, 0x10000
    s_cbranch_scc1 ffn_p3
    s_branch ffn_p3_ok
fz_codeend:
.section .rodata,"a"
.p2align 6
.amdhsa_kernel fz_kernel
  .amdhsa_next_free_vgpr 256
  .amdhsa_next_free_sgpr 102
  .amdhsa_accum_offset 256
  .amdhsa_group_segment_fixed_size 0
  .amdhsa_kernarg_size 104
  .amdhsa_user_sgpr_count 2
  .amdhsa_user_sgpr_kernarg_segment_ptr 1
  .amdhsa_system_sgpr_workgroup_id_x 1
.end_amdhsa_kernel
```

```asm
; @launch kernel=fz_kernel grid=(256,1,1) block=(512,1,1) lds=163840
.amdgcn_target "amdgcn-amd-amdhsa--gfx950"
.text
.globl fz_kernel
.p2align 8
.type fz_kernel,@function
fz_kernel:
    s_load_dwordx2 s[4:5], s[0:1], 96
    s_load_dwordx2 s[8:9], s[0:1], 0
    s_load_dwordx2 s[64:65], s[0:1], 72
    s_cmp_gt_u32 s2, 255
    s_cbranch_scc1 fz_end
    v_lshrrev_b32 v2, 6, v0
    v_and_b32 v1, 63, v0
    s_lshr_b32 s59, s2, 7
    v_readfirstlane_b32 s3, v2
    s_and_b32 s20, s2, 127
    s_cmp_lt_u32 s20, 8
    s_cselect_b32 s20, s3, 0
    s_cmp_lt_u32 s20, 4
    s_cbranch_scc1 fz_pfcback
    s_getpc_b64 s[20:21]
fz_pcb:
    s_sub_u32 s20, s20, fz_pcb-fz_kernel
    s_subb_u32 s21, s21, 0
    v_and_b32 v3, 255, v0
    v_lshlrev_b32 v3, 7, v3
    v_min_u32 v3, fz_codeend-fz_kernel-4, v3
    v_mov_b32 v5, s21
    v_add_co_u32 v4, vcc, s20, v3
    s_nop 1
    v_addc_co_u32 v5, vcc, 0, v5, vcc
    global_load_dword v251, v[4:5], off
fz_pfcback:
    s_cmp_lg_u32 s59, 0
    s_cbranch_scc1 fz_ldh
    s_load_dwordx2 s[12:13], s[0:1], 80
    s_load_dwordx2 s[16:17], s[0:1], 48
fz_ldback:
    s_add_u32 s20, s2, 58
    s_and_b32 s20, s20, 127
    s_lshr_b32 s21, s20, 3
    s_add_u32 s21, s21, 1
    s_and_b32 s22, s20, 7
    s_sub_u32 s23, s20, 124
    s_cmp_ge_u32 s20, 124
    s_cselect_b32 s21, 0, s21
    s_cselect_b32 s22, s23, s22
    s_lshr_b32 s57, s3, 2
    s_or_b32 s23, s57, s59
    s_and_b32 s24, s3, 3
    s_lshl_b32 s25, s22, 6
    s_add_u32 s25, s25, s21
    s_lshl_b32 s26, s23, 5
    s_add_u32 s26, s26, s25
    s_lshl_b32 s27, s24, 9
    s_add_u32 s28, s26, s27
    s_sub_u32 s27, 2048, s27
    s_sub_u32 s27, s27, s26
    s_lshl_b32 s29, s24, 1
    s_add_u32 s29, s29, s23
    s_sub_u32 s30, 15, s29
    s_cmp_lt_u32 s24, 2
    s_cselect_b32 s27, s28, s27
    s_cselect_b32 s31, s29, s30
    s_cselect_b32 s30, s30, s29
    s_sub_u32 s28, 2048, s27
    s_and_b32 s28, s28, 2047
    s_lshl_b32 s27, s27, 11
    s_lshl_b32 s28, s28, 11
    s_mul_i32 s31, s31, 2064
    s_mul_i32 s30, s30, 2064
    v_lshlrev_b32 v239, 4, v1
    s_mov_b32 s10, 0x400000
    s_mov_b32 s11, 0x00020000
    s_mov_b32 s6, 0x690000
    s_mov_b32 s7, 0x00020000
    s_mov_b32 s66, 0x700000
    s_mov_b32 s67, 0x00020000
    s_and_b32 s32, s57, s59
    s_add_u32 s36, s2, 4
    s_and_b32 s36, s36, 7
    s_bfe_u32 s37, s2, 0x10006
    s_lshl_b32 s63, s36, 1
    s_add_u32 s63, s63, s37
    s_cmp_lg_u32 s37, 0
    s_cselect_b32 s37, 8, s36
    s_add_u32 s37, s37, 6
    s_cmp_lt_u32 s36, 6
    s_cselect_b32 s63, s63, s37
    s_lshl_b32 s63, s63, 3
    s_bfe_u32 s37, s2, 0x30003
    s_add_u32 s63, s63, s37
    v_and_b32 v10, 15, v1
    v_lshlrev_b32 v10, 4, v10
    v_lshrrev_b32 v14, 4, v1
    v_lshl_add_u32 v14, v14, 11, v10
    s_lshl_b32 s62, s63, 16
    s_and_b32 s37, s3, 3
    s_lshl_b32 s37, s37, 9
    s_add_u32 s62, s62, s37
    s_mov_b32 s58, 0
    s_waitcnt lgkmcnt(0)
    s_cmp_eq_u32 s2, 66
    s_cbranch_scc1 fz_spec
fz_specback:
    s_cmp_lg_u32 s57, 0
    s_cbranch_scc1 fz_nox
    s_mov_b32 m0, s31
    s_nop 0
    buffer_load_dwordx4 v239, s[8:11], s27 offen nt lds
    buffer_load_dwordx4 v239, s[8:11], s27 offen offset:1024 nt lds
    s_mov_b32 m0, s30
    s_nop 0
    buffer_load_dwordx4 v239, s[8:11], s28 offen nt lds
    buffer_load_dwordx4 v239, s[8:11], s28 offen offset:1024 nt lds
fz_nox:
    buffer_load_dword v250, off, s[4:7], 0
    s_andn2_b32 s32, s57, s59
    s_cbranch_scc0 fz_nowe
    buffer_load_dwordx4 v[160:163], v14, s[64:67], s62 offen offset:0 nt
    buffer_load_dwordx4 v[164:167], v14, s[64:67], s62 offen offset:256 nt
    s_add_u32 s62, s62, 8192
    buffer_load_dwordx4 v[168:171], v14, s[64:67], s62 offen offset:0 nt
    buffer_load_dwordx4 v[172:175], v14, s[64:67], s62 offen offset:256 nt
    s_add_u32 s62, s62, 8192
fz_nowe:
    s_cmp_eq_u32 s57, 0
    s_cbranch_scc1 fz_np
    s_setprio 1
fz_np:
    v_and_b32 v2, 31, v1
    v_lshrrev_b32 v3, 5, v1
    v_and_b32 v4, 15, v1
    v_lshrrev_b32 v5, 4, v1
    v_add_u32 v6, 49536, v239
    v_lshrrev_b32 v10, 1, v2
    v_and_b32 v8, 9, v10
    v_and_b32 v11, 2, v10
    v_lshl_or_b32 v8, v11, 1, v8
    v_bfe_u32 v11, v10, 2, 1
    v_lshl_or_b32 v8, v11, 1, v8
    v_and_b32 v12, 1, v5
    v_cmp_eq_u32 vcc, 1, v12
    v_lshl_add_u32 v9, v4, 1, 1
    s_nop 0
    v_cndmask_b32_e64 v9, v9, 0, vcc
    s_cmp_lt_u32 s3, 5
    s_cselect_b64 s[32:33], -1, 0
    s_cmp_lt_u32 s3, 3
    s_cselect_b64 s[34:35], -1, 0
    v_cndmask_b32_e64 v9, v9, v2, s[32:33]
    v_cndmask_b32_e64 v8, v9, v8, s[34:35]
    s_mov_b32 s36, 0x3d000000
    s_cmp_gt_u32 s3, 4
    s_cselect_b32 s36, 0x3c800000, s36
    s_sub_u32 s37, s3, 1
    s_cmp_lt_u32 s37, 2
    s_cselect_b32 s36, 0x3a800000, s36
    s_cmp_eq_u32 s3, 0
    s_cselect_b32 s32, 16, 0
    s_cselect_b32 s33, 0x3e800000, 0
    s_cselect_b32 s34, 4.0, 0x41000000
    s_cselect_b32 s35, 0x41000000, 4.0
    v_cmp_eq_u32 vcc, 1, v2
    v_mov_b32 v10, s32
    s_nop 0
    v_cndmask_b32_e64 v10, 0, v10, vcc
    v_add_u32 v8, v8, v10
    v_cvt_f32_u32 v8, v8
    v_mul_f32 v8, s36, v8
    s_cmp_eq_u32 s3, 2
    s_cselect_b32 s32, 0x80000000, 0
    v_lshlrev_b32 v10, 31, v2
    v_and_b32 v10, s32, v10
    v_xor_b32 v8, v10, v8
    v_and_b32 v10, 1, v2
    v_cvt_f32_u32 v10, v10
    v_mul_f32 v10, s33, v10
    s_cmp_eq_u32 s3, 1
    s_cselect_b32 s33, 0x3e800000, 0
    v_mov_b32 v11, s33
    v_cndmask_b32_e64 v10, v10, v11, vcc
    s_cmp_eq_u32 s3, 5
    s_cselect_b32 s33, 0x3e800000, 0
    v_cvt_f32_u32 v12, v12
    v_fma_f32 v10, v12, s33, v10
    s_cmp_eq_u32 s3, 6
    s_cselect_b32 s33, 0x3e800000, 0
    s_cmp_eq_u32 s3, 2
    s_cselect_b32 s33, 0xbe800000, s33
    s_cmp_eq_u32 s3, 4
    s_cselect_b32 s33, 0xbe800000, s33
    v_add_f32 v10, s33, v10
    v_cvt_f32_u32 v11, v3
    v_mul_f32 v11, s35, v11
    v_fma_f32 v9, v8, v11, v10
    v_mul_f32 v10, s34, v8
    v_mul_f32 v11, 0x41800000, v8
    v_mov_b32 v104, v9
    v_fmamk_f32 v105, v8, 0x3f800000, v9
    v_fmamk_f32 v106, v8, 0x40000000, v9
    v_fmamk_f32 v107, v8, 0x40400000, v9
    v_add_f32 v108, v104, v10
    v_add_f32 v109, v105, v10
    v_add_f32 v110, v106, v10
    v_add_f32 v111, v107, v10
    v_add_f32 v112, v104, v11
    v_add_f32 v113, v105, v11
    v_add_f32 v114, v106, v11
    v_add_f32 v115, v107, v11
    v_add_f32 v116, v108, v11
    v_add_f32 v117, v109, v11
    v_add_f32 v118, v110, v11
    v_add_f32 v119, v111, v11
    v_cos_f32 v104, v104
    v_cos_f32 v105, v105
    v_cos_f32 v106, v106
    v_cos_f32 v107, v107
    v_cos_f32 v108, v108
    v_cos_f32 v109, v109
    v_cos_f32 v110, v110
    v_cos_f32 v111, v111
    v_cos_f32 v112, v112
    v_cos_f32 v113, v113
    v_cos_f32 v114, v114
    v_cos_f32 v115, v115
    v_cos_f32 v116, v116
    v_cos_f32 v117, v117
    v_cos_f32 v118, v118
    v_cos_f32 v119, v119
    s_lshl_b32 s32, s3, 11
    v_add_u32 v8, s32, v6
    s_cmp_eq_u32 s3, 0
    s_cbranch_scc1 fz_jb
    v_cvt_pk_f16_f32 v128, v104, v105
    v_cvt_pk_f16_f32 v129, v106, v107
    v_cvt_pk_f16_f32 v130, v108, v109
    v_cvt_pk_f16_f32 v131, v110, v111
    v_cvt_pk_f16_f32 v132, v112, v113
    v_cvt_pk_f16_f32 v133, v114, v115
    v_cvt_pk_f16_f32 v134, v116, v117
    v_cvt_pk_f16_f32 v135, v118, v119
fz_jend:
    ds_write_b128 v8, v[128:131] offset:0
    ds_write_b128 v8, v[132:135] offset:1024
    v_mov_b32 v15, 49520
    v_mov_b32 v10, 0
    ds_write_b32 v15, v10
    s_waitcnt lgkmcnt(0)
    s_barrier
    v_lshlrev_b32 v240, 31, v1
    v_lshrrev_b32 v10, 16, v240
    v_or_b32 v240, v240, v10
    v_mov_b32 v229, 0xfffcfffc
    v_mov_b32 v242, 0xffff0000
    s_mov_b32 s42, 0x3f803f80
    s_cmp_lg_u32 s57, 0
    s_cbranch_scc1 fz_nc1
    ds_read_b128 v[16:19], v6 offset:0
    ds_read_b128 v[20:23], v6 offset:1024
    ds_read_b128 v[24:27], v6 offset:2048
    ds_read_b128 v[28:31], v6 offset:3072
    ds_read_b128 v[32:35], v6 offset:4096
    ds_read_b128 v[36:39], v6 offset:5120
    ds_read_b128 v[40:43], v6 offset:6144
    ds_read_b128 v[44:47], v6 offset:7168
    ds_read_b128 v[48:51], v6 offset:8192
    ds_read_b128 v[52:55], v6 offset:9216
    ds_read_b128 v[56:59], v6 offset:10240
    ds_read_b128 v[60:63], v6 offset:11264
    ds_read_b128 v[64:67], v6 offset:12288
    ds_read_b128 v[68:71], v6 offset:13312
    v_lshlrev_b32 v7, 9, v3
    v_bfe_u32 v10, v1, 2, 2
    v_lshl_add_u32 v7, v10, 6, v7
    v_and_b32 v10, 1, v5
    v_lshl_add_u32 v7, v10, 5, v7
    v_and_b32 v10, 3, v1
    v_lshl_add_u32 v7, v10, 3, v7
    v_add_u32 v7, s31, v7
    v_lshlrev_b32 v8, 9, v3
    v_lshl_add_u32 v8, v2, 1, v8
    v_sub_u32 v9, 2048, v8
    v_and_b32 v9, 2047, v9
    v_add_u32 v9, s30, v9
    s_add_u32 s32, s30, 576
    v_sub_u32 v8, s32, v8
    v_cmp_eq_u32 vcc, 0, v2
    s_nop 1
    v_cndmask_b32_e64 v234, 0, -2.0, vcc
    v_mov_b32 v235, 0x3b27c5ac
    s_lshr_b32 s32, s24, 1
    s_lshl_b32 s32, s32, 6
    s_mul_i32 s33, s3, 2304
    s_add_u32 s32, s32, s33
    s_add_u32 s32, s32, 67968
    v_lshl_add_u32 v10, v3, 1, v1
    v_lshlrev_b32 v10, 4, v10
    v_add_u32 v216, s32, v10
    v_bfe_u32 v10, v0, 2, 1
    v_mul_u32_u24 v10, 34, v10
    v_lshrrev_b32 v11, 4, v0
    v_add_u32 v10, v10, v11
    v_lshlrev_b32 v10, 4, v10
    v_bfe_u32 v11, v0, 3, 1
    v_lshl_add_u32 v10, v11, 3, v10
    v_bfe_u32 v11, v0, 1, 1
    v_lshl_add_u32 v10, v11, 2, v10
    v_and_b32 v12, 1, v0
    s_mov_b32 s33, 9216
    s_cmp_eq_u32 s2, 66
    s_cselect_b32 s32, s33, 0x1b40
    v_mul_lo_u32 v11, v12, s32
    v_add_u32 v217, v10, v11
    v_add_u32 v217, 67968, v217
    s_cselect_b32 s32, s33, 0x940
    v_mul_lo_u32 v11, v12, s32
    v_add_u32 v218, v10, v11
    v_add_u32 v218, 70272, v218
    s_cselect_b32 s32, s33, 0xfffff6c0
    v_mul_lo_u32 v11, v12, s32
    v_add_u32 v219, v10, v11
    v_add_u32 v219, 73792, v219
    s_cselect_b32 s32, s33, 0xffffe4c0
    v_mul_lo_u32 v11, v12, s32
    v_add_u32 v220, v10, v11
    v_add_u32 v220, 76096, v220
    v_lshrrev_b32 v10, 2, v0
    v_and_b32 v11, 3, v0
    v_lshlrev_b32 v11, 4, v11
    v_lshl_add_u32 v221, v10, 7, v11
    s_mul_i32 s52, s20, 16512
    s_lshl_b32 s33, s59, 6
    s_add_u32 s52, s52, s33
    s_add_u32 s52, s52, 0x1000
    s_add_u32 s53, s52, 8192
    v_mov_b32 v160, 0
    v_mov_b32 v161, 0
    v_mov_b32 v162, 0
    v_mov_b32 v163, 0
    s_setprio 3
    s_waitcnt vmcnt(0) lgkmcnt(0)
    ds_read_b64_tr_b16 v[88:89], v7 offset:0
    ds_read_b64_tr_b16 v[90:91], v7 offset:256
    ds_read_b64_tr_b16 v[92:93], v7 offset:1024
    ds_read_b64_tr_b16 v[94:95], v7 offset:1280
    ds_read_u16_d16 v96, v9
    ds_read_u16_d16_hi v136, v8 offset:1408
    ds_read_u16_d16 v97, v8 offset:1344
    ds_read_u16_d16_hi v137, v8 offset:1280
    ds_read_u16_d16 v98, v8 offset:1216
    ds_read_u16_d16_hi v138, v8 offset:1152
    ds_read_u16_d16 v99, v8 offset:1088
    ds_read_u16_d16_hi v139, v8 offset:1024
    s_waitcnt lgkmcnt(8)
    v_mfma_f32_32x32x16_bf16 v[104:119], v[88:91], v[16:19], 0
    v_mfma_f32_32x32x16_bf16 v[104:119], v[92:95], v[20:23], v[104:119]
    ds_read_u16_d16 v100, v8 offset:448
    ds_read_u16_d16_hi v140, v8 offset:384
    ds_read_u16_d16 v101, v8 offset:320
    ds_read_u16_d16_hi v141, v8 offset:256
    ds_read_u16_d16 v102, v8 offset:192
    ds_read_u16_d16_hi v142, v8 offset:128
    ds_read_u16_d16 v103, v8 offset:64
    ds_read_u16_d16_hi v143, v8 offset:0
    v_dot2_f32_bf16 v160, v88, s42, v160
    v_dot2_f32_bf16 v161, v88, v88, v161
    v_dot2_f32_bf16 v160, v89, s42, v160
    v_dot2_f32_bf16 v161, v89, v89, v161
    v_dot2_f32_bf16 v160, v90, s42, v160
    v_dot2_f32_bf16 v161, v90, v90, v161
    v_dot2_f32_bf16 v160, v91, s42, v160
    v_dot2_f32_bf16 v161, v91, v91, v161
    v_dot2_f32_bf16 v160, v92, s42, v160
    v_dot2_f32_bf16 v161, v92, v92, v161
    v_dot2_f32_bf16 v160, v93, s42, v160
    v_dot2_f32_bf16 v161, v93, v93, v161
    v_dot2_f32_bf16 v160, v94, s42, v160
    v_dot2_f32_bf16 v161, v94, v94, v161
    v_dot2_f32_bf16 v160, v95, s42, v160
    v_dot2_f32_bf16 v161, v95, v95, v161
    s_waitcnt lgkmcnt(0)
    v_or_b32 v96, v96, v136
    v_or_b32 v97, v97, v137
    v_or_b32 v98, v98, v138
    v_or_b32 v99, v99, v139
    v_or_b32 v100, v100, v140
    v_or_b32 v101, v101, v141
    v_or_b32 v102, v102, v142
    v_or_b32 v103, v103, v143
    v_mfma_f32_32x32x16_bf16 v[120:135], v[96:99], v[16:19], 0
    s_nop 0
    v_mfma_f32_32x32x16_bf16 v[120:135], v[100:103], v[20:23], v[120:135]
    v_dot2_f32_bf16 v162, v96, s42, v162
    v_dot2_f32_bf16 v163, v96, v96, v163
    v_dot2_f32_bf16 v162, v97, s42, v162
    v_dot2_f32_bf16 v163, v97, v97, v163
    v_dot2_f32_bf16 v162, v98, s42, v162
    v_dot2_f32_bf16 v163, v98, v98, v163
    v_dot2_f32_bf16 v162, v99, s42, v162
    v_dot2_f32_bf16 v163, v99, v99, v163
    v_dot2_f32_bf16 v162, v100, s42, v162
    v_dot2_f32_bf16 v163, v100, v100, v163
    v_dot2_f32_bf16 v162, v101, s42, v162
    v_dot2_f32_bf16 v163, v101, v101, v163
    v_dot2_f32_bf16 v162, v102, s42, v162
    v_dot2_f32_bf16 v163, v102, v102, v163
    v_dot2_f32_bf16 v162, v103, s42, v162
    v_dot2_f32_bf16 v163, v103, v103, v163
    s_nop 1
    v_permlane32_swap_b32 v160, v162
    v_permlane32_swap_b32 v161, v163
    v_add_f32 v160, v160, v162
    v_add_f32 v161, v161, v163
    s_nop 1
    v_permlane16_swap_b32 v160, v161
    v_add_f32 v160, v160, v161
    s_nop 1
    v_add_f32_dpp v160, v160, v160 quad_perm:[1,0,3,2] row_mask:0xf bank_mask:0xf
    s_nop 1
    v_add_f32_dpp v160, v160, v160 quad_perm:[2,3,0,1] row_mask:0xf bank_mask:0xf
    s_nop 1
    v_add_f32_dpp v160, v160, v160 row_half_mirror row_mask:0xf bank_mask:0xf
    s_nop 1
    v_add_f32_dpp v160, v160, v160 row_mirror row_mask:0xf bank_mask:0xf
    s_mov_b32 s43, 0x3e800000
    v_mov_b32 v161, v160
    s_nop 1
    v_permlane16_swap_b32 v160, v161
    v_mul_f32 v160, 0x3c800000, v160
    v_fma_f32 v161, v161, s43, v235
    v_fma_f32 v161, -v160, v160, v161
    v_rsq_f32 v161, v161
    s_nop 0
    v_mul_f32 v160, v160, v161
    v_readlane_b32 s32, v161, 0
    v_readlane_b32 s34, v161, 32
    v_readlane_b32 s36, v160, 0
    v_readlane_b32 s37, v160, 32
    s_nop 0
    v_mul_f32 v164, s36, v234
    v_fmac_f32 v164, s37, v234
    v_pk_fma_f32 v[104:105], v[104:105], s[32:33], v[164:165] op_sel_hi:[1,0,0]
    v_pk_fma_f32 v[106:107], v[106:107], s[32:33], v[164:165] op_sel_hi:[1,0,0]
    v_pk_fma_f32 v[108:109], v[108:109], s[32:33], v[164:165] op_sel_hi:[1,0,0]
    v_pk_fma_f32 v[110:111], v[110:111], s[32:33], v[164:165] op_sel_hi:[1,0,0]
    v_pk_fma_f32 v[112:113], v[112:113], s[32:33], v[164:165] op_sel_hi:[1,0,0]
    v_pk_fma_f32 v[114:115], v[114:115], s[32:33], v[164:165] op_sel_hi:[1,0,0]
    v_pk_fma_f32 v[116:117], v[116:117], s[32:33], v[164:165] op_sel_hi:[1,0,0]
    v_pk_fma_f32 v[118:119], v[118:119], s[32:33], v[164:165] op_sel_hi:[1,0,0]
    v_pk_fma_f32 v[104:105], v[120:121], s[34:35], v[104:105] op_sel_hi:[1,0,1]
    v_pk_fma_f32 v[106:107], v[122:123], s[34:35], v[106:107] op_sel_hi:[1,0,1]
    v_pk_fma_f32 v[108:109], v[124:125], s[34:35], v[108:109] op_sel_hi:[1,0,1]
    v_pk_fma_f32 v[110:111], v[126:127], s[34:35], v[110:111] op_sel_hi:[1,0,1]
    v_pk_fma_f32 v[112:113], v[128:129], s[34:35], v[112:113] op_sel_hi:[1,0,1]
    v_pk_fma_f32 v[114:115], v[130:131], s[34:35], v[114:115] op_sel_hi:[1,0,1]
    v_pk_fma_f32 v[116:117], v[132:133], s[34:35], v[116:117] op_sel_hi:[1,0,1]
    v_pk_fma_f32 v[118:119], v[134:135], s[34:35], v[118:119] op_sel_hi:[1,0,1]
    v_cvt_pk_f16_f32 v136, v104, v105
    v_cvt_pk_f16_f32 v137, v106, v107
    v_cvt_pk_f16_f32 v138, v108, v109
    v_cvt_pk_f16_f32 v139, v110, v111
    v_cvt_pk_f16_f32 v140, v112, v113
    v_cvt_pk_f16_f32 v141, v114, v115
    v_cvt_pk_f16_f32 v142, v116, v117
    v_cvt_pk_f16_f32 v143, v118, v119
    v_mov_b32_dpp v152, v136 quad_perm:[1,0,3,2] row_mask:0xf bank_mask:0xf
    v_mov_b32_dpp v153, v137 quad_perm:[1,0,3,2] row_mask:0xf bank_mask:0xf
    v_mov_b32_dpp v154, v138 quad_perm:[1,0,3,2] row_mask:0xf bank_mask:0xf
    v_mov_b32_dpp v155, v139 quad_perm:[1,0,3,2] row_mask:0xf bank_mask:0xf
    v_mov_b32_dpp v156, v140 quad_perm:[1,0,3,2] row_mask:0xf bank_mask:0xf
    v_mov_b32_dpp v157, v141 quad_perm:[1,0,3,2] row_mask:0xf bank_mask:0xf
    v_mov_b32_dpp v158, v142 quad_perm:[1,0,3,2] row_mask:0xf bank_mask:0xf
    v_mov_b32_dpp v159, v143 quad_perm:[1,0,3,2] row_mask:0xf bank_mask:0xf
    v_pk_mul_f16 v144, v136, v24
    v_pk_mul_f16 v145, v137, v25
    v_pk_mul_f16 v146, v138, v26
    v_pk_mul_f16 v147, v139, v27
    v_pk_mul_f16 v148, v140, v28
    v_pk_mul_f16 v149, v141, v29
    v_pk_mul_f16 v150, v142, v30
    v_pk_mul_f16 v151, v143, v31
    v_mfma_f32_16x16x32_f16 v[120:123], v[136:139], v[56:59], 0
    v_pk_fma_f16 v144, v152, v32, v144
    v_pk_fma_f16 v145, v153, v33, v145
    v_pk_fma_f16 v146, v154, v34, v146
    v_pk_fma_f16 v147, v155, v35, v147
    v_mfma_f32_16x16x32_f16 v[120:123], v[140:143], v[60:63], v[120:123]
    v_pk_fma_f16 v148, v156, v36, v148
    v_pk_fma_f16 v149, v157, v37, v149
    v_pk_fma_f16 v150, v158, v38, v150
    v_pk_fma_f16 v151, v159, v39, v151
    v_mfma_f32_32x32x16_f16 v[104:119], v[144:147], v[40:43], 0
    v_xor_b32_dpp v152, v144, v240 quad_perm:[1,0,3,2] row_mask:0xf bank_mask:0xf
    v_xor_b32_dpp v153, v145, v240 quad_perm:[1,0,3,2] row_mask:0xf bank_mask:0xf
    v_xor_b32_dpp v154, v146, v240 quad_perm:[1,0,3,2] row_mask:0xf bank_mask:0xf
    v_xor_b32_dpp v155, v147, v240 quad_perm:[1,0,3,2] row_mask:0xf bank_mask:0xf
    v_mfma_f32_32x32x16_f16 v[104:119], v[148:151], v[44:47], v[104:119]
    v_xor_b32_dpp v156, v148, v240 quad_perm:[1,0,3,2] row_mask:0xf bank_mask:0xf
    v_xor_b32_dpp v157, v149, v240 quad_perm:[1,0,3,2] row_mask:0xf bank_mask:0xf
    v_xor_b32_dpp v158, v150, v240 quad_perm:[1,0,3,2] row_mask:0xf bank_mask:0xf
    v_xor_b32_dpp v159, v151, v240 quad_perm:[1,0,3,2] row_mask:0xf bank_mask:0xf
    v_mfma_f32_32x32x16_f16 v[104:119], v[152:155], v[48:51], v[104:119]
    s_nop 0
    v_mfma_f32_32x32x16_f16 v[104:119], v[156:159], v[52:55], v[104:119]
    v_mfma_f32_16x16x32_f16 v[124:127], v[136:139], v[64:67], 0
    v_mfma_f32_16x16x32_f16 v[124:127], v[140:143], v[68:71], v[124:127]
    v_readfirstlane_b32 s40, v250
    s_nop 1
    s_add_u32 s40, s40, 1
    s_and_b32 s38, s40, 3
    s_and_b32 s39, s40, 15
    s_bfe_u32 s41, s40, 0x20002
    s_lshl_b32 s41, s41, 16
    s_or_b32 s44, s38, s41
    s_bfe_u32 s41, s40, 0x40004
    s_lshl_b32 s41, s41, 4
    s_or_b32 s48, s39, s41
    s_bfe_u32 s41, s40, 0x20004
    s_lshl_b32 s41, s41, 16
    s_or_b32 s45, s38, s41
    s_bfe_u32 s41, s40, 0x40008
    s_lshl_b32 s41, s41, 4
    s_or_b32 s49, s39, s41
    s_bfe_u32 s41, s40, 0x20006
    s_lshl_b32 s41, s41, 16
    s_or_b32 s46, s38, s41
    s_bfe_u32 s41, s40, 0x4000c
    s_lshl_b32 s41, s41, 4
    s_or_b32 s50, s39, s41
    s_bfe_u32 s41, s40, 0x20008
    s_lshl_b32 s41, s41, 16
    s_or_b32 s47, s38, s41
    s_bfe_u32 s41, s40, 0x40010
    s_lshl_b32 s41, s41, 4
    s_or_b32 s51, s39, s41
    s_mov_b32 s38, 0x404
    s_cmp_eq_u32 s2, 66
    s_cselect_b32 s39, 8, 4
    s_cselect_b32 s38, 8, s38
    s_mov_b64 vcc, 0xffff
    v_cvt_pk_f16_f32 v143, v118, v119
    v_cvt_pk_f16_f32 v142, v116, v117
    v_cvt_pk_f16_f32 v141, v114, v115
    v_cvt_pk_f16_f32 v140, v112, v113
    v_cvt_pk_f16_f32 v139, v110, v111
    v_cvt_pk_f16_f32 v138, v108, v109
    v_cvt_pk_f16_f32 v137, v106, v107
    v_cndmask_b32_e64 v104, v104, v121, vcc
    v_cndmask_b32_e64 v105, v105, v125, vcc
    v_pk_add_f16 v147, v142, v143 op_sel:[0,1] op_sel_hi:[1,0] neg_lo:[0,1]
    v_pk_add_f16 v151, v142, v143 op_sel:[0,1] op_sel_hi:[1,0] neg_hi:[1,0]
    v_pk_add_f16 v146, v140, v141 op_sel:[0,1] op_sel_hi:[1,0] neg_lo:[0,1]
    v_pk_add_f16 v150, v140, v141 op_sel:[0,1] op_sel_hi:[1,0] neg_hi:[1,0]
    v_pk_add_f16 v145, v138, v139 op_sel:[0,1] op_sel_hi:[1,0] neg_lo:[0,1]
    v_pk_add_f16 v149, v138, v139 op_sel:[0,1] op_sel_hi:[1,0] neg_hi:[1,0]
    v_cvt_pk_f16_f32 v136, v104, v105
    v_pk_add_f16 v144, v136, v137 op_sel:[0,1] op_sel_hi:[1,0] neg_lo:[0,1]
    v_pk_add_f16 v148, v136, v137 op_sel:[0,1] op_sel_hi:[1,0] neg_hi:[1,0]
    ds_write_b128 v216, v[144:147]
    ds_write_b128 v216, v[148:151] offset:1152
    s_waitcnt lgkmcnt(0)
    v_mov_b32 v10, 1
    s_mov_b64 exec, 1
    ds_add_u32 v15, v10
    s_mov_b64 exec, -1
    s_cmp_gt_u32 s3, 3
    s_cbranch_scc1 fz_bsp0
fz_sy:
    ds_read_b32 v10, v15
    s_waitcnt lgkmcnt(0)
    v_and_b32 v10, 0xff, v10
    v_cmp_ne_u32 vcc, s39, v10
    s_cbranch_vccnz fz_sy
    ds_read_b32 v104, v217 offset:0
    ds_read_b32 v105, v218 offset:0
    ds_read_b32 v106, v219 offset:0
    ds_read_b32 v107, v220 offset:0
    ds_read_b32 v108, v217 offset:256
    ds_read_b32 v109, v218 offset:256
    ds_read_b32 v110, v219 offset:256
    ds_read_b32 v111, v220 offset:256
    s_waitcnt lgkmcnt(4)
    v_pk_add_f16 v112, v104, v106
    v_pk_add_f16 v114, v105, v107
    v_pk_add_f16 v113, v104, v106 neg_lo:[0,1] neg_hi:[0,1]
    v_pk_add_f16 v115, v105, v107 neg_lo:[0,1] neg_hi:[0,1]
    v_pk_add_f16 v116, v112, v114
    v_pk_add_f16 v118, v112, v114 neg_lo:[0,1] neg_hi:[0,1]
    v_pk_add_f16 v117, v113, v115 op_sel:[0,1] op_sel_hi:[1,0] neg_hi:[0,1]
    v_pk_add_f16 v119, v113, v115 op_sel:[0,1] op_sel_hi:[1,0] neg_lo:[0,1]
    v_add_u32 v116, 0x20002, v116
    v_add_u32 v117, 0x20002, v117
    v_add_u32 v118, 0x20002, v118
    v_add_u32 v119, 0x20002, v119
    v_and_or_b32 v116, v116, v229, s44
    v_and_or_b32 v117, v117, v229, s45
    v_and_or_b32 v118, v118, v229, s46
    v_and_or_b32 v119, v119, v229, s47
    buffer_store_dwordx4 v[116:119], v221, s[4:7], s52 offen sc1
    s_waitcnt lgkmcnt(0)
    v_pk_add_f16 v120, v108, v110
    v_pk_add_f16 v122, v109, v111
    v_pk_add_f16 v121, v108, v110 neg_lo:[0,1] neg_hi:[0,1]
    v_pk_add_f16 v123, v109, v111 neg_lo:[0,1] neg_hi:[0,1]
    v_pk_add_f16 v124, v120, v122
    v_pk_add_f16 v126, v120, v122 neg_lo:[0,1] neg_hi:[0,1]
    v_pk_add_f16 v125, v121, v123 op_sel:[0,1] op_sel_hi:[1,0] neg_hi:[0,1]
    v_pk_add_f16 v127, v121, v123 op_sel:[0,1] op_sel_hi:[1,0] neg_lo:[0,1]
    v_add_u32 v124, 0x20002, v124
    v_add_u32 v125, 0x20002, v125
    v_add_u32 v126, 0x20002, v126
    v_add_u32 v127, 0x20002, v127
    v_and_or_b32 v124, v124, v229, s44
    v_and_or_b32 v125, v125, v229, s45
    v_and_or_b32 v126, v126, v229, s46
    v_and_or_b32 v127, v127, v229, s47
    buffer_store_dwordx4 v[124:127], v221, s[4:7], s53 offen sc1
    s_cmp_lg_u32 s59, 0
    s_cbranch_scc1 ffn
    s_and_b32 s32, s3, 3
    s_lshr_b32 s33, s3, 2
    s_lshl_b32 s33, s33, 4
    s_add_u32 s33, s33, s32
    v_and_b32 v8, 12, v4
    v_bfe_u32 v9, v4, 1, 1
    v_lshl_add_u32 v8, v9, 5, v8
    v_add_u32 v8, s33, v8
    v_cvt_f32_u32 v8, v8
    v_and_b32 v12, 1, v1
    v_cvt_f32_u32 v9, v12
    v_lshlrev_b32 v13, 2, v5
    v_cvt_f32_u32 v10, v13
    v_mul_f32 v11, 0x3c800000, v8
    v_mul_f32 v9, 0x3e800000, v9
    v_fma_f32 v9, v11, v10, v9
    v_mov_b32 v128, v9
    v_fmamk_f32 v129, v11, 0x3f800000, v9
    v_fmamk_f32 v130, v11, 0x40000000, v9
    v_fmamk_f32 v131, v11, 0x40400000, v9
    v_mul_f32 v11, 0x3a000000, v8
    v_lshlrev_b32 v9, 31, v1
    v_xor_b32 v11, v9, v11
    v_mul_f32 v9, v11, v10
    v_mov_b32 v112, v9
    v_fmamk_f32 v113, v11, 0x3f800000, v9
    v_fmamk_f32 v114, v11, 0x40000000, v9
    v_fmamk_f32 v115, v11, 0x40400000, v9
    v_fmamk_f32 v116, v11, 0x41800000, v9
    v_fmamk_f32 v117, v11, 0x41880000, v9
    v_fmamk_f32 v118, v11, 0x41900000, v9
    v_fmamk_f32 v119, v11, 0x41980000, v9
    v_cos_f32 v104, v128
    v_sin_f32 v105, v128
    v_cos_f32 v106, v129
    v_sin_f32 v107, v129
    v_cos_f32 v108, v130
    v_sin_f32 v109, v130
    v_cos_f32 v110, v131
    v_sin_f32 v111, v131
    v_sin_f32 v120, v112
    v_sin_f32 v121, v113
    v_sin_f32 v122, v114
    v_sin_f32 v123, v115
    v_sin_f32 v124, v116
    v_sin_f32 v125, v117
    v_sin_f32 v126, v118
    v_sin_f32 v127, v119
    v_cos_f32 v112, v112
    v_cos_f32 v113, v113
    v_cos_f32 v114, v114
    v_cos_f32 v115, v115
    v_cos_f32 v116, v116
    v_cos_f32 v117, v117
    v_cos_f32 v118, v118
    v_cos_f32 v119, v119
    v_cvt_pk_f16_f32 v16, v104, v105
    v_cvt_pk_f16_f32 v17, v106, v107
    v_cvt_pk_f16_f32 v18, v108, v109
    v_cvt_pk_f16_f32 v19, v110, v111
    v_cvt_pk_f16_f32 v20, v112, v113
    v_cvt_pk_f16_f32 v21, v114, v115
    v_cvt_pk_f16_f32 v22, v116, v117
    v_cvt_pk_f16_f32 v23, v118, v119
    v_cvt_pk_f16_f32 v24, v120, v121
    v_cvt_pk_f16_f32 v25, v122, v123
    v_cvt_pk_f16_f32 v26, v124, v125
    v_cvt_pk_f16_f32 v27, v126, v127
    v_lshrrev_b32 v8, 3, v1
    v_mul_u32_u24 v222, 16512, v8
    v_and_b32 v9, 7, v1
    v_lshl_add_u32 v222, v9, 4, v222
    s_mul_i32 s60, s3, 528384
    s_lshl_b32 s32, s20, 7
    s_add_u32 s60, s60, s32
    s_add_u32 s60, s60, 0x1000
    s_add_u32 s61, s60, 132096
    s_add_u32 s16, s60, 264192
    s_add_u32 s17, s60, 396288
    v_lshlrev_b32 v8, 1, v8
    v_bfe_u32 v9, v1, 2, 1
    v_add_u32 v8, v8, v9
    s_lshl_b32 s32, s3, 2
    s_add_u32 s32, s32, 1
    v_lshl_add_u32 v8, v8, 5, s32
    v_cmp_eq_u32 vcc, 1, v12
    v_bfe_u32 v9, v1, 1, 1
    v_mul_u32_u24 v9, 8256, v9
    v_add_u32 v9, 86400, v9
    s_cmp_eq_u32 s3, 3
    s_cselect_b32 s32, 272, 0
    v_sub_u32 v10, 512, v8
    v_cndmask_b32_e64 v10, v8, v10, vcc
    v_and_b32 v11, 16, v10
    v_lshl_add_u32 v11, v11, 6, v9
    v_lshrrev_b32 v12, 7, v10
    v_lshl_add_u32 v11, v12, 8, v11
    v_and_b32 v12, 15, v10
    v_lshl_add_u32 v11, v12, 4, v11
    v_bfe_u32 v12, v10, 5, 2
    v_lshl_add_u32 v223, v12, 2, v11
    v_add_u32 v8, 1, v8
    v_sub_u32 v10, 512, v8
    v_cndmask_b32_e64 v10, v8, v10, vcc
    v_and_b32 v11, 16, v10
    v_lshl_add_u32 v11, v11, 6, v9
    v_lshrrev_b32 v12, 7, v10
    v_lshl_add_u32 v11, v12, 8, v11
    v_and_b32 v12, 15, v10
    v_lshl_add_u32 v11, v12, 4, v11
    v_bfe_u32 v12, v10, 5, 2
    v_lshl_add_u32 v224, v12, 2, v11
    v_add_u32 v8, 1, v8
    v_sub_u32 v10, 512, v8
    v_cndmask_b32_e64 v10, v8, v10, vcc
    v_and_b32 v11, 16, v10
    v_lshl_add_u32 v11, v11, 6, v9
    v_lshrrev_b32 v12, 7, v10
    v_lshl_add_u32 v11, v12, 8, v11
    v_and_b32 v12, 15, v10
    v_lshl_add_u32 v11, v12, 4, v11
    v_bfe_u32 v12, v10, 5, 2
    v_lshl_add_u32 v100, v12, 2, v11
    v_mul_u32_u24 v10, s32, v3
    v_sub_u32 v8, v8, v10
    v_add_u32 v8, 1, v8
    v_sub_u32 v10, 512, v8
    v_cndmask_b32_e64 v10, v8, v10, vcc
    v_lshrrev_b32 v11, 1, v10
    v_and_b32 v11, 256, v11
    v_sub_u32 v10, v10, v11
    v_and_b32 v11, 16, v10
    v_lshl_add_u32 v11, v11, 6, v9
    v_lshrrev_b32 v12, 7, v10
    v_lshl_add_u32 v11, v12, 8, v11
    v_and_b32 v12, 15, v10
    v_lshl_add_u32 v11, v12, 4, v11
    v_bfe_u32 v12, v10, 5, 2
    v_lshl_add_u32 v101, v12, 2, v11
    s_and_b32 s32, s3, 3
    s_lshl_b32 s32, s32, 11
    s_add_u32 s32, s32, 86400
    v_add_u32 v225, s32, v239
    v_add_u32 v8, s33, v13
    v_sub_u32 v9, 32, v8
    v_min_u32 v9, v8, v9
    v_and_b32 v10, 15, v8
    v_cmp_eq_u32 s[32:33], 0, v10
    v_cmp_lt_u32 s[34:35], 16, v8
    v_lshlrev_b32 v10, 10, v9
    v_subrev_u32 v10, 1024, v10
    v_mov_b32 v11, 15872
    v_cmp_eq_u32 vcc, 0, v8
    s_nop 1
    v_cndmask_b32_e64 v10, v10, v11, vcc
    v_and_b32 v11, 3, v1
    v_lshl_add_u32 v10, v11, 4, v10
    v_lshrrev_b32 v11, 2, v4
    v_lshlrev_b32 v12, 7, v11
    v_sub_u32 v13, 960, v12
    v_cndmask_b32_e64 v13, v12, v13, s[34:35]
    v_add_u32 v226, v10, v13
    s_or_b64 s[34:35], s[34:35], s[32:33]
    v_add_u32 v12, 512, v12
    v_sub_u32 v13, 960, v12
    v_cndmask_b32_e64 v13, v12, v13, s[34:35]
    v_add_u32 v227, v10, v13
    s_mul_i32 s56, s20, 16512
    s_add_u32 s56, s56, 0x210000
    v_mov_b32 v249, 0x30003
    v_mov_b32 v252, s44
    v_mov_b32 v253, s45
    v_mov_b32 v254, s46
    v_mov_b32 v255, s47
    s_waitcnt lgkmcnt(0)
    s_waitcnt vmcnt(0)
    s_bitcmp1_b32 s2, 2
    s_cbranch_scc1 fz_p1_ok
    s_add_u32 s32, s60, 99072
    v_mov_b32 v9, 0
fz_p1:
    buffer_load_dword v10, v9, s[4:7], s32 offen sc1
    s_waitcnt vmcnt(0)
    v_xor_b32 v10, v252, v10
    v_and_b32 v10, v249, v10
    v_cmp_ne_u32 vcc, 0, v10
    s_cbranch_vccnz fz_p1_rt
fz_p1_ok:
    s_mov_b32 s58, 0
    buffer_load_dwordx4 v[104:107], v222, s[4:7], s60 offen sc1
    buffer_load_dwordx4 v[108:111], v222, s[4:7], s61 offen sc1
    buffer_load_dwordx4 v[112:115], v222, s[4:7], s16 offen sc1
    buffer_load_dwordx4 v[116:119], v222, s[4:7], s17 offen sc1
fz_h1_c0:
    s_waitcnt vmcnt(3)
    v_xor_b32 v104, v252, v104
    v_xor_b32 v105, v253, v105
    v_xor_b32 v106, v254, v106
    v_xor_b32 v107, v255, v107
    v_or3_b32 v10, v104, v105, v106
    v_bitop3_b32 v10, v10, v107, v249 bitop3:0xa8
    v_cmp_ne_u32 vcc, 0, v10
    s_cbranch_vccnz fz_h1_r0
fz_h1_o0:
    ds_write_b32 v223, v104 offset:0
    ds_write_b32 v223, v105 offset:2048
    ds_write_b32 v223, v106 offset:4096
    ds_write_b32 v223, v107 offset:6144
fz_h1_c1:
    s_waitcnt vmcnt(2)
    v_xor_b32 v108, v252, v108
    v_xor_b32 v109, v253, v109
    v_xor_b32 v110, v254, v110
    v_xor_b32 v111, v255, v111
    v_or3_b32 v10, v108, v109, v110
    v_bitop3_b32 v10, v10, v111, v249 bitop3:0xa8
    v_cmp_ne_u32 vcc, 0, v10
    s_cbranch_vccnz fz_h1_r1
fz_h1_o1:
    ds_write_b32 v224, v108 offset:0
    ds_write_b32 v224, v109 offset:2048
    ds_write_b32 v224, v110 offset:4096
    ds_write_b32 v224, v111 offset:6144
fz_h1_c2:
    s_waitcnt vmcnt(1)
    v_xor_b32 v112, v252, v112
    v_xor_b32 v113, v253, v113
    v_xor_b32 v114, v254, v114
    v_xor_b32 v115, v255, v115
    v_or3_b32 v10, v112, v113, v114
    v_bitop3_b32 v10, v10, v115, v249 bitop3:0xa8
    v_cmp_ne_u32 vcc, 0, v10
    s_cbranch_vccnz fz_h1_r2
fz_h1_o2:
    ds_write_b32 v100, v112 offset:0
    ds_write_b32 v100, v113 offset:2048
    ds_write_b32 v100, v114 offset:4096
    ds_write_b32 v100, v115 offset:6144
fz_h1_c3:
    s_waitcnt vmcnt(0)
    v_xor_b32 v116, v252, v116
    v_xor_b32 v117, v253, v117
    v_xor_b32 v118, v254, v118
    v_xor_b32 v119, v255, v119
    v_or3_b32 v10, v116, v117, v118
    v_bitop3_b32 v10, v10, v119, v249 bitop3:0xa8
    v_cmp_ne_u32 vcc, 0, v10
    s_cbranch_vccnz fz_h1_r3
fz_h1_o3:
    ds_write_b32 v101, v116 offset:0
    ds_write_b32 v101, v117 offset:2048
    ds_write_b32 v101, v118 offset:4096
    ds_write_b32 v101, v119 offset:6144
    s_waitcnt lgkmcnt(0)
    s_setprio 0
fz_hb:
    s_barrier
    ds_read_b128 v[104:107], v225 offset:0
    ds_read_b128 v[108:111], v225 offset:1024
    ds_read_b128 v[112:115], v225 offset:8256
    ds_read_b128 v[116:119], v225 offset:9280
    ds_read_b128 v[72:75], v6 offset:14336
    ds_read_b128 v[76:79], v6 offset:15360
    ds_read_b128 v[80:83], v6 offset:16384
    ds_read_b128 v[84:87], v6 offset:17408
    s_waitcnt lgkmcnt(7)
    v_mfma_f32_16x16x32_f16 v[120:123], v[104:107], v[16:19], 0
    s_waitcnt lgkmcnt(6)
    v_mfma_f32_16x16x32_f16 v[124:127], v[108:111], v[16:19], 0
    s_waitcnt lgkmcnt(5)
    v_mfma_f32_16x16x32_f16 v[128:131], v[112:115], v[16:19], 0
    s_waitcnt lgkmcnt(4)
    v_mfma_f32_16x16x32_f16 v[132:135], v[116:119], v[16:19], 0
    s_waitcnt lgkmcnt(0)
    s_nop 0
    v_cvt_pk_f16_f32 v136, v120, v121
    v_cvt_pk_f16_f32 v137, v122, v123
    v_cvt_pk_f16_f32 v138, v124, v125
    v_cvt_pk_f16_f32 v139, v126, v127
    v_cvt_pk_f16_f32 v140, v128, v129
    v_cvt_pk_f16_f32 v141, v130, v131
    v_cvt_pk_f16_f32 v142, v132, v133
    v_cvt_pk_f16_f32 v143, v134, v135
    v_pk_mul_f16 v144, v136, v20
    v_pk_mul_f16 v145, v137, v21
    v_pk_mul_f16 v146, v138, v22
    v_pk_mul_f16 v147, v139, v23
    v_mov_b32_dpp v152, v136 quad_perm:[1,0,3,2] row_mask:0xf bank_mask:0xf
    v_mov_b32_dpp v153, v137 quad_perm:[1,0,3,2] row_mask:0xf bank_mask:0xf
    v_mov_b32_dpp v154, v138 quad_perm:[1,0,3,2] row_mask:0xf bank_mask:0xf
    v_mov_b32_dpp v155, v139 quad_perm:[1,0,3,2] row_mask:0xf bank_mask:0xf
    v_pk_fma_f16 v144, v152, v24, v144
    v_pk_fma_f16 v145, v153, v25, v145
    v_pk_fma_f16 v146, v154, v26, v146
    v_pk_fma_f16 v147, v155, v27, v147
    s_nop 1
    v_mfma_f32_16x16x32_f16 v[104:107], v[144:147], v[72:75], 0
    v_mfma_f32_16x16x32_f16 v[108:111], v[144:147], v[80:83], 0
    v_xor_b32_dpp v152, v144, v240 quad_perm:[1,0,3,2] row_mask:0xf bank_mask:0xf
    v_xor_b32_dpp v153, v145, v240 quad_perm:[1,0,3,2] row_mask:0xf bank_mask:0xf
    v_xor_b32_dpp v154, v146, v240 quad_perm:[1,0,3,2] row_mask:0xf bank_mask:0xf
    v_xor_b32_dpp v155, v147, v240 quad_perm:[1,0,3,2] row_mask:0xf bank_mask:0xf
    s_nop 1
    v_mfma_f32_16x16x32_f16 v[104:107], v[152:155], v[76:79], v[104:107]
    v_mfma_f32_16x16x32_f16 v[108:111], v[152:155], v[84:87], v[108:111]
    v_pk_mul_f16 v148, v140, v20
    v_pk_mul_f16 v149, v141, v21
    v_pk_mul_f16 v150, v142, v22
    v_pk_mul_f16 v151, v143, v23
    v_mov_b32_dpp v156, v140 quad_perm:[1,0,3,2] row_mask:0xf bank_mask:0xf
    v_mov_b32_dpp v157, v141 quad_perm:[1,0,3,2] row_mask:0xf bank_mask:0xf
    v_mov_b32_dpp v158, v142 quad_perm:[1,0,3,2] row_mask:0xf bank_mask:0xf
    v_mov_b32_dpp v159, v143 quad_perm:[1,0,3,2] row_mask:0xf bank_mask:0xf
    v_pk_fma_f16 v148, v156, v24, v148
    v_pk_fma_f16 v149, v157, v25, v149
    v_pk_fma_f16 v150, v158, v26, v150
    v_pk_fma_f16 v151, v159, v27, v151
    s_nop 1
    v_mfma_f32_16x16x32_f16 v[112:115], v[148:151], v[72:75], 0
    v_mfma_f32_16x16x32_f16 v[116:119], v[148:151], v[80:83], 0
    v_xor_b32_dpp v156, v148, v240 quad_perm:[1,0,3,2] row_mask:0xf bank_mask:0xf
    v_xor_b32_dpp v157, v149, v240 quad_perm:[1,0,3,2] row_mask:0xf bank_mask:0xf
    v_xor_b32_dpp v158, v150, v240 quad_perm:[1,0,3,2] row_mask:0xf bank_mask:0xf
    v_xor_b32_dpp v159, v151, v240 quad_perm:[1,0,3,2] row_mask:0xf bank_mask:0xf
    s_nop 1
    v_mfma_f32_16x16x32_f16 v[112:115], v[156:159], v[76:79], v[112:115]
    v_mfma_f32_16x16x32_f16 v[116:119], v[156:159], v[84:87], v[116:119]
    v_cvt_pk_f16_f32 v120, v104, v105
    v_cvt_pk_f16_f32 v122, v106, v107
    s_nop 4
    v_cvt_pk_f16_f32 v121, v112, v113
    v_cvt_pk_f16_f32 v123, v114, v115
    v_add_u32 v120, 0x20002, v120
    v_add_u32 v121, 0x20002, v121
    v_add_u32 v122, 0x20002, v122
    v_add_u32 v123, 0x20002, v123
    v_and_or_b32 v120, v120, v229, s44
    v_and_or_b32 v121, v121, v229, s45
    v_and_or_b32 v122, v122, v229, s46
    v_and_or_b32 v123, v123, v229, s47
    buffer_store_dwordx4 v[120:123], v226, s[4:7], s56 offen sc1
    v_cvt_pk_f16_f32 v124, v108, v109
    v_cvt_pk_f16_f32 v126, v110, v111
    v_cvt_pk_f16_f32 v125, v116, v117
    v_cvt_pk_f16_f32 v127, v118, v119
    v_add_u32 v124, 0x20002, v124
    v_add_u32 v125, 0x20002, v125
    v_add_u32 v126, 0x20002, v126
    v_add_u32 v127, 0x20002, v127
    v_and_or_b32 v124, v124, v229, s44
    v_and_or_b32 v125, v125, v229, s45
    v_and_or_b32 v126, v126, v229, s46
    v_and_or_b32 v127, v127, v229, s47
    buffer_store_dwordx4 v[124:127], v227, s[4:7], s56 offen sc1
    s_cmp_lg_u32 s57, 0
    s_cbranch_scc1 fz_nc3
    v_sub_u32 v8, 15, v4
    v_min_u32 v8, v4, v8
    v_and_b32 v9, 1, v8
    v_lshlrev_b32 v9, 5, v9
    v_lshrrev_b32 v10, 1, v8
    v_lshl_add_u32 v9, v10, 9, v9
    v_add_u32 v9, s25, v9
    v_sub_u32 v10, 2048, v9
    v_cmp_lt_u32 s[34:35], 7, v4
    s_nop 1
    v_cndmask_b32_e64 v230, v9, v10, s[34:35]
    v_mov_b32 v9, v4
    v_mov_b32 v10, s20
    s_cmp_lg_u32 s21, 0
    s_cbranch_scc0 fz_spec3a
fz_spec3backa:
    v_lshlrev_b32 v10, 7, v10
    v_lshl_add_u32 v10, v9, 3, v10
    v_mul_u32_u24 v11, 66048, v5
    v_add_u32 v228, v10, v11
    v_and_b32 v9, 1, v9
    v_cmp_eq_u32 vcc, 1, v9
    v_mov_b32 v9, s44
    v_mov_b32 v10, s46
    v_cndmask_b32_e64 v236, v9, v10, vcc
    v_mov_b32 v9, s45
    v_mov_b32 v10, s47
    v_cndmask_b32_e64 v237, v9, v10, vcc
    s_lshl_b32 s32, s3, 2
    v_add_u32 v8, s32, v5
    v_lshlrev_b32 v9, 6, v8
    v_cmp_gt_u32 vcc, 16, v8
    s_nop 1
    v_cndmask_b32_e64 v10, 0, 32, vcc
    v_add_u32 v10, v9, v10
    v_sub_u32 v11, 2048, v10
    v_cmp_eq_u32 vcc, 16, v8
    s_nop 1
    v_cndmask_b32_e64 v11, v11, 0, vcc
    v_mov_b32 v12, 0xffff0000
    v_cndmask_b32_e64 v238, -1, v12, vcc
    v_sub_u32 v12, 2018, v9
    v_mul_u32_u24 v13, 2064, v4
    v_add_u32 v231, v13, v9
    v_add_u32 v232, v13, v12
    v_add_u32 v233, v13, v10
    v_add_u32 v241, v13, v11
    s_lshl_b32 s32, s3, 8
    s_add_u32 s32, s32, 102912
    v_lshlrev_b32 v9, 4, v4
    v_add_u32 v10, s32, v9
    v_add_u32 v11, 107008, v239
    v_cmp_gt_u32 vcc, 16, v1
    s_nop 1
    v_cndmask_b32_e64 v243, v11, v10, vcc
    v_lshrrev_b32 v12, 2, v4
    v_cmp_eq_u32 vcc, v12, v5
    s_nop 1
    v_cndmask_b32_e64 v244, v11, v10, vcc
    v_lshrrev_b32 v12, 5, v1
    v_lshl_add_u32 v10, v12, 10, v9
    v_add_u32 v245, 102912, v10
    v_and_b32 v9, 1, v1
    v_cmp_eq_u32 s[28:29], 1, v9
    v_and_b32 v9, 2, v1
    v_cmp_eq_u32 s[30:31], 2, v9
    s_lshl_b32 s37, s3, 2
    v_add_u32 v9, s37, v5
    v_mul_u32_u24 v246, 2176, v9
    s_lshl_b32 s26, s20, 4
    s_add_u32 s26, s26, 0x580000
    v_lshlrev_b32 v247, 4, v5
    s_lshl_b32 s27, s20, 11
    s_lshl_b32 s37, s3, 8
    s_add_u32 s27, s27, s37
    s_add_u32 s27, s27, 0x448000
    v_sub_u32 v248, 2047, v230
    s_mov_b32 s14, 0x400000
    s_mov_b32 s15, 0x00020000
    s_mul_i32 s52, s3, 264192
    s_add_u32 s52, s52, 0x210000
    s_add_u32 s53, s52, 16512
    s_add_u32 s54, s52, 33024
    s_add_u32 s55, s52, 49536
    s_mov_b32 s23, s63
    s_getreg_b32 s24, hwreg(HW_REG_XCC_ID)
    s_and_b32 s24, s24, 15
    v_lshlrev_b32 v10, 4, v0
    v_min_u32 v10, 4336, v10
    v_add_u32 v10, 108032, v10
    v_mov_b32 v104, 0
    v_mov_b32 v105, 0
    v_mov_b32 v106, 0
    v_mov_b32 v107, 0
    ds_write_b128 v10, v[104:107]
    s_mov_b32 s58, 0
    s_waitcnt vmcnt(0)
    buffer_load_dwordx2 v[104:105], v228, s[4:7], s52 offen sc1
    buffer_load_dwordx2 v[106:107], v228, s[4:7], s53 offen sc1
    buffer_load_dwordx2 v[108:109], v228, s[4:7], s54 offen sc1
    buffer_load_dwordx2 v[110:111], v228, s[4:7], s55 offen sc1
    ds_read_b128 v[116:119], v231
    ds_read_b128 v[120:123], v231 offset:16
    ds_read_u16_d16_hi v44, v241
    ds_read_u16_d16_hi v45, v232 offset:28
    ds_read_u16_d16_hi v46, v232 offset:26
    ds_read_u16_d16_hi v47, v232 offset:24
    ds_read_u16_d16_hi v48, v232 offset:22
    ds_read_u16_d16_hi v49, v232 offset:20
    ds_read_u16_d16_hi v50, v232 offset:18
    ds_read_u16_d16_hi v51, v232 offset:16
    ds_read_u16_d16_hi v52, v232 offset:14
    ds_read_u16_d16_hi v53, v232 offset:12
    ds_read_u16_d16_hi v54, v232 offset:10
    ds_read_u16_d16_hi v55, v232 offset:8
    ds_read_u16_d16_hi v56, v232 offset:6
    ds_read_u16_d16_hi v57, v232 offset:4
    ds_read_u16_d16_hi v58, v232 offset:2
    ds_read_u16_d16_hi v59, v232 offset:0
    ds_read_u16_d16_hi v28, v233
    v_mul_u32_u24 v13, 2064, v4
    v_subrev_u32 v13, 104960, v13
    v_sub_u32 v9, v231, v13
    v_sub_u32 v10, v233, v13
    v_sub_u32 v11, v241, v13
    v_sub_u32 v12, v232, v13
    s_mov_b32 s36, 0xffff0000
    s_waitcnt lgkmcnt(0)
    ds_read_b128 v[200:203], v9
    ds_read_b128 v[204:207], v9 offset:16
    ds_read_u16_d16 v208, v11
    ds_read_u16_d16_hi v124, v12 offset:28
    ds_read_u16_d16 v209, v12 offset:26
    ds_read_u16_d16_hi v125, v12 offset:24
    ds_read_u16_d16 v210, v12 offset:22
    ds_read_u16_d16_hi v126, v12 offset:20
    ds_read_u16_d16 v211, v12 offset:18
    ds_read_u16_d16_hi v127, v12 offset:16
    ds_read_u16_d16 v212, v12 offset:14
    ds_read_u16_d16_hi v128, v12 offset:12
    ds_read_u16_d16 v213, v12 offset:10
    ds_read_u16_d16_hi v129, v12 offset:8
    ds_read_u16_d16 v214, v12 offset:6
    ds_read_u16_d16_hi v130, v12 offset:4
    ds_read_u16_d16 v215, v12 offset:2
    ds_read_u16_d16_hi v131, v12 offset:0
    ds_read_u16_d16 v13, v10
    v_and_b32 v29, s36, v116
    v_lshlrev_b32 v30, 16, v117
    v_and_b32 v31, s36, v117
    v_lshlrev_b32 v32, 16, v118
    v_and_b32 v33, s36, v118
    v_lshlrev_b32 v34, 16, v119
    v_and_b32 v35, s36, v119
    v_lshlrev_b32 v36, 16, v120
    v_and_b32 v37, s36, v120
    v_lshlrev_b32 v38, 16, v121
    v_and_b32 v39, s36, v121
    v_lshlrev_b32 v40, 16, v122
    v_and_b32 v41, s36, v122
    v_lshlrev_b32 v42, 16, v123
    v_and_b32 v43, s36, v123
    v_cmp_eq_u32 vcc, 1, v4
    v_mov_b32 v9, s42
    s_nop 0
    v_cndmask_b32_e64 v9, 0, v9, vcc
    v_mov_b32 v116, s42
    v_mov_b32 v117, s42
    v_mov_b32 v118, s42
    v_mov_b32 v119, s42
    v_cmp_eq_u32 vcc, 0, v4
    s_waitcnt lgkmcnt(0)
    v_and_or_b32 v200, v200, s36, v13
    v_or_b32 v208, v208, v124
    v_or_b32 v209, v209, v125
    v_or_b32 v210, v210, v126
    v_or_b32 v211, v211, v127
    v_or_b32 v212, v212, v128
    v_or_b32 v213, v213, v129
    v_or_b32 v214, v214, v130
    v_or_b32 v215, v215, v131
    v_cndmask_b32_e64 v200, v9, v200, vcc
    v_cndmask_b32_e64 v201, v9, v201, vcc
    v_cndmask_b32_e64 v202, v9, v202, vcc
    v_cndmask_b32_e64 v203, v9, v203, vcc
    v_cndmask_b32_e64 v204, v9, v204, vcc
    v_cndmask_b32_e64 v205, v9, v205, vcc
    v_cndmask_b32_e64 v206, v9, v206, vcc
    v_cndmask_b32_e64 v207, v9, v207, vcc
    v_cndmask_b32_e64 v208, v9, v208, vcc
    v_cndmask_b32_e64 v209, v9, v209, vcc
    v_cndmask_b32_e64 v210, v9, v210, vcc
    v_cndmask_b32_e64 v211, v9, v211, vcc
    v_cndmask_b32_e64 v212, v9, v212, vcc
    v_cndmask_b32_e64 v213, v9, v213, vcc
    v_cndmask_b32_e64 v214, v9, v214, vcc
    v_cndmask_b32_e64 v215, v9, v215, vcc
    v_mfma_f32_16x16x32_bf16 v[120:123], v[200:203], v[116:119], 0
    v_mfma_f32_16x16x32_bf16 v[120:123], v[204:207], v[116:119], v[120:123]
    v_mfma_f32_16x16x32_bf16 v[120:123], v[208:211], v[116:119], v[120:123]
    v_mfma_f32_16x16x32_bf16 v[120:123], v[212:215], v[116:119], v[120:123]
    s_nop 7
    ds_write_b32 v243, v120 offset:12
    s_branch fz_h2c
fz_h2:
    buffer_load_dwordx2 v[104:105], v228, s[4:7], s52 offen sc1
    buffer_load_dwordx2 v[106:107], v228, s[4:7], s53 offen sc1
    buffer_load_dwordx2 v[108:109], v228, s[4:7], s54 offen sc1
    buffer_load_dwordx2 v[110:111], v228, s[4:7], s55 offen sc1
fz_h2c:
    s_mov_b32 s36, 0x43000000
fz_h2_c0:
    s_waitcnt vmcnt(3)
    v_xor_b32 v104, v236, v104
    v_xor_b32 v105, v237, v105
    v_bitop3_b32 v9, v104, v105, v249 bitop3:0xa8
    v_cmp_ne_u32 vcc, 0, v9
    s_cbranch_vccnz fz_h2_r0
fz_h2_o0:
    v_mov_b32_dpp v112, v104 row_mirror row_mask:0xf bank_mask:0xf
    v_mov_b32_dpp v113, v105 row_mirror row_mask:0xf bank_mask:0xf
    s_cmp_eq_u32 s2, 66
    s_cbranch_scc1 fz_spec40
fz_spec4back0:
    v_fma_mix_f32 v28, v104, s36, v28 op_sel:[0,0,0] op_sel_hi:[1,0,0]
    v_fma_mix_f32 v29, v104, s36, v29 op_sel:[1,0,0] op_sel_hi:[1,0,0]
    v_fma_mix_f32 v30, v105, s36, v30 op_sel:[0,0,0] op_sel_hi:[1,0,0]
    v_fma_mix_f32 v31, v105, s36, v31 op_sel:[1,0,0] op_sel_hi:[1,0,0]
    v_and_b32 v112, v238, v112
    v_fma_mix_f32 v44, v112, s36, v44 op_sel:[0,0,0] op_sel_hi:[1,0,0]
    v_fma_mix_f32 v45, v112, s36, v45 op_sel:[1,0,0] op_sel_hi:[1,0,0]
    v_fma_mix_f32 v46, v113, s36, v46 op_sel:[0,0,0] op_sel_hi:[1,0,0]
    v_fma_mix_f32 v47, v113, s36, v47 op_sel:[1,0,0] op_sel_hi:[1,0,0]
    v_cvt_pk_bf16_f32 v120, v28, v29
    v_cvt_pk_bf16_f32 v121, v30, v31
    v_cvt_pk_bf16_f32 v128, v44, v45
    v_cvt_pk_bf16_f32 v129, v46, v47
fz_h2_c1:
    s_waitcnt vmcnt(2)
    v_xor_b32 v106, v236, v106
    v_xor_b32 v107, v237, v107
    v_bitop3_b32 v9, v106, v107, v249 bitop3:0xa8
    v_cmp_ne_u32 vcc, 0, v9
    s_cbranch_vccnz fz_h2_r1
fz_h2_o1:
    v_mov_b32_dpp v114, v106 row_mirror row_mask:0xf bank_mask:0xf
    v_mov_b32_dpp v115, v107 row_mirror row_mask:0xf bank_mask:0xf
    s_cmp_eq_u32 s2, 66
    s_cbranch_scc1 fz_spec41
fz_spec4back1:
    v_fma_mix_f32 v32, v106, s36, v32 op_sel:[0,0,0] op_sel_hi:[1,0,0]
    v_fma_mix_f32 v33, v106, s36, v33 op_sel:[1,0,0] op_sel_hi:[1,0,0]
    v_fma_mix_f32 v34, v107, s36, v34 op_sel:[0,0,0] op_sel_hi:[1,0,0]
    v_fma_mix_f32 v35, v107, s36, v35 op_sel:[1,0,0] op_sel_hi:[1,0,0]
    v_fma_mix_f32 v48, v114, s36, v48 op_sel:[0,0,0] op_sel_hi:[1,0,0]
    v_fma_mix_f32 v49, v114, s36, v49 op_sel:[1,0,0] op_sel_hi:[1,0,0]
    v_fma_mix_f32 v50, v115, s36, v50 op_sel:[0,0,0] op_sel_hi:[1,0,0]
    v_fma_mix_f32 v51, v115, s36, v51 op_sel:[1,0,0] op_sel_hi:[1,0,0]
    v_cvt_pk_bf16_f32 v122, v32, v33
    v_cvt_pk_bf16_f32 v123, v34, v35
    v_cvt_pk_bf16_f32 v130, v48, v49
    v_cvt_pk_bf16_f32 v131, v50, v51
    v_mfma_f32_16x16x32_bf16 v[136:139], v[120:123], v[120:123], 0
    v_mfma_f32_16x16x32_bf16 v[140:143], v[200:203], v[120:123], 0
    v_mfma_f32_16x16x32_bf16 v[136:139], v[128:131], v[128:131], v[136:139]
    v_mfma_f32_16x16x32_bf16 v[140:143], v[208:211], v[128:131], v[140:143]
fz_h2_c2:
    s_waitcnt vmcnt(1)
    v_xor_b32 v108, v236, v108
    v_xor_b32 v109, v237, v109
    v_bitop3_b32 v9, v108, v109, v249 bitop3:0xa8
    v_cmp_ne_u32 vcc, 0, v9
    s_cbranch_vccnz fz_h2_r2
fz_h2_o2:
    v_mov_b32_dpp v116, v108 row_mirror row_mask:0xf bank_mask:0xf
    v_mov_b32_dpp v117, v109 row_mirror row_mask:0xf bank_mask:0xf
    s_cmp_eq_u32 s2, 66
    s_cbranch_scc1 fz_spec42
fz_spec4back2:
    v_fma_mix_f32 v36, v108, s36, v36 op_sel:[0,0,0] op_sel_hi:[1,0,0]
    v_fma_mix_f32 v37, v108, s36, v37 op_sel:[1,0,0] op_sel_hi:[1,0,0]
    v_fma_mix_f32 v38, v109, s36, v38 op_sel:[0,0,0] op_sel_hi:[1,0,0]
    v_fma_mix_f32 v39, v109, s36, v39 op_sel:[1,0,0] op_sel_hi:[1,0,0]
    v_fma_mix_f32 v52, v116, s36, v52 op_sel:[0,0,0] op_sel_hi:[1,0,0]
    v_fma_mix_f32 v53, v116, s36, v53 op_sel:[1,0,0] op_sel_hi:[1,0,0]
    v_fma_mix_f32 v54, v117, s36, v54 op_sel:[0,0,0] op_sel_hi:[1,0,0]
    v_fma_mix_f32 v55, v117, s36, v55 op_sel:[1,0,0] op_sel_hi:[1,0,0]
    v_cvt_pk_bf16_f32 v124, v36, v37
    v_cvt_pk_bf16_f32 v125, v38, v39
    v_cvt_pk_bf16_f32 v132, v52, v53
    v_cvt_pk_bf16_f32 v133, v54, v55
fz_h2_c3:
    s_waitcnt vmcnt(0)
    v_xor_b32 v110, v236, v110
    v_xor_b32 v111, v237, v111
    v_bitop3_b32 v9, v110, v111, v249 bitop3:0xa8
    v_cmp_ne_u32 vcc, 0, v9
    s_cbranch_vccnz fz_h2_r3
fz_h2_o3:
    v_mov_b32_dpp v118, v110 row_mirror row_mask:0xf bank_mask:0xf
    v_mov_b32_dpp v119, v111 row_mirror row_mask:0xf bank_mask:0xf
    s_cmp_eq_u32 s2, 66
    s_cbranch_scc1 fz_spec43
fz_spec4back3:
    v_fma_mix_f32 v40, v110, s36, v40 op_sel:[0,0,0] op_sel_hi:[1,0,0]
    v_fma_mix_f32 v41, v110, s36, v41 op_sel:[1,0,0] op_sel_hi:[1,0,0]
    v_fma_mix_f32 v42, v111, s36, v42 op_sel:[0,0,0] op_sel_hi:[1,0,0]
    v_fma_mix_f32 v43, v111, s36, v43 op_sel:[1,0,0] op_sel_hi:[1,0,0]
    v_fma_mix_f32 v56, v118, s36, v56 op_sel:[0,0,0] op_sel_hi:[1,0,0]
    v_fma_mix_f32 v57, v118, s36, v57 op_sel:[1,0,0] op_sel_hi:[1,0,0]
    v_fma_mix_f32 v58, v119, s36, v58 op_sel:[0,0,0] op_sel_hi:[1,0,0]
    v_fma_mix_f32 v59, v119, s36, v59 op_sel:[1,0,0] op_sel_hi:[1,0,0]
    v_cvt_pk_bf16_f32 v126, v40, v41
    v_cvt_pk_bf16_f32 v127, v42, v43
    v_cvt_pk_bf16_f32 v134, v56, v57
    v_cvt_pk_bf16_f32 v135, v58, v59
    v_mfma_f32_16x16x32_bf16 v[136:139], v[124:127], v[124:127], v[136:139]
    v_mfma_f32_16x16x32_bf16 v[140:143], v[204:207], v[124:127], v[140:143]
    v_mfma_f32_16x16x32_bf16 v[136:139], v[132:135], v[132:135], v[136:139]
    v_mfma_f32_16x16x32_bf16 v[140:143], v[212:215], v[132:135], v[140:143]
    s_nop 6
    v_cndmask_b32_e64 v9, v136, v137, s[28:29]
    v_cndmask_b32_e64 v10, v138, v139, s[28:29]
    ds_write_b64 v243, v[140:141]
    v_cndmask_b32_e64 v9, v9, v10, s[30:31]
    ds_write_b32 v244, v9 offset:8
    s_cmp_gt_u32 s3, 3
    s_cbranch_scc1 fz_lp
    s_setprio 2
fz_lp:
    s_waitcnt lgkmcnt(0)
    s_barrier
    ds_read_b128 v[144:147], v245 offset:0
    ds_read_b128 v[148:151], v245 offset:256
    ds_read_b128 v[152:155], v245 offset:512
    ds_read_b128 v[156:159], v245 offset:768
    s_waitcnt lgkmcnt(2)
    v_pk_add_f32 v[144:145], v[144:145], v[148:149]
    v_pk_add_f32 v[146:147], v[146:147], v[150:151]
    s_waitcnt lgkmcnt(0)
    v_pk_add_f32 v[152:153], v[152:153], v[156:157]
    v_pk_add_f32 v[154:155], v[154:155], v[158:159]
    v_pk_add_f32 v[144:145], v[144:145], v[152:153]
    v_pk_add_f32 v[146:147], v[146:147], v[154:155]
    v_mov_b32 v148, v144
    v_mov_b32 v149, v145
    v_mov_b32 v150, v146
    v_mov_b32 v151, v147
    v_permlane32_swap_b32 v144, v148
    v_permlane32_swap_b32 v145, v149
    v_permlane32_swap_b32 v146, v150
    v_permlane32_swap_b32 v147, v151
    v_pk_add_f32 v[144:145], v[144:145], v[148:149]
    v_pk_add_f32 v[146:147], v[146:147], v[150:151]
    v_mul_f32 v145, 0xba800000, v145
    v_mul_f32 v146, 0x3a800000, v146
    v_fma_f32 v146, -v145, v145, v146
    v_cvt_pk_bf16_f32 v153, 0, v145
    v_cvt_pk_bf16_f32 v146, 0, v146
    v_add_f32 v146, 0x3727c5ac, v146
    v_cvt_pk_bf16_f32 v146, 0, v146
    v_sqrt_f32 v146, v146
    v_fmac_f32 v144, v153, v147
    v_cvt_pk_bf16_f32 v146, 0, v146
    v_rcp_f32 v154, v146
    v_mov_b32 v155, s40
    v_mul_f32 v144, v144, v154
    v_cvt_pk_bf16_f32 v144, 0, v144
    v_ashrrev_i32 v145, 31, v144
    v_or_b32 v145, 0x80000000, v145
    v_bitop3_b32 v152, v144, v145, v242 bitop3:0x28
    v_or_b32 v152, v152, v248
    s_nop 1
    v_max_u32_dpp v144, v152, v152 row_ror:1 row_mask:0xf bank_mask:0xf
    s_nop 1
    v_max_u32_dpp v144, v144, v144 row_ror:2 row_mask:0xf bank_mask:0xf
    s_nop 1
    v_max_u32_dpp v144, v144, v144 row_ror:4 row_mask:0xf bank_mask:0xf
    s_nop 1
    v_max_u32_dpp v144, v144, v144 row_ror:8 row_mask:0xf bank_mask:0xf
    v_cmp_eq_u32 vcc, v144, v152
    v_or_b32 v153, s24, v153
    s_nop 0
    s_mov_b64 exec, vcc
    buffer_store_dwordx4 v[152:155], v246, s[4:7], s26 offen sc1
    s_add_u32 s26, s26, 69632
    buffer_store_dwordx4 v[152:155], v246, s[4:7], s26 offen sc1
    buffer_store_dwordx4 v[120:123], v247, s[4:7], s27 offen offset:0 sc1
    buffer_store_dwordx4 v[124:127], v247, s[4:7], s27 offen offset:64 sc1
    buffer_store_dwordx4 v[128:131], v247, s[4:7], s27 offen offset:128 sc1
    buffer_store_dwordx4 v[132:135], v247, s[4:7], s27 offen offset:192 sc1
    s_mov_b64 exec, -1
    s_setprio 0
    s_ff1_i32_b64 s37, vcc
    v_add_f32 v144, 1.0, v154
    v_and_b32 v146, v242, v153
    v_mul_f32 v146, v146, v154
    v_pk_fma_f32 v[28:29], v[28:29], v[144:145], v[146:147] op_sel_hi:[1,0,0]
    v_pk_fma_f32 v[30:31], v[30:31], v[144:145], v[146:147] op_sel_hi:[1,0,0]
    v_pk_fma_f32 v[32:33], v[32:33], v[144:145], v[146:147] op_sel_hi:[1,0,0]
    v_pk_fma_f32 v[34:35], v[34:35], v[144:145], v[146:147] op_sel_hi:[1,0,0]
    v_pk_fma_f32 v[36:37], v[36:37], v[144:145], v[146:147] op_sel_hi:[1,0,0]
    v_pk_fma_f32 v[38:39], v[38:39], v[144:145], v[146:147] op_sel_hi:[1,0,0]
    v_pk_fma_f32 v[40:41], v[40:41], v[144:145], v[146:147] op_sel_hi:[1,0,0]
    v_pk_fma_f32 v[42:43], v[42:43], v[144:145], v[146:147] op_sel_hi:[1,0,0]
    v_pk_fma_f32 v[44:45], v[44:45], v[144:145], v[146:147] op_sel_hi:[1,0,0]
    v_pk_fma_f32 v[46:47], v[46:47], v[144:145], v[146:147] op_sel_hi:[1,0,0]
    v_pk_fma_f32 v[48:49], v[48:49], v[144:145], v[146:147] op_sel_hi:[1,0,0]
    v_pk_fma_f32 v[50:51], v[50:51], v[144:145], v[146:147] op_sel_hi:[1,0,0]
    v_pk_fma_f32 v[52:53], v[52:53], v[144:145], v[146:147] op_sel_hi:[1,0,0]
    v_pk_fma_f32 v[54:55], v[54:55], v[144:145], v[146:147] op_sel_hi:[1,0,0]
    v_pk_fma_f32 v[56:57], v[56:57], v[144:145], v[146:147] op_sel_hi:[1,0,0]
    v_pk_fma_f32 v[58:59], v[58:59], v[144:145], v[146:147] op_sel_hi:[1,0,0]
    v_cvt_pk_bf16_f32 v104, v28, v29
    v_cvt_pk_bf16_f32 v105, v30, v31
    v_cvt_pk_bf16_f32 v106, v32, v33
    v_cvt_pk_bf16_f32 v107, v34, v35
    v_cvt_pk_bf16_f32 v108, v36, v37
    v_cvt_pk_bf16_f32 v109, v38, v39
    v_cvt_pk_bf16_f32 v110, v40, v41
    v_cvt_pk_bf16_f32 v111, v42, v43
    v_cvt_pk_bf16_f32 v112, v44, v45
    v_cvt_pk_bf16_f32 v113, v46, v47
    v_cvt_pk_bf16_f32 v114, v48, v49
    v_cvt_pk_bf16_f32 v115, v50, v51
    v_cvt_pk_bf16_f32 v116, v52, v53
    v_cvt_pk_bf16_f32 v117, v54, v55
    v_cvt_pk_bf16_f32 v118, v56, v57
    v_cvt_pk_bf16_f32 v119, v58, v59
    ds_write_b128 v231, v[104:107]
    ds_write_b128 v231, v[108:111] offset:16
    s_waitcnt lgkmcnt(0)
    s_barrier
    s_cmp_lt_u32 s3, 4
    s_cbranch_scc1 fz_now4
    buffer_load_dwordx4 v[192:195], v14, s[64:67], s62 offen offset:0 nt
    buffer_load_dwordx4 v[196:199], v14, s[64:67], s62 offen offset:256 nt
    s_add_u32 s62, s62, 8192
    buffer_load_dwordx4 v[60:63], v14, s[64:67], s62 offen offset:0 nt
    buffer_load_dwordx4 v[64:67], v14, s[64:67], s62 offen offset:256 nt
    s_add_u32 s62, s62, 8192
    buffer_load_dwordx4 v[68:71], v14, s[64:67], s62 offen offset:0 nt
    buffer_load_dwordx4 v[88:91], v14, s[64:67], s62 offen offset:256 nt
    s_add_u32 s62, s62, 8192
    buffer_load_dwordx4 v[92:95], v14, s[64:67], s62 offen offset:0 nt
    buffer_load_dwordx4 v[96:99], v14, s[64:67], s62 offen offset:256 nt
fz_now4:
    ds_write_b16 v233, v104
    ds_write_b16 v241, v112
    ds_write_b16_d16_hi v232, v112 offset:28
    ds_write_b16 v232, v113 offset:26
    ds_write_b16_d16_hi v232, v113 offset:24
    ds_write_b16 v232, v114 offset:22
    ds_write_b16_d16_hi v232, v114 offset:20
    ds_write_b16 v232, v115 offset:18
    ds_write_b16_d16_hi v232, v115 offset:16
    ds_write_b16 v232, v116 offset:14
    ds_write_b16_d16_hi v232, v116 offset:12
    ds_write_b16 v232, v117 offset:10
    ds_write_b16_d16_hi v232, v117 offset:8
    ds_write_b16 v232, v118 offset:6
    ds_write_b16_d16_hi v232, v118 offset:4
    ds_write_b16 v232, v119 offset:2
    ds_write_b16_d16_hi v232, v119 offset:0
    s_lshl_b32 s32, s3, 1
    s_add_u32 s33, s32, 1
    v_readlane_b32 s34, v230, s32
    v_readlane_b32 s35, v230, s33
    s_mul_i32 s38, s3, 4128
    v_add_u32 v9, s38, v239
    s_lshl_b32 s34, s34, 11
    s_lshl_b32 s35, s35, 11
    s_waitcnt lgkmcnt(0)
    s_barrier
    ds_read_b128 v[104:107], v9 offset:0
    ds_read_b128 v[108:111], v9 offset:1024
    ds_read_b128 v[112:115], v9 offset:2064
    ds_read_b128 v[116:119], v9 offset:3088
    s_lshr_b32 s59, s37, 1
    s_xor_b32 s18, s59, 1
    s_and_b32 s18, s18, 3
    s_cmp_lt_u32 s23, 112
    s_cselect_b32 s38, s18, 8
    s_cmp_eq_u32 s38, s3
    s_cbranch_scc1 fz_sk1
    s_waitcnt lgkmcnt(0)
    s_cmp_eq_u32 s37, s32
    s_cbranch_scc1 fz_sk0
    buffer_store_dwordx4 v[104:107], v239, s[12:15], s34 offen offset:0 sc1
    buffer_store_dwordx4 v[108:111], v239, s[12:15], s34 offen offset:1024 sc1
fz_sk0:
    s_cmp_eq_u32 s37, s33
    s_cbranch_scc1 fz_sk1
    buffer_store_dwordx4 v[112:115], v239, s[12:15], s35 offen offset:0 sc1
    buffer_store_dwordx4 v[116:119], v239, s[12:15], s35 offen offset:1024 sc1
fz_sk1:
    v_and_b32 v15, 7, v4
    v_mul_u32_u24 v15, 544, v15
    v_lshl_add_u32 v15, v5, 4, v15
    v_add_u32 v15, 108032, v15
    s_lshl_b32 s63, s23, 5
    s_and_b32 s38, s3, 3
    s_mul_i32 s38, s38, 118784
    s_add_u32 s63, s63, s38
    s_add_u32 s63, s63, 0x4c8000
    v_lshrrev_b32 v13, 1, v1
    v_mul_u32_u24 v13, 3712, v13
    v_and_b32 v14, 1, v1
    v_lshl_add_u32 v102, v14, 4, v13
    v_add_u32 v103, 59392, v102
    s_lshl_b32 s38, s20, 5
    s_add_u32 s38, s38, 0x548000
    s_cmp_lt_u32 s3, 4
    s_cselect_b32 s63, s38, s63
    v_mov_b32 v14, 0xffffff00
    s_cmp_eq_u32 s18, s3
    s_cbranch_scc1 fz_act
    s_cmp_lg_u32 s59, s3
    s_cbranch_scc1 fz_f2
    s_and_b32 s38, s20, 15
    s_add_u32 s38, s38, 16
    s_mul_i32 s38, s38, 2176
    s_add_u32 s38, s38, 0x580000
    s_lshr_b32 s52, s20, 4
    s_lshl_b32 s52, s52, 7
    s_and_b32 s53, s20, 7
    s_lshl_b32 s53, s53, 4
    s_add_u32 s52, s52, s53
    s_bfe_u32 s53, s20, 0x10003
    s_lshl_b32 s53, s53, 2
    s_add_u32 s52, s52, s53
    v_and_b32 v2, 1, v1
    v_lshl_add_u32 v2, v2, 3, v5
    v_add_u32 v2, s52, v2
    v_and_b32 v3, 31, v2
    v_lshrrev_b32 v6, 5, v2
    v_cmp_gt_u32 vcc, 16, v6
    v_cmp_lt_u32 s[52:53], 16, v3
    v_cmp_eq_u32 s[54:55], 0, v3
    s_nop 1
    s_and_b64 s[54:55], s[54:55], vcc
    s_or_b64 s[52:53], s[52:53], s[54:55]
    v_cmp_eq_u32 s[54:55], 16, v3
    s_nop 1
    s_andn2_b64 s[54:55], s[54:55], vcc
    s_or_b64 s[52:53], s[52:53], s[54:55]
    v_sub_u32 v7, 1024, v2
    v_cndmask_b32_e64 v7, v2, v7, s[52:53]
    v_mov_b32 v8, 512
    v_cmp_eq_u32 vcc, 1024, v7
    s_nop 1
    v_cndmask_b32_e64 v7, v7, v8, vcc
    v_lshrrev_b32 v8, 5, v7
    v_and_b32 v7, 15, v7
    v_lshrrev_b32 v9, 2, v8
    v_lshlrev_b32 v9, 8, v9
    v_and_b32 v8, 3, v8
    v_lshl_add_u32 v9, v8, 4, v9
    v_lshrrev_b32 v8, 3, v7
    v_lshl_add_u32 v9, v8, 6, v9
    v_and_b32 v7, 7, v7
    v_lshl_add_u32 v9, v7, 1, v9
    v_cndmask_b32_e64 v7, 0, 1, s[52:53]
    v_lshl_add_u32 v9, v7, 7, v9
    v_lshlrev_b32 v2, 1, v2
    v_lshrrev_b32 v3, 1, v1
    v_mul_u32_u24 v3, 32, v3
    v_and_b32 v6, 1, v1
    v_lshl_add_u32 v3, v6, 4, v3
    v_mov_b32 v6, 0x7fffffff
    v_cmp_gt_u32 vcc, 32, v1
    s_nop 1
    v_cndmask_b32_e64 v6, v6, v3, vcc
    v_mov_b32 v7, s48
    v_cndmask_b32_e64 v16, 0, v7, vcc
    v_mov_b32 v7, s49
    v_cndmask_b32_e64 v17, 0, v7, vcc
    v_mov_b32 v7, s50
    v_cndmask_b32_e64 v18, 0, v7, vcc
    v_mov_b32 v7, s51
    v_cndmask_b32_e64 v19, 0, v7, vcc
    s_mul_i32 s52, s20, 3712
    s_add_u32 s52, s52, 0x4c8000
    s_add_u32 s53, s52, 1024
    s_add_u32 s54, s52, 2048
    s_add_u32 s55, s52, 3072
    v_lshlrev_b32 v20, 4, v1
    v_add_u32 v21, 1024, v20
    s_mov_b32 s58, 0
    s_nop 3
fz_k2:
    buffer_load_dwordx4 v[24:27], v20, s[4:7], s38 offen sc1
    buffer_load_dwordx4 v[28:31], v21, s[4:7], s38 offen sc1
    s_waitcnt vmcnt(0)
    v_xor_b32 v32, s40, v27
    v_xor_b32 v33, s40, v31
    v_max_u32 v34, v24, v28
    v_or_b32 v32, v32, v33
    v_cmp_ne_u32 vcc, 0, v32
    s_cbranch_vccnz fz_k2_rt
fz_k2_ok:
    v_max_u32_dpp v34, v34, v34 quad_perm:[1,0,3,2] row_mask:0xf bank_mask:0xf
    s_nop 1
    v_max_u32_dpp v34, v34, v34 quad_perm:[2,3,0,1] row_mask:0xf bank_mask:0xf
    s_nop 1
    v_max_u32_dpp v34, v34, v34 row_half_mirror row_mask:0xf bank_mask:0xf
    s_nop 1
    v_max_u32_dpp v34, v34, v34 row_mirror row_mask:0xf bank_mask:0xf
    s_nop 1
    v_max_u32_dpp v34, v34, v34 row_bcast:15 row_mask:0xa bank_mask:0xf
    s_nop 1
    v_max_u32_dpp v34, v34, v34 row_bcast:31 row_mask:0xc bank_mask:0xf
    s_nop 0
    v_readlane_b32 s36, v34, 63
    s_nop 1
    v_cmp_eq_u32 vcc, s36, v24
    v_cmp_eq_u32 s[56:57], s36, v28
    s_nop 1
    v_cndmask_b32_e64 v25, v25, v29, s[56:57]
    v_cndmask_b32_e64 v26, v26, v30, s[56:57]
    s_cmp_lg_u64 vcc, 0
    s_cselect_b32 s39, 0, 64
    s_or_b64 vcc, vcc, s[56:57]
    s_ff1_i32_b64 s41, vcc
    v_readlane_b32 s42, v25, s41
    v_readlane_b32 s43, v26, s41
    s_add_u32 s39, s39, s41
    s_and_b32 s42, s42, 0xffff0000
    s_cmp_eq_u32 s39, s20
    s_cbranch_scc1 fz_win
    s_bitcmp1_b32 s37, 0
    s_cbranch_scc1 fz_d1
    buffer_store_dwordx4 v[104:107], v239, s[12:15], s34 offen offset:0 sc1
    buffer_store_dwordx4 v[108:111], v239, s[12:15], s34 offen offset:1024 sc1
    s_branch fz_win
fz_d1:
    buffer_store_dwordx4 v[112:115], v239, s[12:15], s35 offen offset:0 sc1
    buffer_store_dwordx4 v[116:119], v239, s[12:15], s35 offen offset:1024 sc1
fz_win:
    s_lshl_b32 s39, s39, 11
    s_add_u32 s39, s39, 0x448000
    s_mov_b32 s58, 0
    s_mov_b32 s41, 0xffff0000
    s_nop 0
fz_c2:
    buffer_load_short_d16_hi v10, v9, s[4:7], s39 offen sc1
    s_waitcnt vmcnt(0)
    v_cmp_eq_u32 vcc, s41, v10
    s_cbranch_vccnz fz_c2_rt
fz_c2_ok:
    v_add_f32 v11, s42, v10
    v_cvt_pk_bf16_f32 v11, 0, v11
    v_mul_f32 v11, s43, v11
    v_cvt_pk_bf16_f32 v11, 0, v11
    s_ashr_i32 s39, s36, 31
    s_not_b32 s39, s39
    s_or_b32 s39, s39, 0x80000000
    s_xor_b32 s39, s36, s39
    s_and_b32 s39, s39, 0xffff0000
    v_mov_b32 v12, s39
    v_mul_f32 v12, 0xbfb8aa3b, v12
    v_exp_f32 v12, v12
    s_nop 0
    v_add_f32 v12, 1.0, v12
    v_rcp_f32 v12, v12
    s_nop 0
    v_cvt_pk_bf16_f32 v12, 0, v12
    s_and_b32 s39, s36, 0xffff
    s_sub_u32 s39, 2047, s39
    s_lshl_b32 s39, s39, 11
    v_mov_b32 v13, 0xff
    s_waitcnt lgkmcnt(0)
fz_f2:
    s_cmp_gt_u32 s23, 111
    s_cbranch_scc1 fz_nof2
    s_barrier
    s_cmp_eq_u32 s59, s3
    s_cselect_b32 s19, 4, s3
    s_cmp_lt_u32 s19, 4
    s_cbranch_scc1 fz_f2d
    ds_read_b128 v[120:123], v15 offset:0
    ds_read_b128 v[124:127], v15 offset:64
    ds_read_b128 v[128:131], v15 offset:128
    ds_read_b128 v[132:135], v15 offset:192
    ds_read_b128 v[136:139], v15 offset:256
    ds_read_b128 v[140:143], v15 offset:320
    ds_read_b128 v[144:147], v15 offset:384
    ds_read_b128 v[148:151], v15 offset:448
    s_waitcnt vmcnt(2)
    s_waitcnt lgkmcnt(7)
    v_mfma_f32_16x16x32_bf16 v[152:155], v[120:123], v[160:163], 0
    v_mfma_f32_16x16x32_bf16 v[156:159], v[120:123], v[164:167], 0
    s_waitcnt lgkmcnt(6)
    v_mfma_f32_16x16x32_bf16 v[152:155], v[124:127], v[168:171], v[152:155]
    v_mfma_f32_16x16x32_bf16 v[156:159], v[124:127], v[172:175], v[156:159]
    s_waitcnt lgkmcnt(5)
    v_mfma_f32_16x16x32_bf16 v[152:155], v[128:131], v[176:179], v[152:155]
    v_mfma_f32_16x16x32_bf16 v[156:159], v[128:131], v[180:183], v[156:159]
    s_waitcnt lgkmcnt(4)
    v_mfma_f32_16x16x32_bf16 v[152:155], v[132:135], v[184:187], v[152:155]
    v_mfma_f32_16x16x32_bf16 v[156:159], v[132:135], v[188:191], v[156:159]
    s_waitcnt lgkmcnt(3)
    v_mfma_f32_16x16x32_bf16 v[152:155], v[136:139], v[192:195], v[152:155]
    v_mfma_f32_16x16x32_bf16 v[156:159], v[136:139], v[196:199], v[156:159]
    s_waitcnt lgkmcnt(2)
    v_mfma_f32_16x16x32_bf16 v[152:155], v[140:143], v[60:63], v[152:155]
    v_mfma_f32_16x16x32_bf16 v[156:159], v[140:143], v[64:67], v[156:159]
    s_waitcnt lgkmcnt(1)
    v_mfma_f32_16x16x32_bf16 v[152:155], v[144:147], v[68:71], v[152:155]
    v_mfma_f32_16x16x32_bf16 v[156:159], v[144:147], v[88:91], v[156:159]
    s_waitcnt lgkmcnt(0)
    v_mfma_f32_16x16x32_bf16 v[152:155], v[148:151], v[92:95], v[152:155]
    v_mfma_f32_16x16x32_bf16 v[156:159], v[148:151], v[96:99], v[156:159]
    s_mov_b32 exec_hi, 0
    s_nop 5
    v_and_or_b32 v152, v152, v14, s48
    v_and_or_b32 v153, v153, v14, s49
    v_and_or_b32 v154, v154, v14, s50
    v_and_or_b32 v155, v155, v14, s51
    buffer_store_dwordx4 v[152:155], v102, s[4:7], s63 offen sc1
    v_and_or_b32 v156, v156, v14, s48
    v_and_or_b32 v157, v157, v14, s49
    v_and_or_b32 v158, v158, v14, s50
    v_and_or_b32 v159, v159, v14, s51
    buffer_store_dwordx4 v[156:159], v103, s[4:7], s63 offen sc1
fz_f2d:
    s_mov_b32 exec_hi, -1
    s_cmp_eq_u32 s18, s3
    s_cbranch_scc1 fz_late
    s_cmp_lg_u32 s59, s3
    s_cbranch_scc1 fz_xend
    v_mov_b32 v7, 0
    s_waitcnt vmcnt(0)
    s_branch fz_p5_ok
    s_nop 2
fz_nof2:
    s_cmp_lg_u32 s59, s3
    s_cbranch_scc1 fz_xend
    s_mov_b32 s58, 0
    s_and_b32 s41, s20, 63
    s_mul_i32 s41, s41, 32
    s_add_u32 s41, s41, s52
    v_mov_b32 v7, 0
    s_nop 4
fz_p5:
    buffer_load_dword v8, v7, s[4:7], s41 offen sc1
    s_waitcnt vmcnt(0)
    v_and_b32 v8, 0xff, v8
    v_cmp_ne_u32 vcc, s48, v8
    s_cbranch_vccnz fz_p5_rt
fz_p5_ok:
    s_mov_b32 s58, 0
    buffer_load_dwordx4 v[40:43], v3, s[4:7], s52 offen sc1
    buffer_load_dwordx4 v[44:47], v3, s[4:7], s53 offen sc1
    buffer_load_dwordx4 v[48:51], v3, s[4:7], s54 offen sc1
    buffer_load_dwordx4 v[52:55], v6, s[4:7], s55 offen sc1
fz_h5_c0:
    s_waitcnt vmcnt(3)
    v_xor_b32 v40, s48, v40
    v_xor_b32 v41, s49, v41
    v_xor_b32 v42, s50, v42
    v_xor_b32 v43, s51, v43
    v_or3_b32 v8, v40, v41, v42
    v_bitop3_b32 v8, v8, v43, v13 bitop3:0xa8
    v_cmp_ne_u32 vcc, 0, v8
    s_cbranch_vccnz fz_h5_r0
fz_h5_o0:
fz_h5_c1:
    s_waitcnt vmcnt(2)
    v_xor_b32 v44, s48, v44
    v_xor_b32 v45, s49, v45
    v_xor_b32 v46, s50, v46
    v_xor_b32 v47, s51, v47
    v_or3_b32 v8, v44, v45, v46
    v_bitop3_b32 v8, v8, v47, v13 bitop3:0xa8
    v_cmp_ne_u32 vcc, 0, v8
    s_cbranch_vccnz fz_h5_r1
fz_h5_o1:
    v_pk_add_f32 v[40:41], v[40:41], v[44:45]
    v_pk_add_f32 v[42:43], v[42:43], v[46:47]
fz_h5_c2:
    s_waitcnt vmcnt(1)
    v_xor_b32 v48, s48, v48
    v_xor_b32 v49, s49, v49
    v_xor_b32 v50, s50, v50
    v_xor_b32 v51, s51, v51
    v_or3_b32 v8, v48, v49, v50
    v_bitop3_b32 v8, v8, v51, v13 bitop3:0xa8
    v_cmp_ne_u32 vcc, 0, v8
    s_cbranch_vccnz fz_h5_r2
fz_h5_o2:
    v_pk_add_f32 v[40:41], v[40:41], v[48:49]
    v_pk_add_f32 v[42:43], v[42:43], v[50:51]
fz_h5_c3:
    s_waitcnt vmcnt(0)
    v_xor_b32 v52, v16, v52
    v_xor_b32 v53, v17, v53
    v_xor_b32 v54, v18, v54
    v_xor_b32 v55, v19, v55
    v_or3_b32 v8, v52, v53, v54
    v_bitop3_b32 v8, v8, v55, v13 bitop3:0xa8
    v_cmp_ne_u32 vcc, 0, v8
    s_cbranch_vccnz fz_h5_r3
fz_h5_o3:
    v_pk_add_f32 v[40:41], v[40:41], v[52:53]
    v_pk_add_f32 v[42:43], v[42:43], v[54:55]
    s_nop 1
    v_permlane32_swap_b32 v40, v42
    v_permlane32_swap_b32 v41, v43
    v_pk_add_f32 v[40:41], v[40:41], v[42:43]
    s_nop 1
    v_permlane16_swap_b32 v40, v41
    v_add_f32 v40, v40, v41
    s_nop 1
    v_add_f32_dpp v40, v40, v40 quad_perm:[2,3,0,1] row_mask:0xf bank_mask:0xf
    s_nop 1
    v_add_f32_dpp v40, v40, v40 row_ror:4 row_mask:0xf bank_mask:0xf
    s_nop 1
    v_add_f32_dpp v40, v40, v40 row_ror:8 row_mask:0xf bank_mask:0xf
    v_cvt_pk_bf16_f32 v40, 0, v40
    v_mul_f32 v40, v40, v12
    v_cvt_pk_bf16_f32 v40, 0, v40
    v_add_f32 v40, v40, v11
    v_cvt_pk_bf16_f32 v40, 0, v40
    v_add_f32 v40, v40, v10
    v_cvt_pk_bf16_f32 v40, 0, v40
    s_mov_b32 exec_lo, 0x00030003
    s_mov_b32 exec_hi, 0x00030003
    buffer_store_short_d16_hi v40, v2, s[12:15], s39 offen
    s_cmp_lg_u32 s20, 0
    s_cbranch_scc1 fz_xend
    s_mov_b64 exec, 1
    v_mov_b32 v8, s40
    buffer_store_dword v8, v7, s[4:7], 0 offen
fz_xend:
fz_end:
    s_endpgm
fz_late:
    buffer_store_dwordx4 v[104:107], v239, s[12:15], s34 offen offset:0 sc1
    buffer_store_dwordx4 v[108:111], v239, s[12:15], s34 offen offset:1024 sc1
    buffer_store_dwordx4 v[112:115], v239, s[12:15], s35 offen offset:0 sc1
    buffer_store_dwordx4 v[116:119], v239, s[12:15], s35 offen offset:1024 sc1
    s_branch fz_xend
fz_act:
    s_cmp_gt_u32 s23, 111
    s_cbranch_scc1 fz_xend
    v_lshlrev_b32 v2, 2, v1
    v_and_b32 v11, 3, v1
    v_mov_b32 v3, s48
    v_cmp_eq_u32 vcc, 1, v11
    v_mov_b32 v10, s49
    s_nop 0
    v_cndmask_b32_e64 v3, v3, v10, vcc
    v_cmp_eq_u32 vcc, 2, v11
    v_mov_b32 v10, s50
    s_nop 0
    v_cndmask_b32_e64 v3, v3, v10, vcc
    v_cmp_eq_u32 vcc, 3, v11
    v_mov_b32 v10, s51
    s_nop 0
    v_cndmask_b32_e64 v3, v3, v10, vcc
    v_and_b32 v10, 31, v1
    v_lshlrev_b32 v6, 4, v10
    v_lshrrev_b32 v10, 5, v1
    v_mul_u32_u24 v10, 2184, v10
    v_add_u32 v6, v6, v10
    v_add_u32 v6, 108032, v6
    s_lshl_b32 s38, s23, 11
    s_add_u32 s38, s38, 0x488000
    s_mov_b32 s58, 0
fz_h4:
    buffer_load_dword v16, v2, s[4:7], s38 offen offset:0 sc1
    buffer_load_dword v17, v2, s[4:7], s38 offen offset:256 sc1
    buffer_load_dword v18, v2, s[4:7], s38 offen offset:512 sc1
    buffer_load_dword v19, v2, s[4:7], s38 offen offset:768 sc1
    buffer_load_dword v20, v2, s[4:7], s38 offen offset:1024 sc1
    buffer_load_dword v21, v2, s[4:7], s38 offen offset:1280 sc1
    buffer_load_dword v22, v2, s[4:7], s38 offen offset:1536 sc1
    buffer_load_dword v23, v2, s[4:7], s38 offen offset:1792 sc1
    s_waitcnt vmcnt(6)
    v_xor_b32 v16, v3, v16
    v_xor_b32 v17, v3, v17
    v_or3_b32 v10, v16, v17, 0
    v_add_f32 v16, v16, v17
    s_waitcnt vmcnt(4)
    v_xor_b32 v18, v3, v18
    v_xor_b32 v19, v3, v19
    v_or3_b32 v10, v18, v19, v10
    v_add_f32 v18, v18, v19
    v_add_f32 v16, v16, v18
    s_waitcnt vmcnt(2)
    v_xor_b32 v20, v3, v20
    v_xor_b32 v21, v3, v21
    v_or3_b32 v10, v20, v21, v10
    v_add_f32 v20, v20, v21
    s_waitcnt vmcnt(0)
    v_xor_b32 v22, v3, v22
    v_xor_b32 v23, v3, v23
    v_or3_b32 v10, v22, v23, v10
    v_add_f32 v22, v22, v23
    v_add_f32 v20, v20, v22
    v_and_b32 v10, 0xff, v10
    v_add_f32 v8, v16, v20
    v_cmp_ne_u32 vcc, 0, v10
    s_cbranch_vccnz fz_h4_rt
fz_h4_ok:
    v_cvt_pk_bf16_f32 v8, 0, v8
    v_mov_b32 v9, v8
    s_nop 1
    v_permlane32_swap_b32 v8, v9
    v_mul_f32 v10, 0xbfb8aa3b, v8
    v_exp_f32 v10, v10
    s_nop 0
    v_add_f32 v10, 1.0, v10
    v_rcp_f32 v10, v10
    s_nop 0
    v_mul_f32 v8, v8, v10
    v_cvt_pk_bf16_f32 v8, 0, v8
    v_mul_f32 v8, v8, v9
    v_cvt_pk_bf16_f32 v8, 0, v8
    ds_write_b16_d16_hi v6, v8 offset:0
    ds_write_b16_d16_hi v6, v8 offset:546
    ds_write_b16_d16_hi v6, v8 offset:1092
    ds_write_b16_d16_hi v6, v8 offset:1638
    s_waitcnt lgkmcnt(0)
    s_branch fz_f2
fz_ldh:
    s_load_dwordx2 s[12:13], s[0:1], 56
    s_load_dwordx2 s[16:17], s[0:1], 64
    s_mov_b32 s14, 0x700000
    s_mov_b32 s15, 0x00020000
    s_mov_b32 s18, 0x700000
    s_mov_b32 s19, 0x00020000
    s_branch fz_ldback
fz_spec:
    s_cmp_gt_u32 s3, 3
    s_cbranch_scc1 fz_spec_hi
    s_cmp_eq_u32 s3, 0
    s_cselect_b32 s31, 0, s31
    s_cselect_b32 s30, 33024, s30
    s_cmp_eq_u32 s3, 2
    s_cselect_b32 s31, 30960, s31
    s_cselect_b32 s30, 35088, s30
    s_cmp_eq_u32 s3, 3
    s_cselect_b32 s31, 37152, s31
    s_cselect_b32 s30, 39216, s30
    s_branch fz_specback
fz_spec_hi:
    s_mov_b32 m0, s31
    s_nop 0
    buffer_load_dwordx4 v239, s[8:11], s27 offen lds
    buffer_load_dwordx4 v239, s[8:11], s27 offen offset:1024 lds
    s_mov_b32 m0, s30
    s_nop 0
    buffer_load_dwordx4 v239, s[8:11], s28 offen lds
    buffer_load_dwordx4 v239, s[8:11], s28 offen offset:1024 lds
    v_lshlrev_b32 v13, 3, v0
    v_mov_b32 v10, -1
    v_mov_b32 v11, -1
    s_lshl_b32 s32, s20, 11
    s_add_u32 s32, s32, 0x447800
    s_mov_b32 s18, 0x800
    s_mov_b32 s19, 0x00020000
    s_lshl_b32 s33, s24, 10
    s_min_u32 s34, s33, 2048
    s_add_u32 s34, s34, 104960
    s_mov_b32 m0, s34
    buffer_store_dwordx2 v[10:11], v13, s[4:7], s32 offen sc1
    buffer_load_dwordx4 v239, s[16:19], s33 offen lds
    s_cmp_eq_u32 s24, 0
    s_cselect_b32 s31, 8256, s31
    s_cselect_b32 s30, 22704, s30
    s_cselect_b32 s27, 524288, s27
    s_cselect_b32 s28, 3670016, s28
    s_cmp_eq_u32 s24, 1
    s_cselect_b32 s31, 12384, s31
    s_cselect_b32 s30, 18576, s30
    s_cselect_b32 s27, 1572864, s27
    s_cselect_b32 s28, 2621440, s28
    s_cmp_eq_u32 s24, 2
    s_cselect_b32 s31, 41280, s31
    s_cselect_b32 s30, 43344, s30
    s_cselect_b32 s27, 1572864, s27
    s_cselect_b32 s28, 2621440, s28
    s_cmp_eq_u32 s24, 3
    s_cselect_b32 s31, 45408, s31
    s_cselect_b32 s30, 47472, s30
    s_cselect_b32 s27, 524288, s27
    s_cselect_b32 s28, 3670016, s28
    s_mov_b32 s57, 0
    s_branch fz_specback
fz_jb:
    v_cvt_pk_bf16_f32 v128, v104, v105
    v_cvt_pk_bf16_f32 v129, v106, v107
    v_cvt_pk_bf16_f32 v130, v108, v109
    v_cvt_pk_bf16_f32 v131, v110, v111
    v_cvt_pk_bf16_f32 v132, v112, v113
    v_cvt_pk_bf16_f32 v133, v114, v115
    v_cvt_pk_bf16_f32 v134, v116, v117
    v_cvt_pk_bf16_f32 v135, v118, v119
    s_branch fz_jend
fz_bsp0:
    buffer_load_dwordx4 v[160:163], v14, s[64:67], s62 offen offset:0 nt
    buffer_load_dwordx4 v[164:167], v14, s[64:67], s62 offen offset:256 nt
    s_add_u32 s62, s62, 8192
    buffer_load_dwordx4 v[168:171], v14, s[64:67], s62 offen offset:0 nt
    buffer_load_dwordx4 v[172:175], v14, s[64:67], s62 offen offset:256 nt
    s_add_u32 s62, s62, 8192
    buffer_load_dwordx4 v[176:179], v14, s[64:67], s62 offen offset:0 nt
    buffer_load_dwordx4 v[180:183], v14, s[64:67], s62 offen offset:256 nt
    s_add_u32 s62, s62, 8192
    buffer_load_dwordx4 v[184:187], v14, s[64:67], s62 offen offset:0 nt
    buffer_load_dwordx4 v[188:191], v14, s[64:67], s62 offen offset:256 nt
    s_add_u32 s62, s62, 8192
    s_branch fz_bsp
fz_spec40:
    s_mov_b32 s38, 0x80018001
    s_mov_b32 s39, 0x80018001
    v_cndmask_b32_e64 v112, v112, v104, s[38:39]
    v_cndmask_b32_e64 v113, v113, v105, s[38:39]
    s_branch fz_spec4back0
fz_spec41:
    s_mov_b32 s38, 0x80018001
    s_mov_b32 s39, 0x80018001
    v_cndmask_b32_e64 v114, v114, v106, s[38:39]
    v_cndmask_b32_e64 v115, v115, v107, s[38:39]
    s_branch fz_spec4back1
fz_spec42:
    s_mov_b32 s38, 0x80018001
    s_mov_b32 s39, 0x80018001
    v_cndmask_b32_e64 v116, v116, v108, s[38:39]
    v_cndmask_b32_e64 v117, v117, v109, s[38:39]
    s_branch fz_spec4back2
fz_spec43:
    s_mov_b32 s38, 0x80018001
    s_mov_b32 s39, 0x80018001
    v_cndmask_b32_e64 v118, v118, v110, s[38:39]
    v_cndmask_b32_e64 v119, v119, v111, s[38:39]
    s_branch fz_spec4back3
    s_nop 3
fz_nc1:
    s_setprio 0
    s_cmp_lg_u32 s59, 0
    s_cbranch_scc1 ffn_b
    buffer_load_dwordx4 v[176:179], v14, s[64:67], s62 offen offset:0 nt
    buffer_load_dwordx4 v[180:183], v14, s[64:67], s62 offen offset:256 nt
    s_add_u32 s62, s62, 8192
    buffer_load_dwordx4 v[184:187], v14, s[64:67], s62 offen offset:0 nt
    buffer_load_dwordx4 v[188:191], v14, s[64:67], s62 offen offset:256 nt
    s_add_u32 s62, s62, 8192
    s_mov_b32 m0, s31
    s_nop 0
    buffer_load_dwordx4 v239, s[8:11], s27 offen nt lds
    buffer_load_dwordx4 v239, s[8:11], s27 offen offset:1024 nt lds
    s_mov_b32 m0, s30
    s_nop 0
    buffer_load_dwordx4 v239, s[8:11], s28 offen nt lds
    buffer_load_dwordx4 v239, s[8:11], s28 offen offset:1024 nt lds
    v_lshlrev_b32 v13, 3, v0
    v_mov_b32 v10, -1
    v_mov_b32 v11, -1
    s_lshl_b32 s32, s20, 11
    s_add_u32 s32, s32, 0x447800
    s_mov_b32 s18, 0x800
    s_mov_b32 s19, 0x00020000
    s_lshl_b32 s33, s24, 10
    s_min_u32 s34, s33, 2048
    s_add_u32 s34, s34, 104960
    s_mov_b32 m0, s34
    buffer_store_dwordx2 v[10:11], v13, s[4:7], s32 offen sc1
    buffer_load_dwordx4 v239, s[16:19], s33 offen lds
    s_waitcnt vmcnt(14)
    v_readfirstlane_b32 s40, v250
    s_nop 1
    s_add_u32 s40, s40, 1
    s_and_b32 s38, s40, 3
    s_and_b32 s39, s40, 15
    s_bfe_u32 s41, s40, 0x20002
    s_lshl_b32 s41, s41, 16
    s_or_b32 s44, s38, s41
    s_bfe_u32 s41, s40, 0x40004
    s_lshl_b32 s41, s41, 4
    s_or_b32 s48, s39, s41
    s_bfe_u32 s41, s40, 0x20004
    s_lshl_b32 s41, s41, 16
    s_or_b32 s45, s38, s41
    s_bfe_u32 s41, s40, 0x40008
    s_lshl_b32 s41, s41, 4
    s_or_b32 s49, s39, s41
    s_bfe_u32 s41, s40, 0x20006
    s_lshl_b32 s41, s41, 16
    s_or_b32 s46, s38, s41
    s_bfe_u32 s41, s40, 0x4000c
    s_lshl_b32 s41, s41, 4
    s_or_b32 s50, s39, s41
    s_bfe_u32 s41, s40, 0x20008
    s_lshl_b32 s41, s41, 16
    s_or_b32 s47, s38, s41
    s_bfe_u32 s41, s40, 0x40010
    s_lshl_b32 s41, s41, 4
    s_or_b32 s51, s39, s41
    s_mov_b32 s38, 0x404
    s_cmp_eq_u32 s2, 66
    s_cselect_b32 s39, 8, 4
    s_cselect_b32 s38, 8, s38
fz_bsp:
    s_setprio 0
    s_mov_b32 s57, 1
    s_cmp_gt_u32 s3, 5
    s_cbranch_scc1 fz_nocq
    s_and_b32 s32, s3, 1
    s_lshl_b32 s33, s32, 2
    s_lshl_b32 s32, s32, 11
    v_and_b32 v8, 3, v4
    v_lshrrev_b32 v9, 2, v4
    v_lshl_add_u32 v8, v8, 3, v9
    v_add_u32 v8, s33, v8
    v_cvt_f32_u32 v8, v8
    v_mul_f32 v8, 0x3d000000, v8
    v_cvt_f32_u32 v9, v5
    v_mul_f32 v9, 4.0, v9
    v_mul_f32 v9, v8, v9
    v_mov_b32 v104, v9
    v_fmamk_f32 v105, v8, 0x3f800000, v9
    v_fmamk_f32 v106, v8, 0x40000000, v9
    v_fmamk_f32 v107, v8, 0x40400000, v9
    v_fmamk_f32 v108, v8, 0x41800000, v9
    v_fmamk_f32 v109, v8, 0x41880000, v9
    v_fmamk_f32 v110, v8, 0x41900000, v9
    v_fmamk_f32 v111, v8, 0x41980000, v9
    v_sin_f32 v112, v104
    v_sin_f32 v113, v105
    v_sin_f32 v114, v106
    v_sin_f32 v115, v107
    v_sin_f32 v116, v108
    v_sin_f32 v117, v109
    v_sin_f32 v118, v110
    v_sin_f32 v119, v111
    v_cos_f32 v104, v104
    v_cos_f32 v105, v105
    v_cos_f32 v106, v106
    v_cos_f32 v107, v107
    v_cos_f32 v108, v108
    v_cos_f32 v109, v109
    v_cos_f32 v110, v110
    v_cos_f32 v111, v111
    v_mul_f32 v104, 0x3d800000, v104
    v_mul_f32 v105, 0x3d800000, v105
    v_mul_f32 v106, 0x3d800000, v106
    v_mul_f32 v107, 0x3d800000, v107
    v_mul_f32 v108, 0x3d800000, v108
    v_mul_f32 v109, 0x3d800000, v109
    v_mul_f32 v110, 0x3d800000, v110
    v_mul_f32 v111, 0x3d800000, v111
    v_mul_f32 v112, 0x3d800000, v112
    v_mul_f32 v113, 0x3d800000, v113
    v_mul_f32 v114, 0x3d800000, v114
    v_mul_f32 v115, 0x3d800000, v115
    v_mul_f32 v116, 0x3d800000, v116
    v_mul_f32 v117, 0x3d800000, v117
    v_mul_f32 v118, 0x3d800000, v118
    v_mul_f32 v119, 0x3d800000, v119
    v_cvt_pk_f16_f32 v128, v104, v105
    v_cvt_pk_f16_f32 v129, v106, v107
    v_cvt_pk_f16_f32 v130, v108, v109
    v_cvt_pk_f16_f32 v131, v110, v111
    v_cvt_pk_f16_f32 v132, v112, v113
    v_cvt_pk_f16_f32 v133, v114, v115
    v_cvt_pk_f16_f32 v134, v116, v117
    v_cvt_pk_f16_f32 v135, v118, v119
    v_add_u32 v8, s32, v6
    ds_write_b128 v8, v[128:131] offset:14336
    ds_write_b128 v8, v[132:135] offset:15360
fz_nocq:
    s_and_b32 s32, s3, 3
    s_lshr_b32 s33, s3, 2
    s_lshl_b32 s33, s33, 4
    s_add_u32 s33, s33, s32
    v_and_b32 v8, 12, v4
    v_bfe_u32 v9, v4, 1, 1
    v_lshl_add_u32 v8, v9, 5, v8
    v_add_u32 v8, s33, v8
    v_cvt_f32_u32 v8, v8
    v_and_b32 v12, 1, v1
    v_cvt_f32_u32 v9, v12
    v_lshlrev_b32 v13, 2, v5
    v_cvt_f32_u32 v10, v13
    v_mul_f32 v11, 0x3c800000, v8
    v_mul_f32 v9, 0x3e800000, v9
    v_fma_f32 v9, v11, v10, v9
    v_mov_b32 v128, v9
    v_fmamk_f32 v129, v11, 0x3f800000, v9
    v_fmamk_f32 v130, v11, 0x40000000, v9
    v_fmamk_f32 v131, v11, 0x40400000, v9
    v_mul_f32 v11, 0x3a000000, v8
    v_lshlrev_b32 v9, 31, v1
    v_xor_b32 v11, v9, v11
    v_mul_f32 v9, v11, v10
    v_mov_b32 v112, v9
    v_fmamk_f32 v113, v11, 0x3f800000, v9
    v_fmamk_f32 v114, v11, 0x40000000, v9
    v_fmamk_f32 v115, v11, 0x40400000, v9
    v_fmamk_f32 v116, v11, 0x41800000, v9
    v_fmamk_f32 v117, v11, 0x41880000, v9
    v_fmamk_f32 v118, v11, 0x41900000, v9
    v_fmamk_f32 v119, v11, 0x41980000, v9
    v_cos_f32 v104, v128
    v_sin_f32 v105, v128
    v_cos_f32 v106, v129
    v_sin_f32 v107, v129
    v_cos_f32 v108, v130
    v_sin_f32 v109, v130
    v_cos_f32 v110, v131
    v_sin_f32 v111, v131
    v_sin_f32 v120, v112
    v_sin_f32 v121, v113
    v_sin_f32 v122, v114
    v_sin_f32 v123, v115
    v_sin_f32 v124, v116
    v_sin_f32 v125, v117
    v_sin_f32 v126, v118
    v_sin_f32 v127, v119
    v_cos_f32 v112, v112
    v_cos_f32 v113, v113
    v_cos_f32 v114, v114
    v_cos_f32 v115, v115
    v_cos_f32 v116, v116
    v_cos_f32 v117, v117
    v_cos_f32 v118, v118
    v_cos_f32 v119, v119
    v_cvt_pk_f16_f32 v16, v104, v105
    v_cvt_pk_f16_f32 v17, v106, v107
    v_cvt_pk_f16_f32 v18, v108, v109
    v_cvt_pk_f16_f32 v19, v110, v111
    v_cvt_pk_f16_f32 v20, v112, v113
    v_cvt_pk_f16_f32 v21, v114, v115
    v_cvt_pk_f16_f32 v22, v116, v117
    v_cvt_pk_f16_f32 v23, v118, v119
    v_cvt_pk_f16_f32 v24, v120, v121
    v_cvt_pk_f16_f32 v25, v122, v123
    v_cvt_pk_f16_f32 v26, v124, v125
    v_cvt_pk_f16_f32 v27, v126, v127
    v_lshrrev_b32 v8, 3, v1
    v_mul_u32_u24 v222, 16512, v8
    v_and_b32 v9, 7, v1
    v_lshl_add_u32 v222, v9, 4, v222
    s_mul_i32 s60, s3, 528384
    s_lshl_b32 s32, s20, 7
    s_add_u32 s60, s60, s32
    s_add_u32 s60, s60, 0x1000
    s_add_u32 s61, s60, 132096
    s_add_u32 s16, s60, 264192
    s_add_u32 s17, s60, 396288
    v_lshlrev_b32 v8, 1, v8
    v_bfe_u32 v9, v1, 2, 1
    v_add_u32 v8, v8, v9
    s_lshl_b32 s32, s3, 2
    s_add_u32 s32, s32, 1
    v_lshl_add_u32 v8, v8, 5, s32
    v_cmp_eq_u32 vcc, 1, v12
    v_bfe_u32 v9, v1, 1, 1
    v_mul_u32_u24 v9, 8256, v9
    v_add_u32 v9, 86400, v9
    s_cmp_eq_u32 s3, 3
    s_cselect_b32 s32, 272, 0
    v_sub_u32 v10, 512, v8
    v_cndmask_b32_e64 v10, v8, v10, vcc
    v_and_b32 v11, 16, v10
    v_lshl_add_u32 v11, v11, 6, v9
    v_lshrrev_b32 v12, 7, v10
    v_lshl_add_u32 v11, v12, 8, v11
    v_and_b32 v12, 15, v10
    v_lshl_add_u32 v11, v12, 4, v11
    v_bfe_u32 v12, v10, 5, 2
    v_lshl_add_u32 v223, v12, 2, v11
    v_add_u32 v8, 1, v8
    v_sub_u32 v10, 512, v8
    v_cndmask_b32_e64 v10, v8, v10, vcc
    v_and_b32 v11, 16, v10
    v_lshl_add_u32 v11, v11, 6, v9
    v_lshrrev_b32 v12, 7, v10
    v_lshl_add_u32 v11, v12, 8, v11
    v_and_b32 v12, 15, v10
    v_lshl_add_u32 v11, v12, 4, v11
    v_bfe_u32 v12, v10, 5, 2
    v_lshl_add_u32 v224, v12, 2, v11
    v_add_u32 v8, 1, v8
    v_sub_u32 v10, 512, v8
    v_cndmask_b32_e64 v10, v8, v10, vcc
    v_and_b32 v11, 16, v10
    v_lshl_add_u32 v11, v11, 6, v9
    v_lshrrev_b32 v12, 7, v10
    v_lshl_add_u32 v11, v12, 8, v11
    v_and_b32 v12, 15, v10
    v_lshl_add_u32 v11, v12, 4, v11
    v_bfe_u32 v12, v10, 5, 2
    v_lshl_add_u32 v100, v12, 2, v11
    v_mul_u32_u24 v10, s32, v3
    v_sub_u32 v8, v8, v10
    v_add_u32 v8, 1, v8
    v_sub_u32 v10, 512, v8
    v_cndmask_b32_e64 v10, v8, v10, vcc
    v_lshrrev_b32 v11, 1, v10
    v_and_b32 v11, 256, v11
    v_sub_u32 v10, v10, v11
    v_and_b32 v11, 16, v10
    v_lshl_add_u32 v11, v11, 6, v9
    v_lshrrev_b32 v12, 7, v10
    v_lshl_add_u32 v11, v12, 8, v11
    v_and_b32 v12, 15, v10
    v_lshl_add_u32 v11, v12, 4, v11
    v_bfe_u32 v12, v10, 5, 2
    v_lshl_add_u32 v101, v12, 2, v11
    s_and_b32 s32, s3, 3
    s_lshl_b32 s32, s32, 11
    s_add_u32 s32, s32, 86400
    v_add_u32 v225, s32, v239
    v_add_u32 v8, s33, v13
    v_sub_u32 v9, 32, v8
    v_min_u32 v9, v8, v9
    v_and_b32 v10, 15, v8
    v_cmp_eq_u32 s[32:33], 0, v10
    v_cmp_lt_u32 s[34:35], 16, v8
    v_lshlrev_b32 v10, 10, v9
    v_subrev_u32 v10, 1024, v10
    v_mov_b32 v11, 15872
    v_cmp_eq_u32 vcc, 0, v8
    s_nop 1
    v_cndmask_b32_e64 v10, v10, v11, vcc
    v_and_b32 v11, 3, v1
    v_lshl_add_u32 v10, v11, 4, v10
    v_lshrrev_b32 v11, 2, v4
    v_lshlrev_b32 v12, 7, v11
    v_sub_u32 v13, 960, v12
    v_cndmask_b32_e64 v13, v12, v13, s[34:35]
    v_add_u32 v226, v10, v13
    s_or_b64 s[34:35], s[34:35], s[32:33]
    v_add_u32 v12, 512, v12
    v_sub_u32 v13, 960, v12
    v_cndmask_b32_e64 v13, v12, v13, s[34:35]
    v_add_u32 v227, v10, v13
    s_mul_i32 s56, s20, 16512
    s_add_u32 s56, s56, 0x210000
    v_mov_b32 v249, 0x30003
    v_mov_b32 v252, s44
    v_mov_b32 v253, s45
    v_mov_b32 v254, s46
    v_mov_b32 v255, s47
    s_waitcnt lgkmcnt(0)
    v_sub_u32 v8, 15, v4
    v_min_u32 v8, v4, v8
    v_and_b32 v9, 1, v8
    v_lshlrev_b32 v9, 5, v9
    v_lshrrev_b32 v10, 1, v8
    v_lshl_add_u32 v9, v10, 9, v9
    v_add_u32 v9, s25, v9
    v_sub_u32 v10, 2048, v9
    v_cmp_lt_u32 s[34:35], 7, v4
    s_nop 1
    v_cndmask_b32_e64 v230, v9, v10, s[34:35]
    v_mov_b32 v9, v4
    v_mov_b32 v10, s20
    s_cmp_lg_u32 s21, 0
    s_cbranch_scc0 fz_spec3b
fz_spec3backb:
    v_lshlrev_b32 v10, 7, v10
    v_lshl_add_u32 v10, v9, 3, v10
    v_mul_u32_u24 v11, 66048, v5
    v_add_u32 v228, v10, v11
    v_and_b32 v9, 1, v9
    v_cmp_eq_u32 vcc, 1, v9
    v_mov_b32 v9, s44
    v_mov_b32 v10, s46
    v_cndmask_b32_e64 v236, v9, v10, vcc
    v_mov_b32 v9, s45
    v_mov_b32 v10, s47
    v_cndmask_b32_e64 v237, v9, v10, vcc
    s_lshl_b32 s32, s3, 2
    v_add_u32 v8, s32, v5
    v_lshlrev_b32 v9, 6, v8
    v_cmp_gt_u32 vcc, 16, v8
    s_nop 1
    v_cndmask_b32_e64 v10, 0, 32, vcc
    v_add_u32 v10, v9, v10
    v_sub_u32 v11, 2048, v10
    v_cmp_eq_u32 vcc, 16, v8
    s_nop 1
    v_cndmask_b32_e64 v11, v11, 0, vcc
    v_mov_b32 v12, 0xffff0000
    v_cndmask_b32_e64 v238, -1, v12, vcc
    v_sub_u32 v12, 2018, v9
    v_mul_u32_u24 v13, 2064, v4
    v_add_u32 v231, v13, v9
    v_add_u32 v232, v13, v12
    v_add_u32 v233, v13, v10
    v_add_u32 v241, v13, v11
    s_lshl_b32 s32, s3, 8
    s_add_u32 s32, s32, 102912
    v_lshlrev_b32 v9, 4, v4
    v_add_u32 v10, s32, v9
    v_add_u32 v11, 107008, v239
    v_cmp_gt_u32 vcc, 16, v1
    s_nop 1
    v_cndmask_b32_e64 v243, v11, v10, vcc
    v_lshrrev_b32 v12, 2, v4
    v_cmp_eq_u32 vcc, v12, v5
    s_nop 1
    v_cndmask_b32_e64 v244, v11, v10, vcc
    v_lshrrev_b32 v12, 5, v1
    v_lshl_add_u32 v10, v12, 10, v9
    v_add_u32 v245, 102912, v10
    v_and_b32 v9, 1, v1
    v_cmp_eq_u32 s[28:29], 1, v9
    v_and_b32 v9, 2, v1
    v_cmp_eq_u32 s[30:31], 2, v9
    s_lshl_b32 s37, s3, 2
    v_add_u32 v9, s37, v5
    v_mul_u32_u24 v246, 2176, v9
    s_lshl_b32 s26, s20, 4
    s_add_u32 s26, s26, 0x580000
    v_lshlrev_b32 v247, 4, v5
    s_lshl_b32 s27, s20, 11
    s_lshl_b32 s37, s3, 8
    s_add_u32 s27, s27, s37
    s_add_u32 s27, s27, 0x448000
    v_sub_u32 v248, 2047, v230
    s_mov_b32 s14, 0x400000
    s_mov_b32 s15, 0x00020000
    s_mul_i32 s52, s3, 264192
    s_add_u32 s52, s52, 0x210000
    s_add_u32 s53, s52, 16512
    s_add_u32 s54, s52, 33024
    s_add_u32 s55, s52, 49536
    s_mov_b32 s23, s63
    s_getreg_b32 s24, hwreg(HW_REG_XCC_ID)
    s_and_b32 s24, s24, 15
    v_lshlrev_b32 v10, 4, v0
    v_min_u32 v10, 4336, v10
    v_add_u32 v10, 108032, v10
    v_mov_b32 v104, 0
    v_mov_b32 v105, 0
    v_mov_b32 v106, 0
    v_mov_b32 v107, 0
    ds_write_b128 v10, v[104:107]
    s_cmp_eq_u32 s2, 66
    s_cbranch_scc1 fz_sz
    s_waitcnt vmcnt(0)
    v_mov_b32 v10, 256
    s_mov_b64 exec, 1
    ds_add_u32 v15, v10
    s_mov_b64 exec, -1
fz_sz:
    ds_read_b32 v10, v15
    s_waitcnt lgkmcnt(0)
    v_cmp_ne_u32 vcc, s38, v10
    s_cbranch_vccnz fz_sz
    ds_read_b128 v[116:119], v231
    ds_read_b128 v[120:123], v231 offset:16
    ds_read_u16_d16_hi v44, v241
    ds_read_u16_d16_hi v45, v232 offset:28
    ds_read_u16_d16_hi v46, v232 offset:26
    ds_read_u16_d16_hi v47, v232 offset:24
    ds_read_u16_d16_hi v48, v232 offset:22
    ds_read_u16_d16_hi v49, v232 offset:20
    ds_read_u16_d16_hi v50, v232 offset:18
    ds_read_u16_d16_hi v51, v232 offset:16
    ds_read_u16_d16_hi v52, v232 offset:14
    ds_read_u16_d16_hi v53, v232 offset:12
    ds_read_u16_d16_hi v54, v232 offset:10
    ds_read_u16_d16_hi v55, v232 offset:8
    ds_read_u16_d16_hi v56, v232 offset:6
    ds_read_u16_d16_hi v57, v232 offset:4
    ds_read_u16_d16_hi v58, v232 offset:2
    ds_read_u16_d16_hi v59, v232 offset:0
    ds_read_u16_d16_hi v28, v233
    v_mul_u32_u24 v13, 2064, v4
    v_subrev_u32 v13, 104960, v13
    v_sub_u32 v9, v231, v13
    v_sub_u32 v10, v233, v13
    v_sub_u32 v11, v241, v13
    v_sub_u32 v12, v232, v13
    s_mov_b32 s36, 0xffff0000
    s_waitcnt lgkmcnt(0)
    ds_read_b128 v[200:203], v9
    ds_read_b128 v[204:207], v9 offset:16
    ds_read_u16_d16 v208, v11
    ds_read_u16_d16_hi v124, v12 offset:28
    ds_read_u16_d16 v209, v12 offset:26
    ds_read_u16_d16_hi v125, v12 offset:24
    ds_read_u16_d16 v210, v12 offset:22
    ds_read_u16_d16_hi v126, v12 offset:20
    ds_read_u16_d16 v211, v12 offset:18
    ds_read_u16_d16_hi v127, v12 offset:16
    ds_read_u16_d16 v212, v12 offset:14
    ds_read_u16_d16_hi v128, v12 offset:12
    ds_read_u16_d16 v213, v12 offset:10
    ds_read_u16_d16_hi v129, v12 offset:8
    ds_read_u16_d16 v214, v12 offset:6
    ds_read_u16_d16_hi v130, v12 offset:4
    ds_read_u16_d16 v215, v12 offset:2
    ds_read_u16_d16_hi v131, v12 offset:0
    ds_read_u16_d16 v13, v10
    v_and_b32 v29, s36, v116
    v_lshlrev_b32 v30, 16, v117
    v_and_b32 v31, s36, v117
    v_lshlrev_b32 v32, 16, v118
    v_and_b32 v33, s36, v118
    v_lshlrev_b32 v34, 16, v119
    v_and_b32 v35, s36, v119
    v_lshlrev_b32 v36, 16, v120
    v_and_b32 v37, s36, v120
    v_lshlrev_b32 v38, 16, v121
    v_and_b32 v39, s36, v121
    v_lshlrev_b32 v40, 16, v122
    v_and_b32 v41, s36, v122
    v_lshlrev_b32 v42, 16, v123
    v_and_b32 v43, s36, v123
    v_cmp_eq_u32 vcc, 1, v4
    v_mov_b32 v9, s42
    s_nop 0
    v_cndmask_b32_e64 v9, 0, v9, vcc
    v_mov_b32 v116, s42
    v_mov_b32 v117, s42
    v_mov_b32 v118, s42
    v_mov_b32 v119, s42
    v_cmp_eq_u32 vcc, 0, v4
    s_waitcnt lgkmcnt(0)
    v_and_or_b32 v200, v200, s36, v13
    v_or_b32 v208, v208, v124
    v_or_b32 v209, v209, v125
    v_or_b32 v210, v210, v126
    v_or_b32 v211, v211, v127
    v_or_b32 v212, v212, v128
    v_or_b32 v213, v213, v129
    v_or_b32 v214, v214, v130
    v_or_b32 v215, v215, v131
    v_cndmask_b32_e64 v200, v9, v200, vcc
    v_cndmask_b32_e64 v201, v9, v201, vcc
    v_cndmask_b32_e64 v202, v9, v202, vcc
    v_cndmask_b32_e64 v203, v9, v203, vcc
    v_cndmask_b32_e64 v204, v9, v204, vcc
    v_cndmask_b32_e64 v205, v9, v205, vcc
    v_cndmask_b32_e64 v206, v9, v206, vcc
    v_cndmask_b32_e64 v207, v9, v207, vcc
    v_cndmask_b32_e64 v208, v9, v208, vcc
    v_cndmask_b32_e64 v209, v9, v209, vcc
    v_cndmask_b32_e64 v210, v9, v210, vcc
    v_cndmask_b32_e64 v211, v9, v211, vcc
    v_cndmask_b32_e64 v212, v9, v212, vcc
    v_cndmask_b32_e64 v213, v9, v213, vcc
    v_cndmask_b32_e64 v214, v9, v214, vcc
    v_cndmask_b32_e64 v215, v9, v215, vcc
    v_mfma_f32_16x16x32_bf16 v[120:123], v[200:203], v[116:119], 0
    v_mfma_f32_16x16x32_bf16 v[120:123], v[204:207], v[116:119], v[120:123]
    v_mfma_f32_16x16x32_bf16 v[120:123], v[208:211], v[116:119], v[120:123]
    v_mfma_f32_16x16x32_bf16 v[120:123], v[212:215], v[116:119], v[120:123]
    s_nop 7
    ds_write_b32 v243, v120 offset:12
    s_waitcnt lgkmcnt(0)
    s_branch fz_hb
    s_nop 0
fz_nc3:
    s_mov_b32 s58, 0
    s_waitcnt vmcnt(0)
    s_branch fz_h2
fz_spec3a:
    v_xor_b32 v11, 1, v4
    v_cndmask_b32_e64 v9, v9, v11, s[34:35]
    v_and_b32 v11, 1, v4
    v_cndmask_b32_e64 v11, 0, v11, s[34:35]
    v_sub_u32 v10, v10, v11
    s_cmp_lg_u32 s22, 0
    s_cbranch_scc1 fz_spec3backa
    v_cmp_eq_u32 vcc, 15, v4
    v_mov_b32 v11, 1024
    v_mov_b32 v12, 124
    v_cndmask_b32_e64 v230, v230, v11, vcc
    v_cndmask_b32_e64 v10, v10, v12, vcc
    v_cndmask_b32_e64 v9, v9, 4, vcc
    v_cmp_eq_u32 vcc, 13, v4
    v_mov_b32 v11, 1536
    v_mov_b32 v12, 124
    v_cndmask_b32_e64 v230, v230, v11, vcc
    v_cndmask_b32_e64 v10, v10, v12, vcc
    v_cndmask_b32_e64 v9, v9, 6, vcc
    v_cmp_eq_u32 vcc, 4, v4
    v_mov_b32 v11, 256
    v_mov_b32 v12, 127
    v_cndmask_b32_e64 v230, v230, v11, vcc
    v_cndmask_b32_e64 v10, v10, v12, vcc
    v_cndmask_b32_e64 v9, v9, 8, vcc
    v_cmp_eq_u32 vcc, 11, v4
    v_mov_b32 v11, 1792
    v_mov_b32 v12, 127
    v_cndmask_b32_e64 v230, v230, v11, vcc
    v_cndmask_b32_e64 v10, v10, v12, vcc
    v_cndmask_b32_e64 v9, v9, 14, vcc
    v_cmp_eq_u32 vcc, 6, v4
    v_mov_b32 v11, 768
    v_mov_b32 v12, 127
    v_cndmask_b32_e64 v230, v230, v11, vcc
    v_cndmask_b32_e64 v10, v10, v12, vcc
    v_cndmask_b32_e64 v9, v9, 10, vcc
    v_cmp_eq_u32 vcc, 9, v4
    v_mov_b32 v11, 1280
    v_mov_b32 v12, 127
    v_cndmask_b32_e64 v230, v230, v11, vcc
    v_cndmask_b32_e64 v10, v10, v12, vcc
    v_cndmask_b32_e64 v9, v9, 12, vcc
    s_nop 4
    s_branch fz_spec3backa
fz_spec3b:
    v_xor_b32 v11, 1, v4
    v_cndmask_b32_e64 v9, v9, v11, s[34:35]
    v_and_b32 v11, 1, v4
    v_cndmask_b32_e64 v11, 0, v11, s[34:35]
    v_sub_u32 v10, v10, v11
    s_cmp_lg_u32 s22, 0
    s_cbranch_scc1 fz_spec3backb
    v_cmp_eq_u32 vcc, 15, v4
    v_mov_b32 v11, 1024
    v_mov_b32 v12, 124
    v_cndmask_b32_e64 v230, v230, v11, vcc
    v_cndmask_b32_e64 v10, v10, v12, vcc
    v_cndmask_b32_e64 v9, v9, 4, vcc
    v_cmp_eq_u32 vcc, 13, v4
    v_mov_b32 v11, 1536
    v_mov_b32 v12, 124
    v_cndmask_b32_e64 v230, v230, v11, vcc
    v_cndmask_b32_e64 v10, v10, v12, vcc
    v_cndmask_b32_e64 v9, v9, 6, vcc
    v_cmp_eq_u32 vcc, 4, v4
    v_mov_b32 v11, 256
    v_mov_b32 v12, 127
    v_cndmask_b32_e64 v230, v230, v11, vcc
    v_cndmask_b32_e64 v10, v10, v12, vcc
    v_cndmask_b32_e64 v9, v9, 8, vcc
    v_cmp_eq_u32 vcc, 11, v4
    v_mov_b32 v11, 1792
    v_mov_b32 v12, 127
    v_cndmask_b32_e64 v230, v230, v11, vcc
    v_cndmask_b32_e64 v10, v10, v12, vcc
    v_cndmask_b32_e64 v9, v9, 14, vcc
    v_cmp_eq_u32 vcc, 6, v4
    v_mov_b32 v11, 768
    v_mov_b32 v12, 127
    v_cndmask_b32_e64 v230, v230, v11, vcc
    v_cndmask_b32_e64 v10, v10, v12, vcc
    v_cndmask_b32_e64 v9, v9, 10, vcc
    v_cmp_eq_u32 vcc, 9, v4
    v_mov_b32 v11, 1280
    v_mov_b32 v12, 127
    v_cndmask_b32_e64 v230, v230, v11, vcc
    v_cndmask_b32_e64 v10, v10, v12, vcc
    v_cndmask_b32_e64 v9, v9, 12, vcc
    s_nop 4
    s_branch fz_spec3backb
    s_nop 0
ffn_b:
    s_waitcnt vmcnt(0)
    v_readfirstlane_b32 s40, v250
    s_nop 1
    s_add_u32 s40, s40, 1
    s_and_b32 s38, s40, 3
    s_and_b32 s39, s40, 15
    s_bfe_u32 s41, s40, 0x20002
    s_lshl_b32 s41, s41, 16
    s_or_b32 s44, s38, s41
    s_bfe_u32 s41, s40, 0x40004
    s_lshl_b32 s41, s41, 4
    s_or_b32 s48, s39, s41
    s_bfe_u32 s41, s40, 0x20004
    s_lshl_b32 s41, s41, 16
    s_or_b32 s45, s38, s41
    s_bfe_u32 s41, s40, 0x40008
    s_lshl_b32 s41, s41, 4
    s_or_b32 s49, s39, s41
    s_bfe_u32 s41, s40, 0x20006
    s_lshl_b32 s41, s41, 16
    s_or_b32 s46, s38, s41
    s_bfe_u32 s41, s40, 0x4000c
    s_lshl_b32 s41, s41, 4
    s_or_b32 s50, s39, s41
    s_bfe_u32 s41, s40, 0x20008
    s_lshl_b32 s41, s41, 16
    s_or_b32 s47, s38, s41
    s_bfe_u32 s41, s40, 0x40010
    s_lshl_b32 s41, s41, 4
    s_or_b32 s51, s39, s41
    s_nop 0
ffn:
    s_add_u32 s36, s2, 4
    s_and_b32 s36, s36, 7
    s_bfe_u32 s37, s2, 0x10006
    s_lshl_b32 s22, s36, 1
    s_add_u32 s22, s22, s37
    s_cmp_lg_u32 s37, 0
    s_cselect_b32 s37, 8, s36
    s_add_u32 s37, s37, 6
    s_cmp_lt_u32 s36, 6
    s_cselect_b32 s22, s22, s37
    s_cmp_gt_u32 s22, 13
    s_cbranch_scc1 fz_xend
    s_bfe_u32 s21, s2, 0x30003
    v_lshrrev_b32 v2, 5, v1
    v_and_b32 v3, 31, v1
    v_lshlrev_b32 v4, 1, v2
    v_xor_b32 v3, v4, v3
    v_mul_u32_u24 v4, 7168, v2
    v_lshl_add_u32 v4, v3, 4, v4
    v_xor_b32 v5, 64, v4
    v_xor_b32 v6, 128, v4
    v_xor_b32 v7, 192, v4
    s_lshl_b32 s23, s21, 7
    s_lshl_b32 s24, s3, 4
    s_add_u32 s23, s23, s24
    s_mul_i32 s23, s23, 7168
    s_lshl_b32 s24, s22, 9
    s_add_u32 s23, s23, s24
    s_lshl_b32 s24, s3, 13
    v_mov_b32 v31, 149552
    v_mov_b32 v10, 0
    ds_write_b32 v31, v10
    s_waitcnt lgkmcnt(0)
    s_setprio 0
    s_barrier
    s_add_u32 s28, s24, 81920
    s_mov_b32 m0, s28
    s_add_u32 s29, s23, 0
    buffer_load_dwordx4 v4, s[12:15], s29 offen nt lds
    s_add_u32 s28, s24, 82944
    s_mov_b32 m0, s28
    s_add_u32 s29, s23, 14336
    buffer_load_dwordx4 v5, s[12:15], s29 offen nt lds
    s_add_u32 s28, s24, 83968
    s_mov_b32 m0, s28
    s_add_u32 s29, s23, 28672
    buffer_load_dwordx4 v4, s[12:15], s29 offen nt lds
    s_add_u32 s28, s24, 84992
    s_mov_b32 m0, s28
    s_add_u32 s29, s23, 43008
    buffer_load_dwordx4 v5, s[12:15], s29 offen nt lds
    s_add_u32 s28, s24, 86016
    s_mov_b32 m0, s28
    s_add_u32 s29, s23, 57344
    buffer_load_dwordx4 v6, s[12:15], s29 offen nt lds
    s_add_u32 s28, s24, 87040
    s_mov_b32 m0, s28
    s_add_u32 s29, s23, 71680
    buffer_load_dwordx4 v7, s[12:15], s29 offen nt lds
    s_add_u32 s28, s24, 88064
    s_mov_b32 m0, s28
    s_add_u32 s29, s23, 86016
    buffer_load_dwordx4 v6, s[12:15], s29 offen nt lds
    s_add_u32 s28, s24, 89088
    s_mov_b32 m0, s28
    s_add_u32 s29, s23, 100352
    buffer_load_dwordx4 v7, s[12:15], s29 offen nt lds
    s_add_u32 s28, s24, 0
    s_mov_b32 m0, s28
    s_add_u32 s29, s23, 0
    buffer_load_dwordx4 v4, s[16:19], s29 offen nt lds
    s_add_u32 s28, s24, 1024
    s_mov_b32 m0, s28
    s_add_u32 s29, s23, 14336
    buffer_load_dwordx4 v5, s[16:19], s29 offen nt lds
    s_add_u32 s28, s24, 2048
    s_mov_b32 m0, s28
    s_add_u32 s29, s23, 28672
    buffer_load_dwordx4 v4, s[16:19], s29 offen nt lds
    s_add_u32 s28, s24, 3072
    s_mov_b32 m0, s28
    s_add_u32 s29, s23, 43008
    buffer_load_dwordx4 v5, s[16:19], s29 offen nt lds
    s_add_u32 s28, s24, 4096
    s_mov_b32 m0, s28
    s_add_u32 s29, s23, 57344
    buffer_load_dwordx4 v6, s[16:19], s29 offen nt lds
    s_add_u32 s28, s24, 5120
    s_mov_b32 m0, s28
    s_add_u32 s29, s23, 71680
    buffer_load_dwordx4 v7, s[16:19], s29 offen nt lds
    s_add_u32 s28, s24, 6144
    s_mov_b32 m0, s28
    s_add_u32 s29, s23, 86016
    buffer_load_dwordx4 v6, s[16:19], s29 offen nt lds
    s_add_u32 s28, s24, 7168
    s_mov_b32 m0, s28
    s_add_u32 s29, s23, 100352
    buffer_load_dwordx4 v7, s[16:19], s29 offen nt lds
    v_lshrrev_b32 v2, 4, v1
    v_and_b32 v3, 15, v1
    v_bfe_u32 v9, v1, 2, 2
    v_lshl_add_u32 v8, v2, 3, v9
    v_lshlrev_b32 v8, 9, v8
    v_and_b32 v10, 1, v2
    v_lshl_add_u32 v10, v10, 2, v9
    s_lshl_b32 s28, s3, 1
    v_xor_b32 v10, s28, v10
    v_lshl_add_u32 v8, v10, 5, v8
    v_and_b32 v10, 3, v1
    v_lshl_add_u32 v8, v10, 3, v8
    v_xor_b32 v12, 32, v8
    v_add_u32 v13, 81920, v8
    v_add_u32 v20, 81920, v12
    v_bfe_u32 v9, v0, 2, 2
    v_lshrrev_b32 v10, 6, v0
    v_lshl_add_u32 v9, v10, 2, v9
    v_bfe_u32 v10, v0, 4, 1
    v_and_b32 v11, 3, v0
    v_lshlrev_b32 v11, 1, v11
    v_lshl_add_u32 v10, v10, 3, v11
    v_lshl_add_u32 v11, v9, 5, v10
    v_add_u32 v17, 1, v11
    v_cmp_eq_u32 vcc, 0, v10
    v_cmp_gt_u32 s[28:29], 16, v9
    s_nop 1
    s_and_b64 vcc, vcc, s[28:29]
    v_cndmask_b32_e64 v14, 0, 16, vcc
    v_add_u32 v16, v11, v14
    v_bfe_u32 v10, v0, 5, 1
    v_cmp_eq_u32 s[28:29], 1, v10
    v_sub_u32 v14, 1024, v16
    v_cmp_eq_u32 vcc, 512, v16
    s_nop 1
    v_cndmask_b32_e64 v14, v14, 0, vcc
    v_cndmask_b32_e64 v16, v16, v14, s[28:29]
    v_sub_u32 v14, 1024, v17
    v_cndmask_b32_e64 v17, v17, v14, s[28:29]
    v_lshlrev_b32 v16, 1, v16
    v_add_u32 v16, 147456, v16
    v_lshlrev_b32 v17, 1, v17
    v_add_u32 v17, 147456, v17
    v_lshlrev_b32 v18, 2, v0
    v_add_u32 v18, 149568, v18
    s_lshl_b32 s28, s21, 8
    s_add_u32 s28, s28, 147456
    v_lshlrev_b32 v19, 4, v2
    v_add_u32 v19, s28, v19
    v_mov_b32 v28, 149504
    v_lshlrev_b32 v29, 4, v1
    s_lshl_b32 s30, s22, 3
    s_add_u32 s30, s30, s3
    s_lshl_b32 s30, s30, 3
    s_add_u32 s30, s30, s21
    s_lshl_b32 s30, s30, 8
    s_add_u32 s30, s30, 0x488000
    v_lshlrev_b32 v30, 4, v2
    v_lshl_add_u32 v30, v3, 6, v30
    v_cmp_eq_u32 s[60:61], 1, v3
    v_cmp_eq_u32 s[62:63], 2, v3
    v_cmp_eq_u32 s[64:65], 3, v3
    v_add_u32 v21, 149568, v29
    v_mov_b32 v197, 0xffffff00
    s_and_b32 s35, s2, 0x47
    s_lshl_b32 s31, s3, 3
    s_add_u32 s35, s35, s31
    s_add_u32 s35, s35, 58
    s_and_b32 s35, s35, 127
    s_getreg_b32 s33, hwreg(HW_REG_XCC_ID)
    s_and_b32 s33, s33, 15
    s_lshr_b32 s31, s35, 5
    s_lshl_b32 s31, s31, 2
    s_add_u32 s31, s31, 149520
    v_mov_b32 v22, s31
    s_lshl_b32 s20, s22, 3
    s_add_u32 s20, s20, s21
    s_and_b32 s34, s20, 15
    s_bfe_u32 s28, s20, 0x10004
    s_lshl_b32 s28, s28, 5
    s_add_u32 s34, s34, s28
    s_mul_i32 s34, s34, 2176
    s_add_u32 s34, s34, 0x580000
    s_waitcnt vmcnt(0)
    s_barrier
    ds_read_b64_tr_b16 v[32:33], v13 offset:0
    ds_read_b64_tr_b16 v[34:35], v13 offset:2048
    ds_read_b64_tr_b16 v[36:37], v13 offset:16384
    ds_read_b64_tr_b16 v[38:39], v13 offset:18432
    ds_read_b64_tr_b16 v[40:41], v13 offset:32768
    ds_read_b64_tr_b16 v[42:43], v13 offset:34816
    ds_read_b64_tr_b16 v[44:45], v13 offset:49152
    ds_read_b64_tr_b16 v[46:47], v13 offset:51200
    s_waitcnt lgkmcnt(0)
    ds_read_b64_tr_b16 v[48:49], v20 offset:0
    ds_read_b64_tr_b16 v[50:51], v20 offset:2048
    ds_read_b64_tr_b16 v[52:53], v20 offset:16384
    ds_read_b64_tr_b16 v[54:55], v20 offset:18432
    ds_read_b64_tr_b16 v[56:57], v20 offset:32768
    ds_read_b64_tr_b16 v[58:59], v20 offset:34816
    ds_read_b64_tr_b16 v[60:61], v20 offset:49152
    ds_read_b64_tr_b16 v[62:63], v20 offset:51200
    s_waitcnt lgkmcnt(0)
    ds_read_b64_tr_b16 v[64:65], v8 offset:0
    ds_read_b64_tr_b16 v[66:67], v8 offset:2048
    ds_read_b64_tr_b16 v[68:69], v8 offset:16384
    ds_read_b64_tr_b16 v[70:71], v8 offset:18432
    ds_read_b64_tr_b16 v[72:73], v8 offset:32768
    ds_read_b64_tr_b16 v[74:75], v8 offset:34816
    ds_read_b64_tr_b16 v[76:77], v8 offset:49152
    ds_read_b64_tr_b16 v[78:79], v8 offset:51200
    s_waitcnt lgkmcnt(0)
    ds_read_b64_tr_b16 v[80:81], v12 offset:0
    ds_read_b64_tr_b16 v[82:83], v12 offset:2048
    ds_read_b64_tr_b16 v[84:85], v12 offset:16384
    ds_read_b64_tr_b16 v[86:87], v12 offset:18432
    ds_read_b64_tr_b16 v[88:89], v12 offset:32768
    ds_read_b64_tr_b16 v[90:91], v12 offset:34816
    ds_read_b64_tr_b16 v[92:93], v12 offset:49152
    ds_read_b64_tr_b16 v[94:95], v12 offset:51200
    s_waitcnt lgkmcnt(0)
    s_cmp_lg_u32 s3, 0
    s_cbranch_scc1 ffn_w3
    v_lshlrev_b32 v23, 4, v1
    v_add_u32 v24, 1024, v23
    s_lshl_b32 s28, s20, 4
    s_add_u32 s28, s28, s34
    v_mov_b32 v10, 34828
    s_nop 4
ffn_p3:
    buffer_load_dword v11, v10, s[4:7], s28 offen sc1
    s_waitcnt vmcnt(0) lgkmcnt(0)
    v_cmp_ne_u32 vcc, s40, v11
    s_cbranch_vccnz ffn_p3_rt
ffn_p3_ok:
    s_mov_b32 s58, 0
    s_mov_b32 s54, -1
    s_nop 1
ffn_k3:
    buffer_load_dwordx4 v[200:203], v23, s[4:7], s34 offen sc1
    buffer_load_dwordx4 v[204:207], v24, s[4:7], s34 offen sc1
    s_waitcnt vmcnt(0)
    v_xor_b32 v208, s40, v203
    v_xor_b32 v209, s40, v207
    v_max_u32 v210, v200, v204
    v_or_b32 v208, v208, v209
    v_cmp_ne_u32 vcc, 0, v208
    s_cbranch_vccnz ffn_k3_rt
ffn_k3_ok:
    v_max_u32_dpp v210, v210, v210 quad_perm:[1,0,3,2] row_mask:0xf bank_mask:0xf
    s_nop 1
    v_max_u32_dpp v210, v210, v210 quad_perm:[2,3,0,1] row_mask:0xf bank_mask:0xf
    s_nop 1
    v_max_u32_dpp v210, v210, v210 row_half_mirror row_mask:0xf bank_mask:0xf
    s_nop 1
    v_max_u32_dpp v210, v210, v210 row_mirror row_mask:0xf bank_mask:0xf
    s_nop 1
    v_max_u32_dpp v210, v210, v210 row_bcast:15 row_mask:0xa bank_mask:0xf
    s_nop 1
    v_max_u32_dpp v210, v210, v210 row_bcast:31 row_mask:0xc bank_mask:0xf
    s_nop 0
    v_readlane_b32 s36, v210, 63
    s_nop 1
    v_cmp_eq_u32 vcc, s36, v200
    v_cmp_eq_u32 s[28:29], s36, v204
    s_nop 0
    s_cmp_lg_u64 vcc, 0
    s_cselect_b32 s39, 0, 64
    s_or_b64 vcc, vcc, s[28:29]
    s_ff1_i32_b64 s41, vcc
    s_add_u32 s39, s39, s41
    s_lshl_b32 s39, s39, 11
    s_add_u32 s39, s39, 0x448000
    s_mov_b32 s58, 0
ffn_c3:
    buffer_load_dwordx4 v[128:131], v29, s[4:7], s39 offen sc1
    buffer_load_dwordx4 v[132:135], v29, s[4:7], s39 offen offset:1024 sc1
ffn_c3d:
    v_and_b32 v10, 15, v201
    v_and_b32 v11, 15, v205
    v_cmp_eq_u32 s[24:25], s33, v10
    v_cmp_eq_u32 s[26:27], s33, v11
    s_nop 0
    v_mov_b32 v212, s24
    v_mov_b32 v213, s25
    v_mov_b32 v214, s26
    v_mov_b32 v215, s27
    v_cndmask_b32_e64 v209, v201, v205, s[28:29]
    v_cndmask_b32_e64 v210, v202, v206, s[28:29]
    v_and_b32 v209, 0xffff0000, v209
    s_mov_b64 s[42:43], vcc
    s_mov_b64 exec, vcc
    ds_write_b128 v28, v[208:211]
    ds_write_b128 v28, v[212:215] offset:16
    s_mov_b64 exec, -1
    s_waitcnt vmcnt(1)
    ds_write_b128 v21, v[128:131]
    v_max3_u32 v10, v128, v129, v130
    s_waitcnt vmcnt(0)
    ds_write_b128 v21, v[132:135] offset:1024
    v_max3_u32 v10, v10, v131, v132
    v_max3_u32 v11, v133, v134, v135
    v_max_u32 v10, v10, v11
    v_cmp_eq_u32 vcc, -1, v10
    s_cbranch_vccnz ffn_c3_rt
ffn_c3_ok:
    s_waitcnt lgkmcnt(0)
    s_nop 2
ffn_w3:
    s_barrier
    ds_read_b32 v11, v18
    ds_read_b128 v[200:203], v28
    ds_read_b32 v203, v22
    s_mov_b32 s28, 0xffff0000
    s_waitcnt lgkmcnt(2)
    v_lshlrev_b32 v14, 16, v11
    v_and_b32 v15, s28, v11
    s_waitcnt lgkmcnt(0)
    v_add_f32 v14, v14, v201
    v_add_f32 v15, v15, v201
    v_cvt_pk_bf16_f32 v14, 0, v14
    v_cvt_pk_bf16_f32 v15, 0, v15
    v_mul_f32 v14, v14, v202
    v_mul_f32 v15, v15, v202
    v_cvt_pk_bf16_f32 v14, v14, v15
    ds_write_b16 v16, v14
    ds_write_b16_d16_hi v17, v14
    v_readfirstlane_b32 s24, v203
    s_waitcnt lgkmcnt(0)
    s_barrier
    ds_read_b128 v[128:131], v19 offset:0
    ds_read_b128 v[132:135], v19 offset:64
    ds_read_b128 v[136:139], v19 offset:128
    ds_read_b128 v[140:143], v19 offset:192
    s_waitcnt lgkmcnt(3)
    v_mfma_f32_16x16x32_bf16 v[192:195], v[32:35], v[128:131], 0
    v_mfma_f32_16x16x32_bf16 v[148:151], v[48:51], v[128:131], 0
    v_mfma_f32_16x16x32_bf16 v[152:155], v[64:67], v[128:131], 0
    v_mfma_f32_16x16x32_bf16 v[156:159], v[80:83], v[128:131], 0
    s_waitcnt lgkmcnt(2)
    v_mfma_f32_16x16x32_bf16 v[192:195], v[36:39], v[132:135], v[192:195]
    v_mfma_f32_16x16x32_bf16 v[148:151], v[52:55], v[132:135], v[148:151]
    v_mfma_f32_16x16x32_bf16 v[152:155], v[68:71], v[132:135], v[152:155]
    v_mfma_f32_16x16x32_bf16 v[156:159], v[84:87], v[132:135], v[156:159]
    s_waitcnt lgkmcnt(1)
    v_mfma_f32_16x16x32_bf16 v[192:195], v[40:43], v[136:139], v[192:195]
    v_mfma_f32_16x16x32_bf16 v[148:151], v[56:59], v[136:139], v[148:151]
    v_mfma_f32_16x16x32_bf16 v[152:155], v[72:75], v[136:139], v[152:155]
    v_mfma_f32_16x16x32_bf16 v[156:159], v[88:91], v[136:139], v[156:159]
    s_waitcnt lgkmcnt(0)
    v_mfma_f32_16x16x32_bf16 v[192:195], v[44:47], v[140:143], v[192:195]
    v_mfma_f32_16x16x32_bf16 v[148:151], v[60:63], v[140:143], v[148:151]
    v_mfma_f32_16x16x32_bf16 v[152:155], v[76:79], v[140:143], v[152:155]
    v_mfma_f32_16x16x32_bf16 v[156:159], v[92:95], v[140:143], v[156:159]
    s_nop 5
    v_cndmask_b32_e64 v192, v192, v148, s[60:61]
    v_cndmask_b32_e64 v193, v193, v149, s[60:61]
    v_cndmask_b32_e64 v194, v194, v150, s[60:61]
    v_cndmask_b32_e64 v195, v195, v151, s[60:61]
    v_cndmask_b32_e64 v192, v192, v152, s[62:63]
    v_cndmask_b32_e64 v193, v193, v153, s[62:63]
    v_cndmask_b32_e64 v194, v194, v154, s[62:63]
    v_cndmask_b32_e64 v195, v195, v155, s[62:63]
    v_cndmask_b32_e64 v192, v192, v156, s[64:65]
    v_cndmask_b32_e64 v193, v193, v157, s[64:65]
    v_cndmask_b32_e64 v194, v194, v158, s[64:65]
    v_cndmask_b32_e64 v195, v195, v159, s[64:65]
    s_mov_b32 exec_lo, 0x000f000f
    s_mov_b32 exec_hi, 0x000f000f
    v_and_or_b32 v192, v192, v197, s48
    v_and_or_b32 v193, v193, v197, s49
    v_and_or_b32 v194, v194, v197, s50
    v_and_or_b32 v195, v195, v197, s51
    s_bitcmp1_b32 s24, s35
    s_cbranch_scc0 ffn_rem
    buffer_store_dwordx4 v[192:195], v30, s[4:7], s30 offen
ffn_fin:
    s_endpgm
ffn_rem:
    buffer_store_dwordx4 v[192:195], v30, s[4:7], s30 offen sc1
    s_branch ffn_fin
ffn_c3_rt:
    s_mov_b64 vcc, s[42:43]
    s_add_u32 s58, s58, 1
    s_cmp_lt_u32 s58, 0x10000
    s_cbranch_scc1 ffn_c3
    s_branch ffn_c3_ok
fz_h1_r0:
    s_add_u32 s58, s58, 1
    s_cmp_gt_u32 s58, 0x10000
    s_cbranch_scc1 fz_h1_o0
    buffer_load_dwordx4 v[104:107], v222, s[4:7], s60 offen sc1
    buffer_load_dwordx4 v[108:111], v222, s[4:7], s61 offen sc1
    buffer_load_dwordx4 v[112:115], v222, s[4:7], s16 offen sc1
    buffer_load_dwordx4 v[116:119], v222, s[4:7], s17 offen sc1
    s_branch fz_h1_c0
fz_h1_r1:
    s_add_u32 s58, s58, 1
    s_cmp_gt_u32 s58, 0x10000
    s_cbranch_scc1 fz_h1_o1
    buffer_load_dwordx4 v[108:111], v222, s[4:7], s61 offen sc1
    buffer_load_dwordx4 v[112:115], v222, s[4:7], s16 offen sc1
    buffer_load_dwordx4 v[116:119], v222, s[4:7], s17 offen sc1
    s_branch fz_h1_c1
fz_h1_r2:
    s_add_u32 s58, s58, 1
    s_cmp_gt_u32 s58, 0x10000
    s_cbranch_scc1 fz_h1_o2
    buffer_load_dwordx4 v[112:115], v222, s[4:7], s16 offen sc1
    buffer_load_dwordx4 v[116:119], v222, s[4:7], s17 offen sc1
    s_branch fz_h1_c2
fz_h1_r3:
    s_add_u32 s58, s58, 1
    s_cmp_gt_u32 s58, 0x10000
    s_cbranch_scc1 fz_h1_o3
    buffer_load_dwordx4 v[116:119], v222, s[4:7], s17 offen sc1
    s_branch fz_h1_c3
fz_h2_r0:
    s_add_u32 s58, s58, 1
    s_cmp_gt_u32 s58, 0x10000
    s_cbranch_scc1 fz_h2_o0
    buffer_load_dwordx2 v[104:105], v228, s[4:7], s52 offen sc1
    buffer_load_dwordx2 v[106:107], v228, s[4:7], s53 offen sc1
    buffer_load_dwordx2 v[108:109], v228, s[4:7], s54 offen sc1
    buffer_load_dwordx2 v[110:111], v228, s[4:7], s55 offen sc1
    s_branch fz_h2_c0
fz_h2_r1:
    s_add_u32 s58, s58, 1
    s_cmp_gt_u32 s58, 0x10000
    s_cbranch_scc1 fz_h2_o1
    buffer_load_dwordx2 v[106:107], v228, s[4:7], s53 offen sc1
    buffer_load_dwordx2 v[108:109], v228, s[4:7], s54 offen sc1
    buffer_load_dwordx2 v[110:111], v228, s[4:7], s55 offen sc1
    s_branch fz_h2_c1
fz_h2_r2:
    s_add_u32 s58, s58, 1
    s_cmp_gt_u32 s58, 0x10000
    s_cbranch_scc1 fz_h2_o2
    buffer_load_dwordx2 v[108:109], v228, s[4:7], s54 offen sc1
    buffer_load_dwordx2 v[110:111], v228, s[4:7], s55 offen sc1
    s_branch fz_h2_c2
fz_h2_r3:
    s_add_u32 s58, s58, 1
    s_cmp_gt_u32 s58, 0x10000
    s_cbranch_scc1 fz_h2_o3
    buffer_load_dwordx2 v[110:111], v228, s[4:7], s55 offen sc1
    s_branch fz_h2_c3
fz_h5_r0:
    s_add_u32 s58, s58, 1
    s_cmp_gt_u32 s58, 0x10000
    s_cbranch_scc1 fz_h5_o0
    buffer_load_dwordx4 v[40:43], v3, s[4:7], s52 offen sc1
    buffer_load_dwordx4 v[44:47], v3, s[4:7], s53 offen sc1
    buffer_load_dwordx4 v[48:51], v3, s[4:7], s54 offen sc1
    buffer_load_dwordx4 v[52:55], v6, s[4:7], s55 offen sc1
    s_branch fz_h5_c0
fz_h5_r1:
    s_add_u32 s58, s58, 1
    s_cmp_gt_u32 s58, 0x10000
    s_cbranch_scc1 fz_h5_o1
    buffer_load_dwordx4 v[44:47], v3, s[4:7], s53 offen sc1
    buffer_load_dwordx4 v[48:51], v3, s[4:7], s54 offen sc1
    buffer_load_dwordx4 v[52:55], v6, s[4:7], s55 offen sc1
    s_branch fz_h5_c1
fz_h5_r2:
    s_add_u32 s58, s58, 1
    s_cmp_gt_u32 s58, 0x10000
    s_cbranch_scc1 fz_h5_o2
    buffer_load_dwordx4 v[48:51], v3, s[4:7], s54 offen sc1
    buffer_load_dwordx4 v[52:55], v6, s[4:7], s55 offen sc1
    s_branch fz_h5_c2
fz_h5_r3:
    s_add_u32 s58, s58, 1
    s_cmp_gt_u32 s58, 0x10000
    s_cbranch_scc1 fz_h5_o3
    buffer_load_dwordx4 v[52:55], v6, s[4:7], s55 offen sc1
    s_branch fz_h5_c3
fz_p1_rt:
    s_add_u32 s58, s58, 1
    s_cmp_lt_u32 s58, 0x10000
    s_cbranch_scc1 fz_p1
    s_branch fz_p1_ok
fz_k2_rt:
    s_add_u32 s58, s58, 1
    s_cmp_lt_u32 s58, 0x10000
    s_cbranch_scc1 fz_k2
    s_branch fz_k2_ok
fz_c2_rt:
    s_add_u32 s58, s58, 1
    s_cmp_lt_u32 s58, 0x10000
    s_cbranch_scc1 fz_c2
    s_branch fz_c2_ok
fz_p5_rt:
    s_add_u32 s58, s58, 1
    s_cmp_lt_u32 s58, 0x10000
    s_cbranch_scc1 fz_p5
    s_branch fz_p5_ok
fz_h4_rt:
    s_add_u32 s58, s58, 1
    s_cmp_lt_u32 s58, 0x10000
    s_cbranch_scc1 fz_h4
    s_branch fz_h4_ok
ffn_p3_rt:
    s_add_u32 s58, s58, 1
    s_cmp_lt_u32 s58, 0x10000
    s_cbranch_scc1 ffn_p3
    s_branch ffn_p3_ok
ffn_k3_rt:
    s_add_u32 s58, s58, 1
    s_cmp_lt_u32 s58, 0x10000
    s_cbranch_scc1 ffn_k3
    s_branch ffn_k3_ok
fz_codeend:
.section .rodata,"a"
.p2align 6
.amdhsa_kernel fz_kernel
  .amdhsa_next_free_vgpr 256
  .amdhsa_next_free_sgpr 102
  .amdhsa_accum_offset 256
  .amdhsa_group_segment_fixed_size 0
  .amdhsa_kernarg_size 104
  .amdhsa_user_sgpr_count 2
  .amdhsa_user_sgpr_kernarg_segment_ptr 1
  .amdhsa_system_sgpr_workgroup_id_x 1
.end_amdhsa_kernel
```

```asm
; @launch kernel=fz_kernel grid=(256,1,1) block=(512,1,1) lds=163840
.amdgcn_target "amdgcn-amd-amdhsa--gfx950"
.text
.globl fz_kernel
.p2align 8
.type fz_kernel,@function
fz_kernel:
    s_load_dwordx2 s[4:5], s[0:1], 96
    s_load_dwordx2 s[8:9], s[0:1], 0
    s_load_dwordx2 s[64:65], s[0:1], 72
    s_cmp_gt_u32 s2, 255
    s_cbranch_scc1 fz_end
    v_lshrrev_b32 v2, 6, v0
    v_and_b32 v1, 63, v0
    s_lshr_b32 s59, s2, 7
    v_readfirstlane_b32 s3, v2
    s_and_b32 s20, s2, 127
    s_cmp_lt_u32 s20, 8
    s_cselect_b32 s20, s3, 0
    s_cmp_lt_u32 s20, 4
    s_cbranch_scc1 fz_pfcback
    s_getpc_b64 s[20:21]
fz_pcb:
    s_sub_u32 s20, s20, fz_pcb-fz_kernel
    s_subb_u32 s21, s21, 0
    v_and_b32 v3, 255, v0
    v_lshlrev_b32 v3, 7, v3
    v_min_u32 v3, fz_codeend-fz_kernel-4, v3
    v_mov_b32 v5, s21
    v_add_co_u32 v4, vcc, s20, v3
    s_nop 1
    v_addc_co_u32 v5, vcc, 0, v5, vcc
    global_load_dword v251, v[4:5], off
fz_pfcback:
    s_cmp_lg_u32 s59, 0
    s_cbranch_scc1 fz_ldh
    s_load_dwordx2 s[12:13], s[0:1], 80
    s_load_dwordx2 s[16:17], s[0:1], 48
fz_ldback:
    s_add_u32 s20, s2, 58
    s_and_b32 s20, s20, 127
    s_lshr_b32 s21, s20, 3
    s_add_u32 s21, s21, 1
    s_and_b32 s22, s20, 7
    s_sub_u32 s23, s20, 124
    s_cmp_ge_u32 s20, 124
    s_cselect_b32 s21, 0, s21
    s_cselect_b32 s22, s23, s22
    s_lshr_b32 s57, s3, 2
    s_or_b32 s23, s57, s59
    s_and_b32 s24, s3, 3
    s_lshl_b32 s25, s22, 6
    s_add_u32 s25, s25, s21
    s_lshl_b32 s26, s23, 5
    s_add_u32 s26, s26, s25
    s_lshl_b32 s27, s24, 9
    s_add_u32 s28, s26, s27
    s_sub_u32 s27, 2048, s27
    s_sub_u32 s27, s27, s26
    s_lshl_b32 s29, s24, 1
    s_add_u32 s29, s29, s23
    s_sub_u32 s30, 15, s29
    s_cmp_lt_u32 s24, 2
    s_cselect_b32 s27, s28, s27
    s_cselect_b32 s31, s29, s30
    s_cselect_b32 s30, s30, s29
    s_sub_u32 s28, 2048, s27
    s_and_b32 s28, s28, 2047
    s_lshl_b32 s27, s27, 11
    s_lshl_b32 s28, s28, 11
    s_mul_i32 s31, s31, 2064
    s_mul_i32 s30, s30, 2064
    v_lshlrev_b32 v239, 4, v1
    s_mov_b32 s10, 0x400000
    s_mov_b32 s11, 0x00020000
    s_mov_b32 s6, 0x690000
    s_mov_b32 s7, 0x00020000
    s_mov_b32 s66, 0x700000
    s_mov_b32 s67, 0x00020000
    s_and_b32 s32, s57, s59
    s_add_u32 s36, s2, 4
    s_and_b32 s36, s36, 7
    s_bfe_u32 s37, s2, 0x10006
    s_lshl_b32 s63, s36, 1
    s_add_u32 s63, s63, s37
    s_cmp_lg_u32 s37, 0
    s_cselect_b32 s37, 8, s36
    s_add_u32 s37, s37, 6
    s_cmp_lt_u32 s36, 6
    s_cselect_b32 s63, s63, s37
    s_lshl_b32 s63, s63, 3
    s_bfe_u32 s37, s2, 0x30003
    s_add_u32 s63, s63, s37
    v_and_b32 v10, 15, v1
    v_lshlrev_b32 v10, 4, v10
    v_lshrrev_b32 v14, 4, v1
    v_lshl_add_u32 v14, v14, 11, v10
    s_lshl_b32 s62, s63, 16
    s_and_b32 s37, s3, 3
    s_lshl_b32 s37, s37, 9
    s_add_u32 s62, s62, s37
    s_mov_b32 s58, 0
    s_waitcnt lgkmcnt(0)
    s_cmp_eq_u32 s2, 66
    s_cbranch_scc1 fz_spec
fz_specback:
    s_cmp_lg_u32 s57, 0
    s_cbranch_scc1 fz_nox
    s_mov_b32 m0, s31
    s_nop 0
    buffer_load_dwordx4 v239, s[8:11], s27 offen nt lds
    buffer_load_dwordx4 v239, s[8:11], s27 offen offset:1024 nt lds
    s_mov_b32 m0, s30
    s_nop 0
    buffer_load_dwordx4 v239, s[8:11], s28 offen nt lds
    buffer_load_dwordx4 v239, s[8:11], s28 offen offset:1024 nt lds
fz_nox:
    buffer_load_dword v250, off, s[4:7], 0
    s_andn2_b32 s32, s57, s59
    s_cbranch_scc0 fz_nowe
    buffer_load_dwordx4 v[160:163], v14, s[64:67], s62 offen offset:0 nt
    buffer_load_dwordx4 v[164:167], v14, s[64:67], s62 offen offset:256 nt
    s_add_u32 s62, s62, 8192
    buffer_load_dwordx4 v[168:171], v14, s[64:67], s62 offen offset:0 nt
    buffer_load_dwordx4 v[172:175], v14, s[64:67], s62 offen offset:256 nt
    s_add_u32 s62, s62, 8192
fz_nowe:
    s_cmp_eq_u32 s57, 0
    s_cbranch_scc1 fz_np
    s_setprio 1
fz_np:
    v_and_b32 v2, 31, v1
    v_lshrrev_b32 v3, 5, v1
    v_and_b32 v4, 15, v1
    v_lshrrev_b32 v5, 4, v1
    v_add_u32 v6, 49536, v239
    v_lshrrev_b32 v10, 1, v2
    v_and_b32 v8, 9, v10
    v_and_b32 v11, 2, v10
    v_lshl_or_b32 v8, v11, 1, v8
    v_bfe_u32 v11, v10, 2, 1
    v_lshl_or_b32 v8, v11, 1, v8
    v_and_b32 v12, 1, v5
    v_cmp_eq_u32 vcc, 1, v12
    v_lshl_add_u32 v9, v4, 1, 1
    s_nop 0
    v_cndmask_b32_e64 v9, v9, 0, vcc
    s_cmp_lt_u32 s3, 5
    s_cselect_b64 s[32:33], -1, 0
    s_cmp_lt_u32 s3, 3
    s_cselect_b64 s[34:35], -1, 0
    v_cndmask_b32_e64 v9, v9, v2, s[32:33]
    v_cndmask_b32_e64 v8, v9, v8, s[34:35]
    s_mov_b32 s36, 0x3d000000
    s_cmp_gt_u32 s3, 4
    s_cselect_b32 s36, 0x3c800000, s36
    s_sub_u32 s37, s3, 1
    s_cmp_lt_u32 s37, 2
    s_cselect_b32 s36, 0x3a800000, s36
    s_cmp_eq_u32 s3, 0
    s_cselect_b32 s32, 16, 0
    s_cselect_b32 s33, 0x3e800000, 0
    s_cselect_b32 s34, 4.0, 0x41000000
    s_cselect_b32 s35, 0x41000000, 4.0
    v_cmp_eq_u32 vcc, 1, v2
    v_mov_b32 v10, s32
    s_nop 0
    v_cndmask_b32_e64 v10, 0, v10, vcc
    v_add_u32 v8, v8, v10
    v_cvt_f32_u32 v8, v8
    v_mul_f32 v8, s36, v8
    s_cmp_eq_u32 s3, 2
    s_cselect_b32 s32, 0x80000000, 0
    v_lshlrev_b32 v10, 31, v2
    v_and_b32 v10, s32, v10
    v_xor_b32 v8, v10, v8
    v_and_b32 v10, 1, v2
    v_cvt_f32_u32 v10, v10
    v_mul_f32 v10, s33, v10
    s_cmp_eq_u32 s3, 1
    s_cselect_b32 s33, 0x3e800000, 0
    v_mov_b32 v11, s33
    v_cndmask_b32_e64 v10, v10, v11, vcc
    s_cmp_eq_u32 s3, 5
    s_cselect_b32 s33, 0x3e800000, 0
    v_cvt_f32_u32 v12, v12
    v_fma_f32 v10, v12, s33, v10
    s_cmp_eq_u32 s3, 6
    s_cselect_b32 s33, 0x3e800000, 0
    s_cmp_eq_u32 s3, 2
    s_cselect_b32 s33, 0xbe800000, s33
    s_cmp_eq_u32 s3, 4
    s_cselect_b32 s33, 0xbe800000, s33
    v_add_f32 v10, s33, v10
    v_cvt_f32_u32 v11, v3
    v_mul_f32 v11, s35, v11
    v_fma_f32 v9, v8, v11, v10
    v_mul_f32 v10, s34, v8
    v_mul_f32 v11, 0x41800000, v8
    v_mov_b32 v104, v9
    v_fmamk_f32 v105, v8, 0x3f800000, v9
    v_fmamk_f32 v106, v8, 0x40000000, v9
    v_fmamk_f32 v107, v8, 0x40400000, v9
    v_add_f32 v108, v104, v10
    v_add_f32 v109, v105, v10
    v_add_f32 v110, v106, v10
    v_add_f32 v111, v107, v10
    v_add_f32 v112, v104, v11
    v_add_f32 v113, v105, v11
    v_add_f32 v114, v106, v11
    v_add_f32 v115, v107, v11
    v_add_f32 v116, v108, v11
    v_add_f32 v117, v109, v11
    v_add_f32 v118, v110, v11
    v_add_f32 v119, v111, v11
    v_cos_f32 v104, v104
    v_cos_f32 v105, v105
    v_cos_f32 v106, v106
    v_cos_f32 v107, v107
    v_cos_f32 v108, v108
    v_cos_f32 v109, v109
    v_cos_f32 v110, v110
    v_cos_f32 v111, v111
    v_cos_f32 v112, v112
    v_cos_f32 v113, v113
    v_cos_f32 v114, v114
    v_cos_f32 v115, v115
    v_cos_f32 v116, v116
    v_cos_f32 v117, v117
    v_cos_f32 v118, v118
    v_cos_f32 v119, v119
    s_lshl_b32 s32, s3, 11
    v_add_u32 v8, s32, v6
    s_cmp_eq_u32 s3, 0
    s_cbranch_scc1 fz_jb
    v_cvt_pk_f16_f32 v128, v104, v105
    v_cvt_pk_f16_f32 v129, v106, v107
    v_cvt_pk_f16_f32 v130, v108, v109
    v_cvt_pk_f16_f32 v131, v110, v111
    v_cvt_pk_f16_f32 v132, v112, v113
    v_cvt_pk_f16_f32 v133, v114, v115
    v_cvt_pk_f16_f32 v134, v116, v117
    v_cvt_pk_f16_f32 v135, v118, v119
fz_jend:
    ds_write_b128 v8, v[128:131] offset:0
    ds_write_b128 v8, v[132:135] offset:1024
    v_mov_b32 v15, 49520
    v_mov_b32 v10, 0
    ds_write_b32 v15, v10
    s_waitcnt lgkmcnt(0)
    s_barrier
    v_lshlrev_b32 v240, 31, v1
    v_lshrrev_b32 v10, 16, v240
    v_or_b32 v240, v240, v10
    v_mov_b32 v229, 0xfffcfffc
    v_mov_b32 v242, 0xffff0000
    s_mov_b32 s42, 0x3f803f80
    s_cmp_lg_u32 s57, 0
    s_cbranch_scc1 fz_nc1
    ds_read_b128 v[16:19], v6 offset:0
    ds_read_b128 v[20:23], v6 offset:1024
    ds_read_b128 v[24:27], v6 offset:2048
    ds_read_b128 v[28:31], v6 offset:3072
    ds_read_b128 v[32:35], v6 offset:4096
    ds_read_b128 v[36:39], v6 offset:5120
    ds_read_b128 v[40:43], v6 offset:6144
    ds_read_b128 v[44:47], v6 offset:7168
    ds_read_b128 v[48:51], v6 offset:8192
    ds_read_b128 v[52:55], v6 offset:9216
    ds_read_b128 v[56:59], v6 offset:10240
    ds_read_b128 v[60:63], v6 offset:11264
    ds_read_b128 v[64:67], v6 offset:12288
    ds_read_b128 v[68:71], v6 offset:13312
    v_lshlrev_b32 v7, 9, v3
    v_bfe_u32 v10, v1, 2, 2
    v_lshl_add_u32 v7, v10, 6, v7
    v_and_b32 v10, 1, v5
    v_lshl_add_u32 v7, v10, 5, v7
    v_and_b32 v10, 3, v1
    v_lshl_add_u32 v7, v10, 3, v7
    v_add_u32 v7, s31, v7
    v_lshlrev_b32 v8, 9, v3
    v_lshl_add_u32 v8, v2, 1, v8
    v_sub_u32 v9, 2048, v8
    v_and_b32 v9, 2047, v9
    v_add_u32 v9, s30, v9
    s_add_u32 s32, s30, 576
    v_sub_u32 v8, s32, v8
    v_cmp_eq_u32 vcc, 0, v2
    s_nop 1
    v_cndmask_b32_e64 v234, 0, -2.0, vcc
    v_mov_b32 v235, 0x3b27c5ac
    s_lshr_b32 s32, s24, 1
    s_lshl_b32 s32, s32, 6
    s_mul_i32 s33, s3, 2304
    s_add_u32 s32, s32, s33
    s_add_u32 s32, s32, 67968
    v_lshl_add_u32 v10, v3, 1, v1
    v_lshlrev_b32 v10, 4, v10
    v_add_u32 v216, s32, v10
    v_bfe_u32 v10, v0, 2, 1
    v_mul_u32_u24 v10, 34, v10
    v_lshrrev_b32 v11, 4, v0
    v_add_u32 v10, v10, v11
    v_lshlrev_b32 v10, 4, v10
    v_bfe_u32 v11, v0, 3, 1
    v_lshl_add_u32 v10, v11, 3, v10
    v_bfe_u32 v11, v0, 1, 1
    v_lshl_add_u32 v10, v11, 2, v10
    v_and_b32 v12, 1, v0
    s_mov_b32 s33, 9216
    s_cmp_eq_u32 s2, 66
    s_cselect_b32 s32, s33, 0x1b40
    v_mul_lo_u32 v11, v12, s32
    v_add_u32 v217, v10, v11
    v_add_u32 v217, 67968, v217
    s_cselect_b32 s32, s33, 0x940
    v_mul_lo_u32 v11, v12, s32
    v_add_u32 v218, v10, v11
    v_add_u32 v218, 70272, v218
    s_cselect_b32 s32, s33, 0xfffff6c0
    v_mul_lo_u32 v11, v12, s32
    v_add_u32 v219, v10, v11
    v_add_u32 v219, 73792, v219
    s_cselect_b32 s32, s33, 0xffffe4c0
    v_mul_lo_u32 v11, v12, s32
    v_add_u32 v220, v10, v11
    v_add_u32 v220, 76096, v220
    v_lshrrev_b32 v10, 2, v0
    v_and_b32 v11, 3, v0
    v_lshlrev_b32 v11, 4, v11
    v_lshl_add_u32 v221, v10, 7, v11
    s_mul_i32 s52, s20, 16512
    s_lshl_b32 s33, s59, 6
    s_add_u32 s52, s52, s33
    s_add_u32 s52, s52, 0x1000
    s_add_u32 s53, s52, 8192
    v_mov_b32 v160, 0
    v_mov_b32 v161, 0
    v_mov_b32 v162, 0
    v_mov_b32 v163, 0
    s_setprio 3
    s_waitcnt vmcnt(0) lgkmcnt(0)
    ds_read_b64_tr_b16 v[88:89], v7 offset:0
    ds_read_b64_tr_b16 v[90:91], v7 offset:256
    ds_read_b64_tr_b16 v[92:93], v7 offset:1024
    ds_read_b64_tr_b16 v[94:95], v7 offset:1280
    ds_read_u16_d16 v96, v9
    ds_read_u16_d16_hi v136, v8 offset:1408
    ds_read_u16_d16 v97, v8 offset:1344
    ds_read_u16_d16_hi v137, v8 offset:1280
    ds_read_u16_d16 v98, v8 offset:1216
    ds_read_u16_d16_hi v138, v8 offset:1152
    ds_read_u16_d16 v99, v8 offset:1088
    ds_read_u16_d16_hi v139, v8 offset:1024
    s_waitcnt lgkmcnt(8)
    v_mfma_f32_32x32x16_bf16 v[104:119], v[88:91], v[16:19], 0
    v_mfma_f32_32x32x16_bf16 v[104:119], v[92:95], v[20:23], v[104:119]
    ds_read_u16_d16 v100, v8 offset:448
    ds_read_u16_d16_hi v140, v8 offset:384
    ds_read_u16_d16 v101, v8 offset:320
    ds_read_u16_d16_hi v141, v8 offset:256
    ds_read_u16_d16 v102, v8 offset:192
    ds_read_u16_d16_hi v142, v8 offset:128
    ds_read_u16_d16 v103, v8 offset:64
    ds_read_u16_d16_hi v143, v8 offset:0
    v_dot2_f32_bf16 v160, v88, s42, v160
    v_dot2_f32_bf16 v161, v88, v88, v161
    v_dot2_f32_bf16 v160, v89, s42, v160
    v_dot2_f32_bf16 v161, v89, v89, v161
    v_dot2_f32_bf16 v160, v90, s42, v160
    v_dot2_f32_bf16 v161, v90, v90, v161
    v_dot2_f32_bf16 v160, v91, s42, v160
    v_dot2_f32_bf16 v161, v91, v91, v161
    v_dot2_f32_bf16 v160, v92, s42, v160
    v_dot2_f32_bf16 v161, v92, v92, v161
    v_dot2_f32_bf16 v160, v93, s42, v160
    v_dot2_f32_bf16 v161, v93, v93, v161
    v_dot2_f32_bf16 v160, v94, s42, v160
    v_dot2_f32_bf16 v161, v94, v94, v161
    v_dot2_f32_bf16 v160, v95, s42, v160
    v_dot2_f32_bf16 v161, v95, v95, v161
    s_waitcnt lgkmcnt(0)
    v_or_b32 v96, v96, v136
    v_or_b32 v97, v97, v137
    v_or_b32 v98, v98, v138
    v_or_b32 v99, v99, v139
    v_or_b32 v100, v100, v140
    v_or_b32 v101, v101, v141
    v_or_b32 v102, v102, v142
    v_or_b32 v103, v103, v143
    v_mfma_f32_32x32x16_bf16 v[120:135], v[96:99], v[16:19], 0
    s_nop 0
    v_mfma_f32_32x32x16_bf16 v[120:135], v[100:103], v[20:23], v[120:135]
    v_dot2_f32_bf16 v162, v96, s42, v162
    v_dot2_f32_bf16 v163, v96, v96, v163
    v_dot2_f32_bf16 v162, v97, s42, v162
    v_dot2_f32_bf16 v163, v97, v97, v163
    v_dot2_f32_bf16 v162, v98, s42, v162
    v_dot2_f32_bf16 v163, v98, v98, v163
    v_dot2_f32_bf16 v162, v99, s42, v162
    v_dot2_f32_bf16 v163, v99, v99, v163
    v_dot2_f32_bf16 v162, v100, s42, v162
    v_dot2_f32_bf16 v163, v100, v100, v163
    v_dot2_f32_bf16 v162, v101, s42, v162
    v_dot2_f32_bf16 v163, v101, v101, v163
    v_dot2_f32_bf16 v162, v102, s42, v162
    v_dot2_f32_bf16 v163, v102, v102, v163
    v_dot2_f32_bf16 v162, v103, s42, v162
    v_dot2_f32_bf16 v163, v103, v103, v163
    s_nop 1
    v_permlane32_swap_b32 v160, v162
    v_permlane32_swap_b32 v161, v163
    v_add_f32 v160, v160, v162
    v_add_f32 v161, v161, v163
    s_nop 1
    v_permlane16_swap_b32 v160, v161
    v_add_f32 v160, v160, v161
    s_nop 1
    v_add_f32_dpp v160, v160, v160 quad_perm:[1,0,3,2] row_mask:0xf bank_mask:0xf
    s_nop 1
    v_add_f32_dpp v160, v160, v160 quad_perm:[2,3,0,1] row_mask:0xf bank_mask:0xf
    s_nop 1
    v_add_f32_dpp v160, v160, v160 row_half_mirror row_mask:0xf bank_mask:0xf
    s_nop 1
    v_add_f32_dpp v160, v160, v160 row_mirror row_mask:0xf bank_mask:0xf
    s_mov_b32 s43, 0x3e800000
    v_mov_b32 v161, v160
    s_nop 1
    v_permlane16_swap_b32 v160, v161
    v_mul_f32 v160, 0x3c800000, v160
    v_fma_f32 v161, v161, s43, v235
    v_fma_f32 v161, -v160, v160, v161
    v_rsq_f32 v161, v161
    s_nop 0
    v_mul_f32 v160, v160, v161
    v_readlane_b32 s32, v161, 0
    v_readlane_b32 s34, v161, 32
    v_readlane_b32 s36, v160, 0
    v_readlane_b32 s37, v160, 32
    s_nop 0
    v_mul_f32 v164, s36, v234
    v_fmac_f32 v164, s37, v234
    v_pk_fma_f32 v[104:105], v[104:105], s[32:33], v[164:165] op_sel_hi:[1,0,0]
    v_pk_fma_f32 v[106:107], v[106:107], s[32:33], v[164:165] op_sel_hi:[1,0,0]
    v_pk_fma_f32 v[108:109], v[108:109], s[32:33], v[164:165] op_sel_hi:[1,0,0]
    v_pk_fma_f32 v[110:111], v[110:111], s[32:33], v[164:165] op_sel_hi:[1,0,0]
    v_pk_fma_f32 v[112:113], v[112:113], s[32:33], v[164:165] op_sel_hi:[1,0,0]
    v_pk_fma_f32 v[114:115], v[114:115], s[32:33], v[164:165] op_sel_hi:[1,0,0]
    v_pk_fma_f32 v[116:117], v[116:117], s[32:33], v[164:165] op_sel_hi:[1,0,0]
    v_pk_fma_f32 v[118:119], v[118:119], s[32:33], v[164:165] op_sel_hi:[1,0,0]
    v_pk_fma_f32 v[104:105], v[120:121], s[34:35], v[104:105] op_sel_hi:[1,0,1]
    v_pk_fma_f32 v[106:107], v[122:123], s[34:35], v[106:107] op_sel_hi:[1,0,1]
    v_pk_fma_f32 v[108:109], v[124:125], s[34:35], v[108:109] op_sel_hi:[1,0,1]
    v_pk_fma_f32 v[110:111], v[126:127], s[34:35], v[110:111] op_sel_hi:[1,0,1]
    v_pk_fma_f32 v[112:113], v[128:129], s[34:35], v[112:113] op_sel_hi:[1,0,1]
    v_pk_fma_f32 v[114:115], v[130:131], s[34:35], v[114:115] op_sel_hi:[1,0,1]
    v_pk_fma_f32 v[116:117], v[132:133], s[34:35], v[116:117] op_sel_hi:[1,0,1]
    v_pk_fma_f32 v[118:119], v[134:135], s[34:35], v[118:119] op_sel_hi:[1,0,1]
    v_cvt_pk_f16_f32 v136, v104, v105
    v_cvt_pk_f16_f32 v137, v106, v107
    v_cvt_pk_f16_f32 v138, v108, v109
    v_cvt_pk_f16_f32 v139, v110, v111
    v_cvt_pk_f16_f32 v140, v112, v113
    v_cvt_pk_f16_f32 v141, v114, v115
    v_cvt_pk_f16_f32 v142, v116, v117
    v_cvt_pk_f16_f32 v143, v118, v119
    v_mov_b32_dpp v152, v136 quad_perm:[1,0,3,2] row_mask:0xf bank_mask:0xf
    v_mov_b32_dpp v153, v137 quad_perm:[1,0,3,2] row_mask:0xf bank_mask:0xf
    v_mov_b32_dpp v154, v138 quad_perm:[1,0,3,2] row_mask:0xf bank_mask:0xf
    v_mov_b32_dpp v155, v139 quad_perm:[1,0,3,2] row_mask:0xf bank_mask:0xf
    v_mov_b32_dpp v156, v140 quad_perm:[1,0,3,2] row_mask:0xf bank_mask:0xf
    v_mov_b32_dpp v157, v141 quad_perm:[1,0,3,2] row_mask:0xf bank_mask:0xf
    v_mov_b32_dpp v158, v142 quad_perm:[1,0,3,2] row_mask:0xf bank_mask:0xf
    v_mov_b32_dpp v159, v143 quad_perm:[1,0,3,2] row_mask:0xf bank_mask:0xf
    v_pk_mul_f16 v144, v136, v24
    v_pk_mul_f16 v145, v137, v25
    v_pk_mul_f16 v146, v138, v26
    v_pk_mul_f16 v147, v139, v27
    v_pk_mul_f16 v148, v140, v28
    v_pk_mul_f16 v149, v141, v29
    v_pk_mul_f16 v150, v142, v30
    v_pk_mul_f16 v151, v143, v31
    v_mfma_f32_16x16x32_f16 v[120:123], v[136:139], v[56:59], 0
    v_pk_fma_f16 v144, v152, v32, v144
    v_pk_fma_f16 v145, v153, v33, v145
    v_pk_fma_f16 v146, v154, v34, v146
    v_pk_fma_f16 v147, v155, v35, v147
    v_mfma_f32_16x16x32_f16 v[120:123], v[140:143], v[60:63], v[120:123]
    v_pk_fma_f16 v148, v156, v36, v148
    v_pk_fma_f16 v149, v157, v37, v149
    v_pk_fma_f16 v150, v158, v38, v150
    v_pk_fma_f16 v151, v159, v39, v151
    v_mfma_f32_32x32x16_f16 v[104:119], v[144:147], v[40:43], 0
    v_xor_b32_dpp v152, v144, v240 quad_perm:[1,0,3,2] row_mask:0xf bank_mask:0xf
    v_xor_b32_dpp v153, v145, v240 quad_perm:[1,0,3,2] row_mask:0xf bank_mask:0xf
    v_xor_b32_dpp v154, v146, v240 quad_perm:[1,0,3,2] row_mask:0xf bank_mask:0xf
    v_xor_b32_dpp v155, v147, v240 quad_perm:[1,0,3,2] row_mask:0xf bank_mask:0xf
    v_mfma_f32_32x32x16_f16 v[104:119], v[148:151], v[44:47], v[104:119]
    v_xor_b32_dpp v156, v148, v240 quad_perm:[1,0,3,2] row_mask:0xf bank_mask:0xf
    v_xor_b32_dpp v157, v149, v240 quad_perm:[1,0,3,2] row_mask:0xf bank_mask:0xf
    v_xor_b32_dpp v158, v150, v240 quad_perm:[1,0,3,2] row_mask:0xf bank_mask:0xf
    v_xor_b32_dpp v159, v151, v240 quad_perm:[1,0,3,2] row_mask:0xf bank_mask:0xf
    v_mfma_f32_32x32x16_f16 v[104:119], v[152:155], v[48:51], v[104:119]
    s_nop 0
    v_mfma_f32_32x32x16_f16 v[104:119], v[156:159], v[52:55], v[104:119]
    v_mfma_f32_16x16x32_f16 v[124:127], v[136:139], v[64:67], 0
    v_mfma_f32_16x16x32_f16 v[124:127], v[140:143], v[68:71], v[124:127]
    v_readfirstlane_b32 s40, v250
    s_nop 1
    s_add_u32 s40, s40, 1
    s_and_b32 s38, s40, 3
    s_and_b32 s39, s40, 15
    s_bfe_u32 s41, s40, 0x20002
    s_lshl_b32 s41, s41, 16
    s_or_b32 s44, s38, s41
    s_bfe_u32 s41, s40, 0x40004
    s_lshl_b32 s41, s41, 4
    s_or_b32 s48, s39, s41
    s_bfe_u32 s41, s40, 0x20004
    s_lshl_b32 s41, s41, 16
    s_or_b32 s45, s38, s41
    s_bfe_u32 s41, s40, 0x40008
    s_lshl_b32 s41, s41, 4
    s_or_b32 s49, s39, s41
    s_bfe_u32 s41, s40, 0x20006
    s_lshl_b32 s41, s41, 16
    s_or_b32 s46, s38, s41
    s_bfe_u32 s41, s40, 0x4000c
    s_lshl_b32 s41, s41, 4
    s_or_b32 s50, s39, s41
    s_bfe_u32 s41, s40, 0x20008
    s_lshl_b32 s41, s41, 16
    s_or_b32 s47, s38, s41
    s_bfe_u32 s41, s40, 0x40010
    s_lshl_b32 s41, s41, 4
    s_or_b32 s51, s39, s41
    s_mov_b32 s38, 0x404
    s_cmp_eq_u32 s2, 66
    s_cselect_b32 s39, 8, 4
    s_cselect_b32 s38, 8, s38
    s_mov_b64 vcc, 0xffff
    v_cvt_pk_f16_f32 v143, v118, v119
    v_cvt_pk_f16_f32 v142, v116, v117
    v_cvt_pk_f16_f32 v141, v114, v115
    v_cvt_pk_f16_f32 v140, v112, v113
    v_cvt_pk_f16_f32 v139, v110, v111
    v_cvt_pk_f16_f32 v138, v108, v109
    v_cvt_pk_f16_f32 v137, v106, v107
    v_cndmask_b32_e64 v104, v104, v121, vcc
    v_cndmask_b32_e64 v105, v105, v125, vcc
    v_pk_add_f16 v147, v142, v143 op_sel:[0,1] op_sel_hi:[1,0] neg_lo:[0,1]
    v_pk_add_f16 v151, v142, v143 op_sel:[0,1] op_sel_hi:[1,0] neg_hi:[1,0]
    v_pk_add_f16 v146, v140, v141 op_sel:[0,1] op_sel_hi:[1,0] neg_lo:[0,1]
    v_pk_add_f16 v150, v140, v141 op_sel:[0,1] op_sel_hi:[1,0] neg_hi:[1,0]
    v_pk_add_f16 v145, v138, v139 op_sel:[0,1] op_sel_hi:[1,0] neg_lo:[0,1]
    v_pk_add_f16 v149, v138, v139 op_sel:[0,1] op_sel_hi:[1,0] neg_hi:[1,0]
    v_cvt_pk_f16_f32 v136, v104, v105
    v_pk_add_f16 v144, v136, v137 op_sel:[0,1] op_sel_hi:[1,0] neg_lo:[0,1]
    v_pk_add_f16 v148, v136, v137 op_sel:[0,1] op_sel_hi:[1,0] neg_hi:[1,0]
    ds_write_b128 v216, v[144:147]
    ds_write_b128 v216, v[148:151] offset:1152
    s_waitcnt lgkmcnt(0)
    v_mov_b32 v10, 1
    s_mov_b64 exec, 1
    ds_add_u32 v15, v10
    s_mov_b64 exec, -1
    s_cmp_gt_u32 s3, 3
    s_cbranch_scc1 fz_bsp0
fz_sy:
    ds_read_b32 v10, v15
    s_waitcnt lgkmcnt(0)
    v_and_b32 v10, 0xff, v10
    v_cmp_ne_u32 vcc, s39, v10
    s_cbranch_vccnz fz_sy
    ds_read_b32 v104, v217 offset:0
    ds_read_b32 v105, v218 offset:0
    ds_read_b32 v106, v219 offset:0
    ds_read_b32 v107, v220 offset:0
    ds_read_b32 v108, v217 offset:256
    ds_read_b32 v109, v218 offset:256
    ds_read_b32 v110, v219 offset:256
    ds_read_b32 v111, v220 offset:256
    s_waitcnt lgkmcnt(4)
    v_pk_add_f16 v112, v104, v106
    v_pk_add_f16 v114, v105, v107
    v_pk_add_f16 v113, v104, v106 neg_lo:[0,1] neg_hi:[0,1]
    v_pk_add_f16 v115, v105, v107 neg_lo:[0,1] neg_hi:[0,1]
    v_pk_add_f16 v116, v112, v114
    v_pk_add_f16 v118, v112, v114 neg_lo:[0,1] neg_hi:[0,1]
    v_pk_add_f16 v117, v113, v115 op_sel:[0,1] op_sel_hi:[1,0] neg_hi:[0,1]
    v_pk_add_f16 v119, v113, v115 op_sel:[0,1] op_sel_hi:[1,0] neg_lo:[0,1]
    v_add_u32 v116, 0x20002, v116
    v_add_u32 v117, 0x20002, v117
    v_add_u32 v118, 0x20002, v118
    v_add_u32 v119, 0x20002, v119
    v_and_or_b32 v116, v116, v229, s44
    v_and_or_b32 v117, v117, v229, s45
    v_and_or_b32 v118, v118, v229, s46
    v_and_or_b32 v119, v119, v229, s47
    buffer_store_dwordx4 v[116:119], v221, s[4:7], s52 offen sc1
    s_waitcnt lgkmcnt(0)
    v_pk_add_f16 v120, v108, v110
    v_pk_add_f16 v122, v109, v111
    v_pk_add_f16 v121, v108, v110 neg_lo:[0,1] neg_hi:[0,1]
    v_pk_add_f16 v123, v109, v111 neg_lo:[0,1] neg_hi:[0,1]
    v_pk_add_f16 v124, v120, v122
    v_pk_add_f16 v126, v120, v122 neg_lo:[0,1] neg_hi:[0,1]
    v_pk_add_f16 v125, v121, v123 op_sel:[0,1] op_sel_hi:[1,0] neg_hi:[0,1]
    v_pk_add_f16 v127, v121, v123 op_sel:[0,1] op_sel_hi:[1,0] neg_lo:[0,1]
    v_add_u32 v124, 0x20002, v124
    v_add_u32 v125, 0x20002, v125
    v_add_u32 v126, 0x20002, v126
    v_add_u32 v127, 0x20002, v127
    v_and_or_b32 v124, v124, v229, s44
    v_and_or_b32 v125, v125, v229, s45
    v_and_or_b32 v126, v126, v229, s46
    v_and_or_b32 v127, v127, v229, s47
    buffer_store_dwordx4 v[124:127], v221, s[4:7], s53 offen sc1
    s_cmp_lg_u32 s59, 0
    s_cbranch_scc1 ffn
    s_and_b32 s32, s3, 3
    s_lshr_b32 s33, s3, 2
    s_lshl_b32 s33, s33, 4
    s_add_u32 s33, s33, s32
    v_and_b32 v8, 12, v4
    v_bfe_u32 v9, v4, 1, 1
    v_lshl_add_u32 v8, v9, 5, v8
    v_add_u32 v8, s33, v8
    v_cvt_f32_u32 v8, v8
    v_and_b32 v12, 1, v1
    v_cvt_f32_u32 v9, v12
    v_lshlrev_b32 v13, 2, v5
    v_cvt_f32_u32 v10, v13
    v_mul_f32 v11, 0x3c800000, v8
    v_mul_f32 v9, 0x3e800000, v9
    v_fma_f32 v9, v11, v10, v9
    v_mov_b32 v128, v9
    v_fmamk_f32 v129, v11, 0x3f800000, v9
    v_fmamk_f32 v130, v11, 0x40000000, v9
    v_fmamk_f32 v131, v11, 0x40400000, v9
    v_mul_f32 v11, 0x3a000000, v8
    v_lshlrev_b32 v9, 31, v1
    v_xor_b32 v11, v9, v11
    v_mul_f32 v9, v11, v10
    v_mov_b32 v112, v9
    v_fmamk_f32 v113, v11, 0x3f800000, v9
    v_fmamk_f32 v114, v11, 0x40000000, v9
    v_fmamk_f32 v115, v11, 0x40400000, v9
    v_fmamk_f32 v116, v11, 0x41800000, v9
    v_fmamk_f32 v117, v11, 0x41880000, v9
    v_fmamk_f32 v118, v11, 0x41900000, v9
    v_fmamk_f32 v119, v11, 0x41980000, v9
    v_cos_f32 v104, v128
    v_sin_f32 v105, v128
    v_cos_f32 v106, v129
    v_sin_f32 v107, v129
    v_cos_f32 v108, v130
    v_sin_f32 v109, v130
    v_cos_f32 v110, v131
    v_sin_f32 v111, v131
    v_sin_f32 v120, v112
    v_sin_f32 v121, v113
    v_sin_f32 v122, v114
    v_sin_f32 v123, v115
    v_sin_f32 v124, v116
    v_sin_f32 v125, v117
    v_sin_f32 v126, v118
    v_sin_f32 v127, v119
    v_cos_f32 v112, v112
    v_cos_f32 v113, v113
    v_cos_f32 v114, v114
    v_cos_f32 v115, v115
    v_cos_f32 v116, v116
    v_cos_f32 v117, v117
    v_cos_f32 v118, v118
    v_cos_f32 v119, v119
    v_cvt_pk_f16_f32 v16, v104, v105
    v_cvt_pk_f16_f32 v17, v106, v107
    v_cvt_pk_f16_f32 v18, v108, v109
    v_cvt_pk_f16_f32 v19, v110, v111
    v_cvt_pk_f16_f32 v20, v112, v113
    v_cvt_pk_f16_f32 v21, v114, v115
    v_cvt_pk_f16_f32 v22, v116, v117
    v_cvt_pk_f16_f32 v23, v118, v119
    v_cvt_pk_f16_f32 v24, v120, v121
    v_cvt_pk_f16_f32 v25, v122, v123
    v_cvt_pk_f16_f32 v26, v124, v125
    v_cvt_pk_f16_f32 v27, v126, v127
    v_lshrrev_b32 v8, 3, v1
    v_mul_u32_u24 v222, 16512, v8
    v_and_b32 v9, 7, v1
    v_lshl_add_u32 v222, v9, 4, v222
    s_mul_i32 s60, s3, 528384
    s_lshl_b32 s32, s20, 7
    s_add_u32 s60, s60, s32
    s_add_u32 s60, s60, 0x1000
    s_add_u32 s61, s60, 132096
    s_add_u32 s16, s60, 264192
    s_add_u32 s17, s60, 396288
    v_lshlrev_b32 v8, 1, v8
    v_bfe_u32 v9, v1, 2, 1
    v_add_u32 v8, v8, v9
    s_lshl_b32 s32, s3, 2
    s_add_u32 s32, s32, 1
    v_lshl_add_u32 v8, v8, 5, s32
    v_cmp_eq_u32 vcc, 1, v12
    v_bfe_u32 v9, v1, 1, 1
    v_mul_u32_u24 v9, 8256, v9
    v_add_u32 v9, 86400, v9
    s_cmp_eq_u32 s3, 3
    s_cselect_b32 s32, 272, 0
    v_sub_u32 v10, 512, v8
    v_cndmask_b32_e64 v10, v8, v10, vcc
    v_and_b32 v11, 16, v10
    v_lshl_add_u32 v11, v11, 6, v9
    v_lshrrev_b32 v12, 7, v10
    v_lshl_add_u32 v11, v12, 8, v11
    v_and_b32 v12, 15, v10
    v_lshl_add_u32 v11, v12, 4, v11
    v_bfe_u32 v12, v10, 5, 2
    v_lshl_add_u32 v223, v12, 2, v11
    v_add_u32 v8, 1, v8
    v_sub_u32 v10, 512, v8
    v_cndmask_b32_e64 v10, v8, v10, vcc
    v_and_b32 v11, 16, v10
    v_lshl_add_u32 v11, v11, 6, v9
    v_lshrrev_b32 v12, 7, v10
    v_lshl_add_u32 v11, v12, 8, v11
    v_and_b32 v12, 15, v10
    v_lshl_add_u32 v11, v12, 4, v11
    v_bfe_u32 v12, v10, 5, 2
    v_lshl_add_u32 v224, v12, 2, v11
    v_add_u32 v8, 1, v8
    v_sub_u32 v10, 512, v8
    v_cndmask_b32_e64 v10, v8, v10, vcc
    v_and_b32 v11, 16, v10
    v_lshl_add_u32 v11, v11, 6, v9
    v_lshrrev_b32 v12, 7, v10
    v_lshl_add_u32 v11, v12, 8, v11
    v_and_b32 v12, 15, v10
    v_lshl_add_u32 v11, v12, 4, v11
    v_bfe_u32 v12, v10, 5, 2
    v_lshl_add_u32 v100, v12, 2, v11
    v_mul_u32_u24 v10, s32, v3
    v_sub_u32 v8, v8, v10
    v_add_u32 v8, 1, v8
    v_sub_u32 v10, 512, v8
    v_cndmask_b32_e64 v10, v8, v10, vcc
    v_lshrrev_b32 v11, 1, v10
    v_and_b32 v11, 256, v11
    v_sub_u32 v10, v10, v11
    v_and_b32 v11, 16, v10
    v_lshl_add_u32 v11, v11, 6, v9
    v_lshrrev_b32 v12, 7, v10
    v_lshl_add_u32 v11, v12, 8, v11
    v_and_b32 v12, 15, v10
    v_lshl_add_u32 v11, v12, 4, v11
    v_bfe_u32 v12, v10, 5, 2
    v_lshl_add_u32 v101, v12, 2, v11
    s_and_b32 s32, s3, 3
    s_lshl_b32 s32, s32, 11
    s_add_u32 s32, s32, 86400
    v_add_u32 v225, s32, v239
    v_add_u32 v8, s33, v13
    v_sub_u32 v9, 32, v8
    v_min_u32 v9, v8, v9
    v_and_b32 v10, 15, v8
    v_cmp_eq_u32 s[32:33], 0, v10
    v_cmp_lt_u32 s[34:35], 16, v8
    v_lshlrev_b32 v10, 10, v9
    v_subrev_u32 v10, 1024, v10
    v_mov_b32 v11, 15872
    v_cmp_eq_u32 vcc, 0, v8
    s_nop 1
    v_cndmask_b32_e64 v10, v10, v11, vcc
    v_and_b32 v11, 3, v1
    v_lshl_add_u32 v10, v11, 4, v10
    v_lshrrev_b32 v11, 2, v4
    v_lshlrev_b32 v12, 7, v11
    v_sub_u32 v13, 960, v12
    v_cndmask_b32_e64 v13, v12, v13, s[34:35]
    v_add_u32 v226, v10, v13
    s_or_b64 s[34:35], s[34:35], s[32:33]
    v_add_u32 v12, 512, v12
    v_sub_u32 v13, 960, v12
    v_cndmask_b32_e64 v13, v12, v13, s[34:35]
    v_add_u32 v227, v10, v13
    s_mul_i32 s56, s20, 16512
    s_add_u32 s56, s56, 0x210000
    v_mov_b32 v249, 0x30003
    v_mov_b32 v252, s44
    v_mov_b32 v253, s45
    v_mov_b32 v254, s46
    v_mov_b32 v255, s47
    s_waitcnt lgkmcnt(0)
    s_waitcnt vmcnt(0)
    s_bitcmp1_b32 s2, 2
    s_cbranch_scc1 fz_p1_ok
    s_add_u32 s32, s60, 99072
    v_mov_b32 v9, 0
fz_p1:
    buffer_load_dword v10, v9, s[4:7], s32 offen sc1
    s_waitcnt vmcnt(0)
    v_xor_b32 v10, v252, v10
    v_and_b32 v10, v249, v10
    v_cmp_ne_u32 vcc, 0, v10
    s_cbranch_vccnz fz_p1_rt
fz_p1_ok:
    s_mov_b32 s58, 0
    buffer_load_dwordx4 v[104:107], v222, s[4:7], s60 offen sc1
    buffer_load_dwordx4 v[108:111], v222, s[4:7], s61 offen sc1
    buffer_load_dwordx4 v[112:115], v222, s[4:7], s16 offen sc1
    buffer_load_dwordx4 v[116:119], v222, s[4:7], s17 offen sc1
fz_h1_c0:
    s_waitcnt vmcnt(3)
    v_xor_b32 v104, v252, v104
    v_xor_b32 v105, v253, v105
    v_xor_b32 v106, v254, v106
    v_xor_b32 v107, v255, v107
    v_or3_b32 v10, v104, v105, v106
    v_bitop3_b32 v10, v10, v107, v249 bitop3:0xa8
    v_cmp_ne_u32 vcc, 0, v10
    s_cbranch_vccnz fz_h1_r0
fz_h1_o0:
    ds_write_b32 v223, v104 offset:0
    ds_write_b32 v223, v105 offset:2048
    ds_write_b32 v223, v106 offset:4096
    ds_write_b32 v223, v107 offset:6144
fz_h1_c1:
    s_waitcnt vmcnt(2)
    v_xor_b32 v108, v252, v108
    v_xor_b32 v109, v253, v109
    v_xor_b32 v110, v254, v110
    v_xor_b32 v111, v255, v111
    v_or3_b32 v10, v108, v109, v110
    v_bitop3_b32 v10, v10, v111, v249 bitop3:0xa8
    v_cmp_ne_u32 vcc, 0, v10
    s_cbranch_vccnz fz_h1_r1
fz_h1_o1:
    ds_write_b32 v224, v108 offset:0
    ds_write_b32 v224, v109 offset:2048
    ds_write_b32 v224, v110 offset:4096
    ds_write_b32 v224, v111 offset:6144
fz_h1_c2:
    s_waitcnt vmcnt(1)
    v_xor_b32 v112, v252, v112
    v_xor_b32 v113, v253, v113
    v_xor_b32 v114, v254, v114
    v_xor_b32 v115, v255, v115
    v_or3_b32 v10, v112, v113, v114
    v_bitop3_b32 v10, v10, v115, v249 bitop3:0xa8
    v_cmp_ne_u32 vcc, 0, v10
    s_cbranch_vccnz fz_h1_r2
fz_h1_o2:
    ds_write_b32 v100, v112 offset:0
    ds_write_b32 v100, v113 offset:2048
    ds_write_b32 v100, v114 offset:4096
    ds_write_b32 v100, v115 offset:6144
fz_h1_c3:
    s_waitcnt vmcnt(0)
    v_xor_b32 v116, v252, v116
    v_xor_b32 v117, v253, v117
    v_xor_b32 v118, v254, v118
    v_xor_b32 v119, v255, v119
    v_or3_b32 v10, v116, v117, v118
    v_bitop3_b32 v10, v10, v119, v249 bitop3:0xa8
    v_cmp_ne_u32 vcc, 0, v10
    s_cbranch_vccnz fz_h1_r3
fz_h1_o3:
    ds_write_b32 v101, v116 offset:0
    ds_write_b32 v101, v117 offset:2048
    ds_write_b32 v101, v118 offset:4096
    ds_write_b32 v101, v119 offset:6144
    s_waitcnt lgkmcnt(0)
    s_setprio 0
fz_hb:
    s_barrier
    ds_read_b128 v[104:107], v225 offset:0
    ds_read_b128 v[108:111], v225 offset:1024
    ds_read_b128 v[112:115], v225 offset:8256
    ds_read_b128 v[116:119], v225 offset:9280
    ds_read_b128 v[72:75], v6 offset:14336
    ds_read_b128 v[76:79], v6 offset:15360
    ds_read_b128 v[80:83], v6 offset:16384
    ds_read_b128 v[84:87], v6 offset:17408
    s_waitcnt lgkmcnt(7)
    v_mfma_f32_16x16x32_f16 v[120:123], v[104:107], v[16:19], 0
    s_waitcnt lgkmcnt(6)
    v_mfma_f32_16x16x32_f16 v[124:127], v[108:111], v[16:19], 0
    s_waitcnt lgkmcnt(5)
    v_mfma_f32_16x16x32_f16 v[128:131], v[112:115], v[16:19], 0
    s_waitcnt lgkmcnt(4)
    v_mfma_f32_16x16x32_f16 v[132:135], v[116:119], v[16:19], 0
    s_waitcnt lgkmcnt(0)
    s_nop 0
    v_cvt_pk_f16_f32 v136, v120, v121
    v_cvt_pk_f16_f32 v137, v122, v123
    v_cvt_pk_f16_f32 v138, v124, v125
    v_cvt_pk_f16_f32 v139, v126, v127
    v_cvt_pk_f16_f32 v140, v128, v129
    v_cvt_pk_f16_f32 v141, v130, v131
    v_cvt_pk_f16_f32 v142, v132, v133
    v_cvt_pk_f16_f32 v143, v134, v135
    v_pk_mul_f16 v144, v136, v20
    v_pk_mul_f16 v145, v137, v21
    v_pk_mul_f16 v146, v138, v22
    v_pk_mul_f16 v147, v139, v23
    v_mov_b32_dpp v152, v136 quad_perm:[1,0,3,2] row_mask:0xf bank_mask:0xf
    v_mov_b32_dpp v153, v137 quad_perm:[1,0,3,2] row_mask:0xf bank_mask:0xf
    v_mov_b32_dpp v154, v138 quad_perm:[1,0,3,2] row_mask:0xf bank_mask:0xf
    v_mov_b32_dpp v155, v139 quad_perm:[1,0,3,2] row_mask:0xf bank_mask:0xf
    v_pk_fma_f16 v144, v152, v24, v144
    v_pk_fma_f16 v145, v153, v25, v145
    v_pk_fma_f16 v146, v154, v26, v146
    v_pk_fma_f16 v147, v155, v27, v147
    s_nop 1
    v_mfma_f32_16x16x32_f16 v[104:107], v[144:147], v[72:75], 0
    v_mfma_f32_16x16x32_f16 v[108:111], v[144:147], v[80:83], 0
    v_xor_b32_dpp v152, v144, v240 quad_perm:[1,0,3,2] row_mask:0xf bank_mask:0xf
    v_xor_b32_dpp v153, v145, v240 quad_perm:[1,0,3,2] row_mask:0xf bank_mask:0xf
    v_xor_b32_dpp v154, v146, v240 quad_perm:[1,0,3,2] row_mask:0xf bank_mask:0xf
    v_xor_b32_dpp v155, v147, v240 quad_perm:[1,0,3,2] row_mask:0xf bank_mask:0xf
    s_nop 1
    v_mfma_f32_16x16x32_f16 v[104:107], v[152:155], v[76:79], v[104:107]
    v_mfma_f32_16x16x32_f16 v[108:111], v[152:155], v[84:87], v[108:111]
    v_pk_mul_f16 v148, v140, v20
    v_pk_mul_f16 v149, v141, v21
    v_pk_mul_f16 v150, v142, v22
    v_pk_mul_f16 v151, v143, v23
    v_mov_b32_dpp v156, v140 quad_perm:[1,0,3,2] row_mask:0xf bank_mask:0xf
    v_mov_b32_dpp v157, v141 quad_perm:[1,0,3,2] row_mask:0xf bank_mask:0xf
    v_mov_b32_dpp v158, v142 quad_perm:[1,0,3,2] row_mask:0xf bank_mask:0xf
    v_mov_b32_dpp v159, v143 quad_perm:[1,0,3,2] row_mask:0xf bank_mask:0xf
    v_pk_fma_f16 v148, v156, v24, v148
    v_pk_fma_f16 v149, v157, v25, v149
    v_pk_fma_f16 v150, v158, v26, v150
    v_pk_fma_f16 v151, v159, v27, v151
    s_nop 1
    v_mfma_f32_16x16x32_f16 v[112:115], v[148:151], v[72:75], 0
    v_mfma_f32_16x16x32_f16 v[116:119], v[148:151], v[80:83], 0
    v_xor_b32_dpp v156, v148, v240 quad_perm:[1,0,3,2] row_mask:0xf bank_mask:0xf
    v_xor_b32_dpp v157, v149, v240 quad_perm:[1,0,3,2] row_mask:0xf bank_mask:0xf
    v_xor_b32_dpp v158, v150, v240 quad_perm:[1,0,3,2] row_mask:0xf bank_mask:0xf
    v_xor_b32_dpp v159, v151, v240 quad_perm:[1,0,3,2] row_mask:0xf bank_mask:0xf
    s_nop 1
    v_mfma_f32_16x16x32_f16 v[112:115], v[156:159], v[76:79], v[112:115]
    v_mfma_f32_16x16x32_f16 v[116:119], v[156:159], v[84:87], v[116:119]
    v_cvt_pk_f16_f32 v120, v104, v105
    v_cvt_pk_f16_f32 v122, v106, v107
    s_nop 4
    v_cvt_pk_f16_f32 v121, v112, v113
    v_cvt_pk_f16_f32 v123, v114, v115
    v_add_u32 v120, 0x20002, v120
    v_add_u32 v121, 0x20002, v121
    v_add_u32 v122, 0x20002, v122
    v_add_u32 v123, 0x20002, v123
    v_and_or_b32 v120, v120, v229, s44
    v_and_or_b32 v121, v121, v229, s45
    v_and_or_b32 v122, v122, v229, s46
    v_and_or_b32 v123, v123, v229, s47
    buffer_store_dwordx4 v[120:123], v226, s[4:7], s56 offen sc1
    v_cvt_pk_f16_f32 v124, v108, v109
    v_cvt_pk_f16_f32 v126, v110, v111
    v_cvt_pk_f16_f32 v125, v116, v117
    v_cvt_pk_f16_f32 v127, v118, v119
    v_add_u32 v124, 0x20002, v124
    v_add_u32 v125, 0x20002, v125
    v_add_u32 v126, 0x20002, v126
    v_add_u32 v127, 0x20002, v127
    v_and_or_b32 v124, v124, v229, s44
    v_and_or_b32 v125, v125, v229, s45
    v_and_or_b32 v126, v126, v229, s46
    v_and_or_b32 v127, v127, v229, s47
    buffer_store_dwordx4 v[124:127], v227, s[4:7], s56 offen sc1
    s_cmp_lg_u32 s57, 0
    s_cbranch_scc1 fz_nc3
    v_sub_u32 v8, 15, v4
    v_min_u32 v8, v4, v8
    v_and_b32 v9, 1, v8
    v_lshlrev_b32 v9, 5, v9
    v_lshrrev_b32 v10, 1, v8
    v_lshl_add_u32 v9, v10, 9, v9
    v_add_u32 v9, s25, v9
    v_sub_u32 v10, 2048, v9
    v_cmp_lt_u32 s[34:35], 7, v4
    s_nop 1
    v_cndmask_b32_e64 v230, v9, v10, s[34:35]
    v_mov_b32 v9, v4
    v_mov_b32 v10, s20
    s_cmp_lg_u32 s21, 0
    s_cbranch_scc0 fz_spec3a
fz_spec3backa:
    v_lshlrev_b32 v10, 7, v10
    v_lshl_add_u32 v10, v9, 3, v10
    v_mul_u32_u24 v11, 66048, v5
    v_add_u32 v228, v10, v11
    v_and_b32 v9, 1, v9
    v_cmp_eq_u32 vcc, 1, v9
    v_mov_b32 v9, s44
    v_mov_b32 v10, s46
    v_cndmask_b32_e64 v236, v9, v10, vcc
    v_mov_b32 v9, s45
    v_mov_b32 v10, s47
    v_cndmask_b32_e64 v237, v9, v10, vcc
    s_lshl_b32 s32, s3, 2
    v_add_u32 v8, s32, v5
    v_lshlrev_b32 v9, 6, v8
    v_cmp_gt_u32 vcc, 16, v8
    s_nop 1
    v_cndmask_b32_e64 v10, 0, 32, vcc
    v_add_u32 v10, v9, v10
    v_sub_u32 v11, 2048, v10
    v_cmp_eq_u32 vcc, 16, v8
    s_nop 1
    v_cndmask_b32_e64 v11, v11, 0, vcc
    v_mov_b32 v12, 0xffff0000
    v_cndmask_b32_e64 v238, -1, v12, vcc
    v_sub_u32 v12, 2018, v9
    v_mul_u32_u24 v13, 2064, v4
    v_add_u32 v231, v13, v9
    v_add_u32 v232, v13, v12
    v_add_u32 v233, v13, v10
    v_add_u32 v241, v13, v11
    s_lshl_b32 s32, s3, 8
    s_add_u32 s32, s32, 102912
    v_lshlrev_b32 v9, 4, v4
    v_add_u32 v10, s32, v9
    v_add_u32 v11, 107008, v239
    v_cmp_gt_u32 vcc, 16, v1
    s_nop 1
    v_cndmask_b32_e64 v243, v11, v10, vcc
    v_lshrrev_b32 v12, 2, v4
    v_cmp_eq_u32 vcc, v12, v5
    s_nop 1
    v_cndmask_b32_e64 v244, v11, v10, vcc
    v_lshrrev_b32 v12, 5, v1
    v_lshl_add_u32 v10, v12, 10, v9
    v_add_u32 v245, 102912, v10
    v_and_b32 v9, 1, v1
    v_cmp_eq_u32 s[28:29], 1, v9
    v_and_b32 v9, 2, v1
    v_cmp_eq_u32 s[30:31], 2, v9
    s_lshl_b32 s37, s3, 2
    v_add_u32 v9, s37, v5
    v_mul_u32_u24 v246, 2176, v9
    s_lshl_b32 s26, s20, 4
    s_add_u32 s26, s26, 0x580000
    v_lshlrev_b32 v247, 4, v5
    s_lshl_b32 s27, s20, 11
    s_lshl_b32 s37, s3, 8
    s_add_u32 s27, s27, s37
    s_add_u32 s27, s27, 0x448000
    v_sub_u32 v248, 2047, v230
    s_mov_b32 s14, 0x400000
    s_mov_b32 s15, 0x00020000
    s_mul_i32 s52, s3, 264192
    s_add_u32 s52, s52, 0x210000
    s_add_u32 s53, s52, 16512
    s_add_u32 s54, s52, 33024
    s_add_u32 s55, s52, 49536
    s_mov_b32 s23, s63
    s_getreg_b32 s24, hwreg(HW_REG_XCC_ID)
    s_and_b32 s24, s24, 15
    v_lshlrev_b32 v10, 4, v0
    v_min_u32 v10, 4336, v10
    v_add_u32 v10, 108032, v10
    v_mov_b32 v104, 0
    v_mov_b32 v105, 0
    v_mov_b32 v106, 0
    v_mov_b32 v107, 0
    ds_write_b128 v10, v[104:107]
    s_mov_b32 s58, 0
    s_waitcnt vmcnt(0)
    buffer_load_dwordx2 v[104:105], v228, s[4:7], s52 offen sc1
    buffer_load_dwordx2 v[106:107], v228, s[4:7], s53 offen sc1
    buffer_load_dwordx2 v[108:109], v228, s[4:7], s54 offen sc1
    buffer_load_dwordx2 v[110:111], v228, s[4:7], s55 offen sc1
    ds_read_b128 v[116:119], v231
    ds_read_b128 v[120:123], v231 offset:16
    ds_read_u16_d16_hi v44, v241
    ds_read_u16_d16_hi v45, v232 offset:28
    ds_read_u16_d16_hi v46, v232 offset:26
    ds_read_u16_d16_hi v47, v232 offset:24
    ds_read_u16_d16_hi v48, v232 offset:22
    ds_read_u16_d16_hi v49, v232 offset:20
    ds_read_u16_d16_hi v50, v232 offset:18
    ds_read_u16_d16_hi v51, v232 offset:16
    ds_read_u16_d16_hi v52, v232 offset:14
    ds_read_u16_d16_hi v53, v232 offset:12
    ds_read_u16_d16_hi v54, v232 offset:10
    ds_read_u16_d16_hi v55, v232 offset:8
    ds_read_u16_d16_hi v56, v232 offset:6
    ds_read_u16_d16_hi v57, v232 offset:4
    ds_read_u16_d16_hi v58, v232 offset:2
    ds_read_u16_d16_hi v59, v232 offset:0
    ds_read_u16_d16_hi v28, v233
    v_mul_u32_u24 v13, 2064, v4
    v_subrev_u32 v13, 104960, v13
    v_sub_u32 v9, v231, v13
    v_sub_u32 v10, v233, v13
    v_sub_u32 v11, v241, v13
    v_sub_u32 v12, v232, v13
    s_mov_b32 s36, 0xffff0000
    s_waitcnt lgkmcnt(0)
    ds_read_b128 v[200:203], v9
    ds_read_b128 v[204:207], v9 offset:16
    ds_read_u16_d16 v208, v11
    ds_read_u16_d16_hi v124, v12 offset:28
    ds_read_u16_d16 v209, v12 offset:26
    ds_read_u16_d16_hi v125, v12 offset:24
    ds_read_u16_d16 v210, v12 offset:22
    ds_read_u16_d16_hi v126, v12 offset:20
    ds_read_u16_d16 v211, v12 offset:18
    ds_read_u16_d16_hi v127, v12 offset:16
    ds_read_u16_d16 v212, v12 offset:14
    ds_read_u16_d16_hi v128, v12 offset:12
    ds_read_u16_d16 v213, v12 offset:10
    ds_read_u16_d16_hi v129, v12 offset:8
    ds_read_u16_d16 v214, v12 offset:6
    ds_read_u16_d16_hi v130, v12 offset:4
    ds_read_u16_d16 v215, v12 offset:2
    ds_read_u16_d16_hi v131, v12 offset:0
    ds_read_u16_d16 v13, v10
    v_and_b32 v29, s36, v116
    v_lshlrev_b32 v30, 16, v117
    v_and_b32 v31, s36, v117
    v_lshlrev_b32 v32, 16, v118
    v_and_b32 v33, s36, v118
    v_lshlrev_b32 v34, 16, v119
    v_and_b32 v35, s36, v119
    v_lshlrev_b32 v36, 16, v120
    v_and_b32 v37, s36, v120
    v_lshlrev_b32 v38, 16, v121
    v_and_b32 v39, s36, v121
    v_lshlrev_b32 v40, 16, v122
    v_and_b32 v41, s36, v122
    v_lshlrev_b32 v42, 16, v123
    v_and_b32 v43, s36, v123
    v_cmp_eq_u32 vcc, 1, v4
    v_mov_b32 v9, s42
    s_nop 0
    v_cndmask_b32_e64 v9, 0, v9, vcc
    v_mov_b32 v116, s42
    v_mov_b32 v117, s42
    v_mov_b32 v118, s42
    v_mov_b32 v119, s42
    v_cmp_eq_u32 vcc, 0, v4
    s_waitcnt lgkmcnt(0)
    v_and_or_b32 v200, v200, s36, v13
    v_or_b32 v208, v208, v124
    v_or_b32 v209, v209, v125
    v_or_b32 v210, v210, v126
    v_or_b32 v211, v211, v127
    v_or_b32 v212, v212, v128
    v_or_b32 v213, v213, v129
    v_or_b32 v214, v214, v130
    v_or_b32 v215, v215, v131
    v_cndmask_b32_e64 v200, v9, v200, vcc
    v_cndmask_b32_e64 v201, v9, v201, vcc
    v_cndmask_b32_e64 v202, v9, v202, vcc
    v_cndmask_b32_e64 v203, v9, v203, vcc
    v_cndmask_b32_e64 v204, v9, v204, vcc
    v_cndmask_b32_e64 v205, v9, v205, vcc
    v_cndmask_b32_e64 v206, v9, v206, vcc
    v_cndmask_b32_e64 v207, v9, v207, vcc
    v_cndmask_b32_e64 v208, v9, v208, vcc
    v_cndmask_b32_e64 v209, v9, v209, vcc
    v_cndmask_b32_e64 v210, v9, v210, vcc
    v_cndmask_b32_e64 v211, v9, v211, vcc
    v_cndmask_b32_e64 v212, v9, v212, vcc
    v_cndmask_b32_e64 v213, v9, v213, vcc
    v_cndmask_b32_e64 v214, v9, v214, vcc
    v_cndmask_b32_e64 v215, v9, v215, vcc
    v_mfma_f32_16x16x32_bf16 v[120:123], v[200:203], v[116:119], 0
    v_mfma_f32_16x16x32_bf16 v[120:123], v[204:207], v[116:119], v[120:123]
    v_mfma_f32_16x16x32_bf16 v[120:123], v[208:211], v[116:119], v[120:123]
    v_mfma_f32_16x16x32_bf16 v[120:123], v[212:215], v[116:119], v[120:123]
    s_nop 7
    ds_write_b32 v243, v120 offset:12
    s_branch fz_h2c
fz_h2:
    buffer_load_dwordx2 v[104:105], v228, s[4:7], s52 offen sc1
    buffer_load_dwordx2 v[106:107], v228, s[4:7], s53 offen sc1
    buffer_load_dwordx2 v[108:109], v228, s[4:7], s54 offen sc1
    buffer_load_dwordx2 v[110:111], v228, s[4:7], s55 offen sc1
fz_h2c:
    s_mov_b32 s36, 0x43000000
fz_h2_c0:
    s_waitcnt vmcnt(3)
    v_xor_b32 v104, v236, v104
    v_xor_b32 v105, v237, v105
    v_bitop3_b32 v9, v104, v105, v249 bitop3:0xa8
    v_cmp_ne_u32 vcc, 0, v9
    s_cbranch_vccnz fz_h2_r0
fz_h2_o0:
    v_mov_b32_dpp v112, v104 row_mirror row_mask:0xf bank_mask:0xf
    v_mov_b32_dpp v113, v105 row_mirror row_mask:0xf bank_mask:0xf
    s_cmp_eq_u32 s2, 66
    s_cbranch_scc1 fz_spec40
fz_spec4back0:
    v_fma_mix_f32 v28, v104, s36, v28 op_sel:[0,0,0] op_sel_hi:[1,0,0]
    v_fma_mix_f32 v29, v104, s36, v29 op_sel:[1,0,0] op_sel_hi:[1,0,0]
    v_fma_mix_f32 v30, v105, s36, v30 op_sel:[0,0,0] op_sel_hi:[1,0,0]
    v_fma_mix_f32 v31, v105, s36, v31 op_sel:[1,0,0] op_sel_hi:[1,0,0]
    v_and_b32 v112, v238, v112
    v_fma_mix_f32 v44, v112, s36, v44 op_sel:[0,0,0] op_sel_hi:[1,0,0]
    v_fma_mix_f32 v45, v112, s36, v45 op_sel:[1,0,0] op_sel_hi:[1,0,0]
    v_fma_mix_f32 v46, v113, s36, v46 op_sel:[0,0,0] op_sel_hi:[1,0,0]
    v_fma_mix_f32 v47, v113, s36, v47 op_sel:[1,0,0] op_sel_hi:[1,0,0]
    v_cvt_pk_bf16_f32 v120, v28, v29
    v_cvt_pk_bf16_f32 v121, v30, v31
    v_cvt_pk_bf16_f32 v128, v44, v45
    v_cvt_pk_bf16_f32 v129, v46, v47
fz_h2_c1:
    s_waitcnt vmcnt(2)
    v_xor_b32 v106, v236, v106
    v_xor_b32 v107, v237, v107
    v_bitop3_b32 v9, v106, v107, v249 bitop3:0xa8
    v_cmp_ne_u32 vcc, 0, v9
    s_cbranch_vccnz fz_h2_r1
fz_h2_o1:
    v_mov_b32_dpp v114, v106 row_mirror row_mask:0xf bank_mask:0xf
    v_mov_b32_dpp v115, v107 row_mirror row_mask:0xf bank_mask:0xf
    s_cmp_eq_u32 s2, 66
    s_cbranch_scc1 fz_spec41
fz_spec4back1:
    v_fma_mix_f32 v32, v106, s36, v32 op_sel:[0,0,0] op_sel_hi:[1,0,0]
    v_fma_mix_f32 v33, v106, s36, v33 op_sel:[1,0,0] op_sel_hi:[1,0,0]
    v_fma_mix_f32 v34, v107, s36, v34 op_sel:[0,0,0] op_sel_hi:[1,0,0]
    v_fma_mix_f32 v35, v107, s36, v35 op_sel:[1,0,0] op_sel_hi:[1,0,0]
    v_fma_mix_f32 v48, v114, s36, v48 op_sel:[0,0,0] op_sel_hi:[1,0,0]
    v_fma_mix_f32 v49, v114, s36, v49 op_sel:[1,0,0] op_sel_hi:[1,0,0]
    v_fma_mix_f32 v50, v115, s36, v50 op_sel:[0,0,0] op_sel_hi:[1,0,0]
    v_fma_mix_f32 v51, v115, s36, v51 op_sel:[1,0,0] op_sel_hi:[1,0,0]
    v_cvt_pk_bf16_f32 v122, v32, v33
    v_cvt_pk_bf16_f32 v123, v34, v35
    v_cvt_pk_bf16_f32 v130, v48, v49
    v_cvt_pk_bf16_f32 v131, v50, v51
    v_mfma_f32_16x16x32_bf16 v[136:139], v[120:123], v[120:123], 0
    v_mfma_f32_16x16x32_bf16 v[140:143], v[200:203], v[120:123], 0
    v_mfma_f32_16x16x32_bf16 v[136:139], v[128:131], v[128:131], v[136:139]
    v_mfma_f32_16x16x32_bf16 v[140:143], v[208:211], v[128:131], v[140:143]
fz_h2_c2:
    s_waitcnt vmcnt(1)
    v_xor_b32 v108, v236, v108
    v_xor_b32 v109, v237, v109
    v_bitop3_b32 v9, v108, v109, v249 bitop3:0xa8
    v_cmp_ne_u32 vcc, 0, v9
    s_cbranch_vccnz fz_h2_r2
fz_h2_o2:
    v_mov_b32_dpp v116, v108 row_mirror row_mask:0xf bank_mask:0xf
    v_mov_b32_dpp v117, v109 row_mirror row_mask:0xf bank_mask:0xf
    s_cmp_eq_u32 s2, 66
    s_cbranch_scc1 fz_spec42
fz_spec4back2:
    v_fma_mix_f32 v36, v108, s36, v36 op_sel:[0,0,0] op_sel_hi:[1,0,0]
    v_fma_mix_f32 v37, v108, s36, v37 op_sel:[1,0,0] op_sel_hi:[1,0,0]
    v_fma_mix_f32 v38, v109, s36, v38 op_sel:[0,0,0] op_sel_hi:[1,0,0]
    v_fma_mix_f32 v39, v109, s36, v39 op_sel:[1,0,0] op_sel_hi:[1,0,0]
    v_fma_mix_f32 v52, v116, s36, v52 op_sel:[0,0,0] op_sel_hi:[1,0,0]
    v_fma_mix_f32 v53, v116, s36, v53 op_sel:[1,0,0] op_sel_hi:[1,0,0]
    v_fma_mix_f32 v54, v117, s36, v54 op_sel:[0,0,0] op_sel_hi:[1,0,0]
    v_fma_mix_f32 v55, v117, s36, v55 op_sel:[1,0,0] op_sel_hi:[1,0,0]
    v_cvt_pk_bf16_f32 v124, v36, v37
    v_cvt_pk_bf16_f32 v125, v38, v39
    v_cvt_pk_bf16_f32 v132, v52, v53
    v_cvt_pk_bf16_f32 v133, v54, v55
fz_h2_c3:
    s_waitcnt vmcnt(0)
    v_xor_b32 v110, v236, v110
    v_xor_b32 v111, v237, v111
    v_bitop3_b32 v9, v110, v111, v249 bitop3:0xa8
    v_cmp_ne_u32 vcc, 0, v9
    s_cbranch_vccnz fz_h2_r3
fz_h2_o3:
    v_mov_b32_dpp v118, v110 row_mirror row_mask:0xf bank_mask:0xf
    v_mov_b32_dpp v119, v111 row_mirror row_mask:0xf bank_mask:0xf
    s_cmp_eq_u32 s2, 66
    s_cbranch_scc1 fz_spec43
fz_spec4back3:
    v_fma_mix_f32 v40, v110, s36, v40 op_sel:[0,0,0] op_sel_hi:[1,0,0]
    v_fma_mix_f32 v41, v110, s36, v41 op_sel:[1,0,0] op_sel_hi:[1,0,0]
    v_fma_mix_f32 v42, v111, s36, v42 op_sel:[0,0,0] op_sel_hi:[1,0,0]
    v_fma_mix_f32 v43, v111, s36, v43 op_sel:[1,0,0] op_sel_hi:[1,0,0]
    v_fma_mix_f32 v56, v118, s36, v56 op_sel:[0,0,0] op_sel_hi:[1,0,0]
    v_fma_mix_f32 v57, v118, s36, v57 op_sel:[1,0,0] op_sel_hi:[1,0,0]
    v_fma_mix_f32 v58, v119, s36, v58 op_sel:[0,0,0] op_sel_hi:[1,0,0]
    v_fma_mix_f32 v59, v119, s36, v59 op_sel:[1,0,0] op_sel_hi:[1,0,0]
    v_cvt_pk_bf16_f32 v126, v40, v41
    v_cvt_pk_bf16_f32 v127, v42, v43
    v_cvt_pk_bf16_f32 v134, v56, v57
    v_cvt_pk_bf16_f32 v135, v58, v59
    v_mfma_f32_16x16x32_bf16 v[136:139], v[124:127], v[124:127], v[136:139]
    v_mfma_f32_16x16x32_bf16 v[140:143], v[204:207], v[124:127], v[140:143]
    v_mfma_f32_16x16x32_bf16 v[136:139], v[132:135], v[132:135], v[136:139]
    v_mfma_f32_16x16x32_bf16 v[140:143], v[212:215], v[132:135], v[140:143]
    s_nop 6
    v_cndmask_b32_e64 v9, v136, v137, s[28:29]
    v_cndmask_b32_e64 v10, v138, v139, s[28:29]
    ds_write_b64 v243, v[140:141]
    v_cndmask_b32_e64 v9, v9, v10, s[30:31]
    ds_write_b32 v244, v9 offset:8
    s_cmp_gt_u32 s3, 3
    s_cbranch_scc1 fz_lp
    s_setprio 2
fz_lp:
    s_waitcnt lgkmcnt(0)
    s_barrier
    ds_read_b128 v[144:147], v245 offset:0
    ds_read_b128 v[148:151], v245 offset:256
    ds_read_b128 v[152:155], v245 offset:512
    ds_read_b128 v[156:159], v245 offset:768
    s_waitcnt lgkmcnt(2)
    v_pk_add_f32 v[144:145], v[144:145], v[148:149]
    v_pk_add_f32 v[146:147], v[146:147], v[150:151]
    s_waitcnt lgkmcnt(0)
    v_pk_add_f32 v[152:153], v[152:153], v[156:157]
    v_pk_add_f32 v[154:155], v[154:155], v[158:159]
    v_pk_add_f32 v[144:145], v[144:145], v[152:153]
    v_pk_add_f32 v[146:147], v[146:147], v[154:155]
    v_mov_b32 v148, v144
    v_mov_b32 v149, v145
    v_mov_b32 v150, v146
    v_mov_b32 v151, v147
    v_permlane32_swap_b32 v144, v148
    v_permlane32_swap_b32 v145, v149
    v_permlane32_swap_b32 v146, v150
    v_permlane32_swap_b32 v147, v151
    v_pk_add_f32 v[144:145], v[144:145], v[148:149]
    v_pk_add_f32 v[146:147], v[146:147], v[150:151]
    v_mul_f32 v145, 0xba800000, v145
    v_mul_f32 v146, 0x3a800000, v146
    v_fma_f32 v146, -v145, v145, v146
    v_cvt_pk_bf16_f32 v153, 0, v145
    v_cvt_pk_bf16_f32 v146, 0, v146
    v_add_f32 v146, 0x3727c5ac, v146
    v_cvt_pk_bf16_f32 v146, 0, v146
    v_sqrt_f32 v146, v146
    v_fmac_f32 v144, v153, v147
    v_cvt_pk_bf16_f32 v146, 0, v146
    v_rcp_f32 v154, v146
    v_mov_b32 v155, s40
    v_mul_f32 v144, v144, v154
    v_cvt_pk_bf16_f32 v144, 0, v144
    v_ashrrev_i32 v145, 31, v144
    v_or_b32 v145, 0x80000000, v145
    v_bitop3_b32 v152, v144, v145, v242 bitop3:0x28
    v_or_b32 v152, v152, v248
    s_nop 1
    v_max_u32_dpp v144, v152, v152 row_ror:1 row_mask:0xf bank_mask:0xf
    s_nop 1
    v_max_u32_dpp v144, v144, v144 row_ror:2 row_mask:0xf bank_mask:0xf
    s_nop 1
    v_max_u32_dpp v144, v144, v144 row_ror:4 row_mask:0xf bank_mask:0xf
    s_nop 1
    v_max_u32_dpp v144, v144, v144 row_ror:8 row_mask:0xf bank_mask:0xf
    v_cmp_eq_u32 vcc, v144, v152
    v_or_b32 v153, s24, v153
    s_nop 0
    s_mov_b64 exec, vcc
    buffer_store_dwordx4 v[152:155], v246, s[4:7], s26 offen sc1
    s_add_u32 s26, s26, 69632
    buffer_store_dwordx4 v[152:155], v246, s[4:7], s26 offen sc1
    buffer_store_dwordx4 v[120:123], v247, s[4:7], s27 offen offset:0 sc1
    buffer_store_dwordx4 v[124:127], v247, s[4:7], s27 offen offset:64 sc1
    buffer_store_dwordx4 v[128:131], v247, s[4:7], s27 offen offset:128 sc1
    buffer_store_dwordx4 v[132:135], v247, s[4:7], s27 offen offset:192 sc1
    s_mov_b64 exec, -1
    s_setprio 0
    s_ff1_i32_b64 s37, vcc
    v_add_f32 v144, 1.0, v154
    v_and_b32 v146, v242, v153
    v_mul_f32 v146, v146, v154
    v_pk_fma_f32 v[28:29], v[28:29], v[144:145], v[146:147] op_sel_hi:[1,0,0]
    v_pk_fma_f32 v[30:31], v[30:31], v[144:145], v[146:147] op_sel_hi:[1,0,0]
    v_pk_fma_f32 v[32:33], v[32:33], v[144:145], v[146:147] op_sel_hi:[1,0,0]
    v_pk_fma_f32 v[34:35], v[34:35], v[144:145], v[146:147] op_sel_hi:[1,0,0]
    v_pk_fma_f32 v[36:37], v[36:37], v[144:145], v[146:147] op_sel_hi:[1,0,0]
    v_pk_fma_f32 v[38:39], v[38:39], v[144:145], v[146:147] op_sel_hi:[1,0,0]
    v_pk_fma_f32 v[40:41], v[40:41], v[144:145], v[146:147] op_sel_hi:[1,0,0]
    v_pk_fma_f32 v[42:43], v[42:43], v[144:145], v[146:147] op_sel_hi:[1,0,0]
    v_pk_fma_f32 v[44:45], v[44:45], v[144:145], v[146:147] op_sel_hi:[1,0,0]
    v_pk_fma_f32 v[46:47], v[46:47], v[144:145], v[146:147] op_sel_hi:[1,0,0]
    v_pk_fma_f32 v[48:49], v[48:49], v[144:145], v[146:147] op_sel_hi:[1,0,0]
    v_pk_fma_f32 v[50:51], v[50:51], v[144:145], v[146:147] op_sel_hi:[1,0,0]
    v_pk_fma_f32 v[52:53], v[52:53], v[144:145], v[146:147] op_sel_hi:[1,0,0]
    v_pk_fma_f32 v[54:55], v[54:55], v[144:145], v[146:147] op_sel_hi:[1,0,0]
    v_pk_fma_f32 v[56:57], v[56:57], v[144:145], v[146:147] op_sel_hi:[1,0,0]
    v_pk_fma_f32 v[58:59], v[58:59], v[144:145], v[146:147] op_sel_hi:[1,0,0]
    v_cvt_pk_bf16_f32 v104, v28, v29
    v_cvt_pk_bf16_f32 v105, v30, v31
    v_cvt_pk_bf16_f32 v106, v32, v33
    v_cvt_pk_bf16_f32 v107, v34, v35
    v_cvt_pk_bf16_f32 v108, v36, v37
    v_cvt_pk_bf16_f32 v109, v38, v39
    v_cvt_pk_bf16_f32 v110, v40, v41
    v_cvt_pk_bf16_f32 v111, v42, v43
    v_cvt_pk_bf16_f32 v112, v44, v45
    v_cvt_pk_bf16_f32 v113, v46, v47
    v_cvt_pk_bf16_f32 v114, v48, v49
    v_cvt_pk_bf16_f32 v115, v50, v51
    v_cvt_pk_bf16_f32 v116, v52, v53
    v_cvt_pk_bf16_f32 v117, v54, v55
    v_cvt_pk_bf16_f32 v118, v56, v57
    v_cvt_pk_bf16_f32 v119, v58, v59
    ds_write_b128 v231, v[104:107]
    ds_write_b128 v231, v[108:111] offset:16
    s_waitcnt lgkmcnt(0)
    s_barrier
    s_cmp_lt_u32 s3, 4
    s_cbranch_scc1 fz_now4
    buffer_load_dwordx4 v[192:195], v14, s[64:67], s62 offen offset:0 nt
    buffer_load_dwordx4 v[196:199], v14, s[64:67], s62 offen offset:256 nt
    s_add_u32 s62, s62, 8192
    buffer_load_dwordx4 v[60:63], v14, s[64:67], s62 offen offset:0 nt
    buffer_load_dwordx4 v[64:67], v14, s[64:67], s62 offen offset:256 nt
    s_add_u32 s62, s62, 8192
    buffer_load_dwordx4 v[68:71], v14, s[64:67], s62 offen offset:0 nt
    buffer_load_dwordx4 v[88:91], v14, s[64:67], s62 offen offset:256 nt
    s_add_u32 s62, s62, 8192
    buffer_load_dwordx4 v[92:95], v14, s[64:67], s62 offen offset:0 nt
    buffer_load_dwordx4 v[96:99], v14, s[64:67], s62 offen offset:256 nt
fz_now4:
    ds_write_b16 v233, v104
    ds_write_b16 v241, v112
    ds_write_b16_d16_hi v232, v112 offset:28
    ds_write_b16 v232, v113 offset:26
    ds_write_b16_d16_hi v232, v113 offset:24
    ds_write_b16 v232, v114 offset:22
    ds_write_b16_d16_hi v232, v114 offset:20
    ds_write_b16 v232, v115 offset:18
    ds_write_b16_d16_hi v232, v115 offset:16
    ds_write_b16 v232, v116 offset:14
    ds_write_b16_d16_hi v232, v116 offset:12
    ds_write_b16 v232, v117 offset:10
    ds_write_b16_d16_hi v232, v117 offset:8
    ds_write_b16 v232, v118 offset:6
    ds_write_b16_d16_hi v232, v118 offset:4
    ds_write_b16 v232, v119 offset:2
    ds_write_b16_d16_hi v232, v119 offset:0
    s_lshl_b32 s32, s3, 1
    s_add_u32 s33, s32, 1
    v_readlane_b32 s34, v230, s32
    v_readlane_b32 s35, v230, s33
    s_mul_i32 s38, s3, 4128
    v_add_u32 v9, s38, v239
    s_lshl_b32 s34, s34, 11
    s_lshl_b32 s35, s35, 11
    s_waitcnt lgkmcnt(0)
    s_barrier
    ds_read_b128 v[104:107], v9 offset:0
    ds_read_b128 v[108:111], v9 offset:1024
    ds_read_b128 v[112:115], v9 offset:2064
    ds_read_b128 v[116:119], v9 offset:3088
    s_lshr_b32 s59, s37, 1
    s_xor_b32 s18, s59, 1
    s_and_b32 s18, s18, 3
    s_cmp_lt_u32 s23, 112
    s_cselect_b32 s38, s18, 8
    s_cmp_eq_u32 s38, s3
    s_cbranch_scc1 fz_sk1
    s_cmp_eq_u32 s59, s3
    s_cbranch_scc1 fz_sk1
    s_waitcnt lgkmcnt(0)
    s_cmp_eq_u32 s37, s32
    s_cbranch_scc1 fz_sk0
    buffer_store_dwordx4 v[104:107], v239, s[12:15], s34 offen offset:0 sc1
    buffer_store_dwordx4 v[108:111], v239, s[12:15], s34 offen offset:1024 sc1
fz_sk0:
    s_cmp_eq_u32 s37, s33
    s_cbranch_scc1 fz_sk1
    buffer_store_dwordx4 v[112:115], v239, s[12:15], s35 offen offset:0 sc1
    buffer_store_dwordx4 v[116:119], v239, s[12:15], s35 offen offset:1024 sc1
fz_sk1:
    v_and_b32 v15, 7, v4
    v_mul_u32_u24 v15, 544, v15
    v_lshl_add_u32 v15, v5, 4, v15
    v_add_u32 v15, 108032, v15
    s_lshl_b32 s63, s23, 5
    s_and_b32 s38, s3, 3
    s_mul_i32 s38, s38, 118784
    s_add_u32 s63, s63, s38
    s_add_u32 s63, s63, 0x4c8000
    v_lshrrev_b32 v13, 1, v1
    v_mul_u32_u24 v13, 3712, v13
    v_and_b32 v14, 1, v1
    v_lshl_add_u32 v102, v14, 4, v13
    v_add_u32 v103, 59392, v102
    s_lshl_b32 s38, s20, 5
    s_add_u32 s38, s38, 0x548000
    s_cmp_lt_u32 s3, 4
    s_cselect_b32 s63, s38, s63
    v_mov_b32 v14, 0xffffff00
    s_cmp_eq_u32 s18, s3
    s_cbranch_scc1 fz_act
    s_cmp_lg_u32 s59, s3
    s_cbranch_scc1 fz_f2
    s_and_b32 s38, s20, 15
    s_add_u32 s38, s38, 16
    s_mul_i32 s38, s38, 2176
    s_add_u32 s38, s38, 0x580000
    s_lshr_b32 s52, s20, 4
    s_lshl_b32 s52, s52, 7
    s_and_b32 s53, s20, 7
    s_lshl_b32 s53, s53, 4
    s_add_u32 s52, s52, s53
    s_bfe_u32 s53, s20, 0x10003
    s_lshl_b32 s53, s53, 2
    s_add_u32 s52, s52, s53
    v_and_b32 v2, 1, v1
    v_lshl_add_u32 v2, v2, 3, v5
    v_add_u32 v2, s52, v2
    v_and_b32 v3, 31, v2
    v_lshrrev_b32 v6, 5, v2
    v_cmp_gt_u32 vcc, 16, v6
    v_cmp_lt_u32 s[52:53], 16, v3
    v_cmp_eq_u32 s[54:55], 0, v3
    s_nop 1
    s_and_b64 s[54:55], s[54:55], vcc
    s_or_b64 s[52:53], s[52:53], s[54:55]
    v_cmp_eq_u32 s[54:55], 16, v3
    s_nop 1
    s_andn2_b64 s[54:55], s[54:55], vcc
    s_or_b64 s[52:53], s[52:53], s[54:55]
    v_sub_u32 v7, 1024, v2
    v_cndmask_b32_e64 v7, v2, v7, s[52:53]
    v_mov_b32 v8, 512
    v_cmp_eq_u32 vcc, 1024, v7
    s_nop 1
    v_cndmask_b32_e64 v7, v7, v8, vcc
    v_lshrrev_b32 v8, 5, v7
    v_and_b32 v7, 15, v7
    v_lshrrev_b32 v9, 2, v8
    v_lshlrev_b32 v9, 8, v9
    v_and_b32 v8, 3, v8
    v_lshl_add_u32 v9, v8, 4, v9
    v_lshrrev_b32 v8, 3, v7
    v_lshl_add_u32 v9, v8, 6, v9
    v_and_b32 v7, 7, v7
    v_lshl_add_u32 v9, v7, 1, v9
    v_cndmask_b32_e64 v7, 0, 1, s[52:53]
    v_lshl_add_u32 v9, v7, 7, v9
    v_lshlrev_b32 v2, 1, v2
    v_lshrrev_b32 v3, 1, v1
    v_mul_u32_u24 v3, 32, v3
    v_and_b32 v6, 1, v1
    v_lshl_add_u32 v3, v6, 4, v3
    v_mov_b32 v6, 0x7fffffff
    v_cmp_gt_u32 vcc, 32, v1
    s_nop 1
    v_cndmask_b32_e64 v6, v6, v3, vcc
    v_mov_b32 v7, s48
    v_cndmask_b32_e64 v16, 0, v7, vcc
    v_mov_b32 v7, s49
    v_cndmask_b32_e64 v17, 0, v7, vcc
    v_mov_b32 v7, s50
    v_cndmask_b32_e64 v18, 0, v7, vcc
    v_mov_b32 v7, s51
    v_cndmask_b32_e64 v19, 0, v7, vcc
    s_mul_i32 s52, s20, 3712
    s_add_u32 s52, s52, 0x4c8000
    s_add_u32 s53, s52, 1024
    s_add_u32 s54, s52, 2048
    s_add_u32 s55, s52, 3072
    v_lshlrev_b32 v20, 4, v1
    v_add_u32 v21, 1024, v20
    s_mov_b32 s58, 0
    s_nop 3
fz_k2:
    buffer_load_dwordx4 v[24:27], v20, s[4:7], s38 offen sc1
    buffer_load_dwordx4 v[28:31], v21, s[4:7], s38 offen sc1
    s_waitcnt vmcnt(0)
    v_xor_b32 v32, s40, v27
    v_xor_b32 v33, s40, v31
    v_max_u32 v34, v24, v28
    v_or_b32 v32, v32, v33
    v_cmp_ne_u32 vcc, 0, v32
    s_cbranch_vccnz fz_k2_rt
fz_k2_ok:
    v_max_u32_dpp v34, v34, v34 quad_perm:[1,0,3,2] row_mask:0xf bank_mask:0xf
    s_nop 1
    v_max_u32_dpp v34, v34, v34 quad_perm:[2,3,0,1] row_mask:0xf bank_mask:0xf
    s_nop 1
    v_max_u32_dpp v34, v34, v34 row_half_mirror row_mask:0xf bank_mask:0xf
    s_nop 1
    v_max_u32_dpp v34, v34, v34 row_mirror row_mask:0xf bank_mask:0xf
    s_nop 1
    v_max_u32_dpp v34, v34, v34 row_bcast:15 row_mask:0xa bank_mask:0xf
    s_nop 1
    v_max_u32_dpp v34, v34, v34 row_bcast:31 row_mask:0xc bank_mask:0xf
    s_nop 0
    v_readlane_b32 s36, v34, 63
    s_nop 1
    v_cmp_eq_u32 vcc, s36, v24
    v_cmp_eq_u32 s[56:57], s36, v28
    s_nop 1
    v_cndmask_b32_e64 v25, v25, v29, s[56:57]
    v_cndmask_b32_e64 v26, v26, v30, s[56:57]
    s_cmp_lg_u64 vcc, 0
    s_cselect_b32 s39, 0, 64
    s_or_b64 vcc, vcc, s[56:57]
    s_ff1_i32_b64 s41, vcc
    v_readlane_b32 s42, v25, s41
    v_readlane_b32 s43, v26, s41
    s_add_u32 s39, s39, s41
    s_and_b32 s42, s42, 0xffff0000
    s_cmp_eq_u32 s39, s20
    s_cselect_b32 s19, s37, 16
    s_lshl_b32 s39, s39, 11
    s_add_u32 s39, s39, 0x448000
    s_mov_b32 s58, 0
    s_mov_b32 s41, 0xffff0000
    s_nop 0
fz_c2:
    buffer_load_short_d16_hi v10, v9, s[4:7], s39 offen sc1
    s_waitcnt vmcnt(0)
    v_cmp_eq_u32 vcc, s41, v10
    s_cbranch_vccnz fz_c2_rt
fz_c2_ok:
    s_cmp_eq_u32 s19, s32
    s_cbranch_scc1 fz_sc0
    buffer_store_dwordx4 v[104:107], v239, s[12:15], s34 offen offset:0 sc1
    buffer_store_dwordx4 v[108:111], v239, s[12:15], s34 offen offset:1024 sc1
fz_sc0:
    s_cmp_eq_u32 s19, s33
    s_cbranch_scc1 fz_sc1
    buffer_store_dwordx4 v[112:115], v239, s[12:15], s35 offen offset:0 sc1
    buffer_store_dwordx4 v[116:119], v239, s[12:15], s35 offen offset:1024 sc1
fz_sc1:
    v_add_f32 v11, s42, v10
    v_cvt_pk_bf16_f32 v11, 0, v11
    v_mul_f32 v11, s43, v11
    v_cvt_pk_bf16_f32 v11, 0, v11
    s_ashr_i32 s39, s36, 31
    s_not_b32 s39, s39
    s_or_b32 s39, s39, 0x80000000
    s_xor_b32 s39, s36, s39
    s_and_b32 s39, s39, 0xffff0000
    v_mov_b32 v12, s39
    v_mul_f32 v12, 0xbfb8aa3b, v12
    v_exp_f32 v12, v12
    s_nop 0
    v_add_f32 v12, 1.0, v12
    v_rcp_f32 v12, v12
    s_nop 0
    v_cvt_pk_bf16_f32 v12, 0, v12
    s_and_b32 s39, s36, 0xffff
    s_sub_u32 s39, 2047, s39
    s_lshl_b32 s39, s39, 11
    v_mov_b32 v13, 0xff
    s_waitcnt lgkmcnt(0)
fz_f2:
    s_cmp_gt_u32 s23, 111
    s_cbranch_scc1 fz_nof2
    s_barrier
    s_cmp_eq_u32 s59, s3
    s_cselect_b32 s19, 4, s3
    s_cmp_lt_u32 s19, 4
    s_cbranch_scc1 fz_f2d
    ds_read_b128 v[120:123], v15 offset:0
    ds_read_b128 v[124:127], v15 offset:64
    ds_read_b128 v[128:131], v15 offset:128
    ds_read_b128 v[132:135], v15 offset:192
    ds_read_b128 v[136:139], v15 offset:256
    ds_read_b128 v[140:143], v15 offset:320
    ds_read_b128 v[144:147], v15 offset:384
    ds_read_b128 v[148:151], v15 offset:448
    s_waitcnt vmcnt(2)
    s_waitcnt lgkmcnt(7)
    v_mfma_f32_16x16x32_bf16 v[152:155], v[120:123], v[160:163], 0
    v_mfma_f32_16x16x32_bf16 v[156:159], v[120:123], v[164:167], 0
    s_waitcnt lgkmcnt(6)
    v_mfma_f32_16x16x32_bf16 v[152:155], v[124:127], v[168:171], v[152:155]
    v_mfma_f32_16x16x32_bf16 v[156:159], v[124:127], v[172:175], v[156:159]
    s_waitcnt lgkmcnt(5)
    v_mfma_f32_16x16x32_bf16 v[152:155], v[128:131], v[176:179], v[152:155]
    v_mfma_f32_16x16x32_bf16 v[156:159], v[128:131], v[180:183], v[156:159]
    s_waitcnt lgkmcnt(4)
    v_mfma_f32_16x16x32_bf16 v[152:155], v[132:135], v[184:187], v[152:155]
    v_mfma_f32_16x16x32_bf16 v[156:159], v[132:135], v[188:191], v[156:159]
    s_waitcnt lgkmcnt(3)
    v_mfma_f32_16x16x32_bf16 v[152:155], v[136:139], v[192:195], v[152:155]
    v_mfma_f32_16x16x32_bf16 v[156:159], v[136:139], v[196:199], v[156:159]
    s_waitcnt lgkmcnt(2)
    v_mfma_f32_16x16x32_bf16 v[152:155], v[140:143], v[60:63], v[152:155]
    v_mfma_f32_16x16x32_bf16 v[156:159], v[140:143], v[64:67], v[156:159]
    s_waitcnt lgkmcnt(1)
    v_mfma_f32_16x16x32_bf16 v[152:155], v[144:147], v[68:71], v[152:155]
    v_mfma_f32_16x16x32_bf16 v[156:159], v[144:147], v[88:91], v[156:159]
    s_waitcnt lgkmcnt(0)
    v_mfma_f32_16x16x32_bf16 v[152:155], v[148:151], v[92:95], v[152:155]
    v_mfma_f32_16x16x32_bf16 v[156:159], v[148:151], v[96:99], v[156:159]
    s_mov_b32 exec_hi, 0
    s_nop 5
    v_and_or_b32 v152, v152, v14, s48
    v_and_or_b32 v153, v153, v14, s49
    v_and_or_b32 v154, v154, v14, s50
    v_and_or_b32 v155, v155, v14, s51
    buffer_store_dwordx4 v[152:155], v102, s[4:7], s63 offen sc1
    v_and_or_b32 v156, v156, v14, s48
    v_and_or_b32 v157, v157, v14, s49
    v_and_or_b32 v158, v158, v14, s50
    v_and_or_b32 v159, v159, v14, s51
    buffer_store_dwordx4 v[156:159], v103, s[4:7], s63 offen sc1
fz_f2d:
    s_mov_b32 exec_hi, -1
    s_cmp_eq_u32 s18, s3
    s_cbranch_scc1 fz_late
    s_cmp_lg_u32 s59, s3
    s_cbranch_scc1 fz_xend
    v_mov_b32 v7, 0
    s_waitcnt vmcnt(0)
    s_branch fz_p5_ok
    s_nop 2
fz_nof2:
    s_cmp_lg_u32 s59, s3
    s_cbranch_scc1 fz_xend
    s_mov_b32 s58, 0
    s_and_b32 s41, s20, 63
    s_mul_i32 s41, s41, 32
    s_add_u32 s41, s41, s52
    v_mov_b32 v7, 0
    s_nop 4
fz_p5:
    buffer_load_dword v8, v7, s[4:7], s41 offen sc1
    s_waitcnt vmcnt(0)
    v_and_b32 v8, 0xff, v8
    v_cmp_ne_u32 vcc, s48, v8
    s_cbranch_vccnz fz_p5_rt
fz_p5_ok:
    s_mov_b32 s58, 0
    buffer_load_dwordx4 v[40:43], v3, s[4:7], s52 offen sc1
    buffer_load_dwordx4 v[44:47], v3, s[4:7], s53 offen sc1
    buffer_load_dwordx4 v[48:51], v3, s[4:7], s54 offen sc1
    buffer_load_dwordx4 v[52:55], v6, s[4:7], s55 offen sc1
fz_h5_c0:
    s_waitcnt vmcnt(3)
    v_xor_b32 v40, s48, v40
    v_xor_b32 v41, s49, v41
    v_xor_b32 v42, s50, v42
    v_xor_b32 v43, s51, v43
    v_or3_b32 v8, v40, v41, v42
    v_bitop3_b32 v8, v8, v43, v13 bitop3:0xa8
    v_cmp_ne_u32 vcc, 0, v8
    s_cbranch_vccnz fz_h5_r0
fz_h5_o0:
fz_h5_c1:
    s_waitcnt vmcnt(2)
    v_xor_b32 v44, s48, v44
    v_xor_b32 v45, s49, v45
    v_xor_b32 v46, s50, v46
    v_xor_b32 v47, s51, v47
    v_or3_b32 v8, v44, v45, v46
    v_bitop3_b32 v8, v8, v47, v13 bitop3:0xa8
    v_cmp_ne_u32 vcc, 0, v8
    s_cbranch_vccnz fz_h5_r1
fz_h5_o1:
    v_pk_add_f32 v[40:41], v[40:41], v[44:45]
    v_pk_add_f32 v[42:43], v[42:43], v[46:47]
fz_h5_c2:
    s_waitcnt vmcnt(1)
    v_xor_b32 v48, s48, v48
    v_xor_b32 v49, s49, v49
    v_xor_b32 v50, s50, v50
    v_xor_b32 v51, s51, v51
    v_or3_b32 v8, v48, v49, v50
    v_bitop3_b32 v8, v8, v51, v13 bitop3:0xa8
    v_cmp_ne_u32 vcc, 0, v8
    s_cbranch_vccnz fz_h5_r2
fz_h5_o2:
    v_pk_add_f32 v[40:41], v[40:41], v[48:49]
    v_pk_add_f32 v[42:43], v[42:43], v[50:51]
fz_h5_c3:
    s_waitcnt vmcnt(0)
    v_xor_b32 v52, v16, v52
    v_xor_b32 v53, v17, v53
    v_xor_b32 v54, v18, v54
    v_xor_b32 v55, v19, v55
    v_or3_b32 v8, v52, v53, v54
    v_bitop3_b32 v8, v8, v55, v13 bitop3:0xa8
    v_cmp_ne_u32 vcc, 0, v8
    s_cbranch_vccnz fz_h5_r3
fz_h5_o3:
    v_pk_add_f32 v[40:41], v[40:41], v[52:53]
    v_pk_add_f32 v[42:43], v[42:43], v[54:55]
    s_nop 1
    v_permlane32_swap_b32 v40, v42
    v_permlane32_swap_b32 v41, v43
    v_pk_add_f32 v[40:41], v[40:41], v[42:43]
    s_nop 1
    v_permlane16_swap_b32 v40, v41
    v_add_f32 v40, v40, v41
    s_nop 1
    v_add_f32_dpp v40, v40, v40 quad_perm:[2,3,0,1] row_mask:0xf bank_mask:0xf
    s_nop 1
    v_add_f32_dpp v40, v40, v40 row_ror:4 row_mask:0xf bank_mask:0xf
    s_nop 1
    v_add_f32_dpp v40, v40, v40 row_ror:8 row_mask:0xf bank_mask:0xf
    v_cvt_pk_bf16_f32 v40, 0, v40
    v_mul_f32 v40, v40, v12
    v_cvt_pk_bf16_f32 v40, 0, v40
    v_add_f32 v40, v40, v11
    v_cvt_pk_bf16_f32 v40, 0, v40
    v_add_f32 v40, v40, v10
    v_cvt_pk_bf16_f32 v40, 0, v40
    s_mov_b32 exec_lo, 0x00030003
    s_mov_b32 exec_hi, 0x00030003
    buffer_store_short_d16_hi v40, v2, s[12:15], s39 offen
    s_cmp_lg_u32 s20, 0
    s_cbranch_scc1 fz_xend
    s_mov_b64 exec, 1
    v_mov_b32 v8, s40
    buffer_store_dword v8, v7, s[4:7], 0 offen
fz_xend:
fz_end:
    s_endpgm
fz_late:
    buffer_store_dwordx4 v[104:107], v239, s[12:15], s34 offen offset:0 sc1
    buffer_store_dwordx4 v[108:111], v239, s[12:15], s34 offen offset:1024 sc1
    buffer_store_dwordx4 v[112:115], v239, s[12:15], s35 offen offset:0 sc1
    buffer_store_dwordx4 v[116:119], v239, s[12:15], s35 offen offset:1024 sc1
    s_branch fz_xend
fz_act:
    s_cmp_gt_u32 s23, 111
    s_cbranch_scc1 fz_xend
    v_lshlrev_b32 v2, 2, v1
    v_and_b32 v11, 3, v1
    v_mov_b32 v3, s48
    v_cmp_eq_u32 vcc, 1, v11
    v_mov_b32 v10, s49
    s_nop 0
    v_cndmask_b32_e64 v3, v3, v10, vcc
    v_cmp_eq_u32 vcc, 2, v11
    v_mov_b32 v10, s50
    s_nop 0
    v_cndmask_b32_e64 v3, v3, v10, vcc
    v_cmp_eq_u32 vcc, 3, v11
    v_mov_b32 v10, s51
    s_nop 0
    v_cndmask_b32_e64 v3, v3, v10, vcc
    v_and_b32 v10, 31, v1
    v_lshlrev_b32 v6, 4, v10
    v_lshrrev_b32 v10, 5, v1
    v_mul_u32_u24 v10, 2184, v10
    v_add_u32 v6, v6, v10
    v_add_u32 v6, 108032, v6
    s_lshl_b32 s38, s23, 11
    s_add_u32 s38, s38, 0x488000
    s_mov_b32 s58, 0
fz_h4:
    buffer_load_dword v16, v2, s[4:7], s38 offen offset:0 sc1
    buffer_load_dword v17, v2, s[4:7], s38 offen offset:256 sc1
    buffer_load_dword v18, v2, s[4:7], s38 offen offset:512 sc1
    buffer_load_dword v19, v2, s[4:7], s38 offen offset:768 sc1
    buffer_load_dword v20, v2, s[4:7], s38 offen offset:1024 sc1
    buffer_load_dword v21, v2, s[4:7], s38 offen offset:1280 sc1
    buffer_load_dword v22, v2, s[4:7], s38 offen offset:1536 sc1
    buffer_load_dword v23, v2, s[4:7], s38 offen offset:1792 sc1
    s_waitcnt vmcnt(6)
    v_xor_b32 v16, v3, v16
    v_xor_b32 v17, v3, v17
    v_or3_b32 v10, v16, v17, 0
    v_add_f32 v16, v16, v17
    s_waitcnt vmcnt(4)
    v_xor_b32 v18, v3, v18
    v_xor_b32 v19, v3, v19
    v_or3_b32 v10, v18, v19, v10
    v_add_f32 v18, v18, v19
    v_add_f32 v16, v16, v18
    s_waitcnt vmcnt(2)
    v_xor_b32 v20, v3, v20
    v_xor_b32 v21, v3, v21
    v_or3_b32 v10, v20, v21, v10
    v_add_f32 v20, v20, v21
    s_waitcnt vmcnt(0)
    v_xor_b32 v22, v3, v22
    v_xor_b32 v23, v3, v23
    v_or3_b32 v10, v22, v23, v10
    v_add_f32 v22, v22, v23
    v_add_f32 v20, v20, v22
    v_and_b32 v10, 0xff, v10
    v_add_f32 v8, v16, v20
    v_cmp_ne_u32 vcc, 0, v10
    s_cbranch_vccnz fz_h4_rt
fz_h4_ok:
    v_cvt_pk_bf16_f32 v8, 0, v8
    v_mov_b32 v9, v8
    s_nop 1
    v_permlane32_swap_b32 v8, v9
    v_mul_f32 v10, 0xbfb8aa3b, v8
    v_exp_f32 v10, v10
    s_nop 0
    v_add_f32 v10, 1.0, v10
    v_rcp_f32 v10, v10
    s_nop 0
    v_mul_f32 v8, v8, v10
    v_cvt_pk_bf16_f32 v8, 0, v8
    v_mul_f32 v8, v8, v9
    v_cvt_pk_bf16_f32 v8, 0, v8
    ds_write_b16_d16_hi v6, v8 offset:0
    ds_write_b16_d16_hi v6, v8 offset:546
    ds_write_b16_d16_hi v6, v8 offset:1092
    ds_write_b16_d16_hi v6, v8 offset:1638
    s_waitcnt lgkmcnt(0)
    s_branch fz_f2
fz_ldh:
    s_load_dwordx2 s[12:13], s[0:1], 56
    s_load_dwordx2 s[16:17], s[0:1], 64
    s_mov_b32 s14, 0x700000
    s_mov_b32 s15, 0x00020000
    s_mov_b32 s18, 0x700000
    s_mov_b32 s19, 0x00020000
    s_branch fz_ldback
fz_spec:
    s_cmp_gt_u32 s3, 3
    s_cbranch_scc1 fz_spec_hi
    s_cmp_eq_u32 s3, 0
    s_cselect_b32 s31, 0, s31
    s_cselect_b32 s30, 33024, s30
    s_cmp_eq_u32 s3, 2
    s_cselect_b32 s31, 30960, s31
    s_cselect_b32 s30, 35088, s30
    s_cmp_eq_u32 s3, 3
    s_cselect_b32 s31, 37152, s31
    s_cselect_b32 s30, 39216, s30
    s_branch fz_specback
fz_spec_hi:
    s_mov_b32 m0, s31
    s_nop 0
    buffer_load_dwordx4 v239, s[8:11], s27 offen lds
    buffer_load_dwordx4 v239, s[8:11], s27 offen offset:1024 lds
    s_mov_b32 m0, s30
    s_nop 0
    buffer_load_dwordx4 v239, s[8:11], s28 offen lds
    buffer_load_dwordx4 v239, s[8:11], s28 offen offset:1024 lds
    v_lshlrev_b32 v13, 3, v0
    v_mov_b32 v10, -1
    v_mov_b32 v11, -1
    s_lshl_b32 s32, s20, 11
    s_add_u32 s32, s32, 0x447800
    s_mov_b32 s18, 0x800
    s_mov_b32 s19, 0x00020000
    s_lshl_b32 s33, s24, 10
    s_min_u32 s34, s33, 2048
    s_add_u32 s34, s34, 104960
    s_mov_b32 m0, s34
    buffer_store_dwordx2 v[10:11], v13, s[4:7], s32 offen sc1
    buffer_load_dwordx4 v239, s[16:19], s33 offen lds
    s_cmp_eq_u32 s24, 0
    s_cselect_b32 s31, 8256, s31
    s_cselect_b32 s30, 22704, s30
    s_cselect_b32 s27, 524288, s27
    s_cselect_b32 s28, 3670016, s28
    s_cmp_eq_u32 s24, 1
    s_cselect_b32 s31, 12384, s31
    s_cselect_b32 s30, 18576, s30
    s_cselect_b32 s27, 1572864, s27
    s_cselect_b32 s28, 2621440, s28
    s_cmp_eq_u32 s24, 2
    s_cselect_b32 s31, 41280, s31
    s_cselect_b32 s30, 43344, s30
    s_cselect_b32 s27, 1572864, s27
    s_cselect_b32 s28, 2621440, s28
    s_cmp_eq_u32 s24, 3
    s_cselect_b32 s31, 45408, s31
    s_cselect_b32 s30, 47472, s30
    s_cselect_b32 s27, 524288, s27
    s_cselect_b32 s28, 3670016, s28
    s_mov_b32 s57, 0
    s_branch fz_specback
fz_jb:
    v_cvt_pk_bf16_f32 v128, v104, v105
    v_cvt_pk_bf16_f32 v129, v106, v107
    v_cvt_pk_bf16_f32 v130, v108, v109
    v_cvt_pk_bf16_f32 v131, v110, v111
    v_cvt_pk_bf16_f32 v132, v112, v113
    v_cvt_pk_bf16_f32 v133, v114, v115
    v_cvt_pk_bf16_f32 v134, v116, v117
    v_cvt_pk_bf16_f32 v135, v118, v119
    s_branch fz_jend
fz_bsp0:
    buffer_load_dwordx4 v[160:163], v14, s[64:67], s62 offen offset:0 nt
    buffer_load_dwordx4 v[164:167], v14, s[64:67], s62 offen offset:256 nt
    s_add_u32 s62, s62, 8192
    buffer_load_dwordx4 v[168:171], v14, s[64:67], s62 offen offset:0 nt
    buffer_load_dwordx4 v[172:175], v14, s[64:67], s62 offen offset:256 nt
    s_add_u32 s62, s62, 8192
    buffer_load_dwordx4 v[176:179], v14, s[64:67], s62 offen offset:0 nt
    buffer_load_dwordx4 v[180:183], v14, s[64:67], s62 offen offset:256 nt
    s_add_u32 s62, s62, 8192
    buffer_load_dwordx4 v[184:187], v14, s[64:67], s62 offen offset:0 nt
    buffer_load_dwordx4 v[188:191], v14, s[64:67], s62 offen offset:256 nt
    s_add_u32 s62, s62, 8192
    s_branch fz_bsp
fz_spec40:
    s_mov_b32 s38, 0x80018001
    s_mov_b32 s39, 0x80018001
    v_cndmask_b32_e64 v112, v112, v104, s[38:39]
    v_cndmask_b32_e64 v113, v113, v105, s[38:39]
    s_branch fz_spec4back0
fz_spec41:
    s_mov_b32 s38, 0x80018001
    s_mov_b32 s39, 0x80018001
    v_cndmask_b32_e64 v114, v114, v106, s[38:39]
    v_cndmask_b32_e64 v115, v115, v107, s[38:39]
    s_branch fz_spec4back1
fz_spec42:
    s_mov_b32 s38, 0x80018001
    s_mov_b32 s39, 0x80018001
    v_cndmask_b32_e64 v116, v116, v108, s[38:39]
    v_cndmask_b32_e64 v117, v117, v109, s[38:39]
    s_branch fz_spec4back2
fz_spec43:
    s_mov_b32 s38, 0x80018001
    s_mov_b32 s39, 0x80018001
    v_cndmask_b32_e64 v118, v118, v110, s[38:39]
    v_cndmask_b32_e64 v119, v119, v111, s[38:39]
    s_branch fz_spec4back3
    s_nop 3
fz_nc1:
    s_setprio 0
    s_cmp_lg_u32 s59, 0
    s_cbranch_scc1 ffn_b
    buffer_load_dwordx4 v[176:179], v14, s[64:67], s62 offen offset:0 nt
    buffer_load_dwordx4 v[180:183], v14, s[64:67], s62 offen offset:256 nt
    s_add_u32 s62, s62, 8192
    buffer_load_dwordx4 v[184:187], v14, s[64:67], s62 offen offset:0 nt
    buffer_load_dwordx4 v[188:191], v14, s[64:67], s62 offen offset:256 nt
    s_add_u32 s62, s62, 8192
    s_mov_b32 m0, s31
    s_nop 0
    buffer_load_dwordx4 v239, s[8:11], s27 offen nt lds
    buffer_load_dwordx4 v239, s[8:11], s27 offen offset:1024 nt lds
    s_mov_b32 m0, s30
    s_nop 0
    buffer_load_dwordx4 v239, s[8:11], s28 offen nt lds
    buffer_load_dwordx4 v239, s[8:11], s28 offen offset:1024 nt lds
    v_lshlrev_b32 v13, 3, v0
    v_mov_b32 v10, -1
    v_mov_b32 v11, -1
    s_lshl_b32 s32, s20, 11
    s_add_u32 s32, s32, 0x447800
    s_mov_b32 s18, 0x800
    s_mov_b32 s19, 0x00020000
    s_lshl_b32 s33, s24, 10
    s_min_u32 s34, s33, 2048
    s_add_u32 s34, s34, 104960
    s_mov_b32 m0, s34
    buffer_store_dwordx2 v[10:11], v13, s[4:7], s32 offen sc1
    buffer_load_dwordx4 v239, s[16:19], s33 offen lds
    s_waitcnt vmcnt(14)
    v_readfirstlane_b32 s40, v250
    s_nop 1
    s_add_u32 s40, s40, 1
    s_and_b32 s38, s40, 3
    s_and_b32 s39, s40, 15
    s_bfe_u32 s41, s40, 0x20002
    s_lshl_b32 s41, s41, 16
    s_or_b32 s44, s38, s41
    s_bfe_u32 s41, s40, 0x40004
    s_lshl_b32 s41, s41, 4
    s_or_b32 s48, s39, s41
    s_bfe_u32 s41, s40, 0x20004
    s_lshl_b32 s41, s41, 16
    s_or_b32 s45, s38, s41
    s_bfe_u32 s41, s40, 0x40008
    s_lshl_b32 s41, s41, 4
    s_or_b32 s49, s39, s41
    s_bfe_u32 s41, s40, 0x20006
    s_lshl_b32 s41, s41, 16
    s_or_b32 s46, s38, s41
    s_bfe_u32 s41, s40, 0x4000c
    s_lshl_b32 s41, s41, 4
    s_or_b32 s50, s39, s41
    s_bfe_u32 s41, s40, 0x20008
    s_lshl_b32 s41, s41, 16
    s_or_b32 s47, s38, s41
    s_bfe_u32 s41, s40, 0x40010
    s_lshl_b32 s41, s41, 4
    s_or_b32 s51, s39, s41
    s_mov_b32 s38, 0x404
    s_cmp_eq_u32 s2, 66
    s_cselect_b32 s39, 8, 4
    s_cselect_b32 s38, 8, s38
fz_bsp:
    s_setprio 0
    s_mov_b32 s57, 1
    s_cmp_gt_u32 s3, 5
    s_cbranch_scc1 fz_nocq
    s_and_b32 s32, s3, 1
    s_lshl_b32 s33, s32, 2
    s_lshl_b32 s32, s32, 11
    v_and_b32 v8, 3, v4
    v_lshrrev_b32 v9, 2, v4
    v_lshl_add_u32 v8, v8, 3, v9
    v_add_u32 v8, s33, v8
    v_cvt_f32_u32 v8, v8
    v_mul_f32 v8, 0x3d000000, v8
    v_cvt_f32_u32 v9, v5
    v_mul_f32 v9, 4.0, v9
    v_mul_f32 v9, v8, v9
    v_mov_b32 v104, v9
    v_fmamk_f32 v105, v8, 0x3f800000, v9
    v_fmamk_f32 v106, v8, 0x40000000, v9
    v_fmamk_f32 v107, v8, 0x40400000, v9
    v_fmamk_f32 v108, v8, 0x41800000, v9
    v_fmamk_f32 v109, v8, 0x41880000, v9
    v_fmamk_f32 v110, v8, 0x41900000, v9
    v_fmamk_f32 v111, v8, 0x41980000, v9
    v_sin_f32 v112, v104
    v_sin_f32 v113, v105
    v_sin_f32 v114, v106
    v_sin_f32 v115, v107
    v_sin_f32 v116, v108
    v_sin_f32 v117, v109
    v_sin_f32 v118, v110
    v_sin_f32 v119, v111
    v_cos_f32 v104, v104
    v_cos_f32 v105, v105
    v_cos_f32 v106, v106
    v_cos_f32 v107, v107
    v_cos_f32 v108, v108
    v_cos_f32 v109, v109
    v_cos_f32 v110, v110
    v_cos_f32 v111, v111
    v_mul_f32 v104, 0x3d800000, v104
    v_mul_f32 v105, 0x3d800000, v105
    v_mul_f32 v106, 0x3d800000, v106
    v_mul_f32 v107, 0x3d800000, v107
    v_mul_f32 v108, 0x3d800000, v108
    v_mul_f32 v109, 0x3d800000, v109
    v_mul_f32 v110, 0x3d800000, v110
    v_mul_f32 v111, 0x3d800000, v111
    v_mul_f32 v112, 0x3d800000, v112
    v_mul_f32 v113, 0x3d800000, v113
    v_mul_f32 v114, 0x3d800000, v114
    v_mul_f32 v115, 0x3d800000, v115
    v_mul_f32 v116, 0x3d800000, v116
    v_mul_f32 v117, 0x3d800000, v117
    v_mul_f32 v118, 0x3d800000, v118
    v_mul_f32 v119, 0x3d800000, v119
    v_cvt_pk_f16_f32 v128, v104, v105
    v_cvt_pk_f16_f32 v129, v106, v107
    v_cvt_pk_f16_f32 v130, v108, v109
    v_cvt_pk_f16_f32 v131, v110, v111
    v_cvt_pk_f16_f32 v132, v112, v113
    v_cvt_pk_f16_f32 v133, v114, v115
    v_cvt_pk_f16_f32 v134, v116, v117
    v_cvt_pk_f16_f32 v135, v118, v119
    v_add_u32 v8, s32, v6
    ds_write_b128 v8, v[128:131] offset:14336
    ds_write_b128 v8, v[132:135] offset:15360
fz_nocq:
    s_and_b32 s32, s3, 3
    s_lshr_b32 s33, s3, 2
    s_lshl_b32 s33, s33, 4
    s_add_u32 s33, s33, s32
    v_and_b32 v8, 12, v4
    v_bfe_u32 v9, v4, 1, 1
    v_lshl_add_u32 v8, v9, 5, v8
    v_add_u32 v8, s33, v8
    v_cvt_f32_u32 v8, v8
    v_and_b32 v12, 1, v1
    v_cvt_f32_u32 v9, v12
    v_lshlrev_b32 v13, 2, v5
    v_cvt_f32_u32 v10, v13
    v_mul_f32 v11, 0x3c800000, v8
    v_mul_f32 v9, 0x3e800000, v9
    v_fma_f32 v9, v11, v10, v9
    v_mov_b32 v128, v9
    v_fmamk_f32 v129, v11, 0x3f800000, v9
    v_fmamk_f32 v130, v11, 0x40000000, v9
    v_fmamk_f32 v131, v11, 0x40400000, v9
    v_mul_f32 v11, 0x3a000000, v8
    v_lshlrev_b32 v9, 31, v1
    v_xor_b32 v11, v9, v11
    v_mul_f32 v9, v11, v10
    v_mov_b32 v112, v9
    v_fmamk_f32 v113, v11, 0x3f800000, v9
    v_fmamk_f32 v114, v11, 0x40000000, v9
    v_fmamk_f32 v115, v11, 0x40400000, v9
    v_fmamk_f32 v116, v11, 0x41800000, v9
    v_fmamk_f32 v117, v11, 0x41880000, v9
    v_fmamk_f32 v118, v11, 0x41900000, v9
    v_fmamk_f32 v119, v11, 0x41980000, v9
    v_cos_f32 v104, v128
    v_sin_f32 v105, v128
    v_cos_f32 v106, v129
    v_sin_f32 v107, v129
    v_cos_f32 v108, v130
    v_sin_f32 v109, v130
    v_cos_f32 v110, v131
    v_sin_f32 v111, v131
    v_sin_f32 v120, v112
    v_sin_f32 v121, v113
    v_sin_f32 v122, v114
    v_sin_f32 v123, v115
    v_sin_f32 v124, v116
    v_sin_f32 v125, v117
    v_sin_f32 v126, v118
    v_sin_f32 v127, v119
    v_cos_f32 v112, v112
    v_cos_f32 v113, v113
    v_cos_f32 v114, v114
    v_cos_f32 v115, v115
    v_cos_f32 v116, v116
    v_cos_f32 v117, v117
    v_cos_f32 v118, v118
    v_cos_f32 v119, v119
    v_cvt_pk_f16_f32 v16, v104, v105
    v_cvt_pk_f16_f32 v17, v106, v107
    v_cvt_pk_f16_f32 v18, v108, v109
    v_cvt_pk_f16_f32 v19, v110, v111
    v_cvt_pk_f16_f32 v20, v112, v113
    v_cvt_pk_f16_f32 v21, v114, v115
    v_cvt_pk_f16_f32 v22, v116, v117
    v_cvt_pk_f16_f32 v23, v118, v119
    v_cvt_pk_f16_f32 v24, v120, v121
    v_cvt_pk_f16_f32 v25, v122, v123
    v_cvt_pk_f16_f32 v26, v124, v125
    v_cvt_pk_f16_f32 v27, v126, v127
    v_lshrrev_b32 v8, 3, v1
    v_mul_u32_u24 v222, 16512, v8
    v_and_b32 v9, 7, v1
    v_lshl_add_u32 v222, v9, 4, v222
    s_mul_i32 s60, s3, 528384
    s_lshl_b32 s32, s20, 7
    s_add_u32 s60, s60, s32
    s_add_u32 s60, s60, 0x1000
    s_add_u32 s61, s60, 132096
    s_add_u32 s16, s60, 264192
    s_add_u32 s17, s60, 396288
    v_lshlrev_b32 v8, 1, v8
    v_bfe_u32 v9, v1, 2, 1
    v_add_u32 v8, v8, v9
    s_lshl_b32 s32, s3, 2
    s_add_u32 s32, s32, 1
    v_lshl_add_u32 v8, v8, 5, s32
    v_cmp_eq_u32 vcc, 1, v12
    v_bfe_u32 v9, v1, 1, 1
    v_mul_u32_u24 v9, 8256, v9
    v_add_u32 v9, 86400, v9
    s_cmp_eq_u32 s3, 3
    s_cselect_b32 s32, 272, 0
    v_sub_u32 v10, 512, v8
    v_cndmask_b32_e64 v10, v8, v10, vcc
    v_and_b32 v11, 16, v10
    v_lshl_add_u32 v11, v11, 6, v9
    v_lshrrev_b32 v12, 7, v10
    v_lshl_add_u32 v11, v12, 8, v11
    v_and_b32 v12, 15, v10
    v_lshl_add_u32 v11, v12, 4, v11
    v_bfe_u32 v12, v10, 5, 2
    v_lshl_add_u32 v223, v12, 2, v11
    v_add_u32 v8, 1, v8
    v_sub_u32 v10, 512, v8
    v_cndmask_b32_e64 v10, v8, v10, vcc
    v_and_b32 v11, 16, v10
    v_lshl_add_u32 v11, v11, 6, v9
    v_lshrrev_b32 v12, 7, v10
    v_lshl_add_u32 v11, v12, 8, v11
    v_and_b32 v12, 15, v10
    v_lshl_add_u32 v11, v12, 4, v11
    v_bfe_u32 v12, v10, 5, 2
    v_lshl_add_u32 v224, v12, 2, v11
    v_add_u32 v8, 1, v8
    v_sub_u32 v10, 512, v8
    v_cndmask_b32_e64 v10, v8, v10, vcc
    v_and_b32 v11, 16, v10
    v_lshl_add_u32 v11, v11, 6, v9
    v_lshrrev_b32 v12, 7, v10
    v_lshl_add_u32 v11, v12, 8, v11
    v_and_b32 v12, 15, v10
    v_lshl_add_u32 v11, v12, 4, v11
    v_bfe_u32 v12, v10, 5, 2
    v_lshl_add_u32 v100, v12, 2, v11
    v_mul_u32_u24 v10, s32, v3
    v_sub_u32 v8, v8, v10
    v_add_u32 v8, 1, v8
    v_sub_u32 v10, 512, v8
    v_cndmask_b32_e64 v10, v8, v10, vcc
    v_lshrrev_b32 v11, 1, v10
    v_and_b32 v11, 256, v11
    v_sub_u32 v10, v10, v11
    v_and_b32 v11, 16, v10
    v_lshl_add_u32 v11, v11, 6, v9
    v_lshrrev_b32 v12, 7, v10
    v_lshl_add_u32 v11, v12, 8, v11
    v_and_b32 v12, 15, v10
    v_lshl_add_u32 v11, v12, 4, v11
    v_bfe_u32 v12, v10, 5, 2
    v_lshl_add_u32 v101, v12, 2, v11
    s_and_b32 s32, s3, 3
    s_lshl_b32 s32, s32, 11
    s_add_u32 s32, s32, 86400
    v_add_u32 v225, s32, v239
    v_add_u32 v8, s33, v13
    v_sub_u32 v9, 32, v8
    v_min_u32 v9, v8, v9
    v_and_b32 v10, 15, v8
    v_cmp_eq_u32 s[32:33], 0, v10
    v_cmp_lt_u32 s[34:35], 16, v8
    v_lshlrev_b32 v10, 10, v9
    v_subrev_u32 v10, 1024, v10
    v_mov_b32 v11, 15872
    v_cmp_eq_u32 vcc, 0, v8
    s_nop 1
    v_cndmask_b32_e64 v10, v10, v11, vcc
    v_and_b32 v11, 3, v1
    v_lshl_add_u32 v10, v11, 4, v10
    v_lshrrev_b32 v11, 2, v4
    v_lshlrev_b32 v12, 7, v11
    v_sub_u32 v13, 960, v12
    v_cndmask_b32_e64 v13, v12, v13, s[34:35]
    v_add_u32 v226, v10, v13
    s_or_b64 s[34:35], s[34:35], s[32:33]
    v_add_u32 v12, 512, v12
    v_sub_u32 v13, 960, v12
    v_cndmask_b32_e64 v13, v12, v13, s[34:35]
    v_add_u32 v227, v10, v13
    s_mul_i32 s56, s20, 16512
    s_add_u32 s56, s56, 0x210000
    v_mov_b32 v249, 0x30003
    v_mov_b32 v252, s44
    v_mov_b32 v253, s45
    v_mov_b32 v254, s46
    v_mov_b32 v255, s47
    s_waitcnt lgkmcnt(0)
    v_sub_u32 v8, 15, v4
    v_min_u32 v8, v4, v8
    v_and_b32 v9, 1, v8
    v_lshlrev_b32 v9, 5, v9
    v_lshrrev_b32 v10, 1, v8
    v_lshl_add_u32 v9, v10, 9, v9
    v_add_u32 v9, s25, v9
    v_sub_u32 v10, 2048, v9
    v_cmp_lt_u32 s[34:35], 7, v4
    s_nop 1
    v_cndmask_b32_e64 v230, v9, v10, s[34:35]
    v_mov_b32 v9, v4
    v_mov_b32 v10, s20
    s_cmp_lg_u32 s21, 0
    s_cbranch_scc0 fz_spec3b
fz_spec3backb:
    v_lshlrev_b32 v10, 7, v10
    v_lshl_add_u32 v10, v9, 3, v10
    v_mul_u32_u24 v11, 66048, v5
    v_add_u32 v228, v10, v11
    v_and_b32 v9, 1, v9
    v_cmp_eq_u32 vcc, 1, v9
    v_mov_b32 v9, s44
    v_mov_b32 v10, s46
    v_cndmask_b32_e64 v236, v9, v10, vcc
    v_mov_b32 v9, s45
    v_mov_b32 v10, s47
    v_cndmask_b32_e64 v237, v9, v10, vcc
    s_lshl_b32 s32, s3, 2
    v_add_u32 v8, s32, v5
    v_lshlrev_b32 v9, 6, v8
    v_cmp_gt_u32 vcc, 16, v8
    s_nop 1
    v_cndmask_b32_e64 v10, 0, 32, vcc
    v_add_u32 v10, v9, v10
    v_sub_u32 v11, 2048, v10
    v_cmp_eq_u32 vcc, 16, v8
    s_nop 1
    v_cndmask_b32_e64 v11, v11, 0, vcc
    v_mov_b32 v12, 0xffff0000
    v_cndmask_b32_e64 v238, -1, v12, vcc
    v_sub_u32 v12, 2018, v9
    v_mul_u32_u24 v13, 2064, v4
    v_add_u32 v231, v13, v9
    v_add_u32 v232, v13, v12
    v_add_u32 v233, v13, v10
    v_add_u32 v241, v13, v11
    s_lshl_b32 s32, s3, 8
    s_add_u32 s32, s32, 102912
    v_lshlrev_b32 v9, 4, v4
    v_add_u32 v10, s32, v9
    v_add_u32 v11, 107008, v239
    v_cmp_gt_u32 vcc, 16, v1
    s_nop 1
    v_cndmask_b32_e64 v243, v11, v10, vcc
    v_lshrrev_b32 v12, 2, v4
    v_cmp_eq_u32 vcc, v12, v5
    s_nop 1
    v_cndmask_b32_e64 v244, v11, v10, vcc
    v_lshrrev_b32 v12, 5, v1
    v_lshl_add_u32 v10, v12, 10, v9
    v_add_u32 v245, 102912, v10
    v_and_b32 v9, 1, v1
    v_cmp_eq_u32 s[28:29], 1, v9
    v_and_b32 v9, 2, v1
    v_cmp_eq_u32 s[30:31], 2, v9
    s_lshl_b32 s37, s3, 2
    v_add_u32 v9, s37, v5
    v_mul_u32_u24 v246, 2176, v9
    s_lshl_b32 s26, s20, 4
    s_add_u32 s26, s26, 0x580000
    v_lshlrev_b32 v247, 4, v5
    s_lshl_b32 s27, s20, 11
    s_lshl_b32 s37, s3, 8
    s_add_u32 s27, s27, s37
    s_add_u32 s27, s27, 0x448000
    v_sub_u32 v248, 2047, v230
    s_mov_b32 s14, 0x400000
    s_mov_b32 s15, 0x00020000
    s_mul_i32 s52, s3, 264192
    s_add_u32 s52, s52, 0x210000
    s_add_u32 s53, s52, 16512
    s_add_u32 s54, s52, 33024
    s_add_u32 s55, s52, 49536
    s_mov_b32 s23, s63
    s_getreg_b32 s24, hwreg(HW_REG_XCC_ID)
    s_and_b32 s24, s24, 15
    v_lshlrev_b32 v10, 4, v0
    v_min_u32 v10, 4336, v10
    v_add_u32 v10, 108032, v10
    v_mov_b32 v104, 0
    v_mov_b32 v105, 0
    v_mov_b32 v106, 0
    v_mov_b32 v107, 0
    ds_write_b128 v10, v[104:107]
    s_cmp_eq_u32 s2, 66
    s_cbranch_scc1 fz_sz
    s_waitcnt vmcnt(0)
    v_mov_b32 v10, 256
    s_mov_b64 exec, 1
    ds_add_u32 v15, v10
    s_mov_b64 exec, -1
fz_sz:
    ds_read_b32 v10, v15
    s_waitcnt lgkmcnt(0)
    v_cmp_ne_u32 vcc, s38, v10
    s_cbranch_vccnz fz_sz
    ds_read_b128 v[116:119], v231
    ds_read_b128 v[120:123], v231 offset:16
    ds_read_u16_d16_hi v44, v241
    ds_read_u16_d16_hi v45, v232 offset:28
    ds_read_u16_d16_hi v46, v232 offset:26
    ds_read_u16_d16_hi v47, v232 offset:24
    ds_read_u16_d16_hi v48, v232 offset:22
    ds_read_u16_d16_hi v49, v232 offset:20
    ds_read_u16_d16_hi v50, v232 offset:18
    ds_read_u16_d16_hi v51, v232 offset:16
    ds_read_u16_d16_hi v52, v232 offset:14
    ds_read_u16_d16_hi v53, v232 offset:12
    ds_read_u16_d16_hi v54, v232 offset:10
    ds_read_u16_d16_hi v55, v232 offset:8
    ds_read_u16_d16_hi v56, v232 offset:6
    ds_read_u16_d16_hi v57, v232 offset:4
    ds_read_u16_d16_hi v58, v232 offset:2
    ds_read_u16_d16_hi v59, v232 offset:0
    ds_read_u16_d16_hi v28, v233
    v_mul_u32_u24 v13, 2064, v4
    v_subrev_u32 v13, 104960, v13
    v_sub_u32 v9, v231, v13
    v_sub_u32 v10, v233, v13
    v_sub_u32 v11, v241, v13
    v_sub_u32 v12, v232, v13
    s_mov_b32 s36, 0xffff0000
    s_waitcnt lgkmcnt(0)
    ds_read_b128 v[200:203], v9
    ds_read_b128 v[204:207], v9 offset:16
    ds_read_u16_d16 v208, v11
    ds_read_u16_d16_hi v124, v12 offset:28
    ds_read_u16_d16 v209, v12 offset:26
    ds_read_u16_d16_hi v125, v12 offset:24
    ds_read_u16_d16 v210, v12 offset:22
    ds_read_u16_d16_hi v126, v12 offset:20
    ds_read_u16_d16 v211, v12 offset:18
    ds_read_u16_d16_hi v127, v12 offset:16
    ds_read_u16_d16 v212, v12 offset:14
    ds_read_u16_d16_hi v128, v12 offset:12
    ds_read_u16_d16 v213, v12 offset:10
    ds_read_u16_d16_hi v129, v12 offset:8
    ds_read_u16_d16 v214, v12 offset:6
    ds_read_u16_d16_hi v130, v12 offset:4
    ds_read_u16_d16 v215, v12 offset:2
    ds_read_u16_d16_hi v131, v12 offset:0
    ds_read_u16_d16 v13, v10
    v_and_b32 v29, s36, v116
    v_lshlrev_b32 v30, 16, v117
    v_and_b32 v31, s36, v117
    v_lshlrev_b32 v32, 16, v118
    v_and_b32 v33, s36, v118
    v_lshlrev_b32 v34, 16, v119
    v_and_b32 v35, s36, v119
    v_lshlrev_b32 v36, 16, v120
    v_and_b32 v37, s36, v120
    v_lshlrev_b32 v38, 16, v121
    v_and_b32 v39, s36, v121
    v_lshlrev_b32 v40, 16, v122
    v_and_b32 v41, s36, v122
    v_lshlrev_b32 v42, 16, v123
    v_and_b32 v43, s36, v123
    v_cmp_eq_u32 vcc, 1, v4
    v_mov_b32 v9, s42
    s_nop 0
    v_cndmask_b32_e64 v9, 0, v9, vcc
    v_mov_b32 v116, s42
    v_mov_b32 v117, s42
    v_mov_b32 v118, s42
    v_mov_b32 v119, s42
    v_cmp_eq_u32 vcc, 0, v4
    s_waitcnt lgkmcnt(0)
    v_and_or_b32 v200, v200, s36, v13
    v_or_b32 v208, v208, v124
    v_or_b32 v209, v209, v125
    v_or_b32 v210, v210, v126
    v_or_b32 v211, v211, v127
    v_or_b32 v212, v212, v128
    v_or_b32 v213, v213, v129
    v_or_b32 v214, v214, v130
    v_or_b32 v215, v215, v131
    v_cndmask_b32_e64 v200, v9, v200, vcc
    v_cndmask_b32_e64 v201, v9, v201, vcc
    v_cndmask_b32_e64 v202, v9, v202, vcc
    v_cndmask_b32_e64 v203, v9, v203, vcc
    v_cndmask_b32_e64 v204, v9, v204, vcc
    v_cndmask_b32_e64 v205, v9, v205, vcc
    v_cndmask_b32_e64 v206, v9, v206, vcc
    v_cndmask_b32_e64 v207, v9, v207, vcc
    v_cndmask_b32_e64 v208, v9, v208, vcc
    v_cndmask_b32_e64 v209, v9, v209, vcc
    v_cndmask_b32_e64 v210, v9, v210, vcc
    v_cndmask_b32_e64 v211, v9, v211, vcc
    v_cndmask_b32_e64 v212, v9, v212, vcc
    v_cndmask_b32_e64 v213, v9, v213, vcc
    v_cndmask_b32_e64 v214, v9, v214, vcc
    v_cndmask_b32_e64 v215, v9, v215, vcc
    v_mfma_f32_16x16x32_bf16 v[120:123], v[200:203], v[116:119], 0
    v_mfma_f32_16x16x32_bf16 v[120:123], v[204:207], v[116:119], v[120:123]
    v_mfma_f32_16x16x32_bf16 v[120:123], v[208:211], v[116:119], v[120:123]
    v_mfma_f32_16x16x32_bf16 v[120:123], v[212:215], v[116:119], v[120:123]
    s_nop 7
    ds_write_b32 v243, v120 offset:12
    s_waitcnt lgkmcnt(0)
    s_branch fz_hb
    s_nop 0
fz_nc3:
    s_mov_b32 s58, 0
    s_waitcnt vmcnt(0)
    s_branch fz_h2
fz_spec3a:
    v_xor_b32 v11, 1, v4
    v_cndmask_b32_e64 v9, v9, v11, s[34:35]
    v_and_b32 v11, 1, v4
    v_cndmask_b32_e64 v11, 0, v11, s[34:35]
    v_sub_u32 v10, v10, v11
    s_cmp_lg_u32 s22, 0
    s_cbranch_scc1 fz_spec3backa
    v_cmp_eq_u32 vcc, 15, v4
    v_mov_b32 v11, 1024
    v_mov_b32 v12, 124
    v_cndmask_b32_e64 v230, v230, v11, vcc
    v_cndmask_b32_e64 v10, v10, v12, vcc
    v_cndmask_b32_e64 v9, v9, 4, vcc
    v_cmp_eq_u32 vcc, 13, v4
    v_mov_b32 v11, 1536
    v_mov_b32 v12, 124
    v_cndmask_b32_e64 v230, v230, v11, vcc
    v_cndmask_b32_e64 v10, v10, v12, vcc
    v_cndmask_b32_e64 v9, v9, 6, vcc
    v_cmp_eq_u32 vcc, 4, v4
    v_mov_b32 v11, 256
    v_mov_b32 v12, 127
    v_cndmask_b32_e64 v230, v230, v11, vcc
    v_cndmask_b32_e64 v10, v10, v12, vcc
    v_cndmask_b32_e64 v9, v9, 8, vcc
    v_cmp_eq_u32 vcc, 11, v4
    v_mov_b32 v11, 1792
    v_mov_b32 v12, 127
    v_cndmask_b32_e64 v230, v230, v11, vcc
    v_cndmask_b32_e64 v10, v10, v12, vcc
    v_cndmask_b32_e64 v9, v9, 14, vcc
    v_cmp_eq_u32 vcc, 6, v4
    v_mov_b32 v11, 768
    v_mov_b32 v12, 127
    v_cndmask_b32_e64 v230, v230, v11, vcc
    v_cndmask_b32_e64 v10, v10, v12, vcc
    v_cndmask_b32_e64 v9, v9, 10, vcc
    v_cmp_eq_u32 vcc, 9, v4
    v_mov_b32 v11, 1280
    v_mov_b32 v12, 127
    v_cndmask_b32_e64 v230, v230, v11, vcc
    v_cndmask_b32_e64 v10, v10, v12, vcc
    v_cndmask_b32_e64 v9, v9, 12, vcc
    s_nop 4
    s_branch fz_spec3backa
fz_spec3b:
    v_xor_b32 v11, 1, v4
    v_cndmask_b32_e64 v9, v9, v11, s[34:35]
    v_and_b32 v11, 1, v4
    v_cndmask_b32_e64 v11, 0, v11, s[34:35]
    v_sub_u32 v10, v10, v11
    s_cmp_lg_u32 s22, 0
    s_cbranch_scc1 fz_spec3backb
    v_cmp_eq_u32 vcc, 15, v4
    v_mov_b32 v11, 1024
    v_mov_b32 v12, 124
    v_cndmask_b32_e64 v230, v230, v11, vcc
    v_cndmask_b32_e64 v10, v10, v12, vcc
    v_cndmask_b32_e64 v9, v9, 4, vcc
    v_cmp_eq_u32 vcc, 13, v4
    v_mov_b32 v11, 1536
    v_mov_b32 v12, 124
    v_cndmask_b32_e64 v230, v230, v11, vcc
    v_cndmask_b32_e64 v10, v10, v12, vcc
    v_cndmask_b32_e64 v9, v9, 6, vcc
    v_cmp_eq_u32 vcc, 4, v4
    v_mov_b32 v11, 256
    v_mov_b32 v12, 127
    v_cndmask_b32_e64 v230, v230, v11, vcc
    v_cndmask_b32_e64 v10, v10, v12, vcc
    v_cndmask_b32_e64 v9, v9, 8, vcc
    v_cmp_eq_u32 vcc, 11, v4
    v_mov_b32 v11, 1792
    v_mov_b32 v12, 127
    v_cndmask_b32_e64 v230, v230, v11, vcc
    v_cndmask_b32_e64 v10, v10, v12, vcc
    v_cndmask_b32_e64 v9, v9, 14, vcc
    v_cmp_eq_u32 vcc, 6, v4
    v_mov_b32 v11, 768
    v_mov_b32 v12, 127
    v_cndmask_b32_e64 v230, v230, v11, vcc
    v_cndmask_b32_e64 v10, v10, v12, vcc
    v_cndmask_b32_e64 v9, v9, 10, vcc
    v_cmp_eq_u32 vcc, 9, v4
    v_mov_b32 v11, 1280
    v_mov_b32 v12, 127
    v_cndmask_b32_e64 v230, v230, v11, vcc
    v_cndmask_b32_e64 v10, v10, v12, vcc
    v_cndmask_b32_e64 v9, v9, 12, vcc
    s_nop 4
    s_branch fz_spec3backb
    s_nop 0
ffn_b:
    s_waitcnt vmcnt(0)
    v_readfirstlane_b32 s40, v250
    s_nop 1
    s_add_u32 s40, s40, 1
    s_and_b32 s38, s40, 3
    s_and_b32 s39, s40, 15
    s_bfe_u32 s41, s40, 0x20002
    s_lshl_b32 s41, s41, 16
    s_or_b32 s44, s38, s41
    s_bfe_u32 s41, s40, 0x40004
    s_lshl_b32 s41, s41, 4
    s_or_b32 s48, s39, s41
    s_bfe_u32 s41, s40, 0x20004
    s_lshl_b32 s41, s41, 16
    s_or_b32 s45, s38, s41
    s_bfe_u32 s41, s40, 0x40008
    s_lshl_b32 s41, s41, 4
    s_or_b32 s49, s39, s41
    s_bfe_u32 s41, s40, 0x20006
    s_lshl_b32 s41, s41, 16
    s_or_b32 s46, s38, s41
    s_bfe_u32 s41, s40, 0x4000c
    s_lshl_b32 s41, s41, 4
    s_or_b32 s50, s39, s41
    s_bfe_u32 s41, s40, 0x20008
    s_lshl_b32 s41, s41, 16
    s_or_b32 s47, s38, s41
    s_bfe_u32 s41, s40, 0x40010
    s_lshl_b32 s41, s41, 4
    s_or_b32 s51, s39, s41
    s_nop 0
ffn:
    s_add_u32 s36, s2, 4
    s_and_b32 s36, s36, 7
    s_bfe_u32 s37, s2, 0x10006
    s_lshl_b32 s22, s36, 1
    s_add_u32 s22, s22, s37
    s_cmp_lg_u32 s37, 0
    s_cselect_b32 s37, 8, s36
    s_add_u32 s37, s37, 6
    s_cmp_lt_u32 s36, 6
    s_cselect_b32 s22, s22, s37
    s_cmp_gt_u32 s22, 13
    s_cbranch_scc1 fz_xend
    s_bfe_u32 s21, s2, 0x30003
    v_lshrrev_b32 v2, 5, v1
    v_and_b32 v3, 31, v1
    v_lshlrev_b32 v4, 1, v2
    v_xor_b32 v3, v4, v3
    v_mul_u32_u24 v4, 7168, v2
    v_lshl_add_u32 v4, v3, 4, v4
    v_xor_b32 v5, 64, v4
    v_xor_b32 v6, 128, v4
    v_xor_b32 v7, 192, v4
    s_lshl_b32 s23, s21, 7
    s_lshl_b32 s24, s3, 4
    s_add_u32 s23, s23, s24
    s_mul_i32 s23, s23, 7168
    s_lshl_b32 s24, s22, 9
    s_add_u32 s23, s23, s24
    s_lshl_b32 s24, s3, 13
    v_mov_b32 v31, 149552
    v_mov_b32 v10, 0
    ds_write_b32 v31, v10
    s_waitcnt lgkmcnt(0)
    s_setprio 0
    s_barrier
    s_add_u32 s28, s24, 81920
    s_mov_b32 m0, s28
    s_add_u32 s29, s23, 0
    buffer_load_dwordx4 v4, s[12:15], s29 offen nt lds
    s_add_u32 s28, s24, 82944
    s_mov_b32 m0, s28
    s_add_u32 s29, s23, 14336
    buffer_load_dwordx4 v5, s[12:15], s29 offen nt lds
    s_add_u32 s28, s24, 83968
    s_mov_b32 m0, s28
    s_add_u32 s29, s23, 28672
    buffer_load_dwordx4 v4, s[12:15], s29 offen nt lds
    s_add_u32 s28, s24, 84992
    s_mov_b32 m0, s28
    s_add_u32 s29, s23, 43008
    buffer_load_dwordx4 v5, s[12:15], s29 offen nt lds
    s_add_u32 s28, s24, 86016
    s_mov_b32 m0, s28
    s_add_u32 s29, s23, 57344
    buffer_load_dwordx4 v6, s[12:15], s29 offen nt lds
    s_add_u32 s28, s24, 87040
    s_mov_b32 m0, s28
    s_add_u32 s29, s23, 71680
    buffer_load_dwordx4 v7, s[12:15], s29 offen nt lds
    s_add_u32 s28, s24, 88064
    s_mov_b32 m0, s28
    s_add_u32 s29, s23, 86016
    buffer_load_dwordx4 v6, s[12:15], s29 offen nt lds
    s_add_u32 s28, s24, 89088
    s_mov_b32 m0, s28
    s_add_u32 s29, s23, 100352
    buffer_load_dwordx4 v7, s[12:15], s29 offen nt lds
    s_add_u32 s28, s24, 0
    s_mov_b32 m0, s28
    s_add_u32 s29, s23, 0
    buffer_load_dwordx4 v4, s[16:19], s29 offen nt lds
    s_add_u32 s28, s24, 1024
    s_mov_b32 m0, s28
    s_add_u32 s29, s23, 14336
    buffer_load_dwordx4 v5, s[16:19], s29 offen nt lds
    s_add_u32 s28, s24, 2048
    s_mov_b32 m0, s28
    s_add_u32 s29, s23, 28672
    buffer_load_dwordx4 v4, s[16:19], s29 offen nt lds
    s_add_u32 s28, s24, 3072
    s_mov_b32 m0, s28
    s_add_u32 s29, s23, 43008
    buffer_load_dwordx4 v5, s[16:19], s29 offen nt lds
    s_add_u32 s28, s24, 4096
    s_mov_b32 m0, s28
    s_add_u32 s29, s23, 57344
    buffer_load_dwordx4 v6, s[16:19], s29 offen nt lds
    s_add_u32 s28, s24, 5120
    s_mov_b32 m0, s28
    s_add_u32 s29, s23, 71680
    buffer_load_dwordx4 v7, s[16:19], s29 offen nt lds
    s_add_u32 s28, s24, 6144
    s_mov_b32 m0, s28
    s_add_u32 s29, s23, 86016
    buffer_load_dwordx4 v6, s[16:19], s29 offen nt lds
    s_add_u32 s28, s24, 7168
    s_mov_b32 m0, s28
    s_add_u32 s29, s23, 100352
    buffer_load_dwordx4 v7, s[16:19], s29 offen nt lds
    v_lshrrev_b32 v2, 4, v1
    v_and_b32 v3, 15, v1
    v_bfe_u32 v9, v1, 2, 2
    v_lshl_add_u32 v8, v2, 3, v9
    v_lshlrev_b32 v8, 9, v8
    v_and_b32 v10, 1, v2
    v_lshl_add_u32 v10, v10, 2, v9
    s_lshl_b32 s28, s3, 1
    v_xor_b32 v10, s28, v10
    v_lshl_add_u32 v8, v10, 5, v8
    v_and_b32 v10, 3, v1
    v_lshl_add_u32 v8, v10, 3, v8
    v_xor_b32 v12, 32, v8
    v_add_u32 v13, 81920, v8
    v_add_u32 v20, 81920, v12
    s_lshl_b32 s28, s21, 7
    v_lshl_add_u32 v9, v1, 1, s28
    v_and_b32 v24, 31, v9
    v_lshrrev_b32 v25, 5, v9
    v_cmp_gt_u32 vcc, 16, v25
    v_cmp_lt_u32 s[24:25], 16, v24
    v_cmp_eq_u32 s[26:27], 0, v24
    s_nop 1
    s_and_b64 s[26:27], s[26:27], vcc
    s_or_b64 s[24:25], s[24:25], s[26:27]
    v_cmp_eq_u32 s[26:27], 16, v24
    s_nop 1
    s_andn2_b64 s[26:27], s[26:27], vcc
    s_or_b64 s[24:25], s[24:25], s[26:27]
    v_sub_u32 v26, 1024, v9
    v_cndmask_b32_e64 v26, v9, v26, s[24:25]
    v_mov_b32 v27, 512
    v_cmp_eq_u32 vcc, 1024, v26
    s_nop 1
    v_cndmask_b32_e64 v26, v26, v27, vcc
    v_lshrrev_b32 v27, 5, v26
    v_and_b32 v26, 15, v26
    v_lshrrev_b32 v16, 2, v27
    v_lshlrev_b32 v16, 8, v16
    v_and_b32 v27, 3, v27
    v_lshl_add_u32 v16, v27, 4, v16
    v_lshrrev_b32 v27, 3, v26
    v_lshl_add_u32 v16, v27, 6, v16
    v_and_b32 v26, 7, v26
    v_lshl_add_u32 v16, v26, 1, v16
    v_cndmask_b32_e64 v26, 0, 1, s[24:25]
    v_lshl_add_u32 v16, v26, 7, v16
    v_add_u32 v9, 1, v9
    v_and_b32 v24, 31, v9
    v_lshrrev_b32 v25, 5, v9
    v_cmp_gt_u32 vcc, 16, v25
    v_cmp_lt_u32 s[24:25], 16, v24
    v_cmp_eq_u32 s[26:27], 0, v24
    s_nop 1
    s_and_b64 s[26:27], s[26:27], vcc
    s_or_b64 s[24:25], s[24:25], s[26:27]
    v_cmp_eq_u32 s[26:27], 16, v24
    s_nop 1
    s_andn2_b64 s[26:27], s[26:27], vcc
    s_or_b64 s[24:25], s[24:25], s[26:27]
    v_sub_u32 v26, 1024, v9
    v_cndmask_b32_e64 v26, v9, v26, s[24:25]
    v_mov_b32 v27, 512
    v_cmp_eq_u32 vcc, 1024, v26
    s_nop 1
    v_cndmask_b32_e64 v26, v26, v27, vcc
    v_lshrrev_b32 v27, 5, v26
    v_and_b32 v26, 15, v26
    v_lshrrev_b32 v17, 2, v27
    v_lshlrev_b32 v17, 8, v17
    v_and_b32 v27, 3, v27
    v_lshl_add_u32 v17, v27, 4, v17
    v_lshrrev_b32 v27, 3, v26
    v_lshl_add_u32 v17, v27, 6, v17
    v_and_b32 v26, 7, v26
    v_lshl_add_u32 v17, v26, 1, v17
    v_cndmask_b32_e64 v26, 0, 1, s[24:25]
    v_lshl_add_u32 v17, v26, 7, v17
    s_lshl_b32 s28, s21, 8
    s_add_u32 s28, s28, 147456
    v_lshl_add_u32 v18, v1, 2, s28
    s_lshl_b32 s28, s21, 8
    s_add_u32 s28, s28, 147456
    v_lshlrev_b32 v19, 4, v2
    v_add_u32 v19, s28, v19
    v_mov_b32 v28, 149504
    v_lshlrev_b32 v29, 4, v1
    s_lshl_b32 s30, s22, 3
    s_add_u32 s30, s30, s3
    s_lshl_b32 s30, s30, 3
    s_add_u32 s30, s30, s21
    s_lshl_b32 s30, s30, 8
    s_add_u32 s30, s30, 0x488000
    v_lshlrev_b32 v30, 4, v2
    v_lshl_add_u32 v30, v3, 6, v30
    v_cmp_eq_u32 s[60:61], 1, v3
    v_cmp_eq_u32 s[62:63], 2, v3
    v_cmp_eq_u32 s[64:65], 3, v3
    v_add_u32 v21, 149568, v29
    v_mov_b32 v197, 0xffffff00
    s_and_b32 s35, s2, 0x47
    s_lshl_b32 s31, s3, 3
    s_add_u32 s35, s35, s31
    s_add_u32 s35, s35, 58
    s_and_b32 s35, s35, 127
    s_getreg_b32 s33, hwreg(HW_REG_XCC_ID)
    s_and_b32 s33, s33, 15
    s_lshr_b32 s31, s35, 5
    s_lshl_b32 s31, s31, 2
    s_add_u32 s31, s31, 149520
    v_mov_b32 v22, s31
    s_lshl_b32 s20, s22, 3
    s_add_u32 s20, s20, s21
    s_and_b32 s34, s20, 15
    s_bfe_u32 s28, s20, 0x10004
    s_lshl_b32 s28, s28, 5
    s_add_u32 s34, s34, s28
    s_mul_i32 s34, s34, 2176
    s_add_u32 s34, s34, 0x580000
    s_waitcnt vmcnt(0)
    s_barrier
    ds_read_b64_tr_b16 v[32:33], v13 offset:0
    ds_read_b64_tr_b16 v[34:35], v13 offset:2048
    ds_read_b64_tr_b16 v[36:37], v13 offset:16384
    ds_read_b64_tr_b16 v[38:39], v13 offset:18432
    ds_read_b64_tr_b16 v[40:41], v13 offset:32768
    ds_read_b64_tr_b16 v[42:43], v13 offset:34816
    ds_read_b64_tr_b16 v[44:45], v13 offset:49152
    ds_read_b64_tr_b16 v[46:47], v13 offset:51200
    s_waitcnt lgkmcnt(0)
    ds_read_b64_tr_b16 v[48:49], v20 offset:0
    ds_read_b64_tr_b16 v[50:51], v20 offset:2048
    ds_read_b64_tr_b16 v[52:53], v20 offset:16384
    ds_read_b64_tr_b16 v[54:55], v20 offset:18432
    ds_read_b64_tr_b16 v[56:57], v20 offset:32768
    ds_read_b64_tr_b16 v[58:59], v20 offset:34816
    ds_read_b64_tr_b16 v[60:61], v20 offset:49152
    ds_read_b64_tr_b16 v[62:63], v20 offset:51200
    s_waitcnt lgkmcnt(0)
    ds_read_b64_tr_b16 v[64:65], v8 offset:0
    ds_read_b64_tr_b16 v[66:67], v8 offset:2048
    ds_read_b64_tr_b16 v[68:69], v8 offset:16384
    ds_read_b64_tr_b16 v[70:71], v8 offset:18432
    ds_read_b64_tr_b16 v[72:73], v8 offset:32768
    ds_read_b64_tr_b16 v[74:75], v8 offset:34816
    ds_read_b64_tr_b16 v[76:77], v8 offset:49152
    ds_read_b64_tr_b16 v[78:79], v8 offset:51200
    s_waitcnt lgkmcnt(0)
    ds_read_b64_tr_b16 v[80:81], v12 offset:0
    ds_read_b64_tr_b16 v[82:83], v12 offset:2048
    ds_read_b64_tr_b16 v[84:85], v12 offset:16384
    ds_read_b64_tr_b16 v[86:87], v12 offset:18432
    ds_read_b64_tr_b16 v[88:89], v12 offset:32768
    ds_read_b64_tr_b16 v[90:91], v12 offset:34816
    ds_read_b64_tr_b16 v[92:93], v12 offset:49152
    ds_read_b64_tr_b16 v[94:95], v12 offset:51200
    s_waitcnt lgkmcnt(0)
    s_cmp_lg_u32 s3, 0
    s_cbranch_scc1 ffn_w3
    v_lshlrev_b32 v23, 4, v1
    v_add_u32 v24, 1024, v23
    s_lshl_b32 s28, s20, 4
    s_add_u32 s28, s28, s34
    v_mov_b32 v10, 34828
    s_nop 4
ffn_p3:
    buffer_load_dword v11, v10, s[4:7], s28 offen sc1
    s_waitcnt vmcnt(0) lgkmcnt(0)
    v_cmp_ne_u32 vcc, s40, v11
    s_cbranch_vccnz ffn_p3_rt
ffn_p3_ok:
    s_mov_b32 s58, 0
    s_mov_b32 s54, -1
    s_nop 1
ffn_k3:
    buffer_load_dwordx4 v[200:203], v23, s[4:7], s34 offen sc1
    buffer_load_dwordx4 v[204:207], v24, s[4:7], s34 offen sc1
    s_waitcnt vmcnt(0)
    v_xor_b32 v208, s40, v203
    v_xor_b32 v209, s40, v207
    v_max_u32 v210, v200, v204
    v_or_b32 v208, v208, v209
    v_cmp_ne_u32 vcc, 0, v208
    s_cbranch_vccnz ffn_k3_rt
ffn_k3_ok:
    v_max_u32_dpp v210, v210, v210 quad_perm:[1,0,3,2] row_mask:0xf bank_mask:0xf
    s_nop 1
    v_max_u32_dpp v210, v210, v210 quad_perm:[2,3,0,1] row_mask:0xf bank_mask:0xf
    s_nop 1
    v_max_u32_dpp v210, v210, v210 row_half_mirror row_mask:0xf bank_mask:0xf
    s_nop 1
    v_max_u32_dpp v210, v210, v210 row_mirror row_mask:0xf bank_mask:0xf
    s_nop 1
    v_max_u32_dpp v210, v210, v210 row_bcast:15 row_mask:0xa bank_mask:0xf
    s_nop 1
    v_max_u32_dpp v210, v210, v210 row_bcast:31 row_mask:0xc bank_mask:0xf
    s_nop 0
    v_readlane_b32 s36, v210, 63
    s_nop 1
    v_cmp_eq_u32 vcc, s36, v200
    v_cmp_eq_u32 s[28:29], s36, v204
    s_nop 0
    s_cmp_lg_u64 vcc, 0
    s_cselect_b32 s39, 0, 64
    s_or_b64 vcc, vcc, s[28:29]
    s_ff1_i32_b64 s41, vcc
    s_add_u32 s39, s39, s41
    s_lshl_b32 s39, s39, 11
    s_add_u32 s39, s39, 0x448000
    s_mov_b32 s58, 0
ffn_c3:
    buffer_load_short_d16_hi v14, v16, s[4:7], s39 offen sc1
    buffer_load_short_d16_hi v15, v17, s[4:7], s39 offen sc1
ffn_c3d:
    v_and_b32 v10, 15, v201
    v_and_b32 v11, 15, v205
    v_cmp_eq_u32 s[24:25], s33, v10
    v_cmp_eq_u32 s[26:27], s33, v11
    s_nop 0
    v_mov_b32 v212, s24
    v_mov_b32 v213, s25
    v_mov_b32 v214, s26
    v_mov_b32 v215, s27
    v_cndmask_b32_e64 v209, v201, v205, s[28:29]
    v_cndmask_b32_e64 v210, v202, v206, s[28:29]
    ds_write_b128 v28, v[212:215] offset:16
    v_readlane_b32 s24, v209, s41
    v_readlane_b32 s25, v210, s41
    s_mov_b64 s[42:43], vcc
    s_and_b32 s24, s24, 0xffff0000
    s_mov_b32 s26, 0xffff0000
    s_waitcnt vmcnt(0)
    v_max_u32 v10, v14, v15
    v_add_f32 v14, s24, v14
    v_add_f32 v15, s24, v15
    v_cvt_pk_bf16_f32 v14, 0, v14
    v_cvt_pk_bf16_f32 v15, 0, v15
    v_mul_f32 v14, s25, v14
    v_mul_f32 v15, s25, v15
    v_cvt_pk_bf16_f32 v14, v14, v15
    ds_write_b32 v18, v14
    v_cmp_eq_u32 vcc, s26, v10
    s_cbranch_vccnz ffn_c3_rt
ffn_c3_ok:
    s_waitcnt lgkmcnt(0)
    s_nop 2
ffn_w3:
    s_barrier
    ds_read_b32 v203, v22
    ds_read_b128 v[128:131], v19 offset:0
    ds_read_b128 v[132:135], v19 offset:64
    ds_read_b128 v[136:139], v19 offset:128
    ds_read_b128 v[140:143], v19 offset:192
    s_waitcnt lgkmcnt(3)
    v_mfma_f32_16x16x32_bf16 v[192:195], v[32:35], v[128:131], 0
    v_mfma_f32_16x16x32_bf16 v[148:151], v[48:51], v[128:131], 0
    v_mfma_f32_16x16x32_bf16 v[152:155], v[64:67], v[128:131], 0
    v_mfma_f32_16x16x32_bf16 v[156:159], v[80:83], v[128:131], 0
    s_waitcnt lgkmcnt(2)
    v_mfma_f32_16x16x32_bf16 v[192:195], v[36:39], v[132:135], v[192:195]
    v_mfma_f32_16x16x32_bf16 v[148:151], v[52:55], v[132:135], v[148:151]
    v_mfma_f32_16x16x32_bf16 v[152:155], v[68:71], v[132:135], v[152:155]
    v_mfma_f32_16x16x32_bf16 v[156:159], v[84:87], v[132:135], v[156:159]
    s_waitcnt lgkmcnt(1)
    v_mfma_f32_16x16x32_bf16 v[192:195], v[40:43], v[136:139], v[192:195]
    v_mfma_f32_16x16x32_bf16 v[148:151], v[56:59], v[136:139], v[148:151]
    v_mfma_f32_16x16x32_bf16 v[152:155], v[72:75], v[136:139], v[152:155]
    v_mfma_f32_16x16x32_bf16 v[156:159], v[88:91], v[136:139], v[156:159]
    s_waitcnt lgkmcnt(0)
    v_mfma_f32_16x16x32_bf16 v[192:195], v[44:47], v[140:143], v[192:195]
    v_mfma_f32_16x16x32_bf16 v[148:151], v[60:63], v[140:143], v[148:151]
    v_mfma_f32_16x16x32_bf16 v[152:155], v[76:79], v[140:143], v[152:155]
    v_mfma_f32_16x16x32_bf16 v[156:159], v[92:95], v[140:143], v[156:159]
    v_readfirstlane_b32 s24, v203
    s_nop 4
    v_cndmask_b32_e64 v192, v192, v148, s[60:61]
    v_cndmask_b32_e64 v193, v193, v149, s[60:61]
    v_cndmask_b32_e64 v194, v194, v150, s[60:61]
    v_cndmask_b32_e64 v195, v195, v151, s[60:61]
    v_cndmask_b32_e64 v192, v192, v152, s[62:63]
    v_cndmask_b32_e64 v193, v193, v153, s[62:63]
    v_cndmask_b32_e64 v194, v194, v154, s[62:63]
    v_cndmask_b32_e64 v195, v195, v155, s[62:63]
    v_cndmask_b32_e64 v192, v192, v156, s[64:65]
    v_cndmask_b32_e64 v193, v193, v157, s[64:65]
    v_cndmask_b32_e64 v194, v194, v158, s[64:65]
    v_cndmask_b32_e64 v195, v195, v159, s[64:65]
    s_mov_b32 exec_lo, 0x000f000f
    s_mov_b32 exec_hi, 0x000f000f
    v_and_or_b32 v192, v192, v197, s48
    v_and_or_b32 v193, v193, v197, s49
    v_and_or_b32 v194, v194, v197, s50
    v_and_or_b32 v195, v195, v197, s51
    s_bitcmp1_b32 s24, s35
    s_cbranch_scc0 ffn_rem
    buffer_store_dwordx4 v[192:195], v30, s[4:7], s30 offen
ffn_fin:
    s_endpgm
ffn_rem:
    buffer_store_dwordx4 v[192:195], v30, s[4:7], s30 offen sc1
    s_branch ffn_fin
ffn_c3_rt:
    s_mov_b64 vcc, s[42:43]
    s_add_u32 s58, s58, 1
    s_cmp_lt_u32 s58, 0x10000
    s_cbranch_scc1 ffn_c3
    s_branch ffn_c3_ok
fz_h1_r0:
    s_add_u32 s58, s58, 1
    s_cmp_gt_u32 s58, 0x10000
    s_cbranch_scc1 fz_h1_o0
    buffer_load_dwordx4 v[104:107], v222, s[4:7], s60 offen sc1
    buffer_load_dwordx4 v[108:111], v222, s[4:7], s61 offen sc1
    buffer_load_dwordx4 v[112:115], v222, s[4:7], s16 offen sc1
    buffer_load_dwordx4 v[116:119], v222, s[4:7], s17 offen sc1
    s_branch fz_h1_c0
fz_h1_r1:
    s_add_u32 s58, s58, 1
    s_cmp_gt_u32 s58, 0x10000
    s_cbranch_scc1 fz_h1_o1
    buffer_load_dwordx4 v[108:111], v222, s[4:7], s61 offen sc1
    buffer_load_dwordx4 v[112:115], v222, s[4:7], s16 offen sc1
    buffer_load_dwordx4 v[116:119], v222, s[4:7], s17 offen sc1
    s_branch fz_h1_c1
fz_h1_r2:
    s_add_u32 s58, s58, 1
    s_cmp_gt_u32 s58, 0x10000
    s_cbranch_scc1 fz_h1_o2
    buffer_load_dwordx4 v[112:115], v222, s[4:7], s16 offen sc1
    buffer_load_dwordx4 v[116:119], v222, s[4:7], s17 offen sc1
    s_branch fz_h1_c2
fz_h1_r3:
    s_add_u32 s58, s58, 1
    s_cmp_gt_u32 s58, 0x10000
    s_cbranch_scc1 fz_h1_o3
    buffer_load_dwordx4 v[116:119], v222, s[4:7], s17 offen sc1
    s_branch fz_h1_c3
fz_h2_r0:
    s_add_u32 s58, s58, 1
    s_cmp_gt_u32 s58, 0x10000
    s_cbranch_scc1 fz_h2_o0
    buffer_load_dwordx2 v[104:105], v228, s[4:7], s52 offen sc1
    buffer_load_dwordx2 v[106:107], v228, s[4:7], s53 offen sc1
    buffer_load_dwordx2 v[108:109], v228, s[4:7], s54 offen sc1
    buffer_load_dwordx2 v[110:111], v228, s[4:7], s55 offen sc1
    s_branch fz_h2_c0
fz_h2_r1:
    s_add_u32 s58, s58, 1
    s_cmp_gt_u32 s58, 0x10000
    s_cbranch_scc1 fz_h2_o1
    buffer_load_dwordx2 v[106:107], v228, s[4:7], s53 offen sc1
    buffer_load_dwordx2 v[108:109], v228, s[4:7], s54 offen sc1
    buffer_load_dwordx2 v[110:111], v228, s[4:7], s55 offen sc1
    s_branch fz_h2_c1
fz_h2_r2:
    s_add_u32 s58, s58, 1
    s_cmp_gt_u32 s58, 0x10000
    s_cbranch_scc1 fz_h2_o2
    buffer_load_dwordx2 v[108:109], v228, s[4:7], s54 offen sc1
    buffer_load_dwordx2 v[110:111], v228, s[4:7], s55 offen sc1
    s_branch fz_h2_c2
fz_h2_r3:
    s_add_u32 s58, s58, 1
    s_cmp_gt_u32 s58, 0x10000
    s_cbranch_scc1 fz_h2_o3
    buffer_load_dwordx2 v[110:111], v228, s[4:7], s55 offen sc1
    s_branch fz_h2_c3
fz_h5_r0:
    s_add_u32 s58, s58, 1
    s_cmp_gt_u32 s58, 0x10000
    s_cbranch_scc1 fz_h5_o0
    buffer_load_dwordx4 v[40:43], v3, s[4:7], s52 offen sc1
    buffer_load_dwordx4 v[44:47], v3, s[4:7], s53 offen sc1
    buffer_load_dwordx4 v[48:51], v3, s[4:7], s54 offen sc1
    buffer_load_dwordx4 v[52:55], v6, s[4:7], s55 offen sc1
    s_branch fz_h5_c0
fz_h5_r1:
    s_add_u32 s58, s58, 1
    s_cmp_gt_u32 s58, 0x10000
    s_cbranch_scc1 fz_h5_o1
    buffer_load_dwordx4 v[44:47], v3, s[4:7], s53 offen sc1
    buffer_load_dwordx4 v[48:51], v3, s[4:7], s54 offen sc1
    buffer_load_dwordx4 v[52:55], v6, s[4:7], s55 offen sc1
    s_branch fz_h5_c1
fz_h5_r2:
    s_add_u32 s58, s58, 1
    s_cmp_gt_u32 s58, 0x10000
    s_cbranch_scc1 fz_h5_o2
    buffer_load_dwordx4 v[48:51], v3, s[4:7], s54 offen sc1
    buffer_load_dwordx4 v[52:55], v6, s[4:7], s55 offen sc1
    s_branch fz_h5_c2
fz_h5_r3:
    s_add_u32 s58, s58, 1
    s_cmp_gt_u32 s58, 0x10000
    s_cbranch_scc1 fz_h5_o3
    buffer_load_dwordx4 v[52:55], v6, s[4:7], s55 offen sc1
    s_branch fz_h5_c3
fz_p1_rt:
    s_add_u32 s58, s58, 1
    s_cmp_lt_u32 s58, 0x10000
    s_cbranch_scc1 fz_p1
    s_branch fz_p1_ok
fz_k2_rt:
    s_add_u32 s58, s58, 1
    s_cmp_lt_u32 s58, 0x10000
    s_cbranch_scc1 fz_k2
    s_branch fz_k2_ok
fz_c2_rt:
    s_add_u32 s58, s58, 1
    s_cmp_lt_u32 s58, 0x10000
    s_cbranch_scc1 fz_c2
    s_branch fz_c2_ok
fz_p5_rt:
    s_add_u32 s58, s58, 1
    s_cmp_lt_u32 s58, 0x10000
    s_cbranch_scc1 fz_p5
    s_branch fz_p5_ok
fz_h4_rt:
    s_add_u32 s58, s58, 1
    s_cmp_lt_u32 s58, 0x10000
    s_cbranch_scc1 fz_h4
    s_branch fz_h4_ok
ffn_p3_rt:
    s_add_u32 s58, s58, 1
    s_cmp_lt_u32 s58, 0x10000
    s_cbranch_scc1 ffn_p3
    s_branch ffn_p3_ok
ffn_k3_rt:
    s_add_u32 s58, s58, 1
    s_cmp_lt_u32 s58, 0x10000
    s_cbranch_scc1 ffn_k3
    s_branch ffn_k3_ok
fz_codeend:
.section .rodata,"a"
.p2align 6
.amdhsa_kernel fz_kernel
  .amdhsa_next_free_vgpr 256
  .amdhsa_next_free_sgpr 102
  .amdhsa_accum_offset 256
  .amdhsa_group_segment_fixed_size 0
  .amdhsa_kernarg_size 104
  .amdhsa_user_sgpr_count 2
  .amdhsa_user_sgpr_kernarg_segment_ptr 1
  .amdhsa_system_sgpr_workgroup_id_x 1
.end_amdhsa_kernel
```

```asm
; @launch kernel=fz_kernel grid=(256,1,1) block=(512,1,1) lds=163840
.amdgcn_target "amdgcn-amd-amdhsa--gfx950"
.text
.globl fz_kernel
.p2align 8
.type fz_kernel,@function
fz_kernel:
    s_load_dwordx2 s[4:5], s[0:1], 96
    s_load_dwordx2 s[8:9], s[0:1], 0
    s_load_dwordx2 s[64:65], s[0:1], 72
    s_cmp_gt_u32 s2, 255
    s_cbranch_scc1 fz_end
    v_lshrrev_b32 v2, 6, v0
    v_and_b32 v1, 63, v0
    s_lshr_b32 s59, s2, 7
    v_readfirstlane_b32 s3, v2
    s_and_b32 s20, s2, 127
    s_cmp_lt_u32 s20, 8
    s_cselect_b32 s20, s3, 0
    s_cmp_lt_u32 s20, 4
    s_cbranch_scc1 fz_pfcback
    s_getpc_b64 s[20:21]
fz_pcb:
    s_sub_u32 s20, s20, fz_pcb-fz_kernel
    s_subb_u32 s21, s21, 0
    v_and_b32 v3, 255, v0
    v_lshlrev_b32 v3, 7, v3
    v_min_u32 v3, fz_codeend-fz_kernel-4, v3
    v_mov_b32 v5, s21
    v_add_co_u32 v4, vcc, s20, v3
    s_nop 1
    v_addc_co_u32 v5, vcc, 0, v5, vcc
    global_load_dword v251, v[4:5], off
fz_pfcback:
    s_cmp_lg_u32 s59, 0
    s_cbranch_scc1 fz_ldh
    s_load_dwordx2 s[12:13], s[0:1], 80
    s_load_dwordx2 s[16:17], s[0:1], 48
fz_ldback:
    s_add_u32 s20, s2, 58
    s_and_b32 s20, s20, 127
    s_lshr_b32 s21, s20, 3
    s_add_u32 s21, s21, 1
    s_and_b32 s22, s20, 7
    s_sub_u32 s23, s20, 124
    s_cmp_ge_u32 s20, 124
    s_cselect_b32 s21, 0, s21
    s_cselect_b32 s22, s23, s22
    s_lshr_b32 s57, s3, 2
    s_or_b32 s23, s57, s59
    s_and_b32 s24, s3, 3
    s_lshl_b32 s25, s22, 6
    s_add_u32 s25, s25, s21
    s_lshl_b32 s26, s23, 5
    s_add_u32 s26, s26, s25
    s_lshl_b32 s27, s24, 9
    s_add_u32 s28, s26, s27
    s_sub_u32 s27, 2048, s27
    s_sub_u32 s27, s27, s26
    s_lshl_b32 s29, s24, 1
    s_add_u32 s29, s29, s23
    s_sub_u32 s30, 15, s29
    s_cmp_lt_u32 s24, 2
    s_cselect_b32 s27, s28, s27
    s_cselect_b32 s31, s29, s30
    s_cselect_b32 s30, s30, s29
    s_sub_u32 s28, 2048, s27
    s_and_b32 s28, s28, 2047
    s_lshl_b32 s27, s27, 11
    s_lshl_b32 s28, s28, 11
    s_mul_i32 s31, s31, 2064
    s_mul_i32 s30, s30, 2064
    v_lshlrev_b32 v239, 4, v1
    s_mov_b32 s10, 0x400000
    s_mov_b32 s11, 0x00020000
    s_mov_b32 s6, 0x690000
    s_mov_b32 s7, 0x00020000
    s_mov_b32 s66, 0x700000
    s_mov_b32 s67, 0x00020000
    s_and_b32 s32, s57, s59
    s_add_u32 s36, s2, 4
    s_and_b32 s36, s36, 7
    s_bfe_u32 s37, s2, 0x10006
    s_lshl_b32 s63, s36, 1
    s_add_u32 s63, s63, s37
    s_cmp_lg_u32 s37, 0
    s_cselect_b32 s37, 8, s36
    s_add_u32 s37, s37, 6
    s_cmp_lt_u32 s36, 6
    s_cselect_b32 s63, s63, s37
    s_lshl_b32 s63, s63, 3
    s_bfe_u32 s37, s2, 0x30003
    s_add_u32 s63, s63, s37
    v_and_b32 v10, 15, v1
    v_lshlrev_b32 v10, 4, v10
    v_lshrrev_b32 v14, 4, v1
    v_lshl_add_u32 v14, v14, 11, v10
    s_lshl_b32 s62, s63, 16
    s_and_b32 s37, s3, 3
    s_lshl_b32 s37, s37, 9
    s_add_u32 s62, s62, s37
    s_mov_b32 s58, 0
    s_waitcnt lgkmcnt(0)
    s_cmp_eq_u32 s2, 66
    s_cbranch_scc1 fz_spec
fz_specback:
    s_cmp_lg_u32 s57, 0
    s_cbranch_scc1 fz_nox
    s_mov_b32 m0, s31
    s_nop 0
    buffer_load_dwordx4 v239, s[8:11], s27 offen nt lds
    buffer_load_dwordx4 v239, s[8:11], s27 offen offset:1024 nt lds
    s_mov_b32 m0, s30
    s_nop 0
    buffer_load_dwordx4 v239, s[8:11], s28 offen nt lds
    buffer_load_dwordx4 v239, s[8:11], s28 offen offset:1024 nt lds
fz_nox:
    buffer_load_dword v250, off, s[4:7], 0
    s_andn2_b32 s32, s57, s59
    s_cbranch_scc0 fz_nowe
    buffer_load_dwordx4 v[160:163], v14, s[64:67], s62 offen offset:0 nt
    buffer_load_dwordx4 v[164:167], v14, s[64:67], s62 offen offset:256 nt
    s_add_u32 s62, s62, 8192
    buffer_load_dwordx4 v[168:171], v14, s[64:67], s62 offen offset:0 nt
    buffer_load_dwordx4 v[172:175], v14, s[64:67], s62 offen offset:256 nt
    s_add_u32 s62, s62, 8192
fz_nowe:
    s_cmp_eq_u32 s57, 0
    s_cbranch_scc1 fz_np
    s_setprio 1
fz_np:
    v_and_b32 v2, 31, v1
    v_lshrrev_b32 v3, 5, v1
    v_and_b32 v4, 15, v1
    v_lshrrev_b32 v5, 4, v1
    v_add_u32 v6, 49536, v239
    v_lshrrev_b32 v10, 1, v2
    v_and_b32 v8, 9, v10
    v_and_b32 v11, 2, v10
    v_lshl_or_b32 v8, v11, 1, v8
    v_bfe_u32 v11, v10, 2, 1
    v_lshl_or_b32 v8, v11, 1, v8
    v_and_b32 v12, 1, v5
    v_cmp_eq_u32 vcc, 1, v12
    v_lshl_add_u32 v9, v4, 1, 1
    s_nop 0
    v_cndmask_b32_e64 v9, v9, 0, vcc
    s_cmp_lt_u32 s3, 5
    s_cselect_b64 s[32:33], -1, 0
    s_cmp_lt_u32 s3, 3
    s_cselect_b64 s[34:35], -1, 0
    v_cndmask_b32_e64 v9, v9, v2, s[32:33]
    v_cndmask_b32_e64 v8, v9, v8, s[34:35]
    s_mov_b32 s36, 0x3d000000
    s_cmp_gt_u32 s3, 4
    s_cselect_b32 s36, 0x3c800000, s36
    s_sub_u32 s37, s3, 1
    s_cmp_lt_u32 s37, 2
    s_cselect_b32 s36, 0x3a800000, s36
    s_cmp_eq_u32 s3, 0
    s_cselect_b32 s32, 16, 0
    s_cselect_b32 s33, 0x3e800000, 0
    s_cselect_b32 s34, 4.0, 0x41000000
    s_cselect_b32 s35, 0x41000000, 4.0
    v_cmp_eq_u32 vcc, 1, v2
    v_mov_b32 v10, s32
    s_nop 0
    v_cndmask_b32_e64 v10, 0, v10, vcc
    v_add_u32 v8, v8, v10
    v_cvt_f32_u32 v8, v8
    v_mul_f32 v8, s36, v8
    s_cmp_eq_u32 s3, 2
    s_cselect_b32 s32, 0x80000000, 0
    v_lshlrev_b32 v10, 31, v2
    v_and_b32 v10, s32, v10
    v_xor_b32 v8, v10, v8
    v_and_b32 v10, 1, v2
    v_cvt_f32_u32 v10, v10
    v_mul_f32 v10, s33, v10
    s_cmp_eq_u32 s3, 1
    s_cselect_b32 s33, 0x3e800000, 0
    v_mov_b32 v11, s33
    v_cndmask_b32_e64 v10, v10, v11, vcc
    s_cmp_eq_u32 s3, 5
    s_cselect_b32 s33, 0x3e800000, 0
    v_cvt_f32_u32 v12, v12
    v_fma_f32 v10, v12, s33, v10
    s_cmp_eq_u32 s3, 6
    s_cselect_b32 s33, 0x3e800000, 0
    s_cmp_eq_u32 s3, 2
    s_cselect_b32 s33, 0xbe800000, s33
    s_cmp_eq_u32 s3, 4
    s_cselect_b32 s33, 0xbe800000, s33
    v_add_f32 v10, s33, v10
    v_cvt_f32_u32 v11, v3
    v_mul_f32 v11, s35, v11
    v_fma_f32 v9, v8, v11, v10
    v_mul_f32 v10, s34, v8
    v_mul_f32 v11, 0x41800000, v8
    v_mov_b32 v104, v9
    v_fmamk_f32 v105, v8, 0x3f800000, v9
    v_fmamk_f32 v106, v8, 0x40000000, v9
    v_fmamk_f32 v107, v8, 0x40400000, v9
    v_add_f32 v108, v104, v10
    v_add_f32 v109, v105, v10
    v_add_f32 v110, v106, v10
    v_add_f32 v111, v107, v10
    v_add_f32 v112, v104, v11
    v_add_f32 v113, v105, v11
    v_add_f32 v114, v106, v11
    v_add_f32 v115, v107, v11
    v_add_f32 v116, v108, v11
    v_add_f32 v117, v109, v11
    v_add_f32 v118, v110, v11
    v_add_f32 v119, v111, v11
    v_cos_f32 v104, v104
    v_cos_f32 v105, v105
    v_cos_f32 v106, v106
    v_cos_f32 v107, v107
    v_cos_f32 v108, v108
    v_cos_f32 v109, v109
    v_cos_f32 v110, v110
    v_cos_f32 v111, v111
    v_cos_f32 v112, v112
    v_cos_f32 v113, v113
    v_cos_f32 v114, v114
    v_cos_f32 v115, v115
    v_cos_f32 v116, v116
    v_cos_f32 v117, v117
    v_cos_f32 v118, v118
    v_cos_f32 v119, v119
    s_lshl_b32 s32, s3, 11
    v_add_u32 v8, s32, v6
    s_cmp_eq_u32 s3, 0
    s_cbranch_scc1 fz_jb
    v_cvt_pk_f16_f32 v128, v104, v105
    v_cvt_pk_f16_f32 v129, v106, v107
    v_cvt_pk_f16_f32 v130, v108, v109
    v_cvt_pk_f16_f32 v131, v110, v111
    v_cvt_pk_f16_f32 v132, v112, v113
    v_cvt_pk_f16_f32 v133, v114, v115
    v_cvt_pk_f16_f32 v134, v116, v117
    v_cvt_pk_f16_f32 v135, v118, v119
fz_jend:
    ds_write_b128 v8, v[128:131] offset:0
    ds_write_b128 v8, v[132:135] offset:1024
    v_mov_b32 v15, 49520
    v_mov_b32 v10, 0
    ds_write_b32 v15, v10
    s_waitcnt lgkmcnt(0)
    s_barrier
    v_lshlrev_b32 v240, 31, v1
    v_lshrrev_b32 v10, 16, v240
    v_or_b32 v240, v240, v10
    v_mov_b32 v229, 0xfffcfffc
    v_mov_b32 v242, 0xffff0000
    s_mov_b32 s42, 0x3f803f80
    s_cmp_lg_u32 s57, 0
    s_cbranch_scc1 fz_nc1
    ds_read_b128 v[16:19], v6 offset:0
    ds_read_b128 v[20:23], v6 offset:1024
    ds_read_b128 v[24:27], v6 offset:2048
    ds_read_b128 v[28:31], v6 offset:3072
    ds_read_b128 v[32:35], v6 offset:4096
    ds_read_b128 v[36:39], v6 offset:5120
    ds_read_b128 v[40:43], v6 offset:6144
    ds_read_b128 v[44:47], v6 offset:7168
    ds_read_b128 v[48:51], v6 offset:8192
    ds_read_b128 v[52:55], v6 offset:9216
    ds_read_b128 v[56:59], v6 offset:10240
    ds_read_b128 v[60:63], v6 offset:11264
    ds_read_b128 v[64:67], v6 offset:12288
    ds_read_b128 v[68:71], v6 offset:13312
    v_lshlrev_b32 v7, 9, v3
    v_bfe_u32 v10, v1, 2, 2
    v_lshl_add_u32 v7, v10, 6, v7
    v_and_b32 v10, 1, v5
    v_lshl_add_u32 v7, v10, 5, v7
    v_and_b32 v10, 3, v1
    v_lshl_add_u32 v7, v10, 3, v7
    v_add_u32 v7, s31, v7
    v_lshlrev_b32 v8, 9, v3
    v_lshl_add_u32 v8, v2, 1, v8
    v_sub_u32 v9, 2048, v8
    v_and_b32 v9, 2047, v9
    v_add_u32 v9, s30, v9
    s_add_u32 s32, s30, 576
    v_sub_u32 v8, s32, v8
    v_cmp_eq_u32 vcc, 0, v2
    s_nop 1
    v_cndmask_b32_e64 v234, 0, -2.0, vcc
    v_mov_b32 v235, 0x3b27c5ac
    s_lshr_b32 s32, s24, 1
    s_lshl_b32 s32, s32, 6
    s_mul_i32 s33, s3, 2304
    s_add_u32 s32, s32, s33
    s_add_u32 s32, s32, 67968
    v_lshl_add_u32 v10, v3, 1, v1
    v_lshlrev_b32 v10, 4, v10
    v_add_u32 v216, s32, v10
    v_bfe_u32 v10, v0, 2, 1
    v_mul_u32_u24 v10, 34, v10
    v_lshrrev_b32 v11, 4, v0
    v_add_u32 v10, v10, v11
    v_lshlrev_b32 v10, 4, v10
    v_bfe_u32 v11, v0, 3, 1
    v_lshl_add_u32 v10, v11, 3, v10
    v_bfe_u32 v11, v0, 1, 1
    v_lshl_add_u32 v10, v11, 2, v10
    v_and_b32 v12, 1, v0
    s_mov_b32 s33, 9216
    s_cmp_eq_u32 s2, 66
    s_cselect_b32 s32, s33, 0x1b40
    v_mul_lo_u32 v11, v12, s32
    v_add_u32 v217, v10, v11
    v_add_u32 v217, 67968, v217
    s_cselect_b32 s32, s33, 0x940
    v_mul_lo_u32 v11, v12, s32
    v_add_u32 v218, v10, v11
    v_add_u32 v218, 70272, v218
    s_cselect_b32 s32, s33, 0xfffff6c0
    v_mul_lo_u32 v11, v12, s32
    v_add_u32 v219, v10, v11
    v_add_u32 v219, 73792, v219
    s_cselect_b32 s32, s33, 0xffffe4c0
    v_mul_lo_u32 v11, v12, s32
    v_add_u32 v220, v10, v11
    v_add_u32 v220, 76096, v220
    v_lshrrev_b32 v10, 2, v0
    v_and_b32 v11, 3, v0
    v_lshlrev_b32 v11, 4, v11
    v_lshl_add_u32 v221, v10, 7, v11
    s_mul_i32 s52, s20, 16512
    s_lshl_b32 s33, s59, 6
    s_add_u32 s52, s52, s33
    s_add_u32 s52, s52, 0x1000
    s_add_u32 s53, s52, 8192
    v_mov_b32 v160, 0
    v_mov_b32 v161, 0
    v_mov_b32 v162, 0
    v_mov_b32 v163, 0
    s_setprio 3
    s_waitcnt vmcnt(0) lgkmcnt(0)
    ds_read_b64_tr_b16 v[88:89], v7 offset:0
    ds_read_b64_tr_b16 v[90:91], v7 offset:256
    ds_read_b64_tr_b16 v[92:93], v7 offset:1024
    ds_read_b64_tr_b16 v[94:95], v7 offset:1280
    ds_read_u16_d16 v96, v9
    ds_read_u16_d16_hi v136, v8 offset:1408
    ds_read_u16_d16 v97, v8 offset:1344
    ds_read_u16_d16_hi v137, v8 offset:1280
    ds_read_u16_d16 v98, v8 offset:1216
    ds_read_u16_d16_hi v138, v8 offset:1152
    ds_read_u16_d16 v99, v8 offset:1088
    ds_read_u16_d16_hi v139, v8 offset:1024
    s_waitcnt lgkmcnt(8)
    v_mfma_f32_32x32x16_bf16 v[104:119], v[88:91], v[16:19], 0
    v_mfma_f32_32x32x16_bf16 v[104:119], v[92:95], v[20:23], v[104:119]
    ds_read_u16_d16 v100, v8 offset:448
    ds_read_u16_d16_hi v140, v8 offset:384
    ds_read_u16_d16 v101, v8 offset:320
    ds_read_u16_d16_hi v141, v8 offset:256
    ds_read_u16_d16 v102, v8 offset:192
    ds_read_u16_d16_hi v142, v8 offset:128
    ds_read_u16_d16 v103, v8 offset:64
    ds_read_u16_d16_hi v143, v8 offset:0
    v_dot2_f32_bf16 v160, v88, s42, v160
    v_dot2_f32_bf16 v161, v88, v88, v161
    v_dot2_f32_bf16 v160, v89, s42, v160
    v_dot2_f32_bf16 v161, v89, v89, v161
    v_dot2_f32_bf16 v160, v90, s42, v160
    v_dot2_f32_bf16 v161, v90, v90, v161
    v_dot2_f32_bf16 v160, v91, s42, v160
    v_dot2_f32_bf16 v161, v91, v91, v161
    v_dot2_f32_bf16 v160, v92, s42, v160
    v_dot2_f32_bf16 v161, v92, v92, v161
    v_dot2_f32_bf16 v160, v93, s42, v160
    v_dot2_f32_bf16 v161, v93, v93, v161
    v_dot2_f32_bf16 v160, v94, s42, v160
    v_dot2_f32_bf16 v161, v94, v94, v161
    v_dot2_f32_bf16 v160, v95, s42, v160
    v_dot2_f32_bf16 v161, v95, v95, v161
    s_waitcnt lgkmcnt(0)
    v_or_b32 v96, v96, v136
    v_or_b32 v97, v97, v137
    v_or_b32 v98, v98, v138
    v_or_b32 v99, v99, v139
    v_or_b32 v100, v100, v140
    v_or_b32 v101, v101, v141
    v_or_b32 v102, v102, v142
    v_or_b32 v103, v103, v143
    v_mfma_f32_32x32x16_bf16 v[120:135], v[96:99], v[16:19], 0
    s_nop 0
    v_mfma_f32_32x32x16_bf16 v[120:135], v[100:103], v[20:23], v[120:135]
    v_dot2_f32_bf16 v162, v96, s42, v162
    v_dot2_f32_bf16 v163, v96, v96, v163
    v_dot2_f32_bf16 v162, v97, s42, v162
    v_dot2_f32_bf16 v163, v97, v97, v163
    v_dot2_f32_bf16 v162, v98, s42, v162
    v_dot2_f32_bf16 v163, v98, v98, v163
    v_dot2_f32_bf16 v162, v99, s42, v162
    v_dot2_f32_bf16 v163, v99, v99, v163
    v_dot2_f32_bf16 v162, v100, s42, v162
    v_dot2_f32_bf16 v163, v100, v100, v163
    v_dot2_f32_bf16 v162, v101, s42, v162
    v_dot2_f32_bf16 v163, v101, v101, v163
    v_dot2_f32_bf16 v162, v102, s42, v162
    v_dot2_f32_bf16 v163, v102, v102, v163
    v_dot2_f32_bf16 v162, v103, s42, v162
    v_dot2_f32_bf16 v163, v103, v103, v163
    s_nop 1
    v_permlane32_swap_b32 v160, v162
    v_permlane32_swap_b32 v161, v163
    v_add_f32 v160, v160, v162
    v_add_f32 v161, v161, v163
    s_nop 1
    v_permlane16_swap_b32 v160, v161
    v_add_f32 v160, v160, v161
    s_nop 1
    v_add_f32_dpp v160, v160, v160 quad_perm:[1,0,3,2] row_mask:0xf bank_mask:0xf
    s_nop 1
    v_add_f32_dpp v160, v160, v160 quad_perm:[2,3,0,1] row_mask:0xf bank_mask:0xf
    s_nop 1
    v_add_f32_dpp v160, v160, v160 row_half_mirror row_mask:0xf bank_mask:0xf
    s_nop 1
    v_add_f32_dpp v160, v160, v160 row_mirror row_mask:0xf bank_mask:0xf
    s_mov_b32 s43, 0x3e800000
    v_mov_b32 v161, v160
    s_nop 1
    v_permlane16_swap_b32 v160, v161
    v_mul_f32 v160, 0x3c800000, v160
    v_fma_f32 v161, v161, s43, v235
    v_fma_f32 v161, -v160, v160, v161
    v_rsq_f32 v161, v161
    s_nop 0
    v_mul_f32 v160, v160, v161
    v_readlane_b32 s32, v161, 0
    v_readlane_b32 s34, v161, 32
    v_readlane_b32 s36, v160, 0
    v_readlane_b32 s37, v160, 32
    s_nop 0
    v_mul_f32 v164, s36, v234
    v_fmac_f32 v164, s37, v234
    v_pk_fma_f32 v[104:105], v[104:105], s[32:33], v[164:165] op_sel_hi:[1,0,0]
    v_pk_fma_f32 v[106:107], v[106:107], s[32:33], v[164:165] op_sel_hi:[1,0,0]
    v_pk_fma_f32 v[108:109], v[108:109], s[32:33], v[164:165] op_sel_hi:[1,0,0]
    v_pk_fma_f32 v[110:111], v[110:111], s[32:33], v[164:165] op_sel_hi:[1,0,0]
    v_pk_fma_f32 v[112:113], v[112:113], s[32:33], v[164:165] op_sel_hi:[1,0,0]
    v_pk_fma_f32 v[114:115], v[114:115], s[32:33], v[164:165] op_sel_hi:[1,0,0]
    v_pk_fma_f32 v[116:117], v[116:117], s[32:33], v[164:165] op_sel_hi:[1,0,0]
    v_pk_fma_f32 v[118:119], v[118:119], s[32:33], v[164:165] op_sel_hi:[1,0,0]
    v_pk_fma_f32 v[104:105], v[120:121], s[34:35], v[104:105] op_sel_hi:[1,0,1]
    v_pk_fma_f32 v[106:107], v[122:123], s[34:35], v[106:107] op_sel_hi:[1,0,1]
    v_pk_fma_f32 v[108:109], v[124:125], s[34:35], v[108:109] op_sel_hi:[1,0,1]
    v_pk_fma_f32 v[110:111], v[126:127], s[34:35], v[110:111] op_sel_hi:[1,0,1]
    v_pk_fma_f32 v[112:113], v[128:129], s[34:35], v[112:113] op_sel_hi:[1,0,1]
    v_pk_fma_f32 v[114:115], v[130:131], s[34:35], v[114:115] op_sel_hi:[1,0,1]
    v_pk_fma_f32 v[116:117], v[132:133], s[34:35], v[116:117] op_sel_hi:[1,0,1]
    v_pk_fma_f32 v[118:119], v[134:135], s[34:35], v[118:119] op_sel_hi:[1,0,1]
    v_cvt_pk_f16_f32 v136, v104, v105
    v_cvt_pk_f16_f32 v137, v106, v107
    v_cvt_pk_f16_f32 v138, v108, v109
    v_cvt_pk_f16_f32 v139, v110, v111
    v_cvt_pk_f16_f32 v140, v112, v113
    v_cvt_pk_f16_f32 v141, v114, v115
    v_cvt_pk_f16_f32 v142, v116, v117
    v_cvt_pk_f16_f32 v143, v118, v119
    v_mov_b32_dpp v152, v136 quad_perm:[1,0,3,2] row_mask:0xf bank_mask:0xf
    v_mov_b32_dpp v153, v137 quad_perm:[1,0,3,2] row_mask:0xf bank_mask:0xf
    v_mov_b32_dpp v154, v138 quad_perm:[1,0,3,2] row_mask:0xf bank_mask:0xf
    v_mov_b32_dpp v155, v139 quad_perm:[1,0,3,2] row_mask:0xf bank_mask:0xf
    v_mov_b32_dpp v156, v140 quad_perm:[1,0,3,2] row_mask:0xf bank_mask:0xf
    v_mov_b32_dpp v157, v141 quad_perm:[1,0,3,2] row_mask:0xf bank_mask:0xf
    v_mov_b32_dpp v158, v142 quad_perm:[1,0,3,2] row_mask:0xf bank_mask:0xf
    v_mov_b32_dpp v159, v143 quad_perm:[1,0,3,2] row_mask:0xf bank_mask:0xf
    v_pk_mul_f16 v144, v136, v24
    v_pk_mul_f16 v145, v137, v25
    v_pk_mul_f16 v146, v138, v26
    v_pk_mul_f16 v147, v139, v27
    v_pk_mul_f16 v148, v140, v28
    v_pk_mul_f16 v149, v141, v29
    v_pk_mul_f16 v150, v142, v30
    v_pk_mul_f16 v151, v143, v31
    v_mfma_f32_16x16x32_f16 v[120:123], v[136:139], v[56:59], 0
    v_pk_fma_f16 v144, v152, v32, v144
    v_pk_fma_f16 v145, v153, v33, v145
    v_pk_fma_f16 v146, v154, v34, v146
    v_pk_fma_f16 v147, v155, v35, v147
    v_mfma_f32_16x16x32_f16 v[120:123], v[140:143], v[60:63], v[120:123]
    v_pk_fma_f16 v148, v156, v36, v148
    v_pk_fma_f16 v149, v157, v37, v149
    v_pk_fma_f16 v150, v158, v38, v150
    v_pk_fma_f16 v151, v159, v39, v151
    v_mfma_f32_32x32x16_f16 v[104:119], v[144:147], v[40:43], 0
    v_xor_b32_dpp v152, v144, v240 quad_perm:[1,0,3,2] row_mask:0xf bank_mask:0xf
    v_xor_b32_dpp v153, v145, v240 quad_perm:[1,0,3,2] row_mask:0xf bank_mask:0xf
    v_xor_b32_dpp v154, v146, v240 quad_perm:[1,0,3,2] row_mask:0xf bank_mask:0xf
    v_xor_b32_dpp v155, v147, v240 quad_perm:[1,0,3,2] row_mask:0xf bank_mask:0xf
    v_mfma_f32_32x32x16_f16 v[104:119], v[148:151], v[44:47], v[104:119]
    v_xor_b32_dpp v156, v148, v240 quad_perm:[1,0,3,2] row_mask:0xf bank_mask:0xf
    v_xor_b32_dpp v157, v149, v240 quad_perm:[1,0,3,2] row_mask:0xf bank_mask:0xf
    v_xor_b32_dpp v158, v150, v240 quad_perm:[1,0,3,2] row_mask:0xf bank_mask:0xf
    v_xor_b32_dpp v159, v151, v240 quad_perm:[1,0,3,2] row_mask:0xf bank_mask:0xf
    v_mfma_f32_32x32x16_f16 v[104:119], v[152:155], v[48:51], v[104:119]
    s_nop 0
    v_mfma_f32_32x32x16_f16 v[104:119], v[156:159], v[52:55], v[104:119]
    v_mfma_f32_16x16x32_f16 v[124:127], v[136:139], v[64:67], 0
    v_mfma_f32_16x16x32_f16 v[124:127], v[140:143], v[68:71], v[124:127]
    v_readfirstlane_b32 s40, v250
    s_nop 1
    s_add_u32 s40, s40, 1
    s_and_b32 s38, s40, 3
    s_and_b32 s39, s40, 15
    s_bfe_u32 s41, s40, 0x20002
    s_lshl_b32 s41, s41, 16
    s_or_b32 s44, s38, s41
    s_bfe_u32 s41, s40, 0x40004
    s_lshl_b32 s41, s41, 4
    s_or_b32 s48, s39, s41
    s_bfe_u32 s41, s40, 0x20004
    s_lshl_b32 s41, s41, 16
    s_or_b32 s45, s38, s41
    s_bfe_u32 s41, s40, 0x40008
    s_lshl_b32 s41, s41, 4
    s_or_b32 s49, s39, s41
    s_bfe_u32 s41, s40, 0x20006
    s_lshl_b32 s41, s41, 16
    s_or_b32 s46, s38, s41
    s_bfe_u32 s41, s40, 0x4000c
    s_lshl_b32 s41, s41, 4
    s_or_b32 s50, s39, s41
    s_bfe_u32 s41, s40, 0x20008
    s_lshl_b32 s41, s41, 16
    s_or_b32 s47, s38, s41
    s_bfe_u32 s41, s40, 0x40010
    s_lshl_b32 s41, s41, 4
    s_or_b32 s51, s39, s41
    s_mov_b32 s38, 0x404
    s_cmp_eq_u32 s2, 66
    s_cselect_b32 s39, 8, 4
    s_cselect_b32 s38, 8, s38
    s_mov_b64 vcc, 0xffff
    v_cvt_pk_f16_f32 v143, v118, v119
    v_cvt_pk_f16_f32 v142, v116, v117
    v_cvt_pk_f16_f32 v141, v114, v115
    v_cvt_pk_f16_f32 v140, v112, v113
    v_cvt_pk_f16_f32 v139, v110, v111
    v_cvt_pk_f16_f32 v138, v108, v109
    v_cvt_pk_f16_f32 v137, v106, v107
    v_cndmask_b32_e64 v104, v104, v121, vcc
    v_cndmask_b32_e64 v105, v105, v125, vcc
    v_pk_add_f16 v147, v142, v143 op_sel:[0,1] op_sel_hi:[1,0] neg_lo:[0,1]
    v_pk_add_f16 v151, v142, v143 op_sel:[0,1] op_sel_hi:[1,0] neg_hi:[1,0]
    v_pk_add_f16 v146, v140, v141 op_sel:[0,1] op_sel_hi:[1,0] neg_lo:[0,1]
    v_pk_add_f16 v150, v140, v141 op_sel:[0,1] op_sel_hi:[1,0] neg_hi:[1,0]
    v_pk_add_f16 v145, v138, v139 op_sel:[0,1] op_sel_hi:[1,0] neg_lo:[0,1]
    v_pk_add_f16 v149, v138, v139 op_sel:[0,1] op_sel_hi:[1,0] neg_hi:[1,0]
    v_cvt_pk_f16_f32 v136, v104, v105
    v_pk_add_f16 v144, v136, v137 op_sel:[0,1] op_sel_hi:[1,0] neg_lo:[0,1]
    v_pk_add_f16 v148, v136, v137 op_sel:[0,1] op_sel_hi:[1,0] neg_hi:[1,0]
    ds_write_b128 v216, v[144:147]
    ds_write_b128 v216, v[148:151] offset:1152
    s_waitcnt lgkmcnt(0)
    v_mov_b32 v10, 1
    s_mov_b64 exec, 1
    ds_add_u32 v15, v10
    s_mov_b64 exec, -1
    s_cmp_gt_u32 s3, 3
    s_cbranch_scc1 fz_bsp0
fz_sy:
    ds_read_b32 v10, v15
    s_waitcnt lgkmcnt(0)
    v_and_b32 v10, 0xff, v10
    v_cmp_ne_u32 vcc, s39, v10
    s_cbranch_vccnz fz_sy
    ds_read_b32 v104, v217 offset:0
    ds_read_b32 v105, v218 offset:0
    ds_read_b32 v106, v219 offset:0
    ds_read_b32 v107, v220 offset:0
    ds_read_b32 v108, v217 offset:256
    ds_read_b32 v109, v218 offset:256
    ds_read_b32 v110, v219 offset:256
    ds_read_b32 v111, v220 offset:256
    s_waitcnt lgkmcnt(4)
    v_pk_add_f16 v112, v104, v106
    v_pk_add_f16 v114, v105, v107
    v_pk_add_f16 v113, v104, v106 neg_lo:[0,1] neg_hi:[0,1]
    v_pk_add_f16 v115, v105, v107 neg_lo:[0,1] neg_hi:[0,1]
    v_pk_add_f16 v116, v112, v114
    v_pk_add_f16 v118, v112, v114 neg_lo:[0,1] neg_hi:[0,1]
    v_pk_add_f16 v117, v113, v115 op_sel:[0,1] op_sel_hi:[1,0] neg_hi:[0,1]
    v_pk_add_f16 v119, v113, v115 op_sel:[0,1] op_sel_hi:[1,0] neg_lo:[0,1]
    v_add_u32 v116, 0x20002, v116
    v_add_u32 v117, 0x20002, v117
    v_add_u32 v118, 0x20002, v118
    v_add_u32 v119, 0x20002, v119
    v_and_or_b32 v116, v116, v229, s44
    v_and_or_b32 v117, v117, v229, s45
    v_and_or_b32 v118, v118, v229, s46
    v_and_or_b32 v119, v119, v229, s47
    buffer_store_dwordx4 v[116:119], v221, s[4:7], s52 offen sc1
    s_waitcnt lgkmcnt(0)
    v_pk_add_f16 v120, v108, v110
    v_pk_add_f16 v122, v109, v111
    v_pk_add_f16 v121, v108, v110 neg_lo:[0,1] neg_hi:[0,1]
    v_pk_add_f16 v123, v109, v111 neg_lo:[0,1] neg_hi:[0,1]
    v_pk_add_f16 v124, v120, v122
    v_pk_add_f16 v126, v120, v122 neg_lo:[0,1] neg_hi:[0,1]
    v_pk_add_f16 v125, v121, v123 op_sel:[0,1] op_sel_hi:[1,0] neg_hi:[0,1]
    v_pk_add_f16 v127, v121, v123 op_sel:[0,1] op_sel_hi:[1,0] neg_lo:[0,1]
    v_add_u32 v124, 0x20002, v124
    v_add_u32 v125, 0x20002, v125
    v_add_u32 v126, 0x20002, v126
    v_add_u32 v127, 0x20002, v127
    v_and_or_b32 v124, v124, v229, s44
    v_and_or_b32 v125, v125, v229, s45
    v_and_or_b32 v126, v126, v229, s46
    v_and_or_b32 v127, v127, v229, s47
    buffer_store_dwordx4 v[124:127], v221, s[4:7], s53 offen sc1
    s_cmp_lg_u32 s59, 0
    s_cbranch_scc1 ffn
    s_and_b32 s32, s3, 3
    s_lshr_b32 s33, s3, 2
    s_lshl_b32 s33, s33, 4
    s_add_u32 s33, s33, s32
    v_and_b32 v8, 12, v4
    v_bfe_u32 v9, v4, 1, 1
    v_lshl_add_u32 v8, v9, 5, v8
    v_add_u32 v8, s33, v8
    v_cvt_f32_u32 v8, v8
    v_and_b32 v12, 1, v1
    v_cvt_f32_u32 v9, v12
    v_lshlrev_b32 v13, 2, v5
    v_cvt_f32_u32 v10, v13
    v_mul_f32 v11, 0x3c800000, v8
    v_mul_f32 v9, 0x3e800000, v9
    v_fma_f32 v9, v11, v10, v9
    v_mov_b32 v128, v9
    v_fmamk_f32 v129, v11, 0x3f800000, v9
    v_fmamk_f32 v130, v11, 0x40000000, v9
    v_fmamk_f32 v131, v11, 0x40400000, v9
    v_mul_f32 v11, 0x3a000000, v8
    v_lshlrev_b32 v9, 31, v1
    v_xor_b32 v11, v9, v11
    v_mul_f32 v9, v11, v10
    v_mov_b32 v112, v9
    v_fmamk_f32 v113, v11, 0x3f800000, v9
    v_fmamk_f32 v114, v11, 0x40000000, v9
    v_fmamk_f32 v115, v11, 0x40400000, v9
    v_fmamk_f32 v116, v11, 0x41800000, v9
    v_fmamk_f32 v117, v11, 0x41880000, v9
    v_fmamk_f32 v118, v11, 0x41900000, v9
    v_fmamk_f32 v119, v11, 0x41980000, v9
    v_cos_f32 v104, v128
    v_sin_f32 v105, v128
    v_cos_f32 v106, v129
    v_sin_f32 v107, v129
    v_cos_f32 v108, v130
    v_sin_f32 v109, v130
    v_cos_f32 v110, v131
    v_sin_f32 v111, v131
    v_sin_f32 v120, v112
    v_sin_f32 v121, v113
    v_sin_f32 v122, v114
    v_sin_f32 v123, v115
    v_sin_f32 v124, v116
    v_sin_f32 v125, v117
    v_sin_f32 v126, v118
    v_sin_f32 v127, v119
    v_cos_f32 v112, v112
    v_cos_f32 v113, v113
    v_cos_f32 v114, v114
    v_cos_f32 v115, v115
    v_cos_f32 v116, v116
    v_cos_f32 v117, v117
    v_cos_f32 v118, v118
    v_cos_f32 v119, v119
    v_cvt_pk_f16_f32 v16, v104, v105
    v_cvt_pk_f16_f32 v17, v106, v107
    v_cvt_pk_f16_f32 v18, v108, v109
    v_cvt_pk_f16_f32 v19, v110, v111
    v_cvt_pk_f16_f32 v20, v112, v113
    v_cvt_pk_f16_f32 v21, v114, v115
    v_cvt_pk_f16_f32 v22, v116, v117
    v_cvt_pk_f16_f32 v23, v118, v119
    v_cvt_pk_f16_f32 v24, v120, v121
    v_cvt_pk_f16_f32 v25, v122, v123
    v_cvt_pk_f16_f32 v26, v124, v125
    v_cvt_pk_f16_f32 v27, v126, v127
    v_lshrrev_b32 v8, 3, v1
    v_mul_u32_u24 v222, 16512, v8
    v_and_b32 v9, 7, v1
    v_lshl_add_u32 v222, v9, 4, v222
    s_mul_i32 s60, s3, 528384
    s_lshl_b32 s32, s20, 7
    s_add_u32 s60, s60, s32
    s_add_u32 s60, s60, 0x1000
    s_add_u32 s61, s60, 132096
    s_add_u32 s16, s60, 264192
    s_add_u32 s17, s60, 396288
    v_lshlrev_b32 v8, 1, v8
    v_bfe_u32 v9, v1, 2, 1
    v_add_u32 v8, v8, v9
    s_lshl_b32 s32, s3, 2
    s_add_u32 s32, s32, 1
    v_lshl_add_u32 v8, v8, 5, s32
    v_cmp_eq_u32 vcc, 1, v12
    v_bfe_u32 v9, v1, 1, 1
    v_mul_u32_u24 v9, 8256, v9
    v_add_u32 v9, 86400, v9
    s_cmp_eq_u32 s3, 3
    s_cselect_b32 s32, 272, 0
    v_sub_u32 v10, 512, v8
    v_cndmask_b32_e64 v10, v8, v10, vcc
    v_and_b32 v11, 16, v10
    v_lshl_add_u32 v11, v11, 6, v9
    v_lshrrev_b32 v12, 7, v10
    v_lshl_add_u32 v11, v12, 8, v11
    v_and_b32 v12, 15, v10
    v_lshl_add_u32 v11, v12, 4, v11
    v_bfe_u32 v12, v10, 5, 2
    v_lshl_add_u32 v223, v12, 2, v11
    v_add_u32 v8, 1, v8
    v_sub_u32 v10, 512, v8
    v_cndmask_b32_e64 v10, v8, v10, vcc
    v_and_b32 v11, 16, v10
    v_lshl_add_u32 v11, v11, 6, v9
    v_lshrrev_b32 v12, 7, v10
    v_lshl_add_u32 v11, v12, 8, v11
    v_and_b32 v12, 15, v10
    v_lshl_add_u32 v11, v12, 4, v11
    v_bfe_u32 v12, v10, 5, 2
    v_lshl_add_u32 v224, v12, 2, v11
    v_add_u32 v8, 1, v8
    v_sub_u32 v10, 512, v8
    v_cndmask_b32_e64 v10, v8, v10, vcc
    v_and_b32 v11, 16, v10
    v_lshl_add_u32 v11, v11, 6, v9
    v_lshrrev_b32 v12, 7, v10
    v_lshl_add_u32 v11, v12, 8, v11
    v_and_b32 v12, 15, v10
    v_lshl_add_u32 v11, v12, 4, v11
    v_bfe_u32 v12, v10, 5, 2
    v_lshl_add_u32 v100, v12, 2, v11
    v_mul_u32_u24 v10, s32, v3
    v_sub_u32 v8, v8, v10
    v_add_u32 v8, 1, v8
    v_sub_u32 v10, 512, v8
    v_cndmask_b32_e64 v10, v8, v10, vcc
    v_lshrrev_b32 v11, 1, v10
    v_and_b32 v11, 256, v11
    v_sub_u32 v10, v10, v11
    v_and_b32 v11, 16, v10
    v_lshl_add_u32 v11, v11, 6, v9
    v_lshrrev_b32 v12, 7, v10
    v_lshl_add_u32 v11, v12, 8, v11
    v_and_b32 v12, 15, v10
    v_lshl_add_u32 v11, v12, 4, v11
    v_bfe_u32 v12, v10, 5, 2
    v_lshl_add_u32 v101, v12, 2, v11
    s_and_b32 s32, s3, 3
    s_lshl_b32 s32, s32, 11
    s_add_u32 s32, s32, 86400
    v_add_u32 v225, s32, v239
    v_add_u32 v8, s33, v13
    v_sub_u32 v9, 32, v8
    v_min_u32 v9, v8, v9
    v_and_b32 v10, 15, v8
    v_cmp_eq_u32 s[32:33], 0, v10
    v_cmp_lt_u32 s[34:35], 16, v8
    v_lshlrev_b32 v10, 10, v9
    v_subrev_u32 v10, 1024, v10
    v_mov_b32 v11, 15872
    v_cmp_eq_u32 vcc, 0, v8
    s_nop 1
    v_cndmask_b32_e64 v10, v10, v11, vcc
    v_and_b32 v11, 3, v1
    v_lshl_add_u32 v10, v11, 4, v10
    v_lshrrev_b32 v11, 2, v4
    v_lshlrev_b32 v12, 7, v11
    v_sub_u32 v13, 960, v12
    v_cndmask_b32_e64 v13, v12, v13, s[34:35]
    v_add_u32 v226, v10, v13
    s_or_b64 s[34:35], s[34:35], s[32:33]
    v_add_u32 v12, 512, v12
    v_sub_u32 v13, 960, v12
    v_cndmask_b32_e64 v13, v12, v13, s[34:35]
    v_add_u32 v227, v10, v13
    s_mul_i32 s56, s20, 16512
    s_add_u32 s56, s56, 0x210000
    v_mov_b32 v249, 0x30003
    v_mov_b32 v252, s44
    v_mov_b32 v253, s45
    v_mov_b32 v254, s46
    v_mov_b32 v255, s47
    s_waitcnt lgkmcnt(0)
    s_waitcnt vmcnt(0)
    s_bitcmp1_b32 s2, 2
    s_cbranch_scc1 fz_p1_ok
    s_add_u32 s32, s60, 99072
    v_mov_b32 v9, 0
fz_p1:
    buffer_load_dword v10, v9, s[4:7], s32 offen sc1
    s_waitcnt vmcnt(0)
    v_xor_b32 v10, v252, v10
    v_and_b32 v10, v249, v10
    v_cmp_ne_u32 vcc, 0, v10
    s_cbranch_vccnz fz_p1_rt
fz_p1_ok:
    s_mov_b32 s58, 0
    buffer_load_dwordx4 v[104:107], v222, s[4:7], s60 offen sc1
    buffer_load_dwordx4 v[108:111], v222, s[4:7], s61 offen sc1
    buffer_load_dwordx4 v[112:115], v222, s[4:7], s16 offen sc1
    buffer_load_dwordx4 v[116:119], v222, s[4:7], s17 offen sc1
fz_h1_c0:
    s_waitcnt vmcnt(3)
    v_xor_b32 v104, v252, v104
    v_xor_b32 v105, v253, v105
    v_xor_b32 v106, v254, v106
    v_xor_b32 v107, v255, v107
    v_or3_b32 v10, v104, v105, v106
    v_bitop3_b32 v10, v10, v107, v249 bitop3:0xa8
    v_cmp_ne_u32 vcc, 0, v10
    s_cbranch_vccnz fz_h1_r0
fz_h1_o0:
    ds_write_b32 v223, v104 offset:0
    ds_write_b32 v223, v105 offset:2048
    ds_write_b32 v223, v106 offset:4096
    ds_write_b32 v223, v107 offset:6144
fz_h1_c1:
    s_waitcnt vmcnt(2)
    v_xor_b32 v108, v252, v108
    v_xor_b32 v109, v253, v109
    v_xor_b32 v110, v254, v110
    v_xor_b32 v111, v255, v111
    v_or3_b32 v10, v108, v109, v110
    v_bitop3_b32 v10, v10, v111, v249 bitop3:0xa8
    v_cmp_ne_u32 vcc, 0, v10
    s_cbranch_vccnz fz_h1_r1
fz_h1_o1:
    ds_write_b32 v224, v108 offset:0
    ds_write_b32 v224, v109 offset:2048
    ds_write_b32 v224, v110 offset:4096
    ds_write_b32 v224, v111 offset:6144
fz_h1_c2:
    s_waitcnt vmcnt(1)
    v_xor_b32 v112, v252, v112
    v_xor_b32 v113, v253, v113
    v_xor_b32 v114, v254, v114
    v_xor_b32 v115, v255, v115
    v_or3_b32 v10, v112, v113, v114
    v_bitop3_b32 v10, v10, v115, v249 bitop3:0xa8
    v_cmp_ne_u32 vcc, 0, v10
    s_cbranch_vccnz fz_h1_r2
fz_h1_o2:
    ds_write_b32 v100, v112 offset:0
    ds_write_b32 v100, v113 offset:2048
    ds_write_b32 v100, v114 offset:4096
    ds_write_b32 v100, v115 offset:6144
fz_h1_c3:
    s_waitcnt vmcnt(0)
    v_xor_b32 v116, v252, v116
    v_xor_b32 v117, v253, v117
    v_xor_b32 v118, v254, v118
    v_xor_b32 v119, v255, v119
    v_or3_b32 v10, v116, v117, v118
    v_bitop3_b32 v10, v10, v119, v249 bitop3:0xa8
    v_cmp_ne_u32 vcc, 0, v10
    s_cbranch_vccnz fz_h1_r3
fz_h1_o3:
    ds_write_b32 v101, v116 offset:0
    ds_write_b32 v101, v117 offset:2048
    ds_write_b32 v101, v118 offset:4096
    ds_write_b32 v101, v119 offset:6144
    s_waitcnt lgkmcnt(0)
    s_setprio 0
fz_hb:
    s_barrier
    ds_read_b128 v[104:107], v225 offset:0
    ds_read_b128 v[108:111], v225 offset:1024
    ds_read_b128 v[112:115], v225 offset:8256
    ds_read_b128 v[116:119], v225 offset:9280
    ds_read_b128 v[72:75], v6 offset:14336
    ds_read_b128 v[76:79], v6 offset:15360
    ds_read_b128 v[80:83], v6 offset:16384
    ds_read_b128 v[84:87], v6 offset:17408
    s_waitcnt lgkmcnt(7)
    v_mfma_f32_16x16x32_f16 v[120:123], v[104:107], v[16:19], 0
    s_waitcnt lgkmcnt(6)
    v_mfma_f32_16x16x32_f16 v[124:127], v[108:111], v[16:19], 0
    s_waitcnt lgkmcnt(5)
    v_mfma_f32_16x16x32_f16 v[128:131], v[112:115], v[16:19], 0
    s_waitcnt lgkmcnt(4)
    v_mfma_f32_16x16x32_f16 v[132:135], v[116:119], v[16:19], 0
    s_waitcnt lgkmcnt(0)
    s_nop 0
    v_cvt_pk_f16_f32 v136, v120, v121
    v_cvt_pk_f16_f32 v137, v122, v123
    v_cvt_pk_f16_f32 v138, v124, v125
    v_cvt_pk_f16_f32 v139, v126, v127
    v_cvt_pk_f16_f32 v140, v128, v129
    v_cvt_pk_f16_f32 v141, v130, v131
    v_cvt_pk_f16_f32 v142, v132, v133
    v_cvt_pk_f16_f32 v143, v134, v135
    v_pk_mul_f16 v144, v136, v20
    v_pk_mul_f16 v145, v137, v21
    v_pk_mul_f16 v146, v138, v22
    v_pk_mul_f16 v147, v139, v23
    v_mov_b32_dpp v152, v136 quad_perm:[1,0,3,2] row_mask:0xf bank_mask:0xf
    v_mov_b32_dpp v153, v137 quad_perm:[1,0,3,2] row_mask:0xf bank_mask:0xf
    v_mov_b32_dpp v154, v138 quad_perm:[1,0,3,2] row_mask:0xf bank_mask:0xf
    v_mov_b32_dpp v155, v139 quad_perm:[1,0,3,2] row_mask:0xf bank_mask:0xf
    v_pk_fma_f16 v144, v152, v24, v144
    v_pk_fma_f16 v145, v153, v25, v145
    v_pk_fma_f16 v146, v154, v26, v146
    v_pk_fma_f16 v147, v155, v27, v147
    s_nop 1
    v_mfma_f32_16x16x32_f16 v[104:107], v[144:147], v[72:75], 0
    v_mfma_f32_16x16x32_f16 v[108:111], v[144:147], v[80:83], 0
    v_xor_b32_dpp v152, v144, v240 quad_perm:[1,0,3,2] row_mask:0xf bank_mask:0xf
    v_xor_b32_dpp v153, v145, v240 quad_perm:[1,0,3,2] row_mask:0xf bank_mask:0xf
    v_xor_b32_dpp v154, v146, v240 quad_perm:[1,0,3,2] row_mask:0xf bank_mask:0xf
    v_xor_b32_dpp v155, v147, v240 quad_perm:[1,0,3,2] row_mask:0xf bank_mask:0xf
    s_nop 1
    v_mfma_f32_16x16x32_f16 v[104:107], v[152:155], v[76:79], v[104:107]
    v_mfma_f32_16x16x32_f16 v[108:111], v[152:155], v[84:87], v[108:111]
    v_pk_mul_f16 v148, v140, v20
    v_pk_mul_f16 v149, v141, v21
    v_pk_mul_f16 v150, v142, v22
    v_pk_mul_f16 v151, v143, v23
    v_mov_b32_dpp v156, v140 quad_perm:[1,0,3,2] row_mask:0xf bank_mask:0xf
    v_mov_b32_dpp v157, v141 quad_perm:[1,0,3,2] row_mask:0xf bank_mask:0xf
    v_mov_b32_dpp v158, v142 quad_perm:[1,0,3,2] row_mask:0xf bank_mask:0xf
    v_mov_b32_dpp v159, v143 quad_perm:[1,0,3,2] row_mask:0xf bank_mask:0xf
    v_pk_fma_f16 v148, v156, v24, v148
    v_pk_fma_f16 v149, v157, v25, v149
    v_pk_fma_f16 v150, v158, v26, v150
    v_pk_fma_f16 v151, v159, v27, v151
    s_nop 1
    v_mfma_f32_16x16x32_f16 v[112:115], v[148:151], v[72:75], 0
    v_mfma_f32_16x16x32_f16 v[116:119], v[148:151], v[80:83], 0
    v_xor_b32_dpp v156, v148, v240 quad_perm:[1,0,3,2] row_mask:0xf bank_mask:0xf
    v_xor_b32_dpp v157, v149, v240 quad_perm:[1,0,3,2] row_mask:0xf bank_mask:0xf
    v_xor_b32_dpp v158, v150, v240 quad_perm:[1,0,3,2] row_mask:0xf bank_mask:0xf
    v_xor_b32_dpp v159, v151, v240 quad_perm:[1,0,3,2] row_mask:0xf bank_mask:0xf
    s_nop 1
    v_mfma_f32_16x16x32_f16 v[112:115], v[156:159], v[76:79], v[112:115]
    v_mfma_f32_16x16x32_f16 v[116:119], v[156:159], v[84:87], v[116:119]
    v_cvt_pk_f16_f32 v120, v104, v105
    v_cvt_pk_f16_f32 v122, v106, v107
    s_nop 4
    v_cvt_pk_f16_f32 v121, v112, v113
    v_cvt_pk_f16_f32 v123, v114, v115
    v_add_u32 v120, 0x20002, v120
    v_add_u32 v121, 0x20002, v121
    v_add_u32 v122, 0x20002, v122
    v_add_u32 v123, 0x20002, v123
    v_and_or_b32 v120, v120, v229, s44
    v_and_or_b32 v121, v121, v229, s45
    v_and_or_b32 v122, v122, v229, s46
    v_and_or_b32 v123, v123, v229, s47
    buffer_store_dwordx4 v[120:123], v226, s[4:7], s56 offen sc1
    v_cvt_pk_f16_f32 v124, v108, v109
    v_cvt_pk_f16_f32 v126, v110, v111
    v_cvt_pk_f16_f32 v125, v116, v117
    v_cvt_pk_f16_f32 v127, v118, v119
    v_add_u32 v124, 0x20002, v124
    v_add_u32 v125, 0x20002, v125
    v_add_u32 v126, 0x20002, v126
    v_add_u32 v127, 0x20002, v127
    v_and_or_b32 v124, v124, v229, s44
    v_and_or_b32 v125, v125, v229, s45
    v_and_or_b32 v126, v126, v229, s46
    v_and_or_b32 v127, v127, v229, s47
    buffer_store_dwordx4 v[124:127], v227, s[4:7], s56 offen sc1
    s_cmp_lg_u32 s57, 0
    s_cbranch_scc1 fz_nc3
    v_sub_u32 v8, 15, v4
    v_min_u32 v8, v4, v8
    v_and_b32 v9, 1, v8
    v_lshlrev_b32 v9, 5, v9
    v_lshrrev_b32 v10, 1, v8
    v_lshl_add_u32 v9, v10, 9, v9
    v_add_u32 v9, s25, v9
    v_sub_u32 v10, 2048, v9
    v_cmp_lt_u32 s[34:35], 7, v4
    s_nop 1
    v_cndmask_b32_e64 v230, v9, v10, s[34:35]
    v_mov_b32 v9, v4
    v_mov_b32 v10, s20
    s_cmp_lg_u32 s21, 0
    s_cbranch_scc0 fz_spec3a
fz_spec3backa:
    v_lshlrev_b32 v10, 7, v10
    v_lshl_add_u32 v10, v9, 3, v10
    v_mul_u32_u24 v11, 66048, v5
    v_add_u32 v228, v10, v11
    v_and_b32 v9, 1, v9
    v_cmp_eq_u32 vcc, 1, v9
    v_mov_b32 v9, s44
    v_mov_b32 v10, s46
    v_cndmask_b32_e64 v236, v9, v10, vcc
    v_mov_b32 v9, s45
    v_mov_b32 v10, s47
    v_cndmask_b32_e64 v237, v9, v10, vcc
    s_lshl_b32 s32, s3, 2
    v_add_u32 v8, s32, v5
    v_lshlrev_b32 v9, 6, v8
    v_cmp_gt_u32 vcc, 16, v8
    s_nop 1
    v_cndmask_b32_e64 v10, 0, 32, vcc
    v_add_u32 v10, v9, v10
    v_sub_u32 v11, 2048, v10
    v_cmp_eq_u32 vcc, 16, v8
    s_nop 1
    v_cndmask_b32_e64 v11, v11, 0, vcc
    v_mov_b32 v12, 0xffff0000
    v_cndmask_b32_e64 v238, -1, v12, vcc
    v_sub_u32 v12, 2018, v9
    v_mul_u32_u24 v13, 2064, v4
    v_add_u32 v231, v13, v9
    v_add_u32 v232, v13, v12
    v_add_u32 v233, v13, v10
    v_add_u32 v241, v13, v11
    s_lshl_b32 s32, s3, 8
    s_add_u32 s32, s32, 102912
    v_lshlrev_b32 v9, 4, v4
    v_add_u32 v10, s32, v9
    v_add_u32 v11, 107008, v239
    v_cmp_gt_u32 vcc, 16, v1
    s_nop 1
    v_cndmask_b32_e64 v243, v11, v10, vcc
    v_lshrrev_b32 v12, 2, v4
    v_cmp_eq_u32 vcc, v12, v5
    s_nop 1
    v_cndmask_b32_e64 v244, v11, v10, vcc
    v_lshrrev_b32 v12, 5, v1
    v_lshl_add_u32 v10, v12, 10, v9
    v_add_u32 v245, 102912, v10
    v_and_b32 v9, 1, v1
    v_cmp_eq_u32 s[28:29], 1, v9
    v_and_b32 v9, 2, v1
    v_cmp_eq_u32 s[30:31], 2, v9
    s_lshl_b32 s37, s3, 2
    v_add_u32 v9, s37, v5
    v_mul_u32_u24 v246, 2176, v9
    s_lshl_b32 s26, s20, 4
    s_add_u32 s26, s26, 0x580000
    v_lshlrev_b32 v247, 4, v5
    s_lshl_b32 s27, s20, 11
    s_lshl_b32 s37, s3, 8
    s_add_u32 s27, s27, s37
    s_add_u32 s27, s27, 0x448000
    v_sub_u32 v248, 2047, v230
    s_mov_b32 s14, 0x400000
    s_mov_b32 s15, 0x00020000
    s_mul_i32 s52, s3, 264192
    s_add_u32 s52, s52, 0x210000
    s_add_u32 s53, s52, 16512
    s_add_u32 s54, s52, 33024
    s_add_u32 s55, s52, 49536
    s_mov_b32 s23, s63
    s_getreg_b32 s24, hwreg(HW_REG_XCC_ID)
    s_and_b32 s24, s24, 15
    v_lshlrev_b32 v10, 4, v0
    v_min_u32 v10, 4336, v10
    v_add_u32 v10, 108032, v10
    v_mov_b32 v104, 0
    v_mov_b32 v105, 0
    v_mov_b32 v106, 0
    v_mov_b32 v107, 0
    ds_write_b128 v10, v[104:107]
    s_mov_b32 s58, 0
    s_waitcnt vmcnt(0)
    buffer_load_dwordx2 v[104:105], v228, s[4:7], s52 offen sc1
    buffer_load_dwordx2 v[106:107], v228, s[4:7], s53 offen sc1
    buffer_load_dwordx2 v[108:109], v228, s[4:7], s54 offen sc1
    buffer_load_dwordx2 v[110:111], v228, s[4:7], s55 offen sc1
    ds_read_b128 v[116:119], v231
    ds_read_b128 v[120:123], v231 offset:16
    ds_read_u16_d16_hi v44, v241
    ds_read_u16_d16_hi v45, v232 offset:28
    ds_read_u16_d16_hi v46, v232 offset:26
    ds_read_u16_d16_hi v47, v232 offset:24
    ds_read_u16_d16_hi v48, v232 offset:22
    ds_read_u16_d16_hi v49, v232 offset:20
    ds_read_u16_d16_hi v50, v232 offset:18
    ds_read_u16_d16_hi v51, v232 offset:16
    ds_read_u16_d16_hi v52, v232 offset:14
    ds_read_u16_d16_hi v53, v232 offset:12
    ds_read_u16_d16_hi v54, v232 offset:10
    ds_read_u16_d16_hi v55, v232 offset:8
    ds_read_u16_d16_hi v56, v232 offset:6
    ds_read_u16_d16_hi v57, v232 offset:4
    ds_read_u16_d16_hi v58, v232 offset:2
    ds_read_u16_d16_hi v59, v232 offset:0
    ds_read_u16_d16_hi v28, v233
    v_mul_u32_u24 v13, 2064, v4
    v_subrev_u32 v13, 104960, v13
    v_sub_u32 v9, v231, v13
    v_sub_u32 v10, v233, v13
    v_sub_u32 v11, v241, v13
    v_sub_u32 v12, v232, v13
    s_mov_b32 s36, 0xffff0000
    s_waitcnt lgkmcnt(0)
    ds_read_b128 v[200:203], v9
    ds_read_b128 v[204:207], v9 offset:16
    ds_read_u16_d16 v208, v11
    ds_read_u16_d16_hi v124, v12 offset:28
    ds_read_u16_d16 v209, v12 offset:26
    ds_read_u16_d16_hi v125, v12 offset:24
    ds_read_u16_d16 v210, v12 offset:22
    ds_read_u16_d16_hi v126, v12 offset:20
    ds_read_u16_d16 v211, v12 offset:18
    ds_read_u16_d16_hi v127, v12 offset:16
    ds_read_u16_d16 v212, v12 offset:14
    ds_read_u16_d16_hi v128, v12 offset:12
    ds_read_u16_d16 v213, v12 offset:10
    ds_read_u16_d16_hi v129, v12 offset:8
    ds_read_u16_d16 v214, v12 offset:6
    ds_read_u16_d16_hi v130, v12 offset:4
    ds_read_u16_d16 v215, v12 offset:2
    ds_read_u16_d16_hi v131, v12 offset:0
    ds_read_u16_d16 v13, v10
    v_and_b32 v29, s36, v116
    v_lshlrev_b32 v30, 16, v117
    v_and_b32 v31, s36, v117
    v_lshlrev_b32 v32, 16, v118
    v_and_b32 v33, s36, v118
    v_lshlrev_b32 v34, 16, v119
    v_and_b32 v35, s36, v119
    v_lshlrev_b32 v36, 16, v120
    v_and_b32 v37, s36, v120
    v_lshlrev_b32 v38, 16, v121
    v_and_b32 v39, s36, v121
    v_lshlrev_b32 v40, 16, v122
    v_and_b32 v41, s36, v122
    v_lshlrev_b32 v42, 16, v123
    v_and_b32 v43, s36, v123
    v_cmp_eq_u32 vcc, 1, v4
    v_mov_b32 v9, s42
    s_nop 0
    v_cndmask_b32_e64 v9, 0, v9, vcc
    v_mov_b32 v116, s42
    v_mov_b32 v117, s42
    v_mov_b32 v118, s42
    v_mov_b32 v119, s42
    v_cmp_eq_u32 vcc, 0, v4
    s_waitcnt lgkmcnt(0)
    v_and_or_b32 v200, v200, s36, v13
    v_or_b32 v208, v208, v124
    v_or_b32 v209, v209, v125
    v_or_b32 v210, v210, v126
    v_or_b32 v211, v211, v127
    v_or_b32 v212, v212, v128
    v_or_b32 v213, v213, v129
    v_or_b32 v214, v214, v130
    v_or_b32 v215, v215, v131
    v_cndmask_b32_e64 v200, v9, v200, vcc
    v_cndmask_b32_e64 v201, v9, v201, vcc
    v_cndmask_b32_e64 v202, v9, v202, vcc
    v_cndmask_b32_e64 v203, v9, v203, vcc
    v_cndmask_b32_e64 v204, v9, v204, vcc
    v_cndmask_b32_e64 v205, v9, v205, vcc
    v_cndmask_b32_e64 v206, v9, v206, vcc
    v_cndmask_b32_e64 v207, v9, v207, vcc
    v_cndmask_b32_e64 v208, v9, v208, vcc
    v_cndmask_b32_e64 v209, v9, v209, vcc
    v_cndmask_b32_e64 v210, v9, v210, vcc
    v_cndmask_b32_e64 v211, v9, v211, vcc
    v_cndmask_b32_e64 v212, v9, v212, vcc
    v_cndmask_b32_e64 v213, v9, v213, vcc
    v_cndmask_b32_e64 v214, v9, v214, vcc
    v_cndmask_b32_e64 v215, v9, v215, vcc
    v_mfma_f32_16x16x32_bf16 v[120:123], v[200:203], v[116:119], 0
    v_mfma_f32_16x16x32_bf16 v[120:123], v[204:207], v[116:119], v[120:123]
    v_mfma_f32_16x16x32_bf16 v[120:123], v[208:211], v[116:119], v[120:123]
    v_mfma_f32_16x16x32_bf16 v[120:123], v[212:215], v[116:119], v[120:123]
    s_nop 7
    ds_write_b32 v243, v120 offset:12
    s_branch fz_h2c
fz_h2:
    buffer_load_dwordx2 v[104:105], v228, s[4:7], s52 offen sc1
    buffer_load_dwordx2 v[106:107], v228, s[4:7], s53 offen sc1
    buffer_load_dwordx2 v[108:109], v228, s[4:7], s54 offen sc1
    buffer_load_dwordx2 v[110:111], v228, s[4:7], s55 offen sc1
fz_h2c:
    s_mov_b32 s36, 0x43000000
fz_h2_c0:
    s_waitcnt vmcnt(3)
    v_xor_b32 v104, v236, v104
    v_xor_b32 v105, v237, v105
    v_bitop3_b32 v9, v104, v105, v249 bitop3:0xa8
    v_cmp_ne_u32 vcc, 0, v9
    s_cbranch_vccnz fz_h2_r0
fz_h2_o0:
    v_mov_b32_dpp v112, v104 row_mirror row_mask:0xf bank_mask:0xf
    v_mov_b32_dpp v113, v105 row_mirror row_mask:0xf bank_mask:0xf
    s_cmp_eq_u32 s2, 66
    s_cbranch_scc1 fz_spec40
fz_spec4back0:
    v_fma_mix_f32 v28, v104, s36, v28 op_sel:[0,0,0] op_sel_hi:[1,0,0]
    v_fma_mix_f32 v29, v104, s36, v29 op_sel:[1,0,0] op_sel_hi:[1,0,0]
    v_fma_mix_f32 v30, v105, s36, v30 op_sel:[0,0,0] op_sel_hi:[1,0,0]
    v_fma_mix_f32 v31, v105, s36, v31 op_sel:[1,0,0] op_sel_hi:[1,0,0]
    v_and_b32 v112, v238, v112
    v_fma_mix_f32 v44, v112, s36, v44 op_sel:[0,0,0] op_sel_hi:[1,0,0]
    v_fma_mix_f32 v45, v112, s36, v45 op_sel:[1,0,0] op_sel_hi:[1,0,0]
    v_fma_mix_f32 v46, v113, s36, v46 op_sel:[0,0,0] op_sel_hi:[1,0,0]
    v_fma_mix_f32 v47, v113, s36, v47 op_sel:[1,0,0] op_sel_hi:[1,0,0]
    v_cvt_pk_bf16_f32 v120, v28, v29
    v_cvt_pk_bf16_f32 v121, v30, v31
    v_cvt_pk_bf16_f32 v128, v44, v45
    v_cvt_pk_bf16_f32 v129, v46, v47
fz_h2_c1:
    s_waitcnt vmcnt(2)
    v_xor_b32 v106, v236, v106
    v_xor_b32 v107, v237, v107
    v_bitop3_b32 v9, v106, v107, v249 bitop3:0xa8
    v_cmp_ne_u32 vcc, 0, v9
    s_cbranch_vccnz fz_h2_r1
fz_h2_o1:
    v_mov_b32_dpp v114, v106 row_mirror row_mask:0xf bank_mask:0xf
    v_mov_b32_dpp v115, v107 row_mirror row_mask:0xf bank_mask:0xf
    s_cmp_eq_u32 s2, 66
    s_cbranch_scc1 fz_spec41
fz_spec4back1:
    v_fma_mix_f32 v32, v106, s36, v32 op_sel:[0,0,0] op_sel_hi:[1,0,0]
    v_fma_mix_f32 v33, v106, s36, v33 op_sel:[1,0,0] op_sel_hi:[1,0,0]
    v_fma_mix_f32 v34, v107, s36, v34 op_sel:[0,0,0] op_sel_hi:[1,0,0]
    v_fma_mix_f32 v35, v107, s36, v35 op_sel:[1,0,0] op_sel_hi:[1,0,0]
    v_fma_mix_f32 v48, v114, s36, v48 op_sel:[0,0,0] op_sel_hi:[1,0,0]
    v_fma_mix_f32 v49, v114, s36, v49 op_sel:[1,0,0] op_sel_hi:[1,0,0]
    v_fma_mix_f32 v50, v115, s36, v50 op_sel:[0,0,0] op_sel_hi:[1,0,0]
    v_fma_mix_f32 v51, v115, s36, v51 op_sel:[1,0,0] op_sel_hi:[1,0,0]
    v_cvt_pk_bf16_f32 v122, v32, v33
    v_cvt_pk_bf16_f32 v123, v34, v35
    v_cvt_pk_bf16_f32 v130, v48, v49
    v_cvt_pk_bf16_f32 v131, v50, v51
    v_mfma_f32_16x16x32_bf16 v[136:139], v[120:123], v[120:123], 0
    v_mfma_f32_16x16x32_bf16 v[140:143], v[200:203], v[120:123], 0
    v_mfma_f32_16x16x32_bf16 v[136:139], v[128:131], v[128:131], v[136:139]
    v_mfma_f32_16x16x32_bf16 v[140:143], v[208:211], v[128:131], v[140:143]
fz_h2_c2:
    s_waitcnt vmcnt(1)
    v_xor_b32 v108, v236, v108
    v_xor_b32 v109, v237, v109
    v_bitop3_b32 v9, v108, v109, v249 bitop3:0xa8
    v_cmp_ne_u32 vcc, 0, v9
    s_cbranch_vccnz fz_h2_r2
fz_h2_o2:
    v_mov_b32_dpp v116, v108 row_mirror row_mask:0xf bank_mask:0xf
    v_mov_b32_dpp v117, v109 row_mirror row_mask:0xf bank_mask:0xf
    s_cmp_eq_u32 s2, 66
    s_cbranch_scc1 fz_spec42
fz_spec4back2:
    v_fma_mix_f32 v36, v108, s36, v36 op_sel:[0,0,0] op_sel_hi:[1,0,0]
    v_fma_mix_f32 v37, v108, s36, v37 op_sel:[1,0,0] op_sel_hi:[1,0,0]
    v_fma_mix_f32 v38, v109, s36, v38 op_sel:[0,0,0] op_sel_hi:[1,0,0]
    v_fma_mix_f32 v39, v109, s36, v39 op_sel:[1,0,0] op_sel_hi:[1,0,0]
    v_fma_mix_f32 v52, v116, s36, v52 op_sel:[0,0,0] op_sel_hi:[1,0,0]
    v_fma_mix_f32 v53, v116, s36, v53 op_sel:[1,0,0] op_sel_hi:[1,0,0]
    v_fma_mix_f32 v54, v117, s36, v54 op_sel:[0,0,0] op_sel_hi:[1,0,0]
    v_fma_mix_f32 v55, v117, s36, v55 op_sel:[1,0,0] op_sel_hi:[1,0,0]
    v_cvt_pk_bf16_f32 v124, v36, v37
    v_cvt_pk_bf16_f32 v125, v38, v39
    v_cvt_pk_bf16_f32 v132, v52, v53
    v_cvt_pk_bf16_f32 v133, v54, v55
fz_h2_c3:
    s_waitcnt vmcnt(0)
    v_xor_b32 v110, v236, v110
    v_xor_b32 v111, v237, v111
    v_bitop3_b32 v9, v110, v111, v249 bitop3:0xa8
    v_cmp_ne_u32 vcc, 0, v9
    s_cbranch_vccnz fz_h2_r3
fz_h2_o3:
    v_mov_b32_dpp v118, v110 row_mirror row_mask:0xf bank_mask:0xf
    v_mov_b32_dpp v119, v111 row_mirror row_mask:0xf bank_mask:0xf
    s_cmp_eq_u32 s2, 66
    s_cbranch_scc1 fz_spec43
fz_spec4back3:
    v_fma_mix_f32 v40, v110, s36, v40 op_sel:[0,0,0] op_sel_hi:[1,0,0]
    v_fma_mix_f32 v41, v110, s36, v41 op_sel:[1,0,0] op_sel_hi:[1,0,0]
    v_fma_mix_f32 v42, v111, s36, v42 op_sel:[0,0,0] op_sel_hi:[1,0,0]
    v_fma_mix_f32 v43, v111, s36, v43 op_sel:[1,0,0] op_sel_hi:[1,0,0]
    v_fma_mix_f32 v56, v118, s36, v56 op_sel:[0,0,0] op_sel_hi:[1,0,0]
    v_fma_mix_f32 v57, v118, s36, v57 op_sel:[1,0,0] op_sel_hi:[1,0,0]
    v_fma_mix_f32 v58, v119, s36, v58 op_sel:[0,0,0] op_sel_hi:[1,0,0]
    v_fma_mix_f32 v59, v119, s36, v59 op_sel:[1,0,0] op_sel_hi:[1,0,0]
    v_cvt_pk_bf16_f32 v126, v40, v41
    v_cvt_pk_bf16_f32 v127, v42, v43
    v_cvt_pk_bf16_f32 v134, v56, v57
    v_cvt_pk_bf16_f32 v135, v58, v59
    v_mfma_f32_16x16x32_bf16 v[136:139], v[124:127], v[124:127], v[136:139]
    v_mfma_f32_16x16x32_bf16 v[140:143], v[204:207], v[124:127], v[140:143]
    v_mfma_f32_16x16x32_bf16 v[136:139], v[132:135], v[132:135], v[136:139]
    v_mfma_f32_16x16x32_bf16 v[140:143], v[212:215], v[132:135], v[140:143]
    s_nop 6
    v_cndmask_b32_e64 v9, v136, v137, s[28:29]
    v_cndmask_b32_e64 v10, v138, v139, s[28:29]
    ds_write_b64 v243, v[140:141]
    v_cndmask_b32_e64 v9, v9, v10, s[30:31]
    ds_write_b32 v244, v9 offset:8
    s_cmp_gt_u32 s3, 3
    s_cbranch_scc1 fz_lp
    s_setprio 2
fz_lp:
    s_waitcnt lgkmcnt(0)
    s_barrier
    ds_read_b128 v[144:147], v245 offset:0
    ds_read_b128 v[148:151], v245 offset:256
    ds_read_b128 v[152:155], v245 offset:512
    ds_read_b128 v[156:159], v245 offset:768
    s_waitcnt lgkmcnt(2)
    v_pk_add_f32 v[144:145], v[144:145], v[148:149]
    v_pk_add_f32 v[146:147], v[146:147], v[150:151]
    s_waitcnt lgkmcnt(0)
    v_pk_add_f32 v[152:153], v[152:153], v[156:157]
    v_pk_add_f32 v[154:155], v[154:155], v[158:159]
    v_pk_add_f32 v[144:145], v[144:145], v[152:153]
    v_pk_add_f32 v[146:147], v[146:147], v[154:155]
    v_mov_b32 v148, v144
    v_mov_b32 v149, v145
    v_mov_b32 v150, v146
    v_mov_b32 v151, v147
    v_permlane32_swap_b32 v144, v148
    v_permlane32_swap_b32 v145, v149
    v_permlane32_swap_b32 v146, v150
    v_permlane32_swap_b32 v147, v151
    v_pk_add_f32 v[144:145], v[144:145], v[148:149]
    v_pk_add_f32 v[146:147], v[146:147], v[150:151]
    v_mul_f32 v145, 0xba800000, v145
    v_mul_f32 v146, 0x3a800000, v146
    v_fma_f32 v146, -v145, v145, v146
    v_cvt_pk_bf16_f32 v153, 0, v145
    v_cvt_pk_bf16_f32 v146, 0, v146
    v_add_f32 v146, 0x3727c5ac, v146
    v_cvt_pk_bf16_f32 v146, 0, v146
    v_sqrt_f32 v146, v146
    v_fmac_f32 v144, v153, v147
    v_cvt_pk_bf16_f32 v146, 0, v146
    v_rcp_f32 v154, v146
    v_mov_b32 v155, s40
    v_mul_f32 v144, v144, v154
    v_cvt_pk_bf16_f32 v144, 0, v144
    v_ashrrev_i32 v145, 31, v144
    v_or_b32 v145, 0x80000000, v145
    v_bitop3_b32 v152, v144, v145, v242 bitop3:0x28
    v_or_b32 v152, v152, v248
    s_nop 1
    v_max_u32_dpp v144, v152, v152 row_ror:1 row_mask:0xf bank_mask:0xf
    s_nop 1
    v_max_u32_dpp v144, v144, v144 row_ror:2 row_mask:0xf bank_mask:0xf
    s_nop 1
    v_max_u32_dpp v144, v144, v144 row_ror:4 row_mask:0xf bank_mask:0xf
    s_nop 1
    v_max_u32_dpp v144, v144, v144 row_ror:8 row_mask:0xf bank_mask:0xf
    v_cmp_eq_u32 vcc, v144, v152
    v_or_b32 v153, s24, v153
    s_nop 0
    s_mov_b64 exec, vcc
    buffer_store_dwordx4 v[152:155], v246, s[4:7], s26 offen sc1
    s_add_u32 s26, s26, 69632
    buffer_store_dwordx4 v[152:155], v246, s[4:7], s26 offen sc1
    buffer_store_dwordx4 v[120:123], v247, s[4:7], s27 offen offset:0 sc1
    buffer_store_dwordx4 v[124:127], v247, s[4:7], s27 offen offset:64 sc1
    buffer_store_dwordx4 v[128:131], v247, s[4:7], s27 offen offset:128 sc1
    buffer_store_dwordx4 v[132:135], v247, s[4:7], s27 offen offset:192 sc1
    s_mov_b64 exec, -1
    s_setprio 0
    s_ff1_i32_b64 s37, vcc
    v_add_f32 v144, 1.0, v154
    v_and_b32 v146, v242, v153
    v_mul_f32 v146, v146, v154
    v_pk_fma_f32 v[28:29], v[28:29], v[144:145], v[146:147] op_sel_hi:[1,0,0]
    v_pk_fma_f32 v[30:31], v[30:31], v[144:145], v[146:147] op_sel_hi:[1,0,0]
    v_pk_fma_f32 v[32:33], v[32:33], v[144:145], v[146:147] op_sel_hi:[1,0,0]
    v_pk_fma_f32 v[34:35], v[34:35], v[144:145], v[146:147] op_sel_hi:[1,0,0]
    v_pk_fma_f32 v[36:37], v[36:37], v[144:145], v[146:147] op_sel_hi:[1,0,0]
    v_pk_fma_f32 v[38:39], v[38:39], v[144:145], v[146:147] op_sel_hi:[1,0,0]
    v_pk_fma_f32 v[40:41], v[40:41], v[144:145], v[146:147] op_sel_hi:[1,0,0]
    v_pk_fma_f32 v[42:43], v[42:43], v[144:145], v[146:147] op_sel_hi:[1,0,0]
    v_pk_fma_f32 v[44:45], v[44:45], v[144:145], v[146:147] op_sel_hi:[1,0,0]
    v_pk_fma_f32 v[46:47], v[46:47], v[144:145], v[146:147] op_sel_hi:[1,0,0]
    v_pk_fma_f32 v[48:49], v[48:49], v[144:145], v[146:147] op_sel_hi:[1,0,0]
    v_pk_fma_f32 v[50:51], v[50:51], v[144:145], v[146:147] op_sel_hi:[1,0,0]
    v_pk_fma_f32 v[52:53], v[52:53], v[144:145], v[146:147] op_sel_hi:[1,0,0]
    v_pk_fma_f32 v[54:55], v[54:55], v[144:145], v[146:147] op_sel_hi:[1,0,0]
    v_pk_fma_f32 v[56:57], v[56:57], v[144:145], v[146:147] op_sel_hi:[1,0,0]
    v_pk_fma_f32 v[58:59], v[58:59], v[144:145], v[146:147] op_sel_hi:[1,0,0]
    v_cvt_pk_bf16_f32 v104, v28, v29
    v_cvt_pk_bf16_f32 v105, v30, v31
    v_cvt_pk_bf16_f32 v106, v32, v33
    v_cvt_pk_bf16_f32 v107, v34, v35
    v_cvt_pk_bf16_f32 v108, v36, v37
    v_cvt_pk_bf16_f32 v109, v38, v39
    v_cvt_pk_bf16_f32 v110, v40, v41
    v_cvt_pk_bf16_f32 v111, v42, v43
    v_cvt_pk_bf16_f32 v112, v44, v45
    v_cvt_pk_bf16_f32 v113, v46, v47
    v_cvt_pk_bf16_f32 v114, v48, v49
    v_cvt_pk_bf16_f32 v115, v50, v51
    v_cvt_pk_bf16_f32 v116, v52, v53
    v_cvt_pk_bf16_f32 v117, v54, v55
    v_cvt_pk_bf16_f32 v118, v56, v57
    v_cvt_pk_bf16_f32 v119, v58, v59
    ds_write_b128 v231, v[104:107]
    ds_write_b128 v231, v[108:111] offset:16
    s_waitcnt lgkmcnt(0)
    s_barrier
    s_cmp_lt_u32 s3, 4
    s_cbranch_scc1 fz_now4
    buffer_load_dwordx4 v[192:195], v14, s[64:67], s62 offen offset:0 nt
    buffer_load_dwordx4 v[196:199], v14, s[64:67], s62 offen offset:256 nt
    s_add_u32 s62, s62, 8192
    buffer_load_dwordx4 v[60:63], v14, s[64:67], s62 offen offset:0 nt
    buffer_load_dwordx4 v[64:67], v14, s[64:67], s62 offen offset:256 nt
    s_add_u32 s62, s62, 8192
    buffer_load_dwordx4 v[68:71], v14, s[64:67], s62 offen offset:0 nt
    buffer_load_dwordx4 v[88:91], v14, s[64:67], s62 offen offset:256 nt
    s_add_u32 s62, s62, 8192
    buffer_load_dwordx4 v[92:95], v14, s[64:67], s62 offen offset:0 nt
    buffer_load_dwordx4 v[96:99], v14, s[64:67], s62 offen offset:256 nt
fz_now4:
    ds_write_b16 v233, v104
    ds_write_b16 v241, v112
    ds_write_b16_d16_hi v232, v112 offset:28
    ds_write_b16 v232, v113 offset:26
    ds_write_b16_d16_hi v232, v113 offset:24
    ds_write_b16 v232, v114 offset:22
    ds_write_b16_d16_hi v232, v114 offset:20
    ds_write_b16 v232, v115 offset:18
    ds_write_b16_d16_hi v232, v115 offset:16
    ds_write_b16 v232, v116 offset:14
    ds_write_b16_d16_hi v232, v116 offset:12
    ds_write_b16 v232, v117 offset:10
    ds_write_b16_d16_hi v232, v117 offset:8
    ds_write_b16 v232, v118 offset:6
    ds_write_b16_d16_hi v232, v118 offset:4
    ds_write_b16 v232, v119 offset:2
    ds_write_b16_d16_hi v232, v119 offset:0
    s_lshl_b32 s32, s3, 1
    s_add_u32 s33, s32, 1
    v_readlane_b32 s34, v230, s32
    v_readlane_b32 s35, v230, s33
    s_mul_i32 s38, s3, 4128
    v_add_u32 v9, s38, v239
    s_lshl_b32 s34, s34, 11
    s_lshl_b32 s35, s35, 11
    s_waitcnt lgkmcnt(0)
    s_barrier
    ds_read_b128 v[104:107], v9 offset:0
    ds_read_b128 v[108:111], v9 offset:1024
    ds_read_b128 v[112:115], v9 offset:2064
    ds_read_b128 v[116:119], v9 offset:3088
    s_lshr_b32 s59, s37, 1
    s_xor_b32 s18, s59, 1
    s_and_b32 s18, s18, 3
    s_cmp_lt_u32 s23, 112
    s_cselect_b32 s38, s18, 8
    s_cmp_eq_u32 s38, s3
    s_cbranch_scc1 fz_sk1
    s_cmp_eq_u32 s59, s3
    s_cbranch_scc1 fz_sk1
    s_waitcnt lgkmcnt(0)
    s_cmp_eq_u32 s37, s32
    s_cbranch_scc1 fz_sk0
    buffer_store_dwordx4 v[104:107], v239, s[12:15], s34 offen offset:0 sc1
    buffer_store_dwordx4 v[108:111], v239, s[12:15], s34 offen offset:1024 sc1
fz_sk0:
    s_cmp_eq_u32 s37, s33
    s_cbranch_scc1 fz_sk1
    buffer_store_dwordx4 v[112:115], v239, s[12:15], s35 offen offset:0 sc1
    buffer_store_dwordx4 v[116:119], v239, s[12:15], s35 offen offset:1024 sc1
fz_sk1:
    v_and_b32 v15, 7, v4
    v_mul_u32_u24 v15, 544, v15
    v_lshl_add_u32 v15, v5, 4, v15
    v_add_u32 v15, 108032, v15
    s_lshl_b32 s63, s23, 5
    s_and_b32 s38, s3, 3
    s_mul_i32 s38, s38, 118784
    s_add_u32 s63, s63, s38
    s_add_u32 s63, s63, 0x4c8000
    v_lshrrev_b32 v13, 1, v1
    v_mul_u32_u24 v13, 3712, v13
    v_and_b32 v14, 1, v1
    v_lshl_add_u32 v102, v14, 4, v13
    v_add_u32 v103, 59392, v102
    s_lshl_b32 s38, s20, 5
    s_add_u32 s38, s38, 0x548000
    s_cmp_lt_u32 s3, 4
    s_cselect_b32 s63, s38, s63
    v_mov_b32 v14, 0xffffff00
    s_cmp_eq_u32 s18, s3
    s_cbranch_scc1 fz_act
    s_cmp_lg_u32 s59, s3
    s_cbranch_scc1 fz_f2
    s_and_b32 s38, s20, 15
    s_add_u32 s38, s38, 16
    s_mul_i32 s38, s38, 2176
    s_add_u32 s38, s38, 0x580000
    s_lshr_b32 s52, s20, 4
    s_lshl_b32 s52, s52, 7
    s_and_b32 s53, s20, 7
    s_lshl_b32 s53, s53, 4
    s_add_u32 s52, s52, s53
    s_bfe_u32 s53, s20, 0x10003
    s_lshl_b32 s53, s53, 2
    s_add_u32 s52, s52, s53
    v_and_b32 v2, 1, v1
    v_lshl_add_u32 v2, v2, 3, v5
    v_add_u32 v2, s52, v2
    v_and_b32 v3, 31, v2
    v_lshrrev_b32 v6, 5, v2
    v_cmp_gt_u32 vcc, 16, v6
    v_cmp_lt_u32 s[52:53], 16, v3
    v_cmp_eq_u32 s[54:55], 0, v3
    s_nop 1
    s_and_b64 s[54:55], s[54:55], vcc
    s_or_b64 s[52:53], s[52:53], s[54:55]
    v_cmp_eq_u32 s[54:55], 16, v3
    s_nop 1
    s_andn2_b64 s[54:55], s[54:55], vcc
    s_or_b64 s[52:53], s[52:53], s[54:55]
    v_sub_u32 v7, 1024, v2
    v_cndmask_b32_e64 v7, v2, v7, s[52:53]
    v_mov_b32 v8, 512
    v_cmp_eq_u32 vcc, 1024, v7
    s_nop 1
    v_cndmask_b32_e64 v7, v7, v8, vcc
    v_lshrrev_b32 v8, 5, v7
    v_and_b32 v7, 15, v7
    v_lshrrev_b32 v9, 2, v8
    v_lshlrev_b32 v9, 8, v9
    v_and_b32 v8, 3, v8
    v_lshl_add_u32 v9, v8, 4, v9
    v_lshrrev_b32 v8, 3, v7
    v_lshl_add_u32 v9, v8, 6, v9
    v_and_b32 v7, 7, v7
    v_lshl_add_u32 v9, v7, 1, v9
    v_cndmask_b32_e64 v7, 0, 1, s[52:53]
    v_lshl_add_u32 v9, v7, 7, v9
    v_lshlrev_b32 v2, 1, v2
    v_lshrrev_b32 v3, 1, v1
    v_mul_u32_u24 v3, 32, v3
    v_and_b32 v6, 1, v1
    v_lshl_add_u32 v3, v6, 4, v3
    v_mov_b32 v6, 0x7fffffff
    v_cmp_gt_u32 vcc, 32, v1
    s_nop 1
    v_cndmask_b32_e64 v6, v6, v3, vcc
    v_mov_b32 v7, s48
    v_cndmask_b32_e64 v16, 0, v7, vcc
    v_mov_b32 v7, s49
    v_cndmask_b32_e64 v17, 0, v7, vcc
    v_mov_b32 v7, s50
    v_cndmask_b32_e64 v18, 0, v7, vcc
    v_mov_b32 v7, s51
    v_cndmask_b32_e64 v19, 0, v7, vcc
    s_mul_i32 s52, s20, 3712
    s_add_u32 s52, s52, 0x4c8000
    s_add_u32 s53, s52, 1024
    s_add_u32 s54, s52, 2048
    s_add_u32 s55, s52, 3072
    v_lshlrev_b32 v20, 4, v1
    v_add_u32 v21, 1024, v20
    s_mov_b32 s58, 0
    s_nop 3
fz_k2:
    buffer_load_dwordx4 v[24:27], v20, s[4:7], s38 offen sc1
    buffer_load_dwordx4 v[28:31], v21, s[4:7], s38 offen sc1
    s_waitcnt vmcnt(0)
    v_xor_b32 v32, s40, v27
    v_xor_b32 v33, s40, v31
    v_max_u32 v34, v24, v28
    v_or_b32 v32, v32, v33
    v_cmp_ne_u32 vcc, 0, v32
    s_cbranch_vccnz fz_k2_rt
fz_k2_ok:
    v_max_u32_dpp v34, v34, v34 quad_perm:[1,0,3,2] row_mask:0xf bank_mask:0xf
    s_nop 1
    v_max_u32_dpp v34, v34, v34 quad_perm:[2,3,0,1] row_mask:0xf bank_mask:0xf
    s_nop 1
    v_max_u32_dpp v34, v34, v34 row_half_mirror row_mask:0xf bank_mask:0xf
    s_nop 1
    v_max_u32_dpp v34, v34, v34 row_mirror row_mask:0xf bank_mask:0xf
    s_nop 1
    v_max_u32_dpp v34, v34, v34 row_bcast:15 row_mask:0xa bank_mask:0xf
    s_nop 1
    v_max_u32_dpp v34, v34, v34 row_bcast:31 row_mask:0xc bank_mask:0xf
    s_nop 0
    v_readlane_b32 s36, v34, 63
    s_nop 1
    v_cmp_eq_u32 vcc, s36, v24
    v_cmp_eq_u32 s[56:57], s36, v28
    s_nop 1
    v_cndmask_b32_e64 v25, v25, v29, s[56:57]
    v_cndmask_b32_e64 v26, v26, v30, s[56:57]
    s_cmp_lg_u64 vcc, 0
    s_cselect_b32 s39, 0, 64
    s_or_b64 vcc, vcc, s[56:57]
    s_ff1_i32_b64 s41, vcc
    v_readlane_b32 s42, v25, s41
    v_readlane_b32 s43, v26, s41
    s_add_u32 s39, s39, s41
    s_and_b32 s42, s42, 0xffff0000
    s_cmp_eq_u32 s39, s20
    s_cselect_b32 s19, s37, 16
    s_lshl_b32 s39, s39, 11
    s_add_u32 s39, s39, 0x448000
    s_mov_b32 s58, 0
    s_mov_b32 s41, 0xffff0000
    s_nop 0
fz_c2:
    buffer_load_short_d16_hi v10, v9, s[4:7], s39 offen sc1
    s_waitcnt vmcnt(0)
    v_cmp_eq_u32 vcc, s41, v10
    s_cbranch_vccnz fz_c2_rt
fz_c2_ok:
    s_cmp_eq_u32 s19, s32
    s_cbranch_scc1 fz_sc0
    buffer_store_dwordx4 v[104:107], v239, s[12:15], s34 offen offset:0 sc1
    buffer_store_dwordx4 v[108:111], v239, s[12:15], s34 offen offset:1024 sc1
fz_sc0:
    s_cmp_eq_u32 s19, s33
    s_cbranch_scc1 fz_sc1
    buffer_store_dwordx4 v[112:115], v239, s[12:15], s35 offen offset:0 sc1
    buffer_store_dwordx4 v[116:119], v239, s[12:15], s35 offen offset:1024 sc1
fz_sc1:
    v_add_f32 v11, s42, v10
    v_cvt_pk_bf16_f32 v11, 0, v11
    v_mul_f32 v11, s43, v11
    v_cvt_pk_bf16_f32 v11, 0, v11
    s_ashr_i32 s39, s36, 31
    s_not_b32 s39, s39
    s_or_b32 s39, s39, 0x80000000
    s_xor_b32 s39, s36, s39
    s_and_b32 s39, s39, 0xffff0000
    v_mov_b32 v12, s39
    v_mul_f32 v12, 0xbfb8aa3b, v12
    v_exp_f32 v12, v12
    s_nop 0
    v_add_f32 v12, 1.0, v12
    v_rcp_f32 v12, v12
    s_nop 0
    v_cvt_pk_bf16_f32 v12, 0, v12
    s_and_b32 s39, s36, 0xffff
    s_sub_u32 s39, 2047, s39
    s_lshl_b32 s39, s39, 11
    v_mov_b32 v13, 0xff
    s_waitcnt lgkmcnt(0)
fz_f2:
    s_cmp_gt_u32 s23, 111
    s_cbranch_scc1 fz_nof2
    s_barrier
    s_cmp_eq_u32 s59, s3
    s_cselect_b32 s19, 4, s3
    s_cmp_lt_u32 s19, 4
    s_cbranch_scc1 fz_f2d
    ds_read_b128 v[120:123], v15 offset:0
    ds_read_b128 v[124:127], v15 offset:64
    ds_read_b128 v[128:131], v15 offset:128
    ds_read_b128 v[132:135], v15 offset:192
    ds_read_b128 v[136:139], v15 offset:256
    ds_read_b128 v[140:143], v15 offset:320
    ds_read_b128 v[144:147], v15 offset:384
    ds_read_b128 v[148:151], v15 offset:448
    s_waitcnt vmcnt(2)
    s_waitcnt lgkmcnt(7)
    v_mfma_f32_16x16x32_bf16 v[152:155], v[120:123], v[160:163], 0
    v_mfma_f32_16x16x32_bf16 v[156:159], v[120:123], v[164:167], 0
    s_waitcnt lgkmcnt(6)
    v_mfma_f32_16x16x32_bf16 v[152:155], v[124:127], v[168:171], v[152:155]
    v_mfma_f32_16x16x32_bf16 v[156:159], v[124:127], v[172:175], v[156:159]
    s_waitcnt lgkmcnt(5)
    v_mfma_f32_16x16x32_bf16 v[152:155], v[128:131], v[176:179], v[152:155]
    v_mfma_f32_16x16x32_bf16 v[156:159], v[128:131], v[180:183], v[156:159]
    s_waitcnt lgkmcnt(4)
    v_mfma_f32_16x16x32_bf16 v[152:155], v[132:135], v[184:187], v[152:155]
    v_mfma_f32_16x16x32_bf16 v[156:159], v[132:135], v[188:191], v[156:159]
    s_waitcnt lgkmcnt(3)
    v_mfma_f32_16x16x32_bf16 v[152:155], v[136:139], v[192:195], v[152:155]
    v_mfma_f32_16x16x32_bf16 v[156:159], v[136:139], v[196:199], v[156:159]
    s_waitcnt lgkmcnt(2)
    v_mfma_f32_16x16x32_bf16 v[152:155], v[140:143], v[60:63], v[152:155]
    v_mfma_f32_16x16x32_bf16 v[156:159], v[140:143], v[64:67], v[156:159]
    s_waitcnt lgkmcnt(1)
    v_mfma_f32_16x16x32_bf16 v[152:155], v[144:147], v[68:71], v[152:155]
    v_mfma_f32_16x16x32_bf16 v[156:159], v[144:147], v[88:91], v[156:159]
    s_waitcnt lgkmcnt(0)
    v_mfma_f32_16x16x32_bf16 v[152:155], v[148:151], v[92:95], v[152:155]
    v_mfma_f32_16x16x32_bf16 v[156:159], v[148:151], v[96:99], v[156:159]
    s_mov_b32 exec_hi, 0
    s_nop 5
    v_and_or_b32 v152, v152, v14, s48
    v_and_or_b32 v153, v153, v14, s49
    v_and_or_b32 v154, v154, v14, s50
    v_and_or_b32 v155, v155, v14, s51
    buffer_store_dwordx4 v[152:155], v102, s[4:7], s63 offen sc1
    v_and_or_b32 v156, v156, v14, s48
    v_and_or_b32 v157, v157, v14, s49
    v_and_or_b32 v158, v158, v14, s50
    v_and_or_b32 v159, v159, v14, s51
    buffer_store_dwordx4 v[156:159], v103, s[4:7], s63 offen sc1
fz_f2d:
    s_mov_b32 exec_hi, -1
    s_cmp_eq_u32 s18, s3
    s_cbranch_scc1 fz_late
    s_cmp_lg_u32 s59, s3
    s_cbranch_scc1 fz_xend
    v_mov_b32 v7, 0
    s_waitcnt vmcnt(0)
    s_branch fz_p5_ok
    s_nop 2
fz_nof2:
    s_cmp_lg_u32 s59, s3
    s_cbranch_scc1 fz_xend
    s_mov_b32 s58, 0
    s_and_b32 s41, s20, 63
    s_mul_i32 s41, s41, 32
    s_add_u32 s41, s41, s52
    v_mov_b32 v7, 0
    s_nop 4
fz_p5:
    buffer_load_dword v8, v7, s[4:7], s41 offen sc1
    s_waitcnt vmcnt(0)
    v_and_b32 v8, 0xff, v8
    v_cmp_ne_u32 vcc, s48, v8
    s_cbranch_vccnz fz_p5_rt
fz_p5_ok:
    s_mov_b32 s58, 0
    buffer_load_dwordx4 v[40:43], v3, s[4:7], s52 offen sc1
    buffer_load_dwordx4 v[44:47], v3, s[4:7], s53 offen sc1
    buffer_load_dwordx4 v[48:51], v3, s[4:7], s54 offen sc1
    buffer_load_dwordx4 v[52:55], v6, s[4:7], s55 offen sc1
fz_h5_c0:
    s_waitcnt vmcnt(3)
    v_xor_b32 v40, s48, v40
    v_xor_b32 v41, s49, v41
    v_xor_b32 v42, s50, v42
    v_xor_b32 v43, s51, v43
    v_or3_b32 v8, v40, v41, v42
    v_bitop3_b32 v8, v8, v43, v13 bitop3:0xa8
    v_cmp_ne_u32 vcc, 0, v8
    s_cbranch_vccnz fz_h5_r0
fz_h5_o0:
fz_h5_c1:
    s_waitcnt vmcnt(2)
    v_xor_b32 v44, s48, v44
    v_xor_b32 v45, s49, v45
    v_xor_b32 v46, s50, v46
    v_xor_b32 v47, s51, v47
    v_or3_b32 v8, v44, v45, v46
    v_bitop3_b32 v8, v8, v47, v13 bitop3:0xa8
    v_cmp_ne_u32 vcc, 0, v8
    s_cbranch_vccnz fz_h5_r1
fz_h5_o1:
    v_pk_add_f32 v[40:41], v[40:41], v[44:45]
    v_pk_add_f32 v[42:43], v[42:43], v[46:47]
fz_h5_c2:
    s_waitcnt vmcnt(1)
    v_xor_b32 v48, s48, v48
    v_xor_b32 v49, s49, v49
    v_xor_b32 v50, s50, v50
    v_xor_b32 v51, s51, v51
    v_or3_b32 v8, v48, v49, v50
    v_bitop3_b32 v8, v8, v51, v13 bitop3:0xa8
    v_cmp_ne_u32 vcc, 0, v8
    s_cbranch_vccnz fz_h5_r2
fz_h5_o2:
    v_pk_add_f32 v[40:41], v[40:41], v[48:49]
    v_pk_add_f32 v[42:43], v[42:43], v[50:51]
fz_h5_c3:
    s_waitcnt vmcnt(0)
    v_xor_b32 v52, v16, v52
    v_xor_b32 v53, v17, v53
    v_xor_b32 v54, v18, v54
    v_xor_b32 v55, v19, v55
    v_or3_b32 v8, v52, v53, v54
    v_bitop3_b32 v8, v8, v55, v13 bitop3:0xa8
    v_cmp_ne_u32 vcc, 0, v8
    s_cbranch_vccnz fz_h5_r3
fz_h5_o3:
    v_pk_add_f32 v[40:41], v[40:41], v[52:53]
    v_pk_add_f32 v[42:43], v[42:43], v[54:55]
    s_nop 1
    v_permlane32_swap_b32 v40, v42
    v_permlane32_swap_b32 v41, v43
    v_pk_add_f32 v[40:41], v[40:41], v[42:43]
    s_nop 1
    v_permlane16_swap_b32 v40, v41
    v_add_f32 v40, v40, v41
    s_nop 1
    v_add_f32_dpp v40, v40, v40 quad_perm:[2,3,0,1] row_mask:0xf bank_mask:0xf
    s_nop 1
    v_add_f32_dpp v40, v40, v40 row_ror:4 row_mask:0xf bank_mask:0xf
    s_nop 1
    v_add_f32_dpp v40, v40, v40 row_ror:8 row_mask:0xf bank_mask:0xf
    v_cvt_pk_bf16_f32 v40, 0, v40
    v_mul_f32 v40, v40, v12
    v_cvt_pk_bf16_f32 v40, 0, v40
    v_add_f32 v40, v40, v11
    v_cvt_pk_bf16_f32 v40, 0, v40
    v_add_f32 v40, v40, v10
    v_cvt_pk_bf16_f32 v40, 0, v40
    s_mov_b32 exec_lo, 0x00030003
    s_mov_b32 exec_hi, 0x00030003
    buffer_store_short_d16_hi v40, v2, s[12:15], s39 offen
    s_cmp_lg_u32 s20, 0
    s_cbranch_scc1 fz_xend
    s_mov_b64 exec, 1
    v_mov_b32 v8, s40
    buffer_store_dword v8, v7, s[4:7], 0 offen
fz_xend:
fz_end:
    s_endpgm
fz_late:
    buffer_store_dwordx4 v[104:107], v239, s[12:15], s34 offen offset:0 sc1
    buffer_store_dwordx4 v[108:111], v239, s[12:15], s34 offen offset:1024 sc1
    buffer_store_dwordx4 v[112:115], v239, s[12:15], s35 offen offset:0 sc1
    buffer_store_dwordx4 v[116:119], v239, s[12:15], s35 offen offset:1024 sc1
    s_branch fz_xend
fz_act:
    s_cmp_gt_u32 s23, 111
    s_cbranch_scc1 fz_xend
    v_lshlrev_b32 v2, 2, v1
    v_and_b32 v11, 3, v1
    v_mov_b32 v3, s48
    v_cmp_eq_u32 vcc, 1, v11
    v_mov_b32 v10, s49
    s_nop 0
    v_cndmask_b32_e64 v3, v3, v10, vcc
    v_cmp_eq_u32 vcc, 2, v11
    v_mov_b32 v10, s50
    s_nop 0
    v_cndmask_b32_e64 v3, v3, v10, vcc
    v_cmp_eq_u32 vcc, 3, v11
    v_mov_b32 v10, s51
    s_nop 0
    v_cndmask_b32_e64 v3, v3, v10, vcc
    v_and_b32 v10, 31, v1
    v_lshlrev_b32 v6, 4, v10
    v_lshrrev_b32 v10, 5, v1
    v_mul_u32_u24 v10, 2184, v10
    v_add_u32 v6, v6, v10
    v_add_u32 v6, 108032, v6
    s_lshl_b32 s38, s23, 11
    s_add_u32 s38, s38, 0x488000
    s_mov_b32 s58, 0
fz_h4:
    buffer_load_dword v16, v2, s[4:7], s38 offen offset:0 sc1
    buffer_load_dword v17, v2, s[4:7], s38 offen offset:256 sc1
    buffer_load_dword v18, v2, s[4:7], s38 offen offset:512 sc1
    buffer_load_dword v19, v2, s[4:7], s38 offen offset:768 sc1
    buffer_load_dword v20, v2, s[4:7], s38 offen offset:1024 sc1
    buffer_load_dword v21, v2, s[4:7], s38 offen offset:1280 sc1
    buffer_load_dword v22, v2, s[4:7], s38 offen offset:1536 sc1
    buffer_load_dword v23, v2, s[4:7], s38 offen offset:1792 sc1
    s_waitcnt vmcnt(6)
    v_xor_b32 v16, v3, v16
    v_xor_b32 v17, v3, v17
    v_or3_b32 v10, v16, v17, 0
    v_add_f32 v16, v16, v17
    s_waitcnt vmcnt(4)
    v_xor_b32 v18, v3, v18
    v_xor_b32 v19, v3, v19
    v_or3_b32 v10, v18, v19, v10
    v_add_f32 v18, v18, v19
    v_add_f32 v16, v16, v18
    s_waitcnt vmcnt(2)
    v_xor_b32 v20, v3, v20
    v_xor_b32 v21, v3, v21
    v_or3_b32 v10, v20, v21, v10
    v_add_f32 v20, v20, v21
    s_waitcnt vmcnt(0)
    v_xor_b32 v22, v3, v22
    v_xor_b32 v23, v3, v23
    v_or3_b32 v10, v22, v23, v10
    v_add_f32 v22, v22, v23
    v_add_f32 v20, v20, v22
    v_and_b32 v10, 0xff, v10
    v_add_f32 v8, v16, v20
    v_cmp_ne_u32 vcc, 0, v10
    s_cbranch_vccnz fz_h4_rt
fz_h4_ok:
    v_cvt_pk_bf16_f32 v8, 0, v8
    v_mov_b32 v9, v8
    s_nop 1
    v_permlane32_swap_b32 v8, v9
    v_mul_f32 v10, 0xbfb8aa3b, v8
    v_exp_f32 v10, v10
    s_nop 0
    v_add_f32 v10, 1.0, v10
    v_rcp_f32 v10, v10
    s_nop 0
    v_mul_f32 v8, v8, v10
    v_cvt_pk_bf16_f32 v8, 0, v8
    v_mul_f32 v8, v8, v9
    v_cvt_pk_bf16_f32 v8, 0, v8
    ds_write_b16_d16_hi v6, v8 offset:0
    ds_write_b16_d16_hi v6, v8 offset:546
    ds_write_b16_d16_hi v6, v8 offset:1092
    ds_write_b16_d16_hi v6, v8 offset:1638
    s_waitcnt lgkmcnt(0)
    s_branch fz_f2
fz_ldh:
    s_load_dwordx2 s[12:13], s[0:1], 56
    s_load_dwordx2 s[16:17], s[0:1], 64
    s_mov_b32 s14, 0x700000
    s_mov_b32 s15, 0x00020000
    s_mov_b32 s18, 0x700000
    s_mov_b32 s19, 0x00020000
    s_branch fz_ldback
fz_spec:
    s_cmp_gt_u32 s3, 3
    s_cbranch_scc1 fz_spec_hi
    s_cmp_eq_u32 s3, 0
    s_cselect_b32 s31, 0, s31
    s_cselect_b32 s30, 33024, s30
    s_cmp_eq_u32 s3, 2
    s_cselect_b32 s31, 30960, s31
    s_cselect_b32 s30, 35088, s30
    s_cmp_eq_u32 s3, 3
    s_cselect_b32 s31, 37152, s31
    s_cselect_b32 s30, 39216, s30
    s_branch fz_specback
fz_spec_hi:
    s_mov_b32 m0, s31
    s_nop 0
    buffer_load_dwordx4 v239, s[8:11], s27 offen lds
    buffer_load_dwordx4 v239, s[8:11], s27 offen offset:1024 lds
    s_mov_b32 m0, s30
    s_nop 0
    buffer_load_dwordx4 v239, s[8:11], s28 offen lds
    buffer_load_dwordx4 v239, s[8:11], s28 offen offset:1024 lds
    v_lshlrev_b32 v13, 3, v0
    v_mov_b32 v10, -1
    v_mov_b32 v11, -1
    s_lshl_b32 s32, s20, 11
    s_add_u32 s32, s32, 0x447800
    s_mov_b32 s18, 0x800
    s_mov_b32 s19, 0x00020000
    s_lshl_b32 s33, s24, 10
    s_min_u32 s34, s33, 2048
    s_add_u32 s34, s34, 104960
    s_mov_b32 m0, s34
    buffer_store_dwordx2 v[10:11], v13, s[4:7], s32 offen sc1
    buffer_load_dwordx4 v239, s[16:19], s33 offen lds
    s_cmp_eq_u32 s24, 0
    s_cselect_b32 s31, 8256, s31
    s_cselect_b32 s30, 22704, s30
    s_cselect_b32 s27, 524288, s27
    s_cselect_b32 s28, 3670016, s28
    s_cmp_eq_u32 s24, 1
    s_cselect_b32 s31, 12384, s31
    s_cselect_b32 s30, 18576, s30
    s_cselect_b32 s27, 1572864, s27
    s_cselect_b32 s28, 2621440, s28
    s_cmp_eq_u32 s24, 2
    s_cselect_b32 s31, 41280, s31
    s_cselect_b32 s30, 43344, s30
    s_cselect_b32 s27, 1572864, s27
    s_cselect_b32 s28, 2621440, s28
    s_cmp_eq_u32 s24, 3
    s_cselect_b32 s31, 45408, s31
    s_cselect_b32 s30, 47472, s30
    s_cselect_b32 s27, 524288, s27
    s_cselect_b32 s28, 3670016, s28
    s_mov_b32 s57, 0
    s_branch fz_specback
fz_jb:
    v_cvt_pk_bf16_f32 v128, v104, v105
    v_cvt_pk_bf16_f32 v129, v106, v107
    v_cvt_pk_bf16_f32 v130, v108, v109
    v_cvt_pk_bf16_f32 v131, v110, v111
    v_cvt_pk_bf16_f32 v132, v112, v113
    v_cvt_pk_bf16_f32 v133, v114, v115
    v_cvt_pk_bf16_f32 v134, v116, v117
    v_cvt_pk_bf16_f32 v135, v118, v119
    s_branch fz_jend
fz_bsp0:
    buffer_load_dwordx4 v[160:163], v14, s[64:67], s62 offen offset:0 nt
    buffer_load_dwordx4 v[164:167], v14, s[64:67], s62 offen offset:256 nt
    s_add_u32 s62, s62, 8192
    buffer_load_dwordx4 v[168:171], v14, s[64:67], s62 offen offset:0 nt
    buffer_load_dwordx4 v[172:175], v14, s[64:67], s62 offen offset:256 nt
    s_add_u32 s62, s62, 8192
    buffer_load_dwordx4 v[176:179], v14, s[64:67], s62 offen offset:0 nt
    buffer_load_dwordx4 v[180:183], v14, s[64:67], s62 offen offset:256 nt
    s_add_u32 s62, s62, 8192
    buffer_load_dwordx4 v[184:187], v14, s[64:67], s62 offen offset:0 nt
    buffer_load_dwordx4 v[188:191], v14, s[64:67], s62 offen offset:256 nt
    s_add_u32 s62, s62, 8192
    s_branch fz_bsp
fz_spec40:
    s_mov_b32 s38, 0x80018001
    s_mov_b32 s39, 0x80018001
    v_cndmask_b32_e64 v112, v112, v104, s[38:39]
    v_cndmask_b32_e64 v113, v113, v105, s[38:39]
    s_branch fz_spec4back0
fz_spec41:
    s_mov_b32 s38, 0x80018001
    s_mov_b32 s39, 0x80018001
    v_cndmask_b32_e64 v114, v114, v106, s[38:39]
    v_cndmask_b32_e64 v115, v115, v107, s[38:39]
    s_branch fz_spec4back1
fz_spec42:
    s_mov_b32 s38, 0x80018001
    s_mov_b32 s39, 0x80018001
    v_cndmask_b32_e64 v116, v116, v108, s[38:39]
    v_cndmask_b32_e64 v117, v117, v109, s[38:39]
    s_branch fz_spec4back2
fz_spec43:
    s_mov_b32 s38, 0x80018001
    s_mov_b32 s39, 0x80018001
    v_cndmask_b32_e64 v118, v118, v110, s[38:39]
    v_cndmask_b32_e64 v119, v119, v111, s[38:39]
    s_branch fz_spec4back3
    s_nop 3
fz_nc1:
    s_setprio 0
    s_cmp_lg_u32 s59, 0
    s_cbranch_scc1 ffn_b
    buffer_load_dwordx4 v[176:179], v14, s[64:67], s62 offen offset:0 nt
    buffer_load_dwordx4 v[180:183], v14, s[64:67], s62 offen offset:256 nt
    s_add_u32 s62, s62, 8192
    buffer_load_dwordx4 v[184:187], v14, s[64:67], s62 offen offset:0 nt
    buffer_load_dwordx4 v[188:191], v14, s[64:67], s62 offen offset:256 nt
    s_add_u32 s62, s62, 8192
    s_mov_b32 m0, s31
    s_nop 0
    buffer_load_dwordx4 v239, s[8:11], s27 offen nt lds
    buffer_load_dwordx4 v239, s[8:11], s27 offen offset:1024 nt lds
    s_mov_b32 m0, s30
    s_nop 0
    buffer_load_dwordx4 v239, s[8:11], s28 offen nt lds
    buffer_load_dwordx4 v239, s[8:11], s28 offen offset:1024 nt lds
    v_lshlrev_b32 v13, 3, v0
    v_mov_b32 v10, -1
    v_mov_b32 v11, -1
    s_lshl_b32 s32, s20, 11
    s_add_u32 s32, s32, 0x447800
    s_mov_b32 s18, 0x800
    s_mov_b32 s19, 0x00020000
    s_lshl_b32 s33, s24, 10
    s_min_u32 s34, s33, 2048
    s_add_u32 s34, s34, 104960
    s_mov_b32 m0, s34
    buffer_store_dwordx2 v[10:11], v13, s[4:7], s32 offen sc1
    buffer_load_dwordx4 v239, s[16:19], s33 offen lds
    s_waitcnt vmcnt(14)
    v_readfirstlane_b32 s40, v250
    s_nop 1
    s_add_u32 s40, s40, 1
    s_and_b32 s38, s40, 3
    s_and_b32 s39, s40, 15
    s_bfe_u32 s41, s40, 0x20002
    s_lshl_b32 s41, s41, 16
    s_or_b32 s44, s38, s41
    s_bfe_u32 s41, s40, 0x40004
    s_lshl_b32 s41, s41, 4
    s_or_b32 s48, s39, s41
    s_bfe_u32 s41, s40, 0x20004
    s_lshl_b32 s41, s41, 16
    s_or_b32 s45, s38, s41
    s_bfe_u32 s41, s40, 0x40008
    s_lshl_b32 s41, s41, 4
    s_or_b32 s49, s39, s41
    s_bfe_u32 s41, s40, 0x20006
    s_lshl_b32 s41, s41, 16
    s_or_b32 s46, s38, s41
    s_bfe_u32 s41, s40, 0x4000c
    s_lshl_b32 s41, s41, 4
    s_or_b32 s50, s39, s41
    s_bfe_u32 s41, s40, 0x20008
    s_lshl_b32 s41, s41, 16
    s_or_b32 s47, s38, s41
    s_bfe_u32 s41, s40, 0x40010
    s_lshl_b32 s41, s41, 4
    s_or_b32 s51, s39, s41
    s_mov_b32 s38, 0x404
    s_cmp_eq_u32 s2, 66
    s_cselect_b32 s39, 8, 4
    s_cselect_b32 s38, 8, s38
fz_bsp:
    s_setprio 0
    s_mov_b32 s57, 1
    s_cmp_gt_u32 s3, 5
    s_cbranch_scc1 fz_nocq
    s_and_b32 s32, s3, 1
    s_lshl_b32 s33, s32, 2
    s_lshl_b32 s32, s32, 11
    v_and_b32 v8, 3, v4
    v_lshrrev_b32 v9, 2, v4
    v_lshl_add_u32 v8, v8, 3, v9
    v_add_u32 v8, s33, v8
    v_cvt_f32_u32 v8, v8
    v_mul_f32 v8, 0x3d000000, v8
    v_cvt_f32_u32 v9, v5
    v_mul_f32 v9, 4.0, v9
    v_mul_f32 v9, v8, v9
    v_mov_b32 v104, v9
    v_fmamk_f32 v105, v8, 0x3f800000, v9
    v_fmamk_f32 v106, v8, 0x40000000, v9
    v_fmamk_f32 v107, v8, 0x40400000, v9
    v_fmamk_f32 v108, v8, 0x41800000, v9
    v_fmamk_f32 v109, v8, 0x41880000, v9
    v_fmamk_f32 v110, v8, 0x41900000, v9
    v_fmamk_f32 v111, v8, 0x41980000, v9
    v_sin_f32 v112, v104
    v_sin_f32 v113, v105
    v_sin_f32 v114, v106
    v_sin_f32 v115, v107
    v_sin_f32 v116, v108
    v_sin_f32 v117, v109
    v_sin_f32 v118, v110
    v_sin_f32 v119, v111
    v_cos_f32 v104, v104
    v_cos_f32 v105, v105
    v_cos_f32 v106, v106
    v_cos_f32 v107, v107
    v_cos_f32 v108, v108
    v_cos_f32 v109, v109
    v_cos_f32 v110, v110
    v_cos_f32 v111, v111
    v_mul_f32 v104, 0x3d800000, v104
    v_mul_f32 v105, 0x3d800000, v105
    v_mul_f32 v106, 0x3d800000, v106
    v_mul_f32 v107, 0x3d800000, v107
    v_mul_f32 v108, 0x3d800000, v108
    v_mul_f32 v109, 0x3d800000, v109
    v_mul_f32 v110, 0x3d800000, v110
    v_mul_f32 v111, 0x3d800000, v111
    v_mul_f32 v112, 0x3d800000, v112
    v_mul_f32 v113, 0x3d800000, v113
    v_mul_f32 v114, 0x3d800000, v114
    v_mul_f32 v115, 0x3d800000, v115
    v_mul_f32 v116, 0x3d800000, v116
    v_mul_f32 v117, 0x3d800000, v117
    v_mul_f32 v118, 0x3d800000, v118
    v_mul_f32 v119, 0x3d800000, v119
    v_cvt_pk_f16_f32 v128, v104, v105
    v_cvt_pk_f16_f32 v129, v106, v107
    v_cvt_pk_f16_f32 v130, v108, v109
    v_cvt_pk_f16_f32 v131, v110, v111
    v_cvt_pk_f16_f32 v132, v112, v113
    v_cvt_pk_f16_f32 v133, v114, v115
    v_cvt_pk_f16_f32 v134, v116, v117
    v_cvt_pk_f16_f32 v135, v118, v119
    v_add_u32 v8, s32, v6
    ds_write_b128 v8, v[128:131] offset:14336
    ds_write_b128 v8, v[132:135] offset:15360
fz_nocq:
    s_and_b32 s32, s3, 3
    s_lshr_b32 s33, s3, 2
    s_lshl_b32 s33, s33, 4
    s_add_u32 s33, s33, s32
    v_and_b32 v8, 12, v4
    v_bfe_u32 v9, v4, 1, 1
    v_lshl_add_u32 v8, v9, 5, v8
    v_add_u32 v8, s33, v8
    v_cvt_f32_u32 v8, v8
    v_and_b32 v12, 1, v1
    v_cvt_f32_u32 v9, v12
    v_lshlrev_b32 v13, 2, v5
    v_cvt_f32_u32 v10, v13
    v_mul_f32 v11, 0x3c800000, v8
    v_mul_f32 v9, 0x3e800000, v9
    v_fma_f32 v9, v11, v10, v9
    v_mov_b32 v128, v9
    v_fmamk_f32 v129, v11, 0x3f800000, v9
    v_fmamk_f32 v130, v11, 0x40000000, v9
    v_fmamk_f32 v131, v11, 0x40400000, v9
    v_mul_f32 v11, 0x3a000000, v8
    v_lshlrev_b32 v9, 31, v1
    v_xor_b32 v11, v9, v11
    v_mul_f32 v9, v11, v10
    v_mov_b32 v112, v9
    v_fmamk_f32 v113, v11, 0x3f800000, v9
    v_fmamk_f32 v114, v11, 0x40000000, v9
    v_fmamk_f32 v115, v11, 0x40400000, v9
    v_fmamk_f32 v116, v11, 0x41800000, v9
    v_fmamk_f32 v117, v11, 0x41880000, v9
    v_fmamk_f32 v118, v11, 0x41900000, v9
    v_fmamk_f32 v119, v11, 0x41980000, v9
    v_cos_f32 v104, v128
    v_sin_f32 v105, v128
    v_cos_f32 v106, v129
    v_sin_f32 v107, v129
    v_cos_f32 v108, v130
    v_sin_f32 v109, v130
    v_cos_f32 v110, v131
    v_sin_f32 v111, v131
    v_sin_f32 v120, v112
    v_sin_f32 v121, v113
    v_sin_f32 v122, v114
    v_sin_f32 v123, v115
    v_sin_f32 v124, v116
    v_sin_f32 v125, v117
    v_sin_f32 v126, v118
    v_sin_f32 v127, v119
    v_cos_f32 v112, v112
    v_cos_f32 v113, v113
    v_cos_f32 v114, v114
    v_cos_f32 v115, v115
    v_cos_f32 v116, v116
    v_cos_f32 v117, v117
    v_cos_f32 v118, v118
    v_cos_f32 v119, v119
    v_cvt_pk_f16_f32 v16, v104, v105
    v_cvt_pk_f16_f32 v17, v106, v107
    v_cvt_pk_f16_f32 v18, v108, v109
    v_cvt_pk_f16_f32 v19, v110, v111
    v_cvt_pk_f16_f32 v20, v112, v113
    v_cvt_pk_f16_f32 v21, v114, v115
    v_cvt_pk_f16_f32 v22, v116, v117
    v_cvt_pk_f16_f32 v23, v118, v119
    v_cvt_pk_f16_f32 v24, v120, v121
    v_cvt_pk_f16_f32 v25, v122, v123
    v_cvt_pk_f16_f32 v26, v124, v125
    v_cvt_pk_f16_f32 v27, v126, v127
    s_and_b32 s32, s3, 3
    s_lshl_b32 s32, s32, 11
    s_add_u32 s32, s32, 86400
    v_add_u32 v225, s32, v239
    v_add_u32 v8, s33, v13
    v_sub_u32 v9, 32, v8
    v_min_u32 v9, v8, v9
    v_and_b32 v10, 15, v8
    v_cmp_eq_u32 s[32:33], 0, v10
    v_cmp_lt_u32 s[34:35], 16, v8
    v_lshlrev_b32 v10, 10, v9
    v_subrev_u32 v10, 1024, v10
    v_mov_b32 v11, 15872
    v_cmp_eq_u32 vcc, 0, v8
    s_nop 1
    v_cndmask_b32_e64 v10, v10, v11, vcc
    v_and_b32 v11, 3, v1
    v_lshl_add_u32 v10, v11, 4, v10
    v_lshrrev_b32 v11, 2, v4
    v_lshlrev_b32 v12, 7, v11
    v_sub_u32 v13, 960, v12
    v_cndmask_b32_e64 v13, v12, v13, s[34:35]
    v_add_u32 v226, v10, v13
    s_or_b64 s[34:35], s[34:35], s[32:33]
    v_add_u32 v12, 512, v12
    v_sub_u32 v13, 960, v12
    v_cndmask_b32_e64 v13, v12, v13, s[34:35]
    v_add_u32 v227, v10, v13
    s_mul_i32 s56, s20, 16512
    s_add_u32 s56, s56, 0x210000
    v_mov_b32 v249, 0x30003
    v_mov_b32 v252, s44
    v_mov_b32 v253, s45
    v_mov_b32 v254, s46
    v_mov_b32 v255, s47
    s_waitcnt lgkmcnt(0)
    v_sub_u32 v8, 15, v4
    v_min_u32 v8, v4, v8
    v_and_b32 v9, 1, v8
    v_lshlrev_b32 v9, 5, v9
    v_lshrrev_b32 v10, 1, v8
    v_lshl_add_u32 v9, v10, 9, v9
    v_add_u32 v9, s25, v9
    v_sub_u32 v10, 2048, v9
    v_cmp_lt_u32 s[34:35], 7, v4
    s_nop 1
    v_cndmask_b32_e64 v230, v9, v10, s[34:35]
    v_mov_b32 v9, v4
    v_mov_b32 v10, s20
    s_cmp_lg_u32 s21, 0
    s_cbranch_scc0 fz_spec3b
fz_spec3backb:
    v_lshlrev_b32 v10, 7, v10
    v_lshl_add_u32 v10, v9, 3, v10
    v_mul_u32_u24 v11, 66048, v5
    v_add_u32 v228, v10, v11
    v_and_b32 v9, 1, v9
    v_cmp_eq_u32 vcc, 1, v9
    v_mov_b32 v9, s44
    v_mov_b32 v10, s46
    v_cndmask_b32_e64 v236, v9, v10, vcc
    v_mov_b32 v9, s45
    v_mov_b32 v10, s47
    v_cndmask_b32_e64 v237, v9, v10, vcc
    s_lshl_b32 s32, s3, 2
    v_add_u32 v8, s32, v5
    v_lshlrev_b32 v9, 6, v8
    v_cmp_gt_u32 vcc, 16, v8
    s_nop 1
    v_cndmask_b32_e64 v10, 0, 32, vcc
    v_add_u32 v10, v9, v10
    v_sub_u32 v11, 2048, v10
    v_cmp_eq_u32 vcc, 16, v8
    s_nop 1
    v_cndmask_b32_e64 v11, v11, 0, vcc
    v_mov_b32 v12, 0xffff0000
    v_cndmask_b32_e64 v238, -1, v12, vcc
    v_sub_u32 v12, 2018, v9
    v_mul_u32_u24 v13, 2064, v4
    v_add_u32 v231, v13, v9
    v_add_u32 v232, v13, v12
    v_add_u32 v233, v13, v10
    v_add_u32 v241, v13, v11
    s_lshl_b32 s32, s3, 8
    s_add_u32 s32, s32, 102912
    v_lshlrev_b32 v9, 4, v4
    v_add_u32 v10, s32, v9
    v_add_u32 v11, 107008, v239
    v_cmp_gt_u32 vcc, 16, v1
    s_nop 1
    v_cndmask_b32_e64 v243, v11, v10, vcc
    v_lshrrev_b32 v12, 2, v4
    v_cmp_eq_u32 vcc, v12, v5
    s_nop 1
    v_cndmask_b32_e64 v244, v11, v10, vcc
    v_lshrrev_b32 v12, 5, v1
    v_lshl_add_u32 v10, v12, 10, v9
    v_add_u32 v245, 102912, v10
    v_and_b32 v9, 1, v1
    v_cmp_eq_u32 s[28:29], 1, v9
    v_and_b32 v9, 2, v1
    v_cmp_eq_u32 s[30:31], 2, v9
    s_lshl_b32 s37, s3, 2
    v_add_u32 v9, s37, v5
    v_mul_u32_u24 v246, 2176, v9
    s_lshl_b32 s26, s20, 4
    s_add_u32 s26, s26, 0x580000
    v_lshlrev_b32 v247, 4, v5
    s_lshl_b32 s27, s20, 11
    s_lshl_b32 s37, s3, 8
    s_add_u32 s27, s27, s37
    s_add_u32 s27, s27, 0x448000
    v_sub_u32 v248, 2047, v230
    s_mov_b32 s14, 0x400000
    s_mov_b32 s15, 0x00020000
    s_mul_i32 s52, s3, 264192
    s_add_u32 s52, s52, 0x210000
    s_add_u32 s53, s52, 16512
    s_add_u32 s54, s52, 33024
    s_add_u32 s55, s52, 49536
    s_mov_b32 s23, s63
    s_getreg_b32 s24, hwreg(HW_REG_XCC_ID)
    s_and_b32 s24, s24, 15
    v_lshlrev_b32 v10, 4, v0
    v_min_u32 v10, 4336, v10
    v_add_u32 v10, 108032, v10
    v_mov_b32 v104, 0
    v_mov_b32 v105, 0
    v_mov_b32 v106, 0
    v_mov_b32 v107, 0
    ds_write_b128 v10, v[104:107]
    s_cmp_eq_u32 s2, 66
    s_cbranch_scc1 fz_sz
    s_waitcnt vmcnt(0)
    v_mov_b32 v10, 256
    s_mov_b64 exec, 1
    ds_add_u32 v15, v10
    s_mov_b64 exec, -1
fz_sz:
    ds_read_b32 v10, v15
    s_waitcnt lgkmcnt(0)
    v_cmp_ne_u32 vcc, s38, v10
    s_cbranch_vccnz fz_sz
    ds_read_b128 v[116:119], v231
    ds_read_b128 v[120:123], v231 offset:16
    ds_read_u16_d16_hi v44, v241
    ds_read_u16_d16_hi v45, v232 offset:28
    ds_read_u16_d16_hi v46, v232 offset:26
    ds_read_u16_d16_hi v47, v232 offset:24
    ds_read_u16_d16_hi v48, v232 offset:22
    ds_read_u16_d16_hi v49, v232 offset:20
    ds_read_u16_d16_hi v50, v232 offset:18
    ds_read_u16_d16_hi v51, v232 offset:16
    ds_read_u16_d16_hi v52, v232 offset:14
    ds_read_u16_d16_hi v53, v232 offset:12
    ds_read_u16_d16_hi v54, v232 offset:10
    ds_read_u16_d16_hi v55, v232 offset:8
    ds_read_u16_d16_hi v56, v232 offset:6
    ds_read_u16_d16_hi v57, v232 offset:4
    ds_read_u16_d16_hi v58, v232 offset:2
    ds_read_u16_d16_hi v59, v232 offset:0
    ds_read_u16_d16_hi v28, v233
    v_mul_u32_u24 v13, 2064, v4
    v_subrev_u32 v13, 104960, v13
    v_sub_u32 v9, v231, v13
    v_sub_u32 v10, v233, v13
    v_sub_u32 v11, v241, v13
    v_sub_u32 v12, v232, v13
    s_mov_b32 s36, 0xffff0000
    s_waitcnt lgkmcnt(0)
    ds_read_b128 v[200:203], v9
    ds_read_b128 v[204:207], v9 offset:16
    ds_read_u16_d16 v208, v11
    ds_read_u16_d16_hi v124, v12 offset:28
    ds_read_u16_d16 v209, v12 offset:26
    ds_read_u16_d16_hi v125, v12 offset:24
    ds_read_u16_d16 v210, v12 offset:22
    ds_read_u16_d16_hi v126, v12 offset:20
    ds_read_u16_d16 v211, v12 offset:18
    ds_read_u16_d16_hi v127, v12 offset:16
    ds_read_u16_d16 v212, v12 offset:14
    ds_read_u16_d16_hi v128, v12 offset:12
    ds_read_u16_d16 v213, v12 offset:10
    ds_read_u16_d16_hi v129, v12 offset:8
    ds_read_u16_d16 v214, v12 offset:6
    ds_read_u16_d16_hi v130, v12 offset:4
    ds_read_u16_d16 v215, v12 offset:2
    ds_read_u16_d16_hi v131, v12 offset:0
    ds_read_u16_d16 v13, v10
    v_and_b32 v29, s36, v116
    v_lshlrev_b32 v30, 16, v117
    v_and_b32 v31, s36, v117
    v_lshlrev_b32 v32, 16, v118
    v_and_b32 v33, s36, v118
    v_lshlrev_b32 v34, 16, v119
    v_and_b32 v35, s36, v119
    v_lshlrev_b32 v36, 16, v120
    v_and_b32 v37, s36, v120
    v_lshlrev_b32 v38, 16, v121
    v_and_b32 v39, s36, v121
    v_lshlrev_b32 v40, 16, v122
    v_and_b32 v41, s36, v122
    v_lshlrev_b32 v42, 16, v123
    v_and_b32 v43, s36, v123
    v_cmp_eq_u32 vcc, 1, v4
    v_mov_b32 v9, s42
    s_nop 0
    v_cndmask_b32_e64 v9, 0, v9, vcc
    v_mov_b32 v116, s42
    v_mov_b32 v117, s42
    v_mov_b32 v118, s42
    v_mov_b32 v119, s42
    v_cmp_eq_u32 vcc, 0, v4
    s_waitcnt lgkmcnt(0)
    v_and_or_b32 v200, v200, s36, v13
    v_or_b32 v208, v208, v124
    v_or_b32 v209, v209, v125
    v_or_b32 v210, v210, v126
    v_or_b32 v211, v211, v127
    v_or_b32 v212, v212, v128
    v_or_b32 v213, v213, v129
    v_or_b32 v214, v214, v130
    v_or_b32 v215, v215, v131
    v_cndmask_b32_e64 v200, v9, v200, vcc
    v_cndmask_b32_e64 v201, v9, v201, vcc
    v_cndmask_b32_e64 v202, v9, v202, vcc
    v_cndmask_b32_e64 v203, v9, v203, vcc
    v_cndmask_b32_e64 v204, v9, v204, vcc
    v_cndmask_b32_e64 v205, v9, v205, vcc
    v_cndmask_b32_e64 v206, v9, v206, vcc
    v_cndmask_b32_e64 v207, v9, v207, vcc
    v_cndmask_b32_e64 v208, v9, v208, vcc
    v_cndmask_b32_e64 v209, v9, v209, vcc
    v_cndmask_b32_e64 v210, v9, v210, vcc
    v_cndmask_b32_e64 v211, v9, v211, vcc
    v_cndmask_b32_e64 v212, v9, v212, vcc
    v_cndmask_b32_e64 v213, v9, v213, vcc
    v_cndmask_b32_e64 v214, v9, v214, vcc
    v_cndmask_b32_e64 v215, v9, v215, vcc
    v_mfma_f32_16x16x32_bf16 v[120:123], v[200:203], v[116:119], 0
    v_mfma_f32_16x16x32_bf16 v[120:123], v[204:207], v[116:119], v[120:123]
    v_mfma_f32_16x16x32_bf16 v[120:123], v[208:211], v[116:119], v[120:123]
    v_mfma_f32_16x16x32_bf16 v[120:123], v[212:215], v[116:119], v[120:123]
    s_nop 7
    ds_write_b32 v243, v120 offset:12
    s_waitcnt lgkmcnt(0)
    s_branch fz_hb
    s_nop 0
fz_nc3:
    s_mov_b32 s58, 0
    s_waitcnt vmcnt(0)
    s_branch fz_h2
fz_spec3a:
    v_xor_b32 v11, 1, v4
    v_cndmask_b32_e64 v9, v9, v11, s[34:35]
    v_and_b32 v11, 1, v4
    v_cndmask_b32_e64 v11, 0, v11, s[34:35]
    v_sub_u32 v10, v10, v11
    s_cmp_lg_u32 s22, 0
    s_cbranch_scc1 fz_spec3backa
    v_cmp_eq_u32 vcc, 15, v4
    v_mov_b32 v11, 1024
    v_mov_b32 v12, 124
    v_cndmask_b32_e64 v230, v230, v11, vcc
    v_cndmask_b32_e64 v10, v10, v12, vcc
    v_cndmask_b32_e64 v9, v9, 4, vcc
    v_cmp_eq_u32 vcc, 13, v4
    v_mov_b32 v11, 1536
    v_mov_b32 v12, 124
    v_cndmask_b32_e64 v230, v230, v11, vcc
    v_cndmask_b32_e64 v10, v10, v12, vcc
    v_cndmask_b32_e64 v9, v9, 6, vcc
    v_cmp_eq_u32 vcc, 4, v4
    v_mov_b32 v11, 256
    v_mov_b32 v12, 127
    v_cndmask_b32_e64 v230, v230, v11, vcc
    v_cndmask_b32_e64 v10, v10, v12, vcc
    v_cndmask_b32_e64 v9, v9, 8, vcc
    v_cmp_eq_u32 vcc, 11, v4
    v_mov_b32 v11, 1792
    v_mov_b32 v12, 127
    v_cndmask_b32_e64 v230, v230, v11, vcc
    v_cndmask_b32_e64 v10, v10, v12, vcc
    v_cndmask_b32_e64 v9, v9, 14, vcc
    v_cmp_eq_u32 vcc, 6, v4
    v_mov_b32 v11, 768
    v_mov_b32 v12, 127
    v_cndmask_b32_e64 v230, v230, v11, vcc
    v_cndmask_b32_e64 v10, v10, v12, vcc
    v_cndmask_b32_e64 v9, v9, 10, vcc
    v_cmp_eq_u32 vcc, 9, v4
    v_mov_b32 v11, 1280
    v_mov_b32 v12, 127
    v_cndmask_b32_e64 v230, v230, v11, vcc
    v_cndmask_b32_e64 v10, v10, v12, vcc
    v_cndmask_b32_e64 v9, v9, 12, vcc
    s_nop 4
    s_branch fz_spec3backa
fz_spec3b:
    v_xor_b32 v11, 1, v4
    v_cndmask_b32_e64 v9, v9, v11, s[34:35]
    v_and_b32 v11, 1, v4
    v_cndmask_b32_e64 v11, 0, v11, s[34:35]
    v_sub_u32 v10, v10, v11
    s_cmp_lg_u32 s22, 0
    s_cbranch_scc1 fz_spec3backb
    v_cmp_eq_u32 vcc, 15, v4
    v_mov_b32 v11, 1024
    v_mov_b32 v12, 124
    v_cndmask_b32_e64 v230, v230, v11, vcc
    v_cndmask_b32_e64 v10, v10, v12, vcc
    v_cndmask_b32_e64 v9, v9, 4, vcc
    v_cmp_eq_u32 vcc, 13, v4
    v_mov_b32 v11, 1536
    v_mov_b32 v12, 124
    v_cndmask_b32_e64 v230, v230, v11, vcc
    v_cndmask_b32_e64 v10, v10, v12, vcc
    v_cndmask_b32_e64 v9, v9, 6, vcc
    v_cmp_eq_u32 vcc, 4, v4
    v_mov_b32 v11, 256
    v_mov_b32 v12, 127
    v_cndmask_b32_e64 v230, v230, v11, vcc
    v_cndmask_b32_e64 v10, v10, v12, vcc
    v_cndmask_b32_e64 v9, v9, 8, vcc
    v_cmp_eq_u32 vcc, 11, v4
    v_mov_b32 v11, 1792
    v_mov_b32 v12, 127
    v_cndmask_b32_e64 v230, v230, v11, vcc
    v_cndmask_b32_e64 v10, v10, v12, vcc
    v_cndmask_b32_e64 v9, v9, 14, vcc
    v_cmp_eq_u32 vcc, 6, v4
    v_mov_b32 v11, 768
    v_mov_b32 v12, 127
    v_cndmask_b32_e64 v230, v230, v11, vcc
    v_cndmask_b32_e64 v10, v10, v12, vcc
    v_cndmask_b32_e64 v9, v9, 10, vcc
    v_cmp_eq_u32 vcc, 9, v4
    v_mov_b32 v11, 1280
    v_mov_b32 v12, 127
    v_cndmask_b32_e64 v230, v230, v11, vcc
    v_cndmask_b32_e64 v10, v10, v12, vcc
    v_cndmask_b32_e64 v9, v9, 12, vcc
    s_nop 4
    s_branch fz_spec3backb
    s_nop 0
ffn_b:
    s_waitcnt vmcnt(0)
    v_readfirstlane_b32 s40, v250
    s_nop 1
    s_add_u32 s40, s40, 1
    s_and_b32 s38, s40, 3
    s_and_b32 s39, s40, 15
    s_bfe_u32 s41, s40, 0x20002
    s_lshl_b32 s41, s41, 16
    s_or_b32 s44, s38, s41
    s_bfe_u32 s41, s40, 0x40004
    s_lshl_b32 s41, s41, 4
    s_or_b32 s48, s39, s41
    s_bfe_u32 s41, s40, 0x20004
    s_lshl_b32 s41, s41, 16
    s_or_b32 s45, s38, s41
    s_bfe_u32 s41, s40, 0x40008
    s_lshl_b32 s41, s41, 4
    s_or_b32 s49, s39, s41
    s_bfe_u32 s41, s40, 0x20006
    s_lshl_b32 s41, s41, 16
    s_or_b32 s46, s38, s41
    s_bfe_u32 s41, s40, 0x4000c
    s_lshl_b32 s41, s41, 4
    s_or_b32 s50, s39, s41
    s_bfe_u32 s41, s40, 0x20008
    s_lshl_b32 s41, s41, 16
    s_or_b32 s47, s38, s41
    s_bfe_u32 s41, s40, 0x40010
    s_lshl_b32 s41, s41, 4
    s_or_b32 s51, s39, s41
    s_nop 0
ffn:
    s_add_u32 s36, s2, 4
    s_and_b32 s36, s36, 7
    s_bfe_u32 s37, s2, 0x10006
    s_lshl_b32 s22, s36, 1
    s_add_u32 s22, s22, s37
    s_cmp_lg_u32 s37, 0
    s_cselect_b32 s37, 8, s36
    s_add_u32 s37, s37, 6
    s_cmp_lt_u32 s36, 6
    s_cselect_b32 s22, s22, s37
    s_cmp_gt_u32 s22, 13
    s_cbranch_scc1 fz_xend
    s_bfe_u32 s21, s2, 0x30003
    v_lshrrev_b32 v2, 5, v1
    v_and_b32 v3, 31, v1
    v_lshlrev_b32 v4, 1, v2
    v_xor_b32 v3, v4, v3
    v_mul_u32_u24 v4, 7168, v2
    v_lshl_add_u32 v4, v3, 4, v4
    v_xor_b32 v5, 64, v4
    v_xor_b32 v6, 128, v4
    v_xor_b32 v7, 192, v4
    s_lshl_b32 s23, s21, 7
    s_lshl_b32 s24, s3, 4
    s_add_u32 s23, s23, s24
    s_mul_i32 s23, s23, 7168
    s_lshl_b32 s24, s22, 9
    s_add_u32 s23, s23, s24
    s_lshl_b32 s24, s3, 13
    v_mov_b32 v31, 149552
    v_mov_b32 v10, 0
    ds_write_b32 v31, v10
    s_waitcnt lgkmcnt(0)
    s_setprio 0
    s_barrier
    s_add_u32 s28, s24, 81920
    s_mov_b32 m0, s28
    s_add_u32 s29, s23, 0
    buffer_load_dwordx4 v4, s[12:15], s29 offen nt lds
    s_add_u32 s28, s24, 82944
    s_mov_b32 m0, s28
    s_add_u32 s29, s23, 14336
    buffer_load_dwordx4 v5, s[12:15], s29 offen nt lds
    s_add_u32 s28, s24, 83968
    s_mov_b32 m0, s28
    s_add_u32 s29, s23, 28672
    buffer_load_dwordx4 v4, s[12:15], s29 offen nt lds
    s_add_u32 s28, s24, 84992
    s_mov_b32 m0, s28
    s_add_u32 s29, s23, 43008
    buffer_load_dwordx4 v5, s[12:15], s29 offen nt lds
    s_add_u32 s28, s24, 86016
    s_mov_b32 m0, s28
    s_add_u32 s29, s23, 57344
    buffer_load_dwordx4 v6, s[12:15], s29 offen nt lds
    s_add_u32 s28, s24, 87040
    s_mov_b32 m0, s28
    s_add_u32 s29, s23, 71680
    buffer_load_dwordx4 v7, s[12:15], s29 offen nt lds
    s_add_u32 s28, s24, 88064
    s_mov_b32 m0, s28
    s_add_u32 s29, s23, 86016
    buffer_load_dwordx4 v6, s[12:15], s29 offen nt lds
    s_add_u32 s28, s24, 89088
    s_mov_b32 m0, s28
    s_add_u32 s29, s23, 100352
    buffer_load_dwordx4 v7, s[12:15], s29 offen nt lds
    s_add_u32 s28, s24, 0
    s_mov_b32 m0, s28
    s_add_u32 s29, s23, 0
    buffer_load_dwordx4 v4, s[16:19], s29 offen nt lds
    s_add_u32 s28, s24, 1024
    s_mov_b32 m0, s28
    s_add_u32 s29, s23, 14336
    buffer_load_dwordx4 v5, s[16:19], s29 offen nt lds
    s_add_u32 s28, s24, 2048
    s_mov_b32 m0, s28
    s_add_u32 s29, s23, 28672
    buffer_load_dwordx4 v4, s[16:19], s29 offen nt lds
    s_add_u32 s28, s24, 3072
    s_mov_b32 m0, s28
    s_add_u32 s29, s23, 43008
    buffer_load_dwordx4 v5, s[16:19], s29 offen nt lds
    s_add_u32 s28, s24, 4096
    s_mov_b32 m0, s28
    s_add_u32 s29, s23, 57344
    buffer_load_dwordx4 v6, s[16:19], s29 offen nt lds
    s_add_u32 s28, s24, 5120
    s_mov_b32 m0, s28
    s_add_u32 s29, s23, 71680
    buffer_load_dwordx4 v7, s[16:19], s29 offen nt lds
    s_add_u32 s28, s24, 6144
    s_mov_b32 m0, s28
    s_add_u32 s29, s23, 86016
    buffer_load_dwordx4 v6, s[16:19], s29 offen nt lds
    s_add_u32 s28, s24, 7168
    s_mov_b32 m0, s28
    s_add_u32 s29, s23, 100352
    buffer_load_dwordx4 v7, s[16:19], s29 offen nt lds
    v_lshrrev_b32 v2, 4, v1
    v_and_b32 v3, 15, v1
    v_bfe_u32 v9, v1, 2, 2
    v_lshl_add_u32 v8, v2, 3, v9
    v_lshlrev_b32 v8, 9, v8
    v_and_b32 v10, 1, v2
    v_lshl_add_u32 v10, v10, 2, v9
    s_lshl_b32 s28, s3, 1
    v_xor_b32 v10, s28, v10
    v_lshl_add_u32 v8, v10, 5, v8
    v_and_b32 v10, 3, v1
    v_lshl_add_u32 v8, v10, 3, v8
    v_xor_b32 v12, 32, v8
    v_add_u32 v13, 81920, v8
    v_add_u32 v20, 81920, v12
    s_lshl_b32 s28, s21, 7
    v_lshl_add_u32 v9, v1, 1, s28
    v_and_b32 v24, 31, v9
    v_lshrrev_b32 v25, 5, v9
    v_cmp_gt_u32 vcc, 16, v25
    v_cmp_lt_u32 s[24:25], 16, v24
    v_cmp_eq_u32 s[26:27], 0, v24
    s_nop 1
    s_and_b64 s[26:27], s[26:27], vcc
    s_or_b64 s[24:25], s[24:25], s[26:27]
    v_cmp_eq_u32 s[26:27], 16, v24
    s_nop 1
    s_andn2_b64 s[26:27], s[26:27], vcc
    s_or_b64 s[24:25], s[24:25], s[26:27]
    v_sub_u32 v26, 1024, v9
    v_cndmask_b32_e64 v26, v9, v26, s[24:25]
    v_mov_b32 v27, 512
    v_cmp_eq_u32 vcc, 1024, v26
    s_nop 1
    v_cndmask_b32_e64 v26, v26, v27, vcc
    v_lshrrev_b32 v27, 5, v26
    v_and_b32 v26, 15, v26
    v_lshrrev_b32 v16, 2, v27
    v_lshlrev_b32 v16, 8, v16
    v_and_b32 v27, 3, v27
    v_lshl_add_u32 v16, v27, 4, v16
    v_lshrrev_b32 v27, 3, v26
    v_lshl_add_u32 v16, v27, 6, v16
    v_and_b32 v26, 7, v26
    v_lshl_add_u32 v16, v26, 1, v16
    v_cndmask_b32_e64 v26, 0, 1, s[24:25]
    v_lshl_add_u32 v16, v26, 7, v16
    v_add_u32 v9, 1, v9
    v_and_b32 v24, 31, v9
    v_lshrrev_b32 v25, 5, v9
    v_cmp_gt_u32 vcc, 16, v25
    v_cmp_lt_u32 s[24:25], 16, v24
    v_cmp_eq_u32 s[26:27], 0, v24
    s_nop 1
    s_and_b64 s[26:27], s[26:27], vcc
    s_or_b64 s[24:25], s[24:25], s[26:27]
    v_cmp_eq_u32 s[26:27], 16, v24
    s_nop 1
    s_andn2_b64 s[26:27], s[26:27], vcc
    s_or_b64 s[24:25], s[24:25], s[26:27]
    v_sub_u32 v26, 1024, v9
    v_cndmask_b32_e64 v26, v9, v26, s[24:25]
    v_mov_b32 v27, 512
    v_cmp_eq_u32 vcc, 1024, v26
    s_nop 1
    v_cndmask_b32_e64 v26, v26, v27, vcc
    v_lshrrev_b32 v27, 5, v26
    v_and_b32 v26, 15, v26
    v_lshrrev_b32 v17, 2, v27
    v_lshlrev_b32 v17, 8, v17
    v_and_b32 v27, 3, v27
    v_lshl_add_u32 v17, v27, 4, v17
    v_lshrrev_b32 v27, 3, v26
    v_lshl_add_u32 v17, v27, 6, v17
    v_and_b32 v26, 7, v26
    v_lshl_add_u32 v17, v26, 1, v17
    v_cndmask_b32_e64 v26, 0, 1, s[24:25]
    v_lshl_add_u32 v17, v26, 7, v17
    s_lshl_b32 s28, s21, 8
    s_add_u32 s28, s28, 147456
    v_lshl_add_u32 v18, v1, 2, s28
    s_lshl_b32 s28, s21, 8
    s_add_u32 s28, s28, 147456
    v_lshlrev_b32 v19, 4, v2
    v_add_u32 v19, s28, v19
    v_mov_b32 v28, 149504
    v_lshlrev_b32 v29, 4, v1
    s_lshl_b32 s30, s22, 3
    s_add_u32 s30, s30, s3
    s_lshl_b32 s30, s30, 3
    s_add_u32 s30, s30, s21
    s_lshl_b32 s30, s30, 8
    s_add_u32 s30, s30, 0x488000
    v_lshlrev_b32 v30, 4, v2
    v_lshl_add_u32 v30, v3, 6, v30
    v_cmp_eq_u32 s[60:61], 1, v3
    v_cmp_eq_u32 s[62:63], 2, v3
    v_cmp_eq_u32 s[64:65], 3, v3
    v_add_u32 v21, 149568, v29
    v_mov_b32 v197, 0xffffff00
    s_and_b32 s35, s2, 0x47
    s_lshl_b32 s31, s3, 3
    s_add_u32 s35, s35, s31
    s_add_u32 s35, s35, 58
    s_and_b32 s35, s35, 127
    s_getreg_b32 s33, hwreg(HW_REG_XCC_ID)
    s_and_b32 s33, s33, 15
    s_lshr_b32 s31, s35, 5
    s_lshl_b32 s31, s31, 2
    s_add_u32 s31, s31, 149520
    v_mov_b32 v22, s31
    s_lshl_b32 s20, s22, 3
    s_add_u32 s20, s20, s21
    s_and_b32 s34, s20, 15
    s_bfe_u32 s28, s20, 0x10004
    s_lshl_b32 s28, s28, 5
    s_add_u32 s34, s34, s28
    s_mul_i32 s34, s34, 2176
    s_add_u32 s34, s34, 0x580000
    s_waitcnt vmcnt(0)
    s_barrier
    ds_read_b64_tr_b16 v[32:33], v13 offset:0
    ds_read_b64_tr_b16 v[34:35], v13 offset:2048
    ds_read_b64_tr_b16 v[36:37], v13 offset:16384
    ds_read_b64_tr_b16 v[38:39], v13 offset:18432
    ds_read_b64_tr_b16 v[40:41], v13 offset:32768
    ds_read_b64_tr_b16 v[42:43], v13 offset:34816
    ds_read_b64_tr_b16 v[44:45], v13 offset:49152
    ds_read_b64_tr_b16 v[46:47], v13 offset:51200
    s_waitcnt lgkmcnt(0)
    ds_read_b64_tr_b16 v[48:49], v20 offset:0
    ds_read_b64_tr_b16 v[50:51], v20 offset:2048
    ds_read_b64_tr_b16 v[52:53], v20 offset:16384
    ds_read_b64_tr_b16 v[54:55], v20 offset:18432
    ds_read_b64_tr_b16 v[56:57], v20 offset:32768
    ds_read_b64_tr_b16 v[58:59], v20 offset:34816
    ds_read_b64_tr_b16 v[60:61], v20 offset:49152
    ds_read_b64_tr_b16 v[62:63], v20 offset:51200
    s_waitcnt lgkmcnt(0)
    ds_read_b64_tr_b16 v[64:65], v8 offset:0
    ds_read_b64_tr_b16 v[66:67], v8 offset:2048
    ds_read_b64_tr_b16 v[68:69], v8 offset:16384
    ds_read_b64_tr_b16 v[70:71], v8 offset:18432
    ds_read_b64_tr_b16 v[72:73], v8 offset:32768
    ds_read_b64_tr_b16 v[74:75], v8 offset:34816
    ds_read_b64_tr_b16 v[76:77], v8 offset:49152
    ds_read_b64_tr_b16 v[78:79], v8 offset:51200
    s_waitcnt lgkmcnt(0)
    ds_read_b64_tr_b16 v[80:81], v12 offset:0
    ds_read_b64_tr_b16 v[82:83], v12 offset:2048
    ds_read_b64_tr_b16 v[84:85], v12 offset:16384
    ds_read_b64_tr_b16 v[86:87], v12 offset:18432
    ds_read_b64_tr_b16 v[88:89], v12 offset:32768
    ds_read_b64_tr_b16 v[90:91], v12 offset:34816
    ds_read_b64_tr_b16 v[92:93], v12 offset:49152
    ds_read_b64_tr_b16 v[94:95], v12 offset:51200
    s_waitcnt lgkmcnt(0)
    s_cmp_lg_u32 s3, 0
    s_cbranch_scc1 ffn_w3
    v_lshlrev_b32 v23, 4, v1
    v_add_u32 v24, 1024, v23
    s_lshl_b32 s28, s20, 4
    s_add_u32 s28, s28, s34
    v_mov_b32 v10, 34828
    s_nop 4
ffn_p3:
    buffer_load_dword v11, v10, s[4:7], s28 offen sc1
    s_waitcnt vmcnt(0) lgkmcnt(0)
    v_cmp_ne_u32 vcc, s40, v11
    s_cbranch_vccnz ffn_p3_rt
ffn_p3_ok:
    s_mov_b32 s58, 0
    s_mov_b32 s54, -1
    s_nop 1
ffn_k3:
    buffer_load_dwordx4 v[200:203], v23, s[4:7], s34 offen sc1
    buffer_load_dwordx4 v[204:207], v24, s[4:7], s34 offen sc1
    s_waitcnt vmcnt(0)
    v_xor_b32 v208, s40, v203
    v_xor_b32 v209, s40, v207
    v_max_u32 v210, v200, v204
    v_or_b32 v208, v208, v209
    v_cmp_ne_u32 vcc, 0, v208
    s_cbranch_vccnz ffn_k3_rt
ffn_k3_ok:
    v_max_u32_dpp v210, v210, v210 quad_perm:[1,0,3,2] row_mask:0xf bank_mask:0xf
    s_nop 1
    v_max_u32_dpp v210, v210, v210 quad_perm:[2,3,0,1] row_mask:0xf bank_mask:0xf
    s_nop 1
    v_max_u32_dpp v210, v210, v210 row_half_mirror row_mask:0xf bank_mask:0xf
    s_nop 1
    v_max_u32_dpp v210, v210, v210 row_mirror row_mask:0xf bank_mask:0xf
    s_nop 1
    v_max_u32_dpp v210, v210, v210 row_bcast:15 row_mask:0xa bank_mask:0xf
    s_nop 1
    v_max_u32_dpp v210, v210, v210 row_bcast:31 row_mask:0xc bank_mask:0xf
    s_nop 0
    v_readlane_b32 s36, v210, 63
    s_nop 1
    v_cmp_eq_u32 vcc, s36, v200
    v_cmp_eq_u32 s[28:29], s36, v204
    s_nop 0
    s_cmp_lg_u64 vcc, 0
    s_cselect_b32 s39, 0, 64
    s_or_b64 vcc, vcc, s[28:29]
    s_ff1_i32_b64 s41, vcc
    s_add_u32 s39, s39, s41
    s_lshl_b32 s39, s39, 11
    s_add_u32 s39, s39, 0x448000
    s_mov_b32 s58, 0
ffn_c3:
    buffer_load_short_d16_hi v14, v16, s[4:7], s39 offen sc1
    buffer_load_short_d16_hi v15, v17, s[4:7], s39 offen sc1
ffn_c3d:
    v_and_b32 v10, 15, v201
    v_and_b32 v11, 15, v205
    v_cmp_eq_u32 s[24:25], s33, v10
    v_cmp_eq_u32 s[26:27], s33, v11
    s_nop 0
    v_mov_b32 v212, s24
    v_mov_b32 v213, s25
    v_mov_b32 v214, s26
    v_mov_b32 v215, s27
    v_cndmask_b32_e64 v209, v201, v205, s[28:29]
    v_cndmask_b32_e64 v210, v202, v206, s[28:29]
    ds_write_b128 v28, v[212:215] offset:16
    v_readlane_b32 s24, v209, s41
    v_readlane_b32 s25, v210, s41
    s_mov_b64 s[42:43], vcc
    s_and_b32 s24, s24, 0xffff0000
    s_mov_b32 s26, 0xffff0000
    s_waitcnt vmcnt(0)
    v_max_u32 v10, v14, v15
    v_add_f32 v14, s24, v14
    v_add_f32 v15, s24, v15
    v_cvt_pk_bf16_f32 v14, 0, v14
    v_cvt_pk_bf16_f32 v15, 0, v15
    v_mul_f32 v14, s25, v14
    v_mul_f32 v15, s25, v15
    v_cvt_pk_bf16_f32 v14, v14, v15
    ds_write_b32 v18, v14
    v_cmp_eq_u32 vcc, s26, v10
    s_cbranch_vccnz ffn_c3_rt
ffn_c3_ok:
    s_waitcnt lgkmcnt(0)
    s_nop 2
ffn_w3:
    s_barrier
    ds_read_b32 v203, v22
    ds_read_b128 v[128:131], v19 offset:0
    ds_read_b128 v[132:135], v19 offset:64
    ds_read_b128 v[136:139], v19 offset:128
    ds_read_b128 v[140:143], v19 offset:192
    s_waitcnt lgkmcnt(3)
    v_mfma_f32_16x16x32_bf16 v[192:195], v[32:35], v[128:131], 0
    v_mfma_f32_16x16x32_bf16 v[148:151], v[48:51], v[128:131], 0
    v_mfma_f32_16x16x32_bf16 v[152:155], v[64:67], v[128:131], 0
    v_mfma_f32_16x16x32_bf16 v[156:159], v[80:83], v[128:131], 0
    s_waitcnt lgkmcnt(2)
    v_mfma_f32_16x16x32_bf16 v[192:195], v[36:39], v[132:135], v[192:195]
    v_mfma_f32_16x16x32_bf16 v[148:151], v[52:55], v[132:135], v[148:151]
    v_mfma_f32_16x16x32_bf16 v[152:155], v[68:71], v[132:135], v[152:155]
    v_mfma_f32_16x16x32_bf16 v[156:159], v[84:87], v[132:135], v[156:159]
    s_waitcnt lgkmcnt(1)
    v_mfma_f32_16x16x32_bf16 v[192:195], v[40:43], v[136:139], v[192:195]
    v_mfma_f32_16x16x32_bf16 v[148:151], v[56:59], v[136:139], v[148:151]
    v_mfma_f32_16x16x32_bf16 v[152:155], v[72:75], v[136:139], v[152:155]
    v_mfma_f32_16x16x32_bf16 v[156:159], v[88:91], v[136:139], v[156:159]
    s_waitcnt lgkmcnt(0)
    v_mfma_f32_16x16x32_bf16 v[192:195], v[44:47], v[140:143], v[192:195]
    v_mfma_f32_16x16x32_bf16 v[148:151], v[60:63], v[140:143], v[148:151]
    v_mfma_f32_16x16x32_bf16 v[152:155], v[76:79], v[140:143], v[152:155]
    v_mfma_f32_16x16x32_bf16 v[156:159], v[92:95], v[140:143], v[156:159]
    v_readfirstlane_b32 s24, v203
    s_nop 4
    v_cndmask_b32_e64 v192, v192, v148, s[60:61]
    v_cndmask_b32_e64 v193, v193, v149, s[60:61]
    v_cndmask_b32_e64 v194, v194, v150, s[60:61]
    v_cndmask_b32_e64 v195, v195, v151, s[60:61]
    v_cndmask_b32_e64 v192, v192, v152, s[62:63]
    v_cndmask_b32_e64 v193, v193, v153, s[62:63]
    v_cndmask_b32_e64 v194, v194, v154, s[62:63]
    v_cndmask_b32_e64 v195, v195, v155, s[62:63]
    v_cndmask_b32_e64 v192, v192, v156, s[64:65]
    v_cndmask_b32_e64 v193, v193, v157, s[64:65]
    v_cndmask_b32_e64 v194, v194, v158, s[64:65]
    v_cndmask_b32_e64 v195, v195, v159, s[64:65]
    s_mov_b32 exec_lo, 0x000f000f
    s_mov_b32 exec_hi, 0x000f000f
    v_and_or_b32 v192, v192, v197, s48
    v_and_or_b32 v193, v193, v197, s49
    v_and_or_b32 v194, v194, v197, s50
    v_and_or_b32 v195, v195, v197, s51
    s_bitcmp1_b32 s24, s35
    s_cbranch_scc0 ffn_rem
    buffer_store_dwordx4 v[192:195], v30, s[4:7], s30 offen
ffn_fin:
    s_endpgm
ffn_rem:
    buffer_store_dwordx4 v[192:195], v30, s[4:7], s30 offen sc1
    s_branch ffn_fin
ffn_c3_rt:
    s_mov_b64 vcc, s[42:43]
    s_add_u32 s58, s58, 1
    s_cmp_lt_u32 s58, 0x10000
    s_cbranch_scc1 ffn_c3
    s_branch ffn_c3_ok
fz_h1_r0:
    s_add_u32 s58, s58, 1
    s_cmp_gt_u32 s58, 0x10000
    s_cbranch_scc1 fz_h1_o0
    buffer_load_dwordx4 v[104:107], v222, s[4:7], s60 offen sc1
    buffer_load_dwordx4 v[108:111], v222, s[4:7], s61 offen sc1
    buffer_load_dwordx4 v[112:115], v222, s[4:7], s16 offen sc1
    buffer_load_dwordx4 v[116:119], v222, s[4:7], s17 offen sc1
    s_branch fz_h1_c0
fz_h1_r1:
    s_add_u32 s58, s58, 1
    s_cmp_gt_u32 s58, 0x10000
    s_cbranch_scc1 fz_h1_o1
    buffer_load_dwordx4 v[108:111], v222, s[4:7], s61 offen sc1
    buffer_load_dwordx4 v[112:115], v222, s[4:7], s16 offen sc1
    buffer_load_dwordx4 v[116:119], v222, s[4:7], s17 offen sc1
    s_branch fz_h1_c1
fz_h1_r2:
    s_add_u32 s58, s58, 1
    s_cmp_gt_u32 s58, 0x10000
    s_cbranch_scc1 fz_h1_o2
    buffer_load_dwordx4 v[112:115], v222, s[4:7], s16 offen sc1
    buffer_load_dwordx4 v[116:119], v222, s[4:7], s17 offen sc1
    s_branch fz_h1_c2
fz_h1_r3:
    s_add_u32 s58, s58, 1
    s_cmp_gt_u32 s58, 0x10000
    s_cbranch_scc1 fz_h1_o3
    buffer_load_dwordx4 v[116:119], v222, s[4:7], s17 offen sc1
    s_branch fz_h1_c3
fz_h2_r0:
    s_add_u32 s58, s58, 1
    s_cmp_gt_u32 s58, 0x10000
    s_cbranch_scc1 fz_h2_o0
    buffer_load_dwordx2 v[104:105], v228, s[4:7], s52 offen sc1
    buffer_load_dwordx2 v[106:107], v228, s[4:7], s53 offen sc1
    buffer_load_dwordx2 v[108:109], v228, s[4:7], s54 offen sc1
    buffer_load_dwordx2 v[110:111], v228, s[4:7], s55 offen sc1
    s_branch fz_h2_c0
fz_h2_r1:
    s_add_u32 s58, s58, 1
    s_cmp_gt_u32 s58, 0x10000
    s_cbranch_scc1 fz_h2_o1
    buffer_load_dwordx2 v[106:107], v228, s[4:7], s53 offen sc1
    buffer_load_dwordx2 v[108:109], v228, s[4:7], s54 offen sc1
    buffer_load_dwordx2 v[110:111], v228, s[4:7], s55 offen sc1
    s_branch fz_h2_c1
fz_h2_r2:
    s_add_u32 s58, s58, 1
    s_cmp_gt_u32 s58, 0x10000
    s_cbranch_scc1 fz_h2_o2
    buffer_load_dwordx2 v[108:109], v228, s[4:7], s54 offen sc1
    buffer_load_dwordx2 v[110:111], v228, s[4:7], s55 offen sc1
    s_branch fz_h2_c2
fz_h2_r3:
    s_add_u32 s58, s58, 1
    s_cmp_gt_u32 s58, 0x10000
    s_cbranch_scc1 fz_h2_o3
    buffer_load_dwordx2 v[110:111], v228, s[4:7], s55 offen sc1
    s_branch fz_h2_c3
fz_h5_r0:
    s_add_u32 s58, s58, 1
    s_cmp_gt_u32 s58, 0x10000
    s_cbranch_scc1 fz_h5_o0
    buffer_load_dwordx4 v[40:43], v3, s[4:7], s52 offen sc1
    buffer_load_dwordx4 v[44:47], v3, s[4:7], s53 offen sc1
    buffer_load_dwordx4 v[48:51], v3, s[4:7], s54 offen sc1
    buffer_load_dwordx4 v[52:55], v6, s[4:7], s55 offen sc1
    s_branch fz_h5_c0
fz_h5_r1:
    s_add_u32 s58, s58, 1
    s_cmp_gt_u32 s58, 0x10000
    s_cbranch_scc1 fz_h5_o1
    buffer_load_dwordx4 v[44:47], v3, s[4:7], s53 offen sc1
    buffer_load_dwordx4 v[48:51], v3, s[4:7], s54 offen sc1
    buffer_load_dwordx4 v[52:55], v6, s[4:7], s55 offen sc1
    s_branch fz_h5_c1
fz_h5_r2:
    s_add_u32 s58, s58, 1
    s_cmp_gt_u32 s58, 0x10000
    s_cbranch_scc1 fz_h5_o2
    buffer_load_dwordx4 v[48:51], v3, s[4:7], s54 offen sc1
    buffer_load_dwordx4 v[52:55], v6, s[4:7], s55 offen sc1
    s_branch fz_h5_c2
fz_h5_r3:
    s_add_u32 s58, s58, 1
    s_cmp_gt_u32 s58, 0x10000
    s_cbranch_scc1 fz_h5_o3
    buffer_load_dwordx4 v[52:55], v6, s[4:7], s55 offen sc1
    s_branch fz_h5_c3
fz_p1_rt:
    s_add_u32 s58, s58, 1
    s_cmp_lt_u32 s58, 0x10000
    s_cbranch_scc1 fz_p1
    s_branch fz_p1_ok
fz_k2_rt:
    s_add_u32 s58, s58, 1
    s_cmp_lt_u32 s58, 0x10000
    s_cbranch_scc1 fz_k2
    s_branch fz_k2_ok
fz_c2_rt:
    s_add_u32 s58, s58, 1
    s_cmp_lt_u32 s58, 0x10000
    s_cbranch_scc1 fz_c2
    s_branch fz_c2_ok
fz_p5_rt:
    s_add_u32 s58, s58, 1
    s_cmp_lt_u32 s58, 0x10000
    s_cbranch_scc1 fz_p5
    s_branch fz_p5_ok
fz_h4_rt:
    s_add_u32 s58, s58, 1
    s_cmp_lt_u32 s58, 0x10000
    s_cbranch_scc1 fz_h4
    s_branch fz_h4_ok
ffn_p3_rt:
    s_add_u32 s58, s58, 1
    s_cmp_lt_u32 s58, 0x10000
    s_cbranch_scc1 ffn_p3
    s_branch ffn_p3_ok
ffn_k3_rt:
    s_add_u32 s58, s58, 1
    s_cmp_lt_u32 s58, 0x10000
    s_cbranch_scc1 ffn_k3
    s_branch ffn_k3_ok
fz_codeend:
.section .rodata,"a"
.p2align 6
.amdhsa_kernel fz_kernel
  .amdhsa_next_free_vgpr 256
  .amdhsa_next_free_sgpr 102
  .amdhsa_accum_offset 256
  .amdhsa_group_segment_fixed_size 0
  .amdhsa_kernarg_size 104
  .amdhsa_user_sgpr_count 2
  .amdhsa_user_sgpr_kernarg_segment_ptr 1
  .amdhsa_system_sgpr_workgroup_id_x 1
.end_amdhsa_kernel
```

```asm
; @launch kernel=fz_kernel grid=(256,1,1) block=(512,1,1) lds=163840
.amdgcn_target "amdgcn-amd-amdhsa--gfx950"
.text
.globl fz_kernel
.p2align 8
.type fz_kernel,@function
fz_kernel:
    s_load_dwordx2 s[4:5], s[0:1], 96
    s_load_dwordx2 s[8:9], s[0:1], 0
    s_load_dwordx2 s[64:65], s[0:1], 72
    s_cmp_gt_u32 s2, 255
    s_cbranch_scc1 fz_end
    v_lshrrev_b32 v2, 6, v0
    v_and_b32 v1, 63, v0
    s_lshr_b32 s59, s2, 7
    v_readfirstlane_b32 s3, v2
    s_and_b32 s20, s2, 127
    s_cmp_lt_u32 s20, 8
    s_cselect_b32 s20, s3, 0
    s_cmp_lt_u32 s20, 4
    s_cbranch_scc1 fz_pfcback
    s_getpc_b64 s[20:21]
fz_pcb:
    s_sub_u32 s20, s20, fz_pcb-fz_kernel
    s_subb_u32 s21, s21, 0
    v_and_b32 v3, 255, v0
    v_lshlrev_b32 v3, 7, v3
    v_min_u32 v3, fz_codeend-fz_kernel-4, v3
    v_mov_b32 v5, s21
    v_add_co_u32 v4, vcc, s20, v3
    s_nop 1
    v_addc_co_u32 v5, vcc, 0, v5, vcc
    global_load_dword v251, v[4:5], off
fz_pfcback:
    s_cmp_lg_u32 s59, 0
    s_cbranch_scc1 fz_ldh
    s_load_dwordx2 s[12:13], s[0:1], 80
    s_load_dwordx2 s[16:17], s[0:1], 48
fz_ldback:
    s_add_u32 s20, s2, 58
    s_and_b32 s20, s20, 127
    s_lshr_b32 s21, s20, 3
    s_add_u32 s21, s21, 1
    s_and_b32 s22, s20, 7
    s_sub_u32 s23, s20, 124
    s_cmp_ge_u32 s20, 124
    s_cselect_b32 s21, 0, s21
    s_cselect_b32 s22, s23, s22
    s_lshr_b32 s57, s3, 2
    s_or_b32 s23, s57, s59
    s_and_b32 s24, s3, 3
    s_lshl_b32 s25, s22, 6
    s_add_u32 s25, s25, s21
    s_lshl_b32 s26, s23, 5
    s_add_u32 s26, s26, s25
    s_lshl_b32 s27, s24, 9
    s_add_u32 s28, s26, s27
    s_sub_u32 s27, 2048, s27
    s_sub_u32 s27, s27, s26
    s_lshl_b32 s29, s24, 1
    s_add_u32 s29, s29, s23
    s_sub_u32 s30, 15, s29
    s_cmp_lt_u32 s24, 2
    s_cselect_b32 s27, s28, s27
    s_cselect_b32 s31, s29, s30
    s_cselect_b32 s30, s30, s29
    s_sub_u32 s28, 2048, s27
    s_and_b32 s28, s28, 2047
    s_lshl_b32 s27, s27, 11
    s_lshl_b32 s28, s28, 11
    s_mul_i32 s31, s31, 2064
    s_mul_i32 s30, s30, 2064
    v_lshlrev_b32 v239, 4, v1
    s_mov_b32 s10, 0x400000
    s_mov_b32 s11, 0x00020000
    s_mov_b32 s6, 0x690000
    s_mov_b32 s7, 0x00020000
    s_mov_b32 s66, 0x700000
    s_mov_b32 s67, 0x00020000
    s_and_b32 s32, s57, s59
    s_add_u32 s36, s2, 4
    s_and_b32 s36, s36, 7
    s_bfe_u32 s37, s2, 0x10006
    s_lshl_b32 s63, s36, 1
    s_add_u32 s63, s63, s37
    s_cmp_lg_u32 s37, 0
    s_cselect_b32 s37, 8, s36
    s_add_u32 s37, s37, 6
    s_cmp_lt_u32 s36, 6
    s_cselect_b32 s63, s63, s37
    s_lshl_b32 s63, s63, 3
    s_bfe_u32 s37, s2, 0x30003
    s_add_u32 s63, s63, s37
    v_and_b32 v10, 15, v1
    v_lshlrev_b32 v10, 4, v10
    v_lshrrev_b32 v14, 4, v1
    v_lshl_add_u32 v14, v14, 11, v10
    s_lshl_b32 s62, s63, 16
    s_and_b32 s37, s3, 3
    s_lshl_b32 s37, s37, 9
    s_add_u32 s62, s62, s37
    s_mov_b32 s58, 0
    s_waitcnt lgkmcnt(0)
    s_cmp_eq_u32 s2, 66
    s_cbranch_scc1 fz_spec
fz_specback:
    s_cmp_lg_u32 s57, 0
    s_cbranch_scc1 fz_nox
    s_mov_b32 m0, s31
    s_nop 0
    buffer_load_dwordx4 v239, s[8:11], s27 offen nt lds
    buffer_load_dwordx4 v239, s[8:11], s27 offen offset:1024 nt lds
    s_mov_b32 m0, s30
    s_nop 0
    buffer_load_dwordx4 v239, s[8:11], s28 offen nt lds
    buffer_load_dwordx4 v239, s[8:11], s28 offen offset:1024 nt lds
fz_nox:
    buffer_load_dword v250, off, s[4:7], 0
    s_andn2_b32 s32, s57, s59
    s_cbranch_scc0 fz_nowe
    buffer_load_dwordx4 v[160:163], v14, s[64:67], s62 offen offset:0 nt
    buffer_load_dwordx4 v[164:167], v14, s[64:67], s62 offen offset:256 nt
    s_add_u32 s62, s62, 8192
    buffer_load_dwordx4 v[168:171], v14, s[64:67], s62 offen offset:0 nt
    buffer_load_dwordx4 v[172:175], v14, s[64:67], s62 offen offset:256 nt
    s_add_u32 s62, s62, 8192
fz_nowe:
    s_cmp_eq_u32 s57, 0
    s_cbranch_scc1 fz_np
    s_setprio 1
fz_np:
    v_and_b32 v2, 31, v1
    v_lshrrev_b32 v3, 5, v1
    v_and_b32 v4, 15, v1
    v_lshrrev_b32 v5, 4, v1
    v_add_u32 v6, 49536, v239
    v_lshrrev_b32 v10, 1, v2
    v_and_b32 v8, 9, v10
    v_and_b32 v11, 2, v10
    v_lshl_or_b32 v8, v11, 1, v8
    v_bfe_u32 v11, v10, 2, 1
    v_lshl_or_b32 v8, v11, 1, v8
    v_and_b32 v12, 1, v5
    v_cmp_eq_u32 vcc, 1, v12
    v_lshl_add_u32 v9, v4, 1, 1
    s_nop 0
    v_cndmask_b32_e64 v9, v9, 0, vcc
    s_cmp_lt_u32 s3, 5
    s_cselect_b64 s[32:33], -1, 0
    s_cmp_lt_u32 s3, 3
    s_cselect_b64 s[34:35], -1, 0
    v_cndmask_b32_e64 v9, v9, v2, s[32:33]
    v_cndmask_b32_e64 v8, v9, v8, s[34:35]
    s_mov_b32 s36, 0x3d000000
    s_cmp_gt_u32 s3, 4
    s_cselect_b32 s36, 0x3c800000, s36
    s_sub_u32 s37, s3, 1
    s_cmp_lt_u32 s37, 2
    s_cselect_b32 s36, 0x3a800000, s36
    s_cmp_eq_u32 s3, 0
    s_cselect_b32 s32, 16, 0
    s_cselect_b32 s33, 0x3e800000, 0
    s_cselect_b32 s34, 4.0, 0x41000000
    s_cselect_b32 s35, 0x41000000, 4.0
    v_cmp_eq_u32 vcc, 1, v2
    v_mov_b32 v10, s32
    s_nop 0
    v_cndmask_b32_e64 v10, 0, v10, vcc
    v_add_u32 v8, v8, v10
    v_cvt_f32_u32 v8, v8
    v_mul_f32 v8, s36, v8
    s_cmp_eq_u32 s3, 2
    s_cselect_b32 s32, 0x80000000, 0
    v_lshlrev_b32 v10, 31, v2
    v_and_b32 v10, s32, v10
    v_xor_b32 v8, v10, v8
    v_and_b32 v10, 1, v2
    v_cvt_f32_u32 v10, v10
    v_mul_f32 v10, s33, v10
    s_cmp_eq_u32 s3, 1
    s_cselect_b32 s33, 0x3e800000, 0
    v_mov_b32 v11, s33
    v_cndmask_b32_e64 v10, v10, v11, vcc
    s_cmp_eq_u32 s3, 5
    s_cselect_b32 s33, 0x3e800000, 0
    v_cvt_f32_u32 v12, v12
    v_fma_f32 v10, v12, s33, v10
    s_cmp_eq_u32 s3, 6
    s_cselect_b32 s33, 0x3e800000, 0
    s_cmp_eq_u32 s3, 2
    s_cselect_b32 s33, 0xbe800000, s33
    s_cmp_eq_u32 s3, 4
    s_cselect_b32 s33, 0xbe800000, s33
    v_add_f32 v10, s33, v10
    v_cvt_f32_u32 v11, v3
    v_mul_f32 v11, s35, v11
    v_fma_f32 v9, v8, v11, v10
    v_mul_f32 v10, s34, v8
    v_mul_f32 v11, 0x41800000, v8
    v_mov_b32 v104, v9
    v_fmamk_f32 v105, v8, 0x3f800000, v9
    v_fmamk_f32 v106, v8, 0x40000000, v9
    v_fmamk_f32 v107, v8, 0x40400000, v9
    v_add_f32 v108, v104, v10
    v_add_f32 v109, v105, v10
    v_add_f32 v110, v106, v10
    v_add_f32 v111, v107, v10
    v_add_f32 v112, v104, v11
    v_add_f32 v113, v105, v11
    v_add_f32 v114, v106, v11
    v_add_f32 v115, v107, v11
    v_add_f32 v116, v108, v11
    v_add_f32 v117, v109, v11
    v_add_f32 v118, v110, v11
    v_add_f32 v119, v111, v11
    v_cos_f32 v104, v104
    v_cos_f32 v105, v105
    v_cos_f32 v106, v106
    v_cos_f32 v107, v107
    v_cos_f32 v108, v108
    v_cos_f32 v109, v109
    v_cos_f32 v110, v110
    v_cos_f32 v111, v111
    v_cos_f32 v112, v112
    v_cos_f32 v113, v113
    v_cos_f32 v114, v114
    v_cos_f32 v115, v115
    v_cos_f32 v116, v116
    v_cos_f32 v117, v117
    v_cos_f32 v118, v118
    v_cos_f32 v119, v119
    s_lshl_b32 s32, s3, 11
    v_add_u32 v8, s32, v6
    s_cmp_eq_u32 s3, 0
    s_cbranch_scc1 fz_jb
    v_cvt_pk_f16_f32 v128, v104, v105
    v_cvt_pk_f16_f32 v129, v106, v107
    v_cvt_pk_f16_f32 v130, v108, v109
    v_cvt_pk_f16_f32 v131, v110, v111
    v_cvt_pk_f16_f32 v132, v112, v113
    v_cvt_pk_f16_f32 v133, v114, v115
    v_cvt_pk_f16_f32 v134, v116, v117
    v_cvt_pk_f16_f32 v135, v118, v119
fz_jend:
    ds_write_b128 v8, v[128:131] offset:0
    ds_write_b128 v8, v[132:135] offset:1024
    v_mov_b32 v15, 49520
    v_mov_b32 v10, 0
    v_mov_b32 v11, 0
    ds_write_b64 v15, v[10:11]
    ds_write_b32 v15, v10 offset:8
    s_waitcnt lgkmcnt(0)
    s_barrier
    v_lshlrev_b32 v240, 31, v1
    v_lshrrev_b32 v10, 16, v240
    v_or_b32 v240, v240, v10
    v_mov_b32 v229, 0xfffcfffc
    v_mov_b32 v242, 0xffff0000
    s_mov_b32 s42, 0x3f803f80
    s_cmp_lg_u32 s57, 0
    s_cbranch_scc1 fz_nc1
    ds_read_b128 v[16:19], v6 offset:0
    ds_read_b128 v[20:23], v6 offset:1024
    ds_read_b128 v[24:27], v6 offset:2048
    ds_read_b128 v[28:31], v6 offset:3072
    ds_read_b128 v[32:35], v6 offset:4096
    ds_read_b128 v[36:39], v6 offset:5120
    ds_read_b128 v[40:43], v6 offset:6144
    ds_read_b128 v[44:47], v6 offset:7168
    ds_read_b128 v[48:51], v6 offset:8192
    ds_read_b128 v[52:55], v6 offset:9216
    ds_read_b128 v[56:59], v6 offset:10240
    ds_read_b128 v[60:63], v6 offset:11264
    ds_read_b128 v[64:67], v6 offset:12288
    ds_read_b128 v[68:71], v6 offset:13312
    v_lshlrev_b32 v7, 9, v3
    v_bfe_u32 v10, v1, 2, 2
    v_lshl_add_u32 v7, v10, 6, v7
    v_and_b32 v10, 1, v5
    v_lshl_add_u32 v7, v10, 5, v7
    v_and_b32 v10, 3, v1
    v_lshl_add_u32 v7, v10, 3, v7
    v_add_u32 v7, s31, v7
    v_lshlrev_b32 v8, 9, v3
    v_lshl_add_u32 v8, v2, 1, v8
    v_sub_u32 v9, 2048, v8
    v_and_b32 v9, 2047, v9
    v_add_u32 v9, s30, v9
    s_add_u32 s32, s30, 576
    v_sub_u32 v8, s32, v8
    v_cmp_eq_u32 vcc, 0, v2
    s_nop 1
    v_cndmask_b32_e64 v234, 0, -2.0, vcc
    v_mov_b32 v235, 0x3b27c5ac
    s_lshr_b32 s32, s24, 1
    s_lshl_b32 s32, s32, 6
    s_mul_i32 s33, s3, 2304
    s_add_u32 s32, s32, s33
    s_add_u32 s32, s32, 67968
    v_lshl_add_u32 v10, v3, 1, v1
    v_lshlrev_b32 v10, 4, v10
    v_add_u32 v216, s32, v10
    v_bfe_u32 v10, v0, 2, 1
    v_mul_u32_u24 v10, 34, v10
    v_lshrrev_b32 v11, 4, v0
    v_add_u32 v10, v10, v11
    v_lshlrev_b32 v10, 4, v10
    v_bfe_u32 v11, v0, 3, 1
    v_lshl_add_u32 v10, v11, 3, v10
    v_bfe_u32 v11, v0, 1, 1
    v_lshl_add_u32 v10, v11, 2, v10
    v_and_b32 v12, 1, v0
    s_mov_b32 s33, 9216
    s_cmp_eq_u32 s2, 66
    s_cselect_b32 s32, s33, 0x1b40
    v_mul_lo_u32 v11, v12, s32
    v_add_u32 v217, v10, v11
    v_add_u32 v217, 67968, v217
    s_cselect_b32 s32, s33, 0x940
    v_mul_lo_u32 v11, v12, s32
    v_add_u32 v218, v10, v11
    v_add_u32 v218, 70272, v218
    s_cselect_b32 s32, s33, 0xfffff6c0
    v_mul_lo_u32 v11, v12, s32
    v_add_u32 v219, v10, v11
    v_add_u32 v219, 73792, v219
    s_cselect_b32 s32, s33, 0xffffe4c0
    v_mul_lo_u32 v11, v12, s32
    v_add_u32 v220, v10, v11
    v_add_u32 v220, 76096, v220
    v_lshrrev_b32 v10, 2, v0
    v_and_b32 v11, 3, v0
    v_lshlrev_b32 v11, 4, v11
    v_lshl_add_u32 v221, v10, 7, v11
    s_mul_i32 s52, s20, 16512
    s_lshl_b32 s33, s59, 6
    s_add_u32 s52, s52, s33
    s_add_u32 s52, s52, 0x1000
    s_add_u32 s53, s52, 8192
    v_mov_b32 v160, 0
    v_mov_b32 v161, 0
    v_mov_b32 v162, 0
    v_mov_b32 v163, 0
    s_setprio 3
    s_waitcnt vmcnt(0) lgkmcnt(0)
    ds_read_b64_tr_b16 v[88:89], v7 offset:0
    ds_read_b64_tr_b16 v[90:91], v7 offset:256
    ds_read_b64_tr_b16 v[92:93], v7 offset:1024
    ds_read_b64_tr_b16 v[94:95], v7 offset:1280
    ds_read_u16_d16 v96, v9
    ds_read_u16_d16_hi v136, v8 offset:1408
    ds_read_u16_d16 v97, v8 offset:1344
    ds_read_u16_d16_hi v137, v8 offset:1280
    ds_read_u16_d16 v98, v8 offset:1216
    ds_read_u16_d16_hi v138, v8 offset:1152
    ds_read_u16_d16 v99, v8 offset:1088
    ds_read_u16_d16_hi v139, v8 offset:1024
    s_waitcnt lgkmcnt(8)
    v_mfma_f32_32x32x16_bf16 v[104:119], v[88:91], v[16:19], 0
    v_mfma_f32_32x32x16_bf16 v[104:119], v[92:95], v[20:23], v[104:119]
    ds_read_u16_d16 v100, v8 offset:448
    ds_read_u16_d16_hi v140, v8 offset:384
    ds_read_u16_d16 v101, v8 offset:320
    ds_read_u16_d16_hi v141, v8 offset:256
    ds_read_u16_d16 v102, v8 offset:192
    ds_read_u16_d16_hi v142, v8 offset:128
    ds_read_u16_d16 v103, v8 offset:64
    ds_read_u16_d16_hi v143, v8 offset:0
    v_dot2_f32_bf16 v160, v88, s42, v160
    v_dot2_f32_bf16 v161, v88, v88, v161
    v_dot2_f32_bf16 v160, v89, s42, v160
    v_dot2_f32_bf16 v161, v89, v89, v161
    v_dot2_f32_bf16 v160, v90, s42, v160
    v_dot2_f32_bf16 v161, v90, v90, v161
    v_dot2_f32_bf16 v160, v91, s42, v160
    v_dot2_f32_bf16 v161, v91, v91, v161
    v_dot2_f32_bf16 v160, v92, s42, v160
    v_dot2_f32_bf16 v161, v92, v92, v161
    v_dot2_f32_bf16 v160, v93, s42, v160
    v_dot2_f32_bf16 v161, v93, v93, v161
    v_dot2_f32_bf16 v160, v94, s42, v160
    v_dot2_f32_bf16 v161, v94, v94, v161
    v_dot2_f32_bf16 v160, v95, s42, v160
    v_dot2_f32_bf16 v161, v95, v95, v161
    s_waitcnt lgkmcnt(0)
    v_or_b32 v96, v96, v136
    v_or_b32 v97, v97, v137
    v_or_b32 v98, v98, v138
    v_or_b32 v99, v99, v139
    v_or_b32 v100, v100, v140
    v_or_b32 v101, v101, v141
    v_or_b32 v102, v102, v142
    v_or_b32 v103, v103, v143
    v_mfma_f32_32x32x16_bf16 v[120:135], v[96:99], v[16:19], 0
    s_nop 0
    v_mfma_f32_32x32x16_bf16 v[120:135], v[100:103], v[20:23], v[120:135]
    v_dot2_f32_bf16 v162, v96, s42, v162
    v_dot2_f32_bf16 v163, v96, v96, v163
    v_dot2_f32_bf16 v162, v97, s42, v162
    v_dot2_f32_bf16 v163, v97, v97, v163
    v_dot2_f32_bf16 v162, v98, s42, v162
    v_dot2_f32_bf16 v163, v98, v98, v163
    v_dot2_f32_bf16 v162, v99, s42, v162
    v_dot2_f32_bf16 v163, v99, v99, v163
    v_dot2_f32_bf16 v162, v100, s42, v162
    v_dot2_f32_bf16 v163, v100, v100, v163
    v_dot2_f32_bf16 v162, v101, s42, v162
    v_dot2_f32_bf16 v163, v101, v101, v163
    v_dot2_f32_bf16 v162, v102, s42, v162
    v_dot2_f32_bf16 v163, v102, v102, v163
    v_dot2_f32_bf16 v162, v103, s42, v162
    v_dot2_f32_bf16 v163, v103, v103, v163
    s_nop 1
    v_permlane32_swap_b32 v160, v162
    v_permlane32_swap_b32 v161, v163
    v_add_f32 v160, v160, v162
    v_add_f32 v161, v161, v163
    s_nop 1
    v_permlane16_swap_b32 v160, v161
    v_add_f32 v160, v160, v161
    s_nop 1
    v_add_f32_dpp v160, v160, v160 quad_perm:[1,0,3,2] row_mask:0xf bank_mask:0xf
    s_nop 1
    v_add_f32_dpp v160, v160, v160 quad_perm:[2,3,0,1] row_mask:0xf bank_mask:0xf
    s_nop 1
    v_add_f32_dpp v160, v160, v160 row_half_mirror row_mask:0xf bank_mask:0xf
    s_nop 1
    v_add_f32_dpp v160, v160, v160 row_mirror row_mask:0xf bank_mask:0xf
    s_mov_b32 s43, 0x3e800000
    v_mov_b32 v161, v160
    s_nop 1
    v_permlane16_swap_b32 v160, v161
    v_mul_f32 v160, 0x3c800000, v160
    v_fma_f32 v161, v161, s43, v235
    v_fma_f32 v161, -v160, v160, v161
    v_rsq_f32 v161, v161
    s_nop 0
    v_mul_f32 v160, v160, v161
    v_readlane_b32 s32, v161, 0
    v_readlane_b32 s34, v161, 32
    v_readlane_b32 s36, v160, 0
    v_readlane_b32 s37, v160, 32
    s_nop 0
    v_mul_f32 v164, s36, v234
    v_fmac_f32 v164, s37, v234
    v_pk_fma_f32 v[104:105], v[104:105], s[32:33], v[164:165] op_sel_hi:[1,0,0]
    v_pk_fma_f32 v[106:107], v[106:107], s[32:33], v[164:165] op_sel_hi:[1,0,0]
    v_pk_fma_f32 v[108:109], v[108:109], s[32:33], v[164:165] op_sel_hi:[1,0,0]
    v_pk_fma_f32 v[110:111], v[110:111], s[32:33], v[164:165] op_sel_hi:[1,0,0]
    v_pk_fma_f32 v[112:113], v[112:113], s[32:33], v[164:165] op_sel_hi:[1,0,0]
    v_pk_fma_f32 v[114:115], v[114:115], s[32:33], v[164:165] op_sel_hi:[1,0,0]
    v_pk_fma_f32 v[116:117], v[116:117], s[32:33], v[164:165] op_sel_hi:[1,0,0]
    v_pk_fma_f32 v[118:119], v[118:119], s[32:33], v[164:165] op_sel_hi:[1,0,0]
    v_pk_fma_f32 v[104:105], v[120:121], s[34:35], v[104:105] op_sel_hi:[1,0,1]
    v_pk_fma_f32 v[106:107], v[122:123], s[34:35], v[106:107] op_sel_hi:[1,0,1]
    v_pk_fma_f32 v[108:109], v[124:125], s[34:35], v[108:109] op_sel_hi:[1,0,1]
    v_pk_fma_f32 v[110:111], v[126:127], s[34:35], v[110:111] op_sel_hi:[1,0,1]
    v_pk_fma_f32 v[112:113], v[128:129], s[34:35], v[112:113] op_sel_hi:[1,0,1]
    v_pk_fma_f32 v[114:115], v[130:131], s[34:35], v[114:115] op_sel_hi:[1,0,1]
    v_pk_fma_f32 v[116:117], v[132:133], s[34:35], v[116:117] op_sel_hi:[1,0,1]
    v_pk_fma_f32 v[118:119], v[134:135], s[34:35], v[118:119] op_sel_hi:[1,0,1]
    v_cvt_pk_f16_f32 v136, v104, v105
    v_cvt_pk_f16_f32 v137, v106, v107
    v_cvt_pk_f16_f32 v138, v108, v109
    v_cvt_pk_f16_f32 v139, v110, v111
    v_cvt_pk_f16_f32 v140, v112, v113
    v_cvt_pk_f16_f32 v141, v114, v115
    v_cvt_pk_f16_f32 v142, v116, v117
    v_cvt_pk_f16_f32 v143, v118, v119
    v_mov_b32_dpp v152, v136 quad_perm:[1,0,3,2] row_mask:0xf bank_mask:0xf
    v_mov_b32_dpp v153, v137 quad_perm:[1,0,3,2] row_mask:0xf bank_mask:0xf
    v_mov_b32_dpp v154, v138 quad_perm:[1,0,3,2] row_mask:0xf bank_mask:0xf
    v_mov_b32_dpp v155, v139 quad_perm:[1,0,3,2] row_mask:0xf bank_mask:0xf
    v_mov_b32_dpp v156, v140 quad_perm:[1,0,3,2] row_mask:0xf bank_mask:0xf
    v_mov_b32_dpp v157, v141 quad_perm:[1,0,3,2] row_mask:0xf bank_mask:0xf
    v_mov_b32_dpp v158, v142 quad_perm:[1,0,3,2] row_mask:0xf bank_mask:0xf
    v_mov_b32_dpp v159, v143 quad_perm:[1,0,3,2] row_mask:0xf bank_mask:0xf
    v_pk_mul_f16 v144, v136, v24
    v_pk_mul_f16 v145, v137, v25
    v_pk_mul_f16 v146, v138, v26
    v_pk_mul_f16 v147, v139, v27
    v_pk_mul_f16 v148, v140, v28
    v_pk_mul_f16 v149, v141, v29
    v_pk_mul_f16 v150, v142, v30
    v_pk_mul_f16 v151, v143, v31
    v_mfma_f32_16x16x32_f16 v[120:123], v[136:139], v[56:59], 0
    v_pk_fma_f16 v144, v152, v32, v144
    v_pk_fma_f16 v145, v153, v33, v145
    v_pk_fma_f16 v146, v154, v34, v146
    v_pk_fma_f16 v147, v155, v35, v147
    v_mfma_f32_16x16x32_f16 v[120:123], v[140:143], v[60:63], v[120:123]
    v_pk_fma_f16 v148, v156, v36, v148
    v_pk_fma_f16 v149, v157, v37, v149
    v_pk_fma_f16 v150, v158, v38, v150
    v_pk_fma_f16 v151, v159, v39, v151
    v_mfma_f32_32x32x16_f16 v[104:119], v[144:147], v[40:43], 0
    v_xor_b32_dpp v152, v144, v240 quad_perm:[1,0,3,2] row_mask:0xf bank_mask:0xf
    v_xor_b32_dpp v153, v145, v240 quad_perm:[1,0,3,2] row_mask:0xf bank_mask:0xf
    v_xor_b32_dpp v154, v146, v240 quad_perm:[1,0,3,2] row_mask:0xf bank_mask:0xf
    v_xor_b32_dpp v155, v147, v240 quad_perm:[1,0,3,2] row_mask:0xf bank_mask:0xf
    v_mfma_f32_32x32x16_f16 v[104:119], v[148:151], v[44:47], v[104:119]
    v_xor_b32_dpp v156, v148, v240 quad_perm:[1,0,3,2] row_mask:0xf bank_mask:0xf
    v_xor_b32_dpp v157, v149, v240 quad_perm:[1,0,3,2] row_mask:0xf bank_mask:0xf
    v_xor_b32_dpp v158, v150, v240 quad_perm:[1,0,3,2] row_mask:0xf bank_mask:0xf
    v_xor_b32_dpp v159, v151, v240 quad_perm:[1,0,3,2] row_mask:0xf bank_mask:0xf
    v_mfma_f32_32x32x16_f16 v[104:119], v[152:155], v[48:51], v[104:119]
    s_nop 0
    v_mfma_f32_32x32x16_f16 v[104:119], v[156:159], v[52:55], v[104:119]
    v_mfma_f32_16x16x32_f16 v[124:127], v[136:139], v[64:67], 0
    v_mfma_f32_16x16x32_f16 v[124:127], v[140:143], v[68:71], v[124:127]
    v_readfirstlane_b32 s40, v250
    s_nop 1
    s_add_u32 s40, s40, 1
    s_and_b32 s38, s40, 3
    s_and_b32 s39, s40, 15
    s_bfe_u32 s41, s40, 0x20002
    s_lshl_b32 s41, s41, 16
    s_or_b32 s44, s38, s41
    s_bfe_u32 s41, s40, 0x40004
    s_lshl_b32 s41, s41, 4
    s_or_b32 s48, s39, s41
    s_bfe_u32 s41, s40, 0x20004
    s_lshl_b32 s41, s41, 16
    s_or_b32 s45, s38, s41
    s_bfe_u32 s41, s40, 0x40008
    s_lshl_b32 s41, s41, 4
    s_or_b32 s49, s39, s41
    s_bfe_u32 s41, s40, 0x20006
    s_lshl_b32 s41, s41, 16
    s_or_b32 s46, s38, s41
    s_bfe_u32 s41, s40, 0x4000c
    s_lshl_b32 s41, s41, 4
    s_or_b32 s50, s39, s41
    s_bfe_u32 s41, s40, 0x20008
    s_lshl_b32 s41, s41, 16
    s_or_b32 s47, s38, s41
    s_bfe_u32 s41, s40, 0x40010
    s_lshl_b32 s41, s41, 4
    s_or_b32 s51, s39, s41
    s_mov_b32 s38, 0x404
    s_cmp_eq_u32 s2, 66
    s_cselect_b32 s39, 8, 4
    s_cselect_b32 s38, 8, s38
    s_mov_b64 vcc, 0xffff
    v_cvt_pk_f16_f32 v143, v118, v119
    v_cvt_pk_f16_f32 v142, v116, v117
    v_cvt_pk_f16_f32 v141, v114, v115
    v_cvt_pk_f16_f32 v140, v112, v113
    v_cvt_pk_f16_f32 v139, v110, v111
    v_cvt_pk_f16_f32 v138, v108, v109
    v_cvt_pk_f16_f32 v137, v106, v107
    v_cndmask_b32_e64 v104, v104, v121, vcc
    v_cndmask_b32_e64 v105, v105, v125, vcc
    v_pk_add_f16 v147, v142, v143 op_sel:[0,1] op_sel_hi:[1,0] neg_lo:[0,1]
    v_pk_add_f16 v151, v142, v143 op_sel:[0,1] op_sel_hi:[1,0] neg_hi:[1,0]
    v_pk_add_f16 v146, v140, v141 op_sel:[0,1] op_sel_hi:[1,0] neg_lo:[0,1]
    v_pk_add_f16 v150, v140, v141 op_sel:[0,1] op_sel_hi:[1,0] neg_hi:[1,0]
    v_pk_add_f16 v145, v138, v139 op_sel:[0,1] op_sel_hi:[1,0] neg_lo:[0,1]
    v_pk_add_f16 v149, v138, v139 op_sel:[0,1] op_sel_hi:[1,0] neg_hi:[1,0]
    v_cvt_pk_f16_f32 v136, v104, v105
    v_pk_add_f16 v144, v136, v137 op_sel:[0,1] op_sel_hi:[1,0] neg_lo:[0,1]
    v_pk_add_f16 v148, v136, v137 op_sel:[0,1] op_sel_hi:[1,0] neg_hi:[1,0]
    ds_write_b128 v216, v[144:147]
    ds_write_b128 v216, v[148:151] offset:1152
    s_waitcnt lgkmcnt(0)
    v_mov_b32 v10, 1
    s_mov_b64 exec, 1
    ds_add_u32 v15, v10
    s_mov_b64 exec, -1
    s_cmp_gt_u32 s3, 3
    s_cbranch_scc1 fz_bsp0
fz_sy:
    ds_read_b32 v10, v15
    s_waitcnt lgkmcnt(0)
    v_and_b32 v10, 0xff, v10
    v_cmp_ne_u32 vcc, s39, v10
    s_cbranch_vccnz fz_sy
    ds_read_b32 v104, v217 offset:0
    ds_read_b32 v105, v218 offset:0
    ds_read_b32 v106, v219 offset:0
    ds_read_b32 v107, v220 offset:0
    ds_read_b32 v108, v217 offset:256
    ds_read_b32 v109, v218 offset:256
    ds_read_b32 v110, v219 offset:256
    ds_read_b32 v111, v220 offset:256
    s_waitcnt lgkmcnt(4)
    v_pk_add_f16 v112, v104, v106
    v_pk_add_f16 v114, v105, v107
    v_pk_add_f16 v113, v104, v106 neg_lo:[0,1] neg_hi:[0,1]
    v_pk_add_f16 v115, v105, v107 neg_lo:[0,1] neg_hi:[0,1]
    v_pk_add_f16 v116, v112, v114
    v_pk_add_f16 v118, v112, v114 neg_lo:[0,1] neg_hi:[0,1]
    v_pk_add_f16 v117, v113, v115 op_sel:[0,1] op_sel_hi:[1,0] neg_hi:[0,1]
    v_pk_add_f16 v119, v113, v115 op_sel:[0,1] op_sel_hi:[1,0] neg_lo:[0,1]
    v_add_u32 v116, 0x20002, v116
    v_add_u32 v117, 0x20002, v117
    v_add_u32 v118, 0x20002, v118
    v_add_u32 v119, 0x20002, v119
    v_and_or_b32 v116, v116, v229, s44
    v_and_or_b32 v117, v117, v229, s45
    v_and_or_b32 v118, v118, v229, s46
    v_and_or_b32 v119, v119, v229, s47
    buffer_store_dwordx4 v[116:119], v221, s[4:7], s52 offen sc1
    s_waitcnt lgkmcnt(0)
    v_pk_add_f16 v120, v108, v110
    v_pk_add_f16 v122, v109, v111
    v_pk_add_f16 v121, v108, v110 neg_lo:[0,1] neg_hi:[0,1]
    v_pk_add_f16 v123, v109, v111 neg_lo:[0,1] neg_hi:[0,1]
    v_pk_add_f16 v124, v120, v122
    v_pk_add_f16 v126, v120, v122 neg_lo:[0,1] neg_hi:[0,1]
    v_pk_add_f16 v125, v121, v123 op_sel:[0,1] op_sel_hi:[1,0] neg_hi:[0,1]
    v_pk_add_f16 v127, v121, v123 op_sel:[0,1] op_sel_hi:[1,0] neg_lo:[0,1]
    v_add_u32 v124, 0x20002, v124
    v_add_u32 v125, 0x20002, v125
    v_add_u32 v126, 0x20002, v126
    v_add_u32 v127, 0x20002, v127
    v_and_or_b32 v124, v124, v229, s44
    v_and_or_b32 v125, v125, v229, s45
    v_and_or_b32 v126, v126, v229, s46
    v_and_or_b32 v127, v127, v229, s47
    buffer_store_dwordx4 v[124:127], v221, s[4:7], s53 offen sc1
    s_cmp_lg_u32 s59, 0
    s_cbranch_scc1 ffn
    s_and_b32 s32, s3, 3
    s_lshr_b32 s33, s3, 2
    s_lshl_b32 s33, s33, 4
    s_add_u32 s33, s33, s32
    v_and_b32 v8, 12, v4
    v_bfe_u32 v9, v4, 1, 1
    v_lshl_add_u32 v8, v9, 5, v8
    v_add_u32 v8, s33, v8
    v_cvt_f32_u32 v8, v8
    v_and_b32 v12, 1, v1
    v_cvt_f32_u32 v9, v12
    v_lshlrev_b32 v13, 2, v5
    v_cvt_f32_u32 v10, v13
    v_mul_f32 v11, 0x3c800000, v8
    v_mul_f32 v9, 0x3e800000, v9
    v_fma_f32 v9, v11, v10, v9
    v_mov_b32 v128, v9
    v_fmamk_f32 v129, v11, 0x3f800000, v9
    v_fmamk_f32 v130, v11, 0x40000000, v9
    v_fmamk_f32 v131, v11, 0x40400000, v9
    v_mul_f32 v11, 0x3a000000, v8
    v_lshlrev_b32 v9, 31, v1
    v_xor_b32 v11, v9, v11
    v_mul_f32 v9, v11, v10
    v_mov_b32 v112, v9
    v_fmamk_f32 v113, v11, 0x3f800000, v9
    v_fmamk_f32 v114, v11, 0x40000000, v9
    v_fmamk_f32 v115, v11, 0x40400000, v9
    v_fmamk_f32 v116, v11, 0x41800000, v9
    v_fmamk_f32 v117, v11, 0x41880000, v9
    v_fmamk_f32 v118, v11, 0x41900000, v9
    v_fmamk_f32 v119, v11, 0x41980000, v9
    v_cos_f32 v104, v128
    v_sin_f32 v105, v128
    v_cos_f32 v106, v129
    v_sin_f32 v107, v129
    v_cos_f32 v108, v130
    v_sin_f32 v109, v130
    v_cos_f32 v110, v131
    v_sin_f32 v111, v131
    v_sin_f32 v120, v112
    v_sin_f32 v121, v113
    v_sin_f32 v122, v114
    v_sin_f32 v123, v115
    v_sin_f32 v124, v116
    v_sin_f32 v125, v117
    v_sin_f32 v126, v118
    v_sin_f32 v127, v119
    v_cos_f32 v112, v112
    v_cos_f32 v113, v113
    v_cos_f32 v114, v114
    v_cos_f32 v115, v115
    v_cos_f32 v116, v116
    v_cos_f32 v117, v117
    v_cos_f32 v118, v118
    v_cos_f32 v119, v119
    v_cvt_pk_f16_f32 v16, v104, v105
    v_cvt_pk_f16_f32 v17, v106, v107
    v_cvt_pk_f16_f32 v18, v108, v109
    v_cvt_pk_f16_f32 v19, v110, v111
    v_cvt_pk_f16_f32 v20, v112, v113
    v_cvt_pk_f16_f32 v21, v114, v115
    v_cvt_pk_f16_f32 v22, v116, v117
    v_cvt_pk_f16_f32 v23, v118, v119
    v_cvt_pk_f16_f32 v24, v120, v121
    v_cvt_pk_f16_f32 v25, v122, v123
    v_cvt_pk_f16_f32 v26, v124, v125
    v_cvt_pk_f16_f32 v27, v126, v127
    v_lshrrev_b32 v8, 3, v1
    v_mul_u32_u24 v222, 16512, v8
    v_and_b32 v9, 7, v1
    v_lshl_add_u32 v222, v9, 4, v222
    s_mul_i32 s60, s3, 528384
    s_lshl_b32 s32, s20, 7
    s_add_u32 s60, s60, s32
    s_add_u32 s60, s60, 0x1000
    s_add_u32 s61, s60, 132096
    s_add_u32 s16, s60, 264192
    s_add_u32 s17, s60, 396288
    v_lshlrev_b32 v8, 1, v8
    v_bfe_u32 v9, v1, 2, 1
    v_add_u32 v8, v8, v9
    s_lshl_b32 s32, s3, 2
    s_add_u32 s32, s32, 1
    v_lshl_add_u32 v8, v8, 5, s32
    v_cmp_eq_u32 vcc, 1, v12
    v_bfe_u32 v9, v1, 1, 1
    v_mul_u32_u24 v9, 8256, v9
    v_add_u32 v9, 86400, v9
    s_cmp_eq_u32 s3, 3
    s_cselect_b32 s32, 272, 0
    v_sub_u32 v10, 512, v8
    v_cndmask_b32_e64 v10, v8, v10, vcc
    v_and_b32 v11, 16, v10
    v_lshl_add_u32 v11, v11, 6, v9
    v_lshrrev_b32 v12, 7, v10
    v_lshl_add_u32 v11, v12, 8, v11
    v_and_b32 v12, 15, v10
    v_lshl_add_u32 v11, v12, 4, v11
    v_bfe_u32 v12, v10, 5, 2
    v_lshl_add_u32 v223, v12, 2, v11
    v_add_u32 v8, 1, v8
    v_sub_u32 v10, 512, v8
    v_cndmask_b32_e64 v10, v8, v10, vcc
    v_and_b32 v11, 16, v10
    v_lshl_add_u32 v11, v11, 6, v9
    v_lshrrev_b32 v12, 7, v10
    v_lshl_add_u32 v11, v12, 8, v11
    v_and_b32 v12, 15, v10
    v_lshl_add_u32 v11, v12, 4, v11
    v_bfe_u32 v12, v10, 5, 2
    v_lshl_add_u32 v224, v12, 2, v11
    v_add_u32 v8, 1, v8
    v_sub_u32 v10, 512, v8
    v_cndmask_b32_e64 v10, v8, v10, vcc
    v_and_b32 v11, 16, v10
    v_lshl_add_u32 v11, v11, 6, v9
    v_lshrrev_b32 v12, 7, v10
    v_lshl_add_u32 v11, v12, 8, v11
    v_and_b32 v12, 15, v10
    v_lshl_add_u32 v11, v12, 4, v11
    v_bfe_u32 v12, v10, 5, 2
    v_lshl_add_u32 v100, v12, 2, v11
    v_mul_u32_u24 v10, s32, v3
    v_sub_u32 v8, v8, v10
    v_add_u32 v8, 1, v8
    v_sub_u32 v10, 512, v8
    v_cndmask_b32_e64 v10, v8, v10, vcc
    v_lshrrev_b32 v11, 1, v10
    v_and_b32 v11, 256, v11
    v_sub_u32 v10, v10, v11
    v_and_b32 v11, 16, v10
    v_lshl_add_u32 v11, v11, 6, v9
    v_lshrrev_b32 v12, 7, v10
    v_lshl_add_u32 v11, v12, 8, v11
    v_and_b32 v12, 15, v10
    v_lshl_add_u32 v11, v12, 4, v11
    v_bfe_u32 v12, v10, 5, 2
    v_lshl_add_u32 v101, v12, 2, v11
    s_and_b32 s32, s3, 3
    s_lshl_b32 s32, s32, 11
    s_add_u32 s32, s32, 86400
    v_add_u32 v225, s32, v239
    v_add_u32 v8, s33, v13
    v_sub_u32 v9, 32, v8
    v_min_u32 v9, v8, v9
    v_and_b32 v10, 15, v8
    v_cmp_eq_u32 s[32:33], 0, v10
    v_cmp_lt_u32 s[34:35], 16, v8
    v_lshlrev_b32 v10, 10, v9
    v_subrev_u32 v10, 1024, v10
    v_mov_b32 v11, 15872
    v_cmp_eq_u32 vcc, 0, v8
    s_nop 1
    v_cndmask_b32_e64 v10, v10, v11, vcc
    v_and_b32 v11, 3, v1
    v_lshl_add_u32 v10, v11, 4, v10
    v_lshrrev_b32 v11, 2, v4
    v_lshlrev_b32 v12, 7, v11
    v_sub_u32 v13, 960, v12
    v_cndmask_b32_e64 v13, v12, v13, s[34:35]
    v_add_u32 v226, v10, v13
    s_or_b64 s[34:35], s[34:35], s[32:33]
    v_add_u32 v12, 512, v12
    v_sub_u32 v13, 960, v12
    v_cndmask_b32_e64 v13, v12, v13, s[34:35]
    v_add_u32 v227, v10, v13
    s_mul_i32 s56, s20, 16512
    s_add_u32 s56, s56, 0x210000
    v_mov_b32 v249, 0x30003
    v_mov_b32 v252, s44
    v_mov_b32 v253, s45
    v_mov_b32 v254, s46
    v_mov_b32 v255, s47
    s_waitcnt lgkmcnt(0)
    s_waitcnt vmcnt(0)
    s_bitcmp1_b32 s2, 2
    s_cbranch_scc1 fz_p1_ok
    s_add_u32 s32, s60, 99072
    v_mov_b32 v9, 0
fz_p1:
    buffer_load_dword v10, v9, s[4:7], s32 offen sc1
    s_waitcnt vmcnt(0)
    v_xor_b32 v10, v252, v10
    v_and_b32 v10, v249, v10
    v_cmp_ne_u32 vcc, 0, v10
    s_cbranch_vccnz fz_p1_rt
fz_p1_ok:
    s_mov_b32 s58, 0
    buffer_load_dwordx4 v[104:107], v222, s[4:7], s60 offen sc1
    buffer_load_dwordx4 v[108:111], v222, s[4:7], s61 offen sc1
    buffer_load_dwordx4 v[112:115], v222, s[4:7], s16 offen sc1
    buffer_load_dwordx4 v[116:119], v222, s[4:7], s17 offen sc1
fz_h1_c0:
    s_waitcnt vmcnt(3)
    v_xor_b32 v104, v252, v104
    v_xor_b32 v105, v253, v105
    v_xor_b32 v106, v254, v106
    v_xor_b32 v107, v255, v107
    v_or3_b32 v10, v104, v105, v106
    v_bitop3_b32 v10, v10, v107, v249 bitop3:0xa8
    v_cmp_ne_u32 vcc, 0, v10
    s_cbranch_vccnz fz_h1_r0
fz_h1_o0:
    ds_write_b32 v223, v104 offset:0
    ds_write_b32 v223, v105 offset:2048
    ds_write_b32 v223, v106 offset:4096
    ds_write_b32 v223, v107 offset:6144
fz_h1_c1:
    s_waitcnt vmcnt(2)
    v_xor_b32 v108, v252, v108
    v_xor_b32 v109, v253, v109
    v_xor_b32 v110, v254, v110
    v_xor_b32 v111, v255, v111
    v_or3_b32 v10, v108, v109, v110
    v_bitop3_b32 v10, v10, v111, v249 bitop3:0xa8
    v_cmp_ne_u32 vcc, 0, v10
    s_cbranch_vccnz fz_h1_r1
fz_h1_o1:
    ds_write_b32 v224, v108 offset:0
    ds_write_b32 v224, v109 offset:2048
    ds_write_b32 v224, v110 offset:4096
    ds_write_b32 v224, v111 offset:6144
fz_h1_c2:
    s_waitcnt vmcnt(1)
    v_xor_b32 v112, v252, v112
    v_xor_b32 v113, v253, v113
    v_xor_b32 v114, v254, v114
    v_xor_b32 v115, v255, v115
    v_or3_b32 v10, v112, v113, v114
    v_bitop3_b32 v10, v10, v115, v249 bitop3:0xa8
    v_cmp_ne_u32 vcc, 0, v10
    s_cbranch_vccnz fz_h1_r2
fz_h1_o2:
    ds_write_b32 v100, v112 offset:0
    ds_write_b32 v100, v113 offset:2048
    ds_write_b32 v100, v114 offset:4096
    ds_write_b32 v100, v115 offset:6144
fz_h1_c3:
    s_waitcnt vmcnt(0)
    v_xor_b32 v116, v252, v116
    v_xor_b32 v117, v253, v117
    v_xor_b32 v118, v254, v118
    v_xor_b32 v119, v255, v119
    v_or3_b32 v10, v116, v117, v118
    v_bitop3_b32 v10, v10, v119, v249 bitop3:0xa8
    v_cmp_ne_u32 vcc, 0, v10
    s_cbranch_vccnz fz_h1_r3
fz_h1_o3:
    ds_write_b32 v101, v116 offset:0
    ds_write_b32 v101, v117 offset:2048
    ds_write_b32 v101, v118 offset:4096
    ds_write_b32 v101, v119 offset:6144
    s_waitcnt lgkmcnt(0)
    s_setprio 0
fz_hb:
    s_barrier
    ds_read_b128 v[104:107], v225 offset:0
    ds_read_b128 v[108:111], v225 offset:1024
    ds_read_b128 v[112:115], v225 offset:8256
    ds_read_b128 v[116:119], v225 offset:9280
    ds_read_b128 v[72:75], v6 offset:14336
    ds_read_b128 v[76:79], v6 offset:15360
    ds_read_b128 v[80:83], v6 offset:16384
    ds_read_b128 v[84:87], v6 offset:17408
    s_waitcnt lgkmcnt(7)
    v_mfma_f32_16x16x32_f16 v[120:123], v[104:107], v[16:19], 0
    s_waitcnt lgkmcnt(6)
    v_mfma_f32_16x16x32_f16 v[124:127], v[108:111], v[16:19], 0
    s_waitcnt lgkmcnt(5)
    v_mfma_f32_16x16x32_f16 v[128:131], v[112:115], v[16:19], 0
    s_waitcnt lgkmcnt(4)
    v_mfma_f32_16x16x32_f16 v[132:135], v[116:119], v[16:19], 0
    s_waitcnt lgkmcnt(0)
    s_nop 0
    v_cvt_pk_f16_f32 v136, v120, v121
    v_cvt_pk_f16_f32 v137, v122, v123
    v_cvt_pk_f16_f32 v138, v124, v125
    v_cvt_pk_f16_f32 v139, v126, v127
    v_cvt_pk_f16_f32 v140, v128, v129
    v_cvt_pk_f16_f32 v141, v130, v131
    v_cvt_pk_f16_f32 v142, v132, v133
    v_cvt_pk_f16_f32 v143, v134, v135
    v_pk_mul_f16 v144, v136, v20
    v_pk_mul_f16 v145, v137, v21
    v_pk_mul_f16 v146, v138, v22
    v_pk_mul_f16 v147, v139, v23
    v_mov_b32_dpp v152, v136 quad_perm:[1,0,3,2] row_mask:0xf bank_mask:0xf
    v_mov_b32_dpp v153, v137 quad_perm:[1,0,3,2] row_mask:0xf bank_mask:0xf
    v_mov_b32_dpp v154, v138 quad_perm:[1,0,3,2] row_mask:0xf bank_mask:0xf
    v_mov_b32_dpp v155, v139 quad_perm:[1,0,3,2] row_mask:0xf bank_mask:0xf
    v_pk_fma_f16 v144, v152, v24, v144
    v_pk_fma_f16 v145, v153, v25, v145
    v_pk_fma_f16 v146, v154, v26, v146
    v_pk_fma_f16 v147, v155, v27, v147
    s_nop 1
    v_mfma_f32_16x16x32_f16 v[104:107], v[144:147], v[72:75], 0
    v_mfma_f32_16x16x32_f16 v[108:111], v[144:147], v[80:83], 0
    v_xor_b32_dpp v152, v144, v240 quad_perm:[1,0,3,2] row_mask:0xf bank_mask:0xf
    v_xor_b32_dpp v153, v145, v240 quad_perm:[1,0,3,2] row_mask:0xf bank_mask:0xf
    v_xor_b32_dpp v154, v146, v240 quad_perm:[1,0,3,2] row_mask:0xf bank_mask:0xf
    v_xor_b32_dpp v155, v147, v240 quad_perm:[1,0,3,2] row_mask:0xf bank_mask:0xf
    s_nop 1
    v_mfma_f32_16x16x32_f16 v[104:107], v[152:155], v[76:79], v[104:107]
    v_mfma_f32_16x16x32_f16 v[108:111], v[152:155], v[84:87], v[108:111]
    v_pk_mul_f16 v148, v140, v20
    v_pk_mul_f16 v149, v141, v21
    v_pk_mul_f16 v150, v142, v22
    v_pk_mul_f16 v151, v143, v23
    v_mov_b32_dpp v156, v140 quad_perm:[1,0,3,2] row_mask:0xf bank_mask:0xf
    v_mov_b32_dpp v157, v141 quad_perm:[1,0,3,2] row_mask:0xf bank_mask:0xf
    v_mov_b32_dpp v158, v142 quad_perm:[1,0,3,2] row_mask:0xf bank_mask:0xf
    v_mov_b32_dpp v159, v143 quad_perm:[1,0,3,2] row_mask:0xf bank_mask:0xf
    v_pk_fma_f16 v148, v156, v24, v148
    v_pk_fma_f16 v149, v157, v25, v149
    v_pk_fma_f16 v150, v158, v26, v150
    v_pk_fma_f16 v151, v159, v27, v151
    s_nop 1
    v_mfma_f32_16x16x32_f16 v[112:115], v[148:151], v[72:75], 0
    v_mfma_f32_16x16x32_f16 v[116:119], v[148:151], v[80:83], 0
    v_xor_b32_dpp v156, v148, v240 quad_perm:[1,0,3,2] row_mask:0xf bank_mask:0xf
    v_xor_b32_dpp v157, v149, v240 quad_perm:[1,0,3,2] row_mask:0xf bank_mask:0xf
    v_xor_b32_dpp v158, v150, v240 quad_perm:[1,0,3,2] row_mask:0xf bank_mask:0xf
    v_xor_b32_dpp v159, v151, v240 quad_perm:[1,0,3,2] row_mask:0xf bank_mask:0xf
    s_nop 1
    v_mfma_f32_16x16x32_f16 v[112:115], v[156:159], v[76:79], v[112:115]
    v_mfma_f32_16x16x32_f16 v[116:119], v[156:159], v[84:87], v[116:119]
    v_cvt_pk_f16_f32 v120, v104, v105
    v_cvt_pk_f16_f32 v122, v106, v107
    s_nop 4
    v_cvt_pk_f16_f32 v121, v112, v113
    v_cvt_pk_f16_f32 v123, v114, v115
    v_add_u32 v120, 0x20002, v120
    v_add_u32 v121, 0x20002, v121
    v_add_u32 v122, 0x20002, v122
    v_add_u32 v123, 0x20002, v123
    v_and_or_b32 v120, v120, v229, s44
    v_and_or_b32 v121, v121, v229, s45
    v_and_or_b32 v122, v122, v229, s46
    v_and_or_b32 v123, v123, v229, s47
    buffer_store_dwordx4 v[120:123], v226, s[4:7], s56 offen sc1
    v_cvt_pk_f16_f32 v124, v108, v109
    v_cvt_pk_f16_f32 v126, v110, v111
    v_cvt_pk_f16_f32 v125, v116, v117
    v_cvt_pk_f16_f32 v127, v118, v119
    v_add_u32 v124, 0x20002, v124
    v_add_u32 v125, 0x20002, v125
    v_add_u32 v126, 0x20002, v126
    v_add_u32 v127, 0x20002, v127
    v_and_or_b32 v124, v124, v229, s44
    v_and_or_b32 v125, v125, v229, s45
    v_and_or_b32 v126, v126, v229, s46
    v_and_or_b32 v127, v127, v229, s47
    buffer_store_dwordx4 v[124:127], v227, s[4:7], s56 offen sc1
    s_cmp_lg_u32 s57, 0
    s_cbranch_scc1 fz_nc3
    v_sub_u32 v8, 15, v4
    v_min_u32 v8, v4, v8
    v_and_b32 v9, 1, v8
    v_lshlrev_b32 v9, 5, v9
    v_lshrrev_b32 v10, 1, v8
    v_lshl_add_u32 v9, v10, 9, v9
    v_add_u32 v9, s25, v9
    v_sub_u32 v10, 2048, v9
    v_cmp_lt_u32 s[34:35], 7, v4
    s_nop 1
    v_cndmask_b32_e64 v230, v9, v10, s[34:35]
    v_mov_b32 v9, v4
    v_mov_b32 v10, s20
    s_cmp_lg_u32 s21, 0
    s_cbranch_scc0 fz_spec3a
fz_spec3backa:
    v_lshlrev_b32 v10, 7, v10
    v_lshl_add_u32 v10, v9, 3, v10
    v_mul_u32_u24 v11, 66048, v5
    v_add_u32 v228, v10, v11
    v_and_b32 v9, 1, v9
    v_cmp_eq_u32 vcc, 1, v9
    v_mov_b32 v9, s44
    v_mov_b32 v10, s46
    v_cndmask_b32_e64 v236, v9, v10, vcc
    v_mov_b32 v9, s45
    v_mov_b32 v10, s47
    v_cndmask_b32_e64 v237, v9, v10, vcc
    s_lshl_b32 s32, s3, 2
    v_add_u32 v8, s32, v5
    v_lshlrev_b32 v9, 6, v8
    v_cmp_gt_u32 vcc, 16, v8
    s_nop 1
    v_cndmask_b32_e64 v10, 0, 32, vcc
    v_add_u32 v10, v9, v10
    v_sub_u32 v11, 2048, v10
    v_cmp_eq_u32 vcc, 16, v8
    s_nop 1
    v_cndmask_b32_e64 v11, v11, 0, vcc
    v_mov_b32 v12, 0xffff0000
    v_cndmask_b32_e64 v238, -1, v12, vcc
    v_sub_u32 v12, 2018, v9
    v_mul_u32_u24 v13, 2064, v4
    v_add_u32 v231, v13, v9
    v_add_u32 v232, v13, v12
    v_add_u32 v233, v13, v10
    v_add_u32 v241, v13, v11
    s_lshl_b32 s32, s3, 8
    s_add_u32 s32, s32, 102912
    v_lshlrev_b32 v9, 4, v4
    v_add_u32 v10, s32, v9
    v_add_u32 v11, 107008, v239
    v_cmp_gt_u32 vcc, 16, v1
    s_nop 1
    v_cndmask_b32_e64 v243, v11, v10, vcc
    v_lshrrev_b32 v12, 2, v4
    v_cmp_eq_u32 vcc, v12, v5
    s_nop 1
    v_cndmask_b32_e64 v244, v11, v10, vcc
    v_lshrrev_b32 v12, 5, v1
    v_lshl_add_u32 v10, v12, 10, v9
    v_add_u32 v245, 102912, v10
    v_and_b32 v9, 1, v1
    v_cmp_eq_u32 s[28:29], 1, v9
    v_and_b32 v9, 2, v1
    v_cmp_eq_u32 s[30:31], 2, v9
    s_lshl_b32 s37, s3, 2
    v_add_u32 v9, s37, v5
    v_mul_u32_u24 v246, 2176, v9
    s_lshl_b32 s26, s20, 4
    s_add_u32 s26, s26, 0x580000
    v_lshlrev_b32 v247, 4, v5
    s_lshl_b32 s27, s20, 11
    s_lshl_b32 s37, s3, 8
    s_add_u32 s27, s27, s37
    s_add_u32 s27, s27, 0x448000
    v_sub_u32 v248, 2047, v230
    s_mov_b32 s14, 0x400000
    s_mov_b32 s15, 0x00020000
    s_mul_i32 s52, s3, 264192
    s_add_u32 s52, s52, 0x210000
    s_add_u32 s53, s52, 16512
    s_add_u32 s54, s52, 33024
    s_add_u32 s55, s52, 49536
    s_mov_b32 s23, s63
    s_getreg_b32 s24, hwreg(HW_REG_XCC_ID)
    s_and_b32 s24, s24, 15
    v_lshlrev_b32 v10, 4, v0
    v_min_u32 v10, 4336, v10
    v_add_u32 v10, 108032, v10
    v_mov_b32 v104, 0
    v_mov_b32 v105, 0
    v_mov_b32 v106, 0
    v_mov_b32 v107, 0
    ds_write_b128 v10, v[104:107]
    s_mov_b32 s58, 0
    s_waitcnt vmcnt(0)
    buffer_load_dwordx2 v[104:105], v228, s[4:7], s52 offen sc1
    buffer_load_dwordx2 v[106:107], v228, s[4:7], s53 offen sc1
    buffer_load_dwordx2 v[108:109], v228, s[4:7], s54 offen sc1
    buffer_load_dwordx2 v[110:111], v228, s[4:7], s55 offen sc1
    ds_read_b128 v[116:119], v231
    ds_read_b128 v[120:123], v231 offset:16
    ds_read_u16_d16_hi v44, v241
    ds_read_u16_d16_hi v45, v232 offset:28
    ds_read_u16_d16_hi v46, v232 offset:26
    ds_read_u16_d16_hi v47, v232 offset:24
    ds_read_u16_d16_hi v48, v232 offset:22
    ds_read_u16_d16_hi v49, v232 offset:20
    ds_read_u16_d16_hi v50, v232 offset:18
    ds_read_u16_d16_hi v51, v232 offset:16
    ds_read_u16_d16_hi v52, v232 offset:14
    ds_read_u16_d16_hi v53, v232 offset:12
    ds_read_u16_d16_hi v54, v232 offset:10
    ds_read_u16_d16_hi v55, v232 offset:8
    ds_read_u16_d16_hi v56, v232 offset:6
    ds_read_u16_d16_hi v57, v232 offset:4
    ds_read_u16_d16_hi v58, v232 offset:2
    ds_read_u16_d16_hi v59, v232 offset:0
    ds_read_u16_d16_hi v28, v233
    v_mul_u32_u24 v13, 2064, v4
    v_subrev_u32 v13, 104960, v13
    v_sub_u32 v9, v231, v13
    v_sub_u32 v10, v233, v13
    v_sub_u32 v11, v241, v13
    v_sub_u32 v12, v232, v13
    s_mov_b32 s36, 0xffff0000
    s_waitcnt lgkmcnt(0)
    ds_read_b128 v[200:203], v9
    ds_read_b128 v[204:207], v9 offset:16
    ds_read_u16_d16 v208, v11
    ds_read_u16_d16_hi v124, v12 offset:28
    ds_read_u16_d16 v209, v12 offset:26
    ds_read_u16_d16_hi v125, v12 offset:24
    ds_read_u16_d16 v210, v12 offset:22
    ds_read_u16_d16_hi v126, v12 offset:20
    ds_read_u16_d16 v211, v12 offset:18
    ds_read_u16_d16_hi v127, v12 offset:16
    ds_read_u16_d16 v212, v12 offset:14
    ds_read_u16_d16_hi v128, v12 offset:12
    ds_read_u16_d16 v213, v12 offset:10
    ds_read_u16_d16_hi v129, v12 offset:8
    ds_read_u16_d16 v214, v12 offset:6
    ds_read_u16_d16_hi v130, v12 offset:4
    ds_read_u16_d16 v215, v12 offset:2
    ds_read_u16_d16_hi v131, v12 offset:0
    ds_read_u16_d16 v13, v10
    v_and_b32 v29, s36, v116
    v_lshlrev_b32 v30, 16, v117
    v_and_b32 v31, s36, v117
    v_lshlrev_b32 v32, 16, v118
    v_and_b32 v33, s36, v118
    v_lshlrev_b32 v34, 16, v119
    v_and_b32 v35, s36, v119
    v_lshlrev_b32 v36, 16, v120
    v_and_b32 v37, s36, v120
    v_lshlrev_b32 v38, 16, v121
    v_and_b32 v39, s36, v121
    v_lshlrev_b32 v40, 16, v122
    v_and_b32 v41, s36, v122
    v_lshlrev_b32 v42, 16, v123
    v_and_b32 v43, s36, v123
    v_cmp_eq_u32 vcc, 1, v4
    v_mov_b32 v9, s42
    s_nop 0
    v_cndmask_b32_e64 v9, 0, v9, vcc
    v_mov_b32 v116, s42
    v_mov_b32 v117, s42
    v_mov_b32 v118, s42
    v_mov_b32 v119, s42
    v_cmp_eq_u32 vcc, 0, v4
    s_waitcnt lgkmcnt(0)
    v_and_or_b32 v200, v200, s36, v13
    v_or_b32 v208, v208, v124
    v_or_b32 v209, v209, v125
    v_or_b32 v210, v210, v126
    v_or_b32 v211, v211, v127
    v_or_b32 v212, v212, v128
    v_or_b32 v213, v213, v129
    v_or_b32 v214, v214, v130
    v_or_b32 v215, v215, v131
    v_cndmask_b32_e64 v200, v9, v200, vcc
    v_cndmask_b32_e64 v201, v9, v201, vcc
    v_cndmask_b32_e64 v202, v9, v202, vcc
    v_cndmask_b32_e64 v203, v9, v203, vcc
    v_cndmask_b32_e64 v204, v9, v204, vcc
    v_cndmask_b32_e64 v205, v9, v205, vcc
    v_cndmask_b32_e64 v206, v9, v206, vcc
    v_cndmask_b32_e64 v207, v9, v207, vcc
    v_cndmask_b32_e64 v208, v9, v208, vcc
    v_cndmask_b32_e64 v209, v9, v209, vcc
    v_cndmask_b32_e64 v210, v9, v210, vcc
    v_cndmask_b32_e64 v211, v9, v211, vcc
    v_cndmask_b32_e64 v212, v9, v212, vcc
    v_cndmask_b32_e64 v213, v9, v213, vcc
    v_cndmask_b32_e64 v214, v9, v214, vcc
    v_cndmask_b32_e64 v215, v9, v215, vcc
    v_mfma_f32_16x16x32_bf16 v[120:123], v[200:203], v[116:119], 0
    v_mfma_f32_16x16x32_bf16 v[120:123], v[204:207], v[116:119], v[120:123]
    v_mfma_f32_16x16x32_bf16 v[120:123], v[208:211], v[116:119], v[120:123]
    v_mfma_f32_16x16x32_bf16 v[120:123], v[212:215], v[116:119], v[120:123]
    s_nop 7
    ds_write_b32 v243, v120 offset:12
    s_branch fz_h2c
fz_h2:
    buffer_load_dwordx2 v[104:105], v228, s[4:7], s52 offen sc1
    buffer_load_dwordx2 v[106:107], v228, s[4:7], s53 offen sc1
    buffer_load_dwordx2 v[108:109], v228, s[4:7], s54 offen sc1
    buffer_load_dwordx2 v[110:111], v228, s[4:7], s55 offen sc1
fz_h2c:
    s_mov_b32 s36, 0x43000000
fz_h2_c0:
    s_waitcnt vmcnt(3)
    v_xor_b32 v104, v236, v104
    v_xor_b32 v105, v237, v105
    v_bitop3_b32 v9, v104, v105, v249 bitop3:0xa8
    v_cmp_ne_u32 vcc, 0, v9
    s_cbranch_vccnz fz_h2_r0
fz_h2_o0:
    v_mov_b32_dpp v112, v104 row_mirror row_mask:0xf bank_mask:0xf
    v_mov_b32_dpp v113, v105 row_mirror row_mask:0xf bank_mask:0xf
    s_cmp_eq_u32 s2, 66
    s_cbranch_scc1 fz_spec40
fz_spec4back0:
    v_fma_mix_f32 v28, v104, s36, v28 op_sel:[0,0,0] op_sel_hi:[1,0,0]
    v_fma_mix_f32 v29, v104, s36, v29 op_sel:[1,0,0] op_sel_hi:[1,0,0]
    v_fma_mix_f32 v30, v105, s36, v30 op_sel:[0,0,0] op_sel_hi:[1,0,0]
    v_fma_mix_f32 v31, v105, s36, v31 op_sel:[1,0,0] op_sel_hi:[1,0,0]
    v_and_b32 v112, v238, v112
    v_fma_mix_f32 v44, v112, s36, v44 op_sel:[0,0,0] op_sel_hi:[1,0,0]
    v_fma_mix_f32 v45, v112, s36, v45 op_sel:[1,0,0] op_sel_hi:[1,0,0]
    v_fma_mix_f32 v46, v113, s36, v46 op_sel:[0,0,0] op_sel_hi:[1,0,0]
    v_fma_mix_f32 v47, v113, s36, v47 op_sel:[1,0,0] op_sel_hi:[1,0,0]
    v_cvt_pk_bf16_f32 v120, v28, v29
    v_cvt_pk_bf16_f32 v121, v30, v31
    v_cvt_pk_bf16_f32 v128, v44, v45
    v_cvt_pk_bf16_f32 v129, v46, v47
fz_h2_c1:
    s_waitcnt vmcnt(2)
    v_xor_b32 v106, v236, v106
    v_xor_b32 v107, v237, v107
    v_bitop3_b32 v9, v106, v107, v249 bitop3:0xa8
    v_cmp_ne_u32 vcc, 0, v9
    s_cbranch_vccnz fz_h2_r1
fz_h2_o1:
    v_mov_b32_dpp v114, v106 row_mirror row_mask:0xf bank_mask:0xf
    v_mov_b32_dpp v115, v107 row_mirror row_mask:0xf bank_mask:0xf
    s_cmp_eq_u32 s2, 66
    s_cbranch_scc1 fz_spec41
fz_spec4back1:
    v_fma_mix_f32 v32, v106, s36, v32 op_sel:[0,0,0] op_sel_hi:[1,0,0]
    v_fma_mix_f32 v33, v106, s36, v33 op_sel:[1,0,0] op_sel_hi:[1,0,0]
    v_fma_mix_f32 v34, v107, s36, v34 op_sel:[0,0,0] op_sel_hi:[1,0,0]
    v_fma_mix_f32 v35, v107, s36, v35 op_sel:[1,0,0] op_sel_hi:[1,0,0]
    v_fma_mix_f32 v48, v114, s36, v48 op_sel:[0,0,0] op_sel_hi:[1,0,0]
    v_fma_mix_f32 v49, v114, s36, v49 op_sel:[1,0,0] op_sel_hi:[1,0,0]
    v_fma_mix_f32 v50, v115, s36, v50 op_sel:[0,0,0] op_sel_hi:[1,0,0]
    v_fma_mix_f32 v51, v115, s36, v51 op_sel:[1,0,0] op_sel_hi:[1,0,0]
    v_cvt_pk_bf16_f32 v122, v32, v33
    v_cvt_pk_bf16_f32 v123, v34, v35
    v_cvt_pk_bf16_f32 v130, v48, v49
    v_cvt_pk_bf16_f32 v131, v50, v51
    v_mfma_f32_16x16x32_bf16 v[136:139], v[120:123], v[120:123], 0
    v_mfma_f32_16x16x32_bf16 v[140:143], v[200:203], v[120:123], 0
    v_mfma_f32_16x16x32_bf16 v[136:139], v[128:131], v[128:131], v[136:139]
    v_mfma_f32_16x16x32_bf16 v[140:143], v[208:211], v[128:131], v[140:143]
fz_h2_c2:
    s_waitcnt vmcnt(1)
    v_xor_b32 v108, v236, v108
    v_xor_b32 v109, v237, v109
    v_bitop3_b32 v9, v108, v109, v249 bitop3:0xa8
    v_cmp_ne_u32 vcc, 0, v9
    s_cbranch_vccnz fz_h2_r2
fz_h2_o2:
    v_mov_b32_dpp v116, v108 row_mirror row_mask:0xf bank_mask:0xf
    v_mov_b32_dpp v117, v109 row_mirror row_mask:0xf bank_mask:0xf
    s_cmp_eq_u32 s2, 66
    s_cbranch_scc1 fz_spec42
fz_spec4back2:
    v_fma_mix_f32 v36, v108, s36, v36 op_sel:[0,0,0] op_sel_hi:[1,0,0]
    v_fma_mix_f32 v37, v108, s36, v37 op_sel:[1,0,0] op_sel_hi:[1,0,0]
    v_fma_mix_f32 v38, v109, s36, v38 op_sel:[0,0,0] op_sel_hi:[1,0,0]
    v_fma_mix_f32 v39, v109, s36, v39 op_sel:[1,0,0] op_sel_hi:[1,0,0]
    v_fma_mix_f32 v52, v116, s36, v52 op_sel:[0,0,0] op_sel_hi:[1,0,0]
    v_fma_mix_f32 v53, v116, s36, v53 op_sel:[1,0,0] op_sel_hi:[1,0,0]
    v_fma_mix_f32 v54, v117, s36, v54 op_sel:[0,0,0] op_sel_hi:[1,0,0]
    v_fma_mix_f32 v55, v117, s36, v55 op_sel:[1,0,0] op_sel_hi:[1,0,0]
    v_cvt_pk_bf16_f32 v124, v36, v37
    v_cvt_pk_bf16_f32 v125, v38, v39
    v_cvt_pk_bf16_f32 v132, v52, v53
    v_cvt_pk_bf16_f32 v133, v54, v55
fz_h2_c3:
    s_waitcnt vmcnt(0)
    v_xor_b32 v110, v236, v110
    v_xor_b32 v111, v237, v111
    v_bitop3_b32 v9, v110, v111, v249 bitop3:0xa8
    v_cmp_ne_u32 vcc, 0, v9
    s_cbranch_vccnz fz_h2_r3
fz_h2_o3:
    v_mov_b32_dpp v118, v110 row_mirror row_mask:0xf bank_mask:0xf
    v_mov_b32_dpp v119, v111 row_mirror row_mask:0xf bank_mask:0xf
    s_cmp_eq_u32 s2, 66
    s_cbranch_scc1 fz_spec43
fz_spec4back3:
    v_fma_mix_f32 v40, v110, s36, v40 op_sel:[0,0,0] op_sel_hi:[1,0,0]
    v_fma_mix_f32 v41, v110, s36, v41 op_sel:[1,0,0] op_sel_hi:[1,0,0]
    v_fma_mix_f32 v42, v111, s36, v42 op_sel:[0,0,0] op_sel_hi:[1,0,0]
    v_fma_mix_f32 v43, v111, s36, v43 op_sel:[1,0,0] op_sel_hi:[1,0,0]
    v_fma_mix_f32 v56, v118, s36, v56 op_sel:[0,0,0] op_sel_hi:[1,0,0]
    v_fma_mix_f32 v57, v118, s36, v57 op_sel:[1,0,0] op_sel_hi:[1,0,0]
    v_fma_mix_f32 v58, v119, s36, v58 op_sel:[0,0,0] op_sel_hi:[1,0,0]
    v_fma_mix_f32 v59, v119, s36, v59 op_sel:[1,0,0] op_sel_hi:[1,0,0]
    v_cvt_pk_bf16_f32 v126, v40, v41
    v_cvt_pk_bf16_f32 v127, v42, v43
    v_cvt_pk_bf16_f32 v134, v56, v57
    v_cvt_pk_bf16_f32 v135, v58, v59
    v_mfma_f32_16x16x32_bf16 v[136:139], v[124:127], v[124:127], v[136:139]
    v_mfma_f32_16x16x32_bf16 v[140:143], v[204:207], v[124:127], v[140:143]
    v_mfma_f32_16x16x32_bf16 v[136:139], v[132:135], v[132:135], v[136:139]
    v_mfma_f32_16x16x32_bf16 v[140:143], v[212:215], v[132:135], v[140:143]
    s_nop 6
    v_cndmask_b32_e64 v9, v136, v137, s[28:29]
    v_cndmask_b32_e64 v10, v138, v139, s[28:29]
    ds_write_b64 v243, v[140:141]
    v_cndmask_b32_e64 v9, v9, v10, s[30:31]
    ds_write_b32 v244, v9 offset:8
    s_cmp_gt_u32 s3, 3
    s_cbranch_scc1 fz_lp
    s_setprio 2
fz_lp:
    s_waitcnt lgkmcnt(0)
    s_barrier
    ds_read_b128 v[144:147], v245 offset:0
    ds_read_b128 v[148:151], v245 offset:256
    ds_read_b128 v[152:155], v245 offset:512
    ds_read_b128 v[156:159], v245 offset:768
    s_waitcnt lgkmcnt(2)
    v_pk_add_f32 v[144:145], v[144:145], v[148:149]
    v_pk_add_f32 v[146:147], v[146:147], v[150:151]
    s_waitcnt lgkmcnt(0)
    v_pk_add_f32 v[152:153], v[152:153], v[156:157]
    v_pk_add_f32 v[154:155], v[154:155], v[158:159]
    v_pk_add_f32 v[144:145], v[144:145], v[152:153]
    v_pk_add_f32 v[146:147], v[146:147], v[154:155]
    v_mov_b32 v148, v144
    v_mov_b32 v149, v145
    v_mov_b32 v150, v146
    v_mov_b32 v151, v147
    v_permlane32_swap_b32 v144, v148
    v_permlane32_swap_b32 v145, v149
    v_permlane32_swap_b32 v146, v150
    v_permlane32_swap_b32 v147, v151
    v_pk_add_f32 v[144:145], v[144:145], v[148:149]
    v_pk_add_f32 v[146:147], v[146:147], v[150:151]
    v_mul_f32 v145, 0xba800000, v145
    v_mul_f32 v146, 0x3a800000, v146
    v_fma_f32 v146, -v145, v145, v146
    v_cvt_pk_bf16_f32 v153, 0, v145
    v_cvt_pk_bf16_f32 v146, 0, v146
    v_add_f32 v146, 0x3727c5ac, v146
    v_cvt_pk_bf16_f32 v146, 0, v146
    v_sqrt_f32 v146, v146
    v_fmac_f32 v144, v153, v147
    v_cvt_pk_bf16_f32 v146, 0, v146
    v_rcp_f32 v154, v146
    v_mov_b32 v155, s40
    v_mul_f32 v144, v144, v154
    v_cvt_pk_bf16_f32 v144, 0, v144
    v_ashrrev_i32 v145, 31, v144
    v_or_b32 v145, 0x80000000, v145
    v_bitop3_b32 v152, v144, v145, v242 bitop3:0x28
    v_or_b32 v152, v152, v248
    s_nop 1
    v_max_u32_dpp v144, v152, v152 row_ror:1 row_mask:0xf bank_mask:0xf
    s_nop 1
    v_max_u32_dpp v144, v144, v144 row_ror:2 row_mask:0xf bank_mask:0xf
    s_nop 1
    v_max_u32_dpp v144, v144, v144 row_ror:4 row_mask:0xf bank_mask:0xf
    s_nop 1
    v_max_u32_dpp v144, v144, v144 row_ror:8 row_mask:0xf bank_mask:0xf
    v_cmp_eq_u32 vcc, v144, v152
    v_or_b32 v153, s24, v153
    s_nop 0
    s_mov_b64 exec, vcc
    buffer_store_dwordx4 v[152:155], v246, s[4:7], s26 offen sc1
    s_add_u32 s26, s26, 69632
    buffer_store_dwordx4 v[152:155], v246, s[4:7], s26 offen sc1
    buffer_store_dwordx4 v[120:123], v247, s[4:7], s27 offen offset:0 sc1
    buffer_store_dwordx4 v[124:127], v247, s[4:7], s27 offen offset:64 sc1
    buffer_store_dwordx4 v[128:131], v247, s[4:7], s27 offen offset:128 sc1
    buffer_store_dwordx4 v[132:135], v247, s[4:7], s27 offen offset:192 sc1
    s_mov_b64 exec, -1
    s_setprio 0
    v_readfirstlane_b32 s16, v144
    s_ff1_i32_b64 s37, vcc
    v_add_f32 v144, 1.0, v154
    v_and_b32 v146, v242, v153
    v_mul_f32 v146, v146, v154
    v_pk_fma_f32 v[28:29], v[28:29], v[144:145], v[146:147] op_sel_hi:[1,0,0]
    v_pk_fma_f32 v[30:31], v[30:31], v[144:145], v[146:147] op_sel_hi:[1,0,0]
    v_pk_fma_f32 v[32:33], v[32:33], v[144:145], v[146:147] op_sel_hi:[1,0,0]
    v_pk_fma_f32 v[34:35], v[34:35], v[144:145], v[146:147] op_sel_hi:[1,0,0]
    v_pk_fma_f32 v[36:37], v[36:37], v[144:145], v[146:147] op_sel_hi:[1,0,0]
    v_pk_fma_f32 v[38:39], v[38:39], v[144:145], v[146:147] op_sel_hi:[1,0,0]
    v_pk_fma_f32 v[40:41], v[40:41], v[144:145], v[146:147] op_sel_hi:[1,0,0]
    v_pk_fma_f32 v[42:43], v[42:43], v[144:145], v[146:147] op_sel_hi:[1,0,0]
    v_pk_fma_f32 v[44:45], v[44:45], v[144:145], v[146:147] op_sel_hi:[1,0,0]
    v_pk_fma_f32 v[46:47], v[46:47], v[144:145], v[146:147] op_sel_hi:[1,0,0]
    v_pk_fma_f32 v[48:49], v[48:49], v[144:145], v[146:147] op_sel_hi:[1,0,0]
    v_pk_fma_f32 v[50:51], v[50:51], v[144:145], v[146:147] op_sel_hi:[1,0,0]
    v_pk_fma_f32 v[52:53], v[52:53], v[144:145], v[146:147] op_sel_hi:[1,0,0]
    v_pk_fma_f32 v[54:55], v[54:55], v[144:145], v[146:147] op_sel_hi:[1,0,0]
    v_pk_fma_f32 v[56:57], v[56:57], v[144:145], v[146:147] op_sel_hi:[1,0,0]
    v_pk_fma_f32 v[58:59], v[58:59], v[144:145], v[146:147] op_sel_hi:[1,0,0]
    v_cvt_pk_bf16_f32 v104, v28, v29
    v_cvt_pk_bf16_f32 v105, v30, v31
    v_cvt_pk_bf16_f32 v106, v32, v33
    v_cvt_pk_bf16_f32 v107, v34, v35
    v_cvt_pk_bf16_f32 v108, v36, v37
    v_cvt_pk_bf16_f32 v109, v38, v39
    v_cvt_pk_bf16_f32 v110, v40, v41
    v_cvt_pk_bf16_f32 v111, v42, v43
    v_cvt_pk_bf16_f32 v112, v44, v45
    v_cvt_pk_bf16_f32 v113, v46, v47
    v_cvt_pk_bf16_f32 v114, v48, v49
    v_cvt_pk_bf16_f32 v115, v50, v51
    v_cvt_pk_bf16_f32 v116, v52, v53
    v_cvt_pk_bf16_f32 v117, v54, v55
    v_cvt_pk_bf16_f32 v118, v56, v57
    v_cvt_pk_bf16_f32 v119, v58, v59
    ds_write_b128 v231, v[104:107]
    ds_write_b128 v231, v[108:111] offset:16
    s_waitcnt lgkmcnt(0)
    s_barrier
    s_cmp_lt_u32 s3, 4
    s_cbranch_scc1 fz_now4
    buffer_load_dwordx4 v[192:195], v14, s[64:67], s62 offen offset:0 nt
    buffer_load_dwordx4 v[196:199], v14, s[64:67], s62 offen offset:256 nt
    s_add_u32 s62, s62, 8192
    buffer_load_dwordx4 v[60:63], v14, s[64:67], s62 offen offset:0 nt
    buffer_load_dwordx4 v[64:67], v14, s[64:67], s62 offen offset:256 nt
    s_add_u32 s62, s62, 8192
    buffer_load_dwordx4 v[68:71], v14, s[64:67], s62 offen offset:0 nt
    buffer_load_dwordx4 v[88:91], v14, s[64:67], s62 offen offset:256 nt
    s_add_u32 s62, s62, 8192
    buffer_load_dwordx4 v[92:95], v14, s[64:67], s62 offen offset:0 nt
    buffer_load_dwordx4 v[96:99], v14, s[64:67], s62 offen offset:256 nt
fz_now4:
    ds_write_b16 v233, v104
    ds_write_b16 v241, v112
    ds_write_b16_d16_hi v232, v112 offset:28
    ds_write_b16 v232, v113 offset:26
    ds_write_b16_d16_hi v232, v113 offset:24
    ds_write_b16 v232, v114 offset:22
    ds_write_b16_d16_hi v232, v114 offset:20
    ds_write_b16 v232, v115 offset:18
    ds_write_b16_d16_hi v232, v115 offset:16
    ds_write_b16 v232, v116 offset:14
    ds_write_b16_d16_hi v232, v116 offset:12
    ds_write_b16 v232, v117 offset:10
    ds_write_b16_d16_hi v232, v117 offset:8
    ds_write_b16 v232, v118 offset:6
    ds_write_b16_d16_hi v232, v118 offset:4
    ds_write_b16 v232, v119 offset:2
    ds_write_b16_d16_hi v232, v119 offset:0
    s_lshl_b32 s32, s3, 1
    s_add_u32 s33, s32, 1
    v_readlane_b32 s34, v230, s32
    v_readlane_b32 s35, v230, s33
    s_mul_i32 s38, s3, 4128
    v_add_u32 v9, s38, v239
    s_lshl_b32 s34, s34, 11
    s_lshl_b32 s35, s35, 11
    s_waitcnt lgkmcnt(0)
    s_barrier
    ds_read_b128 v[104:107], v9 offset:0
    ds_read_b128 v[108:111], v9 offset:1024
    ds_read_b128 v[112:115], v9 offset:2064
    ds_read_b128 v[116:119], v9 offset:3088
    s_lshr_b32 s59, s37, 1
    s_xor_b32 s18, s59, 1
    s_and_b32 s18, s18, 3
    s_mov_b32 s17, s59
    s_and_b32 s59, s59, 3
    s_cmp_lt_u32 s23, 112
    s_cselect_b32 s38, s18, 8
    s_cmp_eq_u32 s38, s3
    s_cbranch_scc1 fz_sk1
    s_cmp_eq_u32 s59, s3
    s_cbranch_scc1 fz_sk1
    s_waitcnt lgkmcnt(0)
    s_cmp_eq_u32 s37, s32
    s_cbranch_scc1 fz_sk0
    buffer_store_dwordx4 v[104:107], v239, s[12:15], s34 offen offset:0 sc1
    buffer_store_dwordx4 v[108:111], v239, s[12:15], s34 offen offset:1024 sc1
fz_sk0:
    s_cmp_eq_u32 s37, s33
    s_cbranch_scc1 fz_sk1
    buffer_store_dwordx4 v[112:115], v239, s[12:15], s35 offen offset:0 sc1
    buffer_store_dwordx4 v[116:119], v239, s[12:15], s35 offen offset:1024 sc1
fz_sk1:
    v_and_b32 v15, 7, v4
    v_mul_u32_u24 v15, 544, v15
    v_lshl_add_u32 v15, v5, 4, v15
    v_add_u32 v15, 108032, v15
    s_lshl_b32 s63, s23, 5
    s_and_b32 s38, s3, 3
    s_mul_i32 s38, s38, 118784
    s_add_u32 s63, s63, s38
    s_add_u32 s63, s63, 0x4c8000
    v_lshrrev_b32 v13, 1, v1
    v_mul_u32_u24 v13, 3712, v13
    v_and_b32 v14, 1, v1
    v_lshl_add_u32 v102, v14, 4, v13
    v_add_u32 v103, 59392, v102
    v_mov_b32 v101, 49520
    v_mov_b32 v14, 0xffffff00
    s_cmp_eq_u32 s18, s3
    s_cbranch_scc1 fz_act
    s_cmp_eq_u32 s59, s3
    s_cbranch_scc1 fz_coll
    s_cmp_lt_u32 s3, 4
    s_cbranch_scc1 fz_xend
    s_branch fz_f2
fz_coll:
    s_and_b32 s38, s20, 15
    s_add_u32 s38, s38, 16
    s_mul_i32 s38, s38, 2176
    s_add_u32 s38, s38, 0x580000
    s_lshr_b32 s52, s20, 4
    s_lshl_b32 s52, s52, 7
    s_and_b32 s53, s20, 7
    s_lshl_b32 s53, s53, 4
    s_add_u32 s52, s52, s53
    s_bfe_u32 s53, s20, 0x10003
    s_lshl_b32 s53, s53, 2
    s_add_u32 s52, s52, s53
    v_and_b32 v2, 1, v1
    v_lshl_add_u32 v2, v2, 3, v5
    v_add_u32 v2, s52, v2
    v_and_b32 v3, 31, v2
    v_lshrrev_b32 v6, 5, v2
    v_cmp_gt_u32 vcc, 16, v6
    v_cmp_lt_u32 s[52:53], 16, v3
    v_cmp_eq_u32 s[54:55], 0, v3
    s_nop 1
    s_and_b64 s[54:55], s[54:55], vcc
    s_or_b64 s[52:53], s[52:53], s[54:55]
    v_cmp_eq_u32 s[54:55], 16, v3
    s_nop 1
    s_andn2_b64 s[54:55], s[54:55], vcc
    s_or_b64 s[52:53], s[52:53], s[54:55]
    v_sub_u32 v7, 1024, v2
    v_cndmask_b32_e64 v7, v2, v7, s[52:53]
    v_mov_b32 v8, 512
    v_cmp_eq_u32 vcc, 1024, v7
    s_nop 1
    v_cndmask_b32_e64 v7, v7, v8, vcc
    v_lshrrev_b32 v8, 5, v7
    v_and_b32 v7, 15, v7
    v_lshrrev_b32 v9, 2, v8
    v_lshlrev_b32 v9, 8, v9
    v_and_b32 v8, 3, v8
    v_lshl_add_u32 v9, v8, 4, v9
    v_lshrrev_b32 v8, 3, v7
    v_lshl_add_u32 v9, v8, 6, v9
    v_and_b32 v7, 7, v7
    v_lshl_add_u32 v9, v7, 1, v9
    v_cndmask_b32_e64 v7, 0, 1, s[52:53]
    v_lshl_add_u32 v9, v7, 7, v9
    v_lshlrev_b32 v2, 1, v2
    v_lshrrev_b32 v3, 1, v1
    v_mul_u32_u24 v3, 32, v3
    v_and_b32 v6, 1, v1
    v_lshl_add_u32 v3, v6, 4, v3
    v_mov_b32 v6, 0x7fffffff
    v_cmp_gt_u32 vcc, 32, v1
    s_nop 1
    v_cndmask_b32_e64 v6, v6, v3, vcc
    v_mov_b32 v7, s48
    v_cndmask_b32_e64 v16, 0, v7, vcc
    v_mov_b32 v7, s49
    v_cndmask_b32_e64 v17, 0, v7, vcc
    v_mov_b32 v7, s50
    v_cndmask_b32_e64 v18, 0, v7, vcc
    v_mov_b32 v7, s51
    v_cndmask_b32_e64 v19, 0, v7, vcc
    s_mul_i32 s52, s20, 3712
    s_add_u32 s52, s52, 0x4c8000
    s_add_u32 s53, s52, 1024
    s_add_u32 s54, s52, 2048
    s_add_u32 s55, s52, 3072
    v_lshlrev_b32 v20, 4, v1
    v_add_u32 v21, 1024, v20
    s_mov_b32 s58, 0
    s_nop 3
fz_k2:
    buffer_load_dwordx4 v[24:27], v20, s[4:7], s38 offen sc1
    buffer_load_dwordx4 v[28:31], v21, s[4:7], s38 offen sc1
    s_waitcnt vmcnt(0)
    v_xor_b32 v32, s40, v27
    v_xor_b32 v33, s40, v31
    v_max_u32 v34, v24, v28
    v_or_b32 v32, v32, v33
    v_cmp_ne_u32 vcc, 0, v32
    s_cbranch_vccnz fz_k2_rt
fz_k2_ok:
    v_max_u32_dpp v34, v34, v34 quad_perm:[1,0,3,2] row_mask:0xf bank_mask:0xf
    s_nop 1
    v_max_u32_dpp v34, v34, v34 quad_perm:[2,3,0,1] row_mask:0xf bank_mask:0xf
    s_nop 1
    v_max_u32_dpp v34, v34, v34 row_half_mirror row_mask:0xf bank_mask:0xf
    s_nop 1
    v_max_u32_dpp v34, v34, v34 row_mirror row_mask:0xf bank_mask:0xf
    s_nop 1
    v_max_u32_dpp v34, v34, v34 row_bcast:15 row_mask:0xa bank_mask:0xf
    s_nop 1
    v_max_u32_dpp v34, v34, v34 row_bcast:31 row_mask:0xc bank_mask:0xf
    s_nop 0
    v_readlane_b32 s36, v34, 63
    s_nop 1
    v_cmp_eq_u32 vcc, s36, v24
    v_cmp_eq_u32 s[56:57], s36, v28
    s_nop 1
    v_cndmask_b32_e64 v25, v25, v29, s[56:57]
    v_cndmask_b32_e64 v26, v26, v30, s[56:57]
    s_cmp_lg_u64 vcc, 0
    s_cselect_b32 s39, 0, 64
    s_or_b64 vcc, vcc, s[56:57]
    s_ff1_i32_b64 s41, vcc
    v_readlane_b32 s42, v25, s41
    v_readlane_b32 s43, v26, s41
    s_add_u32 s39, s39, s41
    s_and_b32 s42, s42, 0xffff0000
    s_cmp_eq_u32 s39, s20
    s_cselect_b32 s19, s37, 16
    s_lshl_b32 s39, s39, 11
    s_add_u32 s39, s39, 0x448000
    s_mov_b32 s58, 0
    s_mov_b32 s41, 0xffff0000
    s_nop 0
fz_c2:
    buffer_load_short_d16_hi v10, v9, s[4:7], s39 offen sc1
    s_waitcnt vmcnt(0)
    v_cmp_eq_u32 vcc, s41, v10
    s_cbranch_vccnz fz_c2_rt
fz_c2_ok:
    s_cmp_eq_u32 s19, s32
    s_cbranch_scc1 fz_sc0
    buffer_store_dwordx4 v[104:107], v239, s[12:15], s34 offen offset:0 sc1
    buffer_store_dwordx4 v[108:111], v239, s[12:15], s34 offen offset:1024 sc1
fz_sc0:
    s_cmp_eq_u32 s19, s33
    s_cbranch_scc1 fz_sc1
    buffer_store_dwordx4 v[112:115], v239, s[12:15], s35 offen offset:0 sc1
    buffer_store_dwordx4 v[116:119], v239, s[12:15], s35 offen offset:1024 sc1
fz_sc1:
    v_add_f32 v11, s42, v10
    v_cvt_pk_bf16_f32 v11, 0, v11
    v_mul_f32 v11, s43, v11
    v_cvt_pk_bf16_f32 v11, 0, v11
    s_ashr_i32 s39, s36, 31
    s_not_b32 s39, s39
    s_or_b32 s39, s39, 0x80000000
    s_xor_b32 s39, s36, s39
    s_and_b32 s39, s39, 0xffff0000
    v_mov_b32 v12, s39
    v_mul_f32 v12, 0xbfb8aa3b, v12
    v_exp_f32 v12, v12
    s_nop 0
    v_add_f32 v12, 1.0, v12
    v_rcp_f32 v12, v12
    s_nop 0
    v_cvt_pk_bf16_f32 v12, 0, v12
    s_and_b32 s39, s36, 0xffff
    s_sub_u32 s39, 2047, s39
    s_lshl_b32 s39, s39, 11
    v_mov_b32 v13, 0xff
    s_waitcnt lgkmcnt(0)
fz_f2:
    s_cmp_gt_u32 s23, 111
    s_cbranch_scc1 fz_nof2
    s_cmp_lt_u32 s3, 4
    s_cbranch_scc1 fz_ca
fz_fl1:
    ds_read_b32 v100, v101 offset:4
    s_waitcnt lgkmcnt(0)
    v_cmp_eq_u32 vcc, 0, v100
    s_cbranch_vccnz fz_fl1
    ds_read_b128 v[120:123], v15 offset:0
    ds_read_b128 v[124:127], v15 offset:64
    ds_read_b128 v[128:131], v15 offset:128
    ds_read_b128 v[132:135], v15 offset:192
    ds_read_b128 v[136:139], v15 offset:256
    ds_read_b128 v[140:143], v15 offset:320
    ds_read_b128 v[144:147], v15 offset:384
    ds_read_b128 v[148:151], v15 offset:448
    s_waitcnt vmcnt(2)
    s_waitcnt lgkmcnt(7)
    v_mfma_f32_16x16x32_bf16 v[152:155], v[120:123], v[160:163], 0
    v_mfma_f32_16x16x32_bf16 v[156:159], v[120:123], v[164:167], 0
    s_waitcnt lgkmcnt(6)
    v_mfma_f32_16x16x32_bf16 v[152:155], v[124:127], v[168:171], v[152:155]
    v_mfma_f32_16x16x32_bf16 v[156:159], v[124:127], v[172:175], v[156:159]
    s_waitcnt lgkmcnt(5)
    v_mfma_f32_16x16x32_bf16 v[152:155], v[128:131], v[176:179], v[152:155]
    v_mfma_f32_16x16x32_bf16 v[156:159], v[128:131], v[180:183], v[156:159]
    s_waitcnt lgkmcnt(4)
    v_mfma_f32_16x16x32_bf16 v[152:155], v[132:135], v[184:187], v[152:155]
    v_mfma_f32_16x16x32_bf16 v[156:159], v[132:135], v[188:191], v[156:159]
    s_waitcnt lgkmcnt(3)
    v_mfma_f32_16x16x32_bf16 v[152:155], v[136:139], v[192:195], v[152:155]
    v_mfma_f32_16x16x32_bf16 v[156:159], v[136:139], v[196:199], v[156:159]
    s_waitcnt lgkmcnt(2)
    v_mfma_f32_16x16x32_bf16 v[152:155], v[140:143], v[60:63], v[152:155]
    v_mfma_f32_16x16x32_bf16 v[156:159], v[140:143], v[64:67], v[156:159]
    s_waitcnt lgkmcnt(1)
    v_mfma_f32_16x16x32_bf16 v[152:155], v[144:147], v[68:71], v[152:155]
    v_mfma_f32_16x16x32_bf16 v[156:159], v[144:147], v[88:91], v[156:159]
    s_waitcnt lgkmcnt(0)
    v_mfma_f32_16x16x32_bf16 v[152:155], v[148:151], v[92:95], v[152:155]
    v_mfma_f32_16x16x32_bf16 v[156:159], v[148:151], v[96:99], v[156:159]
    s_mov_b32 exec_hi, 0
    s_nop 5
    v_and_or_b32 v152, v152, v14, s48
    v_and_or_b32 v153, v153, v14, s49
    v_and_or_b32 v154, v154, v14, s50
    v_and_or_b32 v155, v155, v14, s51
    buffer_store_dwordx4 v[152:155], v102, s[4:7], s63 offen sc1
    v_and_or_b32 v156, v156, v14, s48
    v_and_or_b32 v157, v157, v14, s49
    v_and_or_b32 v158, v158, v14, s50
    v_and_or_b32 v159, v159, v14, s51
    buffer_store_dwordx4 v[156:159], v103, s[4:7], s63 offen sc1
fz_f2d:
    s_mov_b32 exec_hi, -1
    v_mov_b32 v100, 1
    s_waitcnt vmcnt(0)
    s_mov_b64 exec, 1
    ds_add_u32 v101, v100 offset:8
    s_mov_b64 exec, -1
    s_branch fz_own
fz_ca:
    ds_read_b32 v100, v101 offset:8
    s_waitcnt lgkmcnt(0)
    v_cmp_ne_u32 vcc, 4, v100
    s_cbranch_vccnz fz_ca
    v_mov_b32 v7, 0
    s_branch fz_p5_ok
    s_nop 3
fz_nof2:
    s_cmp_lg_u32 s59, s3
    s_cbranch_scc1 fz_own
    s_mov_b32 s58, 0
    s_and_b32 s41, s20, 63
    s_mul_i32 s41, s41, 32
    s_add_u32 s41, s41, s52
    v_mov_b32 v7, 0
    s_nop 4
fz_p5:
    buffer_load_dword v8, v7, s[4:7], s41 offen sc1
    s_waitcnt vmcnt(0)
    v_and_b32 v8, 0xff, v8
    v_cmp_ne_u32 vcc, s48, v8
    s_cbranch_vccnz fz_p5_rt
fz_p5_ok:
    s_mov_b32 s58, 0
    buffer_load_dwordx4 v[40:43], v3, s[4:7], s52 offen sc1
    buffer_load_dwordx4 v[44:47], v3, s[4:7], s53 offen sc1
    buffer_load_dwordx4 v[48:51], v3, s[4:7], s54 offen sc1
    buffer_load_dwordx4 v[52:55], v6, s[4:7], s55 offen sc1
fz_h5_c0:
    s_waitcnt vmcnt(3)
    v_xor_b32 v40, s48, v40
    v_xor_b32 v41, s49, v41
    v_xor_b32 v42, s50, v42
    v_xor_b32 v43, s51, v43
    v_or3_b32 v8, v40, v41, v42
    v_bitop3_b32 v8, v8, v43, v13 bitop3:0xa8
    v_cmp_ne_u32 vcc, 0, v8
    s_cbranch_vccnz fz_h5_r0
fz_h5_o0:
fz_h5_c1:
    s_waitcnt vmcnt(2)
    v_xor_b32 v44, s48, v44
    v_xor_b32 v45, s49, v45
    v_xor_b32 v46, s50, v46
    v_xor_b32 v47, s51, v47
    v_or3_b32 v8, v44, v45, v46
    v_bitop3_b32 v8, v8, v47, v13 bitop3:0xa8
    v_cmp_ne_u32 vcc, 0, v8
    s_cbranch_vccnz fz_h5_r1
fz_h5_o1:
    v_pk_add_f32 v[40:41], v[40:41], v[44:45]
    v_pk_add_f32 v[42:43], v[42:43], v[46:47]
fz_h5_c2:
    s_waitcnt vmcnt(1)
    v_xor_b32 v48, s48, v48
    v_xor_b32 v49, s49, v49
    v_xor_b32 v50, s50, v50
    v_xor_b32 v51, s51, v51
    v_or3_b32 v8, v48, v49, v50
    v_bitop3_b32 v8, v8, v51, v13 bitop3:0xa8
    v_cmp_ne_u32 vcc, 0, v8
    s_cbranch_vccnz fz_h5_r2
fz_h5_o2:
    v_pk_add_f32 v[40:41], v[40:41], v[48:49]
    v_pk_add_f32 v[42:43], v[42:43], v[50:51]
fz_h5_c3:
    s_waitcnt vmcnt(0)
    v_xor_b32 v52, v16, v52
    v_xor_b32 v53, v17, v53
    v_xor_b32 v54, v18, v54
    v_xor_b32 v55, v19, v55
    v_or3_b32 v8, v52, v53, v54
    v_bitop3_b32 v8, v8, v55, v13 bitop3:0xa8
    v_cmp_ne_u32 vcc, 0, v8
    s_cbranch_vccnz fz_h5_r3
fz_h5_o3:
    v_pk_add_f32 v[40:41], v[40:41], v[52:53]
    v_pk_add_f32 v[42:43], v[42:43], v[54:55]
    s_nop 1
    v_permlane32_swap_b32 v40, v42
    v_permlane32_swap_b32 v41, v43
    v_pk_add_f32 v[40:41], v[40:41], v[42:43]
    s_nop 1
    v_permlane16_swap_b32 v40, v41
    v_add_f32 v40, v40, v41
    s_nop 1
    v_add_f32_dpp v40, v40, v40 quad_perm:[2,3,0,1] row_mask:0xf bank_mask:0xf
    s_nop 1
    v_add_f32_dpp v40, v40, v40 row_ror:4 row_mask:0xf bank_mask:0xf
    s_nop 1
    v_add_f32_dpp v40, v40, v40 row_ror:8 row_mask:0xf bank_mask:0xf
    v_cvt_pk_bf16_f32 v40, 0, v40
    v_mul_f32 v40, v40, v12
    v_cvt_pk_bf16_f32 v40, 0, v40
    v_add_f32 v40, v40, v11
    v_cvt_pk_bf16_f32 v40, 0, v40
    v_add_f32 v40, v40, v10
    v_cvt_pk_bf16_f32 v40, 0, v40
    s_mov_b32 exec_lo, 0x00030003
    s_mov_b32 exec_hi, 0x00030003
    buffer_store_short_d16_hi v40, v2, s[12:15], s39 offen
    s_cmp_lg_u32 s20, 0
    s_cbranch_scc1 fz_xend
    s_mov_b64 exec, 1
    v_mov_b32 v8, s40
    buffer_store_dword v8, v7, s[4:7], 0 offen
fz_xend:
fz_end:
    s_endpgm
fz_own:
    s_cmp_lg_u32 s17, s3
    s_cbranch_scc1 fz_xend
    s_and_b32 s38, s20, 15
    s_add_u32 s38, s38, 16
    s_mul_i32 s38, s38, 2176
    s_add_u32 s38, s38, 0x580000
    v_lshlrev_b32 v20, 4, v1
    v_add_u32 v21, 1024, v20
    s_mov_b32 s58, 0
fz_k4:
    buffer_load_dwordx4 v[24:27], v20, s[4:7], s38 offen sc1
    buffer_load_dwordx4 v[28:31], v21, s[4:7], s38 offen sc1
    s_waitcnt vmcnt(0)
    v_xor_b32 v32, s40, v27
    v_xor_b32 v33, s40, v31
    v_max_u32 v34, v24, v28
    v_or_b32 v32, v32, v33
    v_cmp_ne_u32 vcc, 0, v32
    s_cbranch_vccnz fz_k4_rt
fz_k4_ok:
    v_max_u32_dpp v34, v34, v34 quad_perm:[1,0,3,2] row_mask:0xf bank_mask:0xf
    s_nop 1
    v_max_u32_dpp v34, v34, v34 quad_perm:[2,3,0,1] row_mask:0xf bank_mask:0xf
    s_nop 1
    v_max_u32_dpp v34, v34, v34 row_half_mirror row_mask:0xf bank_mask:0xf
    s_nop 1
    v_max_u32_dpp v34, v34, v34 row_mirror row_mask:0xf bank_mask:0xf
    s_nop 1
    v_max_u32_dpp v34, v34, v34 row_bcast:15 row_mask:0xa bank_mask:0xf
    s_nop 1
    v_max_u32_dpp v34, v34, v34 row_bcast:31 row_mask:0xc bank_mask:0xf
    s_nop 0
    v_readlane_b32 s36, v34, 63
    s_nop 1
    s_cmp_eq_u32 s36, s16
    s_cbranch_scc1 fz_xend
    s_bitcmp1_b32 s37, 0
    s_cbranch_scc1 fz_o1
    buffer_store_dwordx4 v[104:107], v239, s[12:15], s34 offen offset:0 sc1
    buffer_store_dwordx4 v[108:111], v239, s[12:15], s34 offen offset:1024 sc1
    s_branch fz_xend
fz_o1:
    buffer_store_dwordx4 v[112:115], v239, s[12:15], s35 offen offset:0 sc1
    buffer_store_dwordx4 v[116:119], v239, s[12:15], s35 offen offset:1024 sc1
    s_branch fz_xend
fz_late:
    buffer_store_dwordx4 v[104:107], v239, s[12:15], s34 offen offset:0 sc1
    buffer_store_dwordx4 v[108:111], v239, s[12:15], s34 offen offset:1024 sc1
    buffer_store_dwordx4 v[112:115], v239, s[12:15], s35 offen offset:0 sc1
    buffer_store_dwordx4 v[116:119], v239, s[12:15], s35 offen offset:1024 sc1
    s_branch fz_xend
fz_act:
    s_cmp_gt_u32 s23, 111
    s_cbranch_scc1 fz_xend
    v_lshlrev_b32 v2, 2, v1
    v_and_b32 v11, 3, v1
    v_mov_b32 v3, s48
    v_cmp_eq_u32 vcc, 1, v11
    v_mov_b32 v10, s49
    s_nop 0
    v_cndmask_b32_e64 v3, v3, v10, vcc
    v_cmp_eq_u32 vcc, 2, v11
    v_mov_b32 v10, s50
    s_nop 0
    v_cndmask_b32_e64 v3, v3, v10, vcc
    v_cmp_eq_u32 vcc, 3, v11
    v_mov_b32 v10, s51
    s_nop 0
    v_cndmask_b32_e64 v3, v3, v10, vcc
    v_and_b32 v10, 31, v1
    v_lshlrev_b32 v6, 4, v10
    v_lshrrev_b32 v10, 5, v1
    v_mul_u32_u24 v10, 2184, v10
    v_add_u32 v6, v6, v10
    v_add_u32 v6, 108032, v6
    s_lshl_b32 s38, s23, 11
    s_add_u32 s38, s38, 0x488000
    s_mov_b32 s58, 0
fz_h4:
    buffer_load_dword v16, v2, s[4:7], s38 offen offset:0 sc1
    buffer_load_dword v17, v2, s[4:7], s38 offen offset:256 sc1
    buffer_load_dword v18, v2, s[4:7], s38 offen offset:512 sc1
    buffer_load_dword v19, v2, s[4:7], s38 offen offset:768 sc1
    buffer_load_dword v20, v2, s[4:7], s38 offen offset:1024 sc1
    buffer_load_dword v21, v2, s[4:7], s38 offen offset:1280 sc1
    buffer_load_dword v22, v2, s[4:7], s38 offen offset:1536 sc1
    buffer_load_dword v23, v2, s[4:7], s38 offen offset:1792 sc1
    s_waitcnt vmcnt(6)
    v_xor_b32 v16, v3, v16
    v_xor_b32 v17, v3, v17
    v_or3_b32 v10, v16, v17, 0
    v_add_f32 v16, v16, v17
    s_waitcnt vmcnt(4)
    v_xor_b32 v18, v3, v18
    v_xor_b32 v19, v3, v19
    v_or3_b32 v10, v18, v19, v10
    v_add_f32 v18, v18, v19
    v_add_f32 v16, v16, v18
    s_waitcnt vmcnt(2)
    v_xor_b32 v20, v3, v20
    v_xor_b32 v21, v3, v21
    v_or3_b32 v10, v20, v21, v10
    v_add_f32 v20, v20, v21
    s_waitcnt vmcnt(0)
    v_xor_b32 v22, v3, v22
    v_xor_b32 v23, v3, v23
    v_or3_b32 v10, v22, v23, v10
    v_add_f32 v22, v22, v23
    v_add_f32 v20, v20, v22
    v_and_b32 v10, 0xff, v10
    v_add_f32 v8, v16, v20
    v_cmp_ne_u32 vcc, 0, v10
    s_cbranch_vccnz fz_h4_rt
fz_h4_ok:
    v_cvt_pk_bf16_f32 v8, 0, v8
    v_mov_b32 v9, v8
    s_nop 1
    v_permlane32_swap_b32 v8, v9
    v_mul_f32 v10, 0xbfb8aa3b, v8
    v_exp_f32 v10, v10
    s_nop 0
    v_add_f32 v10, 1.0, v10
    v_rcp_f32 v10, v10
    s_nop 0
    v_mul_f32 v8, v8, v10
    v_cvt_pk_bf16_f32 v8, 0, v8
    v_mul_f32 v8, v8, v9
    v_cvt_pk_bf16_f32 v8, 0, v8
    ds_write_b16_d16_hi v6, v8 offset:0
    ds_write_b16_d16_hi v6, v8 offset:546
    ds_write_b16_d16_hi v6, v8 offset:1092
    ds_write_b16_d16_hi v6, v8 offset:1638
    s_waitcnt lgkmcnt(0)
    v_mov_b32 v8, 1
    ds_write_b32 v101, v8 offset:4
    s_branch fz_late
fz_ldh:
    s_load_dwordx2 s[12:13], s[0:1], 56
    s_load_dwordx2 s[16:17], s[0:1], 64
    s_mov_b32 s14, 0x700000
    s_mov_b32 s15, 0x00020000
    s_mov_b32 s18, 0x700000
    s_mov_b32 s19, 0x00020000
    s_branch fz_ldback
fz_spec:
    s_cmp_gt_u32 s3, 3
    s_cbranch_scc1 fz_spec_hi
    s_cmp_eq_u32 s3, 0
    s_cselect_b32 s31, 0, s31
    s_cselect_b32 s30, 33024, s30
    s_cmp_eq_u32 s3, 2
    s_cselect_b32 s31, 30960, s31
    s_cselect_b32 s30, 35088, s30
    s_cmp_eq_u32 s3, 3
    s_cselect_b32 s31, 37152, s31
    s_cselect_b32 s30, 39216, s30
    s_branch fz_specback
fz_spec_hi:
    s_mov_b32 m0, s31
    s_nop 0
    buffer_load_dwordx4 v239, s[8:11], s27 offen lds
    buffer_load_dwordx4 v239, s[8:11], s27 offen offset:1024 lds
    s_mov_b32 m0, s30
    s_nop 0
    buffer_load_dwordx4 v239, s[8:11], s28 offen lds
    buffer_load_dwordx4 v239, s[8:11], s28 offen offset:1024 lds
    v_lshlrev_b32 v13, 3, v0
    v_mov_b32 v10, -1
    v_mov_b32 v11, -1
    s_lshl_b32 s32, s20, 11
    s_add_u32 s32, s32, 0x447800
    s_mov_b32 s18, 0x800
    s_mov_b32 s19, 0x00020000
    s_lshl_b32 s33, s24, 10
    s_min_u32 s34, s33, 2048
    s_add_u32 s34, s34, 104960
    s_mov_b32 m0, s34
    buffer_store_dwordx2 v[10:11], v13, s[4:7], s32 offen sc1
    buffer_load_dwordx4 v239, s[16:19], s33 offen lds
    s_cmp_eq_u32 s24, 0
    s_cselect_b32 s31, 8256, s31
    s_cselect_b32 s30, 22704, s30
    s_cselect_b32 s27, 524288, s27
    s_cselect_b32 s28, 3670016, s28
    s_cmp_eq_u32 s24, 1
    s_cselect_b32 s31, 12384, s31
    s_cselect_b32 s30, 18576, s30
    s_cselect_b32 s27, 1572864, s27
    s_cselect_b32 s28, 2621440, s28
    s_cmp_eq_u32 s24, 2
    s_cselect_b32 s31, 41280, s31
    s_cselect_b32 s30, 43344, s30
    s_cselect_b32 s27, 1572864, s27
    s_cselect_b32 s28, 2621440, s28
    s_cmp_eq_u32 s24, 3
    s_cselect_b32 s31, 45408, s31
    s_cselect_b32 s30, 47472, s30
    s_cselect_b32 s27, 524288, s27
    s_cselect_b32 s28, 3670016, s28
    s_mov_b32 s57, 0
    s_branch fz_specback
fz_jb:
    v_cvt_pk_bf16_f32 v128, v104, v105
    v_cvt_pk_bf16_f32 v129, v106, v107
    v_cvt_pk_bf16_f32 v130, v108, v109
    v_cvt_pk_bf16_f32 v131, v110, v111
    v_cvt_pk_bf16_f32 v132, v112, v113
    v_cvt_pk_bf16_f32 v133, v114, v115
    v_cvt_pk_bf16_f32 v134, v116, v117
    v_cvt_pk_bf16_f32 v135, v118, v119
    s_branch fz_jend
fz_bsp0:
    buffer_load_dwordx4 v[160:163], v14, s[64:67], s62 offen offset:0 nt
    buffer_load_dwordx4 v[164:167], v14, s[64:67], s62 offen offset:256 nt
    s_add_u32 s62, s62, 8192
    buffer_load_dwordx4 v[168:171], v14, s[64:67], s62 offen offset:0 nt
    buffer_load_dwordx4 v[172:175], v14, s[64:67], s62 offen offset:256 nt
    s_add_u32 s62, s62, 8192
    buffer_load_dwordx4 v[176:179], v14, s[64:67], s62 offen offset:0 nt
    buffer_load_dwordx4 v[180:183], v14, s[64:67], s62 offen offset:256 nt
    s_add_u32 s62, s62, 8192
    buffer_load_dwordx4 v[184:187], v14, s[64:67], s62 offen offset:0 nt
    buffer_load_dwordx4 v[188:191], v14, s[64:67], s62 offen offset:256 nt
    s_add_u32 s62, s62, 8192
    s_branch fz_bsp
fz_spec40:
    s_mov_b32 s38, 0x80018001
    s_mov_b32 s39, 0x80018001
    v_cndmask_b32_e64 v112, v112, v104, s[38:39]
    v_cndmask_b32_e64 v113, v113, v105, s[38:39]
    s_branch fz_spec4back0
fz_spec41:
    s_mov_b32 s38, 0x80018001
    s_mov_b32 s39, 0x80018001
    v_cndmask_b32_e64 v114, v114, v106, s[38:39]
    v_cndmask_b32_e64 v115, v115, v107, s[38:39]
    s_branch fz_spec4back1
fz_spec42:
    s_mov_b32 s38, 0x80018001
    s_mov_b32 s39, 0x80018001
    v_cndmask_b32_e64 v116, v116, v108, s[38:39]
    v_cndmask_b32_e64 v117, v117, v109, s[38:39]
    s_branch fz_spec4back2
fz_spec43:
    s_mov_b32 s38, 0x80018001
    s_mov_b32 s39, 0x80018001
    v_cndmask_b32_e64 v118, v118, v110, s[38:39]
    v_cndmask_b32_e64 v119, v119, v111, s[38:39]
    s_branch fz_spec4back3
    s_nop 3
fz_nc1:
    s_setprio 0
    s_cmp_lg_u32 s59, 0
    s_cbranch_scc1 ffn_b
    buffer_load_dwordx4 v[176:179], v14, s[64:67], s62 offen offset:0 nt
    buffer_load_dwordx4 v[180:183], v14, s[64:67], s62 offen offset:256 nt
    s_add_u32 s62, s62, 8192
    buffer_load_dwordx4 v[184:187], v14, s[64:67], s62 offen offset:0 nt
    buffer_load_dwordx4 v[188:191], v14, s[64:67], s62 offen offset:256 nt
    s_add_u32 s62, s62, 8192
    s_mov_b32 m0, s31
    s_nop 0
    buffer_load_dwordx4 v239, s[8:11], s27 offen nt lds
    buffer_load_dwordx4 v239, s[8:11], s27 offen offset:1024 nt lds
    s_mov_b32 m0, s30
    s_nop 0
    buffer_load_dwordx4 v239, s[8:11], s28 offen nt lds
    buffer_load_dwordx4 v239, s[8:11], s28 offen offset:1024 nt lds
    v_lshlrev_b32 v13, 3, v0
    v_mov_b32 v10, -1
    v_mov_b32 v11, -1
    s_lshl_b32 s32, s20, 11
    s_add_u32 s32, s32, 0x447800
    s_mov_b32 s18, 0x800
    s_mov_b32 s19, 0x00020000
    s_lshl_b32 s33, s24, 10
    s_min_u32 s34, s33, 2048
    s_add_u32 s34, s34, 104960
    s_mov_b32 m0, s34
    buffer_store_dwordx2 v[10:11], v13, s[4:7], s32 offen sc1
    buffer_load_dwordx4 v239, s[16:19], s33 offen lds
    s_waitcnt vmcnt(14)
    v_readfirstlane_b32 s40, v250
    s_nop 1
    s_add_u32 s40, s40, 1
    s_and_b32 s38, s40, 3
    s_and_b32 s39, s40, 15
    s_bfe_u32 s41, s40, 0x20002
    s_lshl_b32 s41, s41, 16
    s_or_b32 s44, s38, s41
    s_bfe_u32 s41, s40, 0x40004
    s_lshl_b32 s41, s41, 4
    s_or_b32 s48, s39, s41
    s_bfe_u32 s41, s40, 0x20004
    s_lshl_b32 s41, s41, 16
    s_or_b32 s45, s38, s41
    s_bfe_u32 s41, s40, 0x40008
    s_lshl_b32 s41, s41, 4
    s_or_b32 s49, s39, s41
    s_bfe_u32 s41, s40, 0x20006
    s_lshl_b32 s41, s41, 16
    s_or_b32 s46, s38, s41
    s_bfe_u32 s41, s40, 0x4000c
    s_lshl_b32 s41, s41, 4
    s_or_b32 s50, s39, s41
    s_bfe_u32 s41, s40, 0x20008
    s_lshl_b32 s41, s41, 16
    s_or_b32 s47, s38, s41
    s_bfe_u32 s41, s40, 0x40010
    s_lshl_b32 s41, s41, 4
    s_or_b32 s51, s39, s41
    s_mov_b32 s38, 0x404
    s_cmp_eq_u32 s2, 66
    s_cselect_b32 s39, 8, 4
    s_cselect_b32 s38, 8, s38
fz_bsp:
    s_setprio 0
    s_mov_b32 s57, 1
    s_cmp_gt_u32 s3, 5
    s_cbranch_scc1 fz_nocq
    s_and_b32 s32, s3, 1
    s_lshl_b32 s33, s32, 2
    s_lshl_b32 s32, s32, 11
    v_and_b32 v8, 3, v4
    v_lshrrev_b32 v9, 2, v4
    v_lshl_add_u32 v8, v8, 3, v9
    v_add_u32 v8, s33, v8
    v_cvt_f32_u32 v8, v8
    v_mul_f32 v8, 0x3d000000, v8
    v_cvt_f32_u32 v9, v5
    v_mul_f32 v9, 4.0, v9
    v_mul_f32 v9, v8, v9
    v_mov_b32 v104, v9
    v_fmamk_f32 v105, v8, 0x3f800000, v9
    v_fmamk_f32 v106, v8, 0x40000000, v9
    v_fmamk_f32 v107, v8, 0x40400000, v9
    v_fmamk_f32 v108, v8, 0x41800000, v9
    v_fmamk_f32 v109, v8, 0x41880000, v9
    v_fmamk_f32 v110, v8, 0x41900000, v9
    v_fmamk_f32 v111, v8, 0x41980000, v9
    v_sin_f32 v112, v104
    v_sin_f32 v113, v105
    v_sin_f32 v114, v106
    v_sin_f32 v115, v107
    v_sin_f32 v116, v108
    v_sin_f32 v117, v109
    v_sin_f32 v118, v110
    v_sin_f32 v119, v111
    v_cos_f32 v104, v104
    v_cos_f32 v105, v105
    v_cos_f32 v106, v106
    v_cos_f32 v107, v107
    v_cos_f32 v108, v108
    v_cos_f32 v109, v109
    v_cos_f32 v110, v110
    v_cos_f32 v111, v111
    v_mul_f32 v104, 0x3d800000, v104
    v_mul_f32 v105, 0x3d800000, v105
    v_mul_f32 v106, 0x3d800000, v106
    v_mul_f32 v107, 0x3d800000, v107
    v_mul_f32 v108, 0x3d800000, v108
    v_mul_f32 v109, 0x3d800000, v109
    v_mul_f32 v110, 0x3d800000, v110
    v_mul_f32 v111, 0x3d800000, v111
    v_mul_f32 v112, 0x3d800000, v112
    v_mul_f32 v113, 0x3d800000, v113
    v_mul_f32 v114, 0x3d800000, v114
    v_mul_f32 v115, 0x3d800000, v115
    v_mul_f32 v116, 0x3d800000, v116
    v_mul_f32 v117, 0x3d800000, v117
    v_mul_f32 v118, 0x3d800000, v118
    v_mul_f32 v119, 0x3d800000, v119
    v_cvt_pk_f16_f32 v128, v104, v105
    v_cvt_pk_f16_f32 v129, v106, v107
    v_cvt_pk_f16_f32 v130, v108, v109
    v_cvt_pk_f16_f32 v131, v110, v111
    v_cvt_pk_f16_f32 v132, v112, v113
    v_cvt_pk_f16_f32 v133, v114, v115
    v_cvt_pk_f16_f32 v134, v116, v117
    v_cvt_pk_f16_f32 v135, v118, v119
    v_add_u32 v8, s32, v6
    ds_write_b128 v8, v[128:131] offset:14336
    ds_write_b128 v8, v[132:135] offset:15360
fz_nocq:
    s_and_b32 s32, s3, 3
    s_lshr_b32 s33, s3, 2
    s_lshl_b32 s33, s33, 4
    s_add_u32 s33, s33, s32
    v_and_b32 v8, 12, v4
    v_bfe_u32 v9, v4, 1, 1
    v_lshl_add_u32 v8, v9, 5, v8
    v_add_u32 v8, s33, v8
    v_cvt_f32_u32 v8, v8
    v_and_b32 v12, 1, v1
    v_cvt_f32_u32 v9, v12
    v_lshlrev_b32 v13, 2, v5
    v_cvt_f32_u32 v10, v13
    v_mul_f32 v11, 0x3c800000, v8
    v_mul_f32 v9, 0x3e800000, v9
    v_fma_f32 v9, v11, v10, v9
    v_mov_b32 v128, v9
    v_fmamk_f32 v129, v11, 0x3f800000, v9
    v_fmamk_f32 v130, v11, 0x40000000, v9
    v_fmamk_f32 v131, v11, 0x40400000, v9
    v_mul_f32 v11, 0x3a000000, v8
    v_lshlrev_b32 v9, 31, v1
    v_xor_b32 v11, v9, v11
    v_mul_f32 v9, v11, v10
    v_mov_b32 v112, v9
    v_fmamk_f32 v113, v11, 0x3f800000, v9
    v_fmamk_f32 v114, v11, 0x40000000, v9
    v_fmamk_f32 v115, v11, 0x40400000, v9
    v_fmamk_f32 v116, v11, 0x41800000, v9
    v_fmamk_f32 v117, v11, 0x41880000, v9
    v_fmamk_f32 v118, v11, 0x41900000, v9
    v_fmamk_f32 v119, v11, 0x41980000, v9
    v_cos_f32 v104, v128
    v_sin_f32 v105, v128
    v_cos_f32 v106, v129
    v_sin_f32 v107, v129
    v_cos_f32 v108, v130
    v_sin_f32 v109, v130
    v_cos_f32 v110, v131
    v_sin_f32 v111, v131
    v_sin_f32 v120, v112
    v_sin_f32 v121, v113
    v_sin_f32 v122, v114
    v_sin_f32 v123, v115
    v_sin_f32 v124, v116
    v_sin_f32 v125, v117
    v_sin_f32 v126, v118
    v_sin_f32 v127, v119
    v_cos_f32 v112, v112
    v_cos_f32 v113, v113
    v_cos_f32 v114, v114
    v_cos_f32 v115, v115
    v_cos_f32 v116, v116
    v_cos_f32 v117, v117
    v_cos_f32 v118, v118
    v_cos_f32 v119, v119
    v_cvt_pk_f16_f32 v16, v104, v105
    v_cvt_pk_f16_f32 v17, v106, v107
    v_cvt_pk_f16_f32 v18, v108, v109
    v_cvt_pk_f16_f32 v19, v110, v111
    v_cvt_pk_f16_f32 v20, v112, v113
    v_cvt_pk_f16_f32 v21, v114, v115
    v_cvt_pk_f16_f32 v22, v116, v117
    v_cvt_pk_f16_f32 v23, v118, v119
    v_cvt_pk_f16_f32 v24, v120, v121
    v_cvt_pk_f16_f32 v25, v122, v123
    v_cvt_pk_f16_f32 v26, v124, v125
    v_cvt_pk_f16_f32 v27, v126, v127
    s_and_b32 s32, s3, 3
    s_lshl_b32 s32, s32, 11
    s_add_u32 s32, s32, 86400
    v_add_u32 v225, s32, v239
    v_add_u32 v8, s33, v13
    v_sub_u32 v9, 32, v8
    v_min_u32 v9, v8, v9
    v_and_b32 v10, 15, v8
    v_cmp_eq_u32 s[32:33], 0, v10
    v_cmp_lt_u32 s[34:35], 16, v8
    v_lshlrev_b32 v10, 10, v9
    v_subrev_u32 v10, 1024, v10
    v_mov_b32 v11, 15872
    v_cmp_eq_u32 vcc, 0, v8
    s_nop 1
    v_cndmask_b32_e64 v10, v10, v11, vcc
    v_and_b32 v11, 3, v1
    v_lshl_add_u32 v10, v11, 4, v10
    v_lshrrev_b32 v11, 2, v4
    v_lshlrev_b32 v12, 7, v11
    v_sub_u32 v13, 960, v12
    v_cndmask_b32_e64 v13, v12, v13, s[34:35]
    v_add_u32 v226, v10, v13
    s_or_b64 s[34:35], s[34:35], s[32:33]
    v_add_u32 v12, 512, v12
    v_sub_u32 v13, 960, v12
    v_cndmask_b32_e64 v13, v12, v13, s[34:35]
    v_add_u32 v227, v10, v13
    s_mul_i32 s56, s20, 16512
    s_add_u32 s56, s56, 0x210000
    v_mov_b32 v249, 0x30003
    v_mov_b32 v252, s44
    v_mov_b32 v253, s45
    v_mov_b32 v254, s46
    v_mov_b32 v255, s47
    s_waitcnt lgkmcnt(0)
    v_sub_u32 v8, 15, v4
    v_min_u32 v8, v4, v8
    v_and_b32 v9, 1, v8
    v_lshlrev_b32 v9, 5, v9
    v_lshrrev_b32 v10, 1, v8
    v_lshl_add_u32 v9, v10, 9, v9
    v_add_u32 v9, s25, v9
    v_sub_u32 v10, 2048, v9
    v_cmp_lt_u32 s[34:35], 7, v4
    s_nop 1
    v_cndmask_b32_e64 v230, v9, v10, s[34:35]
    v_mov_b32 v9, v4
    v_mov_b32 v10, s20
    s_cmp_lg_u32 s21, 0
    s_cbranch_scc0 fz_spec3b
fz_spec3backb:
    v_lshlrev_b32 v10, 7, v10
    v_lshl_add_u32 v10, v9, 3, v10
    v_mul_u32_u24 v11, 66048, v5
    v_add_u32 v228, v10, v11
    v_and_b32 v9, 1, v9
    v_cmp_eq_u32 vcc, 1, v9
    v_mov_b32 v9, s44
    v_mov_b32 v10, s46
    v_cndmask_b32_e64 v236, v9, v10, vcc
    v_mov_b32 v9, s45
    v_mov_b32 v10, s47
    v_cndmask_b32_e64 v237, v9, v10, vcc
    s_lshl_b32 s32, s3, 2
    v_add_u32 v8, s32, v5
    v_lshlrev_b32 v9, 6, v8
    v_cmp_gt_u32 vcc, 16, v8
    s_nop 1
    v_cndmask_b32_e64 v10, 0, 32, vcc
    v_add_u32 v10, v9, v10
    v_sub_u32 v11, 2048, v10
    v_cmp_eq_u32 vcc, 16, v8
    s_nop 1
    v_cndmask_b32_e64 v11, v11, 0, vcc
    v_mov_b32 v12, 0xffff0000
    v_cndmask_b32_e64 v238, -1, v12, vcc
    v_sub_u32 v12, 2018, v9
    v_mul_u32_u24 v13, 2064, v4
    v_add_u32 v231, v13, v9
    v_add_u32 v232, v13, v12
    v_add_u32 v233, v13, v10
    v_add_u32 v241, v13, v11
    s_lshl_b32 s32, s3, 8
    s_add_u32 s32, s32, 102912
    v_lshlrev_b32 v9, 4, v4
    v_add_u32 v10, s32, v9
    v_add_u32 v11, 107008, v239
    v_cmp_gt_u32 vcc, 16, v1
    s_nop 1
    v_cndmask_b32_e64 v243, v11, v10, vcc
    v_lshrrev_b32 v12, 2, v4
    v_cmp_eq_u32 vcc, v12, v5
    s_nop 1
    v_cndmask_b32_e64 v244, v11, v10, vcc
    v_lshrrev_b32 v12, 5, v1
    v_lshl_add_u32 v10, v12, 10, v9
    v_add_u32 v245, 102912, v10
    v_and_b32 v9, 1, v1
    v_cmp_eq_u32 s[28:29], 1, v9
    v_and_b32 v9, 2, v1
    v_cmp_eq_u32 s[30:31], 2, v9
    s_lshl_b32 s37, s3, 2
    v_add_u32 v9, s37, v5
    v_mul_u32_u24 v246, 2176, v9
    s_lshl_b32 s26, s20, 4
    s_add_u32 s26, s26, 0x580000
    v_lshlrev_b32 v247, 4, v5
    s_lshl_b32 s27, s20, 11
    s_lshl_b32 s37, s3, 8
    s_add_u32 s27, s27, s37
    s_add_u32 s27, s27, 0x448000
    v_sub_u32 v248, 2047, v230
    s_mov_b32 s14, 0x400000
    s_mov_b32 s15, 0x00020000
    s_mul_i32 s52, s3, 264192
    s_add_u32 s52, s52, 0x210000
    s_add_u32 s53, s52, 16512
    s_add_u32 s54, s52, 33024
    s_add_u32 s55, s52, 49536
    s_mov_b32 s23, s63
    s_getreg_b32 s24, hwreg(HW_REG_XCC_ID)
    s_and_b32 s24, s24, 15
    v_lshlrev_b32 v10, 4, v0
    v_min_u32 v10, 4336, v10
    v_add_u32 v10, 108032, v10
    v_mov_b32 v104, 0
    v_mov_b32 v105, 0
    v_mov_b32 v106, 0
    v_mov_b32 v107, 0
    ds_write_b128 v10, v[104:107]
    s_cmp_eq_u32 s2, 66
    s_cbranch_scc1 fz_sz
    s_waitcnt vmcnt(0)
    v_mov_b32 v10, 256
    s_mov_b64 exec, 1
    ds_add_u32 v15, v10
    s_mov_b64 exec, -1
fz_sz:
    ds_read_b32 v10, v15
    s_waitcnt lgkmcnt(0)
    v_cmp_ne_u32 vcc, s38, v10
    s_cbranch_vccnz fz_sz
    ds_read_b128 v[116:119], v231
    ds_read_b128 v[120:123], v231 offset:16
    ds_read_u16_d16_hi v44, v241
    ds_read_u16_d16_hi v45, v232 offset:28
    ds_read_u16_d16_hi v46, v232 offset:26
    ds_read_u16_d16_hi v47, v232 offset:24
    ds_read_u16_d16_hi v48, v232 offset:22
    ds_read_u16_d16_hi v49, v232 offset:20
    ds_read_u16_d16_hi v50, v232 offset:18
    ds_read_u16_d16_hi v51, v232 offset:16
    ds_read_u16_d16_hi v52, v232 offset:14
    ds_read_u16_d16_hi v53, v232 offset:12
    ds_read_u16_d16_hi v54, v232 offset:10
    ds_read_u16_d16_hi v55, v232 offset:8
    ds_read_u16_d16_hi v56, v232 offset:6
    ds_read_u16_d16_hi v57, v232 offset:4
    ds_read_u16_d16_hi v58, v232 offset:2
    ds_read_u16_d16_hi v59, v232 offset:0
    ds_read_u16_d16_hi v28, v233
    v_mul_u32_u24 v13, 2064, v4
    v_subrev_u32 v13, 104960, v13
    v_sub_u32 v9, v231, v13
    v_sub_u32 v10, v233, v13
    v_sub_u32 v11, v241, v13
    v_sub_u32 v12, v232, v13
    s_mov_b32 s36, 0xffff0000
    s_waitcnt lgkmcnt(0)
    ds_read_b128 v[200:203], v9
    ds_read_b128 v[204:207], v9 offset:16
    ds_read_u16_d16 v208, v11
    ds_read_u16_d16_hi v124, v12 offset:28
    ds_read_u16_d16 v209, v12 offset:26
    ds_read_u16_d16_hi v125, v12 offset:24
    ds_read_u16_d16 v210, v12 offset:22
    ds_read_u16_d16_hi v126, v12 offset:20
    ds_read_u16_d16 v211, v12 offset:18
    ds_read_u16_d16_hi v127, v12 offset:16
    ds_read_u16_d16 v212, v12 offset:14
    ds_read_u16_d16_hi v128, v12 offset:12
    ds_read_u16_d16 v213, v12 offset:10
    ds_read_u16_d16_hi v129, v12 offset:8
    ds_read_u16_d16 v214, v12 offset:6
    ds_read_u16_d16_hi v130, v12 offset:4
    ds_read_u16_d16 v215, v12 offset:2
    ds_read_u16_d16_hi v131, v12 offset:0
    ds_read_u16_d16 v13, v10
    v_and_b32 v29, s36, v116
    v_lshlrev_b32 v30, 16, v117
    v_and_b32 v31, s36, v117
    v_lshlrev_b32 v32, 16, v118
    v_and_b32 v33, s36, v118
    v_lshlrev_b32 v34, 16, v119
    v_and_b32 v35, s36, v119
    v_lshlrev_b32 v36, 16, v120
    v_and_b32 v37, s36, v120
    v_lshlrev_b32 v38, 16, v121
    v_and_b32 v39, s36, v121
    v_lshlrev_b32 v40, 16, v122
    v_and_b32 v41, s36, v122
    v_lshlrev_b32 v42, 16, v123
    v_and_b32 v43, s36, v123
    v_cmp_eq_u32 vcc, 1, v4
    v_mov_b32 v9, s42
    s_nop 0
    v_cndmask_b32_e64 v9, 0, v9, vcc
    v_mov_b32 v116, s42
    v_mov_b32 v117, s42
    v_mov_b32 v118, s42
    v_mov_b32 v119, s42
    v_cmp_eq_u32 vcc, 0, v4
    s_waitcnt lgkmcnt(0)
    v_and_or_b32 v200, v200, s36, v13
    v_or_b32 v208, v208, v124
    v_or_b32 v209, v209, v125
    v_or_b32 v210, v210, v126
    v_or_b32 v211, v211, v127
    v_or_b32 v212, v212, v128
    v_or_b32 v213, v213, v129
    v_or_b32 v214, v214, v130
    v_or_b32 v215, v215, v131
    v_cndmask_b32_e64 v200, v9, v200, vcc
    v_cndmask_b32_e64 v201, v9, v201, vcc
    v_cndmask_b32_e64 v202, v9, v202, vcc
    v_cndmask_b32_e64 v203, v9, v203, vcc
    v_cndmask_b32_e64 v204, v9, v204, vcc
    v_cndmask_b32_e64 v205, v9, v205, vcc
    v_cndmask_b32_e64 v206, v9, v206, vcc
    v_cndmask_b32_e64 v207, v9, v207, vcc
    v_cndmask_b32_e64 v208, v9, v208, vcc
    v_cndmask_b32_e64 v209, v9, v209, vcc
    v_cndmask_b32_e64 v210, v9, v210, vcc
    v_cndmask_b32_e64 v211, v9, v211, vcc
    v_cndmask_b32_e64 v212, v9, v212, vcc
    v_cndmask_b32_e64 v213, v9, v213, vcc
    v_cndmask_b32_e64 v214, v9, v214, vcc
    v_cndmask_b32_e64 v215, v9, v215, vcc
    v_mfma_f32_16x16x32_bf16 v[120:123], v[200:203], v[116:119], 0
    v_mfma_f32_16x16x32_bf16 v[120:123], v[204:207], v[116:119], v[120:123]
    v_mfma_f32_16x16x32_bf16 v[120:123], v[208:211], v[116:119], v[120:123]
    v_mfma_f32_16x16x32_bf16 v[120:123], v[212:215], v[116:119], v[120:123]
    s_nop 7
    ds_write_b32 v243, v120 offset:12
    s_waitcnt lgkmcnt(0)
    s_branch fz_hb
    s_nop 0
fz_nc3:
    s_mov_b32 s58, 0
    s_waitcnt vmcnt(0)
    s_branch fz_h2
fz_spec3a:
    v_xor_b32 v11, 1, v4
    v_cndmask_b32_e64 v9, v9, v11, s[34:35]
    v_and_b32 v11, 1, v4
    v_cndmask_b32_e64 v11, 0, v11, s[34:35]
    v_sub_u32 v10, v10, v11
    s_cmp_lg_u32 s22, 0
    s_cbranch_scc1 fz_spec3backa
    v_cmp_eq_u32 vcc, 15, v4
    v_mov_b32 v11, 1024
    v_mov_b32 v12, 124
    v_cndmask_b32_e64 v230, v230, v11, vcc
    v_cndmask_b32_e64 v10, v10, v12, vcc
    v_cndmask_b32_e64 v9, v9, 4, vcc
    v_cmp_eq_u32 vcc, 13, v4
    v_mov_b32 v11, 1536
    v_mov_b32 v12, 124
    v_cndmask_b32_e64 v230, v230, v11, vcc
    v_cndmask_b32_e64 v10, v10, v12, vcc
    v_cndmask_b32_e64 v9, v9, 6, vcc
    v_cmp_eq_u32 vcc, 4, v4
    v_mov_b32 v11, 256
    v_mov_b32 v12, 127
    v_cndmask_b32_e64 v230, v230, v11, vcc
    v_cndmask_b32_e64 v10, v10, v12, vcc
    v_cndmask_b32_e64 v9, v9, 8, vcc
    v_cmp_eq_u32 vcc, 11, v4
    v_mov_b32 v11, 1792
    v_mov_b32 v12, 127
    v_cndmask_b32_e64 v230, v230, v11, vcc
    v_cndmask_b32_e64 v10, v10, v12, vcc
    v_cndmask_b32_e64 v9, v9, 14, vcc
    v_cmp_eq_u32 vcc, 6, v4
    v_mov_b32 v11, 768
    v_mov_b32 v12, 127
    v_cndmask_b32_e64 v230, v230, v11, vcc
    v_cndmask_b32_e64 v10, v10, v12, vcc
    v_cndmask_b32_e64 v9, v9, 10, vcc
    v_cmp_eq_u32 vcc, 9, v4
    v_mov_b32 v11, 1280
    v_mov_b32 v12, 127
    v_cndmask_b32_e64 v230, v230, v11, vcc
    v_cndmask_b32_e64 v10, v10, v12, vcc
    v_cndmask_b32_e64 v9, v9, 12, vcc
    s_nop 4
    s_branch fz_spec3backa
fz_spec3b:
    v_xor_b32 v11, 1, v4
    v_cndmask_b32_e64 v9, v9, v11, s[34:35]
    v_and_b32 v11, 1, v4
    v_cndmask_b32_e64 v11, 0, v11, s[34:35]
    v_sub_u32 v10, v10, v11
    s_cmp_lg_u32 s22, 0
    s_cbranch_scc1 fz_spec3backb
    v_cmp_eq_u32 vcc, 15, v4
    v_mov_b32 v11, 1024
    v_mov_b32 v12, 124
    v_cndmask_b32_e64 v230, v230, v11, vcc
    v_cndmask_b32_e64 v10, v10, v12, vcc
    v_cndmask_b32_e64 v9, v9, 4, vcc
    v_cmp_eq_u32 vcc, 13, v4
    v_mov_b32 v11, 1536
    v_mov_b32 v12, 124
    v_cndmask_b32_e64 v230, v230, v11, vcc
    v_cndmask_b32_e64 v10, v10, v12, vcc
    v_cndmask_b32_e64 v9, v9, 6, vcc
    v_cmp_eq_u32 vcc, 4, v4
    v_mov_b32 v11, 256
    v_mov_b32 v12, 127
    v_cndmask_b32_e64 v230, v230, v11, vcc
    v_cndmask_b32_e64 v10, v10, v12, vcc
    v_cndmask_b32_e64 v9, v9, 8, vcc
    v_cmp_eq_u32 vcc, 11, v4
    v_mov_b32 v11, 1792
    v_mov_b32 v12, 127
    v_cndmask_b32_e64 v230, v230, v11, vcc
    v_cndmask_b32_e64 v10, v10, v12, vcc
    v_cndmask_b32_e64 v9, v9, 14, vcc
    v_cmp_eq_u32 vcc, 6, v4
    v_mov_b32 v11, 768
    v_mov_b32 v12, 127
    v_cndmask_b32_e64 v230, v230, v11, vcc
    v_cndmask_b32_e64 v10, v10, v12, vcc
    v_cndmask_b32_e64 v9, v9, 10, vcc
    v_cmp_eq_u32 vcc, 9, v4
    v_mov_b32 v11, 1280
    v_mov_b32 v12, 127
    v_cndmask_b32_e64 v230, v230, v11, vcc
    v_cndmask_b32_e64 v10, v10, v12, vcc
    v_cndmask_b32_e64 v9, v9, 12, vcc
    s_nop 4
    s_branch fz_spec3backb
    s_nop 0
ffn_b:
    s_waitcnt vmcnt(0)
    v_readfirstlane_b32 s40, v250
    s_nop 1
    s_add_u32 s40, s40, 1
    s_and_b32 s38, s40, 3
    s_and_b32 s39, s40, 15
    s_bfe_u32 s41, s40, 0x20002
    s_lshl_b32 s41, s41, 16
    s_or_b32 s44, s38, s41
    s_bfe_u32 s41, s40, 0x40004
    s_lshl_b32 s41, s41, 4
    s_or_b32 s48, s39, s41
    s_bfe_u32 s41, s40, 0x20004
    s_lshl_b32 s41, s41, 16
    s_or_b32 s45, s38, s41
    s_bfe_u32 s41, s40, 0x40008
    s_lshl_b32 s41, s41, 4
    s_or_b32 s49, s39, s41
    s_bfe_u32 s41, s40, 0x20006
    s_lshl_b32 s41, s41, 16
    s_or_b32 s46, s38, s41
    s_bfe_u32 s41, s40, 0x4000c
    s_lshl_b32 s41, s41, 4
    s_or_b32 s50, s39, s41
    s_bfe_u32 s41, s40, 0x20008
    s_lshl_b32 s41, s41, 16
    s_or_b32 s47, s38, s41
    s_bfe_u32 s41, s40, 0x40010
    s_lshl_b32 s41, s41, 4
    s_or_b32 s51, s39, s41
    s_nop 0
ffn:
    s_add_u32 s36, s2, 4
    s_and_b32 s36, s36, 7
    s_bfe_u32 s37, s2, 0x10006
    s_lshl_b32 s22, s36, 1
    s_add_u32 s22, s22, s37
    s_cmp_lg_u32 s37, 0
    s_cselect_b32 s37, 8, s36
    s_add_u32 s37, s37, 6
    s_cmp_lt_u32 s36, 6
    s_cselect_b32 s22, s22, s37
    s_cmp_gt_u32 s22, 13
    s_cbranch_scc1 fz_xend
    s_bfe_u32 s21, s2, 0x30003
    v_lshrrev_b32 v2, 5, v1
    v_and_b32 v3, 31, v1
    v_lshlrev_b32 v4, 1, v2
    v_xor_b32 v3, v4, v3
    v_mul_u32_u24 v4, 7168, v2
    v_lshl_add_u32 v4, v3, 4, v4
    v_xor_b32 v5, 64, v4
    v_xor_b32 v6, 128, v4
    v_xor_b32 v7, 192, v4
    s_lshl_b32 s23, s21, 7
    s_lshl_b32 s24, s3, 4
    s_add_u32 s23, s23, s24
    s_mul_i32 s23, s23, 7168
    s_lshl_b32 s24, s22, 9
    s_add_u32 s23, s23, s24
    s_lshl_b32 s24, s3, 13
    v_mov_b32 v31, 149552
    v_mov_b32 v10, 0
    ds_write_b32 v31, v10
    s_waitcnt lgkmcnt(0)
    s_setprio 0
    s_barrier
    s_add_u32 s28, s24, 81920
    s_mov_b32 m0, s28
    s_add_u32 s29, s23, 0
    buffer_load_dwordx4 v4, s[12:15], s29 offen nt lds
    s_add_u32 s28, s24, 82944
    s_mov_b32 m0, s28
    s_add_u32 s29, s23, 14336
    buffer_load_dwordx4 v5, s[12:15], s29 offen nt lds
    s_add_u32 s28, s24, 83968
    s_mov_b32 m0, s28
    s_add_u32 s29, s23, 28672
    buffer_load_dwordx4 v4, s[12:15], s29 offen nt lds
    s_add_u32 s28, s24, 84992
    s_mov_b32 m0, s28
    s_add_u32 s29, s23, 43008
    buffer_load_dwordx4 v5, s[12:15], s29 offen nt lds
    s_add_u32 s28, s24, 86016
    s_mov_b32 m0, s28
    s_add_u32 s29, s23, 57344
    buffer_load_dwordx4 v6, s[12:15], s29 offen nt lds
    s_add_u32 s28, s24, 87040
    s_mov_b32 m0, s28
    s_add_u32 s29, s23, 71680
    buffer_load_dwordx4 v7, s[12:15], s29 offen nt lds
    s_add_u32 s28, s24, 88064
    s_mov_b32 m0, s28
    s_add_u32 s29, s23, 86016
    buffer_load_dwordx4 v6, s[12:15], s29 offen nt lds
    s_add_u32 s28, s24, 89088
    s_mov_b32 m0, s28
    s_add_u32 s29, s23, 100352
    buffer_load_dwordx4 v7, s[12:15], s29 offen nt lds
    s_add_u32 s28, s24, 0
    s_mov_b32 m0, s28
    s_add_u32 s29, s23, 0
    buffer_load_dwordx4 v4, s[16:19], s29 offen nt lds
    s_add_u32 s28, s24, 1024
    s_mov_b32 m0, s28
    s_add_u32 s29, s23, 14336
    buffer_load_dwordx4 v5, s[16:19], s29 offen nt lds
    s_add_u32 s28, s24, 2048
    s_mov_b32 m0, s28
    s_add_u32 s29, s23, 28672
    buffer_load_dwordx4 v4, s[16:19], s29 offen nt lds
    s_add_u32 s28, s24, 3072
    s_mov_b32 m0, s28
    s_add_u32 s29, s23, 43008
    buffer_load_dwordx4 v5, s[16:19], s29 offen nt lds
    s_add_u32 s28, s24, 4096
    s_mov_b32 m0, s28
    s_add_u32 s29, s23, 57344
    buffer_load_dwordx4 v6, s[16:19], s29 offen nt lds
    s_add_u32 s28, s24, 5120
    s_mov_b32 m0, s28
    s_add_u32 s29, s23, 71680
    buffer_load_dwordx4 v7, s[16:19], s29 offen nt lds
    s_add_u32 s28, s24, 6144
    s_mov_b32 m0, s28
    s_add_u32 s29, s23, 86016
    buffer_load_dwordx4 v6, s[16:19], s29 offen nt lds
    s_add_u32 s28, s24, 7168
    s_mov_b32 m0, s28
    s_add_u32 s29, s23, 100352
    buffer_load_dwordx4 v7, s[16:19], s29 offen nt lds
    v_lshrrev_b32 v2, 4, v1
    v_and_b32 v3, 15, v1
    v_bfe_u32 v9, v1, 2, 2
    v_lshl_add_u32 v8, v2, 3, v9
    v_lshlrev_b32 v8, 9, v8
    v_and_b32 v10, 1, v2
    v_lshl_add_u32 v10, v10, 2, v9
    s_lshl_b32 s28, s3, 1
    v_xor_b32 v10, s28, v10
    v_lshl_add_u32 v8, v10, 5, v8
    v_and_b32 v10, 3, v1
    v_lshl_add_u32 v8, v10, 3, v8
    v_xor_b32 v12, 32, v8
    v_add_u32 v13, 81920, v8
    v_add_u32 v20, 81920, v12
    s_lshl_b32 s28, s21, 7
    v_lshl_add_u32 v9, v1, 1, s28
    v_and_b32 v24, 31, v9
    v_lshrrev_b32 v25, 5, v9
    v_cmp_gt_u32 vcc, 16, v25
    v_cmp_lt_u32 s[24:25], 16, v24
    v_cmp_eq_u32 s[26:27], 0, v24
    s_nop 1
    s_and_b64 s[26:27], s[26:27], vcc
    s_or_b64 s[24:25], s[24:25], s[26:27]
    v_cmp_eq_u32 s[26:27], 16, v24
    s_nop 1
    s_andn2_b64 s[26:27], s[26:27], vcc
    s_or_b64 s[24:25], s[24:25], s[26:27]
    v_sub_u32 v26, 1024, v9
    v_cndmask_b32_e64 v26, v9, v26, s[24:25]
    v_mov_b32 v27, 512
    v_cmp_eq_u32 vcc, 1024, v26
    s_nop 1
    v_cndmask_b32_e64 v26, v26, v27, vcc
    v_lshrrev_b32 v27, 5, v26
    v_and_b32 v26, 15, v26
    v_lshrrev_b32 v16, 2, v27
    v_lshlrev_b32 v16, 8, v16
    v_and_b32 v27, 3, v27
    v_lshl_add_u32 v16, v27, 4, v16
    v_lshrrev_b32 v27, 3, v26
    v_lshl_add_u32 v16, v27, 6, v16
    v_and_b32 v26, 7, v26
    v_lshl_add_u32 v16, v26, 1, v16
    v_cndmask_b32_e64 v26, 0, 1, s[24:25]
    v_lshl_add_u32 v16, v26, 7, v16
    v_add_u32 v9, 1, v9
    v_and_b32 v24, 31, v9
    v_lshrrev_b32 v25, 5, v9
    v_cmp_gt_u32 vcc, 16, v25
    v_cmp_lt_u32 s[24:25], 16, v24
    v_cmp_eq_u32 s[26:27], 0, v24
    s_nop 1
    s_and_b64 s[26:27], s[26:27], vcc
    s_or_b64 s[24:25], s[24:25], s[26:27]
    v_cmp_eq_u32 s[26:27], 16, v24
    s_nop 1
    s_andn2_b64 s[26:27], s[26:27], vcc
    s_or_b64 s[24:25], s[24:25], s[26:27]
    v_sub_u32 v26, 1024, v9
    v_cndmask_b32_e64 v26, v9, v26, s[24:25]
    v_mov_b32 v27, 512
    v_cmp_eq_u32 vcc, 1024, v26
    s_nop 1
    v_cndmask_b32_e64 v26, v26, v27, vcc
    v_lshrrev_b32 v27, 5, v26
    v_and_b32 v26, 15, v26
    v_lshrrev_b32 v17, 2, v27
    v_lshlrev_b32 v17, 8, v17
    v_and_b32 v27, 3, v27
    v_lshl_add_u32 v17, v27, 4, v17
    v_lshrrev_b32 v27, 3, v26
    v_lshl_add_u32 v17, v27, 6, v17
    v_and_b32 v26, 7, v26
    v_lshl_add_u32 v17, v26, 1, v17
    v_cndmask_b32_e64 v26, 0, 1, s[24:25]
    v_lshl_add_u32 v17, v26, 7, v17
    s_lshl_b32 s28, s21, 8
    s_add_u32 s28, s28, 147456
    v_lshl_add_u32 v18, v1, 2, s28
    s_lshl_b32 s28, s21, 8
    s_add_u32 s28, s28, 147456
    v_lshlrev_b32 v19, 4, v2
    v_add_u32 v19, s28, v19
    v_mov_b32 v28, 149504
    v_lshlrev_b32 v29, 4, v1
    s_lshl_b32 s30, s22, 3
    s_add_u32 s30, s30, s3
    s_lshl_b32 s30, s30, 3
    s_add_u32 s30, s30, s21
    s_lshl_b32 s30, s30, 8
    s_add_u32 s30, s30, 0x488000
    v_lshlrev_b32 v30, 4, v2
    v_lshl_add_u32 v30, v3, 6, v30
    v_cmp_eq_u32 s[60:61], 1, v3
    v_cmp_eq_u32 s[62:63], 2, v3
    v_cmp_eq_u32 s[64:65], 3, v3
    v_add_u32 v21, 149568, v29
    v_mov_b32 v197, 0xffffff00
    s_and_b32 s35, s2, 0x47
    s_lshl_b32 s31, s3, 3
    s_add_u32 s35, s35, s31
    s_add_u32 s35, s35, 58
    s_and_b32 s35, s35, 127
    s_getreg_b32 s33, hwreg(HW_REG_XCC_ID)
    s_and_b32 s33, s33, 15
    s_lshr_b32 s31, s35, 5
    s_lshl_b32 s31, s31, 2
    s_add_u32 s31, s31, 149520
    v_mov_b32 v22, s31
    s_lshl_b32 s20, s22, 3
    s_add_u32 s20, s20, s21
    s_and_b32 s34, s20, 15
    s_bfe_u32 s28, s20, 0x10004
    s_lshl_b32 s28, s28, 5
    s_add_u32 s34, s34, s28
    s_mul_i32 s34, s34, 2176
    s_add_u32 s34, s34, 0x580000
    s_waitcnt vmcnt(0)
    s_barrier
    ds_read_b64_tr_b16 v[32:33], v13 offset:0
    ds_read_b64_tr_b16 v[34:35], v13 offset:2048
    ds_read_b64_tr_b16 v[36:37], v13 offset:16384
    ds_read_b64_tr_b16 v[38:39], v13 offset:18432
    ds_read_b64_tr_b16 v[40:41], v13 offset:32768
    ds_read_b64_tr_b16 v[42:43], v13 offset:34816
    ds_read_b64_tr_b16 v[44:45], v13 offset:49152
    ds_read_b64_tr_b16 v[46:47], v13 offset:51200
    s_waitcnt lgkmcnt(0)
    ds_read_b64_tr_b16 v[48:49], v20 offset:0
    ds_read_b64_tr_b16 v[50:51], v20 offset:2048
    ds_read_b64_tr_b16 v[52:53], v20 offset:16384
    ds_read_b64_tr_b16 v[54:55], v20 offset:18432
    ds_read_b64_tr_b16 v[56:57], v20 offset:32768
    ds_read_b64_tr_b16 v[58:59], v20 offset:34816
    ds_read_b64_tr_b16 v[60:61], v20 offset:49152
    ds_read_b64_tr_b16 v[62:63], v20 offset:51200
    s_waitcnt lgkmcnt(0)
    ds_read_b64_tr_b16 v[64:65], v8 offset:0
    ds_read_b64_tr_b16 v[66:67], v8 offset:2048
    ds_read_b64_tr_b16 v[68:69], v8 offset:16384
    ds_read_b64_tr_b16 v[70:71], v8 offset:18432
    ds_read_b64_tr_b16 v[72:73], v8 offset:32768
    ds_read_b64_tr_b16 v[74:75], v8 offset:34816
    ds_read_b64_tr_b16 v[76:77], v8 offset:49152
    ds_read_b64_tr_b16 v[78:79], v8 offset:51200
    s_waitcnt lgkmcnt(0)
    ds_read_b64_tr_b16 v[80:81], v12 offset:0
    ds_read_b64_tr_b16 v[82:83], v12 offset:2048
    ds_read_b64_tr_b16 v[84:85], v12 offset:16384
    ds_read_b64_tr_b16 v[86:87], v12 offset:18432
    ds_read_b64_tr_b16 v[88:89], v12 offset:32768
    ds_read_b64_tr_b16 v[90:91], v12 offset:34816
    ds_read_b64_tr_b16 v[92:93], v12 offset:49152
    ds_read_b64_tr_b16 v[94:95], v12 offset:51200
    s_waitcnt lgkmcnt(0)
    s_cmp_lg_u32 s3, 0
    s_cbranch_scc1 ffn_w3
    v_lshlrev_b32 v23, 4, v1
    v_add_u32 v24, 1024, v23
    s_lshl_b32 s28, s20, 4
    s_add_u32 s28, s28, s34
    v_mov_b32 v10, 34828
    s_nop 4
ffn_p3:
    buffer_load_dword v11, v10, s[4:7], s28 offen sc1
    s_waitcnt vmcnt(0) lgkmcnt(0)
    v_cmp_ne_u32 vcc, s40, v11
    s_cbranch_vccnz ffn_p3_rt
ffn_p3_ok:
    s_mov_b32 s58, 0
    s_mov_b32 s54, -1
    s_nop 1
ffn_k3:
    buffer_load_dwordx4 v[200:203], v23, s[4:7], s34 offen sc1
    buffer_load_dwordx4 v[204:207], v24, s[4:7], s34 offen sc1
    s_waitcnt vmcnt(0)
    v_xor_b32 v208, s40, v203
    v_xor_b32 v209, s40, v207
    v_max_u32 v210, v200, v204
    v_or_b32 v208, v208, v209
    v_cmp_ne_u32 vcc, 0, v208
    s_cbranch_vccnz ffn_k3_rt
ffn_k3_ok:
    v_max_u32_dpp v210, v210, v210 quad_perm:[1,0,3,2] row_mask:0xf bank_mask:0xf
    s_nop 1
    v_max_u32_dpp v210, v210, v210 quad_perm:[2,3,0,1] row_mask:0xf bank_mask:0xf
    s_nop 1
    v_max_u32_dpp v210, v210, v210 row_half_mirror row_mask:0xf bank_mask:0xf
    s_nop 1
    v_max_u32_dpp v210, v210, v210 row_mirror row_mask:0xf bank_mask:0xf
    s_nop 1
    v_max_u32_dpp v210, v210, v210 row_bcast:15 row_mask:0xa bank_mask:0xf
    s_nop 1
    v_max_u32_dpp v210, v210, v210 row_bcast:31 row_mask:0xc bank_mask:0xf
    s_nop 0
    v_readlane_b32 s36, v210, 63
    s_nop 1
    v_cmp_eq_u32 vcc, s36, v200
    v_cmp_eq_u32 s[28:29], s36, v204
    s_nop 0
    s_cmp_lg_u64 vcc, 0
    s_cselect_b32 s39, 0, 64
    s_or_b64 vcc, vcc, s[28:29]
    s_ff1_i32_b64 s41, vcc
    s_add_u32 s39, s39, s41
    s_lshl_b32 s39, s39, 11
    s_add_u32 s39, s39, 0x448000
    s_mov_b32 s58, 0
ffn_c3:
    buffer_load_short_d16_hi v14, v16, s[4:7], s39 offen sc1
    buffer_load_short_d16_hi v15, v17, s[4:7], s39 offen sc1
ffn_c3d:
    v_and_b32 v10, 15, v201
    v_and_b32 v11, 15, v205
    v_cmp_eq_u32 s[24:25], s33, v10
    v_cmp_eq_u32 s[26:27], s33, v11
    s_nop 0
    v_mov_b32 v212, s24
    v_mov_b32 v213, s25
    v_mov_b32 v214, s26
    v_mov_b32 v215, s27
    v_cndmask_b32_e64 v209, v201, v205, s[28:29]
    v_cndmask_b32_e64 v210, v202, v206, s[28:29]
    ds_write_b128 v28, v[212:215] offset:16
    v_readlane_b32 s24, v209, s41
    v_readlane_b32 s25, v210, s41
    s_mov_b64 s[42:43], vcc
    s_and_b32 s24, s24, 0xffff0000
    s_mov_b32 s26, 0xffff0000
    s_waitcnt vmcnt(0)
    v_max_u32 v10, v14, v15
    v_add_f32 v14, s24, v14
    v_add_f32 v15, s24, v15
    v_cvt_pk_bf16_f32 v14, 0, v14
    v_cvt_pk_bf16_f32 v15, 0, v15
    v_mul_f32 v14, s25, v14
    v_mul_f32 v15, s25, v15
    v_cvt_pk_bf16_f32 v14, v14, v15
    ds_write_b32 v18, v14
    v_cmp_eq_u32 vcc, s26, v10
    s_cbranch_vccnz ffn_c3_rt
ffn_c3_ok:
    s_waitcnt lgkmcnt(0)
    s_nop 2
ffn_w3:
    s_barrier
    ds_read_b32 v203, v22
    ds_read_b128 v[128:131], v19 offset:0
    ds_read_b128 v[132:135], v19 offset:64
    ds_read_b128 v[136:139], v19 offset:128
    ds_read_b128 v[140:143], v19 offset:192
    s_waitcnt lgkmcnt(3)
    v_mfma_f32_16x16x32_bf16 v[192:195], v[32:35], v[128:131], 0
    v_mfma_f32_16x16x32_bf16 v[148:151], v[48:51], v[128:131], 0
    v_mfma_f32_16x16x32_bf16 v[152:155], v[64:67], v[128:131], 0
    v_mfma_f32_16x16x32_bf16 v[156:159], v[80:83], v[128:131], 0
    s_waitcnt lgkmcnt(2)
    v_mfma_f32_16x16x32_bf16 v[192:195], v[36:39], v[132:135], v[192:195]
    v_mfma_f32_16x16x32_bf16 v[148:151], v[52:55], v[132:135], v[148:151]
    v_mfma_f32_16x16x32_bf16 v[152:155], v[68:71], v[132:135], v[152:155]
    v_mfma_f32_16x16x32_bf16 v[156:159], v[84:87], v[132:135], v[156:159]
    s_waitcnt lgkmcnt(1)
    v_mfma_f32_16x16x32_bf16 v[192:195], v[40:43], v[136:139], v[192:195]
    v_mfma_f32_16x16x32_bf16 v[148:151], v[56:59], v[136:139], v[148:151]
    v_mfma_f32_16x16x32_bf16 v[152:155], v[72:75], v[136:139], v[152:155]
    v_mfma_f32_16x16x32_bf16 v[156:159], v[88:91], v[136:139], v[156:159]
    s_waitcnt lgkmcnt(0)
    v_mfma_f32_16x16x32_bf16 v[192:195], v[44:47], v[140:143], v[192:195]
    v_mfma_f32_16x16x32_bf16 v[148:151], v[60:63], v[140:143], v[148:151]
    v_mfma_f32_16x16x32_bf16 v[152:155], v[76:79], v[140:143], v[152:155]
    v_mfma_f32_16x16x32_bf16 v[156:159], v[92:95], v[140:143], v[156:159]
    v_readfirstlane_b32 s24, v203
    s_nop 4
    v_cndmask_b32_e64 v192, v192, v148, s[60:61]
    v_cndmask_b32_e64 v193, v193, v149, s[60:61]
    v_cndmask_b32_e64 v194, v194, v150, s[60:61]
    v_cndmask_b32_e64 v195, v195, v151, s[60:61]
    v_cndmask_b32_e64 v192, v192, v152, s[62:63]
    v_cndmask_b32_e64 v193, v193, v153, s[62:63]
    v_cndmask_b32_e64 v194, v194, v154, s[62:63]
    v_cndmask_b32_e64 v195, v195, v155, s[62:63]
    v_cndmask_b32_e64 v192, v192, v156, s[64:65]
    v_cndmask_b32_e64 v193, v193, v157, s[64:65]
    v_cndmask_b32_e64 v194, v194, v158, s[64:65]
    v_cndmask_b32_e64 v195, v195, v159, s[64:65]
    s_mov_b32 exec_lo, 0x000f000f
    s_mov_b32 exec_hi, 0x000f000f
    v_and_or_b32 v192, v192, v197, s48
    v_and_or_b32 v193, v193, v197, s49
    v_and_or_b32 v194, v194, v197, s50
    v_and_or_b32 v195, v195, v197, s51
    s_bitcmp1_b32 s24, s35
    s_cbranch_scc0 ffn_rem
    buffer_store_dwordx4 v[192:195], v30, s[4:7], s30 offen
ffn_fin:
    s_endpgm
ffn_rem:
    buffer_store_dwordx4 v[192:195], v30, s[4:7], s30 offen sc1
    s_branch ffn_fin
ffn_c3_rt:
    s_mov_b64 vcc, s[42:43]
    s_add_u32 s58, s58, 1
    s_cmp_lt_u32 s58, 0x10000
    s_cbranch_scc1 ffn_c3
    s_branch ffn_c3_ok
fz_h1_r0:
    s_add_u32 s58, s58, 1
    s_cmp_gt_u32 s58, 0x10000
    s_cbranch_scc1 fz_h1_o0
    buffer_load_dwordx4 v[104:107], v222, s[4:7], s60 offen sc1
    buffer_load_dwordx4 v[108:111], v222, s[4:7], s61 offen sc1
    buffer_load_dwordx4 v[112:115], v222, s[4:7], s16 offen sc1
    buffer_load_dwordx4 v[116:119], v222, s[4:7], s17 offen sc1
    s_branch fz_h1_c0
fz_h1_r1:
    s_add_u32 s58, s58, 1
    s_cmp_gt_u32 s58, 0x10000
    s_cbranch_scc1 fz_h1_o1
    buffer_load_dwordx4 v[108:111], v222, s[4:7], s61 offen sc1
    buffer_load_dwordx4 v[112:115], v222, s[4:7], s16 offen sc1
    buffer_load_dwordx4 v[116:119], v222, s[4:7], s17 offen sc1
    s_branch fz_h1_c1
fz_h1_r2:
    s_add_u32 s58, s58, 1
    s_cmp_gt_u32 s58, 0x10000
    s_cbranch_scc1 fz_h1_o2
    buffer_load_dwordx4 v[112:115], v222, s[4:7], s16 offen sc1
    buffer_load_dwordx4 v[116:119], v222, s[4:7], s17 offen sc1
    s_branch fz_h1_c2
fz_h1_r3:
    s_add_u32 s58, s58, 1
    s_cmp_gt_u32 s58, 0x10000
    s_cbranch_scc1 fz_h1_o3
    buffer_load_dwordx4 v[116:119], v222, s[4:7], s17 offen sc1
    s_branch fz_h1_c3
fz_h2_r0:
    s_add_u32 s58, s58, 1
    s_cmp_gt_u32 s58, 0x10000
    s_cbranch_scc1 fz_h2_o0
    buffer_load_dwordx2 v[104:105], v228, s[4:7], s52 offen sc1
    buffer_load_dwordx2 v[106:107], v228, s[4:7], s53 offen sc1
    buffer_load_dwordx2 v[108:109], v228, s[4:7], s54 offen sc1
    buffer_load_dwordx2 v[110:111], v228, s[4:7], s55 offen sc1
    s_branch fz_h2_c0
fz_h2_r1:
    s_add_u32 s58, s58, 1
    s_cmp_gt_u32 s58, 0x10000
    s_cbranch_scc1 fz_h2_o1
    buffer_load_dwordx2 v[106:107], v228, s[4:7], s53 offen sc1
    buffer_load_dwordx2 v[108:109], v228, s[4:7], s54 offen sc1
    buffer_load_dwordx2 v[110:111], v228, s[4:7], s55 offen sc1
    s_branch fz_h2_c1
fz_h2_r2:
    s_add_u32 s58, s58, 1
    s_cmp_gt_u32 s58, 0x10000
    s_cbranch_scc1 fz_h2_o2
    buffer_load_dwordx2 v[108:109], v228, s[4:7], s54 offen sc1
    buffer_load_dwordx2 v[110:111], v228, s[4:7], s55 offen sc1
    s_branch fz_h2_c2
fz_h2_r3:
    s_add_u32 s58, s58, 1
    s_cmp_gt_u32 s58, 0x10000
    s_cbranch_scc1 fz_h2_o3
    buffer_load_dwordx2 v[110:111], v228, s[4:7], s55 offen sc1
    s_branch fz_h2_c3
fz_h5_r0:
    s_add_u32 s58, s58, 1
    s_cmp_gt_u32 s58, 0x10000
    s_cbranch_scc1 fz_h5_o0
    buffer_load_dwordx4 v[40:43], v3, s[4:7], s52 offen sc1
    buffer_load_dwordx4 v[44:47], v3, s[4:7], s53 offen sc1
    buffer_load_dwordx4 v[48:51], v3, s[4:7], s54 offen sc1
    buffer_load_dwordx4 v[52:55], v6, s[4:7], s55 offen sc1
    s_branch fz_h5_c0
fz_h5_r1:
    s_add_u32 s58, s58, 1
    s_cmp_gt_u32 s58, 0x10000
    s_cbranch_scc1 fz_h5_o1
    buffer_load_dwordx4 v[44:47], v3, s[4:7], s53 offen sc1
    buffer_load_dwordx4 v[48:51], v3, s[4:7], s54 offen sc1
    buffer_load_dwordx4 v[52:55], v6, s[4:7], s55 offen sc1
    s_branch fz_h5_c1
fz_h5_r2:
    s_add_u32 s58, s58, 1
    s_cmp_gt_u32 s58, 0x10000
    s_cbranch_scc1 fz_h5_o2
    buffer_load_dwordx4 v[48:51], v3, s[4:7], s54 offen sc1
    buffer_load_dwordx4 v[52:55], v6, s[4:7], s55 offen sc1
    s_branch fz_h5_c2
fz_h5_r3:
    s_add_u32 s58, s58, 1
    s_cmp_gt_u32 s58, 0x10000
    s_cbranch_scc1 fz_h5_o3
    buffer_load_dwordx4 v[52:55], v6, s[4:7], s55 offen sc1
    s_branch fz_h5_c3
fz_p1_rt:
    s_add_u32 s58, s58, 1
    s_cmp_lt_u32 s58, 0x10000
    s_cbranch_scc1 fz_p1
    s_branch fz_p1_ok
fz_k2_rt:
    s_add_u32 s58, s58, 1
    s_cmp_lt_u32 s58, 0x10000
    s_cbranch_scc1 fz_k2
    s_branch fz_k2_ok
fz_c2_rt:
    s_add_u32 s58, s58, 1
    s_cmp_lt_u32 s58, 0x10000
    s_cbranch_scc1 fz_c2
    s_branch fz_c2_ok
fz_p5_rt:
    s_add_u32 s58, s58, 1
    s_cmp_lt_u32 s58, 0x10000
    s_cbranch_scc1 fz_p5
    s_branch fz_p5_ok
fz_k4_rt:
    s_add_u32 s58, s58, 1
    s_cmp_lt_u32 s58, 0x10000
    s_cbranch_scc1 fz_k4
    s_branch fz_k4_ok
fz_h4_rt:
    s_add_u32 s58, s58, 1
    s_cmp_lt_u32 s58, 0x10000
    s_cbranch_scc1 fz_h4
    s_branch fz_h4_ok
ffn_p3_rt:
    s_add_u32 s58, s58, 1
    s_cmp_lt_u32 s58, 0x10000
    s_cbranch_scc1 ffn_p3
    s_branch ffn_p3_ok
ffn_k3_rt:
    s_add_u32 s58, s58, 1
    s_cmp_lt_u32 s58, 0x10000
    s_cbranch_scc1 ffn_k3
    s_branch ffn_k3_ok
fz_codeend:
.section .rodata,"a"
.p2align 6
.amdhsa_kernel fz_kernel
  .amdhsa_next_free_vgpr 256
  .amdhsa_next_free_sgpr 102
  .amdhsa_accum_offset 256
  .amdhsa_group_segment_fixed_size 0
  .amdhsa_kernarg_size 104
  .amdhsa_user_sgpr_count 2
  .amdhsa_user_sgpr_kernarg_segment_ptr 1
  .amdhsa_system_sgpr_workgroup_id_x 1
.end_amdhsa_kernel
```

```asm
; @launch kernel=fz_kernel grid=(256,1,1) block=(512,1,1) lds=163840
.amdgcn_target "amdgcn-amd-amdhsa--gfx950"
.text
.globl fz_kernel
.p2align 8
.type fz_kernel,@function
fz_kernel:
    s_load_dwordx2 s[4:5], s[0:1], 96
    s_load_dwordx2 s[8:9], s[0:1], 0
    s_load_dwordx2 s[64:65], s[0:1], 72
    s_cmp_gt_u32 s2, 255
    s_cbranch_scc1 fz_end
    v_lshrrev_b32 v2, 6, v0
    v_and_b32 v1, 63, v0
    s_lshr_b32 s59, s2, 7
    v_readfirstlane_b32 s3, v2
    s_and_b32 s20, s2, 127
    s_cmp_lt_u32 s20, 8
    s_cselect_b32 s20, s3, 0
    s_cmp_lt_u32 s20, 4
    s_cbranch_scc1 fz_pfcback
    s_getpc_b64 s[20:21]
fz_pcb:
    s_sub_u32 s20, s20, fz_pcb-fz_kernel
    s_subb_u32 s21, s21, 0
    v_and_b32 v3, 255, v0
    v_lshlrev_b32 v3, 7, v3
    v_min_u32 v3, fz_codeend-fz_kernel-4, v3
    v_mov_b32 v5, s21
    v_add_co_u32 v4, vcc, s20, v3
    s_nop 1
    v_addc_co_u32 v5, vcc, 0, v5, vcc
    global_load_dword v251, v[4:5], off
fz_pfcback:
    s_cmp_lg_u32 s59, 0
    s_cbranch_scc1 fz_ldh
    s_load_dwordx2 s[12:13], s[0:1], 80
    s_load_dwordx2 s[16:17], s[0:1], 48
fz_ldback:
    s_add_u32 s20, s2, 58
    s_and_b32 s20, s20, 127
    s_lshr_b32 s21, s20, 3
    s_add_u32 s21, s21, 1
    s_and_b32 s22, s20, 7
    s_sub_u32 s23, s20, 124
    s_cmp_ge_u32 s20, 124
    s_cselect_b32 s21, 0, s21
    s_cselect_b32 s22, s23, s22
    s_lshr_b32 s57, s3, 2
    s_or_b32 s23, s57, s59
    s_and_b32 s24, s3, 3
    s_lshl_b32 s25, s22, 6
    s_add_u32 s25, s25, s21
    s_lshl_b32 s26, s23, 5
    s_add_u32 s26, s26, s25
    s_lshl_b32 s27, s24, 9
    s_add_u32 s28, s26, s27
    s_sub_u32 s27, 2048, s27
    s_sub_u32 s27, s27, s26
    s_lshl_b32 s29, s24, 1
    s_add_u32 s29, s29, s23
    s_sub_u32 s30, 15, s29
    s_cmp_lt_u32 s24, 2
    s_cselect_b32 s27, s28, s27
    s_cselect_b32 s31, s29, s30
    s_cselect_b32 s30, s30, s29
    s_sub_u32 s28, 2048, s27
    s_and_b32 s28, s28, 2047
    s_lshl_b32 s27, s27, 11
    s_lshl_b32 s28, s28, 11
    s_mul_i32 s31, s31, 2064
    s_mul_i32 s30, s30, 2064
    v_lshlrev_b32 v239, 4, v1
    s_mov_b32 s10, 0x400000
    s_mov_b32 s11, 0x00020000
    s_mov_b32 s6, 0x690000
    s_mov_b32 s7, 0x00020000
    s_mov_b32 s66, 0x700000
    s_mov_b32 s67, 0x00020000
    s_and_b32 s32, s57, s59
    s_add_u32 s36, s2, 4
    s_and_b32 s36, s36, 7
    s_bfe_u32 s37, s2, 0x10006
    s_lshl_b32 s63, s36, 1
    s_add_u32 s63, s63, s37
    s_cmp_lg_u32 s37, 0
    s_cselect_b32 s37, 8, s36
    s_add_u32 s37, s37, 6
    s_cmp_lt_u32 s36, 6
    s_cselect_b32 s63, s63, s37
    s_lshl_b32 s63, s63, 3
    s_bfe_u32 s37, s2, 0x30003
    s_add_u32 s63, s63, s37
    v_and_b32 v10, 15, v1
    v_lshlrev_b32 v10, 4, v10
    v_lshrrev_b32 v14, 4, v1
    v_lshl_add_u32 v14, v14, 11, v10
    s_lshl_b32 s62, s63, 16
    s_and_b32 s37, s3, 3
    s_lshl_b32 s37, s37, 9
    s_add_u32 s62, s62, s37
    s_mov_b32 s58, 0
    s_waitcnt lgkmcnt(0)
    s_cmp_eq_u32 s2, 66
    s_cbranch_scc1 fz_spec
fz_specback:
    s_cmp_lg_u32 s57, 0
    s_cbranch_scc1 fz_nox
    s_mov_b32 m0, s31
    s_nop 0
    buffer_load_dwordx4 v239, s[8:11], s27 offen nt lds
    buffer_load_dwordx4 v239, s[8:11], s27 offen offset:1024 nt lds
    s_mov_b32 m0, s30
    s_nop 0
    buffer_load_dwordx4 v239, s[8:11], s28 offen nt lds
    buffer_load_dwordx4 v239, s[8:11], s28 offen offset:1024 nt lds
fz_nox:
    buffer_load_dword v250, off, s[4:7], 0
    s_andn2_b32 s32, s57, s59
    s_cbranch_scc0 fz_nowe
    buffer_load_dwordx4 v[160:163], v14, s[64:67], s62 offen offset:0 nt
    buffer_load_dwordx4 v[164:167], v14, s[64:67], s62 offen offset:256 nt
    s_add_u32 s62, s62, 8192
    buffer_load_dwordx4 v[168:171], v14, s[64:67], s62 offen offset:0 nt
    buffer_load_dwordx4 v[172:175], v14, s[64:67], s62 offen offset:256 nt
    s_add_u32 s62, s62, 8192
fz_nowe:
    s_cmp_eq_u32 s57, 0
    s_cbranch_scc1 fz_np
    s_setprio 1
fz_np:
    v_and_b32 v2, 31, v1
    v_lshrrev_b32 v3, 5, v1
    v_and_b32 v4, 15, v1
    v_lshrrev_b32 v5, 4, v1
    v_add_u32 v6, 49536, v239
    v_lshrrev_b32 v10, 1, v2
    v_and_b32 v8, 9, v10
    v_and_b32 v11, 2, v10
    v_lshl_or_b32 v8, v11, 1, v8
    v_bfe_u32 v11, v10, 2, 1
    v_lshl_or_b32 v8, v11, 1, v8
    v_and_b32 v12, 1, v5
    v_cmp_eq_u32 vcc, 1, v12
    v_lshl_add_u32 v9, v4, 1, 1
    s_nop 0
    v_cndmask_b32_e64 v9, v9, 0, vcc
    s_cmp_lt_u32 s3, 5
    s_cselect_b64 s[32:33], -1, 0
    s_cmp_lt_u32 s3, 3
    s_cselect_b64 s[34:35], -1, 0
    v_cndmask_b32_e64 v9, v9, v2, s[32:33]
    v_cndmask_b32_e64 v8, v9, v8, s[34:35]
    s_mov_b32 s36, 0x3d000000
    s_cmp_gt_u32 s3, 4
    s_cselect_b32 s36, 0x3c800000, s36
    s_sub_u32 s37, s3, 1
    s_cmp_lt_u32 s37, 2
    s_cselect_b32 s36, 0x3a800000, s36
    s_cmp_eq_u32 s3, 0
    s_cselect_b32 s32, 16, 0
    s_cselect_b32 s33, 0x3e800000, 0
    s_cselect_b32 s34, 4.0, 0x41000000
    s_cselect_b32 s35, 0x41000000, 4.0
    v_cmp_eq_u32 vcc, 1, v2
    v_mov_b32 v10, s32
    s_nop 0
    v_cndmask_b32_e64 v10, 0, v10, vcc
    v_add_u32 v8, v8, v10
    v_cvt_f32_u32 v8, v8
    v_mul_f32 v8, s36, v8
    s_cmp_eq_u32 s3, 2
    s_cselect_b32 s32, 0x80000000, 0
    v_lshlrev_b32 v10, 31, v2
    v_and_b32 v10, s32, v10
    v_xor_b32 v8, v10, v8
    v_and_b32 v10, 1, v2
    v_cvt_f32_u32 v10, v10
    v_mul_f32 v10, s33, v10
    s_cmp_eq_u32 s3, 1
    s_cselect_b32 s33, 0x3e800000, 0
    v_mov_b32 v11, s33
    v_cndmask_b32_e64 v10, v10, v11, vcc
    s_cmp_eq_u32 s3, 5
    s_cselect_b32 s33, 0x3e800000, 0
    v_cvt_f32_u32 v12, v12
    v_fma_f32 v10, v12, s33, v10
    s_cmp_eq_u32 s3, 6
    s_cselect_b32 s33, 0x3e800000, 0
    s_cmp_eq_u32 s3, 2
    s_cselect_b32 s33, 0xbe800000, s33
    s_cmp_eq_u32 s3, 4
    s_cselect_b32 s33, 0xbe800000, s33
    v_add_f32 v10, s33, v10
    v_cvt_f32_u32 v11, v3
    v_mul_f32 v11, s35, v11
    v_fma_f32 v9, v8, v11, v10
    v_mul_f32 v10, s34, v8
    v_mul_f32 v11, 0x41800000, v8
    v_mov_b32 v104, v9
    v_fmamk_f32 v105, v8, 0x3f800000, v9
    v_fmamk_f32 v106, v8, 0x40000000, v9
    v_fmamk_f32 v107, v8, 0x40400000, v9
    v_add_f32 v108, v104, v10
    v_add_f32 v109, v105, v10
    v_add_f32 v110, v106, v10
    v_add_f32 v111, v107, v10
    v_add_f32 v112, v104, v11
    v_add_f32 v113, v105, v11
    v_add_f32 v114, v106, v11
    v_add_f32 v115, v107, v11
    v_add_f32 v116, v108, v11
    v_add_f32 v117, v109, v11
    v_add_f32 v118, v110, v11
    v_add_f32 v119, v111, v11
    v_cos_f32 v104, v104
    v_cos_f32 v105, v105
    v_cos_f32 v106, v106
    v_cos_f32 v107, v107
    v_cos_f32 v108, v108
    v_cos_f32 v109, v109
    v_cos_f32 v110, v110
    v_cos_f32 v111, v111
    v_cos_f32 v112, v112
    v_cos_f32 v113, v113
    v_cos_f32 v114, v114
    v_cos_f32 v115, v115
    v_cos_f32 v116, v116
    v_cos_f32 v117, v117
    v_cos_f32 v118, v118
    v_cos_f32 v119, v119
    s_lshl_b32 s32, s3, 11
    v_add_u32 v8, s32, v6
    s_cmp_eq_u32 s3, 0
    s_cbranch_scc1 fz_jb
    v_cvt_pk_f16_f32 v128, v104, v105
    v_cvt_pk_f16_f32 v129, v106, v107
    v_cvt_pk_f16_f32 v130, v108, v109
    v_cvt_pk_f16_f32 v131, v110, v111
    v_cvt_pk_f16_f32 v132, v112, v113
    v_cvt_pk_f16_f32 v133, v114, v115
    v_cvt_pk_f16_f32 v134, v116, v117
    v_cvt_pk_f16_f32 v135, v118, v119
fz_jend:
    ds_write_b128 v8, v[128:131] offset:0
    ds_write_b128 v8, v[132:135] offset:1024
    v_mov_b32 v15, 49520
    v_mov_b32 v10, 0
    v_mov_b32 v11, 0
    ds_write_b64 v15, v[10:11]
    ds_write_b32 v15, v10 offset:8
    s_waitcnt lgkmcnt(0)
    s_barrier
    v_lshlrev_b32 v240, 31, v1
    v_lshrrev_b32 v10, 16, v240
    v_or_b32 v240, v240, v10
    v_mov_b32 v229, 0xfffcfffc
    v_mov_b32 v242, 0xffff0000
    s_mov_b32 s42, 0x3f803f80
    s_cmp_lg_u32 s57, 0
    s_cbranch_scc1 fz_nc1
    ds_read_b128 v[16:19], v6 offset:0
    ds_read_b128 v[20:23], v6 offset:1024
    ds_read_b128 v[24:27], v6 offset:2048
    ds_read_b128 v[28:31], v6 offset:3072
    ds_read_b128 v[32:35], v6 offset:4096
    ds_read_b128 v[36:39], v6 offset:5120
    ds_read_b128 v[40:43], v6 offset:6144
    ds_read_b128 v[44:47], v6 offset:7168
    ds_read_b128 v[48:51], v6 offset:8192
    ds_read_b128 v[52:55], v6 offset:9216
    ds_read_b128 v[56:59], v6 offset:10240
    ds_read_b128 v[60:63], v6 offset:11264
    ds_read_b128 v[64:67], v6 offset:12288
    ds_read_b128 v[68:71], v6 offset:13312
    v_lshlrev_b32 v7, 9, v3
    v_bfe_u32 v10, v1, 2, 2
    v_lshl_add_u32 v7, v10, 6, v7
    v_and_b32 v10, 1, v5
    v_lshl_add_u32 v7, v10, 5, v7
    v_and_b32 v10, 3, v1
    v_lshl_add_u32 v7, v10, 3, v7
    v_add_u32 v7, s31, v7
    v_lshlrev_b32 v8, 9, v3
    v_lshl_add_u32 v8, v2, 1, v8
    v_sub_u32 v9, 2048, v8
    v_and_b32 v9, 2047, v9
    v_add_u32 v9, s30, v9
    s_add_u32 s32, s30, 576
    v_sub_u32 v8, s32, v8
    v_cmp_eq_u32 vcc, 0, v2
    s_nop 1
    v_cndmask_b32_e64 v234, 0, -2.0, vcc
    v_mov_b32 v235, 0x3b27c5ac
    s_lshr_b32 s32, s24, 1
    s_lshl_b32 s32, s32, 6
    s_mul_i32 s33, s3, 2304
    s_add_u32 s32, s32, s33
    s_add_u32 s32, s32, 67968
    v_lshl_add_u32 v10, v3, 1, v1
    v_lshlrev_b32 v10, 4, v10
    v_add_u32 v216, s32, v10
    v_bfe_u32 v10, v0, 2, 1
    v_mul_u32_u24 v10, 34, v10
    v_lshrrev_b32 v11, 4, v0
    v_add_u32 v10, v10, v11
    v_lshlrev_b32 v10, 4, v10
    v_bfe_u32 v11, v0, 3, 1
    v_lshl_add_u32 v10, v11, 3, v10
    v_bfe_u32 v11, v0, 1, 1
    v_lshl_add_u32 v10, v11, 2, v10
    v_and_b32 v12, 1, v0
    s_mov_b32 s33, 9216
    s_cmp_eq_u32 s2, 66
    s_cselect_b32 s32, s33, 0x1b40
    v_mul_lo_u32 v11, v12, s32
    v_add_u32 v217, v10, v11
    v_add_u32 v217, 67968, v217
    s_cselect_b32 s32, s33, 0x940
    v_mul_lo_u32 v11, v12, s32
    v_add_u32 v218, v10, v11
    v_add_u32 v218, 70272, v218
    s_cselect_b32 s32, s33, 0xfffff6c0
    v_mul_lo_u32 v11, v12, s32
    v_add_u32 v219, v10, v11
    v_add_u32 v219, 73792, v219
    s_cselect_b32 s32, s33, 0xffffe4c0
    v_mul_lo_u32 v11, v12, s32
    v_add_u32 v220, v10, v11
    v_add_u32 v220, 76096, v220
    v_lshrrev_b32 v10, 2, v0
    v_and_b32 v11, 3, v0
    v_lshlrev_b32 v11, 4, v11
    v_lshl_add_u32 v221, v10, 7, v11
    s_mul_i32 s52, s20, 16512
    s_lshl_b32 s33, s59, 6
    s_add_u32 s52, s52, s33
    s_add_u32 s52, s52, 0x1000
    s_add_u32 s53, s52, 8192
    v_mov_b32 v160, 0
    v_mov_b32 v161, 0
    v_mov_b32 v162, 0
    v_mov_b32 v163, 0
    s_setprio 3
    s_waitcnt vmcnt(0) lgkmcnt(0)
    ds_read_b64_tr_b16 v[88:89], v7 offset:0
    ds_read_b64_tr_b16 v[90:91], v7 offset:256
    ds_read_b64_tr_b16 v[92:93], v7 offset:1024
    ds_read_b64_tr_b16 v[94:95], v7 offset:1280
    ds_read_u16_d16 v96, v9
    ds_read_u16_d16_hi v136, v8 offset:1408
    ds_read_u16_d16 v97, v8 offset:1344
    ds_read_u16_d16_hi v137, v8 offset:1280
    ds_read_u16_d16 v98, v8 offset:1216
    ds_read_u16_d16_hi v138, v8 offset:1152
    ds_read_u16_d16 v99, v8 offset:1088
    ds_read_u16_d16_hi v139, v8 offset:1024
    s_waitcnt lgkmcnt(8)
    v_mfma_f32_32x32x16_bf16 v[104:119], v[88:91], v[16:19], 0
    v_mfma_f32_32x32x16_bf16 v[104:119], v[92:95], v[20:23], v[104:119]
    ds_read_u16_d16 v100, v8 offset:448
    ds_read_u16_d16_hi v140, v8 offset:384
    ds_read_u16_d16 v101, v8 offset:320
    ds_read_u16_d16_hi v141, v8 offset:256
    ds_read_u16_d16 v102, v8 offset:192
    ds_read_u16_d16_hi v142, v8 offset:128
    ds_read_u16_d16 v103, v8 offset:64
    ds_read_u16_d16_hi v143, v8 offset:0
    v_dot2_f32_bf16 v160, v88, s42, v160
    v_dot2_f32_bf16 v161, v88, v88, v161
    v_dot2_f32_bf16 v160, v89, s42, v160
    v_dot2_f32_bf16 v161, v89, v89, v161
    v_dot2_f32_bf16 v160, v90, s42, v160
    v_dot2_f32_bf16 v161, v90, v90, v161
    v_dot2_f32_bf16 v160, v91, s42, v160
    v_dot2_f32_bf16 v161, v91, v91, v161
    v_dot2_f32_bf16 v160, v92, s42, v160
    v_dot2_f32_bf16 v161, v92, v92, v161
    v_dot2_f32_bf16 v160, v93, s42, v160
    v_dot2_f32_bf16 v161, v93, v93, v161
    v_dot2_f32_bf16 v160, v94, s42, v160
    v_dot2_f32_bf16 v161, v94, v94, v161
    v_dot2_f32_bf16 v160, v95, s42, v160
    v_dot2_f32_bf16 v161, v95, v95, v161
    s_waitcnt lgkmcnt(0)
    v_or_b32 v96, v96, v136
    v_or_b32 v97, v97, v137
    v_or_b32 v98, v98, v138
    v_or_b32 v99, v99, v139
    v_or_b32 v100, v100, v140
    v_or_b32 v101, v101, v141
    v_or_b32 v102, v102, v142
    v_or_b32 v103, v103, v143
    v_mfma_f32_32x32x16_bf16 v[120:135], v[96:99], v[16:19], 0
    s_nop 0
    v_mfma_f32_32x32x16_bf16 v[120:135], v[100:103], v[20:23], v[120:135]
    v_dot2_f32_bf16 v162, v96, s42, v162
    v_dot2_f32_bf16 v163, v96, v96, v163
    v_dot2_f32_bf16 v162, v97, s42, v162
    v_dot2_f32_bf16 v163, v97, v97, v163
    v_dot2_f32_bf16 v162, v98, s42, v162
    v_dot2_f32_bf16 v163, v98, v98, v163
    v_dot2_f32_bf16 v162, v99, s42, v162
    v_dot2_f32_bf16 v163, v99, v99, v163
    v_dot2_f32_bf16 v162, v100, s42, v162
    v_dot2_f32_bf16 v163, v100, v100, v163
    v_dot2_f32_bf16 v162, v101, s42, v162
    v_dot2_f32_bf16 v163, v101, v101, v163
    v_dot2_f32_bf16 v162, v102, s42, v162
    v_dot2_f32_bf16 v163, v102, v102, v163
    v_dot2_f32_bf16 v162, v103, s42, v162
    v_dot2_f32_bf16 v163, v103, v103, v163
    s_nop 1
    v_permlane32_swap_b32 v160, v162
    v_permlane32_swap_b32 v161, v163
    v_add_f32 v160, v160, v162
    v_add_f32 v161, v161, v163
    s_nop 1
    v_permlane16_swap_b32 v160, v161
    v_add_f32 v160, v160, v161
    s_nop 1
    v_add_f32_dpp v160, v160, v160 quad_perm:[1,0,3,2] row_mask:0xf bank_mask:0xf
    s_nop 1
    v_add_f32_dpp v160, v160, v160 quad_perm:[2,3,0,1] row_mask:0xf bank_mask:0xf
    s_nop 1
    v_add_f32_dpp v160, v160, v160 row_half_mirror row_mask:0xf bank_mask:0xf
    s_nop 1
    v_add_f32_dpp v160, v160, v160 row_mirror row_mask:0xf bank_mask:0xf
    s_mov_b32 s43, 0x3e800000
    v_mov_b32 v161, v160
    s_nop 1
    v_permlane16_swap_b32 v160, v161
    v_mul_f32 v160, 0x3c800000, v160
    v_fma_f32 v161, v161, s43, v235
    v_fma_f32 v161, -v160, v160, v161
    v_rsq_f32 v161, v161
    s_nop 0
    v_mul_f32 v160, v160, v161
    v_readlane_b32 s32, v161, 0
    v_readlane_b32 s34, v161, 32
    v_readlane_b32 s36, v160, 0
    v_readlane_b32 s37, v160, 32
    s_nop 0
    v_mul_f32 v164, s36, v234
    v_fmac_f32 v164, s37, v234
    v_pk_fma_f32 v[104:105], v[104:105], s[32:33], v[164:165] op_sel_hi:[1,0,0]
    v_pk_fma_f32 v[106:107], v[106:107], s[32:33], v[164:165] op_sel_hi:[1,0,0]
    v_pk_fma_f32 v[108:109], v[108:109], s[32:33], v[164:165] op_sel_hi:[1,0,0]
    v_pk_fma_f32 v[110:111], v[110:111], s[32:33], v[164:165] op_sel_hi:[1,0,0]
    v_pk_fma_f32 v[112:113], v[112:113], s[32:33], v[164:165] op_sel_hi:[1,0,0]
    v_pk_fma_f32 v[114:115], v[114:115], s[32:33], v[164:165] op_sel_hi:[1,0,0]
    v_pk_fma_f32 v[116:117], v[116:117], s[32:33], v[164:165] op_sel_hi:[1,0,0]
    v_pk_fma_f32 v[118:119], v[118:119], s[32:33], v[164:165] op_sel_hi:[1,0,0]
    v_pk_fma_f32 v[104:105], v[120:121], s[34:35], v[104:105] op_sel_hi:[1,0,1]
    v_pk_fma_f32 v[106:107], v[122:123], s[34:35], v[106:107] op_sel_hi:[1,0,1]
    v_pk_fma_f32 v[108:109], v[124:125], s[34:35], v[108:109] op_sel_hi:[1,0,1]
    v_pk_fma_f32 v[110:111], v[126:127], s[34:35], v[110:111] op_sel_hi:[1,0,1]
    v_pk_fma_f32 v[112:113], v[128:129], s[34:35], v[112:113] op_sel_hi:[1,0,1]
    v_pk_fma_f32 v[114:115], v[130:131], s[34:35], v[114:115] op_sel_hi:[1,0,1]
    v_pk_fma_f32 v[116:117], v[132:133], s[34:35], v[116:117] op_sel_hi:[1,0,1]
    v_pk_fma_f32 v[118:119], v[134:135], s[34:35], v[118:119] op_sel_hi:[1,0,1]
    v_cvt_pk_f16_f32 v136, v104, v105
    v_cvt_pk_f16_f32 v137, v106, v107
    v_cvt_pk_f16_f32 v138, v108, v109
    v_cvt_pk_f16_f32 v139, v110, v111
    v_cvt_pk_f16_f32 v140, v112, v113
    v_cvt_pk_f16_f32 v141, v114, v115
    v_cvt_pk_f16_f32 v142, v116, v117
    v_cvt_pk_f16_f32 v143, v118, v119
    v_mov_b32_dpp v152, v136 quad_perm:[1,0,3,2] row_mask:0xf bank_mask:0xf
    v_mov_b32_dpp v153, v137 quad_perm:[1,0,3,2] row_mask:0xf bank_mask:0xf
    v_mov_b32_dpp v154, v138 quad_perm:[1,0,3,2] row_mask:0xf bank_mask:0xf
    v_mov_b32_dpp v155, v139 quad_perm:[1,0,3,2] row_mask:0xf bank_mask:0xf
    v_mov_b32_dpp v156, v140 quad_perm:[1,0,3,2] row_mask:0xf bank_mask:0xf
    v_mov_b32_dpp v157, v141 quad_perm:[1,0,3,2] row_mask:0xf bank_mask:0xf
    v_mov_b32_dpp v158, v142 quad_perm:[1,0,3,2] row_mask:0xf bank_mask:0xf
    v_mov_b32_dpp v159, v143 quad_perm:[1,0,3,2] row_mask:0xf bank_mask:0xf
    v_pk_mul_f16 v144, v136, v24
    v_pk_mul_f16 v145, v137, v25
    v_pk_mul_f16 v146, v138, v26
    v_pk_mul_f16 v147, v139, v27
    v_pk_mul_f16 v148, v140, v28
    v_pk_mul_f16 v149, v141, v29
    v_pk_mul_f16 v150, v142, v30
    v_pk_mul_f16 v151, v143, v31
    v_mfma_f32_16x16x32_f16 v[120:123], v[136:139], v[56:59], 0
    v_pk_fma_f16 v144, v152, v32, v144
    v_pk_fma_f16 v145, v153, v33, v145
    v_pk_fma_f16 v146, v154, v34, v146
    v_pk_fma_f16 v147, v155, v35, v147
    v_mfma_f32_16x16x32_f16 v[120:123], v[140:143], v[60:63], v[120:123]
    v_pk_fma_f16 v148, v156, v36, v148
    v_pk_fma_f16 v149, v157, v37, v149
    v_pk_fma_f16 v150, v158, v38, v150
    v_pk_fma_f16 v151, v159, v39, v151
    v_mfma_f32_32x32x16_f16 v[104:119], v[144:147], v[40:43], 0
    v_xor_b32_dpp v152, v144, v240 quad_perm:[1,0,3,2] row_mask:0xf bank_mask:0xf
    v_xor_b32_dpp v153, v145, v240 quad_perm:[1,0,3,2] row_mask:0xf bank_mask:0xf
    v_xor_b32_dpp v154, v146, v240 quad_perm:[1,0,3,2] row_mask:0xf bank_mask:0xf
    v_xor_b32_dpp v155, v147, v240 quad_perm:[1,0,3,2] row_mask:0xf bank_mask:0xf
    v_mfma_f32_32x32x16_f16 v[104:119], v[148:151], v[44:47], v[104:119]
    v_xor_b32_dpp v156, v148, v240 quad_perm:[1,0,3,2] row_mask:0xf bank_mask:0xf
    v_xor_b32_dpp v157, v149, v240 quad_perm:[1,0,3,2] row_mask:0xf bank_mask:0xf
    v_xor_b32_dpp v158, v150, v240 quad_perm:[1,0,3,2] row_mask:0xf bank_mask:0xf
    v_xor_b32_dpp v159, v151, v240 quad_perm:[1,0,3,2] row_mask:0xf bank_mask:0xf
    v_mfma_f32_32x32x16_f16 v[104:119], v[152:155], v[48:51], v[104:119]
    s_nop 0
    v_mfma_f32_32x32x16_f16 v[104:119], v[156:159], v[52:55], v[104:119]
    v_mfma_f32_16x16x32_f16 v[124:127], v[136:139], v[64:67], 0
    v_mfma_f32_16x16x32_f16 v[124:127], v[140:143], v[68:71], v[124:127]
    v_readfirstlane_b32 s40, v250
    s_nop 1
    s_add_u32 s40, s40, 1
    s_and_b32 s38, s40, 3
    s_and_b32 s39, s40, 15
    s_bfe_u32 s41, s40, 0x20002
    s_lshl_b32 s41, s41, 16
    s_or_b32 s44, s38, s41
    s_bfe_u32 s41, s40, 0x40004
    s_lshl_b32 s41, s41, 4
    s_or_b32 s48, s39, s41
    s_bfe_u32 s41, s40, 0x20004
    s_lshl_b32 s41, s41, 16
    s_or_b32 s45, s38, s41
    s_bfe_u32 s41, s40, 0x40008
    s_lshl_b32 s41, s41, 4
    s_or_b32 s49, s39, s41
    s_bfe_u32 s41, s40, 0x20006
    s_lshl_b32 s41, s41, 16
    s_or_b32 s46, s38, s41
    s_bfe_u32 s41, s40, 0x4000c
    s_lshl_b32 s41, s41, 4
    s_or_b32 s50, s39, s41
    s_bfe_u32 s41, s40, 0x20008
    s_lshl_b32 s41, s41, 16
    s_or_b32 s47, s38, s41
    s_bfe_u32 s41, s40, 0x40010
    s_lshl_b32 s41, s41, 4
    s_or_b32 s51, s39, s41
    s_mov_b32 s38, 0x404
    s_cmp_eq_u32 s2, 66
    s_cselect_b32 s39, 8, 4
    s_cselect_b32 s38, 8, s38
    s_mov_b64 vcc, 0xffff
    v_cvt_pk_f16_f32 v143, v118, v119
    v_cvt_pk_f16_f32 v142, v116, v117
    v_cvt_pk_f16_f32 v141, v114, v115
    v_cvt_pk_f16_f32 v140, v112, v113
    v_cvt_pk_f16_f32 v139, v110, v111
    v_cvt_pk_f16_f32 v138, v108, v109
    v_cvt_pk_f16_f32 v137, v106, v107
    v_cndmask_b32_e64 v104, v104, v121, vcc
    v_cndmask_b32_e64 v105, v105, v125, vcc
    v_pk_add_f16 v147, v142, v143 op_sel:[0,1] op_sel_hi:[1,0] neg_lo:[0,1]
    v_pk_add_f16 v151, v142, v143 op_sel:[0,1] op_sel_hi:[1,0] neg_hi:[1,0]
    v_pk_add_f16 v146, v140, v141 op_sel:[0,1] op_sel_hi:[1,0] neg_lo:[0,1]
    v_pk_add_f16 v150, v140, v141 op_sel:[0,1] op_sel_hi:[1,0] neg_hi:[1,0]
    v_pk_add_f16 v145, v138, v139 op_sel:[0,1] op_sel_hi:[1,0] neg_lo:[0,1]
    v_pk_add_f16 v149, v138, v139 op_sel:[0,1] op_sel_hi:[1,0] neg_hi:[1,0]
    v_cvt_pk_f16_f32 v136, v104, v105
    v_pk_add_f16 v144, v136, v137 op_sel:[0,1] op_sel_hi:[1,0] neg_lo:[0,1]
    v_pk_add_f16 v148, v136, v137 op_sel:[0,1] op_sel_hi:[1,0] neg_hi:[1,0]
    ds_write_b128 v216, v[144:147]
    ds_write_b128 v216, v[148:151] offset:1152
    s_waitcnt lgkmcnt(0)
    v_mov_b32 v10, 1
    s_mov_b64 exec, 1
    ds_add_u32 v15, v10
    s_mov_b64 exec, -1
    s_cmp_gt_u32 s3, 3
    s_cbranch_scc1 fz_bsp0
fz_sy:
    ds_read_b32 v10, v15
    s_waitcnt lgkmcnt(0)
    v_and_b32 v10, 0xff, v10
    v_cmp_ne_u32 vcc, s39, v10
    s_cbranch_vccnz fz_sy
    ds_read_b32 v104, v217 offset:0
    ds_read_b32 v105, v218 offset:0
    ds_read_b32 v106, v219 offset:0
    ds_read_b32 v107, v220 offset:0
    ds_read_b32 v108, v217 offset:256
    ds_read_b32 v109, v218 offset:256
    ds_read_b32 v110, v219 offset:256
    ds_read_b32 v111, v220 offset:256
    s_waitcnt lgkmcnt(4)
    v_pk_add_f16 v112, v104, v106
    v_pk_add_f16 v114, v105, v107
    v_pk_add_f16 v113, v104, v106 neg_lo:[0,1] neg_hi:[0,1]
    v_pk_add_f16 v115, v105, v107 neg_lo:[0,1] neg_hi:[0,1]
    v_pk_add_f16 v116, v112, v114
    v_pk_add_f16 v118, v112, v114 neg_lo:[0,1] neg_hi:[0,1]
    v_pk_add_f16 v117, v113, v115 op_sel:[0,1] op_sel_hi:[1,0] neg_hi:[0,1]
    v_pk_add_f16 v119, v113, v115 op_sel:[0,1] op_sel_hi:[1,0] neg_lo:[0,1]
    v_add_u32 v116, 0x20002, v116
    v_add_u32 v117, 0x20002, v117
    v_add_u32 v118, 0x20002, v118
    v_add_u32 v119, 0x20002, v119
    v_and_or_b32 v116, v116, v229, s44
    v_and_or_b32 v117, v117, v229, s45
    v_and_or_b32 v118, v118, v229, s46
    v_and_or_b32 v119, v119, v229, s47
    buffer_store_dwordx4 v[116:119], v221, s[4:7], s52 offen sc1
    s_waitcnt lgkmcnt(0)
    v_pk_add_f16 v120, v108, v110
    v_pk_add_f16 v122, v109, v111
    v_pk_add_f16 v121, v108, v110 neg_lo:[0,1] neg_hi:[0,1]
    v_pk_add_f16 v123, v109, v111 neg_lo:[0,1] neg_hi:[0,1]
    v_pk_add_f16 v124, v120, v122
    v_pk_add_f16 v126, v120, v122 neg_lo:[0,1] neg_hi:[0,1]
    v_pk_add_f16 v125, v121, v123 op_sel:[0,1] op_sel_hi:[1,0] neg_hi:[0,1]
    v_pk_add_f16 v127, v121, v123 op_sel:[0,1] op_sel_hi:[1,0] neg_lo:[0,1]
    v_add_u32 v124, 0x20002, v124
    v_add_u32 v125, 0x20002, v125
    v_add_u32 v126, 0x20002, v126
    v_add_u32 v127, 0x20002, v127
    v_and_or_b32 v124, v124, v229, s44
    v_and_or_b32 v125, v125, v229, s45
    v_and_or_b32 v126, v126, v229, s46
    v_and_or_b32 v127, v127, v229, s47
    buffer_store_dwordx4 v[124:127], v221, s[4:7], s53 offen sc1
    s_cmp_lg_u32 s59, 0
    s_cbranch_scc1 ffn
    s_and_b32 s32, s3, 3
    s_lshr_b32 s33, s3, 2
    s_lshl_b32 s33, s33, 4
    s_add_u32 s33, s33, s32
    v_and_b32 v8, 12, v4
    v_bfe_u32 v9, v4, 1, 1
    v_lshl_add_u32 v8, v9, 5, v8
    v_add_u32 v8, s33, v8
    v_cvt_f32_u32 v8, v8
    v_and_b32 v12, 1, v1
    v_cvt_f32_u32 v9, v12
    v_lshlrev_b32 v13, 2, v5
    v_cvt_f32_u32 v10, v13
    v_mul_f32 v11, 0x3c800000, v8
    v_mul_f32 v9, 0x3e800000, v9
    v_fma_f32 v9, v11, v10, v9
    v_mov_b32 v128, v9
    v_fmamk_f32 v129, v11, 0x3f800000, v9
    v_fmamk_f32 v130, v11, 0x40000000, v9
    v_fmamk_f32 v131, v11, 0x40400000, v9
    v_mul_f32 v11, 0x3a000000, v8
    v_lshlrev_b32 v9, 31, v1
    v_xor_b32 v11, v9, v11
    v_mul_f32 v9, v11, v10
    v_mov_b32 v112, v9
    v_fmamk_f32 v113, v11, 0x3f800000, v9
    v_fmamk_f32 v114, v11, 0x40000000, v9
    v_fmamk_f32 v115, v11, 0x40400000, v9
    v_fmamk_f32 v116, v11, 0x41800000, v9
    v_fmamk_f32 v117, v11, 0x41880000, v9
    v_fmamk_f32 v118, v11, 0x41900000, v9
    v_fmamk_f32 v119, v11, 0x41980000, v9
    v_cos_f32 v104, v128
    v_sin_f32 v105, v128
    v_cos_f32 v106, v129
    v_sin_f32 v107, v129
    v_cos_f32 v108, v130
    v_sin_f32 v109, v130
    v_cos_f32 v110, v131
    v_sin_f32 v111, v131
    v_sin_f32 v120, v112
    v_sin_f32 v121, v113
    v_sin_f32 v122, v114
    v_sin_f32 v123, v115
    v_sin_f32 v124, v116
    v_sin_f32 v125, v117
    v_sin_f32 v126, v118
    v_sin_f32 v127, v119
    v_cos_f32 v112, v112
    v_cos_f32 v113, v113
    v_cos_f32 v114, v114
    v_cos_f32 v115, v115
    v_cos_f32 v116, v116
    v_cos_f32 v117, v117
    v_cos_f32 v118, v118
    v_cos_f32 v119, v119
    v_cvt_pk_f16_f32 v16, v104, v105
    v_cvt_pk_f16_f32 v17, v106, v107
    v_cvt_pk_f16_f32 v18, v108, v109
    v_cvt_pk_f16_f32 v19, v110, v111
    v_cvt_pk_f16_f32 v20, v112, v113
    v_cvt_pk_f16_f32 v21, v114, v115
    v_cvt_pk_f16_f32 v22, v116, v117
    v_cvt_pk_f16_f32 v23, v118, v119
    v_cvt_pk_f16_f32 v24, v120, v121
    v_cvt_pk_f16_f32 v25, v122, v123
    v_cvt_pk_f16_f32 v26, v124, v125
    v_cvt_pk_f16_f32 v27, v126, v127
    v_lshrrev_b32 v8, 3, v1
    v_mul_u32_u24 v222, 16512, v8
    v_and_b32 v9, 7, v1
    v_lshl_add_u32 v222, v9, 4, v222
    s_mul_i32 s60, s3, 528384
    s_lshl_b32 s32, s20, 7
    s_add_u32 s60, s60, s32
    s_add_u32 s60, s60, 0x1000
    s_add_u32 s61, s60, 132096
    s_add_u32 s16, s60, 264192
    s_add_u32 s17, s60, 396288
    v_lshlrev_b32 v8, 1, v8
    v_bfe_u32 v9, v1, 2, 1
    v_add_u32 v8, v8, v9
    s_lshl_b32 s32, s3, 2
    s_add_u32 s32, s32, 1
    v_lshl_add_u32 v8, v8, 5, s32
    v_cmp_eq_u32 vcc, 1, v12
    v_bfe_u32 v9, v1, 1, 1
    v_mul_u32_u24 v9, 8256, v9
    v_add_u32 v9, 86400, v9
    s_cmp_eq_u32 s3, 3
    s_cselect_b32 s32, 272, 0
    v_sub_u32 v10, 512, v8
    v_cndmask_b32_e64 v10, v8, v10, vcc
    v_and_b32 v11, 16, v10
    v_lshl_add_u32 v11, v11, 6, v9
    v_lshrrev_b32 v12, 7, v10
    v_lshl_add_u32 v11, v12, 8, v11
    v_and_b32 v12, 15, v10
    v_lshl_add_u32 v11, v12, 4, v11
    v_bfe_u32 v12, v10, 5, 2
    v_lshl_add_u32 v223, v12, 2, v11
    v_add_u32 v8, 1, v8
    v_sub_u32 v10, 512, v8
    v_cndmask_b32_e64 v10, v8, v10, vcc
    v_and_b32 v11, 16, v10
    v_lshl_add_u32 v11, v11, 6, v9
    v_lshrrev_b32 v12, 7, v10
    v_lshl_add_u32 v11, v12, 8, v11
    v_and_b32 v12, 15, v10
    v_lshl_add_u32 v11, v12, 4, v11
    v_bfe_u32 v12, v10, 5, 2
    v_lshl_add_u32 v224, v12, 2, v11
    v_add_u32 v8, 1, v8
    v_sub_u32 v10, 512, v8
    v_cndmask_b32_e64 v10, v8, v10, vcc
    v_and_b32 v11, 16, v10
    v_lshl_add_u32 v11, v11, 6, v9
    v_lshrrev_b32 v12, 7, v10
    v_lshl_add_u32 v11, v12, 8, v11
    v_and_b32 v12, 15, v10
    v_lshl_add_u32 v11, v12, 4, v11
    v_bfe_u32 v12, v10, 5, 2
    v_lshl_add_u32 v100, v12, 2, v11
    v_mul_u32_u24 v10, s32, v3
    v_sub_u32 v8, v8, v10
    v_add_u32 v8, 1, v8
    v_sub_u32 v10, 512, v8
    v_cndmask_b32_e64 v10, v8, v10, vcc
    v_lshrrev_b32 v11, 1, v10
    v_and_b32 v11, 256, v11
    v_sub_u32 v10, v10, v11
    v_and_b32 v11, 16, v10
    v_lshl_add_u32 v11, v11, 6, v9
    v_lshrrev_b32 v12, 7, v10
    v_lshl_add_u32 v11, v12, 8, v11
    v_and_b32 v12, 15, v10
    v_lshl_add_u32 v11, v12, 4, v11
    v_bfe_u32 v12, v10, 5, 2
    v_lshl_add_u32 v101, v12, 2, v11
    s_and_b32 s32, s3, 3
    s_lshl_b32 s32, s32, 11
    s_add_u32 s32, s32, 86400
    v_add_u32 v225, s32, v239
    v_add_u32 v8, s33, v13
    v_sub_u32 v9, 32, v8
    v_min_u32 v9, v8, v9
    v_and_b32 v10, 15, v8
    v_cmp_eq_u32 s[32:33], 0, v10
    v_cmp_lt_u32 s[34:35], 16, v8
    v_lshlrev_b32 v10, 10, v9
    v_subrev_u32 v10, 1024, v10
    v_mov_b32 v11, 15872
    v_cmp_eq_u32 vcc, 0, v8
    s_nop 1
    v_cndmask_b32_e64 v10, v10, v11, vcc
    v_and_b32 v11, 3, v1
    v_lshl_add_u32 v10, v11, 4, v10
    v_lshrrev_b32 v11, 2, v4
    v_lshlrev_b32 v12, 7, v11
    v_sub_u32 v13, 960, v12
    v_cndmask_b32_e64 v13, v12, v13, s[34:35]
    v_add_u32 v226, v10, v13
    s_or_b64 s[34:35], s[34:35], s[32:33]
    v_add_u32 v12, 512, v12
    v_sub_u32 v13, 960, v12
    v_cndmask_b32_e64 v13, v12, v13, s[34:35]
    v_add_u32 v227, v10, v13
    s_mul_i32 s56, s20, 16512
    s_add_u32 s56, s56, 0x210000
    v_mov_b32 v249, 0x30003
    v_mov_b32 v252, s44
    v_mov_b32 v253, s45
    v_mov_b32 v254, s46
    v_mov_b32 v255, s47
    s_waitcnt lgkmcnt(0)
    s_waitcnt vmcnt(0)
    s_bitcmp1_b32 s2, 2
    s_cbranch_scc1 fz_p1_ok
    s_add_u32 s32, s60, 99072
    v_mov_b32 v9, 0
fz_p1:
    buffer_load_dword v10, v9, s[4:7], s32 offen sc1
    s_waitcnt vmcnt(0)
    v_xor_b32 v10, v252, v10
    v_and_b32 v10, v249, v10
    v_cmp_ne_u32 vcc, 0, v10
    s_cbranch_vccnz fz_p1_rt
fz_p1_ok:
    s_mov_b32 s58, 0
    buffer_load_dwordx4 v[104:107], v222, s[4:7], s60 offen sc1
    buffer_load_dwordx4 v[108:111], v222, s[4:7], s61 offen sc1
    buffer_load_dwordx4 v[112:115], v222, s[4:7], s16 offen sc1
    buffer_load_dwordx4 v[116:119], v222, s[4:7], s17 offen sc1
fz_h1_c0:
    s_waitcnt vmcnt(3)
    v_xor_b32 v104, v252, v104
    v_xor_b32 v105, v253, v105
    v_xor_b32 v106, v254, v106
    v_xor_b32 v107, v255, v107
    v_or3_b32 v10, v104, v105, v106
    v_bitop3_b32 v10, v10, v107, v249 bitop3:0xa8
    v_cmp_ne_u32 vcc, 0, v10
    s_cbranch_vccnz fz_h1_r0
fz_h1_o0:
    ds_write_b32 v223, v104 offset:0
    ds_write_b32 v223, v105 offset:2048
    ds_write_b32 v223, v106 offset:4096
    ds_write_b32 v223, v107 offset:6144
fz_h1_c1:
    s_waitcnt vmcnt(2)
    v_xor_b32 v108, v252, v108
    v_xor_b32 v109, v253, v109
    v_xor_b32 v110, v254, v110
    v_xor_b32 v111, v255, v111
    v_or3_b32 v10, v108, v109, v110
    v_bitop3_b32 v10, v10, v111, v249 bitop3:0xa8
    v_cmp_ne_u32 vcc, 0, v10
    s_cbranch_vccnz fz_h1_r1
fz_h1_o1:
    ds_write_b32 v224, v108 offset:0
    ds_write_b32 v224, v109 offset:2048
    ds_write_b32 v224, v110 offset:4096
    ds_write_b32 v224, v111 offset:6144
fz_h1_c2:
    s_waitcnt vmcnt(1)
    v_xor_b32 v112, v252, v112
    v_xor_b32 v113, v253, v113
    v_xor_b32 v114, v254, v114
    v_xor_b32 v115, v255, v115
    v_or3_b32 v10, v112, v113, v114
    v_bitop3_b32 v10, v10, v115, v249 bitop3:0xa8
    v_cmp_ne_u32 vcc, 0, v10
    s_cbranch_vccnz fz_h1_r2
fz_h1_o2:
    ds_write_b32 v100, v112 offset:0
    ds_write_b32 v100, v113 offset:2048
    ds_write_b32 v100, v114 offset:4096
    ds_write_b32 v100, v115 offset:6144
fz_h1_c3:
    s_waitcnt vmcnt(0)
    v_xor_b32 v116, v252, v116
    v_xor_b32 v117, v253, v117
    v_xor_b32 v118, v254, v118
    v_xor_b32 v119, v255, v119
    v_or3_b32 v10, v116, v117, v118
    v_bitop3_b32 v10, v10, v119, v249 bitop3:0xa8
    v_cmp_ne_u32 vcc, 0, v10
    s_cbranch_vccnz fz_h1_r3
fz_h1_o3:
    ds_write_b32 v101, v116 offset:0
    ds_write_b32 v101, v117 offset:2048
    ds_write_b32 v101, v118 offset:4096
    ds_write_b32 v101, v119 offset:6144
    s_waitcnt lgkmcnt(0)
    s_setprio 0
fz_hb:
    s_barrier
    ds_read_b128 v[104:107], v225 offset:0
    ds_read_b128 v[108:111], v225 offset:1024
    ds_read_b128 v[112:115], v225 offset:8256
    ds_read_b128 v[116:119], v225 offset:9280
    ds_read_b128 v[72:75], v6 offset:14336
    ds_read_b128 v[76:79], v6 offset:15360
    ds_read_b128 v[80:83], v6 offset:16384
    ds_read_b128 v[84:87], v6 offset:17408
    s_waitcnt lgkmcnt(7)
    v_mfma_f32_16x16x32_f16 v[120:123], v[104:107], v[16:19], 0
    s_waitcnt lgkmcnt(6)
    v_mfma_f32_16x16x32_f16 v[124:127], v[108:111], v[16:19], 0
    s_waitcnt lgkmcnt(5)
    v_mfma_f32_16x16x32_f16 v[128:131], v[112:115], v[16:19], 0
    s_waitcnt lgkmcnt(4)
    v_mfma_f32_16x16x32_f16 v[132:135], v[116:119], v[16:19], 0
    s_waitcnt lgkmcnt(0)
    s_nop 0
    v_cvt_pk_f16_f32 v136, v120, v121
    v_cvt_pk_f16_f32 v137, v122, v123
    v_cvt_pk_f16_f32 v138, v124, v125
    v_cvt_pk_f16_f32 v139, v126, v127
    v_cvt_pk_f16_f32 v140, v128, v129
    v_cvt_pk_f16_f32 v141, v130, v131
    v_cvt_pk_f16_f32 v142, v132, v133
    v_cvt_pk_f16_f32 v143, v134, v135
    v_pk_mul_f16 v144, v136, v20
    v_pk_mul_f16 v145, v137, v21
    v_pk_mul_f16 v146, v138, v22
    v_pk_mul_f16 v147, v139, v23
    v_mov_b32_dpp v152, v136 quad_perm:[1,0,3,2] row_mask:0xf bank_mask:0xf
    v_mov_b32_dpp v153, v137 quad_perm:[1,0,3,2] row_mask:0xf bank_mask:0xf
    v_mov_b32_dpp v154, v138 quad_perm:[1,0,3,2] row_mask:0xf bank_mask:0xf
    v_mov_b32_dpp v155, v139 quad_perm:[1,0,3,2] row_mask:0xf bank_mask:0xf
    v_pk_fma_f16 v144, v152, v24, v144
    v_pk_fma_f16 v145, v153, v25, v145
    v_pk_fma_f16 v146, v154, v26, v146
    v_pk_fma_f16 v147, v155, v27, v147
    s_nop 1
    v_mfma_f32_16x16x32_f16 v[104:107], v[144:147], v[72:75], 0
    v_mfma_f32_16x16x32_f16 v[108:111], v[144:147], v[80:83], 0
    v_xor_b32_dpp v152, v144, v240 quad_perm:[1,0,3,2] row_mask:0xf bank_mask:0xf
    v_xor_b32_dpp v153, v145, v240 quad_perm:[1,0,3,2] row_mask:0xf bank_mask:0xf
    v_xor_b32_dpp v154, v146, v240 quad_perm:[1,0,3,2] row_mask:0xf bank_mask:0xf
    v_xor_b32_dpp v155, v147, v240 quad_perm:[1,0,3,2] row_mask:0xf bank_mask:0xf
    s_nop 1
    v_mfma_f32_16x16x32_f16 v[104:107], v[152:155], v[76:79], v[104:107]
    v_mfma_f32_16x16x32_f16 v[108:111], v[152:155], v[84:87], v[108:111]
    v_pk_mul_f16 v148, v140, v20
    v_pk_mul_f16 v149, v141, v21
    v_pk_mul_f16 v150, v142, v22
    v_pk_mul_f16 v151, v143, v23
    v_mov_b32_dpp v156, v140 quad_perm:[1,0,3,2] row_mask:0xf bank_mask:0xf
    v_mov_b32_dpp v157, v141 quad_perm:[1,0,3,2] row_mask:0xf bank_mask:0xf
    v_mov_b32_dpp v158, v142 quad_perm:[1,0,3,2] row_mask:0xf bank_mask:0xf
    v_mov_b32_dpp v159, v143 quad_perm:[1,0,3,2] row_mask:0xf bank_mask:0xf
    v_pk_fma_f16 v148, v156, v24, v148
    v_pk_fma_f16 v149, v157, v25, v149
    v_pk_fma_f16 v150, v158, v26, v150
    v_pk_fma_f16 v151, v159, v27, v151
    s_nop 1
    v_mfma_f32_16x16x32_f16 v[112:115], v[148:151], v[72:75], 0
    v_mfma_f32_16x16x32_f16 v[116:119], v[148:151], v[80:83], 0
    v_xor_b32_dpp v156, v148, v240 quad_perm:[1,0,3,2] row_mask:0xf bank_mask:0xf
    v_xor_b32_dpp v157, v149, v240 quad_perm:[1,0,3,2] row_mask:0xf bank_mask:0xf
    v_xor_b32_dpp v158, v150, v240 quad_perm:[1,0,3,2] row_mask:0xf bank_mask:0xf
    v_xor_b32_dpp v159, v151, v240 quad_perm:[1,0,3,2] row_mask:0xf bank_mask:0xf
    s_nop 1
    v_mfma_f32_16x16x32_f16 v[112:115], v[156:159], v[76:79], v[112:115]
    v_mfma_f32_16x16x32_f16 v[116:119], v[156:159], v[84:87], v[116:119]
    v_cvt_pk_f16_f32 v120, v104, v105
    v_cvt_pk_f16_f32 v122, v106, v107
    s_nop 4
    v_cvt_pk_f16_f32 v121, v112, v113
    v_cvt_pk_f16_f32 v123, v114, v115
    v_add_u32 v120, 0x20002, v120
    v_add_u32 v121, 0x20002, v121
    v_add_u32 v122, 0x20002, v122
    v_add_u32 v123, 0x20002, v123
    v_and_or_b32 v120, v120, v229, s44
    v_and_or_b32 v121, v121, v229, s45
    v_and_or_b32 v122, v122, v229, s46
    v_and_or_b32 v123, v123, v229, s47
    buffer_store_dwordx4 v[120:123], v226, s[4:7], s56 offen sc1
    v_cvt_pk_f16_f32 v124, v108, v109
    v_cvt_pk_f16_f32 v126, v110, v111
    v_cvt_pk_f16_f32 v125, v116, v117
    v_cvt_pk_f16_f32 v127, v118, v119
    v_add_u32 v124, 0x20002, v124
    v_add_u32 v125, 0x20002, v125
    v_add_u32 v126, 0x20002, v126
    v_add_u32 v127, 0x20002, v127
    v_and_or_b32 v124, v124, v229, s44
    v_and_or_b32 v125, v125, v229, s45
    v_and_or_b32 v126, v126, v229, s46
    v_and_or_b32 v127, v127, v229, s47
    buffer_store_dwordx4 v[124:127], v227, s[4:7], s56 offen sc1
    s_cmp_lg_u32 s57, 0
    s_cbranch_scc1 fz_nc3
    v_sub_u32 v8, 15, v4
    v_min_u32 v8, v4, v8
    v_and_b32 v9, 1, v8
    v_lshlrev_b32 v9, 5, v9
    v_lshrrev_b32 v10, 1, v8
    v_lshl_add_u32 v9, v10, 9, v9
    v_add_u32 v9, s25, v9
    v_sub_u32 v10, 2048, v9
    v_cmp_lt_u32 s[34:35], 7, v4
    s_nop 1
    v_cndmask_b32_e64 v230, v9, v10, s[34:35]
    v_mov_b32 v9, v4
    v_mov_b32 v10, s20
    s_cmp_lg_u32 s21, 0
    s_cbranch_scc0 fz_spec3a
fz_spec3backa:
    v_lshlrev_b32 v10, 7, v10
    v_lshl_add_u32 v10, v9, 3, v10
    v_mul_u32_u24 v11, 66048, v5
    v_add_u32 v228, v10, v11
    v_and_b32 v9, 1, v9
    v_cmp_eq_u32 vcc, 1, v9
    v_mov_b32 v9, s44
    v_mov_b32 v10, s46
    v_cndmask_b32_e64 v236, v9, v10, vcc
    v_mov_b32 v9, s45
    v_mov_b32 v10, s47
    v_cndmask_b32_e64 v237, v9, v10, vcc
    s_lshl_b32 s32, s3, 2
    v_add_u32 v8, s32, v5
    v_lshlrev_b32 v9, 6, v8
    v_cmp_gt_u32 vcc, 16, v8
    s_nop 1
    v_cndmask_b32_e64 v10, 0, 32, vcc
    v_add_u32 v10, v9, v10
    v_sub_u32 v11, 2048, v10
    v_cmp_eq_u32 vcc, 16, v8
    s_nop 1
    v_cndmask_b32_e64 v11, v11, 0, vcc
    v_mov_b32 v12, 0xffff0000
    v_cndmask_b32_e64 v238, -1, v12, vcc
    v_sub_u32 v12, 2018, v9
    v_mul_u32_u24 v13, 2064, v4
    v_add_u32 v231, v13, v9
    v_add_u32 v232, v13, v12
    v_add_u32 v233, v13, v10
    v_add_u32 v241, v13, v11
    s_lshl_b32 s32, s3, 8
    s_add_u32 s32, s32, 102912
    v_lshlrev_b32 v9, 4, v4
    v_add_u32 v10, s32, v9
    v_add_u32 v11, 107008, v239
    v_cmp_gt_u32 vcc, 16, v1
    s_nop 1
    v_cndmask_b32_e64 v243, v11, v10, vcc
    v_lshrrev_b32 v12, 2, v4
    v_cmp_eq_u32 vcc, v12, v5
    s_nop 1
    v_cndmask_b32_e64 v244, v11, v10, vcc
    v_lshrrev_b32 v12, 5, v1
    v_lshl_add_u32 v10, v12, 10, v9
    v_add_u32 v245, 102912, v10
    v_and_b32 v9, 1, v1
    v_cmp_eq_u32 s[28:29], 1, v9
    v_and_b32 v9, 2, v1
    v_cmp_eq_u32 s[30:31], 2, v9
    s_lshl_b32 s37, s3, 2
    v_add_u32 v9, s37, v5
    v_mul_u32_u24 v246, 2176, v9
    s_lshl_b32 s26, s20, 4
    s_add_u32 s26, s26, 0x580000
    v_lshlrev_b32 v247, 4, v5
    s_lshl_b32 s27, s20, 11
    s_lshl_b32 s37, s3, 8
    s_add_u32 s27, s27, s37
    s_add_u32 s27, s27, 0x448000
    v_sub_u32 v248, 2047, v230
    s_mov_b32 s14, 0x400000
    s_mov_b32 s15, 0x00020000
    s_mul_i32 s52, s3, 264192
    s_add_u32 s52, s52, 0x210000
    s_add_u32 s53, s52, 16512
    s_add_u32 s54, s52, 33024
    s_add_u32 s55, s52, 49536
    s_mov_b32 s23, s63
    s_getreg_b32 s24, hwreg(HW_REG_XCC_ID)
    s_and_b32 s24, s24, 15
    v_lshlrev_b32 v10, 4, v0
    v_min_u32 v10, 4336, v10
    v_add_u32 v10, 108032, v10
    v_mov_b32 v104, 0
    v_mov_b32 v105, 0
    v_mov_b32 v106, 0
    v_mov_b32 v107, 0
    ds_write_b128 v10, v[104:107]
    s_mov_b32 s58, 0
    s_waitcnt vmcnt(0)
    buffer_load_dwordx2 v[104:105], v228, s[4:7], s52 offen sc1
    buffer_load_dwordx2 v[106:107], v228, s[4:7], s53 offen sc1
    buffer_load_dwordx2 v[108:109], v228, s[4:7], s54 offen sc1
    buffer_load_dwordx2 v[110:111], v228, s[4:7], s55 offen sc1
    ds_read_b128 v[116:119], v231
    ds_read_b128 v[120:123], v231 offset:16
    ds_read_u16_d16_hi v44, v241
    ds_read_u16_d16_hi v45, v232 offset:28
    ds_read_u16_d16_hi v46, v232 offset:26
    ds_read_u16_d16_hi v47, v232 offset:24
    ds_read_u16_d16_hi v48, v232 offset:22
    ds_read_u16_d16_hi v49, v232 offset:20
    ds_read_u16_d16_hi v50, v232 offset:18
    ds_read_u16_d16_hi v51, v232 offset:16
    ds_read_u16_d16_hi v52, v232 offset:14
    ds_read_u16_d16_hi v53, v232 offset:12
    ds_read_u16_d16_hi v54, v232 offset:10
    ds_read_u16_d16_hi v55, v232 offset:8
    ds_read_u16_d16_hi v56, v232 offset:6
    ds_read_u16_d16_hi v57, v232 offset:4
    ds_read_u16_d16_hi v58, v232 offset:2
    ds_read_u16_d16_hi v59, v232 offset:0
    ds_read_u16_d16_hi v28, v233
    v_mul_u32_u24 v13, 2064, v4
    v_subrev_u32 v13, 104960, v13
    v_sub_u32 v9, v231, v13
    v_sub_u32 v10, v233, v13
    v_sub_u32 v11, v241, v13
    v_sub_u32 v12, v232, v13
    s_mov_b32 s36, 0xffff0000
    s_waitcnt lgkmcnt(0)
    ds_read_b128 v[200:203], v9
    ds_read_b128 v[204:207], v9 offset:16
    ds_read_u16_d16 v208, v11
    ds_read_u16_d16_hi v124, v12 offset:28
    ds_read_u16_d16 v209, v12 offset:26
    ds_read_u16_d16_hi v125, v12 offset:24
    ds_read_u16_d16 v210, v12 offset:22
    ds_read_u16_d16_hi v126, v12 offset:20
    ds_read_u16_d16 v211, v12 offset:18
    ds_read_u16_d16_hi v127, v12 offset:16
    ds_read_u16_d16 v212, v12 offset:14
    ds_read_u16_d16_hi v128, v12 offset:12
    ds_read_u16_d16 v213, v12 offset:10
    ds_read_u16_d16_hi v129, v12 offset:8
    ds_read_u16_d16 v214, v12 offset:6
    ds_read_u16_d16_hi v130, v12 offset:4
    ds_read_u16_d16 v215, v12 offset:2
    ds_read_u16_d16_hi v131, v12 offset:0
    ds_read_u16_d16 v13, v10
    v_and_b32 v29, s36, v116
    v_lshlrev_b32 v30, 16, v117
    v_and_b32 v31, s36, v117
    v_lshlrev_b32 v32, 16, v118
    v_and_b32 v33, s36, v118
    v_lshlrev_b32 v34, 16, v119
    v_and_b32 v35, s36, v119
    v_lshlrev_b32 v36, 16, v120
    v_and_b32 v37, s36, v120
    v_lshlrev_b32 v38, 16, v121
    v_and_b32 v39, s36, v121
    v_lshlrev_b32 v40, 16, v122
    v_and_b32 v41, s36, v122
    v_lshlrev_b32 v42, 16, v123
    v_and_b32 v43, s36, v123
    v_cmp_eq_u32 vcc, 1, v4
    v_mov_b32 v9, s42
    s_nop 0
    v_cndmask_b32_e64 v9, 0, v9, vcc
    v_mov_b32 v116, s42
    v_mov_b32 v117, s42
    v_mov_b32 v118, s42
    v_mov_b32 v119, s42
    v_cmp_eq_u32 vcc, 0, v4
    s_waitcnt lgkmcnt(0)
    v_and_or_b32 v200, v200, s36, v13
    v_or_b32 v208, v208, v124
    v_or_b32 v209, v209, v125
    v_or_b32 v210, v210, v126
    v_or_b32 v211, v211, v127
    v_or_b32 v212, v212, v128
    v_or_b32 v213, v213, v129
    v_or_b32 v214, v214, v130
    v_or_b32 v215, v215, v131
    v_cndmask_b32_e64 v200, v9, v200, vcc
    v_cndmask_b32_e64 v201, v9, v201, vcc
    v_cndmask_b32_e64 v202, v9, v202, vcc
    v_cndmask_b32_e64 v203, v9, v203, vcc
    v_cndmask_b32_e64 v204, v9, v204, vcc
    v_cndmask_b32_e64 v205, v9, v205, vcc
    v_cndmask_b32_e64 v206, v9, v206, vcc
    v_cndmask_b32_e64 v207, v9, v207, vcc
    v_cndmask_b32_e64 v208, v9, v208, vcc
    v_cndmask_b32_e64 v209, v9, v209, vcc
    v_cndmask_b32_e64 v210, v9, v210, vcc
    v_cndmask_b32_e64 v211, v9, v211, vcc
    v_cndmask_b32_e64 v212, v9, v212, vcc
    v_cndmask_b32_e64 v213, v9, v213, vcc
    v_cndmask_b32_e64 v214, v9, v214, vcc
    v_cndmask_b32_e64 v215, v9, v215, vcc
    v_mfma_f32_16x16x32_bf16 v[120:123], v[200:203], v[116:119], 0
    v_mfma_f32_16x16x32_bf16 v[120:123], v[204:207], v[116:119], v[120:123]
    v_mfma_f32_16x16x32_bf16 v[120:123], v[208:211], v[116:119], v[120:123]
    v_mfma_f32_16x16x32_bf16 v[120:123], v[212:215], v[116:119], v[120:123]
    s_nop 7
    ds_write_b32 v243, v120 offset:12
    s_branch fz_h2c
fz_h2:
    buffer_load_dwordx2 v[104:105], v228, s[4:7], s52 offen sc1
    buffer_load_dwordx2 v[106:107], v228, s[4:7], s53 offen sc1
    buffer_load_dwordx2 v[108:109], v228, s[4:7], s54 offen sc1
    buffer_load_dwordx2 v[110:111], v228, s[4:7], s55 offen sc1
fz_h2c:
    s_mov_b32 s36, 0x43000000
fz_h2_c0:
    s_waitcnt vmcnt(3)
    v_xor_b32 v104, v236, v104
    v_xor_b32 v105, v237, v105
    v_bitop3_b32 v9, v104, v105, v249 bitop3:0xa8
    v_cmp_ne_u32 vcc, 0, v9
    s_cbranch_vccnz fz_h2_r0
fz_h2_o0:
    v_mov_b32_dpp v112, v104 row_mirror row_mask:0xf bank_mask:0xf
    v_mov_b32_dpp v113, v105 row_mirror row_mask:0xf bank_mask:0xf
    s_cmp_eq_u32 s2, 66
    s_cbranch_scc1 fz_spec40
fz_spec4back0:
    v_fma_mix_f32 v28, v104, s36, v28 op_sel:[0,0,0] op_sel_hi:[1,0,0]
    v_fma_mix_f32 v29, v104, s36, v29 op_sel:[1,0,0] op_sel_hi:[1,0,0]
    v_fma_mix_f32 v30, v105, s36, v30 op_sel:[0,0,0] op_sel_hi:[1,0,0]
    v_fma_mix_f32 v31, v105, s36, v31 op_sel:[1,0,0] op_sel_hi:[1,0,0]
    v_and_b32 v112, v238, v112
    v_fma_mix_f32 v44, v112, s36, v44 op_sel:[0,0,0] op_sel_hi:[1,0,0]
    v_fma_mix_f32 v45, v112, s36, v45 op_sel:[1,0,0] op_sel_hi:[1,0,0]
    v_fma_mix_f32 v46, v113, s36, v46 op_sel:[0,0,0] op_sel_hi:[1,0,0]
    v_fma_mix_f32 v47, v113, s36, v47 op_sel:[1,0,0] op_sel_hi:[1,0,0]
    v_cvt_pk_bf16_f32 v120, v28, v29
    v_cvt_pk_bf16_f32 v121, v30, v31
    v_cvt_pk_bf16_f32 v128, v44, v45
    v_cvt_pk_bf16_f32 v129, v46, v47
fz_h2_c1:
    s_waitcnt vmcnt(2)
    v_xor_b32 v106, v236, v106
    v_xor_b32 v107, v237, v107
    v_bitop3_b32 v9, v106, v107, v249 bitop3:0xa8
    v_cmp_ne_u32 vcc, 0, v9
    s_cbranch_vccnz fz_h2_r1
fz_h2_o1:
    v_mov_b32_dpp v114, v106 row_mirror row_mask:0xf bank_mask:0xf
    v_mov_b32_dpp v115, v107 row_mirror row_mask:0xf bank_mask:0xf
    s_cmp_eq_u32 s2, 66
    s_cbranch_scc1 fz_spec41
fz_spec4back1:
    v_fma_mix_f32 v32, v106, s36, v32 op_sel:[0,0,0] op_sel_hi:[1,0,0]
    v_fma_mix_f32 v33, v106, s36, v33 op_sel:[1,0,0] op_sel_hi:[1,0,0]
    v_fma_mix_f32 v34, v107, s36, v34 op_sel:[0,0,0] op_sel_hi:[1,0,0]
    v_fma_mix_f32 v35, v107, s36, v35 op_sel:[1,0,0] op_sel_hi:[1,0,0]
    v_fma_mix_f32 v48, v114, s36, v48 op_sel:[0,0,0] op_sel_hi:[1,0,0]
    v_fma_mix_f32 v49, v114, s36, v49 op_sel:[1,0,0] op_sel_hi:[1,0,0]
    v_fma_mix_f32 v50, v115, s36, v50 op_sel:[0,0,0] op_sel_hi:[1,0,0]
    v_fma_mix_f32 v51, v115, s36, v51 op_sel:[1,0,0] op_sel_hi:[1,0,0]
    v_cvt_pk_bf16_f32 v122, v32, v33
    v_cvt_pk_bf16_f32 v123, v34, v35
    v_cvt_pk_bf16_f32 v130, v48, v49
    v_cvt_pk_bf16_f32 v131, v50, v51
    v_mfma_f32_16x16x32_bf16 v[136:139], v[120:123], v[120:123], 0
    v_mfma_f32_16x16x32_bf16 v[140:143], v[200:203], v[120:123], 0
    v_mfma_f32_16x16x32_bf16 v[136:139], v[128:131], v[128:131], v[136:139]
    v_mfma_f32_16x16x32_bf16 v[140:143], v[208:211], v[128:131], v[140:143]
fz_h2_c2:
    s_waitcnt vmcnt(1)
    v_xor_b32 v108, v236, v108
    v_xor_b32 v109, v237, v109
    v_bitop3_b32 v9, v108, v109, v249 bitop3:0xa8
    v_cmp_ne_u32 vcc, 0, v9
    s_cbranch_vccnz fz_h2_r2
fz_h2_o2:
    v_mov_b32_dpp v116, v108 row_mirror row_mask:0xf bank_mask:0xf
    v_mov_b32_dpp v117, v109 row_mirror row_mask:0xf bank_mask:0xf
    s_cmp_eq_u32 s2, 66
    s_cbranch_scc1 fz_spec42
fz_spec4back2:
    v_fma_mix_f32 v36, v108, s36, v36 op_sel:[0,0,0] op_sel_hi:[1,0,0]
    v_fma_mix_f32 v37, v108, s36, v37 op_sel:[1,0,0] op_sel_hi:[1,0,0]
    v_fma_mix_f32 v38, v109, s36, v38 op_sel:[0,0,0] op_sel_hi:[1,0,0]
    v_fma_mix_f32 v39, v109, s36, v39 op_sel:[1,0,0] op_sel_hi:[1,0,0]
    v_fma_mix_f32 v52, v116, s36, v52 op_sel:[0,0,0] op_sel_hi:[1,0,0]
    v_fma_mix_f32 v53, v116, s36, v53 op_sel:[1,0,0] op_sel_hi:[1,0,0]
    v_fma_mix_f32 v54, v117, s36, v54 op_sel:[0,0,0] op_sel_hi:[1,0,0]
    v_fma_mix_f32 v55, v117, s36, v55 op_sel:[1,0,0] op_sel_hi:[1,0,0]
    v_cvt_pk_bf16_f32 v124, v36, v37
    v_cvt_pk_bf16_f32 v125, v38, v39
    v_cvt_pk_bf16_f32 v132, v52, v53
    v_cvt_pk_bf16_f32 v133, v54, v55
fz_h2_c3:
    s_waitcnt vmcnt(0)
    v_xor_b32 v110, v236, v110
    v_xor_b32 v111, v237, v111
    v_bitop3_b32 v9, v110, v111, v249 bitop3:0xa8
    v_cmp_ne_u32 vcc, 0, v9
    s_cbranch_vccnz fz_h2_r3
fz_h2_o3:
    v_mov_b32_dpp v118, v110 row_mirror row_mask:0xf bank_mask:0xf
    v_mov_b32_dpp v119, v111 row_mirror row_mask:0xf bank_mask:0xf
    s_cmp_eq_u32 s2, 66
    s_cbranch_scc1 fz_spec43
fz_spec4back3:
    v_fma_mix_f32 v40, v110, s36, v40 op_sel:[0,0,0] op_sel_hi:[1,0,0]
    v_fma_mix_f32 v41, v110, s36, v41 op_sel:[1,0,0] op_sel_hi:[1,0,0]
    v_fma_mix_f32 v42, v111, s36, v42 op_sel:[0,0,0] op_sel_hi:[1,0,0]
    v_fma_mix_f32 v43, v111, s36, v43 op_sel:[1,0,0] op_sel_hi:[1,0,0]
    v_fma_mix_f32 v56, v118, s36, v56 op_sel:[0,0,0] op_sel_hi:[1,0,0]
    v_fma_mix_f32 v57, v118, s36, v57 op_sel:[1,0,0] op_sel_hi:[1,0,0]
    v_fma_mix_f32 v58, v119, s36, v58 op_sel:[0,0,0] op_sel_hi:[1,0,0]
    v_fma_mix_f32 v59, v119, s36, v59 op_sel:[1,0,0] op_sel_hi:[1,0,0]
    v_cvt_pk_bf16_f32 v126, v40, v41
    v_cvt_pk_bf16_f32 v127, v42, v43
    v_cvt_pk_bf16_f32 v134, v56, v57
    v_cvt_pk_bf16_f32 v135, v58, v59
    v_mfma_f32_16x16x32_bf16 v[136:139], v[124:127], v[124:127], v[136:139]
    v_mfma_f32_16x16x32_bf16 v[140:143], v[204:207], v[124:127], v[140:143]
    v_mfma_f32_16x16x32_bf16 v[136:139], v[132:135], v[132:135], v[136:139]
    v_mfma_f32_16x16x32_bf16 v[140:143], v[212:215], v[132:135], v[140:143]
    s_nop 6
    v_cndmask_b32_e64 v9, v136, v137, s[28:29]
    v_cndmask_b32_e64 v10, v138, v139, s[28:29]
    ds_write_b64 v243, v[140:141]
    v_cndmask_b32_e64 v9, v9, v10, s[30:31]
    ds_write_b32 v244, v9 offset:8
    s_cmp_gt_u32 s3, 3
    s_cbranch_scc1 fz_lp
    s_setprio 2
fz_lp:
    s_waitcnt lgkmcnt(0)
    s_barrier
    ds_read_b128 v[144:147], v245 offset:0
    ds_read_b128 v[148:151], v245 offset:256
    ds_read_b128 v[152:155], v245 offset:512
    ds_read_b128 v[156:159], v245 offset:768
    s_waitcnt lgkmcnt(2)
    v_pk_add_f32 v[144:145], v[144:145], v[148:149]
    v_pk_add_f32 v[146:147], v[146:147], v[150:151]
    s_waitcnt lgkmcnt(0)
    v_pk_add_f32 v[152:153], v[152:153], v[156:157]
    v_pk_add_f32 v[154:155], v[154:155], v[158:159]
    v_pk_add_f32 v[144:145], v[144:145], v[152:153]
    v_pk_add_f32 v[146:147], v[146:147], v[154:155]
    v_mov_b32 v148, v144
    v_mov_b32 v149, v145
    v_mov_b32 v150, v146
    v_mov_b32 v151, v147
    v_permlane32_swap_b32 v144, v148
    v_permlane32_swap_b32 v145, v149
    v_permlane32_swap_b32 v146, v150
    v_permlane32_swap_b32 v147, v151
    v_pk_add_f32 v[144:145], v[144:145], v[148:149]
    v_pk_add_f32 v[146:147], v[146:147], v[150:151]
    v_mul_f32 v145, 0xba800000, v145
    v_mul_f32 v146, 0x3a800000, v146
    v_fma_f32 v146, -v145, v145, v146
    v_cvt_pk_bf16_f32 v153, 0, v145
    v_cvt_pk_bf16_f32 v146, 0, v146
    v_add_f32 v146, 0x3727c5ac, v146
    v_cvt_pk_bf16_f32 v146, 0, v146
    v_sqrt_f32 v146, v146
    v_fmac_f32 v144, v153, v147
    v_cvt_pk_bf16_f32 v146, 0, v146
    v_rcp_f32 v154, v146
    v_mov_b32 v155, s40
    v_mul_f32 v144, v144, v154
    v_cvt_pk_bf16_f32 v144, 0, v144
    v_ashrrev_i32 v145, 31, v144
    v_or_b32 v145, 0x80000000, v145
    v_bitop3_b32 v152, v144, v145, v242 bitop3:0x28
    v_or_b32 v152, v152, v248
    s_nop 1
    v_max_u32_dpp v144, v152, v152 row_ror:1 row_mask:0xf bank_mask:0xf
    s_nop 1
    v_max_u32_dpp v144, v144, v144 row_ror:2 row_mask:0xf bank_mask:0xf
    s_nop 1
    v_max_u32_dpp v144, v144, v144 row_ror:4 row_mask:0xf bank_mask:0xf
    s_nop 1
    v_max_u32_dpp v144, v144, v144 row_ror:8 row_mask:0xf bank_mask:0xf
    v_cmp_eq_u32 vcc, v144, v152
    v_or_b32 v153, s24, v153
    s_nop 0
    s_mov_b64 exec, vcc
    buffer_store_dwordx4 v[152:155], v246, s[4:7], s26 offen sc1
    s_add_u32 s26, s26, 69632
    buffer_store_dwordx4 v[152:155], v246, s[4:7], s26 offen sc1
    buffer_store_dwordx4 v[120:123], v247, s[4:7], s27 offen offset:0 sc1
    buffer_store_dwordx4 v[124:127], v247, s[4:7], s27 offen offset:64 sc1
    buffer_store_dwordx4 v[128:131], v247, s[4:7], s27 offen offset:128 sc1
    buffer_store_dwordx4 v[132:135], v247, s[4:7], s27 offen offset:192 sc1
    s_mov_b64 exec, -1
    s_setprio 0
    s_ff1_i32_b64 s37, vcc
    v_add_f32 v144, 1.0, v154
    v_and_b32 v146, v242, v153
    v_mul_f32 v146, v146, v154
    v_pk_fma_f32 v[28:29], v[28:29], v[144:145], v[146:147] op_sel_hi:[1,0,0]
    v_pk_fma_f32 v[30:31], v[30:31], v[144:145], v[146:147] op_sel_hi:[1,0,0]
    v_pk_fma_f32 v[32:33], v[32:33], v[144:145], v[146:147] op_sel_hi:[1,0,0]
    v_pk_fma_f32 v[34:35], v[34:35], v[144:145], v[146:147] op_sel_hi:[1,0,0]
    v_pk_fma_f32 v[36:37], v[36:37], v[144:145], v[146:147] op_sel_hi:[1,0,0]
    v_pk_fma_f32 v[38:39], v[38:39], v[144:145], v[146:147] op_sel_hi:[1,0,0]
    v_pk_fma_f32 v[40:41], v[40:41], v[144:145], v[146:147] op_sel_hi:[1,0,0]
    v_pk_fma_f32 v[42:43], v[42:43], v[144:145], v[146:147] op_sel_hi:[1,0,0]
    v_pk_fma_f32 v[44:45], v[44:45], v[144:145], v[146:147] op_sel_hi:[1,0,0]
    v_pk_fma_f32 v[46:47], v[46:47], v[144:145], v[146:147] op_sel_hi:[1,0,0]
    v_pk_fma_f32 v[48:49], v[48:49], v[144:145], v[146:147] op_sel_hi:[1,0,0]
    v_pk_fma_f32 v[50:51], v[50:51], v[144:145], v[146:147] op_sel_hi:[1,0,0]
    v_pk_fma_f32 v[52:53], v[52:53], v[144:145], v[146:147] op_sel_hi:[1,0,0]
    v_pk_fma_f32 v[54:55], v[54:55], v[144:145], v[146:147] op_sel_hi:[1,0,0]
    v_pk_fma_f32 v[56:57], v[56:57], v[144:145], v[146:147] op_sel_hi:[1,0,0]
    v_pk_fma_f32 v[58:59], v[58:59], v[144:145], v[146:147] op_sel_hi:[1,0,0]
    v_cvt_pk_bf16_f32 v104, v28, v29
    v_cvt_pk_bf16_f32 v105, v30, v31
    v_cvt_pk_bf16_f32 v106, v32, v33
    v_cvt_pk_bf16_f32 v107, v34, v35
    v_cvt_pk_bf16_f32 v108, v36, v37
    v_cvt_pk_bf16_f32 v109, v38, v39
    v_cvt_pk_bf16_f32 v110, v40, v41
    v_cvt_pk_bf16_f32 v111, v42, v43
    v_cvt_pk_bf16_f32 v112, v44, v45
    v_cvt_pk_bf16_f32 v113, v46, v47
    v_cvt_pk_bf16_f32 v114, v48, v49
    v_cvt_pk_bf16_f32 v115, v50, v51
    v_cvt_pk_bf16_f32 v116, v52, v53
    v_cvt_pk_bf16_f32 v117, v54, v55
    v_cvt_pk_bf16_f32 v118, v56, v57
    v_cvt_pk_bf16_f32 v119, v58, v59
    ds_write_b128 v231, v[104:107]
    ds_write_b128 v231, v[108:111] offset:16
    s_waitcnt lgkmcnt(0)
    s_barrier
    s_cmp_lt_u32 s3, 4
    s_cbranch_scc1 fz_now4
    buffer_load_dwordx4 v[192:195], v14, s[64:67], s62 offen offset:0 nt
    buffer_load_dwordx4 v[196:199], v14, s[64:67], s62 offen offset:256 nt
    s_add_u32 s62, s62, 8192
    buffer_load_dwordx4 v[60:63], v14, s[64:67], s62 offen offset:0 nt
    buffer_load_dwordx4 v[64:67], v14, s[64:67], s62 offen offset:256 nt
    s_add_u32 s62, s62, 8192
    buffer_load_dwordx4 v[68:71], v14, s[64:67], s62 offen offset:0 nt
    buffer_load_dwordx4 v[88:91], v14, s[64:67], s62 offen offset:256 nt
    s_add_u32 s62, s62, 8192
    buffer_load_dwordx4 v[92:95], v14, s[64:67], s62 offen offset:0 nt
    buffer_load_dwordx4 v[96:99], v14, s[64:67], s62 offen offset:256 nt
fz_now4:
    ds_write_b16 v233, v104
    ds_write_b16 v241, v112
    ds_write_b16_d16_hi v232, v112 offset:28
    ds_write_b16 v232, v113 offset:26
    ds_write_b16_d16_hi v232, v113 offset:24
    ds_write_b16 v232, v114 offset:22
    ds_write_b16_d16_hi v232, v114 offset:20
    ds_write_b16 v232, v115 offset:18
    ds_write_b16_d16_hi v232, v115 offset:16
    ds_write_b16 v232, v116 offset:14
    ds_write_b16_d16_hi v232, v116 offset:12
    ds_write_b16 v232, v117 offset:10
    ds_write_b16_d16_hi v232, v117 offset:8
    ds_write_b16 v232, v118 offset:6
    ds_write_b16_d16_hi v232, v118 offset:4
    ds_write_b16 v232, v119 offset:2
    ds_write_b16_d16_hi v232, v119 offset:0
    s_lshl_b32 s32, s3, 1
    s_add_u32 s33, s32, 1
    v_readlane_b32 s34, v230, s32
    v_readlane_b32 s35, v230, s33
    s_mul_i32 s38, s3, 4128
    v_add_u32 v9, s38, v239
    s_lshl_b32 s34, s34, 11
    s_lshl_b32 s35, s35, 11
    s_waitcnt lgkmcnt(0)
    s_barrier
    ds_read_b128 v[104:107], v9 offset:0
    ds_read_b128 v[108:111], v9 offset:1024
    ds_read_b128 v[112:115], v9 offset:2064
    ds_read_b128 v[116:119], v9 offset:3088
    s_lshr_b32 s59, s37, 1
    s_xor_b32 s18, s59, 1
    s_and_b32 s18, s18, 3
    s_and_b32 s59, s59, 3
    s_cmp_lt_u32 s23, 112
    s_cselect_b32 s38, s18, 8
    s_cmp_eq_u32 s38, s3
    s_cbranch_scc1 fz_sk1
    s_cmp_eq_u32 s59, s3
    s_cbranch_scc1 fz_sk1
    s_waitcnt lgkmcnt(0)
    s_cmp_eq_u32 s37, s32
    s_cbranch_scc1 fz_sk0
    buffer_store_dwordx4 v[104:107], v239, s[12:15], s34 offen offset:0 sc1
    buffer_store_dwordx4 v[108:111], v239, s[12:15], s34 offen offset:1024 sc1
fz_sk0:
    s_cmp_eq_u32 s37, s33
    s_cbranch_scc1 fz_sk1
    buffer_store_dwordx4 v[112:115], v239, s[12:15], s35 offen offset:0 sc1
    buffer_store_dwordx4 v[116:119], v239, s[12:15], s35 offen offset:1024 sc1
fz_sk1:
    v_and_b32 v15, 7, v4
    v_mul_u32_u24 v15, 544, v15
    v_lshl_add_u32 v15, v5, 4, v15
    v_add_u32 v15, 108032, v15
    s_lshl_b32 s63, s23, 5
    s_and_b32 s38, s3, 3
    s_mul_i32 s38, s38, 118784
    s_add_u32 s63, s63, s38
    s_add_u32 s63, s63, 0x4c8000
    v_lshrrev_b32 v13, 1, v1
    v_mul_u32_u24 v13, 3712, v13
    v_and_b32 v14, 1, v1
    v_lshl_add_u32 v102, v14, 4, v13
    v_add_u32 v103, 59392, v102
    v_mov_b32 v101, 49520
    v_mov_b32 v14, 0xffffff00
    s_cmp_eq_u32 s18, s3
    s_cbranch_scc1 fz_act
    s_cmp_eq_u32 s59, s3
    s_cbranch_scc1 fz_coll
    s_cmp_lt_u32 s3, 4
    s_cbranch_scc1 fz_xend
    s_branch fz_f2
fz_coll:
    s_mul_i32 s16, s37, 2064
    v_add_u32 v9, s16, v239
    v_readlane_b32 s16, v230, s37
    ds_read_b128 v[120:123], v9
    ds_read_b128 v[124:127], v9 offset:1024
    s_lshl_b32 s16, s16, 11
    s_and_b32 s38, s20, 15
    s_add_u32 s38, s38, 16
    s_mul_i32 s38, s38, 2176
    s_add_u32 s38, s38, 0x580000
    s_lshr_b32 s52, s20, 4
    s_lshl_b32 s52, s52, 7
    s_and_b32 s53, s20, 7
    s_lshl_b32 s53, s53, 4
    s_add_u32 s52, s52, s53
    s_bfe_u32 s53, s20, 0x10003
    s_lshl_b32 s53, s53, 2
    s_add_u32 s52, s52, s53
    v_and_b32 v2, 1, v1
    v_lshl_add_u32 v2, v2, 3, v5
    v_add_u32 v2, s52, v2
    v_and_b32 v3, 31, v2
    v_lshrrev_b32 v6, 5, v2
    v_cmp_gt_u32 vcc, 16, v6
    v_cmp_lt_u32 s[52:53], 16, v3
    v_cmp_eq_u32 s[54:55], 0, v3
    s_nop 1
    s_and_b64 s[54:55], s[54:55], vcc
    s_or_b64 s[52:53], s[52:53], s[54:55]
    v_cmp_eq_u32 s[54:55], 16, v3
    s_nop 1
    s_andn2_b64 s[54:55], s[54:55], vcc
    s_or_b64 s[52:53], s[52:53], s[54:55]
    v_sub_u32 v7, 1024, v2
    v_cndmask_b32_e64 v7, v2, v7, s[52:53]
    v_mov_b32 v8, 512
    v_cmp_eq_u32 vcc, 1024, v7
    s_nop 1
    v_cndmask_b32_e64 v7, v7, v8, vcc
    v_lshrrev_b32 v8, 5, v7
    v_and_b32 v7, 15, v7
    v_lshrrev_b32 v9, 2, v8
    v_lshlrev_b32 v9, 8, v9
    v_and_b32 v8, 3, v8
    v_lshl_add_u32 v9, v8, 4, v9
    v_lshrrev_b32 v8, 3, v7
    v_lshl_add_u32 v9, v8, 6, v9
    v_and_b32 v7, 7, v7
    v_lshl_add_u32 v9, v7, 1, v9
    v_cndmask_b32_e64 v7, 0, 1, s[52:53]
    v_lshl_add_u32 v9, v7, 7, v9
    v_lshlrev_b32 v2, 1, v2
    v_lshrrev_b32 v3, 1, v1
    v_mul_u32_u24 v3, 32, v3
    v_and_b32 v6, 1, v1
    v_lshl_add_u32 v3, v6, 4, v3
    v_mov_b32 v6, 0x7fffffff
    v_cmp_gt_u32 vcc, 32, v1
    s_nop 1
    v_cndmask_b32_e64 v6, v6, v3, vcc
    v_mov_b32 v7, s48
    v_cndmask_b32_e64 v16, 0, v7, vcc
    v_mov_b32 v7, s49
    v_cndmask_b32_e64 v17, 0, v7, vcc
    v_mov_b32 v7, s50
    v_cndmask_b32_e64 v18, 0, v7, vcc
    v_mov_b32 v7, s51
    v_cndmask_b32_e64 v19, 0, v7, vcc
    s_mul_i32 s52, s20, 3712
    s_add_u32 s52, s52, 0x4c8000
    s_add_u32 s53, s52, 1024
    s_add_u32 s54, s52, 2048
    s_add_u32 s55, s52, 3072
    v_lshlrev_b32 v20, 4, v1
    v_add_u32 v21, 1024, v20
    s_mov_b32 s58, 0
    s_nop 3
fz_k2:
    buffer_load_dwordx4 v[24:27], v20, s[4:7], s38 offen sc1
    buffer_load_dwordx4 v[28:31], v21, s[4:7], s38 offen sc1
    s_waitcnt vmcnt(0)
    v_xor_b32 v32, s40, v27
    v_xor_b32 v33, s40, v31
    v_max_u32 v34, v24, v28
    v_or_b32 v32, v32, v33
    v_cmp_ne_u32 vcc, 0, v32
    s_cbranch_vccnz fz_k2_rt
fz_k2_ok:
    v_max_u32_dpp v34, v34, v34 quad_perm:[1,0,3,2] row_mask:0xf bank_mask:0xf
    s_nop 1
    v_max_u32_dpp v34, v34, v34 quad_perm:[2,3,0,1] row_mask:0xf bank_mask:0xf
    s_nop 1
    v_max_u32_dpp v34, v34, v34 row_half_mirror row_mask:0xf bank_mask:0xf
    s_nop 1
    v_max_u32_dpp v34, v34, v34 row_mirror row_mask:0xf bank_mask:0xf
    s_nop 1
    v_max_u32_dpp v34, v34, v34 row_bcast:15 row_mask:0xa bank_mask:0xf
    s_nop 1
    v_max_u32_dpp v34, v34, v34 row_bcast:31 row_mask:0xc bank_mask:0xf
    s_nop 0
    v_readlane_b32 s36, v34, 63
    s_nop 1
    v_cmp_eq_u32 vcc, s36, v24
    v_cmp_eq_u32 s[56:57], s36, v28
    s_nop 1
    v_cndmask_b32_e64 v25, v25, v29, s[56:57]
    v_cndmask_b32_e64 v26, v26, v30, s[56:57]
    s_cmp_lg_u64 vcc, 0
    s_cselect_b32 s39, 0, 64
    s_or_b64 vcc, vcc, s[56:57]
    s_ff1_i32_b64 s41, vcc
    v_readlane_b32 s42, v25, s41
    v_readlane_b32 s43, v26, s41
    s_add_u32 s39, s39, s41
    s_and_b32 s42, s42, 0xffff0000
    s_cmp_eq_u32 s39, s20
    s_cselect_b32 s16, 0x7ff00000, s16
    s_mov_b32 s19, s37
    s_lshl_b32 s39, s39, 11
    s_add_u32 s39, s39, 0x448000
    s_mov_b32 s58, 0
    s_mov_b32 s41, 0xffff0000
    s_nop 0
fz_c2:
    buffer_load_short_d16_hi v10, v9, s[4:7], s39 offen sc1
    s_waitcnt vmcnt(0)
    v_cmp_eq_u32 vcc, s41, v10
    s_cbranch_vccnz fz_c2_rt
fz_c2_ok:
    s_waitcnt lgkmcnt(0)
    buffer_store_dwordx4 v[120:123], v239, s[12:15], s16 offen offset:0 sc1
    buffer_store_dwordx4 v[124:127], v239, s[12:15], s16 offen offset:1024 sc1
    s_cmp_eq_u32 s19, s32
    s_cbranch_scc1 fz_sc0
    buffer_store_dwordx4 v[104:107], v239, s[12:15], s34 offen offset:0 sc1
    buffer_store_dwordx4 v[108:111], v239, s[12:15], s34 offen offset:1024 sc1
fz_sc0:
    s_cmp_eq_u32 s19, s33
    s_cbranch_scc1 fz_sc1
    buffer_store_dwordx4 v[112:115], v239, s[12:15], s35 offen offset:0 sc1
    buffer_store_dwordx4 v[116:119], v239, s[12:15], s35 offen offset:1024 sc1
fz_sc1:
    v_add_f32 v11, s42, v10
    v_cvt_pk_bf16_f32 v11, 0, v11
    v_mul_f32 v11, s43, v11
    v_cvt_pk_bf16_f32 v11, 0, v11
    s_ashr_i32 s39, s36, 31
    s_not_b32 s39, s39
    s_or_b32 s39, s39, 0x80000000
    s_xor_b32 s39, s36, s39
    s_and_b32 s39, s39, 0xffff0000
    v_mov_b32 v12, s39
    v_mul_f32 v12, 0xbfb8aa3b, v12
    v_exp_f32 v12, v12
    s_nop 0
    v_add_f32 v12, 1.0, v12
    v_rcp_f32 v12, v12
    s_nop 0
    v_cvt_pk_bf16_f32 v12, 0, v12
    s_and_b32 s39, s36, 0xffff
    s_sub_u32 s39, 2047, s39
    s_lshl_b32 s39, s39, 11
    v_mov_b32 v13, 0xff
    s_waitcnt lgkmcnt(0)
fz_f2:
    s_cmp_gt_u32 s23, 111
    s_cbranch_scc1 fz_nof2
    s_cmp_lt_u32 s3, 4
    s_cbranch_scc1 fz_ca
fz_fl1:
    ds_read_b32 v100, v101 offset:4
    s_waitcnt lgkmcnt(0)
    v_cmp_eq_u32 vcc, 0, v100
    s_cbranch_vccnz fz_fl1
    ds_read_b128 v[120:123], v15 offset:0
    ds_read_b128 v[124:127], v15 offset:64
    ds_read_b128 v[128:131], v15 offset:128
    ds_read_b128 v[132:135], v15 offset:192
    ds_read_b128 v[136:139], v15 offset:256
    ds_read_b128 v[140:143], v15 offset:320
    ds_read_b128 v[144:147], v15 offset:384
    ds_read_b128 v[148:151], v15 offset:448
    s_waitcnt vmcnt(2)
    s_waitcnt lgkmcnt(7)
    v_mfma_f32_16x16x32_bf16 v[152:155], v[120:123], v[160:163], 0
    v_mfma_f32_16x16x32_bf16 v[156:159], v[120:123], v[164:167], 0
    s_waitcnt lgkmcnt(6)
    v_mfma_f32_16x16x32_bf16 v[152:155], v[124:127], v[168:171], v[152:155]
    v_mfma_f32_16x16x32_bf16 v[156:159], v[124:127], v[172:175], v[156:159]
    s_waitcnt lgkmcnt(5)
    v_mfma_f32_16x16x32_bf16 v[152:155], v[128:131], v[176:179], v[152:155]
    v_mfma_f32_16x16x32_bf16 v[156:159], v[128:131], v[180:183], v[156:159]
    s_waitcnt lgkmcnt(4)
    v_mfma_f32_16x16x32_bf16 v[152:155], v[132:135], v[184:187], v[152:155]
    v_mfma_f32_16x16x32_bf16 v[156:159], v[132:135], v[188:191], v[156:159]
    s_waitcnt lgkmcnt(3)
    v_mfma_f32_16x16x32_bf16 v[152:155], v[136:139], v[192:195], v[152:155]
    v_mfma_f32_16x16x32_bf16 v[156:159], v[136:139], v[196:199], v[156:159]
    s_waitcnt lgkmcnt(2)
    v_mfma_f32_16x16x32_bf16 v[152:155], v[140:143], v[60:63], v[152:155]
    v_mfma_f32_16x16x32_bf16 v[156:159], v[140:143], v[64:67], v[156:159]
    s_waitcnt lgkmcnt(1)
    v_mfma_f32_16x16x32_bf16 v[152:155], v[144:147], v[68:71], v[152:155]
    v_mfma_f32_16x16x32_bf16 v[156:159], v[144:147], v[88:91], v[156:159]
    s_waitcnt lgkmcnt(0)
    v_mfma_f32_16x16x32_bf16 v[152:155], v[148:151], v[92:95], v[152:155]
    v_mfma_f32_16x16x32_bf16 v[156:159], v[148:151], v[96:99], v[156:159]
    s_mov_b32 exec_hi, 0
    s_nop 5
    v_and_or_b32 v152, v152, v14, s48
    v_and_or_b32 v153, v153, v14, s49
    v_and_or_b32 v154, v154, v14, s50
    v_and_or_b32 v155, v155, v14, s51
    buffer_store_dwordx4 v[152:155], v102, s[4:7], s63 offen sc1
    v_and_or_b32 v156, v156, v14, s48
    v_and_or_b32 v157, v157, v14, s49
    v_and_or_b32 v158, v158, v14, s50
    v_and_or_b32 v159, v159, v14, s51
    buffer_store_dwordx4 v[156:159], v103, s[4:7], s63 offen sc1
fz_f2d:
    s_mov_b32 exec_hi, -1
    v_mov_b32 v100, 1
    s_waitcnt vmcnt(0)
    s_mov_b64 exec, 1
    ds_add_u32 v101, v100 offset:8
    s_mov_b64 exec, -1
    s_branch fz_xend
fz_ca:
    ds_read_b32 v100, v101 offset:8
    s_waitcnt lgkmcnt(0)
    v_cmp_ne_u32 vcc, 4, v100
    s_cbranch_vccnz fz_ca
    v_mov_b32 v7, 0
    s_branch fz_p5_ok
    s_nop 3
fz_nof2:
    s_cmp_lg_u32 s59, s3
    s_cbranch_scc1 fz_xend
    s_mov_b32 s58, 0
    s_and_b32 s41, s20, 63
    s_mul_i32 s41, s41, 32
    s_add_u32 s41, s41, s52
    v_mov_b32 v7, 0
    s_nop 4
fz_p5:
    buffer_load_dword v8, v7, s[4:7], s41 offen sc1
    s_waitcnt vmcnt(0)
    v_and_b32 v8, 0xff, v8
    v_cmp_ne_u32 vcc, s48, v8
    s_cbranch_vccnz fz_p5_rt
fz_p5_ok:
    s_mov_b32 s58, 0
    buffer_load_dwordx4 v[40:43], v3, s[4:7], s52 offen sc1
    buffer_load_dwordx4 v[44:47], v3, s[4:7], s53 offen sc1
    buffer_load_dwordx4 v[48:51], v3, s[4:7], s54 offen sc1
    buffer_load_dwordx4 v[52:55], v6, s[4:7], s55 offen sc1
fz_h5_c0:
    s_waitcnt vmcnt(3)
    v_xor_b32 v40, s48, v40
    v_xor_b32 v41, s49, v41
    v_xor_b32 v42, s50, v42
    v_xor_b32 v43, s51, v43
    v_or3_b32 v8, v40, v41, v42
    v_bitop3_b32 v8, v8, v43, v13 bitop3:0xa8
    v_cmp_ne_u32 vcc, 0, v8
    s_cbranch_vccnz fz_h5_r0
fz_h5_o0:
fz_h5_c1:
    s_waitcnt vmcnt(2)
    v_xor_b32 v44, s48, v44
    v_xor_b32 v45, s49, v45
    v_xor_b32 v46, s50, v46
    v_xor_b32 v47, s51, v47
    v_or3_b32 v8, v44, v45, v46
    v_bitop3_b32 v8, v8, v47, v13 bitop3:0xa8
    v_cmp_ne_u32 vcc, 0, v8
    s_cbranch_vccnz fz_h5_r1
fz_h5_o1:
    v_pk_add_f32 v[40:41], v[40:41], v[44:45]
    v_pk_add_f32 v[42:43], v[42:43], v[46:47]
fz_h5_c2:
    s_waitcnt vmcnt(1)
    v_xor_b32 v48, s48, v48
    v_xor_b32 v49, s49, v49
    v_xor_b32 v50, s50, v50
    v_xor_b32 v51, s51, v51
    v_or3_b32 v8, v48, v49, v50
    v_bitop3_b32 v8, v8, v51, v13 bitop3:0xa8
    v_cmp_ne_u32 vcc, 0, v8
    s_cbranch_vccnz fz_h5_r2
fz_h5_o2:
    v_pk_add_f32 v[40:41], v[40:41], v[48:49]
    v_pk_add_f32 v[42:43], v[42:43], v[50:51]
fz_h5_c3:
    s_waitcnt vmcnt(0)
    v_xor_b32 v52, v16, v52
    v_xor_b32 v53, v17, v53
    v_xor_b32 v54, v18, v54
    v_xor_b32 v55, v19, v55
    v_or3_b32 v8, v52, v53, v54
    v_bitop3_b32 v8, v8, v55, v13 bitop3:0xa8
    v_cmp_ne_u32 vcc, 0, v8
    s_cbranch_vccnz fz_h5_r3
fz_h5_o3:
    v_pk_add_f32 v[40:41], v[40:41], v[52:53]
    v_pk_add_f32 v[42:43], v[42:43], v[54:55]
    s_nop 1
    v_permlane32_swap_b32 v40, v42
    v_permlane32_swap_b32 v41, v43
    v_pk_add_f32 v[40:41], v[40:41], v[42:43]
    s_nop 1
    v_permlane16_swap_b32 v40, v41
    v_add_f32 v40, v40, v41
    s_nop 1
    v_add_f32_dpp v40, v40, v40 quad_perm:[2,3,0,1] row_mask:0xf bank_mask:0xf
    s_nop 1
    v_add_f32_dpp v40, v40, v40 row_ror:4 row_mask:0xf bank_mask:0xf
    s_nop 1
    v_add_f32_dpp v40, v40, v40 row_ror:8 row_mask:0xf bank_mask:0xf
    v_cvt_pk_bf16_f32 v40, 0, v40
    v_mul_f32 v40, v40, v12
    v_cvt_pk_bf16_f32 v40, 0, v40
    v_add_f32 v40, v40, v11
    v_cvt_pk_bf16_f32 v40, 0, v40
    v_add_f32 v40, v40, v10
    v_cvt_pk_bf16_f32 v40, 0, v40
    s_mov_b32 exec_lo, 0x00030003
    s_mov_b32 exec_hi, 0x00030003
    buffer_store_short_d16_hi v40, v2, s[12:15], s39 offen
    s_cmp_lg_u32 s20, 0
    s_cbranch_scc1 fz_xend
    s_mov_b64 exec, 1
    v_mov_b32 v8, s40
    buffer_store_dword v8, v7, s[4:7], 0 offen
fz_xend:
fz_end:
    s_endpgm
fz_late:
    buffer_store_dwordx4 v[104:107], v239, s[12:15], s34 offen offset:0 sc1
    buffer_store_dwordx4 v[108:111], v239, s[12:15], s34 offen offset:1024 sc1
    buffer_store_dwordx4 v[112:115], v239, s[12:15], s35 offen offset:0 sc1
    buffer_store_dwordx4 v[116:119], v239, s[12:15], s35 offen offset:1024 sc1
    s_branch fz_xend
fz_act:
    s_cmp_gt_u32 s23, 111
    s_cbranch_scc1 fz_xend
    v_lshlrev_b32 v2, 2, v1
    v_and_b32 v11, 3, v1
    v_mov_b32 v3, s48
    v_cmp_eq_u32 vcc, 1, v11
    v_mov_b32 v10, s49
    s_nop 0
    v_cndmask_b32_e64 v3, v3, v10, vcc
    v_cmp_eq_u32 vcc, 2, v11
    v_mov_b32 v10, s50
    s_nop 0
    v_cndmask_b32_e64 v3, v3, v10, vcc
    v_cmp_eq_u32 vcc, 3, v11
    v_mov_b32 v10, s51
    s_nop 0
    v_cndmask_b32_e64 v3, v3, v10, vcc
    v_and_b32 v10, 31, v1
    v_lshlrev_b32 v6, 4, v10
    v_lshrrev_b32 v10, 5, v1
    v_mul_u32_u24 v10, 2184, v10
    v_add_u32 v6, v6, v10
    v_add_u32 v6, 108032, v6
    s_lshl_b32 s38, s23, 11
    s_add_u32 s38, s38, 0x488000
    s_mov_b32 s58, 0
fz_h4:
    buffer_load_dword v16, v2, s[4:7], s38 offen offset:0 sc1
    buffer_load_dword v17, v2, s[4:7], s38 offen offset:256 sc1
    buffer_load_dword v18, v2, s[4:7], s38 offen offset:512 sc1
    buffer_load_dword v19, v2, s[4:7], s38 offen offset:768 sc1
    buffer_load_dword v20, v2, s[4:7], s38 offen offset:1024 sc1
    buffer_load_dword v21, v2, s[4:7], s38 offen offset:1280 sc1
    buffer_load_dword v22, v2, s[4:7], s38 offen offset:1536 sc1
    buffer_load_dword v23, v2, s[4:7], s38 offen offset:1792 sc1
    s_waitcnt vmcnt(6)
    v_xor_b32 v16, v3, v16
    v_xor_b32 v17, v3, v17
    v_or3_b32 v10, v16, v17, 0
    v_add_f32 v16, v16, v17
    s_waitcnt vmcnt(4)
    v_xor_b32 v18, v3, v18
    v_xor_b32 v19, v3, v19
    v_or3_b32 v10, v18, v19, v10
    v_add_f32 v18, v18, v19
    v_add_f32 v16, v16, v18
    s_waitcnt vmcnt(2)
    v_xor_b32 v20, v3, v20
    v_xor_b32 v21, v3, v21
    v_or3_b32 v10, v20, v21, v10
    v_add_f32 v20, v20, v21
    s_waitcnt vmcnt(0)
    v_xor_b32 v22, v3, v22
    v_xor_b32 v23, v3, v23
    v_or3_b32 v10, v22, v23, v10
    v_add_f32 v22, v22, v23
    v_add_f32 v20, v20, v22
    v_and_b32 v10, 0xff, v10
    v_add_f32 v8, v16, v20
    v_cmp_ne_u32 vcc, 0, v10
    s_cbranch_vccnz fz_h4_rt
fz_h4_ok:
    v_cvt_pk_bf16_f32 v8, 0, v8
    v_mov_b32 v9, v8
    s_nop 1
    v_permlane32_swap_b32 v8, v9
    v_mul_f32 v10, 0xbfb8aa3b, v8
    v_exp_f32 v10, v10
    s_nop 0
    v_add_f32 v10, 1.0, v10
    v_rcp_f32 v10, v10
    s_nop 0
    v_mul_f32 v8, v8, v10
    v_cvt_pk_bf16_f32 v8, 0, v8
    v_mul_f32 v8, v8, v9
    v_cvt_pk_bf16_f32 v8, 0, v8
    ds_write_b16_d16_hi v6, v8 offset:0
    ds_write_b16_d16_hi v6, v8 offset:546
    ds_write_b16_d16_hi v6, v8 offset:1092
    ds_write_b16_d16_hi v6, v8 offset:1638
    s_waitcnt lgkmcnt(0)
    v_mov_b32 v8, 1
    ds_write_b32 v101, v8 offset:4
    s_branch fz_late
fz_ldh:
    s_load_dwordx2 s[12:13], s[0:1], 56
    s_load_dwordx2 s[16:17], s[0:1], 64
    s_mov_b32 s14, 0x700000
    s_mov_b32 s15, 0x00020000
    s_mov_b32 s18, 0x700000
    s_mov_b32 s19, 0x00020000
    s_branch fz_ldback
fz_spec:
    s_cmp_gt_u32 s3, 3
    s_cbranch_scc1 fz_spec_hi
    s_cmp_eq_u32 s3, 0
    s_cselect_b32 s31, 0, s31
    s_cselect_b32 s30, 33024, s30
    s_cmp_eq_u32 s3, 2
    s_cselect_b32 s31, 30960, s31
    s_cselect_b32 s30, 35088, s30
    s_cmp_eq_u32 s3, 3
    s_cselect_b32 s31, 37152, s31
    s_cselect_b32 s30, 39216, s30
    s_branch fz_specback
fz_spec_hi:
    s_mov_b32 m0, s31
    s_nop 0
    buffer_load_dwordx4 v239, s[8:11], s27 offen lds
    buffer_load_dwordx4 v239, s[8:11], s27 offen offset:1024 lds
    s_mov_b32 m0, s30
    s_nop 0
    buffer_load_dwordx4 v239, s[8:11], s28 offen lds
    buffer_load_dwordx4 v239, s[8:11], s28 offen offset:1024 lds
    v_lshlrev_b32 v13, 3, v0
    v_mov_b32 v10, -1
    v_mov_b32 v11, -1
    s_lshl_b32 s32, s20, 11
    s_add_u32 s32, s32, 0x447800
    s_mov_b32 s18, 0x800
    s_mov_b32 s19, 0x00020000
    s_lshl_b32 s33, s24, 10
    s_min_u32 s34, s33, 2048
    s_add_u32 s34, s34, 104960
    s_mov_b32 m0, s34
    buffer_store_dwordx2 v[10:11], v13, s[4:7], s32 offen sc1
    buffer_load_dwordx4 v239, s[16:19], s33 offen lds
    s_cmp_eq_u32 s24, 0
    s_cselect_b32 s31, 8256, s31
    s_cselect_b32 s30, 22704, s30
    s_cselect_b32 s27, 524288, s27
    s_cselect_b32 s28, 3670016, s28
    s_cmp_eq_u32 s24, 1
    s_cselect_b32 s31, 12384, s31
    s_cselect_b32 s30, 18576, s30
    s_cselect_b32 s27, 1572864, s27
    s_cselect_b32 s28, 2621440, s28
    s_cmp_eq_u32 s24, 2
    s_cselect_b32 s31, 41280, s31
    s_cselect_b32 s30, 43344, s30
    s_cselect_b32 s27, 1572864, s27
    s_cselect_b32 s28, 2621440, s28
    s_cmp_eq_u32 s24, 3
    s_cselect_b32 s31, 45408, s31
    s_cselect_b32 s30, 47472, s30
    s_cselect_b32 s27, 524288, s27
    s_cselect_b32 s28, 3670016, s28
    s_mov_b32 s57, 0
    s_branch fz_specback
fz_jb:
    v_cvt_pk_bf16_f32 v128, v104, v105
    v_cvt_pk_bf16_f32 v129, v106, v107
    v_cvt_pk_bf16_f32 v130, v108, v109
    v_cvt_pk_bf16_f32 v131, v110, v111
    v_cvt_pk_bf16_f32 v132, v112, v113
    v_cvt_pk_bf16_f32 v133, v114, v115
    v_cvt_pk_bf16_f32 v134, v116, v117
    v_cvt_pk_bf16_f32 v135, v118, v119
    s_branch fz_jend
fz_bsp0:
    buffer_load_dwordx4 v[160:163], v14, s[64:67], s62 offen offset:0 nt
    buffer_load_dwordx4 v[164:167], v14, s[64:67], s62 offen offset:256 nt
    s_add_u32 s62, s62, 8192
    buffer_load_dwordx4 v[168:171], v14, s[64:67], s62 offen offset:0 nt
    buffer_load_dwordx4 v[172:175], v14, s[64:67], s62 offen offset:256 nt
    s_add_u32 s62, s62, 8192
    buffer_load_dwordx4 v[176:179], v14, s[64:67], s62 offen offset:0 nt
    buffer_load_dwordx4 v[180:183], v14, s[64:67], s62 offen offset:256 nt
    s_add_u32 s62, s62, 8192
    buffer_load_dwordx4 v[184:187], v14, s[64:67], s62 offen offset:0 nt
    buffer_load_dwordx4 v[188:191], v14, s[64:67], s62 offen offset:256 nt
    s_add_u32 s62, s62, 8192
    s_branch fz_bsp
fz_spec40:
    s_mov_b32 s38, 0x80018001
    s_mov_b32 s39, 0x80018001
    v_cndmask_b32_e64 v112, v112, v104, s[38:39]
    v_cndmask_b32_e64 v113, v113, v105, s[38:39]
    s_branch fz_spec4back0
fz_spec41:
    s_mov_b32 s38, 0x80018001
    s_mov_b32 s39, 0x80018001
    v_cndmask_b32_e64 v114, v114, v106, s[38:39]
    v_cndmask_b32_e64 v115, v115, v107, s[38:39]
    s_branch fz_spec4back1
fz_spec42:
    s_mov_b32 s38, 0x80018001
    s_mov_b32 s39, 0x80018001
    v_cndmask_b32_e64 v116, v116, v108, s[38:39]
    v_cndmask_b32_e64 v117, v117, v109, s[38:39]
    s_branch fz_spec4back2
fz_spec43:
    s_mov_b32 s38, 0x80018001
    s_mov_b32 s39, 0x80018001
    v_cndmask_b32_e64 v118, v118, v110, s[38:39]
    v_cndmask_b32_e64 v119, v119, v111, s[38:39]
    s_branch fz_spec4back3
    s_nop 3
fz_nc1:
    s_setprio 0
    s_cmp_lg_u32 s59, 0
    s_cbranch_scc1 ffn_b
    buffer_load_dwordx4 v[176:179], v14, s[64:67], s62 offen offset:0 nt
    buffer_load_dwordx4 v[180:183], v14, s[64:67], s62 offen offset:256 nt
    s_add_u32 s62, s62, 8192
    buffer_load_dwordx4 v[184:187], v14, s[64:67], s62 offen offset:0 nt
    buffer_load_dwordx4 v[188:191], v14, s[64:67], s62 offen offset:256 nt
    s_add_u32 s62, s62, 8192
    s_mov_b32 m0, s31
    s_nop 0
    buffer_load_dwordx4 v239, s[8:11], s27 offen nt lds
    buffer_load_dwordx4 v239, s[8:11], s27 offen offset:1024 nt lds
    s_mov_b32 m0, s30
    s_nop 0
    buffer_load_dwordx4 v239, s[8:11], s28 offen nt lds
    buffer_load_dwordx4 v239, s[8:11], s28 offen offset:1024 nt lds
    v_lshlrev_b32 v13, 3, v0
    v_mov_b32 v10, -1
    v_mov_b32 v11, -1
    s_lshl_b32 s32, s20, 11
    s_add_u32 s32, s32, 0x447800
    s_mov_b32 s18, 0x800
    s_mov_b32 s19, 0x00020000
    s_lshl_b32 s33, s24, 10
    s_min_u32 s34, s33, 2048
    s_add_u32 s34, s34, 104960
    s_mov_b32 m0, s34
    buffer_store_dwordx2 v[10:11], v13, s[4:7], s32 offen sc1
    buffer_load_dwordx4 v239, s[16:19], s33 offen lds
    s_waitcnt vmcnt(14)
    v_readfirstlane_b32 s40, v250
    s_nop 1
    s_add_u32 s40, s40, 1
    s_and_b32 s38, s40, 3
    s_and_b32 s39, s40, 15
    s_bfe_u32 s41, s40, 0x20002
    s_lshl_b32 s41, s41, 16
    s_or_b32 s44, s38, s41
    s_bfe_u32 s41, s40, 0x40004
    s_lshl_b32 s41, s41, 4
    s_or_b32 s48, s39, s41
    s_bfe_u32 s41, s40, 0x20004
    s_lshl_b32 s41, s41, 16
    s_or_b32 s45, s38, s41
    s_bfe_u32 s41, s40, 0x40008
    s_lshl_b32 s41, s41, 4
    s_or_b32 s49, s39, s41
    s_bfe_u32 s41, s40, 0x20006
    s_lshl_b32 s41, s41, 16
    s_or_b32 s46, s38, s41
    s_bfe_u32 s41, s40, 0x4000c
    s_lshl_b32 s41, s41, 4
    s_or_b32 s50, s39, s41
    s_bfe_u32 s41, s40, 0x20008
    s_lshl_b32 s41, s41, 16
    s_or_b32 s47, s38, s41
    s_bfe_u32 s41, s40, 0x40010
    s_lshl_b32 s41, s41, 4
    s_or_b32 s51, s39, s41
    s_mov_b32 s38, 0x404
    s_cmp_eq_u32 s2, 66
    s_cselect_b32 s39, 8, 4
    s_cselect_b32 s38, 8, s38
fz_bsp:
    s_setprio 0
    s_mov_b32 s57, 1
    s_cmp_gt_u32 s3, 5
    s_cbranch_scc1 fz_nocq
    s_and_b32 s32, s3, 1
    s_lshl_b32 s33, s32, 2
    s_lshl_b32 s32, s32, 11
    v_and_b32 v8, 3, v4
    v_lshrrev_b32 v9, 2, v4
    v_lshl_add_u32 v8, v8, 3, v9
    v_add_u32 v8, s33, v8
    v_cvt_f32_u32 v8, v8
    v_mul_f32 v8, 0x3d000000, v8
    v_cvt_f32_u32 v9, v5
    v_mul_f32 v9, 4.0, v9
    v_mul_f32 v9, v8, v9
    v_mov_b32 v104, v9
    v_fmamk_f32 v105, v8, 0x3f800000, v9
    v_fmamk_f32 v106, v8, 0x40000000, v9
    v_fmamk_f32 v107, v8, 0x40400000, v9
    v_fmamk_f32 v108, v8, 0x41800000, v9
    v_fmamk_f32 v109, v8, 0x41880000, v9
    v_fmamk_f32 v110, v8, 0x41900000, v9
    v_fmamk_f32 v111, v8, 0x41980000, v9
    v_sin_f32 v112, v104
    v_sin_f32 v113, v105
    v_sin_f32 v114, v106
    v_sin_f32 v115, v107
    v_sin_f32 v116, v108
    v_sin_f32 v117, v109
    v_sin_f32 v118, v110
    v_sin_f32 v119, v111
    v_cos_f32 v104, v104
    v_cos_f32 v105, v105
    v_cos_f32 v106, v106
    v_cos_f32 v107, v107
    v_cos_f32 v108, v108
    v_cos_f32 v109, v109
    v_cos_f32 v110, v110
    v_cos_f32 v111, v111
    v_mul_f32 v104, 0x3d800000, v104
    v_mul_f32 v105, 0x3d800000, v105
    v_mul_f32 v106, 0x3d800000, v106
    v_mul_f32 v107, 0x3d800000, v107
    v_mul_f32 v108, 0x3d800000, v108
    v_mul_f32 v109, 0x3d800000, v109
    v_mul_f32 v110, 0x3d800000, v110
    v_mul_f32 v111, 0x3d800000, v111
    v_mul_f32 v112, 0x3d800000, v112
    v_mul_f32 v113, 0x3d800000, v113
    v_mul_f32 v114, 0x3d800000, v114
    v_mul_f32 v115, 0x3d800000, v115
    v_mul_f32 v116, 0x3d800000, v116
    v_mul_f32 v117, 0x3d800000, v117
    v_mul_f32 v118, 0x3d800000, v118
    v_mul_f32 v119, 0x3d800000, v119
    v_cvt_pk_f16_f32 v128, v104, v105
    v_cvt_pk_f16_f32 v129, v106, v107
    v_cvt_pk_f16_f32 v130, v108, v109
    v_cvt_pk_f16_f32 v131, v110, v111
    v_cvt_pk_f16_f32 v132, v112, v113
    v_cvt_pk_f16_f32 v133, v114, v115
    v_cvt_pk_f16_f32 v134, v116, v117
    v_cvt_pk_f16_f32 v135, v118, v119
    v_add_u32 v8, s32, v6
    ds_write_b128 v8, v[128:131] offset:14336
    ds_write_b128 v8, v[132:135] offset:15360
fz_nocq:
    s_and_b32 s32, s3, 3
    s_lshr_b32 s33, s3, 2
    s_lshl_b32 s33, s33, 4
    s_add_u32 s33, s33, s32
    v_and_b32 v8, 12, v4
    v_bfe_u32 v9, v4, 1, 1
    v_lshl_add_u32 v8, v9, 5, v8
    v_add_u32 v8, s33, v8
    v_cvt_f32_u32 v8, v8
    v_and_b32 v12, 1, v1
    v_cvt_f32_u32 v9, v12
    v_lshlrev_b32 v13, 2, v5
    v_cvt_f32_u32 v10, v13
    v_mul_f32 v11, 0x3c800000, v8
    v_mul_f32 v9, 0x3e800000, v9
    v_fma_f32 v9, v11, v10, v9
    v_mov_b32 v128, v9
    v_fmamk_f32 v129, v11, 0x3f800000, v9
    v_fmamk_f32 v130, v11, 0x40000000, v9
    v_fmamk_f32 v131, v11, 0x40400000, v9
    v_mul_f32 v11, 0x3a000000, v8
    v_lshlrev_b32 v9, 31, v1
    v_xor_b32 v11, v9, v11
    v_mul_f32 v9, v11, v10
    v_mov_b32 v112, v9
    v_fmamk_f32 v113, v11, 0x3f800000, v9
    v_fmamk_f32 v114, v11, 0x40000000, v9
    v_fmamk_f32 v115, v11, 0x40400000, v9
    v_fmamk_f32 v116, v11, 0x41800000, v9
    v_fmamk_f32 v117, v11, 0x41880000, v9
    v_fmamk_f32 v118, v11, 0x41900000, v9
    v_fmamk_f32 v119, v11, 0x41980000, v9
    v_cos_f32 v104, v128
    v_sin_f32 v105, v128
    v_cos_f32 v106, v129
    v_sin_f32 v107, v129
    v_cos_f32 v108, v130
    v_sin_f32 v109, v130
    v_cos_f32 v110, v131
    v_sin_f32 v111, v131
    v_sin_f32 v120, v112
    v_sin_f32 v121, v113
    v_sin_f32 v122, v114
    v_sin_f32 v123, v115
    v_sin_f32 v124, v116
    v_sin_f32 v125, v117
    v_sin_f32 v126, v118
    v_sin_f32 v127, v119
    v_cos_f32 v112, v112
    v_cos_f32 v113, v113
    v_cos_f32 v114, v114
    v_cos_f32 v115, v115
    v_cos_f32 v116, v116
    v_cos_f32 v117, v117
    v_cos_f32 v118, v118
    v_cos_f32 v119, v119
    v_cvt_pk_f16_f32 v16, v104, v105
    v_cvt_pk_f16_f32 v17, v106, v107
    v_cvt_pk_f16_f32 v18, v108, v109
    v_cvt_pk_f16_f32 v19, v110, v111
    v_cvt_pk_f16_f32 v20, v112, v113
    v_cvt_pk_f16_f32 v21, v114, v115
    v_cvt_pk_f16_f32 v22, v116, v117
    v_cvt_pk_f16_f32 v23, v118, v119
    v_cvt_pk_f16_f32 v24, v120, v121
    v_cvt_pk_f16_f32 v25, v122, v123
    v_cvt_pk_f16_f32 v26, v124, v125
    v_cvt_pk_f16_f32 v27, v126, v127
    s_and_b32 s32, s3, 3
    s_lshl_b32 s32, s32, 11
    s_add_u32 s32, s32, 86400
    v_add_u32 v225, s32, v239
    v_add_u32 v8, s33, v13
    v_sub_u32 v9, 32, v8
    v_min_u32 v9, v8, v9
    v_and_b32 v10, 15, v8
    v_cmp_eq_u32 s[32:33], 0, v10
    v_cmp_lt_u32 s[34:35], 16, v8
    v_lshlrev_b32 v10, 10, v9
    v_subrev_u32 v10, 1024, v10
    v_mov_b32 v11, 15872
    v_cmp_eq_u32 vcc, 0, v8
    s_nop 1
    v_cndmask_b32_e64 v10, v10, v11, vcc
    v_and_b32 v11, 3, v1
    v_lshl_add_u32 v10, v11, 4, v10
    v_lshrrev_b32 v11, 2, v4
    v_lshlrev_b32 v12, 7, v11
    v_sub_u32 v13, 960, v12
    v_cndmask_b32_e64 v13, v12, v13, s[34:35]
    v_add_u32 v226, v10, v13
    s_or_b64 s[34:35], s[34:35], s[32:33]
    v_add_u32 v12, 512, v12
    v_sub_u32 v13, 960, v12
    v_cndmask_b32_e64 v13, v12, v13, s[34:35]
    v_add_u32 v227, v10, v13
    s_mul_i32 s56, s20, 16512
    s_add_u32 s56, s56, 0x210000
    v_mov_b32 v249, 0x30003
    v_mov_b32 v252, s44
    v_mov_b32 v253, s45
    v_mov_b32 v254, s46
    v_mov_b32 v255, s47
    s_waitcnt lgkmcnt(0)
    v_sub_u32 v8, 15, v4
    v_min_u32 v8, v4, v8
    v_and_b32 v9, 1, v8
    v_lshlrev_b32 v9, 5, v9
    v_lshrrev_b32 v10, 1, v8
    v_lshl_add_u32 v9, v10, 9, v9
    v_add_u32 v9, s25, v9
    v_sub_u32 v10, 2048, v9
    v_cmp_lt_u32 s[34:35], 7, v4
    s_nop 1
    v_cndmask_b32_e64 v230, v9, v10, s[34:35]
    v_mov_b32 v9, v4
    v_mov_b32 v10, s20
    s_cmp_lg_u32 s21, 0
    s_cbranch_scc0 fz_spec3b
fz_spec3backb:
    v_lshlrev_b32 v10, 7, v10
    v_lshl_add_u32 v10, v9, 3, v10
    v_mul_u32_u24 v11, 66048, v5
    v_add_u32 v228, v10, v11
    v_and_b32 v9, 1, v9
    v_cmp_eq_u32 vcc, 1, v9
    v_mov_b32 v9, s44
    v_mov_b32 v10, s46
    v_cndmask_b32_e64 v236, v9, v10, vcc
    v_mov_b32 v9, s45
    v_mov_b32 v10, s47
    v_cndmask_b32_e64 v237, v9, v10, vcc
    s_lshl_b32 s32, s3, 2
    v_add_u32 v8, s32, v5
    v_lshlrev_b32 v9, 6, v8
    v_cmp_gt_u32 vcc, 16, v8
    s_nop 1
    v_cndmask_b32_e64 v10, 0, 32, vcc
    v_add_u32 v10, v9, v10
    v_sub_u32 v11, 2048, v10
    v_cmp_eq_u32 vcc, 16, v8
    s_nop 1
    v_cndmask_b32_e64 v11, v11, 0, vcc
    v_mov_b32 v12, 0xffff0000
    v_cndmask_b32_e64 v238, -1, v12, vcc
    v_sub_u32 v12, 2018, v9
    v_mul_u32_u24 v13, 2064, v4
    v_add_u32 v231, v13, v9
    v_add_u32 v232, v13, v12
    v_add_u32 v233, v13, v10
    v_add_u32 v241, v13, v11
    s_lshl_b32 s32, s3, 8
    s_add_u32 s32, s32, 102912
    v_lshlrev_b32 v9, 4, v4
    v_add_u32 v10, s32, v9
    v_add_u32 v11, 107008, v239
    v_cmp_gt_u32 vcc, 16, v1
    s_nop 1
    v_cndmask_b32_e64 v243, v11, v10, vcc
    v_lshrrev_b32 v12, 2, v4
    v_cmp_eq_u32 vcc, v12, v5
    s_nop 1
    v_cndmask_b32_e64 v244, v11, v10, vcc
    v_lshrrev_b32 v12, 5, v1
    v_lshl_add_u32 v10, v12, 10, v9
    v_add_u32 v245, 102912, v10
    v_and_b32 v9, 1, v1
    v_cmp_eq_u32 s[28:29], 1, v9
    v_and_b32 v9, 2, v1
    v_cmp_eq_u32 s[30:31], 2, v9
    s_lshl_b32 s37, s3, 2
    v_add_u32 v9, s37, v5
    v_mul_u32_u24 v246, 2176, v9
    s_lshl_b32 s26, s20, 4
    s_add_u32 s26, s26, 0x580000
    v_lshlrev_b32 v247, 4, v5
    s_lshl_b32 s27, s20, 11
    s_lshl_b32 s37, s3, 8
    s_add_u32 s27, s27, s37
    s_add_u32 s27, s27, 0x448000
    v_sub_u32 v248, 2047, v230
    s_mov_b32 s14, 0x400000
    s_mov_b32 s15, 0x00020000
    s_mul_i32 s52, s3, 264192
    s_add_u32 s52, s52, 0x210000
    s_add_u32 s53, s52, 16512
    s_add_u32 s54, s52, 33024
    s_add_u32 s55, s52, 49536
    s_mov_b32 s23, s63
    s_getreg_b32 s24, hwreg(HW_REG_XCC_ID)
    s_and_b32 s24, s24, 15
    v_lshlrev_b32 v10, 4, v0
    v_min_u32 v10, 4336, v10
    v_add_u32 v10, 108032, v10
    v_mov_b32 v104, 0
    v_mov_b32 v105, 0
    v_mov_b32 v106, 0
    v_mov_b32 v107, 0
    ds_write_b128 v10, v[104:107]
    s_cmp_eq_u32 s2, 66
    s_cbranch_scc1 fz_sz
    s_waitcnt vmcnt(0)
    v_mov_b32 v10, 256
    s_mov_b64 exec, 1
    ds_add_u32 v15, v10
    s_mov_b64 exec, -1
fz_sz:
    ds_read_b32 v10, v15
    s_waitcnt lgkmcnt(0)
    v_cmp_ne_u32 vcc, s38, v10
    s_cbranch_vccnz fz_sz
    ds_read_b128 v[116:119], v231
    ds_read_b128 v[120:123], v231 offset:16
    ds_read_u16_d16_hi v44, v241
    ds_read_u16_d16_hi v45, v232 offset:28
    ds_read_u16_d16_hi v46, v232 offset:26
    ds_read_u16_d16_hi v47, v232 offset:24
    ds_read_u16_d16_hi v48, v232 offset:22
    ds_read_u16_d16_hi v49, v232 offset:20
    ds_read_u16_d16_hi v50, v232 offset:18
    ds_read_u16_d16_hi v51, v232 offset:16
    ds_read_u16_d16_hi v52, v232 offset:14
    ds_read_u16_d16_hi v53, v232 offset:12
    ds_read_u16_d16_hi v54, v232 offset:10
    ds_read_u16_d16_hi v55, v232 offset:8
    ds_read_u16_d16_hi v56, v232 offset:6
    ds_read_u16_d16_hi v57, v232 offset:4
    ds_read_u16_d16_hi v58, v232 offset:2
    ds_read_u16_d16_hi v59, v232 offset:0
    ds_read_u16_d16_hi v28, v233
    v_mul_u32_u24 v13, 2064, v4
    v_subrev_u32 v13, 104960, v13
    v_sub_u32 v9, v231, v13
    v_sub_u32 v10, v233, v13
    v_sub_u32 v11, v241, v13
    v_sub_u32 v12, v232, v13
    s_mov_b32 s36, 0xffff0000
    s_waitcnt lgkmcnt(0)
    ds_read_b128 v[200:203], v9
    ds_read_b128 v[204:207], v9 offset:16
    ds_read_u16_d16 v208, v11
    ds_read_u16_d16_hi v124, v12 offset:28
    ds_read_u16_d16 v209, v12 offset:26
    ds_read_u16_d16_hi v125, v12 offset:24
    ds_read_u16_d16 v210, v12 offset:22
    ds_read_u16_d16_hi v126, v12 offset:20
    ds_read_u16_d16 v211, v12 offset:18
    ds_read_u16_d16_hi v127, v12 offset:16
    ds_read_u16_d16 v212, v12 offset:14
    ds_read_u16_d16_hi v128, v12 offset:12
    ds_read_u16_d16 v213, v12 offset:10
    ds_read_u16_d16_hi v129, v12 offset:8
    ds_read_u16_d16 v214, v12 offset:6
    ds_read_u16_d16_hi v130, v12 offset:4
    ds_read_u16_d16 v215, v12 offset:2
    ds_read_u16_d16_hi v131, v12 offset:0
    ds_read_u16_d16 v13, v10
    v_and_b32 v29, s36, v116
    v_lshlrev_b32 v30, 16, v117
    v_and_b32 v31, s36, v117
    v_lshlrev_b32 v32, 16, v118
    v_and_b32 v33, s36, v118
    v_lshlrev_b32 v34, 16, v119
    v_and_b32 v35, s36, v119
    v_lshlrev_b32 v36, 16, v120
    v_and_b32 v37, s36, v120
    v_lshlrev_b32 v38, 16, v121
    v_and_b32 v39, s36, v121
    v_lshlrev_b32 v40, 16, v122
    v_and_b32 v41, s36, v122
    v_lshlrev_b32 v42, 16, v123
    v_and_b32 v43, s36, v123
    v_cmp_eq_u32 vcc, 1, v4
    v_mov_b32 v9, s42
    s_nop 0
    v_cndmask_b32_e64 v9, 0, v9, vcc
    v_mov_b32 v116, s42
    v_mov_b32 v117, s42
    v_mov_b32 v118, s42
    v_mov_b32 v119, s42
    v_cmp_eq_u32 vcc, 0, v4
    s_waitcnt lgkmcnt(0)
    v_and_or_b32 v200, v200, s36, v13
    v_or_b32 v208, v208, v124
    v_or_b32 v209, v209, v125
    v_or_b32 v210, v210, v126
    v_or_b32 v211, v211, v127
    v_or_b32 v212, v212, v128
    v_or_b32 v213, v213, v129
    v_or_b32 v214, v214, v130
    v_or_b32 v215, v215, v131
    v_cndmask_b32_e64 v200, v9, v200, vcc
    v_cndmask_b32_e64 v201, v9, v201, vcc
    v_cndmask_b32_e64 v202, v9, v202, vcc
    v_cndmask_b32_e64 v203, v9, v203, vcc
    v_cndmask_b32_e64 v204, v9, v204, vcc
    v_cndmask_b32_e64 v205, v9, v205, vcc
    v_cndmask_b32_e64 v206, v9, v206, vcc
    v_cndmask_b32_e64 v207, v9, v207, vcc
    v_cndmask_b32_e64 v208, v9, v208, vcc
    v_cndmask_b32_e64 v209, v9, v209, vcc
    v_cndmask_b32_e64 v210, v9, v210, vcc
    v_cndmask_b32_e64 v211, v9, v211, vcc
    v_cndmask_b32_e64 v212, v9, v212, vcc
    v_cndmask_b32_e64 v213, v9, v213, vcc
    v_cndmask_b32_e64 v214, v9, v214, vcc
    v_cndmask_b32_e64 v215, v9, v215, vcc
    v_mfma_f32_16x16x32_bf16 v[120:123], v[200:203], v[116:119], 0
    v_mfma_f32_16x16x32_bf16 v[120:123], v[204:207], v[116:119], v[120:123]
    v_mfma_f32_16x16x32_bf16 v[120:123], v[208:211], v[116:119], v[120:123]
    v_mfma_f32_16x16x32_bf16 v[120:123], v[212:215], v[116:119], v[120:123]
    s_nop 7
    ds_write_b32 v243, v120 offset:12
    s_waitcnt lgkmcnt(0)
    s_branch fz_hb
    s_nop 0
fz_nc3:
    s_mov_b32 s58, 0
    s_waitcnt vmcnt(0)
    s_branch fz_h2
fz_spec3a:
    v_xor_b32 v11, 1, v4
    v_cndmask_b32_e64 v9, v9, v11, s[34:35]
    v_and_b32 v11, 1, v4
    v_cndmask_b32_e64 v11, 0, v11, s[34:35]
    v_sub_u32 v10, v10, v11
    s_cmp_lg_u32 s22, 0
    s_cbranch_scc1 fz_spec3backa
    v_cmp_eq_u32 vcc, 15, v4
    v_mov_b32 v11, 1024
    v_mov_b32 v12, 124
    v_cndmask_b32_e64 v230, v230, v11, vcc
    v_cndmask_b32_e64 v10, v10, v12, vcc
    v_cndmask_b32_e64 v9, v9, 4, vcc
    v_cmp_eq_u32 vcc, 13, v4
    v_mov_b32 v11, 1536
    v_mov_b32 v12, 124
    v_cndmask_b32_e64 v230, v230, v11, vcc
    v_cndmask_b32_e64 v10, v10, v12, vcc
    v_cndmask_b32_e64 v9, v9, 6, vcc
    v_cmp_eq_u32 vcc, 4, v4
    v_mov_b32 v11, 256
    v_mov_b32 v12, 127
    v_cndmask_b32_e64 v230, v230, v11, vcc
    v_cndmask_b32_e64 v10, v10, v12, vcc
    v_cndmask_b32_e64 v9, v9, 8, vcc
    v_cmp_eq_u32 vcc, 11, v4
    v_mov_b32 v11, 1792
    v_mov_b32 v12, 127
    v_cndmask_b32_e64 v230, v230, v11, vcc
    v_cndmask_b32_e64 v10, v10, v12, vcc
    v_cndmask_b32_e64 v9, v9, 14, vcc
    v_cmp_eq_u32 vcc, 6, v4
    v_mov_b32 v11, 768
    v_mov_b32 v12, 127
    v_cndmask_b32_e64 v230, v230, v11, vcc
    v_cndmask_b32_e64 v10, v10, v12, vcc
    v_cndmask_b32_e64 v9, v9, 10, vcc
    v_cmp_eq_u32 vcc, 9, v4
    v_mov_b32 v11, 1280
    v_mov_b32 v12, 127
    v_cndmask_b32_e64 v230, v230, v11, vcc
    v_cndmask_b32_e64 v10, v10, v12, vcc
    v_cndmask_b32_e64 v9, v9, 12, vcc
    s_nop 4
    s_branch fz_spec3backa
fz_spec3b:
    v_xor_b32 v11, 1, v4
    v_cndmask_b32_e64 v9, v9, v11, s[34:35]
    v_and_b32 v11, 1, v4
    v_cndmask_b32_e64 v11, 0, v11, s[34:35]
    v_sub_u32 v10, v10, v11
    s_cmp_lg_u32 s22, 0
    s_cbranch_scc1 fz_spec3backb
    v_cmp_eq_u32 vcc, 15, v4
    v_mov_b32 v11, 1024
    v_mov_b32 v12, 124
    v_cndmask_b32_e64 v230, v230, v11, vcc
    v_cndmask_b32_e64 v10, v10, v12, vcc
    v_cndmask_b32_e64 v9, v9, 4, vcc
    v_cmp_eq_u32 vcc, 13, v4
    v_mov_b32 v11, 1536
    v_mov_b32 v12, 124
    v_cndmask_b32_e64 v230, v230, v11, vcc
    v_cndmask_b32_e64 v10, v10, v12, vcc
    v_cndmask_b32_e64 v9, v9, 6, vcc
    v_cmp_eq_u32 vcc, 4, v4
    v_mov_b32 v11, 256
    v_mov_b32 v12, 127
    v_cndmask_b32_e64 v230, v230, v11, vcc
    v_cndmask_b32_e64 v10, v10, v12, vcc
    v_cndmask_b32_e64 v9, v9, 8, vcc
    v_cmp_eq_u32 vcc, 11, v4
    v_mov_b32 v11, 1792
    v_mov_b32 v12, 127
    v_cndmask_b32_e64 v230, v230, v11, vcc
    v_cndmask_b32_e64 v10, v10, v12, vcc
    v_cndmask_b32_e64 v9, v9, 14, vcc
    v_cmp_eq_u32 vcc, 6, v4
    v_mov_b32 v11, 768
    v_mov_b32 v12, 127
    v_cndmask_b32_e64 v230, v230, v11, vcc
    v_cndmask_b32_e64 v10, v10, v12, vcc
    v_cndmask_b32_e64 v9, v9, 10, vcc
    v_cmp_eq_u32 vcc, 9, v4
    v_mov_b32 v11, 1280
    v_mov_b32 v12, 127
    v_cndmask_b32_e64 v230, v230, v11, vcc
    v_cndmask_b32_e64 v10, v10, v12, vcc
    v_cndmask_b32_e64 v9, v9, 12, vcc
    s_nop 4
    s_branch fz_spec3backb
    s_nop 0
ffn_b:
    s_waitcnt vmcnt(0)
    v_readfirstlane_b32 s40, v250
    s_nop 1
    s_add_u32 s40, s40, 1
    s_and_b32 s38, s40, 3
    s_and_b32 s39, s40, 15
    s_bfe_u32 s41, s40, 0x20002
    s_lshl_b32 s41, s41, 16
    s_or_b32 s44, s38, s41
    s_bfe_u32 s41, s40, 0x40004
    s_lshl_b32 s41, s41, 4
    s_or_b32 s48, s39, s41
    s_bfe_u32 s41, s40, 0x20004
    s_lshl_b32 s41, s41, 16
    s_or_b32 s45, s38, s41
    s_bfe_u32 s41, s40, 0x40008
    s_lshl_b32 s41, s41, 4
    s_or_b32 s49, s39, s41
    s_bfe_u32 s41, s40, 0x20006
    s_lshl_b32 s41, s41, 16
    s_or_b32 s46, s38, s41
    s_bfe_u32 s41, s40, 0x4000c
    s_lshl_b32 s41, s41, 4
    s_or_b32 s50, s39, s41
    s_bfe_u32 s41, s40, 0x20008
    s_lshl_b32 s41, s41, 16
    s_or_b32 s47, s38, s41
    s_bfe_u32 s41, s40, 0x40010
    s_lshl_b32 s41, s41, 4
    s_or_b32 s51, s39, s41
    s_nop 0
ffn:
    s_add_u32 s36, s2, 4
    s_and_b32 s36, s36, 7
    s_bfe_u32 s37, s2, 0x10006
    s_lshl_b32 s22, s36, 1
    s_add_u32 s22, s22, s37
    s_cmp_lg_u32 s37, 0
    s_cselect_b32 s37, 8, s36
    s_add_u32 s37, s37, 6
    s_cmp_lt_u32 s36, 6
    s_cselect_b32 s22, s22, s37
    s_cmp_gt_u32 s22, 13
    s_cbranch_scc1 fz_xend
    s_bfe_u32 s21, s2, 0x30003
    v_lshrrev_b32 v2, 5, v1
    v_and_b32 v3, 31, v1
    v_lshlrev_b32 v4, 1, v2
    v_xor_b32 v3, v4, v3
    v_mul_u32_u24 v4, 7168, v2
    v_lshl_add_u32 v4, v3, 4, v4
    v_xor_b32 v5, 64, v4
    v_xor_b32 v6, 128, v4
    v_xor_b32 v7, 192, v4
    s_lshl_b32 s23, s21, 7
    s_lshl_b32 s24, s3, 4
    s_add_u32 s23, s23, s24
    s_mul_i32 s23, s23, 7168
    s_lshl_b32 s24, s22, 9
    s_add_u32 s23, s23, s24
    s_lshl_b32 s24, s3, 13
    v_mov_b32 v31, 149552
    v_mov_b32 v10, 0
    ds_write_b32 v31, v10
    s_waitcnt lgkmcnt(0)
    s_setprio 0
    s_barrier
    s_add_u32 s28, s24, 81920
    s_mov_b32 m0, s28
    s_add_u32 s29, s23, 0
    buffer_load_dwordx4 v4, s[12:15], s29 offen nt lds
    s_add_u32 s28, s24, 82944
    s_mov_b32 m0, s28
    s_add_u32 s29, s23, 14336
    buffer_load_dwordx4 v5, s[12:15], s29 offen nt lds
    s_add_u32 s28, s24, 83968
    s_mov_b32 m0, s28
    s_add_u32 s29, s23, 28672
    buffer_load_dwordx4 v4, s[12:15], s29 offen nt lds
    s_add_u32 s28, s24, 84992
    s_mov_b32 m0, s28
    s_add_u32 s29, s23, 43008
    buffer_load_dwordx4 v5, s[12:15], s29 offen nt lds
    s_add_u32 s28, s24, 86016
    s_mov_b32 m0, s28
    s_add_u32 s29, s23, 57344
    buffer_load_dwordx4 v6, s[12:15], s29 offen nt lds
    s_add_u32 s28, s24, 87040
    s_mov_b32 m0, s28
    s_add_u32 s29, s23, 71680
    buffer_load_dwordx4 v7, s[12:15], s29 offen nt lds
    s_add_u32 s28, s24, 88064
    s_mov_b32 m0, s28
    s_add_u32 s29, s23, 86016
    buffer_load_dwordx4 v6, s[12:15], s29 offen nt lds
    s_add_u32 s28, s24, 89088
    s_mov_b32 m0, s28
    s_add_u32 s29, s23, 100352
    buffer_load_dwordx4 v7, s[12:15], s29 offen nt lds
    s_add_u32 s28, s24, 0
    s_mov_b32 m0, s28
    s_add_u32 s29, s23, 0
    buffer_load_dwordx4 v4, s[16:19], s29 offen nt lds
    s_add_u32 s28, s24, 1024
    s_mov_b32 m0, s28
    s_add_u32 s29, s23, 14336
    buffer_load_dwordx4 v5, s[16:19], s29 offen nt lds
    s_add_u32 s28, s24, 2048
    s_mov_b32 m0, s28
    s_add_u32 s29, s23, 28672
    buffer_load_dwordx4 v4, s[16:19], s29 offen nt lds
    s_add_u32 s28, s24, 3072
    s_mov_b32 m0, s28
    s_add_u32 s29, s23, 43008
    buffer_load_dwordx4 v5, s[16:19], s29 offen nt lds
    s_add_u32 s28, s24, 4096
    s_mov_b32 m0, s28
    s_add_u32 s29, s23, 57344
    buffer_load_dwordx4 v6, s[16:19], s29 offen nt lds
    s_add_u32 s28, s24, 5120
    s_mov_b32 m0, s28
    s_add_u32 s29, s23, 71680
    buffer_load_dwordx4 v7, s[16:19], s29 offen nt lds
    s_add_u32 s28, s24, 6144
    s_mov_b32 m0, s28
    s_add_u32 s29, s23, 86016
    buffer_load_dwordx4 v6, s[16:19], s29 offen nt lds
    s_add_u32 s28, s24, 7168
    s_mov_b32 m0, s28
    s_add_u32 s29, s23, 100352
    buffer_load_dwordx4 v7, s[16:19], s29 offen nt lds
    v_lshrrev_b32 v2, 4, v1
    v_and_b32 v3, 15, v1
    v_bfe_u32 v9, v1, 2, 2
    v_lshl_add_u32 v8, v2, 3, v9
    v_lshlrev_b32 v8, 9, v8
    v_and_b32 v10, 1, v2
    v_lshl_add_u32 v10, v10, 2, v9
    s_lshl_b32 s28, s3, 1
    v_xor_b32 v10, s28, v10
    v_lshl_add_u32 v8, v10, 5, v8
    v_and_b32 v10, 3, v1
    v_lshl_add_u32 v8, v10, 3, v8
    v_xor_b32 v12, 32, v8
    v_add_u32 v13, 81920, v8
    v_add_u32 v20, 81920, v12
    s_lshl_b32 s28, s21, 7
    v_lshl_add_u32 v9, v1, 1, s28
    v_and_b32 v24, 31, v9
    v_lshrrev_b32 v25, 5, v9
    v_cmp_gt_u32 vcc, 16, v25
    v_cmp_lt_u32 s[24:25], 16, v24
    v_cmp_eq_u32 s[26:27], 0, v24
    s_nop 1
    s_and_b64 s[26:27], s[26:27], vcc
    s_or_b64 s[24:25], s[24:25], s[26:27]
    v_cmp_eq_u32 s[26:27], 16, v24
    s_nop 1
    s_andn2_b64 s[26:27], s[26:27], vcc
    s_or_b64 s[24:25], s[24:25], s[26:27]
    v_sub_u32 v26, 1024, v9
    v_cndmask_b32_e64 v26, v9, v26, s[24:25]
    v_mov_b32 v27, 512
    v_cmp_eq_u32 vcc, 1024, v26
    s_nop 1
    v_cndmask_b32_e64 v26, v26, v27, vcc
    v_lshrrev_b32 v27, 5, v26
    v_and_b32 v26, 15, v26
    v_lshrrev_b32 v16, 2, v27
    v_lshlrev_b32 v16, 8, v16
    v_and_b32 v27, 3, v27
    v_lshl_add_u32 v16, v27, 4, v16
    v_lshrrev_b32 v27, 3, v26
    v_lshl_add_u32 v16, v27, 6, v16
    v_and_b32 v26, 7, v26
    v_lshl_add_u32 v16, v26, 1, v16
    v_cndmask_b32_e64 v26, 0, 1, s[24:25]
    v_lshl_add_u32 v16, v26, 7, v16
    v_add_u32 v9, 1, v9
    v_and_b32 v24, 31, v9
    v_lshrrev_b32 v25, 5, v9
    v_cmp_gt_u32 vcc, 16, v25
    v_cmp_lt_u32 s[24:25], 16, v24
    v_cmp_eq_u32 s[26:27], 0, v24
    s_nop 1
    s_and_b64 s[26:27], s[26:27], vcc
    s_or_b64 s[24:25], s[24:25], s[26:27]
    v_cmp_eq_u32 s[26:27], 16, v24
    s_nop 1
    s_andn2_b64 s[26:27], s[26:27], vcc
    s_or_b64 s[24:25], s[24:25], s[26:27]
    v_sub_u32 v26, 1024, v9
    v_cndmask_b32_e64 v26, v9, v26, s[24:25]
    v_mov_b32 v27, 512
    v_cmp_eq_u32 vcc, 1024, v26
    s_nop 1
    v_cndmask_b32_e64 v26, v26, v27, vcc
    v_lshrrev_b32 v27, 5, v26
    v_and_b32 v26, 15, v26
    v_lshrrev_b32 v17, 2, v27
    v_lshlrev_b32 v17, 8, v17
    v_and_b32 v27, 3, v27
    v_lshl_add_u32 v17, v27, 4, v17
    v_lshrrev_b32 v27, 3, v26
    v_lshl_add_u32 v17, v27, 6, v17
    v_and_b32 v26, 7, v26
    v_lshl_add_u32 v17, v26, 1, v17
    v_cndmask_b32_e64 v26, 0, 1, s[24:25]
    v_lshl_add_u32 v17, v26, 7, v17
    s_lshl_b32 s28, s21, 8
    s_add_u32 s28, s28, 147456
    v_lshl_add_u32 v18, v1, 2, s28
    s_lshl_b32 s28, s21, 8
    s_add_u32 s28, s28, 147456
    v_lshlrev_b32 v19, 4, v2
    v_add_u32 v19, s28, v19
    v_mov_b32 v28, 149504
    v_lshlrev_b32 v29, 4, v1
    s_lshl_b32 s30, s22, 3
    s_add_u32 s30, s30, s3
    s_lshl_b32 s30, s30, 3
    s_add_u32 s30, s30, s21
    s_lshl_b32 s30, s30, 8
    s_add_u32 s30, s30, 0x488000
    v_lshlrev_b32 v30, 4, v2
    v_lshl_add_u32 v30, v3, 6, v30
    v_cmp_eq_u32 s[60:61], 1, v3
    v_cmp_eq_u32 s[62:63], 2, v3
    v_cmp_eq_u32 s[64:65], 3, v3
    v_add_u32 v21, 149568, v29
    v_mov_b32 v197, 0xffffff00
    s_and_b32 s35, s2, 0x47
    s_lshl_b32 s31, s3, 3
    s_add_u32 s35, s35, s31
    s_add_u32 s35, s35, 58
    s_and_b32 s35, s35, 127
    s_getreg_b32 s33, hwreg(HW_REG_XCC_ID)
    s_and_b32 s33, s33, 15
    s_lshr_b32 s31, s35, 5
    s_lshl_b32 s31, s31, 2
    s_add_u32 s31, s31, 149520
    v_mov_b32 v22, s31
    s_lshl_b32 s20, s22, 3
    s_add_u32 s20, s20, s21
    s_and_b32 s34, s20, 15
    s_bfe_u32 s28, s20, 0x10004
    s_lshl_b32 s28, s28, 5
    s_add_u32 s34, s34, s28
    s_mul_i32 s34, s34, 2176
    s_add_u32 s34, s34, 0x580000
    s_waitcnt vmcnt(0)
    s_barrier
    ds_read_b64_tr_b16 v[32:33], v13 offset:0
    ds_read_b64_tr_b16 v[34:35], v13 offset:2048
    ds_read_b64_tr_b16 v[36:37], v13 offset:16384
    ds_read_b64_tr_b16 v[38:39], v13 offset:18432
    ds_read_b64_tr_b16 v[40:41], v13 offset:32768
    ds_read_b64_tr_b16 v[42:43], v13 offset:34816
    ds_read_b64_tr_b16 v[44:45], v13 offset:49152
    ds_read_b64_tr_b16 v[46:47], v13 offset:51200
    s_waitcnt lgkmcnt(0)
    ds_read_b64_tr_b16 v[48:49], v20 offset:0
    ds_read_b64_tr_b16 v[50:51], v20 offset:2048
    ds_read_b64_tr_b16 v[52:53], v20 offset:16384
    ds_read_b64_tr_b16 v[54:55], v20 offset:18432
    ds_read_b64_tr_b16 v[56:57], v20 offset:32768
    ds_read_b64_tr_b16 v[58:59], v20 offset:34816
    ds_read_b64_tr_b16 v[60:61], v20 offset:49152
    ds_read_b64_tr_b16 v[62:63], v20 offset:51200
    s_waitcnt lgkmcnt(0)
    ds_read_b64_tr_b16 v[64:65], v8 offset:0
    ds_read_b64_tr_b16 v[66:67], v8 offset:2048
    ds_read_b64_tr_b16 v[68:69], v8 offset:16384
    ds_read_b64_tr_b16 v[70:71], v8 offset:18432
    ds_read_b64_tr_b16 v[72:73], v8 offset:32768
    ds_read_b64_tr_b16 v[74:75], v8 offset:34816
    ds_read_b64_tr_b16 v[76:77], v8 offset:49152
    ds_read_b64_tr_b16 v[78:79], v8 offset:51200
    s_waitcnt lgkmcnt(0)
    ds_read_b64_tr_b16 v[80:81], v12 offset:0
    ds_read_b64_tr_b16 v[82:83], v12 offset:2048
    ds_read_b64_tr_b16 v[84:85], v12 offset:16384
    ds_read_b64_tr_b16 v[86:87], v12 offset:18432
    ds_read_b64_tr_b16 v[88:89], v12 offset:32768
    ds_read_b64_tr_b16 v[90:91], v12 offset:34816
    ds_read_b64_tr_b16 v[92:93], v12 offset:49152
    ds_read_b64_tr_b16 v[94:95], v12 offset:51200
    s_waitcnt lgkmcnt(0)
    s_cmp_lg_u32 s3, 0
    s_cbranch_scc1 ffn_w3
    v_lshlrev_b32 v23, 4, v1
    v_add_u32 v24, 1024, v23
    s_lshl_b32 s28, s20, 4
    s_add_u32 s28, s28, s34
    v_mov_b32 v10, 34828
    s_nop 4
ffn_p3:
    buffer_load_dword v11, v10, s[4:7], s28 offen sc1
    s_waitcnt vmcnt(0) lgkmcnt(0)
    v_cmp_ne_u32 vcc, s40, v11
    s_cbranch_vccnz ffn_p3_rt
ffn_p3_ok:
    s_mov_b32 s58, 0
    s_mov_b32 s54, -1
    s_nop 1
ffn_k3:
    buffer_load_dwordx4 v[200:203], v23, s[4:7], s34 offen sc1
    buffer_load_dwordx4 v[204:207], v24, s[4:7], s34 offen sc1
    s_waitcnt vmcnt(0)
    v_xor_b32 v208, s40, v203
    v_xor_b32 v209, s40, v207
    v_max_u32 v210, v200, v204
    v_or_b32 v208, v208, v209
    v_cmp_ne_u32 vcc, 0, v208
    s_cbranch_vccnz ffn_k3_rt
ffn_k3_ok:
    v_max_u32_dpp v210, v210, v210 quad_perm:[1,0,3,2] row_mask:0xf bank_mask:0xf
    s_nop 1
    v_max_u32_dpp v210, v210, v210 quad_perm:[2,3,0,1] row_mask:0xf bank_mask:0xf
    s_nop 1
    v_max_u32_dpp v210, v210, v210 row_half_mirror row_mask:0xf bank_mask:0xf
    s_nop 1
    v_max_u32_dpp v210, v210, v210 row_mirror row_mask:0xf bank_mask:0xf
    s_nop 1
    v_max_u32_dpp v210, v210, v210 row_bcast:15 row_mask:0xa bank_mask:0xf
    s_nop 1
    v_max_u32_dpp v210, v210, v210 row_bcast:31 row_mask:0xc bank_mask:0xf
    s_nop 0
    v_readlane_b32 s36, v210, 63
    s_nop 1
    v_cmp_eq_u32 vcc, s36, v200
    v_cmp_eq_u32 s[28:29], s36, v204
    s_nop 0
    s_cmp_lg_u64 vcc, 0
    s_cselect_b32 s39, 0, 64
    s_or_b64 vcc, vcc, s[28:29]
    s_ff1_i32_b64 s41, vcc
    s_add_u32 s39, s39, s41
    s_lshl_b32 s39, s39, 11
    s_add_u32 s39, s39, 0x448000
    s_mov_b32 s58, 0
ffn_c3:
    buffer_load_short_d16_hi v14, v16, s[4:7], s39 offen sc1
    buffer_load_short_d16_hi v15, v17, s[4:7], s39 offen sc1
ffn_c3d:
    v_and_b32 v10, 15, v201
    v_and_b32 v11, 15, v205
    v_cmp_eq_u32 s[24:25], s33, v10
    v_cmp_eq_u32 s[26:27], s33, v11
    s_nop 0
    v_mov_b32 v212, s24
    v_mov_b32 v213, s25
    v_mov_b32 v214, s26
    v_mov_b32 v215, s27
    v_cndmask_b32_e64 v209, v201, v205, s[28:29]
    v_cndmask_b32_e64 v210, v202, v206, s[28:29]
    ds_write_b128 v28, v[212:215] offset:16
    v_readlane_b32 s24, v209, s41
    v_readlane_b32 s25, v210, s41
    s_mov_b64 s[42:43], vcc
    s_and_b32 s24, s24, 0xffff0000
    s_mov_b32 s26, 0xffff0000
    s_waitcnt vmcnt(0)
    v_max_u32 v10, v14, v15
    v_add_f32 v14, s24, v14
    v_add_f32 v15, s24, v15
    v_cvt_pk_bf16_f32 v14, 0, v14
    v_cvt_pk_bf16_f32 v15, 0, v15
    v_mul_f32 v14, s25, v14
    v_mul_f32 v15, s25, v15
    v_cvt_pk_bf16_f32 v14, v14, v15
    ds_write_b32 v18, v14
    v_cmp_eq_u32 vcc, s26, v10
    s_cbranch_vccnz ffn_c3_rt
ffn_c3_ok:
    s_waitcnt lgkmcnt(0)
    s_nop 2
ffn_w3:
    s_barrier
    ds_read_b32 v203, v22
    ds_read_b128 v[128:131], v19 offset:0
    ds_read_b128 v[132:135], v19 offset:64
    ds_read_b128 v[136:139], v19 offset:128
    ds_read_b128 v[140:143], v19 offset:192
    s_waitcnt lgkmcnt(3)
    v_mfma_f32_16x16x32_bf16 v[192:195], v[32:35], v[128:131], 0
    v_mfma_f32_16x16x32_bf16 v[148:151], v[48:51], v[128:131], 0
    v_mfma_f32_16x16x32_bf16 v[152:155], v[64:67], v[128:131], 0
    v_mfma_f32_16x16x32_bf16 v[156:159], v[80:83], v[128:131], 0
    s_waitcnt lgkmcnt(2)
    v_mfma_f32_16x16x32_bf16 v[192:195], v[36:39], v[132:135], v[192:195]
    v_mfma_f32_16x16x32_bf16 v[148:151], v[52:55], v[132:135], v[148:151]
    v_mfma_f32_16x16x32_bf16 v[152:155], v[68:71], v[132:135], v[152:155]
    v_mfma_f32_16x16x32_bf16 v[156:159], v[84:87], v[132:135], v[156:159]
    s_waitcnt lgkmcnt(1)
    v_mfma_f32_16x16x32_bf16 v[192:195], v[40:43], v[136:139], v[192:195]
    v_mfma_f32_16x16x32_bf16 v[148:151], v[56:59], v[136:139], v[148:151]
    v_mfma_f32_16x16x32_bf16 v[152:155], v[72:75], v[136:139], v[152:155]
    v_mfma_f32_16x16x32_bf16 v[156:159], v[88:91], v[136:139], v[156:159]
    s_waitcnt lgkmcnt(0)
    v_mfma_f32_16x16x32_bf16 v[192:195], v[44:47], v[140:143], v[192:195]
    v_mfma_f32_16x16x32_bf16 v[148:151], v[60:63], v[140:143], v[148:151]
    v_mfma_f32_16x16x32_bf16 v[152:155], v[76:79], v[140:143], v[152:155]
    v_mfma_f32_16x16x32_bf16 v[156:159], v[92:95], v[140:143], v[156:159]
    v_readfirstlane_b32 s24, v203
    s_nop 4
    v_cndmask_b32_e64 v192, v192, v148, s[60:61]
    v_cndmask_b32_e64 v193, v193, v149, s[60:61]
    v_cndmask_b32_e64 v194, v194, v150, s[60:61]
    v_cndmask_b32_e64 v195, v195, v151, s[60:61]
    v_cndmask_b32_e64 v192, v192, v152, s[62:63]
    v_cndmask_b32_e64 v193, v193, v153, s[62:63]
    v_cndmask_b32_e64 v194, v194, v154, s[62:63]
    v_cndmask_b32_e64 v195, v195, v155, s[62:63]
    v_cndmask_b32_e64 v192, v192, v156, s[64:65]
    v_cndmask_b32_e64 v193, v193, v157, s[64:65]
    v_cndmask_b32_e64 v194, v194, v158, s[64:65]
    v_cndmask_b32_e64 v195, v195, v159, s[64:65]
    s_mov_b32 exec_lo, 0x000f000f
    s_mov_b32 exec_hi, 0x000f000f
    v_and_or_b32 v192, v192, v197, s48
    v_and_or_b32 v193, v193, v197, s49
    v_and_or_b32 v194, v194, v197, s50
    v_and_or_b32 v195, v195, v197, s51
    s_bitcmp1_b32 s24, s35
    s_cbranch_scc0 ffn_rem
    buffer_store_dwordx4 v[192:195], v30, s[4:7], s30 offen
ffn_fin:
    s_endpgm
ffn_rem:
    buffer_store_dwordx4 v[192:195], v30, s[4:7], s30 offen sc1
    s_branch ffn_fin
ffn_c3_rt:
    s_mov_b64 vcc, s[42:43]
    s_add_u32 s58, s58, 1
    s_cmp_lt_u32 s58, 0x10000
    s_cbranch_scc1 ffn_c3
    s_branch ffn_c3_ok
fz_h1_r0:
    s_add_u32 s58, s58, 1
    s_cmp_gt_u32 s58, 0x10000
    s_cbranch_scc1 fz_h1_o0
    buffer_load_dwordx4 v[104:107], v222, s[4:7], s60 offen sc1
    buffer_load_dwordx4 v[108:111], v222, s[4:7], s61 offen sc1
    buffer_load_dwordx4 v[112:115], v222, s[4:7], s16 offen sc1
    buffer_load_dwordx4 v[116:119], v222, s[4:7], s17 offen sc1
    s_branch fz_h1_c0
fz_h1_r1:
    s_add_u32 s58, s58, 1
    s_cmp_gt_u32 s58, 0x10000
    s_cbranch_scc1 fz_h1_o1
    buffer_load_dwordx4 v[108:111], v222, s[4:7], s61 offen sc1
    buffer_load_dwordx4 v[112:115], v222, s[4:7], s16 offen sc1
    buffer_load_dwordx4 v[116:119], v222, s[4:7], s17 offen sc1
    s_branch fz_h1_c1
fz_h1_r2:
    s_add_u32 s58, s58, 1
    s_cmp_gt_u32 s58, 0x10000
    s_cbranch_scc1 fz_h1_o2
    buffer_load_dwordx4 v[112:115], v222, s[4:7], s16 offen sc1
    buffer_load_dwordx4 v[116:119], v222, s[4:7], s17 offen sc1
    s_branch fz_h1_c2
fz_h1_r3:
    s_add_u32 s58, s58, 1
    s_cmp_gt_u32 s58, 0x10000
    s_cbranch_scc1 fz_h1_o3
    buffer_load_dwordx4 v[116:119], v222, s[4:7], s17 offen sc1
    s_branch fz_h1_c3
fz_h2_r0:
    s_add_u32 s58, s58, 1
    s_cmp_gt_u32 s58, 0x10000
    s_cbranch_scc1 fz_h2_o0
    buffer_load_dwordx2 v[104:105], v228, s[4:7], s52 offen sc1
    buffer_load_dwordx2 v[106:107], v228, s[4:7], s53 offen sc1
    buffer_load_dwordx2 v[108:109], v228, s[4:7], s54 offen sc1
    buffer_load_dwordx2 v[110:111], v228, s[4:7], s55 offen sc1
    s_branch fz_h2_c0
fz_h2_r1:
    s_add_u32 s58, s58, 1
    s_cmp_gt_u32 s58, 0x10000
    s_cbranch_scc1 fz_h2_o1
    buffer_load_dwordx2 v[106:107], v228, s[4:7], s53 offen sc1
    buffer_load_dwordx2 v[108:109], v228, s[4:7], s54 offen sc1
    buffer_load_dwordx2 v[110:111], v228, s[4:7], s55 offen sc1
    s_branch fz_h2_c1
fz_h2_r2:
    s_add_u32 s58, s58, 1
    s_cmp_gt_u32 s58, 0x10000
    s_cbranch_scc1 fz_h2_o2
    buffer_load_dwordx2 v[108:109], v228, s[4:7], s54 offen sc1
    buffer_load_dwordx2 v[110:111], v228, s[4:7], s55 offen sc1
    s_branch fz_h2_c2
fz_h2_r3:
    s_add_u32 s58, s58, 1
    s_cmp_gt_u32 s58, 0x10000
    s_cbranch_scc1 fz_h2_o3
    buffer_load_dwordx2 v[110:111], v228, s[4:7], s55 offen sc1
    s_branch fz_h2_c3
fz_h5_r0:
    s_add_u32 s58, s58, 1
    s_cmp_gt_u32 s58, 0x10000
    s_cbranch_scc1 fz_h5_o0
    buffer_load_dwordx4 v[40:43], v3, s[4:7], s52 offen sc1
    buffer_load_dwordx4 v[44:47], v3, s[4:7], s53 offen sc1
    buffer_load_dwordx4 v[48:51], v3, s[4:7], s54 offen sc1
    buffer_load_dwordx4 v[52:55], v6, s[4:7], s55 offen sc1
    s_branch fz_h5_c0
fz_h5_r1:
    s_add_u32 s58, s58, 1
    s_cmp_gt_u32 s58, 0x10000
    s_cbranch_scc1 fz_h5_o1
    buffer_load_dwordx4 v[44:47], v3, s[4:7], s53 offen sc1
    buffer_load_dwordx4 v[48:51], v3, s[4:7], s54 offen sc1
    buffer_load_dwordx4 v[52:55], v6, s[4:7], s55 offen sc1
    s_branch fz_h5_c1
fz_h5_r2:
    s_add_u32 s58, s58, 1
    s_cmp_gt_u32 s58, 0x10000
    s_cbranch_scc1 fz_h5_o2
    buffer_load_dwordx4 v[48:51], v3, s[4:7], s54 offen sc1
    buffer_load_dwordx4 v[52:55], v6, s[4:7], s55 offen sc1
    s_branch fz_h5_c2
fz_h5_r3:
    s_add_u32 s58, s58, 1
    s_cmp_gt_u32 s58, 0x10000
    s_cbranch_scc1 fz_h5_o3
    buffer_load_dwordx4 v[52:55], v6, s[4:7], s55 offen sc1
    s_branch fz_h5_c3
fz_p1_rt:
    s_add_u32 s58, s58, 1
    s_cmp_lt_u32 s58, 0x10000
    s_cbranch_scc1 fz_p1
    s_branch fz_p1_ok
fz_k2_rt:
    s_add_u32 s58, s58, 1
    s_cmp_lt_u32 s58, 0x10000
    s_cbranch_scc1 fz_k2
    s_branch fz_k2_ok
fz_c2_rt:
    s_add_u32 s58, s58, 1
    s_cmp_lt_u32 s58, 0x10000
    s_cbranch_scc1 fz_c2
    s_branch fz_c2_ok
fz_p5_rt:
    s_add_u32 s58, s58, 1
    s_cmp_lt_u32 s58, 0x10000
    s_cbranch_scc1 fz_p5
    s_branch fz_p5_ok
fz_h4_rt:
    s_add_u32 s58, s58, 1
    s_cmp_lt_u32 s58, 0x10000
    s_cbranch_scc1 fz_h4
    s_branch fz_h4_ok
ffn_p3_rt:
    s_add_u32 s58, s58, 1
    s_cmp_lt_u32 s58, 0x10000
    s_cbranch_scc1 ffn_p3
    s_branch ffn_p3_ok
ffn_k3_rt:
    s_add_u32 s58, s58, 1
    s_cmp_lt_u32 s58, 0x10000
    s_cbranch_scc1 ffn_k3
    s_branch ffn_k3_ok
fz_codeend:
.section .rodata,"a"
.p2align 6
.amdhsa_kernel fz_kernel
  .amdhsa_next_free_vgpr 256
  .amdhsa_next_free_sgpr 102
  .amdhsa_accum_offset 256
  .amdhsa_group_segment_fixed_size 0
  .amdhsa_kernarg_size 104
  .amdhsa_user_sgpr_count 2
  .amdhsa_user_sgpr_kernarg_segment_ptr 1
  .amdhsa_system_sgpr_workgroup_id_x 1
.end_amdhsa_kernel
```

```asm
; @launch kernel=fz_kernel grid=(256,1,1) block=(512,1,1) lds=163840
.amdgcn_target "amdgcn-amd-amdhsa--gfx950"
.text
.globl fz_kernel
.p2align 8
.type fz_kernel,@function
fz_kernel:
    s_load_dwordx2 s[4:5], s[0:1], 96
    s_load_dwordx2 s[8:9], s[0:1], 0
    s_load_dwordx2 s[64:65], s[0:1], 72
    s_cmp_gt_u32 s2, 255
    s_cbranch_scc1 fz_end
    v_lshrrev_b32 v2, 6, v0
    v_and_b32 v1, 63, v0
    s_lshr_b32 s59, s2, 7
    v_readfirstlane_b32 s3, v2
    s_and_b32 s20, s2, 127
    s_cmp_lt_u32 s20, 8
    s_cselect_b32 s20, s3, 0
    s_cmp_lt_u32 s20, 4
    s_cbranch_scc1 fz_pfcback
    s_getpc_b64 s[20:21]
fz_pcb:
    s_sub_u32 s20, s20, fz_pcb-fz_kernel
    s_subb_u32 s21, s21, 0
    v_and_b32 v3, 255, v0
    v_lshlrev_b32 v3, 7, v3
    v_min_u32 v3, fz_codeend-fz_kernel-4, v3
    v_mov_b32 v5, s21
    v_add_co_u32 v4, vcc, s20, v3
    s_nop 1
    v_addc_co_u32 v5, vcc, 0, v5, vcc
    global_load_dword v251, v[4:5], off
fz_pfcback:
    s_cmp_lg_u32 s59, 0
    s_cbranch_scc1 fz_ldh
    s_load_dwordx2 s[12:13], s[0:1], 80
    s_load_dwordx2 s[16:17], s[0:1], 48
fz_ldback:
    s_add_u32 s20, s2, 58
    s_and_b32 s20, s20, 127
    s_lshr_b32 s21, s20, 3
    s_add_u32 s21, s21, 1
    s_and_b32 s22, s20, 7
    s_sub_u32 s23, s20, 124
    s_cmp_ge_u32 s20, 124
    s_cselect_b32 s21, 0, s21
    s_cselect_b32 s22, s23, s22
    s_lshr_b32 s57, s3, 2
    s_or_b32 s23, s57, s59
    s_and_b32 s24, s3, 3
    s_lshl_b32 s25, s22, 6
    s_add_u32 s25, s25, s21
    s_lshl_b32 s26, s23, 5
    s_add_u32 s26, s26, s25
    s_lshl_b32 s27, s24, 9
    s_add_u32 s28, s26, s27
    s_sub_u32 s27, 2048, s27
    s_sub_u32 s27, s27, s26
    s_lshl_b32 s29, s24, 1
    s_add_u32 s29, s29, s23
    s_sub_u32 s30, 15, s29
    s_cmp_lt_u32 s24, 2
    s_cselect_b32 s27, s28, s27
    s_cselect_b32 s31, s29, s30
    s_cselect_b32 s30, s30, s29
    s_sub_u32 s28, 2048, s27
    s_and_b32 s28, s28, 2047
    s_lshl_b32 s27, s27, 11
    s_lshl_b32 s28, s28, 11
    s_mul_i32 s31, s31, 2064
    s_mul_i32 s30, s30, 2064
    v_lshlrev_b32 v239, 4, v1
    s_mov_b32 s10, 0x400000
    s_mov_b32 s11, 0x00020000
    s_mov_b32 s6, 0x690000
    s_mov_b32 s7, 0x00020000
    s_mov_b32 s66, 0x700000
    s_mov_b32 s67, 0x00020000
    s_and_b32 s32, s57, s59
    s_add_u32 s36, s2, 4
    s_and_b32 s36, s36, 7
    s_bfe_u32 s37, s2, 0x10006
    s_lshl_b32 s63, s36, 1
    s_add_u32 s63, s63, s37
    s_cmp_lg_u32 s37, 0
    s_cselect_b32 s37, 8, s36
    s_add_u32 s37, s37, 6
    s_cmp_lt_u32 s36, 6
    s_cselect_b32 s63, s63, s37
    s_lshl_b32 s63, s63, 3
    s_bfe_u32 s37, s2, 0x30003
    s_add_u32 s63, s63, s37
    v_and_b32 v10, 15, v1
    v_lshlrev_b32 v10, 4, v10
    v_lshrrev_b32 v14, 4, v1
    v_lshl_add_u32 v14, v14, 11, v10
    s_lshl_b32 s62, s63, 16
    s_and_b32 s37, s3, 3
    s_lshl_b32 s37, s37, 9
    s_add_u32 s62, s62, s37
    s_mov_b32 s58, 0
    s_waitcnt lgkmcnt(0)
    s_cmp_eq_u32 s2, 66
    s_cbranch_scc1 fz_spec
fz_specback:
    s_cmp_lg_u32 s57, 0
    s_cbranch_scc1 fz_nox
    s_mov_b32 m0, s31
    s_nop 0
    buffer_load_dwordx4 v239, s[8:11], s27 offen nt lds
    buffer_load_dwordx4 v239, s[8:11], s27 offen offset:1024 nt lds
    s_mov_b32 m0, s30
    s_nop 0
    buffer_load_dwordx4 v239, s[8:11], s28 offen nt lds
    buffer_load_dwordx4 v239, s[8:11], s28 offen offset:1024 nt lds
fz_nox:
    buffer_load_dword v250, off, s[4:7], 0
    s_andn2_b32 s32, s57, s59
    s_cbranch_scc0 fz_nowe
    buffer_load_dwordx4 v[160:163], v14, s[64:67], s62 offen offset:0 nt
    buffer_load_dwordx4 v[164:167], v14, s[64:67], s62 offen offset:256 nt
    s_add_u32 s62, s62, 8192
    buffer_load_dwordx4 v[168:171], v14, s[64:67], s62 offen offset:0 nt
    buffer_load_dwordx4 v[172:175], v14, s[64:67], s62 offen offset:256 nt
    s_add_u32 s62, s62, 8192
fz_nowe:
    s_cmp_eq_u32 s57, 0
    s_cbranch_scc1 fz_np
    s_setprio 1
fz_np:
    v_and_b32 v2, 31, v1
    v_lshrrev_b32 v3, 5, v1
    v_and_b32 v4, 15, v1
    v_lshrrev_b32 v5, 4, v1
    v_add_u32 v6, 49536, v239
    v_lshrrev_b32 v10, 1, v2
    v_and_b32 v8, 9, v10
    v_and_b32 v11, 2, v10
    v_lshl_or_b32 v8, v11, 1, v8
    v_bfe_u32 v11, v10, 2, 1
    v_lshl_or_b32 v8, v11, 1, v8
    v_and_b32 v12, 1, v5
    v_cmp_eq_u32 vcc, 1, v12
    v_lshl_add_u32 v9, v4, 1, 1
    s_nop 0
    v_cndmask_b32_e64 v9, v9, 0, vcc
    s_cmp_lt_u32 s3, 5
    s_cselect_b64 s[32:33], -1, 0
    s_cmp_lt_u32 s3, 3
    s_cselect_b64 s[34:35], -1, 0
    v_cndmask_b32_e64 v9, v9, v2, s[32:33]
    v_cndmask_b32_e64 v8, v9, v8, s[34:35]
    s_mov_b32 s36, 0x3d000000
    s_cmp_gt_u32 s3, 4
    s_cselect_b32 s36, 0x3c800000, s36
    s_sub_u32 s37, s3, 1
    s_cmp_lt_u32 s37, 2
    s_cselect_b32 s36, 0x3a800000, s36
    s_cmp_eq_u32 s3, 0
    s_cselect_b32 s32, 16, 0
    s_cselect_b32 s33, 0x3e800000, 0
    s_cselect_b32 s34, 4.0, 0x41000000
    s_cselect_b32 s35, 0x41000000, 4.0
    v_cmp_eq_u32 vcc, 1, v2
    v_mov_b32 v10, s32
    s_nop 0
    v_cndmask_b32_e64 v10, 0, v10, vcc
    v_add_u32 v8, v8, v10
    v_cvt_f32_u32 v8, v8
    v_mul_f32 v8, s36, v8
    s_cmp_eq_u32 s3, 2
    s_cselect_b32 s32, 0x80000000, 0
    v_lshlrev_b32 v10, 31, v2
    v_and_b32 v10, s32, v10
    v_xor_b32 v8, v10, v8
    v_and_b32 v10, 1, v2
    v_cvt_f32_u32 v10, v10
    v_mul_f32 v10, s33, v10
    s_cmp_eq_u32 s3, 1
    s_cselect_b32 s33, 0x3e800000, 0
    v_mov_b32 v11, s33
    v_cndmask_b32_e64 v10, v10, v11, vcc
    s_cmp_eq_u32 s3, 5
    s_cselect_b32 s33, 0x3e800000, 0
    v_cvt_f32_u32 v12, v12
    v_fma_f32 v10, v12, s33, v10
    s_cmp_eq_u32 s3, 6
    s_cselect_b32 s33, 0x3e800000, 0
    s_cmp_eq_u32 s3, 2
    s_cselect_b32 s33, 0xbe800000, s33
    s_cmp_eq_u32 s3, 4
    s_cselect_b32 s33, 0xbe800000, s33
    v_add_f32 v10, s33, v10
    v_cvt_f32_u32 v11, v3
    v_mul_f32 v11, s35, v11
    v_fma_f32 v9, v8, v11, v10
    v_mul_f32 v10, s34, v8
    v_mul_f32 v11, 0x41800000, v8
    v_mov_b32 v104, v9
    v_fmamk_f32 v105, v8, 0x3f800000, v9
    v_fmamk_f32 v106, v8, 0x40000000, v9
    v_fmamk_f32 v107, v8, 0x40400000, v9
    v_add_f32 v108, v104, v10
    v_add_f32 v109, v105, v10
    v_add_f32 v110, v106, v10
    v_add_f32 v111, v107, v10
    v_add_f32 v112, v104, v11
    v_add_f32 v113, v105, v11
    v_add_f32 v114, v106, v11
    v_add_f32 v115, v107, v11
    v_add_f32 v116, v108, v11
    v_add_f32 v117, v109, v11
    v_add_f32 v118, v110, v11
    v_add_f32 v119, v111, v11
    v_cos_f32 v104, v104
    v_cos_f32 v105, v105
    v_cos_f32 v106, v106
    v_cos_f32 v107, v107
    v_cos_f32 v108, v108
    v_cos_f32 v109, v109
    v_cos_f32 v110, v110
    v_cos_f32 v111, v111
    v_cos_f32 v112, v112
    v_cos_f32 v113, v113
    v_cos_f32 v114, v114
    v_cos_f32 v115, v115
    v_cos_f32 v116, v116
    v_cos_f32 v117, v117
    v_cos_f32 v118, v118
    v_cos_f32 v119, v119
    s_lshl_b32 s32, s3, 11
    v_add_u32 v8, s32, v6
    s_cmp_eq_u32 s3, 0
    s_cbranch_scc1 fz_jb
    v_cvt_pk_f16_f32 v128, v104, v105
    v_cvt_pk_f16_f32 v129, v106, v107
    v_cvt_pk_f16_f32 v130, v108, v109
    v_cvt_pk_f16_f32 v131, v110, v111
    v_cvt_pk_f16_f32 v132, v112, v113
    v_cvt_pk_f16_f32 v133, v114, v115
    v_cvt_pk_f16_f32 v134, v116, v117
    v_cvt_pk_f16_f32 v135, v118, v119
fz_jend:
    ds_write_b128 v8, v[128:131] offset:0
    ds_write_b128 v8, v[132:135] offset:1024
    v_mov_b32 v15, 49520
    v_mov_b32 v10, 0
    v_mov_b32 v11, 0
    ds_write_b64 v15, v[10:11]
    ds_write_b32 v15, v10 offset:8
    s_waitcnt lgkmcnt(0)
    s_barrier
    v_lshlrev_b32 v240, 31, v1
    v_lshrrev_b32 v10, 16, v240
    v_or_b32 v240, v240, v10
    v_mov_b32 v229, 0xfffcfffc
    v_mov_b32 v242, 0xffff0000
    s_mov_b32 s42, 0x3f803f80
    s_cmp_lg_u32 s57, 0
    s_cbranch_scc1 fz_nc1
    ds_read_b128 v[16:19], v6 offset:0
    ds_read_b128 v[20:23], v6 offset:1024
    ds_read_b128 v[24:27], v6 offset:2048
    ds_read_b128 v[28:31], v6 offset:3072
    ds_read_b128 v[32:35], v6 offset:4096
    ds_read_b128 v[36:39], v6 offset:5120
    ds_read_b128 v[40:43], v6 offset:6144
    ds_read_b128 v[44:47], v6 offset:7168
    ds_read_b128 v[48:51], v6 offset:8192
    ds_read_b128 v[52:55], v6 offset:9216
    ds_read_b128 v[56:59], v6 offset:10240
    ds_read_b128 v[60:63], v6 offset:11264
    ds_read_b128 v[64:67], v6 offset:12288
    ds_read_b128 v[68:71], v6 offset:13312
    v_lshlrev_b32 v7, 9, v3
    v_bfe_u32 v10, v1, 2, 2
    v_lshl_add_u32 v7, v10, 6, v7
    v_and_b32 v10, 1, v5
    v_lshl_add_u32 v7, v10, 5, v7
    v_and_b32 v10, 3, v1
    v_lshl_add_u32 v7, v10, 3, v7
    v_add_u32 v7, s31, v7
    v_lshlrev_b32 v8, 9, v3
    v_lshl_add_u32 v8, v2, 1, v8
    v_sub_u32 v9, 2048, v8
    v_and_b32 v9, 2047, v9
    v_add_u32 v9, s30, v9
    s_add_u32 s32, s30, 576
    v_sub_u32 v8, s32, v8
    v_cmp_eq_u32 vcc, 0, v2
    s_nop 1
    v_cndmask_b32_e64 v234, 0, -2.0, vcc
    v_mov_b32 v235, 0x3b27c5ac
    s_lshr_b32 s32, s24, 1
    s_lshl_b32 s32, s32, 6
    s_mul_i32 s33, s3, 2304
    s_add_u32 s32, s32, s33
    s_add_u32 s32, s32, 67968
    v_lshl_add_u32 v10, v3, 1, v1
    v_lshlrev_b32 v10, 4, v10
    v_add_u32 v216, s32, v10
    v_bfe_u32 v10, v0, 2, 1
    v_mul_u32_u24 v10, 34, v10
    v_lshrrev_b32 v11, 4, v0
    v_add_u32 v10, v10, v11
    v_lshlrev_b32 v10, 4, v10
    v_bfe_u32 v11, v0, 3, 1
    v_lshl_add_u32 v10, v11, 3, v10
    v_bfe_u32 v11, v0, 1, 1
    v_lshl_add_u32 v10, v11, 2, v10
    v_and_b32 v12, 1, v0
    s_mov_b32 s33, 9216
    s_cmp_eq_u32 s2, 66
    s_cselect_b32 s32, s33, 0x1b40
    v_mul_lo_u32 v11, v12, s32
    v_add_u32 v217, v10, v11
    v_add_u32 v217, 67968, v217
    s_cselect_b32 s32, s33, 0x940
    v_mul_lo_u32 v11, v12, s32
    v_add_u32 v218, v10, v11
    v_add_u32 v218, 70272, v218
    s_cselect_b32 s32, s33, 0xfffff6c0
    v_mul_lo_u32 v11, v12, s32
    v_add_u32 v219, v10, v11
    v_add_u32 v219, 73792, v219
    s_cselect_b32 s32, s33, 0xffffe4c0
    v_mul_lo_u32 v11, v12, s32
    v_add_u32 v220, v10, v11
    v_add_u32 v220, 76096, v220
    v_lshrrev_b32 v10, 2, v0
    v_and_b32 v11, 3, v0
    v_lshlrev_b32 v11, 4, v11
    v_lshl_add_u32 v221, v10, 7, v11
    s_mul_i32 s52, s20, 16512
    s_lshl_b32 s33, s59, 6
    s_add_u32 s52, s52, s33
    s_add_u32 s52, s52, 0x1000
    s_add_u32 s53, s52, 8192
    v_mov_b32 v160, 0
    v_mov_b32 v161, 0
    v_mov_b32 v162, 0
    v_mov_b32 v163, 0
    s_setprio 3
    s_waitcnt vmcnt(0) lgkmcnt(0)
    ds_read_b64_tr_b16 v[88:89], v7 offset:0
    ds_read_b64_tr_b16 v[90:91], v7 offset:256
    ds_read_b64_tr_b16 v[92:93], v7 offset:1024
    ds_read_b64_tr_b16 v[94:95], v7 offset:1280
    ds_read_u16_d16 v96, v9
    ds_read_u16_d16_hi v136, v8 offset:1408
    ds_read_u16_d16 v97, v8 offset:1344
    ds_read_u16_d16_hi v137, v8 offset:1280
    ds_read_u16_d16 v98, v8 offset:1216
    ds_read_u16_d16_hi v138, v8 offset:1152
    ds_read_u16_d16 v99, v8 offset:1088
    ds_read_u16_d16_hi v139, v8 offset:1024
    s_waitcnt lgkmcnt(8)
    v_mfma_f32_32x32x16_bf16 v[104:119], v[88:91], v[16:19], 0
    v_mfma_f32_32x32x16_bf16 v[104:119], v[92:95], v[20:23], v[104:119]
    ds_read_u16_d16 v100, v8 offset:448
    ds_read_u16_d16_hi v140, v8 offset:384
    ds_read_u16_d16 v101, v8 offset:320
    ds_read_u16_d16_hi v141, v8 offset:256
    ds_read_u16_d16 v102, v8 offset:192
    ds_read_u16_d16_hi v142, v8 offset:128
    ds_read_u16_d16 v103, v8 offset:64
    ds_read_u16_d16_hi v143, v8 offset:0
    v_dot2_f32_bf16 v160, v88, s42, v160
    v_dot2_f32_bf16 v161, v88, v88, v161
    v_dot2_f32_bf16 v160, v89, s42, v160
    v_dot2_f32_bf16 v161, v89, v89, v161
    v_dot2_f32_bf16 v160, v90, s42, v160
    v_dot2_f32_bf16 v161, v90, v90, v161
    v_dot2_f32_bf16 v160, v91, s42, v160
    v_dot2_f32_bf16 v161, v91, v91, v161
    v_dot2_f32_bf16 v160, v92, s42, v160
    v_dot2_f32_bf16 v161, v92, v92, v161
    v_dot2_f32_bf16 v160, v93, s42, v160
    v_dot2_f32_bf16 v161, v93, v93, v161
    v_dot2_f32_bf16 v160, v94, s42, v160
    v_dot2_f32_bf16 v161, v94, v94, v161
    v_dot2_f32_bf16 v160, v95, s42, v160
    v_dot2_f32_bf16 v161, v95, v95, v161
    s_waitcnt lgkmcnt(0)
    v_or_b32 v96, v96, v136
    v_or_b32 v97, v97, v137
    v_or_b32 v98, v98, v138
    v_or_b32 v99, v99, v139
    v_or_b32 v100, v100, v140
    v_or_b32 v101, v101, v141
    v_or_b32 v102, v102, v142
    v_or_b32 v103, v103, v143
    v_mfma_f32_32x32x16_bf16 v[120:135], v[96:99], v[16:19], 0
    s_nop 0
    v_mfma_f32_32x32x16_bf16 v[120:135], v[100:103], v[20:23], v[120:135]
    v_dot2_f32_bf16 v162, v96, s42, v162
    v_dot2_f32_bf16 v163, v96, v96, v163
    v_dot2_f32_bf16 v162, v97, s42, v162
    v_dot2_f32_bf16 v163, v97, v97, v163
    v_dot2_f32_bf16 v162, v98, s42, v162
    v_dot2_f32_bf16 v163, v98, v98, v163
    v_dot2_f32_bf16 v162, v99, s42, v162
    v_dot2_f32_bf16 v163, v99, v99, v163
    v_dot2_f32_bf16 v162, v100, s42, v162
    v_dot2_f32_bf16 v163, v100, v100, v163
    v_dot2_f32_bf16 v162, v101, s42, v162
    v_dot2_f32_bf16 v163, v101, v101, v163
    v_dot2_f32_bf16 v162, v102, s42, v162
    v_dot2_f32_bf16 v163, v102, v102, v163
    v_dot2_f32_bf16 v162, v103, s42, v162
    v_dot2_f32_bf16 v163, v103, v103, v163
    s_nop 1
    v_permlane32_swap_b32 v160, v162
    v_permlane32_swap_b32 v161, v163
    v_add_f32 v160, v160, v162
    v_add_f32 v161, v161, v163
    s_nop 1
    v_permlane16_swap_b32 v160, v161
    v_add_f32 v160, v160, v161
    s_nop 1
    v_add_f32_dpp v160, v160, v160 quad_perm:[1,0,3,2] row_mask:0xf bank_mask:0xf
    s_nop 1
    v_add_f32_dpp v160, v160, v160 quad_perm:[2,3,0,1] row_mask:0xf bank_mask:0xf
    s_nop 1
    v_add_f32_dpp v160, v160, v160 row_half_mirror row_mask:0xf bank_mask:0xf
    s_nop 1
    v_add_f32_dpp v160, v160, v160 row_mirror row_mask:0xf bank_mask:0xf
    s_mov_b32 s43, 0x3e800000
    v_mov_b32 v161, v160
    s_nop 1
    v_permlane16_swap_b32 v160, v161
    v_mul_f32 v160, 0x3c800000, v160
    v_fma_f32 v161, v161, s43, v235
    v_fma_f32 v161, -v160, v160, v161
    v_rsq_f32 v161, v161
    s_nop 0
    v_mul_f32 v160, v160, v161
    v_readlane_b32 s32, v161, 0
    v_readlane_b32 s34, v161, 32
    v_readlane_b32 s36, v160, 0
    v_readlane_b32 s37, v160, 32
    s_nop 0
    v_mul_f32 v164, s36, v234
    v_fmac_f32 v164, s37, v234
    v_pk_fma_f32 v[104:105], v[104:105], s[32:33], v[164:165] op_sel_hi:[1,0,0]
    v_pk_fma_f32 v[106:107], v[106:107], s[32:33], v[164:165] op_sel_hi:[1,0,0]
    v_pk_fma_f32 v[108:109], v[108:109], s[32:33], v[164:165] op_sel_hi:[1,0,0]
    v_pk_fma_f32 v[110:111], v[110:111], s[32:33], v[164:165] op_sel_hi:[1,0,0]
    v_pk_fma_f32 v[112:113], v[112:113], s[32:33], v[164:165] op_sel_hi:[1,0,0]
    v_pk_fma_f32 v[114:115], v[114:115], s[32:33], v[164:165] op_sel_hi:[1,0,0]
    v_pk_fma_f32 v[116:117], v[116:117], s[32:33], v[164:165] op_sel_hi:[1,0,0]
    v_pk_fma_f32 v[118:119], v[118:119], s[32:33], v[164:165] op_sel_hi:[1,0,0]
    v_pk_fma_f32 v[104:105], v[120:121], s[34:35], v[104:105] op_sel_hi:[1,0,1]
    v_pk_fma_f32 v[106:107], v[122:123], s[34:35], v[106:107] op_sel_hi:[1,0,1]
    v_pk_fma_f32 v[108:109], v[124:125], s[34:35], v[108:109] op_sel_hi:[1,0,1]
    v_pk_fma_f32 v[110:111], v[126:127], s[34:35], v[110:111] op_sel_hi:[1,0,1]
    v_pk_fma_f32 v[112:113], v[128:129], s[34:35], v[112:113] op_sel_hi:[1,0,1]
    v_pk_fma_f32 v[114:115], v[130:131], s[34:35], v[114:115] op_sel_hi:[1,0,1]
    v_pk_fma_f32 v[116:117], v[132:133], s[34:35], v[116:117] op_sel_hi:[1,0,1]
    v_pk_fma_f32 v[118:119], v[134:135], s[34:35], v[118:119] op_sel_hi:[1,0,1]
    v_cvt_pk_f16_f32 v136, v104, v105
    v_cvt_pk_f16_f32 v137, v106, v107
    v_cvt_pk_f16_f32 v138, v108, v109
    v_cvt_pk_f16_f32 v139, v110, v111
    v_cvt_pk_f16_f32 v140, v112, v113
    v_cvt_pk_f16_f32 v141, v114, v115
    v_cvt_pk_f16_f32 v142, v116, v117
    v_cvt_pk_f16_f32 v143, v118, v119
    v_mov_b32_dpp v152, v136 quad_perm:[1,0,3,2] row_mask:0xf bank_mask:0xf
    v_mov_b32_dpp v153, v137 quad_perm:[1,0,3,2] row_mask:0xf bank_mask:0xf
    v_mov_b32_dpp v154, v138 quad_perm:[1,0,3,2] row_mask:0xf bank_mask:0xf
    v_mov_b32_dpp v155, v139 quad_perm:[1,0,3,2] row_mask:0xf bank_mask:0xf
    v_mov_b32_dpp v156, v140 quad_perm:[1,0,3,2] row_mask:0xf bank_mask:0xf
    v_mov_b32_dpp v157, v141 quad_perm:[1,0,3,2] row_mask:0xf bank_mask:0xf
    v_mov_b32_dpp v158, v142 quad_perm:[1,0,3,2] row_mask:0xf bank_mask:0xf
    v_mov_b32_dpp v159, v143 quad_perm:[1,0,3,2] row_mask:0xf bank_mask:0xf
    v_pk_mul_f16 v144, v136, v24
    v_pk_mul_f16 v145, v137, v25
    v_pk_mul_f16 v146, v138, v26
    v_pk_mul_f16 v147, v139, v27
    v_pk_mul_f16 v148, v140, v28
    v_pk_mul_f16 v149, v141, v29
    v_pk_mul_f16 v150, v142, v30
    v_pk_mul_f16 v151, v143, v31
    v_mfma_f32_16x16x32_f16 v[120:123], v[136:139], v[56:59], 0
    v_pk_fma_f16 v144, v152, v32, v144
    v_pk_fma_f16 v145, v153, v33, v145
    v_pk_fma_f16 v146, v154, v34, v146
    v_pk_fma_f16 v147, v155, v35, v147
    v_mfma_f32_16x16x32_f16 v[120:123], v[140:143], v[60:63], v[120:123]
    v_pk_fma_f16 v148, v156, v36, v148
    v_pk_fma_f16 v149, v157, v37, v149
    v_pk_fma_f16 v150, v158, v38, v150
    v_pk_fma_f16 v151, v159, v39, v151
    v_mfma_f32_32x32x16_f16 v[104:119], v[144:147], v[40:43], 0
    v_xor_b32_dpp v152, v144, v240 quad_perm:[1,0,3,2] row_mask:0xf bank_mask:0xf
    v_xor_b32_dpp v153, v145, v240 quad_perm:[1,0,3,2] row_mask:0xf bank_mask:0xf
    v_xor_b32_dpp v154, v146, v240 quad_perm:[1,0,3,2] row_mask:0xf bank_mask:0xf
    v_xor_b32_dpp v155, v147, v240 quad_perm:[1,0,3,2] row_mask:0xf bank_mask:0xf
    v_mfma_f32_32x32x16_f16 v[104:119], v[148:151], v[44:47], v[104:119]
    v_xor_b32_dpp v156, v148, v240 quad_perm:[1,0,3,2] row_mask:0xf bank_mask:0xf
    v_xor_b32_dpp v157, v149, v240 quad_perm:[1,0,3,2] row_mask:0xf bank_mask:0xf
    v_xor_b32_dpp v158, v150, v240 quad_perm:[1,0,3,2] row_mask:0xf bank_mask:0xf
    v_xor_b32_dpp v159, v151, v240 quad_perm:[1,0,3,2] row_mask:0xf bank_mask:0xf
    v_mfma_f32_32x32x16_f16 v[104:119], v[152:155], v[48:51], v[104:119]
    s_nop 0
    v_mfma_f32_32x32x16_f16 v[104:119], v[156:159], v[52:55], v[104:119]
    v_mfma_f32_16x16x32_f16 v[124:127], v[136:139], v[64:67], 0
    v_mfma_f32_16x16x32_f16 v[124:127], v[140:143], v[68:71], v[124:127]
    v_readfirstlane_b32 s40, v250
    s_nop 1
    s_add_u32 s40, s40, 1
    s_and_b32 s38, s40, 3
    s_and_b32 s39, s40, 15
    s_bfe_u32 s41, s40, 0x20002
    s_lshl_b32 s41, s41, 16
    s_or_b32 s44, s38, s41
    s_bfe_u32 s41, s40, 0x40004
    s_lshl_b32 s41, s41, 4
    s_or_b32 s48, s39, s41
    s_bfe_u32 s41, s40, 0x20004
    s_lshl_b32 s41, s41, 16
    s_or_b32 s45, s38, s41
    s_bfe_u32 s41, s40, 0x40008
    s_lshl_b32 s41, s41, 4
    s_or_b32 s49, s39, s41
    s_bfe_u32 s41, s40, 0x20006
    s_lshl_b32 s41, s41, 16
    s_or_b32 s46, s38, s41
    s_bfe_u32 s41, s40, 0x4000c
    s_lshl_b32 s41, s41, 4
    s_or_b32 s50, s39, s41
    s_bfe_u32 s41, s40, 0x20008
    s_lshl_b32 s41, s41, 16
    s_or_b32 s47, s38, s41
    s_bfe_u32 s41, s40, 0x40010
    s_lshl_b32 s41, s41, 4
    s_or_b32 s51, s39, s41
    s_mov_b32 s38, 0x404
    s_cmp_eq_u32 s2, 66
    s_cselect_b32 s39, 8, 4
    s_cselect_b32 s38, 8, s38
    s_mov_b64 vcc, 0xffff
    v_cvt_pk_f16_f32 v143, v118, v119
    v_cvt_pk_f16_f32 v142, v116, v117
    v_cvt_pk_f16_f32 v141, v114, v115
    v_cvt_pk_f16_f32 v140, v112, v113
    v_cvt_pk_f16_f32 v139, v110, v111
    v_cvt_pk_f16_f32 v138, v108, v109
    v_cvt_pk_f16_f32 v137, v106, v107
    v_cndmask_b32_e64 v104, v104, v121, vcc
    v_cndmask_b32_e64 v105, v105, v125, vcc
    v_pk_add_f16 v147, v142, v143 op_sel:[0,1] op_sel_hi:[1,0] neg_lo:[0,1]
    v_pk_add_f16 v151, v142, v143 op_sel:[0,1] op_sel_hi:[1,0] neg_hi:[1,0]
    v_pk_add_f16 v146, v140, v141 op_sel:[0,1] op_sel_hi:[1,0] neg_lo:[0,1]
    v_pk_add_f16 v150, v140, v141 op_sel:[0,1] op_sel_hi:[1,0] neg_hi:[1,0]
    v_pk_add_f16 v145, v138, v139 op_sel:[0,1] op_sel_hi:[1,0] neg_lo:[0,1]
    v_pk_add_f16 v149, v138, v139 op_sel:[0,1] op_sel_hi:[1,0] neg_hi:[1,0]
    v_cvt_pk_f16_f32 v136, v104, v105
    v_pk_add_f16 v144, v136, v137 op_sel:[0,1] op_sel_hi:[1,0] neg_lo:[0,1]
    v_pk_add_f16 v148, v136, v137 op_sel:[0,1] op_sel_hi:[1,0] neg_hi:[1,0]
    ds_write_b128 v216, v[144:147]
    ds_write_b128 v216, v[148:151] offset:1152
    s_waitcnt lgkmcnt(0)
    v_mov_b32 v10, 1
    s_mov_b64 exec, 1
    ds_add_u32 v15, v10
    s_mov_b64 exec, -1
    s_cmp_gt_u32 s3, 3
    s_cbranch_scc1 fz_bsp0
fz_sy:
    ds_read_b32 v10, v15
    s_waitcnt lgkmcnt(0)
    v_and_b32 v10, 0xff, v10
    v_cmp_ne_u32 vcc, s39, v10
    s_cbranch_vccnz fz_sy
    ds_read_b32 v104, v217 offset:0
    ds_read_b32 v105, v218 offset:0
    ds_read_b32 v106, v219 offset:0
    ds_read_b32 v107, v220 offset:0
    ds_read_b32 v108, v217 offset:256
    ds_read_b32 v109, v218 offset:256
    ds_read_b32 v110, v219 offset:256
    ds_read_b32 v111, v220 offset:256
    s_waitcnt lgkmcnt(4)
    v_pk_add_f16 v112, v104, v106
    v_pk_add_f16 v114, v105, v107
    v_pk_add_f16 v113, v104, v106 neg_lo:[0,1] neg_hi:[0,1]
    v_pk_add_f16 v115, v105, v107 neg_lo:[0,1] neg_hi:[0,1]
    v_pk_add_f16 v116, v112, v114
    v_pk_add_f16 v118, v112, v114 neg_lo:[0,1] neg_hi:[0,1]
    v_pk_add_f16 v117, v113, v115 op_sel:[0,1] op_sel_hi:[1,0] neg_hi:[0,1]
    v_pk_add_f16 v119, v113, v115 op_sel:[0,1] op_sel_hi:[1,0] neg_lo:[0,1]
    v_add_u32 v116, 0x20002, v116
    v_add_u32 v117, 0x20002, v117
    v_add_u32 v118, 0x20002, v118
    v_add_u32 v119, 0x20002, v119
    v_and_or_b32 v116, v116, v229, s44
    v_and_or_b32 v117, v117, v229, s45
    v_and_or_b32 v118, v118, v229, s46
    v_and_or_b32 v119, v119, v229, s47
    buffer_store_dwordx4 v[116:119], v221, s[4:7], s52 offen sc1
    s_waitcnt lgkmcnt(0)
    v_pk_add_f16 v120, v108, v110
    v_pk_add_f16 v122, v109, v111
    v_pk_add_f16 v121, v108, v110 neg_lo:[0,1] neg_hi:[0,1]
    v_pk_add_f16 v123, v109, v111 neg_lo:[0,1] neg_hi:[0,1]
    v_pk_add_f16 v124, v120, v122
    v_pk_add_f16 v126, v120, v122 neg_lo:[0,1] neg_hi:[0,1]
    v_pk_add_f16 v125, v121, v123 op_sel:[0,1] op_sel_hi:[1,0] neg_hi:[0,1]
    v_pk_add_f16 v127, v121, v123 op_sel:[0,1] op_sel_hi:[1,0] neg_lo:[0,1]
    v_add_u32 v124, 0x20002, v124
    v_add_u32 v125, 0x20002, v125
    v_add_u32 v126, 0x20002, v126
    v_add_u32 v127, 0x20002, v127
    v_and_or_b32 v124, v124, v229, s44
    v_and_or_b32 v125, v125, v229, s45
    v_and_or_b32 v126, v126, v229, s46
    v_and_or_b32 v127, v127, v229, s47
    buffer_store_dwordx4 v[124:127], v221, s[4:7], s53 offen sc1
    s_cmp_lg_u32 s59, 0
    s_cbranch_scc1 ffn
    s_and_b32 s32, s3, 3
    s_lshr_b32 s33, s3, 2
    s_lshl_b32 s33, s33, 4
    s_add_u32 s33, s33, s32
    v_and_b32 v8, 12, v4
    v_bfe_u32 v9, v4, 1, 1
    v_lshl_add_u32 v8, v9, 5, v8
    v_add_u32 v8, s33, v8
    v_cvt_f32_u32 v8, v8
    v_and_b32 v12, 1, v1
    v_cvt_f32_u32 v9, v12
    v_lshlrev_b32 v13, 2, v5
    v_cvt_f32_u32 v10, v13
    v_mul_f32 v11, 0x3c800000, v8
    v_mul_f32 v9, 0x3e800000, v9
    v_fma_f32 v9, v11, v10, v9
    v_mov_b32 v128, v9
    v_fmamk_f32 v129, v11, 0x3f800000, v9
    v_fmamk_f32 v130, v11, 0x40000000, v9
    v_fmamk_f32 v131, v11, 0x40400000, v9
    v_mul_f32 v11, 0x3a000000, v8
    v_lshlrev_b32 v9, 31, v1
    v_xor_b32 v11, v9, v11
    v_mul_f32 v9, v11, v10
    v_mov_b32 v112, v9
    v_fmamk_f32 v113, v11, 0x3f800000, v9
    v_fmamk_f32 v114, v11, 0x40000000, v9
    v_fmamk_f32 v115, v11, 0x40400000, v9
    v_fmamk_f32 v116, v11, 0x41800000, v9
    v_fmamk_f32 v117, v11, 0x41880000, v9
    v_fmamk_f32 v118, v11, 0x41900000, v9
    v_fmamk_f32 v119, v11, 0x41980000, v9
    v_cos_f32 v104, v128
    v_sin_f32 v105, v128
    v_cos_f32 v106, v129
    v_sin_f32 v107, v129
    v_cos_f32 v108, v130
    v_sin_f32 v109, v130
    v_cos_f32 v110, v131
    v_sin_f32 v111, v131
    v_sin_f32 v120, v112
    v_sin_f32 v121, v113
    v_sin_f32 v122, v114
    v_sin_f32 v123, v115
    v_sin_f32 v124, v116
    v_sin_f32 v125, v117
    v_sin_f32 v126, v118
    v_sin_f32 v127, v119
    v_cos_f32 v112, v112
    v_cos_f32 v113, v113
    v_cos_f32 v114, v114
    v_cos_f32 v115, v115
    v_cos_f32 v116, v116
    v_cos_f32 v117, v117
    v_cos_f32 v118, v118
    v_cos_f32 v119, v119
    v_cvt_pk_f16_f32 v16, v104, v105
    v_cvt_pk_f16_f32 v17, v106, v107
    v_cvt_pk_f16_f32 v18, v108, v109
    v_cvt_pk_f16_f32 v19, v110, v111
    v_cvt_pk_f16_f32 v20, v112, v113
    v_cvt_pk_f16_f32 v21, v114, v115
    v_cvt_pk_f16_f32 v22, v116, v117
    v_cvt_pk_f16_f32 v23, v118, v119
    v_cvt_pk_f16_f32 v24, v120, v121
    v_cvt_pk_f16_f32 v25, v122, v123
    v_cvt_pk_f16_f32 v26, v124, v125
    v_cvt_pk_f16_f32 v27, v126, v127
    v_lshrrev_b32 v8, 3, v1
    v_mul_u32_u24 v222, 16512, v8
    v_and_b32 v9, 7, v1
    v_lshl_add_u32 v222, v9, 4, v222
    s_mul_i32 s60, s3, 528384
    s_lshl_b32 s32, s20, 7
    s_add_u32 s60, s60, s32
    s_add_u32 s60, s60, 0x1000
    s_add_u32 s61, s60, 132096
    s_add_u32 s16, s60, 264192
    s_add_u32 s17, s60, 396288
    v_lshlrev_b32 v8, 1, v8
    v_bfe_u32 v9, v1, 2, 1
    v_add_u32 v8, v8, v9
    s_lshl_b32 s32, s3, 2
    s_add_u32 s32, s32, 1
    v_lshl_add_u32 v8, v8, 5, s32
    v_cmp_eq_u32 vcc, 1, v12
    v_bfe_u32 v9, v1, 1, 1
    v_mul_u32_u24 v9, 8256, v9
    v_add_u32 v9, 86400, v9
    s_cmp_eq_u32 s3, 3
    s_cselect_b32 s32, 272, 0
    v_sub_u32 v10, 512, v8
    v_cndmask_b32_e64 v10, v8, v10, vcc
    v_and_b32 v11, 16, v10
    v_lshl_add_u32 v11, v11, 6, v9
    v_lshrrev_b32 v12, 7, v10
    v_lshl_add_u32 v11, v12, 8, v11
    v_and_b32 v12, 15, v10
    v_lshl_add_u32 v11, v12, 4, v11
    v_bfe_u32 v12, v10, 5, 2
    v_lshl_add_u32 v223, v12, 2, v11
    v_add_u32 v8, 1, v8
    v_sub_u32 v10, 512, v8
    v_cndmask_b32_e64 v10, v8, v10, vcc
    v_and_b32 v11, 16, v10
    v_lshl_add_u32 v11, v11, 6, v9
    v_lshrrev_b32 v12, 7, v10
    v_lshl_add_u32 v11, v12, 8, v11
    v_and_b32 v12, 15, v10
    v_lshl_add_u32 v11, v12, 4, v11
    v_bfe_u32 v12, v10, 5, 2
    v_lshl_add_u32 v224, v12, 2, v11
    v_add_u32 v8, 1, v8
    v_sub_u32 v10, 512, v8
    v_cndmask_b32_e64 v10, v8, v10, vcc
    v_and_b32 v11, 16, v10
    v_lshl_add_u32 v11, v11, 6, v9
    v_lshrrev_b32 v12, 7, v10
    v_lshl_add_u32 v11, v12, 8, v11
    v_and_b32 v12, 15, v10
    v_lshl_add_u32 v11, v12, 4, v11
    v_bfe_u32 v12, v10, 5, 2
    v_lshl_add_u32 v100, v12, 2, v11
    v_mul_u32_u24 v10, s32, v3
    v_sub_u32 v8, v8, v10
    v_add_u32 v8, 1, v8
    v_sub_u32 v10, 512, v8
    v_cndmask_b32_e64 v10, v8, v10, vcc
    v_lshrrev_b32 v11, 1, v10
    v_and_b32 v11, 256, v11
    v_sub_u32 v10, v10, v11
    v_and_b32 v11, 16, v10
    v_lshl_add_u32 v11, v11, 6, v9
    v_lshrrev_b32 v12, 7, v10
    v_lshl_add_u32 v11, v12, 8, v11
    v_and_b32 v12, 15, v10
    v_lshl_add_u32 v11, v12, 4, v11
    v_bfe_u32 v12, v10, 5, 2
    v_lshl_add_u32 v101, v12, 2, v11
    s_and_b32 s32, s3, 3
    s_lshl_b32 s32, s32, 11
    s_add_u32 s32, s32, 86400
    v_add_u32 v225, s32, v239
    v_add_u32 v8, s33, v13
    v_sub_u32 v9, 32, v8
    v_min_u32 v9, v8, v9
    v_and_b32 v10, 15, v8
    v_cmp_eq_u32 s[32:33], 0, v10
    v_cmp_lt_u32 s[34:35], 16, v8
    v_lshlrev_b32 v10, 10, v9
    v_subrev_u32 v10, 1024, v10
    v_mov_b32 v11, 15872
    v_cmp_eq_u32 vcc, 0, v8
    s_nop 1
    v_cndmask_b32_e64 v10, v10, v11, vcc
    v_and_b32 v11, 3, v1
    v_lshl_add_u32 v10, v11, 4, v10
    v_lshrrev_b32 v11, 2, v4
    v_lshlrev_b32 v12, 7, v11
    v_sub_u32 v13, 960, v12
    v_cndmask_b32_e64 v13, v12, v13, s[34:35]
    v_add_u32 v226, v10, v13
    s_or_b64 s[34:35], s[34:35], s[32:33]
    v_add_u32 v12, 512, v12
    v_sub_u32 v13, 960, v12
    v_cndmask_b32_e64 v13, v12, v13, s[34:35]
    v_add_u32 v227, v10, v13
    s_mul_i32 s56, s20, 16512
    s_add_u32 s56, s56, 0x210000
    v_mov_b32 v249, 0x30003
    v_mov_b32 v252, s44
    v_mov_b32 v253, s45
    v_mov_b32 v254, s46
    v_mov_b32 v255, s47
    s_waitcnt lgkmcnt(0)
    s_waitcnt vmcnt(0)
    s_bitcmp1_b32 s2, 2
    s_cbranch_scc1 fz_p1_ok
    s_add_u32 s32, s60, 99072
    v_mov_b32 v9, 0
fz_p1:
    buffer_load_dword v10, v9, s[4:7], s32 offen sc1
    s_waitcnt vmcnt(0)
    v_xor_b32 v10, v252, v10
    v_and_b32 v10, v249, v10
    v_cmp_ne_u32 vcc, 0, v10
    s_cbranch_vccnz fz_p1_rt
fz_p1_ok:
    s_mov_b32 s58, 0
    buffer_load_dwordx4 v[104:107], v222, s[4:7], s60 offen sc1
    buffer_load_dwordx4 v[108:111], v222, s[4:7], s61 offen sc1
    buffer_load_dwordx4 v[112:115], v222, s[4:7], s16 offen sc1
    buffer_load_dwordx4 v[116:119], v222, s[4:7], s17 offen sc1
fz_h1_c0:
    s_waitcnt vmcnt(3)
    v_xor_b32 v104, v252, v104
    v_xor_b32 v105, v253, v105
    v_xor_b32 v106, v254, v106
    v_xor_b32 v107, v255, v107
    v_or3_b32 v10, v104, v105, v106
    v_bitop3_b32 v10, v10, v107, v249 bitop3:0xa8
    v_cmp_ne_u32 vcc, 0, v10
    s_cbranch_vccnz fz_h1_r0
fz_h1_o0:
    ds_write_b32 v223, v104 offset:0
    ds_write_b32 v223, v105 offset:2048
    ds_write_b32 v223, v106 offset:4096
    ds_write_b32 v223, v107 offset:6144
fz_h1_c1:
    s_waitcnt vmcnt(2)
    v_xor_b32 v108, v252, v108
    v_xor_b32 v109, v253, v109
    v_xor_b32 v110, v254, v110
    v_xor_b32 v111, v255, v111
    v_or3_b32 v10, v108, v109, v110
    v_bitop3_b32 v10, v10, v111, v249 bitop3:0xa8
    v_cmp_ne_u32 vcc, 0, v10
    s_cbranch_vccnz fz_h1_r1
fz_h1_o1:
    ds_write_b32 v224, v108 offset:0
    ds_write_b32 v224, v109 offset:2048
    ds_write_b32 v224, v110 offset:4096
    ds_write_b32 v224, v111 offset:6144
fz_h1_c2:
    s_waitcnt vmcnt(1)
    v_xor_b32 v112, v252, v112
    v_xor_b32 v113, v253, v113
    v_xor_b32 v114, v254, v114
    v_xor_b32 v115, v255, v115
    v_or3_b32 v10, v112, v113, v114
    v_bitop3_b32 v10, v10, v115, v249 bitop3:0xa8
    v_cmp_ne_u32 vcc, 0, v10
    s_cbranch_vccnz fz_h1_r2
fz_h1_o2:
    ds_write_b32 v100, v112 offset:0
    ds_write_b32 v100, v113 offset:2048
    ds_write_b32 v100, v114 offset:4096
    ds_write_b32 v100, v115 offset:6144
fz_h1_c3:
    s_waitcnt vmcnt(0)
    v_xor_b32 v116, v252, v116
    v_xor_b32 v117, v253, v117
    v_xor_b32 v118, v254, v118
    v_xor_b32 v119, v255, v119
    v_or3_b32 v10, v116, v117, v118
    v_bitop3_b32 v10, v10, v119, v249 bitop3:0xa8
    v_cmp_ne_u32 vcc, 0, v10
    s_cbranch_vccnz fz_h1_r3
fz_h1_o3:
    ds_write_b32 v101, v116 offset:0
    ds_write_b32 v101, v117 offset:2048
    ds_write_b32 v101, v118 offset:4096
    ds_write_b32 v101, v119 offset:6144
    s_waitcnt lgkmcnt(0)
    s_setprio 0
fz_hb:
    s_barrier
    ds_read_b128 v[104:107], v225 offset:0
    ds_read_b128 v[108:111], v225 offset:1024
    ds_read_b128 v[112:115], v225 offset:8256
    ds_read_b128 v[116:119], v225 offset:9280
    ds_read_b128 v[72:75], v6 offset:14336
    ds_read_b128 v[76:79], v6 offset:15360
    ds_read_b128 v[80:83], v6 offset:16384
    ds_read_b128 v[84:87], v6 offset:17408
    s_waitcnt lgkmcnt(7)
    v_mfma_f32_16x16x32_f16 v[120:123], v[104:107], v[16:19], 0
    s_waitcnt lgkmcnt(6)
    v_mfma_f32_16x16x32_f16 v[124:127], v[108:111], v[16:19], 0
    s_waitcnt lgkmcnt(5)
    v_mfma_f32_16x16x32_f16 v[128:131], v[112:115], v[16:19], 0
    s_waitcnt lgkmcnt(4)
    v_mfma_f32_16x16x32_f16 v[132:135], v[116:119], v[16:19], 0
    s_waitcnt lgkmcnt(0)
    s_nop 0
    v_cvt_pk_f16_f32 v136, v120, v121
    v_cvt_pk_f16_f32 v137, v122, v123
    v_cvt_pk_f16_f32 v138, v124, v125
    v_cvt_pk_f16_f32 v139, v126, v127
    v_cvt_pk_f16_f32 v140, v128, v129
    v_cvt_pk_f16_f32 v141, v130, v131
    v_cvt_pk_f16_f32 v142, v132, v133
    v_cvt_pk_f16_f32 v143, v134, v135
    v_pk_mul_f16 v144, v136, v20
    v_pk_mul_f16 v145, v137, v21
    v_pk_mul_f16 v146, v138, v22
    v_pk_mul_f16 v147, v139, v23
    v_mov_b32_dpp v152, v136 quad_perm:[1,0,3,2] row_mask:0xf bank_mask:0xf
    v_mov_b32_dpp v153, v137 quad_perm:[1,0,3,2] row_mask:0xf bank_mask:0xf
    v_mov_b32_dpp v154, v138 quad_perm:[1,0,3,2] row_mask:0xf bank_mask:0xf
    v_mov_b32_dpp v155, v139 quad_perm:[1,0,3,2] row_mask:0xf bank_mask:0xf
    v_pk_fma_f16 v144, v152, v24, v144
    v_pk_fma_f16 v145, v153, v25, v145
    v_pk_fma_f16 v146, v154, v26, v146
    v_pk_fma_f16 v147, v155, v27, v147
    s_nop 1
    v_mfma_f32_16x16x32_f16 v[104:107], v[144:147], v[72:75], 0
    v_mfma_f32_16x16x32_f16 v[108:111], v[144:147], v[80:83], 0
    v_xor_b32_dpp v152, v144, v240 quad_perm:[1,0,3,2] row_mask:0xf bank_mask:0xf
    v_xor_b32_dpp v153, v145, v240 quad_perm:[1,0,3,2] row_mask:0xf bank_mask:0xf
    v_xor_b32_dpp v154, v146, v240 quad_perm:[1,0,3,2] row_mask:0xf bank_mask:0xf
    v_xor_b32_dpp v155, v147, v240 quad_perm:[1,0,3,2] row_mask:0xf bank_mask:0xf
    s_nop 1
    v_mfma_f32_16x16x32_f16 v[104:107], v[152:155], v[76:79], v[104:107]
    v_mfma_f32_16x16x32_f16 v[108:111], v[152:155], v[84:87], v[108:111]
    v_pk_mul_f16 v148, v140, v20
    v_pk_mul_f16 v149, v141, v21
    v_pk_mul_f16 v150, v142, v22
    v_pk_mul_f16 v151, v143, v23
    v_mov_b32_dpp v156, v140 quad_perm:[1,0,3,2] row_mask:0xf bank_mask:0xf
    v_mov_b32_dpp v157, v141 quad_perm:[1,0,3,2] row_mask:0xf bank_mask:0xf
    v_mov_b32_dpp v158, v142 quad_perm:[1,0,3,2] row_mask:0xf bank_mask:0xf
    v_mov_b32_dpp v159, v143 quad_perm:[1,0,3,2] row_mask:0xf bank_mask:0xf
    v_pk_fma_f16 v148, v156, v24, v148
    v_pk_fma_f16 v149, v157, v25, v149
    v_pk_fma_f16 v150, v158, v26, v150
    v_pk_fma_f16 v151, v159, v27, v151
    s_nop 1
    v_mfma_f32_16x16x32_f16 v[112:115], v[148:151], v[72:75], 0
    v_mfma_f32_16x16x32_f16 v[116:119], v[148:151], v[80:83], 0
    v_xor_b32_dpp v156, v148, v240 quad_perm:[1,0,3,2] row_mask:0xf bank_mask:0xf
    v_xor_b32_dpp v157, v149, v240 quad_perm:[1,0,3,2] row_mask:0xf bank_mask:0xf
    v_xor_b32_dpp v158, v150, v240 quad_perm:[1,0,3,2] row_mask:0xf bank_mask:0xf
    v_xor_b32_dpp v159, v151, v240 quad_perm:[1,0,3,2] row_mask:0xf bank_mask:0xf
    s_nop 1
    v_mfma_f32_16x16x32_f16 v[112:115], v[156:159], v[76:79], v[112:115]
    v_mfma_f32_16x16x32_f16 v[116:119], v[156:159], v[84:87], v[116:119]
    v_cvt_pk_f16_f32 v120, v104, v105
    v_cvt_pk_f16_f32 v122, v106, v107
    s_nop 4
    v_cvt_pk_f16_f32 v121, v112, v113
    v_cvt_pk_f16_f32 v123, v114, v115
    v_add_u32 v120, 0x20002, v120
    v_add_u32 v121, 0x20002, v121
    v_add_u32 v122, 0x20002, v122
    v_add_u32 v123, 0x20002, v123
    v_and_or_b32 v120, v120, v229, s44
    v_and_or_b32 v121, v121, v229, s45
    v_and_or_b32 v122, v122, v229, s46
    v_and_or_b32 v123, v123, v229, s47
    buffer_store_dwordx4 v[120:123], v226, s[4:7], s56 offen sc1
    v_cvt_pk_f16_f32 v124, v108, v109
    v_cvt_pk_f16_f32 v126, v110, v111
    v_cvt_pk_f16_f32 v125, v116, v117
    v_cvt_pk_f16_f32 v127, v118, v119
    v_add_u32 v124, 0x20002, v124
    v_add_u32 v125, 0x20002, v125
    v_add_u32 v126, 0x20002, v126
    v_add_u32 v127, 0x20002, v127
    v_and_or_b32 v124, v124, v229, s44
    v_and_or_b32 v125, v125, v229, s45
    v_and_or_b32 v126, v126, v229, s46
    v_and_or_b32 v127, v127, v229, s47
    buffer_store_dwordx4 v[124:127], v227, s[4:7], s56 offen sc1
    s_cmp_lg_u32 s57, 0
    s_cbranch_scc1 fz_nc3
    s_setprio 1
    v_sub_u32 v8, 15, v4
    v_min_u32 v8, v4, v8
    v_and_b32 v9, 1, v8
    v_lshlrev_b32 v9, 5, v9
    v_lshrrev_b32 v10, 1, v8
    v_lshl_add_u32 v9, v10, 9, v9
    v_add_u32 v9, s25, v9
    v_sub_u32 v10, 2048, v9
    v_cmp_lt_u32 s[34:35], 7, v4
    s_nop 1
    v_cndmask_b32_e64 v230, v9, v10, s[34:35]
    v_mov_b32 v9, v4
    v_mov_b32 v10, s20
    s_cmp_lg_u32 s21, 0
    s_cbranch_scc0 fz_spec3a
fz_spec3backa:
    v_lshlrev_b32 v10, 7, v10
    v_lshl_add_u32 v10, v9, 3, v10
    v_mul_u32_u24 v11, 66048, v5
    v_add_u32 v228, v10, v11
    v_and_b32 v9, 1, v9
    v_cmp_eq_u32 vcc, 1, v9
    v_mov_b32 v9, s44
    v_mov_b32 v10, s46
    v_cndmask_b32_e64 v236, v9, v10, vcc
    v_mov_b32 v9, s45
    v_mov_b32 v10, s47
    v_cndmask_b32_e64 v237, v9, v10, vcc
    s_lshl_b32 s32, s3, 2
    v_add_u32 v8, s32, v5
    v_lshlrev_b32 v9, 6, v8
    v_cmp_gt_u32 vcc, 16, v8
    s_nop 1
    v_cndmask_b32_e64 v10, 0, 32, vcc
    v_add_u32 v10, v9, v10
    v_sub_u32 v11, 2048, v10
    v_cmp_eq_u32 vcc, 16, v8
    s_nop 1
    v_cndmask_b32_e64 v11, v11, 0, vcc
    v_mov_b32 v12, 0xffff0000
    v_cndmask_b32_e64 v238, -1, v12, vcc
    v_sub_u32 v12, 2018, v9
    v_mul_u32_u24 v13, 2064, v4
    v_add_u32 v231, v13, v9
    v_add_u32 v232, v13, v12
    v_add_u32 v233, v13, v10
    v_add_u32 v241, v13, v11
    s_lshl_b32 s32, s3, 8
    s_add_u32 s32, s32, 102912
    v_lshlrev_b32 v9, 4, v4
    v_add_u32 v10, s32, v9
    v_add_u32 v11, 107008, v239
    v_cmp_gt_u32 vcc, 16, v1
    s_nop 1
    v_cndmask_b32_e64 v243, v11, v10, vcc
    v_lshrrev_b32 v12, 2, v4
    v_cmp_eq_u32 vcc, v12, v5
    s_nop 1
    v_cndmask_b32_e64 v244, v11, v10, vcc
    v_lshrrev_b32 v12, 5, v1
    v_lshl_add_u32 v10, v12, 10, v9
    v_add_u32 v245, 102912, v10
    v_and_b32 v9, 1, v1
    v_cmp_eq_u32 s[28:29], 1, v9
    v_and_b32 v9, 2, v1
    v_cmp_eq_u32 s[30:31], 2, v9
    s_lshl_b32 s37, s3, 2
    v_add_u32 v9, s37, v5
    v_mul_u32_u24 v246, 2176, v9
    s_lshl_b32 s26, s20, 4
    s_add_u32 s26, s26, 0x580000
    v_lshlrev_b32 v247, 4, v5
    s_lshl_b32 s27, s20, 11
    s_lshl_b32 s37, s3, 8
    s_add_u32 s27, s27, s37
    s_add_u32 s27, s27, 0x448000
    v_sub_u32 v248, 2047, v230
    s_mov_b32 s14, 0x400000
    s_mov_b32 s15, 0x00020000
    s_mul_i32 s52, s3, 264192
    s_add_u32 s52, s52, 0x210000
    s_add_u32 s53, s52, 16512
    s_add_u32 s54, s52, 33024
    s_add_u32 s55, s52, 49536
    s_mov_b32 s23, s63
    s_getreg_b32 s24, hwreg(HW_REG_XCC_ID)
    s_and_b32 s24, s24, 15
    v_lshlrev_b32 v10, 4, v0
    v_min_u32 v10, 4336, v10
    v_add_u32 v10, 108032, v10
    v_mov_b32 v104, 0
    v_mov_b32 v105, 0
    v_mov_b32 v106, 0
    v_mov_b32 v107, 0
    ds_write_b128 v10, v[104:107]
    ds_read_b128 v[116:119], v231
    ds_read_b128 v[120:123], v231 offset:16
    ds_read_u16_d16_hi v44, v241
    ds_read_u16_d16_hi v45, v232 offset:28
    ds_read_u16_d16_hi v46, v232 offset:26
    ds_read_u16_d16_hi v47, v232 offset:24
    ds_read_u16_d16_hi v48, v232 offset:22
    ds_read_u16_d16_hi v49, v232 offset:20
    ds_read_u16_d16_hi v50, v232 offset:18
    ds_read_u16_d16_hi v51, v232 offset:16
    ds_read_u16_d16_hi v52, v232 offset:14
    ds_read_u16_d16_hi v53, v232 offset:12
    ds_read_u16_d16_hi v54, v232 offset:10
    ds_read_u16_d16_hi v55, v232 offset:8
    ds_read_u16_d16_hi v56, v232 offset:6
    ds_read_u16_d16_hi v57, v232 offset:4
    ds_read_u16_d16_hi v58, v232 offset:2
    ds_read_u16_d16_hi v59, v232 offset:0
    ds_read_u16_d16_hi v28, v233
    s_mov_b32 s36, 0xffff0000
    s_waitcnt lgkmcnt(15)
    v_and_b32 v29, s36, v116
    v_lshlrev_b32 v30, 16, v117
    v_and_b32 v31, s36, v117
    v_lshlrev_b32 v32, 16, v118
    v_and_b32 v33, s36, v118
    v_lshlrev_b32 v34, 16, v119
    v_and_b32 v35, s36, v119
    v_lshlrev_b32 v36, 16, v120
    v_and_b32 v37, s36, v120
    v_lshlrev_b32 v38, 16, v121
    v_and_b32 v39, s36, v121
    v_lshlrev_b32 v40, 16, v122
    v_and_b32 v41, s36, v122
    v_lshlrev_b32 v42, 16, v123
    v_and_b32 v43, s36, v123
    v_mul_u32_u24 v13, 2064, v4
    v_subrev_u32 v13, 104960, v13
    v_sub_u32 v9, v231, v13
    v_sub_u32 v10, v233, v13
    v_sub_u32 v11, v241, v13
    v_sub_u32 v12, v232, v13
    s_mov_b32 s36, 0xffff0000
    ds_read_b128 v[200:203], v9
    ds_read_b128 v[204:207], v9 offset:16
    ds_read_u16_d16 v208, v11
    ds_read_u16_d16_hi v124, v12 offset:28
    ds_read_u16_d16 v209, v12 offset:26
    ds_read_u16_d16_hi v125, v12 offset:24
    ds_read_u16_d16 v210, v12 offset:22
    ds_read_u16_d16_hi v126, v12 offset:20
    ds_read_u16_d16 v211, v12 offset:18
    ds_read_u16_d16_hi v127, v12 offset:16
    ds_read_u16_d16 v212, v12 offset:14
    ds_read_u16_d16_hi v128, v12 offset:12
    ds_read_u16_d16 v213, v12 offset:10
    ds_read_u16_d16_hi v129, v12 offset:8
    ds_read_u16_d16 v214, v12 offset:6
    ds_read_u16_d16_hi v130, v12 offset:4
    ds_read_u16_d16 v215, v12 offset:2
    ds_read_u16_d16_hi v131, v12 offset:0
    ds_read_u16_d16 v13, v10
    v_cmp_eq_u32 vcc, 1, v4
    v_mov_b32 v9, s42
    s_nop 0
    v_cndmask_b32_e64 v9, 0, v9, vcc
    v_mov_b32 v116, s42
    v_mov_b32 v117, s42
    v_mov_b32 v118, s42
    v_mov_b32 v119, s42
    v_cmp_eq_u32 vcc, 0, v4
    s_waitcnt lgkmcnt(0)
    v_and_or_b32 v200, v200, s36, v13
    v_or_b32 v208, v208, v124
    v_or_b32 v209, v209, v125
    v_or_b32 v210, v210, v126
    v_or_b32 v211, v211, v127
    v_or_b32 v212, v212, v128
    v_or_b32 v213, v213, v129
    v_or_b32 v214, v214, v130
    v_or_b32 v215, v215, v131
    v_cndmask_b32_e64 v200, v9, v200, vcc
    v_cndmask_b32_e64 v201, v9, v201, vcc
    v_cndmask_b32_e64 v202, v9, v202, vcc
    v_cndmask_b32_e64 v203, v9, v203, vcc
    v_cndmask_b32_e64 v204, v9, v204, vcc
    v_cndmask_b32_e64 v205, v9, v205, vcc
    v_cndmask_b32_e64 v206, v9, v206, vcc
    v_cndmask_b32_e64 v207, v9, v207, vcc
    v_cndmask_b32_e64 v208, v9, v208, vcc
    v_cndmask_b32_e64 v209, v9, v209, vcc
    v_cndmask_b32_e64 v210, v9, v210, vcc
    v_cndmask_b32_e64 v211, v9, v211, vcc
    v_cndmask_b32_e64 v212, v9, v212, vcc
    v_cndmask_b32_e64 v213, v9, v213, vcc
    v_cndmask_b32_e64 v214, v9, v214, vcc
    v_cndmask_b32_e64 v215, v9, v215, vcc
    v_mfma_f32_16x16x32_bf16 v[120:123], v[200:203], v[116:119], 0
    v_mfma_f32_16x16x32_bf16 v[120:123], v[204:207], v[116:119], v[120:123]
    v_mfma_f32_16x16x32_bf16 v[120:123], v[208:211], v[116:119], v[120:123]
    v_mfma_f32_16x16x32_bf16 v[120:123], v[212:215], v[116:119], v[120:123]
    s_nop 7
    ds_write_b32 v243, v120 offset:12
    s_mov_b32 s58, 0
    s_waitcnt vmcnt(0)
fz_h2:
    buffer_load_dwordx2 v[104:105], v228, s[4:7], s52 offen sc1
    buffer_load_dwordx2 v[106:107], v228, s[4:7], s53 offen sc1
    buffer_load_dwordx2 v[108:109], v228, s[4:7], s54 offen sc1
    buffer_load_dwordx2 v[110:111], v228, s[4:7], s55 offen sc1
fz_h2c:
    s_setprio 0
    s_mov_b32 s36, 0x43000000
fz_h2_c0:
    s_waitcnt vmcnt(3)
    v_xor_b32 v104, v236, v104
    v_xor_b32 v105, v237, v105
    v_bitop3_b32 v9, v104, v105, v249 bitop3:0xa8
    v_cmp_ne_u32 vcc, 0, v9
    s_cbranch_vccnz fz_h2_r0
fz_h2_o0:
    v_mov_b32_dpp v112, v104 row_mirror row_mask:0xf bank_mask:0xf
    v_mov_b32_dpp v113, v105 row_mirror row_mask:0xf bank_mask:0xf
    s_cmp_eq_u32 s2, 66
    s_cbranch_scc1 fz_spec40
fz_spec4back0:
    v_fma_mix_f32 v28, v104, s36, v28 op_sel:[0,0,0] op_sel_hi:[1,0,0]
    v_fma_mix_f32 v29, v104, s36, v29 op_sel:[1,0,0] op_sel_hi:[1,0,0]
    v_fma_mix_f32 v30, v105, s36, v30 op_sel:[0,0,0] op_sel_hi:[1,0,0]
    v_fma_mix_f32 v31, v105, s36, v31 op_sel:[1,0,0] op_sel_hi:[1,0,0]
    v_and_b32 v112, v238, v112
    v_fma_mix_f32 v44, v112, s36, v44 op_sel:[0,0,0] op_sel_hi:[1,0,0]
    v_fma_mix_f32 v45, v112, s36, v45 op_sel:[1,0,0] op_sel_hi:[1,0,0]
    v_fma_mix_f32 v46, v113, s36, v46 op_sel:[0,0,0] op_sel_hi:[1,0,0]
    v_fma_mix_f32 v47, v113, s36, v47 op_sel:[1,0,0] op_sel_hi:[1,0,0]
    v_cvt_pk_bf16_f32 v120, v28, v29
    v_cvt_pk_bf16_f32 v121, v30, v31
    v_cvt_pk_bf16_f32 v128, v44, v45
    v_cvt_pk_bf16_f32 v129, v46, v47
fz_h2_c1:
    s_waitcnt vmcnt(2)
    v_xor_b32 v106, v236, v106
    v_xor_b32 v107, v237, v107
    v_bitop3_b32 v9, v106, v107, v249 bitop3:0xa8
    v_cmp_ne_u32 vcc, 0, v9
    s_cbranch_vccnz fz_h2_r1
fz_h2_o1:
    v_mov_b32_dpp v114, v106 row_mirror row_mask:0xf bank_mask:0xf
    v_mov_b32_dpp v115, v107 row_mirror row_mask:0xf bank_mask:0xf
    s_cmp_eq_u32 s2, 66
    s_cbranch_scc1 fz_spec41
fz_spec4back1:
    v_fma_mix_f32 v32, v106, s36, v32 op_sel:[0,0,0] op_sel_hi:[1,0,0]
    v_fma_mix_f32 v33, v106, s36, v33 op_sel:[1,0,0] op_sel_hi:[1,0,0]
    v_fma_mix_f32 v34, v107, s36, v34 op_sel:[0,0,0] op_sel_hi:[1,0,0]
    v_fma_mix_f32 v35, v107, s36, v35 op_sel:[1,0,0] op_sel_hi:[1,0,0]
    v_fma_mix_f32 v48, v114, s36, v48 op_sel:[0,0,0] op_sel_hi:[1,0,0]
    v_fma_mix_f32 v49, v114, s36, v49 op_sel:[1,0,0] op_sel_hi:[1,0,0]
    v_fma_mix_f32 v50, v115, s36, v50 op_sel:[0,0,0] op_sel_hi:[1,0,0]
    v_fma_mix_f32 v51, v115, s36, v51 op_sel:[1,0,0] op_sel_hi:[1,0,0]
    v_cvt_pk_bf16_f32 v122, v32, v33
    v_cvt_pk_bf16_f32 v123, v34, v35
    v_cvt_pk_bf16_f32 v130, v48, v49
    v_cvt_pk_bf16_f32 v131, v50, v51
    v_mfma_f32_16x16x32_bf16 v[136:139], v[120:123], v[120:123], 0
    v_mfma_f32_16x16x32_bf16 v[140:143], v[200:203], v[120:123], 0
    v_mfma_f32_16x16x32_bf16 v[136:139], v[128:131], v[128:131], v[136:139]
    v_mfma_f32_16x16x32_bf16 v[140:143], v[208:211], v[128:131], v[140:143]
fz_h2_c2:
    s_waitcnt vmcnt(1)
    v_xor_b32 v108, v236, v108
    v_xor_b32 v109, v237, v109
    v_bitop3_b32 v9, v108, v109, v249 bitop3:0xa8
    v_cmp_ne_u32 vcc, 0, v9
    s_cbranch_vccnz fz_h2_r2
fz_h2_o2:
    v_mov_b32_dpp v116, v108 row_mirror row_mask:0xf bank_mask:0xf
    v_mov_b32_dpp v117, v109 row_mirror row_mask:0xf bank_mask:0xf
    s_cmp_eq_u32 s2, 66
    s_cbranch_scc1 fz_spec42
fz_spec4back2:
    v_fma_mix_f32 v36, v108, s36, v36 op_sel:[0,0,0] op_sel_hi:[1,0,0]
    v_fma_mix_f32 v37, v108, s36, v37 op_sel:[1,0,0] op_sel_hi:[1,0,0]
    v_fma_mix_f32 v38, v109, s36, v38 op_sel:[0,0,0] op_sel_hi:[1,0,0]
    v_fma_mix_f32 v39, v109, s36, v39 op_sel:[1,0,0] op_sel_hi:[1,0,0]
    v_fma_mix_f32 v52, v116, s36, v52 op_sel:[0,0,0] op_sel_hi:[1,0,0]
    v_fma_mix_f32 v53, v116, s36, v53 op_sel:[1,0,0] op_sel_hi:[1,0,0]
    v_fma_mix_f32 v54, v117, s36, v54 op_sel:[0,0,0] op_sel_hi:[1,0,0]
    v_fma_mix_f32 v55, v117, s36, v55 op_sel:[1,0,0] op_sel_hi:[1,0,0]
    v_cvt_pk_bf16_f32 v124, v36, v37
    v_cvt_pk_bf16_f32 v125, v38, v39
    v_cvt_pk_bf16_f32 v132, v52, v53
    v_cvt_pk_bf16_f32 v133, v54, v55
fz_h2_c3:
    s_waitcnt vmcnt(0)
    v_xor_b32 v110, v236, v110
    v_xor_b32 v111, v237, v111
    v_bitop3_b32 v9, v110, v111, v249 bitop3:0xa8
    v_cmp_ne_u32 vcc, 0, v9
    s_cbranch_vccnz fz_h2_r3
fz_h2_o3:
    v_mov_b32_dpp v118, v110 row_mirror row_mask:0xf bank_mask:0xf
    v_mov_b32_dpp v119, v111 row_mirror row_mask:0xf bank_mask:0xf
    s_cmp_eq_u32 s2, 66
    s_cbranch_scc1 fz_spec43
fz_spec4back3:
    v_fma_mix_f32 v40, v110, s36, v40 op_sel:[0,0,0] op_sel_hi:[1,0,0]
    v_fma_mix_f32 v41, v110, s36, v41 op_sel:[1,0,0] op_sel_hi:[1,0,0]
    v_fma_mix_f32 v42, v111, s36, v42 op_sel:[0,0,0] op_sel_hi:[1,0,0]
    v_fma_mix_f32 v43, v111, s36, v43 op_sel:[1,0,0] op_sel_hi:[1,0,0]
    v_fma_mix_f32 v56, v118, s36, v56 op_sel:[0,0,0] op_sel_hi:[1,0,0]
    v_fma_mix_f32 v57, v118, s36, v57 op_sel:[1,0,0] op_sel_hi:[1,0,0]
    v_fma_mix_f32 v58, v119, s36, v58 op_sel:[0,0,0] op_sel_hi:[1,0,0]
    v_fma_mix_f32 v59, v119, s36, v59 op_sel:[1,0,0] op_sel_hi:[1,0,0]
    v_cvt_pk_bf16_f32 v126, v40, v41
    v_cvt_pk_bf16_f32 v127, v42, v43
    v_cvt_pk_bf16_f32 v134, v56, v57
    v_cvt_pk_bf16_f32 v135, v58, v59
    v_mfma_f32_16x16x32_bf16 v[136:139], v[124:127], v[124:127], v[136:139]
    v_mfma_f32_16x16x32_bf16 v[140:143], v[204:207], v[124:127], v[140:143]
    v_mfma_f32_16x16x32_bf16 v[136:139], v[132:135], v[132:135], v[136:139]
    v_mfma_f32_16x16x32_bf16 v[140:143], v[212:215], v[132:135], v[140:143]
    s_nop 6
    v_cndmask_b32_e64 v9, v136, v137, s[28:29]
    v_cndmask_b32_e64 v10, v138, v139, s[28:29]
    ds_write_b64 v243, v[140:141]
    v_cndmask_b32_e64 v9, v9, v10, s[30:31]
    ds_write_b32 v244, v9 offset:8
    s_cmp_gt_u32 s3, 3
    s_cbranch_scc1 fz_lp
    s_setprio 2
fz_lp:
    s_waitcnt lgkmcnt(0)
    s_barrier
    ds_read_b128 v[144:147], v245 offset:0
    ds_read_b128 v[148:151], v245 offset:256
    ds_read_b128 v[152:155], v245 offset:512
    ds_read_b128 v[156:159], v245 offset:768
    s_waitcnt lgkmcnt(2)
    v_pk_add_f32 v[144:145], v[144:145], v[148:149]
    v_pk_add_f32 v[146:147], v[146:147], v[150:151]
    s_waitcnt lgkmcnt(0)
    v_pk_add_f32 v[152:153], v[152:153], v[156:157]
    v_pk_add_f32 v[154:155], v[154:155], v[158:159]
    v_pk_add_f32 v[144:145], v[144:145], v[152:153]
    v_pk_add_f32 v[146:147], v[146:147], v[154:155]
    v_mov_b32 v148, v144
    v_mov_b32 v149, v145
    v_mov_b32 v150, v146
    v_mov_b32 v151, v147
    v_permlane32_swap_b32 v144, v148
    v_permlane32_swap_b32 v145, v149
    v_permlane32_swap_b32 v146, v150
    v_permlane32_swap_b32 v147, v151
    v_pk_add_f32 v[144:145], v[144:145], v[148:149]
    v_pk_add_f32 v[146:147], v[146:147], v[150:151]
    v_mul_f32 v145, 0xba800000, v145
    v_mul_f32 v146, 0x3a800000, v146
    v_fma_f32 v146, -v145, v145, v146
    v_cvt_pk_bf16_f32 v153, 0, v145
    v_cvt_pk_bf16_f32 v146, 0, v146
    v_add_f32 v146, 0x3727c5ac, v146
    v_cvt_pk_bf16_f32 v146, 0, v146
    v_sqrt_f32 v146, v146
    v_fmac_f32 v144, v153, v147
    v_cvt_pk_bf16_f32 v146, 0, v146
    v_rcp_f32 v154, v146
    v_mov_b32 v155, s40
    v_mul_f32 v144, v144, v154
    v_cvt_pk_bf16_f32 v144, 0, v144
    v_ashrrev_i32 v145, 31, v144
    v_or_b32 v145, 0x80000000, v145
    v_bitop3_b32 v152, v144, v145, v242 bitop3:0x28
    v_or_b32 v152, v152, v248
    s_nop 1
    v_max_u32_dpp v144, v152, v152 row_ror:1 row_mask:0xf bank_mask:0xf
    s_nop 1
    v_max_u32_dpp v144, v144, v144 row_ror:2 row_mask:0xf bank_mask:0xf
    s_nop 1
    v_max_u32_dpp v144, v144, v144 row_ror:4 row_mask:0xf bank_mask:0xf
    s_nop 1
    v_max_u32_dpp v144, v144, v144 row_ror:8 row_mask:0xf bank_mask:0xf
    v_cmp_eq_u32 vcc, v144, v152
    v_or_b32 v153, s24, v153
    s_nop 0
    s_mov_b64 exec, vcc
    buffer_store_dwordx4 v[152:155], v246, s[4:7], s26 offen sc1
    s_add_u32 s26, s26, 69632
    buffer_store_dwordx4 v[152:155], v246, s[4:7], s26 offen sc1
    buffer_store_dwordx4 v[120:123], v247, s[4:7], s27 offen offset:0 sc1
    buffer_store_dwordx4 v[124:127], v247, s[4:7], s27 offen offset:64 sc1
    buffer_store_dwordx4 v[128:131], v247, s[4:7], s27 offen offset:128 sc1
    buffer_store_dwordx4 v[132:135], v247, s[4:7], s27 offen offset:192 sc1
    s_mov_b64 exec, -1
    s_setprio 0
    s_ff1_i32_b64 s37, vcc
    v_add_f32 v144, 1.0, v154
    v_and_b32 v146, v242, v153
    v_mul_f32 v146, v146, v154
    v_pk_fma_f32 v[28:29], v[28:29], v[144:145], v[146:147] op_sel_hi:[1,0,0]
    v_pk_fma_f32 v[30:31], v[30:31], v[144:145], v[146:147] op_sel_hi:[1,0,0]
    v_pk_fma_f32 v[32:33], v[32:33], v[144:145], v[146:147] op_sel_hi:[1,0,0]
    v_pk_fma_f32 v[34:35], v[34:35], v[144:145], v[146:147] op_sel_hi:[1,0,0]
    v_pk_fma_f32 v[36:37], v[36:37], v[144:145], v[146:147] op_sel_hi:[1,0,0]
    v_pk_fma_f32 v[38:39], v[38:39], v[144:145], v[146:147] op_sel_hi:[1,0,0]
    v_pk_fma_f32 v[40:41], v[40:41], v[144:145], v[146:147] op_sel_hi:[1,0,0]
    v_pk_fma_f32 v[42:43], v[42:43], v[144:145], v[146:147] op_sel_hi:[1,0,0]
    v_pk_fma_f32 v[44:45], v[44:45], v[144:145], v[146:147] op_sel_hi:[1,0,0]
    v_pk_fma_f32 v[46:47], v[46:47], v[144:145], v[146:147] op_sel_hi:[1,0,0]
    v_pk_fma_f32 v[48:49], v[48:49], v[144:145], v[146:147] op_sel_hi:[1,0,0]
    v_pk_fma_f32 v[50:51], v[50:51], v[144:145], v[146:147] op_sel_hi:[1,0,0]
    v_pk_fma_f32 v[52:53], v[52:53], v[144:145], v[146:147] op_sel_hi:[1,0,0]
    v_pk_fma_f32 v[54:55], v[54:55], v[144:145], v[146:147] op_sel_hi:[1,0,0]
    v_pk_fma_f32 v[56:57], v[56:57], v[144:145], v[146:147] op_sel_hi:[1,0,0]
    v_pk_fma_f32 v[58:59], v[58:59], v[144:145], v[146:147] op_sel_hi:[1,0,0]
    v_cvt_pk_bf16_f32 v104, v28, v29
    v_cvt_pk_bf16_f32 v105, v30, v31
    v_cvt_pk_bf16_f32 v106, v32, v33
    v_cvt_pk_bf16_f32 v107, v34, v35
    v_cvt_pk_bf16_f32 v108, v36, v37
    v_cvt_pk_bf16_f32 v109, v38, v39
    v_cvt_pk_bf16_f32 v110, v40, v41
    v_cvt_pk_bf16_f32 v111, v42, v43
    v_cvt_pk_bf16_f32 v112, v44, v45
    v_cvt_pk_bf16_f32 v113, v46, v47
    v_cvt_pk_bf16_f32 v114, v48, v49
    v_cvt_pk_bf16_f32 v115, v50, v51
    v_cvt_pk_bf16_f32 v116, v52, v53
    v_cvt_pk_bf16_f32 v117, v54, v55
    v_cvt_pk_bf16_f32 v118, v56, v57
    v_cvt_pk_bf16_f32 v119, v58, v59
    ds_write_b128 v231, v[104:107]
    ds_write_b128 v231, v[108:111] offset:16
    s_waitcnt lgkmcnt(0)
    s_barrier
    s_cmp_lt_u32 s3, 4
    s_cbranch_scc1 fz_now4
    buffer_load_dwordx4 v[192:195], v14, s[64:67], s62 offen offset:0 nt
    buffer_load_dwordx4 v[196:199], v14, s[64:67], s62 offen offset:256 nt
    s_add_u32 s62, s62, 8192
    buffer_load_dwordx4 v[60:63], v14, s[64:67], s62 offen offset:0 nt
    buffer_load_dwordx4 v[64:67], v14, s[64:67], s62 offen offset:256 nt
    s_add_u32 s62, s62, 8192
    buffer_load_dwordx4 v[68:71], v14, s[64:67], s62 offen offset:0 nt
    buffer_load_dwordx4 v[88:91], v14, s[64:67], s62 offen offset:256 nt
    s_add_u32 s62, s62, 8192
    buffer_load_dwordx4 v[92:95], v14, s[64:67], s62 offen offset:0 nt
    buffer_load_dwordx4 v[96:99], v14, s[64:67], s62 offen offset:256 nt
fz_now4:
    ds_write_b16 v233, v104
    ds_write_b16 v241, v112
    ds_write_b16_d16_hi v232, v112 offset:28
    ds_write_b16 v232, v113 offset:26
    ds_write_b16_d16_hi v232, v113 offset:24
    ds_write_b16 v232, v114 offset:22
    ds_write_b16_d16_hi v232, v114 offset:20
    ds_write_b16 v232, v115 offset:18
    ds_write_b16_d16_hi v232, v115 offset:16
    ds_write_b16 v232, v116 offset:14
    ds_write_b16_d16_hi v232, v116 offset:12
    ds_write_b16 v232, v117 offset:10
    ds_write_b16_d16_hi v232, v117 offset:8
    ds_write_b16 v232, v118 offset:6
    ds_write_b16_d16_hi v232, v118 offset:4
    ds_write_b16 v232, v119 offset:2
    ds_write_b16_d16_hi v232, v119 offset:0
    s_lshl_b32 s32, s3, 1
    s_add_u32 s33, s32, 1
    v_readlane_b32 s34, v230, s32
    v_readlane_b32 s35, v230, s33
    s_mul_i32 s38, s3, 4128
    v_add_u32 v9, s38, v239
    s_lshl_b32 s34, s34, 11
    s_lshl_b32 s35, s35, 11
    s_waitcnt lgkmcnt(0)
    s_barrier
    ds_read_b128 v[104:107], v9 offset:0
    ds_read_b128 v[108:111], v9 offset:1024
    ds_read_b128 v[112:115], v9 offset:2064
    ds_read_b128 v[116:119], v9 offset:3088
    s_lshr_b32 s59, s37, 1
    s_xor_b32 s18, s59, 1
    s_and_b32 s18, s18, 3
    s_and_b32 s59, s59, 3
    s_cmp_lt_u32 s23, 112
    s_cselect_b32 s38, s18, 8
    s_cmp_eq_u32 s38, s3
    s_cbranch_scc1 fz_sk1
    s_cmp_eq_u32 s59, s3
    s_cbranch_scc1 fz_sk1
    s_waitcnt lgkmcnt(0)
    s_cmp_eq_u32 s37, s32
    s_cbranch_scc1 fz_sk0
    buffer_store_dwordx4 v[104:107], v239, s[12:15], s34 offen offset:0 sc1
    buffer_store_dwordx4 v[108:111], v239, s[12:15], s34 offen offset:1024 sc1
fz_sk0:
    s_cmp_eq_u32 s37, s33
    s_cbranch_scc1 fz_sk1
    buffer_store_dwordx4 v[112:115], v239, s[12:15], s35 offen offset:0 sc1
    buffer_store_dwordx4 v[116:119], v239, s[12:15], s35 offen offset:1024 sc1
fz_sk1:
    v_and_b32 v15, 7, v4
    v_mul_u32_u24 v15, 544, v15
    v_lshl_add_u32 v15, v5, 4, v15
    v_add_u32 v15, 108032, v15
    s_lshl_b32 s63, s23, 5
    s_and_b32 s38, s3, 3
    s_mul_i32 s38, s38, 118784
    s_add_u32 s63, s63, s38
    s_add_u32 s63, s63, 0x4c8000
    v_lshrrev_b32 v13, 1, v1
    v_mul_u32_u24 v13, 3712, v13
    v_and_b32 v14, 1, v1
    v_lshl_add_u32 v102, v14, 4, v13
    v_add_u32 v103, 59392, v102
    v_mov_b32 v101, 49520
    v_mov_b32 v14, 0xffffff00
    s_cmp_eq_u32 s18, s3
    s_cbranch_scc1 fz_act
    s_cmp_eq_u32 s59, s3
    s_cbranch_scc1 fz_coll
    s_cmp_lt_u32 s3, 4
    s_cbranch_scc1 fz_xend
    s_branch fz_f2
fz_coll:
    s_mul_i32 s16, s37, 2064
    v_add_u32 v9, s16, v239
    v_readlane_b32 s16, v230, s37
    ds_read_b128 v[120:123], v9
    ds_read_b128 v[124:127], v9 offset:1024
    s_lshl_b32 s16, s16, 11
    s_and_b32 s38, s20, 15
    s_add_u32 s38, s38, 16
    s_mul_i32 s38, s38, 2176
    s_add_u32 s38, s38, 0x580000
    s_lshr_b32 s52, s20, 4
    s_lshl_b32 s52, s52, 7
    s_and_b32 s53, s20, 7
    s_lshl_b32 s53, s53, 4
    s_add_u32 s52, s52, s53
    s_bfe_u32 s53, s20, 0x10003
    s_lshl_b32 s53, s53, 2
    s_add_u32 s52, s52, s53
    v_and_b32 v2, 1, v1
    v_lshl_add_u32 v2, v2, 3, v5
    v_add_u32 v2, s52, v2
    v_and_b32 v3, 31, v2
    v_lshrrev_b32 v6, 5, v2
    v_cmp_gt_u32 vcc, 16, v6
    v_cmp_lt_u32 s[52:53], 16, v3
    v_cmp_eq_u32 s[54:55], 0, v3
    s_nop 1
    s_and_b64 s[54:55], s[54:55], vcc
    s_or_b64 s[52:53], s[52:53], s[54:55]
    v_cmp_eq_u32 s[54:55], 16, v3
    s_nop 1
    s_andn2_b64 s[54:55], s[54:55], vcc
    s_or_b64 s[52:53], s[52:53], s[54:55]
    v_sub_u32 v7, 1024, v2
    v_cndmask_b32_e64 v7, v2, v7, s[52:53]
    v_mov_b32 v8, 512
    v_cmp_eq_u32 vcc, 1024, v7
    s_nop 1
    v_cndmask_b32_e64 v7, v7, v8, vcc
    v_lshrrev_b32 v8, 5, v7
    v_and_b32 v7, 15, v7
    v_lshrrev_b32 v9, 2, v8
    v_lshlrev_b32 v9, 8, v9
    v_and_b32 v8, 3, v8
    v_lshl_add_u32 v9, v8, 4, v9
    v_lshrrev_b32 v8, 3, v7
    v_lshl_add_u32 v9, v8, 6, v9
    v_and_b32 v7, 7, v7
    v_lshl_add_u32 v9, v7, 1, v9
    v_cndmask_b32_e64 v7, 0, 1, s[52:53]
    v_lshl_add_u32 v9, v7, 7, v9
    v_lshlrev_b32 v2, 1, v2
    v_lshrrev_b32 v3, 1, v1
    v_mul_u32_u24 v3, 32, v3
    v_and_b32 v6, 1, v1
    v_lshl_add_u32 v3, v6, 4, v3
    v_mov_b32 v6, 0x7fffffff
    v_cmp_gt_u32 vcc, 32, v1
    s_nop 1
    v_cndmask_b32_e64 v6, v6, v3, vcc
    v_mov_b32 v7, s48
    v_cndmask_b32_e64 v16, 0, v7, vcc
    v_mov_b32 v7, s49
    v_cndmask_b32_e64 v17, 0, v7, vcc
    v_mov_b32 v7, s50
    v_cndmask_b32_e64 v18, 0, v7, vcc
    v_mov_b32 v7, s51
    v_cndmask_b32_e64 v19, 0, v7, vcc
    s_mul_i32 s52, s20, 3712
    s_add_u32 s52, s52, 0x4c8000
    s_add_u32 s53, s52, 1024
    s_add_u32 s54, s52, 2048
    s_add_u32 s55, s52, 3072
    v_lshlrev_b32 v20, 4, v1
    v_add_u32 v21, 1024, v20
    s_mov_b32 s58, 0
    s_nop 3
fz_k2:
    buffer_load_dwordx4 v[24:27], v20, s[4:7], s38 offen sc1
    buffer_load_dwordx4 v[28:31], v21, s[4:7], s38 offen sc1
    s_waitcnt vmcnt(0)
    v_xor_b32 v32, s40, v27
    v_xor_b32 v33, s40, v31
    v_max_u32 v34, v24, v28
    v_or_b32 v32, v32, v33
    v_cmp_ne_u32 vcc, 0, v32
    s_cbranch_vccnz fz_k2_rt
fz_k2_ok:
    v_max_u32_dpp v34, v34, v34 quad_perm:[1,0,3,2] row_mask:0xf bank_mask:0xf
    s_nop 1
    v_max_u32_dpp v34, v34, v34 quad_perm:[2,3,0,1] row_mask:0xf bank_mask:0xf
    s_nop 1
    v_max_u32_dpp v34, v34, v34 row_half_mirror row_mask:0xf bank_mask:0xf
    s_nop 1
    v_max_u32_dpp v34, v34, v34 row_mirror row_mask:0xf bank_mask:0xf
    s_nop 1
    v_max_u32_dpp v34, v34, v34 row_bcast:15 row_mask:0xa bank_mask:0xf
    s_nop 1
    v_max_u32_dpp v34, v34, v34 row_bcast:31 row_mask:0xc bank_mask:0xf
    s_nop 0
    v_readlane_b32 s36, v34, 63
    s_nop 1
    v_cmp_eq_u32 vcc, s36, v24
    v_cmp_eq_u32 s[56:57], s36, v28
    s_nop 1
    v_cndmask_b32_e64 v25, v25, v29, s[56:57]
    v_cndmask_b32_e64 v26, v26, v30, s[56:57]
    s_cmp_lg_u64 vcc, 0
    s_cselect_b32 s39, 0, 64
    s_or_b64 vcc, vcc, s[56:57]
    s_ff1_i32_b64 s41, vcc
    v_readlane_b32 s42, v25, s41
    v_readlane_b32 s43, v26, s41
    s_add_u32 s39, s39, s41
    s_and_b32 s42, s42, 0xffff0000
    s_cmp_eq_u32 s39, s20
    s_cselect_b32 s16, 0x7ff00000, s16
    s_mov_b32 s19, s37
    s_lshl_b32 s39, s39, 11
    s_add_u32 s39, s39, 0x448000
    s_mov_b32 s58, 0
    s_mov_b32 s41, 0xffff0000
    s_nop 0
fz_c2:
    buffer_load_short_d16_hi v10, v9, s[4:7], s39 offen sc1
    s_waitcnt vmcnt(0)
    v_cmp_eq_u32 vcc, s41, v10
    s_cbranch_vccnz fz_c2_rt
fz_c2_ok:
    s_waitcnt lgkmcnt(0)
    buffer_store_dwordx4 v[120:123], v239, s[12:15], s16 offen offset:0 sc1
    buffer_store_dwordx4 v[124:127], v239, s[12:15], s16 offen offset:1024 sc1
    s_cmp_eq_u32 s19, s32
    s_cbranch_scc1 fz_sc0
    buffer_store_dwordx4 v[104:107], v239, s[12:15], s34 offen offset:0 sc1
    buffer_store_dwordx4 v[108:111], v239, s[12:15], s34 offen offset:1024 sc1
fz_sc0:
    s_cmp_eq_u32 s19, s33
    s_cbranch_scc1 fz_sc1
    buffer_store_dwordx4 v[112:115], v239, s[12:15], s35 offen offset:0 sc1
    buffer_store_dwordx4 v[116:119], v239, s[12:15], s35 offen offset:1024 sc1
fz_sc1:
    v_add_f32 v11, s42, v10
    v_cvt_pk_bf16_f32 v11, 0, v11
    v_mul_f32 v11, s43, v11
    v_cvt_pk_bf16_f32 v11, 0, v11
    s_ashr_i32 s39, s36, 31
    s_not_b32 s39, s39
    s_or_b32 s39, s39, 0x80000000
    s_xor_b32 s39, s36, s39
    s_and_b32 s39, s39, 0xffff0000
    v_mov_b32 v12, s39
    v_mul_f32 v12, 0xbfb8aa3b, v12
    v_exp_f32 v12, v12
    s_nop 0
    v_add_f32 v12, 1.0, v12
    v_rcp_f32 v12, v12
    s_nop 0
    v_cvt_pk_bf16_f32 v12, 0, v12
    s_and_b32 s39, s36, 0xffff
    s_sub_u32 s39, 2047, s39
    s_lshl_b32 s39, s39, 11
    v_mov_b32 v13, 0xff
    s_waitcnt lgkmcnt(0)
fz_f2:
    s_cmp_gt_u32 s23, 111
    s_cbranch_scc1 fz_nof2
    s_cmp_lt_u32 s3, 4
    s_cbranch_scc1 fz_ca
fz_fl1:
    ds_read_b32 v100, v101 offset:4
    s_waitcnt lgkmcnt(0)
    v_cmp_eq_u32 vcc, 0, v100
    s_cbranch_vccnz fz_fl1
    ds_read_b128 v[120:123], v15 offset:0
    ds_read_b128 v[124:127], v15 offset:64
    ds_read_b128 v[128:131], v15 offset:128
    ds_read_b128 v[132:135], v15 offset:192
    ds_read_b128 v[136:139], v15 offset:256
    ds_read_b128 v[140:143], v15 offset:320
    ds_read_b128 v[144:147], v15 offset:384
    ds_read_b128 v[148:151], v15 offset:448
    s_waitcnt vmcnt(2)
    s_waitcnt lgkmcnt(7)
    v_mfma_f32_16x16x32_bf16 v[152:155], v[120:123], v[160:163], 0
    v_mfma_f32_16x16x32_bf16 v[156:159], v[120:123], v[164:167], 0
    s_waitcnt lgkmcnt(6)
    v_mfma_f32_16x16x32_bf16 v[152:155], v[124:127], v[168:171], v[152:155]
    v_mfma_f32_16x16x32_bf16 v[156:159], v[124:127], v[172:175], v[156:159]
    s_waitcnt lgkmcnt(5)
    v_mfma_f32_16x16x32_bf16 v[152:155], v[128:131], v[176:179], v[152:155]
    v_mfma_f32_16x16x32_bf16 v[156:159], v[128:131], v[180:183], v[156:159]
    s_waitcnt lgkmcnt(4)
    v_mfma_f32_16x16x32_bf16 v[152:155], v[132:135], v[184:187], v[152:155]
    v_mfma_f32_16x16x32_bf16 v[156:159], v[132:135], v[188:191], v[156:159]
    s_waitcnt lgkmcnt(3)
    v_mfma_f32_16x16x32_bf16 v[152:155], v[136:139], v[192:195], v[152:155]
    v_mfma_f32_16x16x32_bf16 v[156:159], v[136:139], v[196:199], v[156:159]
    s_waitcnt lgkmcnt(2)
    v_mfma_f32_16x16x32_bf16 v[152:155], v[140:143], v[60:63], v[152:155]
    v_mfma_f32_16x16x32_bf16 v[156:159], v[140:143], v[64:67], v[156:159]
    s_waitcnt lgkmcnt(1)
    v_mfma_f32_16x16x32_bf16 v[152:155], v[144:147], v[68:71], v[152:155]
    v_mfma_f32_16x16x32_bf16 v[156:159], v[144:147], v[88:91], v[156:159]
    s_waitcnt lgkmcnt(0)
    v_mfma_f32_16x16x32_bf16 v[152:155], v[148:151], v[92:95], v[152:155]
    v_mfma_f32_16x16x32_bf16 v[156:159], v[148:151], v[96:99], v[156:159]
    s_mov_b32 exec_hi, 0
    s_nop 5
    v_and_or_b32 v152, v152, v14, s48
    v_and_or_b32 v153, v153, v14, s49
    v_and_or_b32 v154, v154, v14, s50
    v_and_or_b32 v155, v155, v14, s51
    buffer_store_dwordx4 v[152:155], v102, s[4:7], s63 offen sc1
    v_and_or_b32 v156, v156, v14, s48
    v_and_or_b32 v157, v157, v14, s49
    v_and_or_b32 v158, v158, v14, s50
    v_and_or_b32 v159, v159, v14, s51
    buffer_store_dwordx4 v[156:159], v103, s[4:7], s63 offen sc1
fz_f2d:
    s_mov_b32 exec_hi, -1
    v_mov_b32 v100, 1
    s_waitcnt vmcnt(0)
    s_mov_b64 exec, 1
    ds_add_u32 v101, v100 offset:8
    s_mov_b64 exec, -1
    s_branch fz_xend
fz_ca:
    ds_read_b32 v100, v101 offset:8
    s_waitcnt lgkmcnt(0)
    v_cmp_ne_u32 vcc, 4, v100
    s_cbranch_vccnz fz_ca
    v_mov_b32 v7, 0
    s_branch fz_p5_ok
    s_nop 3
fz_nof2:
    s_cmp_lg_u32 s59, s3
    s_cbranch_scc1 fz_xend
    s_mov_b32 s58, 0
    s_and_b32 s41, s20, 63
    s_mul_i32 s41, s41, 32
    s_add_u32 s41, s41, s52
    v_mov_b32 v7, 0
    s_nop 4
fz_p5:
    buffer_load_dword v8, v7, s[4:7], s41 offen sc1
    s_waitcnt vmcnt(0)
    v_and_b32 v8, 0xff, v8
    v_cmp_ne_u32 vcc, s48, v8
    s_cbranch_vccnz fz_p5_rt
fz_p5_ok:
    s_mov_b32 s58, 0
    buffer_load_dwordx4 v[40:43], v3, s[4:7], s52 offen sc1
    buffer_load_dwordx4 v[44:47], v3, s[4:7], s53 offen sc1
    buffer_load_dwordx4 v[48:51], v3, s[4:7], s54 offen sc1
    buffer_load_dwordx4 v[52:55], v6, s[4:7], s55 offen sc1
fz_h5_c0:
    s_waitcnt vmcnt(3)
    v_xor_b32 v40, s48, v40
    v_xor_b32 v41, s49, v41
    v_xor_b32 v42, s50, v42
    v_xor_b32 v43, s51, v43
    v_or3_b32 v8, v40, v41, v42
    v_bitop3_b32 v8, v8, v43, v13 bitop3:0xa8
    v_cmp_ne_u32 vcc, 0, v8
    s_cbranch_vccnz fz_h5_r0
fz_h5_o0:
fz_h5_c1:
    s_waitcnt vmcnt(2)
    v_xor_b32 v44, s48, v44
    v_xor_b32 v45, s49, v45
    v_xor_b32 v46, s50, v46
    v_xor_b32 v47, s51, v47
    v_or3_b32 v8, v44, v45, v46
    v_bitop3_b32 v8, v8, v47, v13 bitop3:0xa8
    v_cmp_ne_u32 vcc, 0, v8
    s_cbranch_vccnz fz_h5_r1
fz_h5_o1:
    v_pk_add_f32 v[40:41], v[40:41], v[44:45]
    v_pk_add_f32 v[42:43], v[42:43], v[46:47]
fz_h5_c2:
    s_waitcnt vmcnt(1)
    v_xor_b32 v48, s48, v48
    v_xor_b32 v49, s49, v49
    v_xor_b32 v50, s50, v50
    v_xor_b32 v51, s51, v51
    v_or3_b32 v8, v48, v49, v50
    v_bitop3_b32 v8, v8, v51, v13 bitop3:0xa8
    v_cmp_ne_u32 vcc, 0, v8
    s_cbranch_vccnz fz_h5_r2
fz_h5_o2:
    v_pk_add_f32 v[40:41], v[40:41], v[48:49]
    v_pk_add_f32 v[42:43], v[42:43], v[50:51]
fz_h5_c3:
    s_waitcnt vmcnt(0)
    v_xor_b32 v52, v16, v52
    v_xor_b32 v53, v17, v53
    v_xor_b32 v54, v18, v54
    v_xor_b32 v55, v19, v55
    v_or3_b32 v8, v52, v53, v54
    v_bitop3_b32 v8, v8, v55, v13 bitop3:0xa8
    v_cmp_ne_u32 vcc, 0, v8
    s_cbranch_vccnz fz_h5_r3
fz_h5_o3:
    v_pk_add_f32 v[40:41], v[40:41], v[52:53]
    v_pk_add_f32 v[42:43], v[42:43], v[54:55]
    s_nop 1
    v_permlane32_swap_b32 v40, v42
    v_permlane32_swap_b32 v41, v43
    v_pk_add_f32 v[40:41], v[40:41], v[42:43]
    s_nop 1
    v_permlane16_swap_b32 v40, v41
    v_add_f32 v40, v40, v41
    s_nop 1
    v_add_f32_dpp v40, v40, v40 quad_perm:[2,3,0,1] row_mask:0xf bank_mask:0xf
    s_nop 1
    v_add_f32_dpp v40, v40, v40 row_ror:4 row_mask:0xf bank_mask:0xf
    s_nop 1
    v_add_f32_dpp v40, v40, v40 row_ror:8 row_mask:0xf bank_mask:0xf
    v_cvt_pk_bf16_f32 v40, 0, v40
    v_mul_f32 v40, v40, v12
    v_cvt_pk_bf16_f32 v40, 0, v40
    v_add_f32 v40, v40, v11
    v_cvt_pk_bf16_f32 v40, 0, v40
    v_add_f32 v40, v40, v10
    v_cvt_pk_bf16_f32 v40, 0, v40
    s_mov_b32 exec_lo, 0x00030003
    s_mov_b32 exec_hi, 0x00030003
    buffer_store_short_d16_hi v40, v2, s[12:15], s39 offen
    s_cmp_lg_u32 s20, 0
    s_cbranch_scc1 fz_xend
    s_mov_b64 exec, 1
    v_mov_b32 v8, s40
    buffer_store_dword v8, v7, s[4:7], 0 offen
fz_xend:
fz_end:
    s_endpgm
fz_late:
    buffer_store_dwordx4 v[104:107], v239, s[12:15], s34 offen offset:0 sc1
    buffer_store_dwordx4 v[108:111], v239, s[12:15], s34 offen offset:1024 sc1
    buffer_store_dwordx4 v[112:115], v239, s[12:15], s35 offen offset:0 sc1
    buffer_store_dwordx4 v[116:119], v239, s[12:15], s35 offen offset:1024 sc1
    s_branch fz_xend
fz_act:
    s_cmp_gt_u32 s23, 111
    s_cbranch_scc1 fz_xend
    v_lshlrev_b32 v2, 2, v1
    v_and_b32 v11, 3, v1
    v_mov_b32 v3, s48
    v_cmp_eq_u32 vcc, 1, v11
    v_mov_b32 v10, s49
    s_nop 0
    v_cndmask_b32_e64 v3, v3, v10, vcc
    v_cmp_eq_u32 vcc, 2, v11
    v_mov_b32 v10, s50
    s_nop 0
    v_cndmask_b32_e64 v3, v3, v10, vcc
    v_cmp_eq_u32 vcc, 3, v11
    v_mov_b32 v10, s51
    s_nop 0
    v_cndmask_b32_e64 v3, v3, v10, vcc
    v_and_b32 v10, 31, v1
    v_lshlrev_b32 v6, 4, v10
    v_lshrrev_b32 v10, 5, v1
    v_mul_u32_u24 v10, 2184, v10
    v_add_u32 v6, v6, v10
    v_add_u32 v6, 108032, v6
    s_lshl_b32 s38, s23, 11
    s_add_u32 s38, s38, 0x488000
    s_mov_b32 s58, 0
fz_h4:
    buffer_load_dword v16, v2, s[4:7], s38 offen offset:0 sc1
    buffer_load_dword v17, v2, s[4:7], s38 offen offset:256 sc1
    buffer_load_dword v18, v2, s[4:7], s38 offen offset:512 sc1
    buffer_load_dword v19, v2, s[4:7], s38 offen offset:768 sc1
    buffer_load_dword v20, v2, s[4:7], s38 offen offset:1024 sc1
    buffer_load_dword v21, v2, s[4:7], s38 offen offset:1280 sc1
    buffer_load_dword v22, v2, s[4:7], s38 offen offset:1536 sc1
    buffer_load_dword v23, v2, s[4:7], s38 offen offset:1792 sc1
    s_waitcnt vmcnt(6)
    v_xor_b32 v16, v3, v16
    v_xor_b32 v17, v3, v17
    v_or3_b32 v10, v16, v17, 0
    v_add_f32 v16, v16, v17
    s_waitcnt vmcnt(4)
    v_xor_b32 v18, v3, v18
    v_xor_b32 v19, v3, v19
    v_or3_b32 v10, v18, v19, v10
    v_add_f32 v18, v18, v19
    v_add_f32 v16, v16, v18
    s_waitcnt vmcnt(2)
    v_xor_b32 v20, v3, v20
    v_xor_b32 v21, v3, v21
    v_or3_b32 v10, v20, v21, v10
    v_add_f32 v20, v20, v21
    s_waitcnt vmcnt(0)
    v_xor_b32 v22, v3, v22
    v_xor_b32 v23, v3, v23
    v_or3_b32 v10, v22, v23, v10
    v_add_f32 v22, v22, v23
    v_add_f32 v20, v20, v22
    v_and_b32 v10, 0xff, v10
    v_add_f32 v8, v16, v20
    v_cmp_ne_u32 vcc, 0, v10
    s_cbranch_vccnz fz_h4_rt
fz_h4_ok:
    v_cvt_pk_bf16_f32 v8, 0, v8
    v_mov_b32 v9, v8
    s_nop 1
    v_permlane32_swap_b32 v8, v9
    v_mul_f32 v10, 0xbfb8aa3b, v8
    v_exp_f32 v10, v10
    s_nop 0
    v_add_f32 v10, 1.0, v10
    v_rcp_f32 v10, v10
    s_nop 0
    v_mul_f32 v8, v8, v10
    v_cvt_pk_bf16_f32 v8, 0, v8
    v_mul_f32 v8, v8, v9
    v_cvt_pk_bf16_f32 v8, 0, v8
    ds_write_b16_d16_hi v6, v8 offset:0
    ds_write_b16_d16_hi v6, v8 offset:546
    ds_write_b16_d16_hi v6, v8 offset:1092
    ds_write_b16_d16_hi v6, v8 offset:1638
    s_waitcnt lgkmcnt(0)
    v_mov_b32 v8, 1
    ds_write_b32 v101, v8 offset:4
    s_branch fz_late
fz_ldh:
    s_load_dwordx2 s[12:13], s[0:1], 56
    s_load_dwordx2 s[16:17], s[0:1], 64
    s_mov_b32 s14, 0x700000
    s_mov_b32 s15, 0x00020000
    s_mov_b32 s18, 0x700000
    s_mov_b32 s19, 0x00020000
    s_branch fz_ldback
fz_spec:
    s_cmp_gt_u32 s3, 3
    s_cbranch_scc1 fz_spec_hi
    s_cmp_eq_u32 s3, 0
    s_cselect_b32 s31, 0, s31
    s_cselect_b32 s30, 33024, s30
    s_cmp_eq_u32 s3, 2
    s_cselect_b32 s31, 30960, s31
    s_cselect_b32 s30, 35088, s30
    s_cmp_eq_u32 s3, 3
    s_cselect_b32 s31, 37152, s31
    s_cselect_b32 s30, 39216, s30
    s_branch fz_specback
fz_spec_hi:
    s_mov_b32 m0, s31
    s_nop 0
    buffer_load_dwordx4 v239, s[8:11], s27 offen lds
    buffer_load_dwordx4 v239, s[8:11], s27 offen offset:1024 lds
    s_mov_b32 m0, s30
    s_nop 0
    buffer_load_dwordx4 v239, s[8:11], s28 offen lds
    buffer_load_dwordx4 v239, s[8:11], s28 offen offset:1024 lds
    v_lshlrev_b32 v13, 3, v0
    v_mov_b32 v10, -1
    v_mov_b32 v11, -1
    s_lshl_b32 s32, s20, 11
    s_add_u32 s32, s32, 0x447800
    s_mov_b32 s18, 0x800
    s_mov_b32 s19, 0x00020000
    s_lshl_b32 s33, s24, 10
    s_min_u32 s34, s33, 2048
    s_add_u32 s34, s34, 104960
    s_mov_b32 m0, s34
    buffer_store_dwordx2 v[10:11], v13, s[4:7], s32 offen sc1
    buffer_load_dwordx4 v239, s[16:19], s33 offen lds
    s_cmp_eq_u32 s24, 0
    s_cselect_b32 s31, 8256, s31
    s_cselect_b32 s30, 22704, s30
    s_cselect_b32 s27, 524288, s27
    s_cselect_b32 s28, 3670016, s28
    s_cmp_eq_u32 s24, 1
    s_cselect_b32 s31, 12384, s31
    s_cselect_b32 s30, 18576, s30
    s_cselect_b32 s27, 1572864, s27
    s_cselect_b32 s28, 2621440, s28
    s_cmp_eq_u32 s24, 2
    s_cselect_b32 s31, 41280, s31
    s_cselect_b32 s30, 43344, s30
    s_cselect_b32 s27, 1572864, s27
    s_cselect_b32 s28, 2621440, s28
    s_cmp_eq_u32 s24, 3
    s_cselect_b32 s31, 45408, s31
    s_cselect_b32 s30, 47472, s30
    s_cselect_b32 s27, 524288, s27
    s_cselect_b32 s28, 3670016, s28
    s_mov_b32 s57, 0
    s_branch fz_specback
fz_jb:
    v_cvt_pk_bf16_f32 v128, v104, v105
    v_cvt_pk_bf16_f32 v129, v106, v107
    v_cvt_pk_bf16_f32 v130, v108, v109
    v_cvt_pk_bf16_f32 v131, v110, v111
    v_cvt_pk_bf16_f32 v132, v112, v113
    v_cvt_pk_bf16_f32 v133, v114, v115
    v_cvt_pk_bf16_f32 v134, v116, v117
    v_cvt_pk_bf16_f32 v135, v118, v119
    s_branch fz_jend
fz_bsp0:
    buffer_load_dwordx4 v[160:163], v14, s[64:67], s62 offen offset:0 nt
    buffer_load_dwordx4 v[164:167], v14, s[64:67], s62 offen offset:256 nt
    s_add_u32 s62, s62, 8192
    buffer_load_dwordx4 v[168:171], v14, s[64:67], s62 offen offset:0 nt
    buffer_load_dwordx4 v[172:175], v14, s[64:67], s62 offen offset:256 nt
    s_add_u32 s62, s62, 8192
    buffer_load_dwordx4 v[176:179], v14, s[64:67], s62 offen offset:0 nt
    buffer_load_dwordx4 v[180:183], v14, s[64:67], s62 offen offset:256 nt
    s_add_u32 s62, s62, 8192
    buffer_load_dwordx4 v[184:187], v14, s[64:67], s62 offen offset:0 nt
    buffer_load_dwordx4 v[188:191], v14, s[64:67], s62 offen offset:256 nt
    s_add_u32 s62, s62, 8192
    s_branch fz_bsp
fz_spec40:
    s_mov_b32 s38, 0x80018001
    s_mov_b32 s39, 0x80018001
    v_cndmask_b32_e64 v112, v112, v104, s[38:39]
    v_cndmask_b32_e64 v113, v113, v105, s[38:39]
    s_branch fz_spec4back0
fz_spec41:
    s_mov_b32 s38, 0x80018001
    s_mov_b32 s39, 0x80018001
    v_cndmask_b32_e64 v114, v114, v106, s[38:39]
    v_cndmask_b32_e64 v115, v115, v107, s[38:39]
    s_branch fz_spec4back1
fz_spec42:
    s_mov_b32 s38, 0x80018001
    s_mov_b32 s39, 0x80018001
    v_cndmask_b32_e64 v116, v116, v108, s[38:39]
    v_cndmask_b32_e64 v117, v117, v109, s[38:39]
    s_branch fz_spec4back2
fz_spec43:
    s_mov_b32 s38, 0x80018001
    s_mov_b32 s39, 0x80018001
    v_cndmask_b32_e64 v118, v118, v110, s[38:39]
    v_cndmask_b32_e64 v119, v119, v111, s[38:39]
    s_branch fz_spec4back3
    s_nop 3
fz_nc1:
    s_setprio 0
    s_cmp_lg_u32 s59, 0
    s_cbranch_scc1 ffn_b
    buffer_load_dwordx4 v[176:179], v14, s[64:67], s62 offen offset:0 nt
    buffer_load_dwordx4 v[180:183], v14, s[64:67], s62 offen offset:256 nt
    s_add_u32 s62, s62, 8192
    buffer_load_dwordx4 v[184:187], v14, s[64:67], s62 offen offset:0 nt
    buffer_load_dwordx4 v[188:191], v14, s[64:67], s62 offen offset:256 nt
    s_add_u32 s62, s62, 8192
    s_mov_b32 m0, s31
    s_nop 0
    buffer_load_dwordx4 v239, s[8:11], s27 offen nt lds
    buffer_load_dwordx4 v239, s[8:11], s27 offen offset:1024 nt lds
    s_mov_b32 m0, s30
    s_nop 0
    buffer_load_dwordx4 v239, s[8:11], s28 offen nt lds
    buffer_load_dwordx4 v239, s[8:11], s28 offen offset:1024 nt lds
    v_lshlrev_b32 v13, 3, v0
    v_mov_b32 v10, -1
    v_mov_b32 v11, -1
    s_lshl_b32 s32, s20, 11
    s_add_u32 s32, s32, 0x447800
    s_mov_b32 s18, 0x800
    s_mov_b32 s19, 0x00020000
    s_lshl_b32 s33, s24, 10
    s_min_u32 s34, s33, 2048
    s_add_u32 s34, s34, 104960
    s_mov_b32 m0, s34
    buffer_store_dwordx2 v[10:11], v13, s[4:7], s32 offen sc1
    buffer_load_dwordx4 v239, s[16:19], s33 offen lds
    s_waitcnt vmcnt(14)
    v_readfirstlane_b32 s40, v250
    s_nop 1
    s_add_u32 s40, s40, 1
    s_and_b32 s38, s40, 3
    s_and_b32 s39, s40, 15
    s_bfe_u32 s41, s40, 0x20002
    s_lshl_b32 s41, s41, 16
    s_or_b32 s44, s38, s41
    s_bfe_u32 s41, s40, 0x40004
    s_lshl_b32 s41, s41, 4
    s_or_b32 s48, s39, s41
    s_bfe_u32 s41, s40, 0x20004
    s_lshl_b32 s41, s41, 16
    s_or_b32 s45, s38, s41
    s_bfe_u32 s41, s40, 0x40008
    s_lshl_b32 s41, s41, 4
    s_or_b32 s49, s39, s41
    s_bfe_u32 s41, s40, 0x20006
    s_lshl_b32 s41, s41, 16
    s_or_b32 s46, s38, s41
    s_bfe_u32 s41, s40, 0x4000c
    s_lshl_b32 s41, s41, 4
    s_or_b32 s50, s39, s41
    s_bfe_u32 s41, s40, 0x20008
    s_lshl_b32 s41, s41, 16
    s_or_b32 s47, s38, s41
    s_bfe_u32 s41, s40, 0x40010
    s_lshl_b32 s41, s41, 4
    s_or_b32 s51, s39, s41
    s_mov_b32 s38, 0x404
    s_cmp_eq_u32 s2, 66
    s_cselect_b32 s39, 8, 4
    s_cselect_b32 s38, 8, s38
fz_bsp:
    s_setprio 0
    s_mov_b32 s57, 1
    s_cmp_gt_u32 s3, 5
    s_cbranch_scc1 fz_nocq
    s_and_b32 s32, s3, 1
    s_lshl_b32 s33, s32, 2
    s_lshl_b32 s32, s32, 11
    v_and_b32 v8, 3, v4
    v_lshrrev_b32 v9, 2, v4
    v_lshl_add_u32 v8, v8, 3, v9
    v_add_u32 v8, s33, v8
    v_cvt_f32_u32 v8, v8
    v_mul_f32 v8, 0x3d000000, v8
    v_cvt_f32_u32 v9, v5
    v_mul_f32 v9, 4.0, v9
    v_mul_f32 v9, v8, v9
    v_mov_b32 v104, v9
    v_fmamk_f32 v105, v8, 0x3f800000, v9
    v_fmamk_f32 v106, v8, 0x40000000, v9
    v_fmamk_f32 v107, v8, 0x40400000, v9
    v_fmamk_f32 v108, v8, 0x41800000, v9
    v_fmamk_f32 v109, v8, 0x41880000, v9
    v_fmamk_f32 v110, v8, 0x41900000, v9
    v_fmamk_f32 v111, v8, 0x41980000, v9
    v_sin_f32 v112, v104
    v_sin_f32 v113, v105
    v_sin_f32 v114, v106
    v_sin_f32 v115, v107
    v_sin_f32 v116, v108
    v_sin_f32 v117, v109
    v_sin_f32 v118, v110
    v_sin_f32 v119, v111
    v_cos_f32 v104, v104
    v_cos_f32 v105, v105
    v_cos_f32 v106, v106
    v_cos_f32 v107, v107
    v_cos_f32 v108, v108
    v_cos_f32 v109, v109
    v_cos_f32 v110, v110
    v_cos_f32 v111, v111
    v_mul_f32 v104, 0x3d800000, v104
    v_mul_f32 v105, 0x3d800000, v105
    v_mul_f32 v106, 0x3d800000, v106
    v_mul_f32 v107, 0x3d800000, v107
    v_mul_f32 v108, 0x3d800000, v108
    v_mul_f32 v109, 0x3d800000, v109
    v_mul_f32 v110, 0x3d800000, v110
    v_mul_f32 v111, 0x3d800000, v111
    v_mul_f32 v112, 0x3d800000, v112
    v_mul_f32 v113, 0x3d800000, v113
    v_mul_f32 v114, 0x3d800000, v114
    v_mul_f32 v115, 0x3d800000, v115
    v_mul_f32 v116, 0x3d800000, v116
    v_mul_f32 v117, 0x3d800000, v117
    v_mul_f32 v118, 0x3d800000, v118
    v_mul_f32 v119, 0x3d800000, v119
    v_cvt_pk_f16_f32 v128, v104, v105
    v_cvt_pk_f16_f32 v129, v106, v107
    v_cvt_pk_f16_f32 v130, v108, v109
    v_cvt_pk_f16_f32 v131, v110, v111
    v_cvt_pk_f16_f32 v132, v112, v113
    v_cvt_pk_f16_f32 v133, v114, v115
    v_cvt_pk_f16_f32 v134, v116, v117
    v_cvt_pk_f16_f32 v135, v118, v119
    v_add_u32 v8, s32, v6
    ds_write_b128 v8, v[128:131] offset:14336
    ds_write_b128 v8, v[132:135] offset:15360
fz_nocq:
    s_and_b32 s32, s3, 3
    s_lshr_b32 s33, s3, 2
    s_lshl_b32 s33, s33, 4
    s_add_u32 s33, s33, s32
    v_and_b32 v8, 12, v4
    v_bfe_u32 v9, v4, 1, 1
    v_lshl_add_u32 v8, v9, 5, v8
    v_add_u32 v8, s33, v8
    v_cvt_f32_u32 v8, v8
    v_and_b32 v12, 1, v1
    v_cvt_f32_u32 v9, v12
    v_lshlrev_b32 v13, 2, v5
    v_cvt_f32_u32 v10, v13
    v_mul_f32 v11, 0x3c800000, v8
    v_mul_f32 v9, 0x3e800000, v9
    v_fma_f32 v9, v11, v10, v9
    v_mov_b32 v128, v9
    v_fmamk_f32 v129, v11, 0x3f800000, v9
    v_fmamk_f32 v130, v11, 0x40000000, v9
    v_fmamk_f32 v131, v11, 0x40400000, v9
    v_mul_f32 v11, 0x3a000000, v8
    v_lshlrev_b32 v9, 31, v1
    v_xor_b32 v11, v9, v11
    v_mul_f32 v9, v11, v10
    v_mov_b32 v112, v9
    v_fmamk_f32 v113, v11, 0x3f800000, v9
    v_fmamk_f32 v114, v11, 0x40000000, v9
    v_fmamk_f32 v115, v11, 0x40400000, v9
    v_fmamk_f32 v116, v11, 0x41800000, v9
    v_fmamk_f32 v117, v11, 0x41880000, v9
    v_fmamk_f32 v118, v11, 0x41900000, v9
    v_fmamk_f32 v119, v11, 0x41980000, v9
    v_cos_f32 v104, v128
    v_sin_f32 v105, v128
    v_cos_f32 v106, v129
    v_sin_f32 v107, v129
    v_cos_f32 v108, v130
    v_sin_f32 v109, v130
    v_cos_f32 v110, v131
    v_sin_f32 v111, v131
    v_sin_f32 v120, v112
    v_sin_f32 v121, v113
    v_sin_f32 v122, v114
    v_sin_f32 v123, v115
    v_sin_f32 v124, v116
    v_sin_f32 v125, v117
    v_sin_f32 v126, v118
    v_sin_f32 v127, v119
    v_cos_f32 v112, v112
    v_cos_f32 v113, v113
    v_cos_f32 v114, v114
    v_cos_f32 v115, v115
    v_cos_f32 v116, v116
    v_cos_f32 v117, v117
    v_cos_f32 v118, v118
    v_cos_f32 v119, v119
    v_cvt_pk_f16_f32 v16, v104, v105
    v_cvt_pk_f16_f32 v17, v106, v107
    v_cvt_pk_f16_f32 v18, v108, v109
    v_cvt_pk_f16_f32 v19, v110, v111
    v_cvt_pk_f16_f32 v20, v112, v113
    v_cvt_pk_f16_f32 v21, v114, v115
    v_cvt_pk_f16_f32 v22, v116, v117
    v_cvt_pk_f16_f32 v23, v118, v119
    v_cvt_pk_f16_f32 v24, v120, v121
    v_cvt_pk_f16_f32 v25, v122, v123
    v_cvt_pk_f16_f32 v26, v124, v125
    v_cvt_pk_f16_f32 v27, v126, v127
    s_and_b32 s32, s3, 3
    s_lshl_b32 s32, s32, 11
    s_add_u32 s32, s32, 86400
    v_add_u32 v225, s32, v239
    v_add_u32 v8, s33, v13
    v_sub_u32 v9, 32, v8
    v_min_u32 v9, v8, v9
    v_and_b32 v10, 15, v8
    v_cmp_eq_u32 s[32:33], 0, v10
    v_cmp_lt_u32 s[34:35], 16, v8
    v_lshlrev_b32 v10, 10, v9
    v_subrev_u32 v10, 1024, v10
    v_mov_b32 v11, 15872
    v_cmp_eq_u32 vcc, 0, v8
    s_nop 1
    v_cndmask_b32_e64 v10, v10, v11, vcc
    v_and_b32 v11, 3, v1
    v_lshl_add_u32 v10, v11, 4, v10
    v_lshrrev_b32 v11, 2, v4
    v_lshlrev_b32 v12, 7, v11
    v_sub_u32 v13, 960, v12
    v_cndmask_b32_e64 v13, v12, v13, s[34:35]
    v_add_u32 v226, v10, v13
    s_or_b64 s[34:35], s[34:35], s[32:33]
    v_add_u32 v12, 512, v12
    v_sub_u32 v13, 960, v12
    v_cndmask_b32_e64 v13, v12, v13, s[34:35]
    v_add_u32 v227, v10, v13
    s_mul_i32 s56, s20, 16512
    s_add_u32 s56, s56, 0x210000
    v_mov_b32 v249, 0x30003
    v_mov_b32 v252, s44
    v_mov_b32 v253, s45
    v_mov_b32 v254, s46
    v_mov_b32 v255, s47
    s_waitcnt lgkmcnt(0)
    v_sub_u32 v8, 15, v4
    v_min_u32 v8, v4, v8
    v_and_b32 v9, 1, v8
    v_lshlrev_b32 v9, 5, v9
    v_lshrrev_b32 v10, 1, v8
    v_lshl_add_u32 v9, v10, 9, v9
    v_add_u32 v9, s25, v9
    v_sub_u32 v10, 2048, v9
    v_cmp_lt_u32 s[34:35], 7, v4
    s_nop 1
    v_cndmask_b32_e64 v230, v9, v10, s[34:35]
    v_mov_b32 v9, v4
    v_mov_b32 v10, s20
    s_cmp_lg_u32 s21, 0
    s_cbranch_scc0 fz_spec3b
fz_spec3backb:
    v_lshlrev_b32 v10, 7, v10
    v_lshl_add_u32 v10, v9, 3, v10
    v_mul_u32_u24 v11, 66048, v5
    v_add_u32 v228, v10, v11
    v_and_b32 v9, 1, v9
    v_cmp_eq_u32 vcc, 1, v9
    v_mov_b32 v9, s44
    v_mov_b32 v10, s46
    v_cndmask_b32_e64 v236, v9, v10, vcc
    v_mov_b32 v9, s45
    v_mov_b32 v10, s47
    v_cndmask_b32_e64 v237, v9, v10, vcc
    s_lshl_b32 s32, s3, 2
    v_add_u32 v8, s32, v5
    v_lshlrev_b32 v9, 6, v8
    v_cmp_gt_u32 vcc, 16, v8
    s_nop 1
    v_cndmask_b32_e64 v10, 0, 32, vcc
    v_add_u32 v10, v9, v10
    v_sub_u32 v11, 2048, v10
    v_cmp_eq_u32 vcc, 16, v8
    s_nop 1
    v_cndmask_b32_e64 v11, v11, 0, vcc
    v_mov_b32 v12, 0xffff0000
    v_cndmask_b32_e64 v238, -1, v12, vcc
    v_sub_u32 v12, 2018, v9
    v_mul_u32_u24 v13, 2064, v4
    v_add_u32 v231, v13, v9
    v_add_u32 v232, v13, v12
    v_add_u32 v233, v13, v10
    v_add_u32 v241, v13, v11
    s_lshl_b32 s32, s3, 8
    s_add_u32 s32, s32, 102912
    v_lshlrev_b32 v9, 4, v4
    v_add_u32 v10, s32, v9
    v_add_u32 v11, 107008, v239
    v_cmp_gt_u32 vcc, 16, v1
    s_nop 1
    v_cndmask_b32_e64 v243, v11, v10, vcc
    v_lshrrev_b32 v12, 2, v4
    v_cmp_eq_u32 vcc, v12, v5
    s_nop 1
    v_cndmask_b32_e64 v244, v11, v10, vcc
    v_lshrrev_b32 v12, 5, v1
    v_lshl_add_u32 v10, v12, 10, v9
    v_add_u32 v245, 102912, v10
    v_and_b32 v9, 1, v1
    v_cmp_eq_u32 s[28:29], 1, v9
    v_and_b32 v9, 2, v1
    v_cmp_eq_u32 s[30:31], 2, v9
    s_lshl_b32 s37, s3, 2
    v_add_u32 v9, s37, v5
    v_mul_u32_u24 v246, 2176, v9
    s_lshl_b32 s26, s20, 4
    s_add_u32 s26, s26, 0x580000
    v_lshlrev_b32 v247, 4, v5
    s_lshl_b32 s27, s20, 11
    s_lshl_b32 s37, s3, 8
    s_add_u32 s27, s27, s37
    s_add_u32 s27, s27, 0x448000
    v_sub_u32 v248, 2047, v230
    s_mov_b32 s14, 0x400000
    s_mov_b32 s15, 0x00020000
    s_mul_i32 s52, s3, 264192
    s_add_u32 s52, s52, 0x210000
    s_add_u32 s53, s52, 16512
    s_add_u32 s54, s52, 33024
    s_add_u32 s55, s52, 49536
    s_mov_b32 s23, s63
    s_getreg_b32 s24, hwreg(HW_REG_XCC_ID)
    s_and_b32 s24, s24, 15
    v_lshlrev_b32 v10, 4, v0
    v_min_u32 v10, 4336, v10
    v_add_u32 v10, 108032, v10
    v_mov_b32 v104, 0
    v_mov_b32 v105, 0
    v_mov_b32 v106, 0
    v_mov_b32 v107, 0
    ds_write_b128 v10, v[104:107]
    s_cmp_eq_u32 s2, 66
    s_cbranch_scc1 fz_sz
    s_waitcnt vmcnt(0)
    v_mov_b32 v10, 256
    s_mov_b64 exec, 1
    ds_add_u32 v15, v10
    s_mov_b64 exec, -1
fz_sz:
    ds_read_b32 v10, v15
    s_waitcnt lgkmcnt(0)
    v_cmp_ne_u32 vcc, s38, v10
    s_cbranch_vccnz fz_sz
    ds_read_b128 v[116:119], v231
    ds_read_b128 v[120:123], v231 offset:16
    ds_read_u16_d16_hi v44, v241
    ds_read_u16_d16_hi v45, v232 offset:28
    ds_read_u16_d16_hi v46, v232 offset:26
    ds_read_u16_d16_hi v47, v232 offset:24
    ds_read_u16_d16_hi v48, v232 offset:22
    ds_read_u16_d16_hi v49, v232 offset:20
    ds_read_u16_d16_hi v50, v232 offset:18
    ds_read_u16_d16_hi v51, v232 offset:16
    ds_read_u16_d16_hi v52, v232 offset:14
    ds_read_u16_d16_hi v53, v232 offset:12
    ds_read_u16_d16_hi v54, v232 offset:10
    ds_read_u16_d16_hi v55, v232 offset:8
    ds_read_u16_d16_hi v56, v232 offset:6
    ds_read_u16_d16_hi v57, v232 offset:4
    ds_read_u16_d16_hi v58, v232 offset:2
    ds_read_u16_d16_hi v59, v232 offset:0
    ds_read_u16_d16_hi v28, v233
    s_mov_b32 s36, 0xffff0000
    s_waitcnt lgkmcnt(15)
    v_and_b32 v29, s36, v116
    v_lshlrev_b32 v30, 16, v117
    v_and_b32 v31, s36, v117
    v_lshlrev_b32 v32, 16, v118
    v_and_b32 v33, s36, v118
    v_lshlrev_b32 v34, 16, v119
    v_and_b32 v35, s36, v119
    v_lshlrev_b32 v36, 16, v120
    v_and_b32 v37, s36, v120
    v_lshlrev_b32 v38, 16, v121
    v_and_b32 v39, s36, v121
    v_lshlrev_b32 v40, 16, v122
    v_and_b32 v41, s36, v122
    v_lshlrev_b32 v42, 16, v123
    v_and_b32 v43, s36, v123
    s_waitcnt lgkmcnt(0)
    s_branch fz_hb
    s_nop 2
fz_nc3:
    v_mul_u32_u24 v13, 2064, v4
    v_subrev_u32 v13, 104960, v13
    v_sub_u32 v9, v231, v13
    v_sub_u32 v10, v233, v13
    v_sub_u32 v11, v241, v13
    v_sub_u32 v12, v232, v13
    s_mov_b32 s36, 0xffff0000
    ds_read_b128 v[200:203], v9
    ds_read_b128 v[204:207], v9 offset:16
    ds_read_u16_d16 v208, v11
    ds_read_u16_d16_hi v124, v12 offset:28
    ds_read_u16_d16 v209, v12 offset:26
    ds_read_u16_d16_hi v125, v12 offset:24
    ds_read_u16_d16 v210, v12 offset:22
    ds_read_u16_d16_hi v126, v12 offset:20
    ds_read_u16_d16 v211, v12 offset:18
    ds_read_u16_d16_hi v127, v12 offset:16
    ds_read_u16_d16 v212, v12 offset:14
    ds_read_u16_d16_hi v128, v12 offset:12
    ds_read_u16_d16 v213, v12 offset:10
    ds_read_u16_d16_hi v129, v12 offset:8
    ds_read_u16_d16 v214, v12 offset:6
    ds_read_u16_d16_hi v130, v12 offset:4
    ds_read_u16_d16 v215, v12 offset:2
    ds_read_u16_d16_hi v131, v12 offset:0
    ds_read_u16_d16 v13, v10
    v_cmp_eq_u32 vcc, 1, v4
    v_mov_b32 v9, s42
    s_nop 0
    v_cndmask_b32_e64 v9, 0, v9, vcc
    v_mov_b32 v116, s42
    v_mov_b32 v117, s42
    v_mov_b32 v118, s42
    v_mov_b32 v119, s42
    v_cmp_eq_u32 vcc, 0, v4
    s_waitcnt lgkmcnt(0)
    v_and_or_b32 v200, v200, s36, v13
    v_or_b32 v208, v208, v124
    v_or_b32 v209, v209, v125
    v_or_b32 v210, v210, v126
    v_or_b32 v211, v211, v127
    v_or_b32 v212, v212, v128
    v_or_b32 v213, v213, v129
    v_or_b32 v214, v214, v130
    v_or_b32 v215, v215, v131
    v_cndmask_b32_e64 v200, v9, v200, vcc
    v_cndmask_b32_e64 v201, v9, v201, vcc
    v_cndmask_b32_e64 v202, v9, v202, vcc
    v_cndmask_b32_e64 v203, v9, v203, vcc
    v_cndmask_b32_e64 v204, v9, v204, vcc
    v_cndmask_b32_e64 v205, v9, v205, vcc
    v_cndmask_b32_e64 v206, v9, v206, vcc
    v_cndmask_b32_e64 v207, v9, v207, vcc
    v_cndmask_b32_e64 v208, v9, v208, vcc
    v_cndmask_b32_e64 v209, v9, v209, vcc
    v_cndmask_b32_e64 v210, v9, v210, vcc
    v_cndmask_b32_e64 v211, v9, v211, vcc
    v_cndmask_b32_e64 v212, v9, v212, vcc
    v_cndmask_b32_e64 v213, v9, v213, vcc
    v_cndmask_b32_e64 v214, v9, v214, vcc
    v_cndmask_b32_e64 v215, v9, v215, vcc
    v_mfma_f32_16x16x32_bf16 v[120:123], v[200:203], v[116:119], 0
    v_mfma_f32_16x16x32_bf16 v[120:123], v[204:207], v[116:119], v[120:123]
    v_mfma_f32_16x16x32_bf16 v[120:123], v[208:211], v[116:119], v[120:123]
    v_mfma_f32_16x16x32_bf16 v[120:123], v[212:215], v[116:119], v[120:123]
    s_nop 7
    ds_write_b32 v243, v120 offset:12
    s_waitcnt lgkmcnt(0)
    s_mov_b32 s58, 0
    s_waitcnt vmcnt(0)
    s_branch fz_h2
fz_spec3a:
    v_xor_b32 v11, 1, v4
    v_cndmask_b32_e64 v9, v9, v11, s[34:35]
    v_and_b32 v11, 1, v4
    v_cndmask_b32_e64 v11, 0, v11, s[34:35]
    v_sub_u32 v10, v10, v11
    s_cmp_lg_u32 s22, 0
    s_cbranch_scc1 fz_spec3backa
    v_cmp_eq_u32 vcc, 15, v4
    v_mov_b32 v11, 1024
    v_mov_b32 v12, 124
    v_cndmask_b32_e64 v230, v230, v11, vcc
    v_cndmask_b32_e64 v10, v10, v12, vcc
    v_cndmask_b32_e64 v9, v9, 4, vcc
    v_cmp_eq_u32 vcc, 13, v4
    v_mov_b32 v11, 1536
    v_mov_b32 v12, 124
    v_cndmask_b32_e64 v230, v230, v11, vcc
    v_cndmask_b32_e64 v10, v10, v12, vcc
    v_cndmask_b32_e64 v9, v9, 6, vcc
    v_cmp_eq_u32 vcc, 4, v4
    v_mov_b32 v11, 256
    v_mov_b32 v12, 127
    v_cndmask_b32_e64 v230, v230, v11, vcc
    v_cndmask_b32_e64 v10, v10, v12, vcc
    v_cndmask_b32_e64 v9, v9, 8, vcc
    v_cmp_eq_u32 vcc, 11, v4
    v_mov_b32 v11, 1792
    v_mov_b32 v12, 127
    v_cndmask_b32_e64 v230, v230, v11, vcc
    v_cndmask_b32_e64 v10, v10, v12, vcc
    v_cndmask_b32_e64 v9, v9, 14, vcc
    v_cmp_eq_u32 vcc, 6, v4
    v_mov_b32 v11, 768
    v_mov_b32 v12, 127
    v_cndmask_b32_e64 v230, v230, v11, vcc
    v_cndmask_b32_e64 v10, v10, v12, vcc
    v_cndmask_b32_e64 v9, v9, 10, vcc
    v_cmp_eq_u32 vcc, 9, v4
    v_mov_b32 v11, 1280
    v_mov_b32 v12, 127
    v_cndmask_b32_e64 v230, v230, v11, vcc
    v_cndmask_b32_e64 v10, v10, v12, vcc
    v_cndmask_b32_e64 v9, v9, 12, vcc
    s_nop 4
    s_branch fz_spec3backa
fz_spec3b:
    v_xor_b32 v11, 1, v4
    v_cndmask_b32_e64 v9, v9, v11, s[34:35]
    v_and_b32 v11, 1, v4
    v_cndmask_b32_e64 v11, 0, v11, s[34:35]
    v_sub_u32 v10, v10, v11
    s_cmp_lg_u32 s22, 0
    s_cbranch_scc1 fz_spec3backb
    v_cmp_eq_u32 vcc, 15, v4
    v_mov_b32 v11, 1024
    v_mov_b32 v12, 124
    v_cndmask_b32_e64 v230, v230, v11, vcc
    v_cndmask_b32_e64 v10, v10, v12, vcc
    v_cndmask_b32_e64 v9, v9, 4, vcc
    v_cmp_eq_u32 vcc, 13, v4
    v_mov_b32 v11, 1536
    v_mov_b32 v12, 124
    v_cndmask_b32_e64 v230, v230, v11, vcc
    v_cndmask_b32_e64 v10, v10, v12, vcc
    v_cndmask_b32_e64 v9, v9, 6, vcc
    v_cmp_eq_u32 vcc, 4, v4
    v_mov_b32 v11, 256
    v_mov_b32 v12, 127
    v_cndmask_b32_e64 v230, v230, v11, vcc
    v_cndmask_b32_e64 v10, v10, v12, vcc
    v_cndmask_b32_e64 v9, v9, 8, vcc
    v_cmp_eq_u32 vcc, 11, v4
    v_mov_b32 v11, 1792
    v_mov_b32 v12, 127
    v_cndmask_b32_e64 v230, v230, v11, vcc
    v_cndmask_b32_e64 v10, v10, v12, vcc
    v_cndmask_b32_e64 v9, v9, 14, vcc
    v_cmp_eq_u32 vcc, 6, v4
    v_mov_b32 v11, 768
    v_mov_b32 v12, 127
    v_cndmask_b32_e64 v230, v230, v11, vcc
    v_cndmask_b32_e64 v10, v10, v12, vcc
    v_cndmask_b32_e64 v9, v9, 10, vcc
    v_cmp_eq_u32 vcc, 9, v4
    v_mov_b32 v11, 1280
    v_mov_b32 v12, 127
    v_cndmask_b32_e64 v230, v230, v11, vcc
    v_cndmask_b32_e64 v10, v10, v12, vcc
    v_cndmask_b32_e64 v9, v9, 12, vcc
    s_nop 4
    s_branch fz_spec3backb
    s_nop 0
ffn_b:
    s_waitcnt vmcnt(0)
    v_readfirstlane_b32 s40, v250
    s_nop 1
    s_add_u32 s40, s40, 1
    s_and_b32 s38, s40, 3
    s_and_b32 s39, s40, 15
    s_bfe_u32 s41, s40, 0x20002
    s_lshl_b32 s41, s41, 16
    s_or_b32 s44, s38, s41
    s_bfe_u32 s41, s40, 0x40004
    s_lshl_b32 s41, s41, 4
    s_or_b32 s48, s39, s41
    s_bfe_u32 s41, s40, 0x20004
    s_lshl_b32 s41, s41, 16
    s_or_b32 s45, s38, s41
    s_bfe_u32 s41, s40, 0x40008
    s_lshl_b32 s41, s41, 4
    s_or_b32 s49, s39, s41
    s_bfe_u32 s41, s40, 0x20006
    s_lshl_b32 s41, s41, 16
    s_or_b32 s46, s38, s41
    s_bfe_u32 s41, s40, 0x4000c
    s_lshl_b32 s41, s41, 4
    s_or_b32 s50, s39, s41
    s_bfe_u32 s41, s40, 0x20008
    s_lshl_b32 s41, s41, 16
    s_or_b32 s47, s38, s41
    s_bfe_u32 s41, s40, 0x40010
    s_lshl_b32 s41, s41, 4
    s_or_b32 s51, s39, s41
    s_nop 0
ffn:
    s_add_u32 s36, s2, 4
    s_and_b32 s36, s36, 7
    s_bfe_u32 s37, s2, 0x10006
    s_lshl_b32 s22, s36, 1
    s_add_u32 s22, s22, s37
    s_cmp_lg_u32 s37, 0
    s_cselect_b32 s37, 8, s36
    s_add_u32 s37, s37, 6
    s_cmp_lt_u32 s36, 6
    s_cselect_b32 s22, s22, s37
    s_cmp_gt_u32 s22, 13
    s_cbranch_scc1 fz_xend
    s_bfe_u32 s21, s2, 0x30003
    v_lshrrev_b32 v2, 5, v1
    v_and_b32 v3, 31, v1
    v_lshlrev_b32 v4, 1, v2
    v_xor_b32 v3, v4, v3
    v_mul_u32_u24 v4, 7168, v2
    v_lshl_add_u32 v4, v3, 4, v4
    v_xor_b32 v5, 64, v4
    v_xor_b32 v6, 128, v4
    v_xor_b32 v7, 192, v4
    s_lshl_b32 s23, s21, 7
    s_lshl_b32 s24, s3, 4
    s_add_u32 s23, s23, s24
    s_mul_i32 s23, s23, 7168
    s_lshl_b32 s24, s22, 9
    s_add_u32 s23, s23, s24
    s_lshl_b32 s24, s3, 13
    v_mov_b32 v31, 149552
    v_mov_b32 v10, 0
    ds_write_b32 v31, v10
    s_waitcnt lgkmcnt(0)
    s_setprio 0
    s_barrier
    s_add_u32 s28, s24, 81920
    s_mov_b32 m0, s28
    s_add_u32 s29, s23, 0
    buffer_load_dwordx4 v4, s[12:15], s29 offen nt lds
    s_add_u32 s28, s24, 82944
    s_mov_b32 m0, s28
    s_add_u32 s29, s23, 14336
    buffer_load_dwordx4 v5, s[12:15], s29 offen nt lds
    s_add_u32 s28, s24, 83968
    s_mov_b32 m0, s28
    s_add_u32 s29, s23, 28672
    buffer_load_dwordx4 v4, s[12:15], s29 offen nt lds
    s_add_u32 s28, s24, 84992
    s_mov_b32 m0, s28
    s_add_u32 s29, s23, 43008
    buffer_load_dwordx4 v5, s[12:15], s29 offen nt lds
    s_add_u32 s28, s24, 86016
    s_mov_b32 m0, s28
    s_add_u32 s29, s23, 57344
    buffer_load_dwordx4 v6, s[12:15], s29 offen nt lds
    s_add_u32 s28, s24, 87040
    s_mov_b32 m0, s28
    s_add_u32 s29, s23, 71680
    buffer_load_dwordx4 v7, s[12:15], s29 offen nt lds
    s_add_u32 s28, s24, 88064
    s_mov_b32 m0, s28
    s_add_u32 s29, s23, 86016
    buffer_load_dwordx4 v6, s[12:15], s29 offen nt lds
    s_add_u32 s28, s24, 89088
    s_mov_b32 m0, s28
    s_add_u32 s29, s23, 100352
    buffer_load_dwordx4 v7, s[12:15], s29 offen nt lds
    s_add_u32 s28, s24, 0
    s_mov_b32 m0, s28
    s_add_u32 s29, s23, 0
    buffer_load_dwordx4 v4, s[16:19], s29 offen nt lds
    s_add_u32 s28, s24, 1024
    s_mov_b32 m0, s28
    s_add_u32 s29, s23, 14336
    buffer_load_dwordx4 v5, s[16:19], s29 offen nt lds
    s_add_u32 s28, s24, 2048
    s_mov_b32 m0, s28
    s_add_u32 s29, s23, 28672
    buffer_load_dwordx4 v4, s[16:19], s29 offen nt lds
    s_add_u32 s28, s24, 3072
    s_mov_b32 m0, s28
    s_add_u32 s29, s23, 43008
    buffer_load_dwordx4 v5, s[16:19], s29 offen nt lds
    s_add_u32 s28, s24, 4096
    s_mov_b32 m0, s28
    s_add_u32 s29, s23, 57344
    buffer_load_dwordx4 v6, s[16:19], s29 offen nt lds
    s_add_u32 s28, s24, 5120
    s_mov_b32 m0, s28
    s_add_u32 s29, s23, 71680
    buffer_load_dwordx4 v7, s[16:19], s29 offen nt lds
    s_add_u32 s28, s24, 6144
    s_mov_b32 m0, s28
    s_add_u32 s29, s23, 86016
    buffer_load_dwordx4 v6, s[16:19], s29 offen nt lds
    s_add_u32 s28, s24, 7168
    s_mov_b32 m0, s28
    s_add_u32 s29, s23, 100352
    buffer_load_dwordx4 v7, s[16:19], s29 offen nt lds
    v_lshrrev_b32 v2, 4, v1
    v_and_b32 v3, 15, v1
    v_bfe_u32 v9, v1, 2, 2
    v_lshl_add_u32 v8, v2, 3, v9
    v_lshlrev_b32 v8, 9, v8
    v_and_b32 v10, 1, v2
    v_lshl_add_u32 v10, v10, 2, v9
    s_lshl_b32 s28, s3, 1
    v_xor_b32 v10, s28, v10
    v_lshl_add_u32 v8, v10, 5, v8
    v_and_b32 v10, 3, v1
    v_lshl_add_u32 v8, v10, 3, v8
    v_xor_b32 v12, 32, v8
    v_add_u32 v13, 81920, v8
    v_add_u32 v20, 81920, v12
    s_lshl_b32 s28, s21, 7
    v_lshl_add_u32 v9, v1, 1, s28
    v_and_b32 v24, 31, v9
    v_lshrrev_b32 v25, 5, v9
    v_cmp_gt_u32 vcc, 16, v25
    v_cmp_lt_u32 s[24:25], 16, v24
    v_cmp_eq_u32 s[26:27], 0, v24
    s_nop 1
    s_and_b64 s[26:27], s[26:27], vcc
    s_or_b64 s[24:25], s[24:25], s[26:27]
    v_cmp_eq_u32 s[26:27], 16, v24
    s_nop 1
    s_andn2_b64 s[26:27], s[26:27], vcc
    s_or_b64 s[24:25], s[24:25], s[26:27]
    v_sub_u32 v26, 1024, v9
    v_cndmask_b32_e64 v26, v9, v26, s[24:25]
    v_mov_b32 v27, 512
    v_cmp_eq_u32 vcc, 1024, v26
    s_nop 1
    v_cndmask_b32_e64 v26, v26, v27, vcc
    v_lshrrev_b32 v27, 5, v26
    v_and_b32 v26, 15, v26
    v_lshrrev_b32 v16, 2, v27
    v_lshlrev_b32 v16, 8, v16
    v_and_b32 v27, 3, v27
    v_lshl_add_u32 v16, v27, 4, v16
    v_lshrrev_b32 v27, 3, v26
    v_lshl_add_u32 v16, v27, 6, v16
    v_and_b32 v26, 7, v26
    v_lshl_add_u32 v16, v26, 1, v16
    v_cndmask_b32_e64 v26, 0, 1, s[24:25]
    v_lshl_add_u32 v16, v26, 7, v16
    v_add_u32 v9, 1, v9
    v_and_b32 v24, 31, v9
    v_lshrrev_b32 v25, 5, v9
    v_cmp_gt_u32 vcc, 16, v25
    v_cmp_lt_u32 s[24:25], 16, v24
    v_cmp_eq_u32 s[26:27], 0, v24
    s_nop 1
    s_and_b64 s[26:27], s[26:27], vcc
    s_or_b64 s[24:25], s[24:25], s[26:27]
    v_cmp_eq_u32 s[26:27], 16, v24
    s_nop 1
    s_andn2_b64 s[26:27], s[26:27], vcc
    s_or_b64 s[24:25], s[24:25], s[26:27]
    v_sub_u32 v26, 1024, v9
    v_cndmask_b32_e64 v26, v9, v26, s[24:25]
    v_mov_b32 v27, 512
    v_cmp_eq_u32 vcc, 1024, v26
    s_nop 1
    v_cndmask_b32_e64 v26, v26, v27, vcc
    v_lshrrev_b32 v27, 5, v26
    v_and_b32 v26, 15, v26
    v_lshrrev_b32 v17, 2, v27
    v_lshlrev_b32 v17, 8, v17
    v_and_b32 v27, 3, v27
    v_lshl_add_u32 v17, v27, 4, v17
    v_lshrrev_b32 v27, 3, v26
    v_lshl_add_u32 v17, v27, 6, v17
    v_and_b32 v26, 7, v26
    v_lshl_add_u32 v17, v26, 1, v17
    v_cndmask_b32_e64 v26, 0, 1, s[24:25]
    v_lshl_add_u32 v17, v26, 7, v17
    s_lshl_b32 s28, s21, 8
    s_add_u32 s28, s28, 147456
    v_lshl_add_u32 v18, v1, 2, s28
    s_lshl_b32 s28, s21, 8
    s_add_u32 s28, s28, 147456
    v_lshlrev_b32 v19, 4, v2
    v_add_u32 v19, s28, v19
    v_mov_b32 v28, 149504
    v_lshlrev_b32 v29, 4, v1
    s_lshl_b32 s30, s22, 3
    s_add_u32 s30, s30, s3
    s_lshl_b32 s30, s30, 3
    s_add_u32 s30, s30, s21
    s_lshl_b32 s30, s30, 8
    s_add_u32 s30, s30, 0x488000
    v_lshlrev_b32 v30, 4, v2
    v_lshl_add_u32 v30, v3, 6, v30
    v_cmp_eq_u32 s[60:61], 1, v3
    v_cmp_eq_u32 s[62:63], 2, v3
    v_cmp_eq_u32 s[64:65], 3, v3
    v_add_u32 v21, 149568, v29
    v_mov_b32 v197, 0xffffff00
    s_and_b32 s35, s2, 0x47
    s_lshl_b32 s31, s3, 3
    s_add_u32 s35, s35, s31
    s_add_u32 s35, s35, 58
    s_and_b32 s35, s35, 127
    s_getreg_b32 s33, hwreg(HW_REG_XCC_ID)
    s_and_b32 s33, s33, 15
    s_lshr_b32 s31, s35, 5
    s_lshl_b32 s31, s31, 2
    s_add_u32 s31, s31, 149520
    v_mov_b32 v22, s31
    s_lshl_b32 s20, s22, 3
    s_add_u32 s20, s20, s21
    s_and_b32 s34, s20, 15
    s_bfe_u32 s28, s20, 0x10004
    s_lshl_b32 s28, s28, 5
    s_add_u32 s34, s34, s28
    s_mul_i32 s34, s34, 2176
    s_add_u32 s34, s34, 0x580000
    s_waitcnt vmcnt(0)
    s_barrier
    ds_read_b64_tr_b16 v[32:33], v13 offset:0
    ds_read_b64_tr_b16 v[34:35], v13 offset:2048
    ds_read_b64_tr_b16 v[36:37], v13 offset:16384
    ds_read_b64_tr_b16 v[38:39], v13 offset:18432
    ds_read_b64_tr_b16 v[40:41], v13 offset:32768
    ds_read_b64_tr_b16 v[42:43], v13 offset:34816
    ds_read_b64_tr_b16 v[44:45], v13 offset:49152
    ds_read_b64_tr_b16 v[46:47], v13 offset:51200
    s_waitcnt lgkmcnt(0)
    ds_read_b64_tr_b16 v[48:49], v20 offset:0
    ds_read_b64_tr_b16 v[50:51], v20 offset:2048
    ds_read_b64_tr_b16 v[52:53], v20 offset:16384
    ds_read_b64_tr_b16 v[54:55], v20 offset:18432
    ds_read_b64_tr_b16 v[56:57], v20 offset:32768
    ds_read_b64_tr_b16 v[58:59], v20 offset:34816
    ds_read_b64_tr_b16 v[60:61], v20 offset:49152
    ds_read_b64_tr_b16 v[62:63], v20 offset:51200
    s_waitcnt lgkmcnt(0)
    ds_read_b64_tr_b16 v[64:65], v8 offset:0
    ds_read_b64_tr_b16 v[66:67], v8 offset:2048
    ds_read_b64_tr_b16 v[68:69], v8 offset:16384
    ds_read_b64_tr_b16 v[70:71], v8 offset:18432
    ds_read_b64_tr_b16 v[72:73], v8 offset:32768
    ds_read_b64_tr_b16 v[74:75], v8 offset:34816
    ds_read_b64_tr_b16 v[76:77], v8 offset:49152
    ds_read_b64_tr_b16 v[78:79], v8 offset:51200
    s_waitcnt lgkmcnt(0)
    ds_read_b64_tr_b16 v[80:81], v12 offset:0
    ds_read_b64_tr_b16 v[82:83], v12 offset:2048
    ds_read_b64_tr_b16 v[84:85], v12 offset:16384
    ds_read_b64_tr_b16 v[86:87], v12 offset:18432
    ds_read_b64_tr_b16 v[88:89], v12 offset:32768
    ds_read_b64_tr_b16 v[90:91], v12 offset:34816
    ds_read_b64_tr_b16 v[92:93], v12 offset:49152
    ds_read_b64_tr_b16 v[94:95], v12 offset:51200
    s_waitcnt lgkmcnt(0)
    s_cmp_lg_u32 s3, 0
    s_cbranch_scc1 ffn_w3
    v_lshlrev_b32 v23, 4, v1
    v_add_u32 v24, 1024, v23
    s_lshl_b32 s28, s20, 4
    s_add_u32 s28, s28, s34
    v_mov_b32 v10, 34828
    s_nop 4
ffn_p3:
    buffer_load_dword v11, v10, s[4:7], s28 offen sc1
    s_waitcnt vmcnt(0) lgkmcnt(0)
    v_cmp_ne_u32 vcc, s40, v11
    s_cbranch_vccnz ffn_p3_rt
ffn_p3_ok:
    s_mov_b32 s58, 0
    s_mov_b32 s54, -1
    s_nop 1
ffn_k3:
    buffer_load_dwordx4 v[200:203], v23, s[4:7], s34 offen sc1
    buffer_load_dwordx4 v[204:207], v24, s[4:7], s34 offen sc1
    s_waitcnt vmcnt(0)
    v_xor_b32 v208, s40, v203
    v_xor_b32 v209, s40, v207
    v_max_u32 v210, v200, v204
    v_or_b32 v208, v208, v209
    v_cmp_ne_u32 vcc, 0, v208
    s_cbranch_vccnz ffn_k3_rt
ffn_k3_ok:
    v_max_u32_dpp v210, v210, v210 quad_perm:[1,0,3,2] row_mask:0xf bank_mask:0xf
    s_nop 1
    v_max_u32_dpp v210, v210, v210 quad_perm:[2,3,0,1] row_mask:0xf bank_mask:0xf
    s_nop 1
    v_max_u32_dpp v210, v210, v210 row_half_mirror row_mask:0xf bank_mask:0xf
    s_nop 1
    v_max_u32_dpp v210, v210, v210 row_mirror row_mask:0xf bank_mask:0xf
    s_nop 1
    v_max_u32_dpp v210, v210, v210 row_bcast:15 row_mask:0xa bank_mask:0xf
    s_nop 1
    v_max_u32_dpp v210, v210, v210 row_bcast:31 row_mask:0xc bank_mask:0xf
    s_nop 0
    v_readlane_b32 s36, v210, 63
    s_nop 1
    v_cmp_eq_u32 vcc, s36, v200
    v_cmp_eq_u32 s[28:29], s36, v204
    s_nop 0
    s_cmp_lg_u64 vcc, 0
    s_cselect_b32 s39, 0, 64
    s_or_b64 vcc, vcc, s[28:29]
    s_ff1_i32_b64 s41, vcc
    s_add_u32 s39, s39, s41
    s_lshl_b32 s39, s39, 11
    s_add_u32 s39, s39, 0x448000
    s_mov_b32 s58, 0
ffn_c3:
    buffer_load_short_d16_hi v14, v16, s[4:7], s39 offen sc1
    buffer_load_short_d16_hi v15, v17, s[4:7], s39 offen sc1
ffn_c3d:
    v_and_b32 v10, 15, v201
    v_and_b32 v11, 15, v205
    v_cmp_eq_u32 s[24:25], s33, v10
    v_cmp_eq_u32 s[26:27], s33, v11
    s_nop 0
    v_mov_b32 v212, s24
    v_mov_b32 v213, s25
    v_mov_b32 v214, s26
    v_mov_b32 v215, s27
    v_cndmask_b32_e64 v209, v201, v205, s[28:29]
    v_cndmask_b32_e64 v210, v202, v206, s[28:29]
    ds_write_b128 v28, v[212:215] offset:16
    v_readlane_b32 s24, v209, s41
    v_readlane_b32 s25, v210, s41
    s_mov_b64 s[42:43], vcc
    s_and_b32 s24, s24, 0xffff0000
    s_mov_b32 s26, 0xffff0000
    s_waitcnt vmcnt(0)
    v_max_u32 v10, v14, v15
    v_add_f32 v14, s24, v14
    v_add_f32 v15, s24, v15
    v_cvt_pk_bf16_f32 v14, 0, v14
    v_cvt_pk_bf16_f32 v15, 0, v15
    v_mul_f32 v14, s25, v14
    v_mul_f32 v15, s25, v15
    v_cvt_pk_bf16_f32 v14, v14, v15
    ds_write_b32 v18, v14
    v_cmp_eq_u32 vcc, s26, v10
    s_cbranch_vccnz ffn_c3_rt
ffn_c3_ok:
    s_waitcnt lgkmcnt(0)
    s_nop 2
ffn_w3:
    s_barrier
    ds_read_b32 v203, v22
    ds_read_b128 v[128:131], v19 offset:0
    ds_read_b128 v[132:135], v19 offset:64
    ds_read_b128 v[136:139], v19 offset:128
    ds_read_b128 v[140:143], v19 offset:192
    s_waitcnt lgkmcnt(3)
    v_mfma_f32_16x16x32_bf16 v[192:195], v[32:35], v[128:131], 0
    v_mfma_f32_16x16x32_bf16 v[148:151], v[48:51], v[128:131], 0
    v_mfma_f32_16x16x32_bf16 v[152:155], v[64:67], v[128:131], 0
    v_mfma_f32_16x16x32_bf16 v[156:159], v[80:83], v[128:131], 0
    s_waitcnt lgkmcnt(2)
    v_mfma_f32_16x16x32_bf16 v[192:195], v[36:39], v[132:135], v[192:195]
    v_mfma_f32_16x16x32_bf16 v[148:151], v[52:55], v[132:135], v[148:151]
    v_mfma_f32_16x16x32_bf16 v[152:155], v[68:71], v[132:135], v[152:155]
    v_mfma_f32_16x16x32_bf16 v[156:159], v[84:87], v[132:135], v[156:159]
    s_waitcnt lgkmcnt(1)
    v_mfma_f32_16x16x32_bf16 v[192:195], v[40:43], v[136:139], v[192:195]
    v_mfma_f32_16x16x32_bf16 v[148:151], v[56:59], v[136:139], v[148:151]
    v_mfma_f32_16x16x32_bf16 v[152:155], v[72:75], v[136:139], v[152:155]
    v_mfma_f32_16x16x32_bf16 v[156:159], v[88:91], v[136:139], v[156:159]
    s_waitcnt lgkmcnt(0)
    v_mfma_f32_16x16x32_bf16 v[192:195], v[44:47], v[140:143], v[192:195]
    v_mfma_f32_16x16x32_bf16 v[148:151], v[60:63], v[140:143], v[148:151]
    v_mfma_f32_16x16x32_bf16 v[152:155], v[76:79], v[140:143], v[152:155]
    v_mfma_f32_16x16x32_bf16 v[156:159], v[92:95], v[140:143], v[156:159]
    v_readfirstlane_b32 s24, v203
    s_nop 4
    v_cndmask_b32_e64 v192, v192, v148, s[60:61]
    v_cndmask_b32_e64 v193, v193, v149, s[60:61]
    v_cndmask_b32_e64 v194, v194, v150, s[60:61]
    v_cndmask_b32_e64 v195, v195, v151, s[60:61]
    v_cndmask_b32_e64 v192, v192, v152, s[62:63]
    v_cndmask_b32_e64 v193, v193, v153, s[62:63]
    v_cndmask_b32_e64 v194, v194, v154, s[62:63]
    v_cndmask_b32_e64 v195, v195, v155, s[62:63]
    v_cndmask_b32_e64 v192, v192, v156, s[64:65]
    v_cndmask_b32_e64 v193, v193, v157, s[64:65]
    v_cndmask_b32_e64 v194, v194, v158, s[64:65]
    v_cndmask_b32_e64 v195, v195, v159, s[64:65]
    s_mov_b32 exec_lo, 0x000f000f
    s_mov_b32 exec_hi, 0x000f000f
    v_and_or_b32 v192, v192, v197, s48
    v_and_or_b32 v193, v193, v197, s49
    v_and_or_b32 v194, v194, v197, s50
    v_and_or_b32 v195, v195, v197, s51
    s_bitcmp1_b32 s24, s35
    s_cbranch_scc0 ffn_rem
    buffer_store_dwordx4 v[192:195], v30, s[4:7], s30 offen
ffn_fin:
    s_endpgm
ffn_rem:
    buffer_store_dwordx4 v[192:195], v30, s[4:7], s30 offen sc1
    s_branch ffn_fin
ffn_c3_rt:
    s_mov_b64 vcc, s[42:43]
    s_add_u32 s58, s58, 1
    s_cmp_lt_u32 s58, 0x10000
    s_cbranch_scc1 ffn_c3
    s_branch ffn_c3_ok
fz_h1_r0:
    s_add_u32 s58, s58, 1
    s_cmp_gt_u32 s58, 0x10000
    s_cbranch_scc1 fz_h1_o0
    buffer_load_dwordx4 v[104:107], v222, s[4:7], s60 offen sc1
    buffer_load_dwordx4 v[108:111], v222, s[4:7], s61 offen sc1
    buffer_load_dwordx4 v[112:115], v222, s[4:7], s16 offen sc1
    buffer_load_dwordx4 v[116:119], v222, s[4:7], s17 offen sc1
    s_branch fz_h1_c0
fz_h1_r1:
    s_add_u32 s58, s58, 1
    s_cmp_gt_u32 s58, 0x10000
    s_cbranch_scc1 fz_h1_o1
    buffer_load_dwordx4 v[108:111], v222, s[4:7], s61 offen sc1
    buffer_load_dwordx4 v[112:115], v222, s[4:7], s16 offen sc1
    buffer_load_dwordx4 v[116:119], v222, s[4:7], s17 offen sc1
    s_branch fz_h1_c1
fz_h1_r2:
    s_add_u32 s58, s58, 1
    s_cmp_gt_u32 s58, 0x10000
    s_cbranch_scc1 fz_h1_o2
    buffer_load_dwordx4 v[112:115], v222, s[4:7], s16 offen sc1
    buffer_load_dwordx4 v[116:119], v222, s[4:7], s17 offen sc1
    s_branch fz_h1_c2
fz_h1_r3:
    s_add_u32 s58, s58, 1
    s_cmp_gt_u32 s58, 0x10000
    s_cbranch_scc1 fz_h1_o3
    buffer_load_dwordx4 v[116:119], v222, s[4:7], s17 offen sc1
    s_branch fz_h1_c3
fz_h2_r0:
    s_add_u32 s58, s58, 1
    s_cmp_gt_u32 s58, 0x10000
    s_cbranch_scc1 fz_h2_o0
    buffer_load_dwordx2 v[104:105], v228, s[4:7], s52 offen sc1
    buffer_load_dwordx2 v[106:107], v228, s[4:7], s53 offen sc1
    buffer_load_dwordx2 v[108:109], v228, s[4:7], s54 offen sc1
    buffer_load_dwordx2 v[110:111], v228, s[4:7], s55 offen sc1
    s_branch fz_h2_c0
fz_h2_r1:
    s_add_u32 s58, s58, 1
    s_cmp_gt_u32 s58, 0x10000
    s_cbranch_scc1 fz_h2_o1
    buffer_load_dwordx2 v[106:107], v228, s[4:7], s53 offen sc1
    buffer_load_dwordx2 v[108:109], v228, s[4:7], s54 offen sc1
    buffer_load_dwordx2 v[110:111], v228, s[4:7], s55 offen sc1
    s_branch fz_h2_c1
fz_h2_r2:
    s_add_u32 s58, s58, 1
    s_cmp_gt_u32 s58, 0x10000
    s_cbranch_scc1 fz_h2_o2
    buffer_load_dwordx2 v[108:109], v228, s[4:7], s54 offen sc1
    buffer_load_dwordx2 v[110:111], v228, s[4:7], s55 offen sc1
    s_branch fz_h2_c2
fz_h2_r3:
    s_add_u32 s58, s58, 1
    s_cmp_gt_u32 s58, 0x10000
    s_cbranch_scc1 fz_h2_o3
    buffer_load_dwordx2 v[110:111], v228, s[4:7], s55 offen sc1
    s_branch fz_h2_c3
fz_h5_r0:
    s_add_u32 s58, s58, 1
    s_cmp_gt_u32 s58, 0x10000
    s_cbranch_scc1 fz_h5_o0
    buffer_load_dwordx4 v[40:43], v3, s[4:7], s52 offen sc1
    buffer_load_dwordx4 v[44:47], v3, s[4:7], s53 offen sc1
    buffer_load_dwordx4 v[48:51], v3, s[4:7], s54 offen sc1
    buffer_load_dwordx4 v[52:55], v6, s[4:7], s55 offen sc1
    s_branch fz_h5_c0
fz_h5_r1:
    s_add_u32 s58, s58, 1
    s_cmp_gt_u32 s58, 0x10000
    s_cbranch_scc1 fz_h5_o1
    buffer_load_dwordx4 v[44:47], v3, s[4:7], s53 offen sc1
    buffer_load_dwordx4 v[48:51], v3, s[4:7], s54 offen sc1
    buffer_load_dwordx4 v[52:55], v6, s[4:7], s55 offen sc1
    s_branch fz_h5_c1
fz_h5_r2:
    s_add_u32 s58, s58, 1
    s_cmp_gt_u32 s58, 0x10000
    s_cbranch_scc1 fz_h5_o2
    buffer_load_dwordx4 v[48:51], v3, s[4:7], s54 offen sc1
    buffer_load_dwordx4 v[52:55], v6, s[4:7], s55 offen sc1
    s_branch fz_h5_c2
fz_h5_r3:
    s_add_u32 s58, s58, 1
    s_cmp_gt_u32 s58, 0x10000
    s_cbranch_scc1 fz_h5_o3
    buffer_load_dwordx4 v[52:55], v6, s[4:7], s55 offen sc1
    s_branch fz_h5_c3
fz_p1_rt:
    s_add_u32 s58, s58, 1
    s_cmp_lt_u32 s58, 0x10000
    s_cbranch_scc1 fz_p1
    s_branch fz_p1_ok
fz_k2_rt:
    s_add_u32 s58, s58, 1
    s_cmp_lt_u32 s58, 0x10000
    s_cbranch_scc1 fz_k2
    s_branch fz_k2_ok
fz_c2_rt:
    s_add_u32 s58, s58, 1
    s_cmp_lt_u32 s58, 0x10000
    s_cbranch_scc1 fz_c2
    s_branch fz_c2_ok
fz_p5_rt:
    s_add_u32 s58, s58, 1
    s_cmp_lt_u32 s58, 0x10000
    s_cbranch_scc1 fz_p5
    s_branch fz_p5_ok
fz_h4_rt:
    s_add_u32 s58, s58, 1
    s_cmp_lt_u32 s58, 0x10000
    s_cbranch_scc1 fz_h4
    s_branch fz_h4_ok
ffn_p3_rt:
    s_add_u32 s58, s58, 1
    s_cmp_lt_u32 s58, 0x10000
    s_cbranch_scc1 ffn_p3
    s_branch ffn_p3_ok
ffn_k3_rt:
    s_add_u32 s58, s58, 1
    s_cmp_lt_u32 s58, 0x10000
    s_cbranch_scc1 ffn_k3
    s_branch ffn_k3_ok
fz_codeend:
.section .rodata,"a"
.p2align 6
.amdhsa_kernel fz_kernel
  .amdhsa_next_free_vgpr 256
  .amdhsa_next_free_sgpr 102
  .amdhsa_accum_offset 256
  .amdhsa_group_segment_fixed_size 0
  .amdhsa_kernarg_size 104
  .amdhsa_user_sgpr_count 2
  .amdhsa_user_sgpr_kernarg_segment_ptr 1
  .amdhsa_system_sgpr_workgroup_id_x 1
.end_amdhsa_kernel
```
